```python
import torch

def _softmax(x, axis=-1):
    return torch.softmax(x, dim=axis)

def _gelu(x):
    return torch.nn.functional.gelu(x, approximate='tanh')

def _silu(x):
    return torch.nn.functional.silu(x)

def _sigmoid(x):
    return torch.sigmoid(x)

def _layernorm(x, axis=-1, eps=1e-05):
    m = x.mean(dim=axis, keepdim=True)
    v = x.var(dim=axis, keepdim=True, unbiased=False)
    return (x - m) / torch.sqrt(v + eps)

def _scatter_add(tgt, idx, src, axis=0):
    return tgt.clone().index_add_(axis, idx, src)

def _segment_sum(src, seg, n):
    out = torch.zeros((n,) + src.shape[1:], dtype=src.dtype)
    return out.index_add_(0, seg, src)

def _pad(x, pw):
    flat = tuple((v for pair in reversed(pw) for v in pair))
    return torch.nn.functional.pad(x, flat)
kernel_name = 'adaLN_cond__spectral_gfnet__mixer_token_mlp__prompt'

def setup_inputs():

    _w = lambda a: (lambda t: t.to(torch.bfloat16) if t.is_floating_point() else t)(torch.as_tensor(a))

    def _A_setup():
        B, S, D = (1, 2048, 576)
        Df = D // 2 + 1
        return {'x': _w((lambda *s: torch.randn(*s, dtype=torch.bfloat16) * 0.05)(B, S, D)), 'w_r': _w((lambda *s: torch.randn(*s, dtype=torch.bfloat16) * 1.6)(S, Df) * 0.02), 'w_i': _w((lambda *s: torch.randn(*s, dtype=torch.bfloat16) * 1.6)(S, Df) * 0.02)}
    _A_in = _A_setup()

    def _B_setup():
        B, S, D, F = (1, 2048, 576, 4608)
        return {'x': _w((lambda *s: torch.randn(*s, dtype=torch.bfloat16) * 0.05)(B, S, D)), 'w1': _w((lambda *s: torch.randn(*s, dtype=torch.bfloat16) * 0.8)(S, F) * S ** (-0.5)), 'b1': _w((lambda *s: torch.randn(*s, dtype=torch.bfloat16) * 12.8)(F) * 0.02), 'w2': _w((lambda *s: torch.randn(*s, dtype=torch.bfloat16) * 0.2)(F, S) * F ** (-0.5)), 'b2': _w((lambda *s: torch.randn(*s, dtype=torch.bfloat16) * 1.6)(S) * 0.02)}
    _B_in = _B_setup()
    return {'A_x': _A_in['x'], 'A_w_r': _A_in['w_r'], 'A_w_i': _A_in['w_i'], 'B_x': _B_in['x'], 'B_w1': _B_in['w1'], 'B_b1': _B_in['b1'], 'B_w2': _B_in['w2'], 'B_b2': _B_in['b2'], 'c': _w((lambda *s: torch.randn(*s, dtype=torch.bfloat16) * 0.1)(1, 576) * 8.0), 'w_mod': _w((lambda *s: torch.randn(*s, dtype=torch.bfloat16) * 0.1)(576, 6 * 576) * 576 ** (-0.5) * 8.0)}

def reference(A_x, A_w_r, A_w_i, B_x, B_w1, B_b1, B_w2, B_b2, c, w_mod):

    def _A_ref(x, w_r, w_i):
        B, S, D = x.shape
        X = (lambda x, axes=(-2, -1): torch.fft.rfft2(x.float(), dim=axes))(x, axes=(-2, -1))
        W = w_r + 1j * w_i
        X = X * W
        y = (lambda x, s, axes=(-2, -1): torch.fft.irfft2(x, s=s, dim=axes).to(torch.bfloat16))(X, (S, D), axes=(-2, -1))
        return y

    def _B_ref(x, w1, b1, w2, b2):
        B, S, D = x.shape
        h = _layernorm(x, axis=-1)
        u = torch.einsum('bsd,sf->bdf', h, w1) + b1
        u = _gelu(u)
        y = torch.einsum('bdf,fs->bds', u, w2) + b2
        return (lambda x, *d: x.permute(*d))(y, 0, 2, 1)
    x = A_x
    mod = (_silu(c) @ w_mod).reshape(c.shape[0], 6, 1, -1)
    sa, ca, ga, sb, cb, gb = (mod[:, 0].clone(), mod[:, 1].clone(), mod[:, 2].clone(), mod[:, 3].clone(), mod[:, 4].clone(), mod[:, 5].clone())
    h = _layernorm(x, axis=-1) * (1 + ca) + sa
    x = x + ga * _A_ref(h, A_w_r, A_w_i)
    h = _layernorm(x, axis=-1) * (1 + cb) + sb
    x = x + gb * _B_ref(h, B_w1, B_b1, B_w2, B_b2)
    return x
```

```asm
; @launch kernel=p0_kernel grid=(172,1,1) block=(256,1,1) lds=37376
; @launch kernel=p1_kernel grid=(256,1,1) block=(512,1,1) lds=13056
; @launch kernel=p2_kernel grid=(289,1,1) block=(256,1,1) lds=8704
; @launch kernel=p3_kernel grid=(256,1,1) block=(512,1,1) lds=12032
; @launch kernel=g1_kernel grid=(216,1,1) block=(512,1,1) lds=143360
; @launch kernel=g2_kernel grid=(256,1,1) block=(512,1,1) lds=139264
.amdgcn_target "amdgcn-amd-amdhsa--gfx950"
.text
.globl p0_kernel
.p2align 8
.type p0_kernel,@function
p0_kernel:
    s_cmp_ge_u32 s2, 172
    s_cbranch_scc1 p0_done
    s_load_dwordx2 s[4:5], s[0:1], 96
    s_cmp_ge_u32 s2, 108
    s_cbranch_scc1 p0_wt
    s_load_dwordx4 s[8:11], s[0:1], 64
    v_and_b32 v1, 3, v0
    v_lshrrev_b32 v2, 2, v0
    s_movk_i32 s3, 6912
    v_mul_lo_u32 v3, v2, s3
    v_lshl_add_u32 v3, v1, 4, v3
    v_lshlrev_b32 v4, 1, v2
    s_lshl_b32 s24, s2, 6
    v_mov_b32 v8, 0
    v_mov_b32 v9, 0
    v_mov_b32 v10, 0
    v_mov_b32 v11, 0
    v_mov_b32 v12, 0
    v_mov_b32 v13, 0
    v_mov_b32 v14, 0
    v_mov_b32 v15, 0
    v_mov_b32 v16, 0
    s_waitcnt lgkmcnt(0)
    s_mov_b32 s12, s8
    s_mov_b32 s13, s9
    s_mov_b32 s14, 0x480
    s_mov_b32 s15, 0x20000
    s_mov_b32 s16, s10
    s_mov_b32 s17, s11
    s_mov_b32 s18, 0x3cc000
    s_mov_b32 s19, 0x20000
    s_mov_b32 s20, s4
    s_mov_b32 s21, s5
    s_mov_b32 s22, 0x3600
    s_mov_b32 s23, 0x20000
    buffer_load_short_d16_hi v8, v4, s[12:15], 0 offen offset:0
    buffer_load_short_d16_hi v9, v4, s[12:15], 0 offen offset:128
    buffer_load_short_d16_hi v10, v4, s[12:15], 0 offen offset:256
    buffer_load_short_d16_hi v11, v4, s[12:15], 0 offen offset:384
    buffer_load_short_d16_hi v12, v4, s[12:15], 0 offen offset:512
    buffer_load_short_d16_hi v13, v4, s[12:15], 0 offen offset:640
    buffer_load_short_d16_hi v14, v4, s[12:15], 0 offen offset:768
    buffer_load_short_d16_hi v15, v4, s[12:15], 0 offen offset:896
    buffer_load_short_d16_hi v16, v4, s[12:15], 0 offen offset:1024
    buffer_load_dwordx4 v[20:23], v3, s[16:19], s24 offen
    s_add_u32 s24, s24, 442368
    buffer_load_dwordx4 v[24:27], v3, s[16:19], s24 offen
    s_add_u32 s24, s24, 442368
    buffer_load_dwordx4 v[28:31], v3, s[16:19], s24 offen
    s_add_u32 s24, s24, 442368
    buffer_load_dwordx4 v[32:35], v3, s[16:19], s24 offen
    s_add_u32 s24, s24, 442368
    buffer_load_dwordx4 v[36:39], v3, s[16:19], s24 offen
    s_add_u32 s24, s24, 442368
    buffer_load_dwordx4 v[40:43], v3, s[16:19], s24 offen
    s_add_u32 s24, s24, 442368
    buffer_load_dwordx4 v[44:47], v3, s[16:19], s24 offen
    s_add_u32 s24, s24, 442368
    buffer_load_dwordx4 v[48:51], v3, s[16:19], s24 offen
    s_add_u32 s24, s24, 442368
    buffer_load_dwordx4 v[52:55], v3, s[16:19], s24 offen
    s_mov_b32 s25, 0xffff0000
    v_mov_b32 v60, 0
    v_mov_b32 v61, 0
    v_mov_b32 v62, 0
    v_mov_b32 v63, 0
    v_mov_b32 v64, 0
    v_mov_b32 v65, 0
    v_mov_b32 v66, 0
    v_mov_b32 v67, 0
    s_waitcnt vmcnt(9)
    v_mul_f32 v70, 0xbfb8aa3b, v8
    v_exp_f32 v70, v70
    s_nop 0
    v_add_f32 v70, 1.0, v70
    v_rcp_f32 v70, v70
    s_nop 0
    v_mul_f32 v8, v8, v70
    v_cvt_pk_bf16_f32 v8, v8, v8
    v_lshlrev_b32 v8, 16, v8
    v_mul_f32 v71, 0xbfb8aa3b, v9
    v_exp_f32 v71, v71
    s_nop 0
    v_add_f32 v71, 1.0, v71
    v_rcp_f32 v71, v71
    s_nop 0
    v_mul_f32 v9, v9, v71
    v_cvt_pk_bf16_f32 v9, v9, v9
    v_lshlrev_b32 v9, 16, v9
    v_mul_f32 v70, 0xbfb8aa3b, v10
    v_exp_f32 v70, v70
    s_nop 0
    v_add_f32 v70, 1.0, v70
    v_rcp_f32 v70, v70
    s_nop 0
    v_mul_f32 v10, v10, v70
    v_cvt_pk_bf16_f32 v10, v10, v10
    v_lshlrev_b32 v10, 16, v10
    v_mul_f32 v71, 0xbfb8aa3b, v11
    v_exp_f32 v71, v71
    s_nop 0
    v_add_f32 v71, 1.0, v71
    v_rcp_f32 v71, v71
    s_nop 0
    v_mul_f32 v11, v11, v71
    v_cvt_pk_bf16_f32 v11, v11, v11
    v_lshlrev_b32 v11, 16, v11
    v_mul_f32 v70, 0xbfb8aa3b, v12
    v_exp_f32 v70, v70
    s_nop 0
    v_add_f32 v70, 1.0, v70
    v_rcp_f32 v70, v70
    s_nop 0
    v_mul_f32 v12, v12, v70
    v_cvt_pk_bf16_f32 v12, v12, v12
    v_lshlrev_b32 v12, 16, v12
    v_mul_f32 v71, 0xbfb8aa3b, v13
    v_exp_f32 v71, v71
    s_nop 0
    v_add_f32 v71, 1.0, v71
    v_rcp_f32 v71, v71
    s_nop 0
    v_mul_f32 v13, v13, v71
    v_cvt_pk_bf16_f32 v13, v13, v13
    v_lshlrev_b32 v13, 16, v13
    v_mul_f32 v70, 0xbfb8aa3b, v14
    v_exp_f32 v70, v70
    s_nop 0
    v_add_f32 v70, 1.0, v70
    v_rcp_f32 v70, v70
    s_nop 0
    v_mul_f32 v14, v14, v70
    v_cvt_pk_bf16_f32 v14, v14, v14
    v_lshlrev_b32 v14, 16, v14
    v_mul_f32 v71, 0xbfb8aa3b, v15
    v_exp_f32 v71, v71
    s_nop 0
    v_add_f32 v71, 1.0, v71
    v_rcp_f32 v71, v71
    s_nop 0
    v_mul_f32 v15, v15, v71
    v_cvt_pk_bf16_f32 v15, v15, v15
    v_lshlrev_b32 v15, 16, v15
    v_mul_f32 v70, 0xbfb8aa3b, v16
    v_exp_f32 v70, v70
    s_nop 0
    v_add_f32 v70, 1.0, v70
    v_rcp_f32 v70, v70
    s_nop 0
    v_mul_f32 v16, v16, v70
    v_cvt_pk_bf16_f32 v16, v16, v16
    v_lshlrev_b32 v16, 16, v16
    s_waitcnt vmcnt(8)
    v_lshlrev_b32 v72, 16, v20
    v_and_b32 v73, s25, v20
    v_fmac_f32 v60, v8, v72
    v_fmac_f32 v61, v8, v73
    v_lshlrev_b32 v72, 16, v21
    v_and_b32 v73, s25, v21
    v_fmac_f32 v62, v8, v72
    v_fmac_f32 v63, v8, v73
    v_lshlrev_b32 v72, 16, v22
    v_and_b32 v73, s25, v22
    v_fmac_f32 v64, v8, v72
    v_fmac_f32 v65, v8, v73
    v_lshlrev_b32 v72, 16, v23
    v_and_b32 v73, s25, v23
    v_fmac_f32 v66, v8, v72
    v_fmac_f32 v67, v8, v73
    s_waitcnt vmcnt(7)
    v_lshlrev_b32 v72, 16, v24
    v_and_b32 v73, s25, v24
    v_fmac_f32 v60, v9, v72
    v_fmac_f32 v61, v9, v73
    v_lshlrev_b32 v72, 16, v25
    v_and_b32 v73, s25, v25
    v_fmac_f32 v62, v9, v72
    v_fmac_f32 v63, v9, v73
    v_lshlrev_b32 v72, 16, v26
    v_and_b32 v73, s25, v26
    v_fmac_f32 v64, v9, v72
    v_fmac_f32 v65, v9, v73
    v_lshlrev_b32 v72, 16, v27
    v_and_b32 v73, s25, v27
    v_fmac_f32 v66, v9, v72
    v_fmac_f32 v67, v9, v73
    s_waitcnt vmcnt(6)
    v_lshlrev_b32 v72, 16, v28
    v_and_b32 v73, s25, v28
    v_fmac_f32 v60, v10, v72
    v_fmac_f32 v61, v10, v73
    v_lshlrev_b32 v72, 16, v29
    v_and_b32 v73, s25, v29
    v_fmac_f32 v62, v10, v72
    v_fmac_f32 v63, v10, v73
    v_lshlrev_b32 v72, 16, v30
    v_and_b32 v73, s25, v30
    v_fmac_f32 v64, v10, v72
    v_fmac_f32 v65, v10, v73
    v_lshlrev_b32 v72, 16, v31
    v_and_b32 v73, s25, v31
    v_fmac_f32 v66, v10, v72
    v_fmac_f32 v67, v10, v73
    s_waitcnt vmcnt(5)
    v_lshlrev_b32 v72, 16, v32
    v_and_b32 v73, s25, v32
    v_fmac_f32 v60, v11, v72
    v_fmac_f32 v61, v11, v73
    v_lshlrev_b32 v72, 16, v33
    v_and_b32 v73, s25, v33
    v_fmac_f32 v62, v11, v72
    v_fmac_f32 v63, v11, v73
    v_lshlrev_b32 v72, 16, v34
    v_and_b32 v73, s25, v34
    v_fmac_f32 v64, v11, v72
    v_fmac_f32 v65, v11, v73
    v_lshlrev_b32 v72, 16, v35
    v_and_b32 v73, s25, v35
    v_fmac_f32 v66, v11, v72
    v_fmac_f32 v67, v11, v73
    s_waitcnt vmcnt(4)
    v_lshlrev_b32 v72, 16, v36
    v_and_b32 v73, s25, v36
    v_fmac_f32 v60, v12, v72
    v_fmac_f32 v61, v12, v73
    v_lshlrev_b32 v72, 16, v37
    v_and_b32 v73, s25, v37
    v_fmac_f32 v62, v12, v72
    v_fmac_f32 v63, v12, v73
    v_lshlrev_b32 v72, 16, v38
    v_and_b32 v73, s25, v38
    v_fmac_f32 v64, v12, v72
    v_fmac_f32 v65, v12, v73
    v_lshlrev_b32 v72, 16, v39
    v_and_b32 v73, s25, v39
    v_fmac_f32 v66, v12, v72
    v_fmac_f32 v67, v12, v73
    s_waitcnt vmcnt(3)
    v_lshlrev_b32 v72, 16, v40
    v_and_b32 v73, s25, v40
    v_fmac_f32 v60, v13, v72
    v_fmac_f32 v61, v13, v73
    v_lshlrev_b32 v72, 16, v41
    v_and_b32 v73, s25, v41
    v_fmac_f32 v62, v13, v72
    v_fmac_f32 v63, v13, v73
    v_lshlrev_b32 v72, 16, v42
    v_and_b32 v73, s25, v42
    v_fmac_f32 v64, v13, v72
    v_fmac_f32 v65, v13, v73
    v_lshlrev_b32 v72, 16, v43
    v_and_b32 v73, s25, v43
    v_fmac_f32 v66, v13, v72
    v_fmac_f32 v67, v13, v73
    s_waitcnt vmcnt(2)
    v_lshlrev_b32 v72, 16, v44
    v_and_b32 v73, s25, v44
    v_fmac_f32 v60, v14, v72
    v_fmac_f32 v61, v14, v73
    v_lshlrev_b32 v72, 16, v45
    v_and_b32 v73, s25, v45
    v_fmac_f32 v62, v14, v72
    v_fmac_f32 v63, v14, v73
    v_lshlrev_b32 v72, 16, v46
    v_and_b32 v73, s25, v46
    v_fmac_f32 v64, v14, v72
    v_fmac_f32 v65, v14, v73
    v_lshlrev_b32 v72, 16, v47
    v_and_b32 v73, s25, v47
    v_fmac_f32 v66, v14, v72
    v_fmac_f32 v67, v14, v73
    s_waitcnt vmcnt(1)
    v_lshlrev_b32 v72, 16, v48
    v_and_b32 v73, s25, v48
    v_fmac_f32 v60, v15, v72
    v_fmac_f32 v61, v15, v73
    v_lshlrev_b32 v72, 16, v49
    v_and_b32 v73, s25, v49
    v_fmac_f32 v62, v15, v72
    v_fmac_f32 v63, v15, v73
    v_lshlrev_b32 v72, 16, v50
    v_and_b32 v73, s25, v50
    v_fmac_f32 v64, v15, v72
    v_fmac_f32 v65, v15, v73
    v_lshlrev_b32 v72, 16, v51
    v_and_b32 v73, s25, v51
    v_fmac_f32 v66, v15, v72
    v_fmac_f32 v67, v15, v73
    s_waitcnt vmcnt(0)
    v_lshlrev_b32 v72, 16, v52
    v_and_b32 v73, s25, v52
    v_fmac_f32 v60, v16, v72
    v_fmac_f32 v61, v16, v73
    v_lshlrev_b32 v72, 16, v53
    v_and_b32 v73, s25, v53
    v_fmac_f32 v62, v16, v72
    v_fmac_f32 v63, v16, v73
    v_lshlrev_b32 v72, 16, v54
    v_and_b32 v73, s25, v54
    v_fmac_f32 v64, v16, v72
    v_fmac_f32 v65, v16, v73
    v_lshlrev_b32 v72, 16, v55
    v_and_b32 v73, s25, v55
    v_fmac_f32 v66, v16, v72
    v_fmac_f32 v67, v16, v73
    v_add_f32_dpp v60, v60, v60 row_ror:4 row_mask:0xf bank_mask:0xf
    v_add_f32_dpp v61, v61, v61 row_ror:4 row_mask:0xf bank_mask:0xf
    v_add_f32_dpp v62, v62, v62 row_ror:4 row_mask:0xf bank_mask:0xf
    v_add_f32_dpp v63, v63, v63 row_ror:4 row_mask:0xf bank_mask:0xf
    v_add_f32_dpp v64, v64, v64 row_ror:4 row_mask:0xf bank_mask:0xf
    v_add_f32_dpp v65, v65, v65 row_ror:4 row_mask:0xf bank_mask:0xf
    v_add_f32_dpp v66, v66, v66 row_ror:4 row_mask:0xf bank_mask:0xf
    v_add_f32_dpp v67, v67, v67 row_ror:4 row_mask:0xf bank_mask:0xf
    v_add_f32_dpp v60, v60, v60 row_ror:8 row_mask:0xf bank_mask:0xf
    v_add_f32_dpp v61, v61, v61 row_ror:8 row_mask:0xf bank_mask:0xf
    v_add_f32_dpp v62, v62, v62 row_ror:8 row_mask:0xf bank_mask:0xf
    v_add_f32_dpp v63, v63, v63 row_ror:8 row_mask:0xf bank_mask:0xf
    v_add_f32_dpp v64, v64, v64 row_ror:8 row_mask:0xf bank_mask:0xf
    v_add_f32_dpp v65, v65, v65 row_ror:8 row_mask:0xf bank_mask:0xf
    v_add_f32_dpp v66, v66, v66 row_ror:8 row_mask:0xf bank_mask:0xf
    v_add_f32_dpp v67, v67, v67 row_ror:8 row_mask:0xf bank_mask:0xf
    v_lshrrev_b32 v5, 4, v0
    v_lshlrev_b32 v5, 7, v5
    v_lshl_add_u32 v5, v1, 5, v5
    v_and_b32 v6, 15, v0
    v_cmp_gt_u32 vcc, 4, v6
    s_nop 0
    s_and_saveexec_b64 s[26:27], vcc
    ds_write_b128 v5, v[60:63]
    ds_write_b128 v5, v[64:67] offset:16
    s_mov_b64 exec, s[26:27]
    s_waitcnt lgkmcnt(0)
    s_barrier
    v_cmp_gt_u32 vcc, 32, v0
    s_nop 0
    s_and_saveexec_b64 s[26:27], vcc
    s_cbranch_execz p0_end
    v_lshlrev_b32 v5, 2, v0
    ds_read_b32 v20, v5 offset:0
    ds_read_b32 v21, v5 offset:128
    ds_read_b32 v22, v5 offset:256
    ds_read_b32 v23, v5 offset:384
    ds_read_b32 v24, v5 offset:512
    ds_read_b32 v25, v5 offset:640
    ds_read_b32 v26, v5 offset:768
    ds_read_b32 v27, v5 offset:896
    ds_read_b32 v28, v5 offset:1024
    ds_read_b32 v29, v5 offset:1152
    ds_read_b32 v30, v5 offset:1280
    ds_read_b32 v31, v5 offset:1408
    ds_read_b32 v32, v5 offset:1536
    ds_read_b32 v33, v5 offset:1664
    ds_read_b32 v34, v5 offset:1792
    ds_read_b32 v35, v5 offset:1920
    s_waitcnt lgkmcnt(0)
    v_add_f32 v20, v20, v21
    v_add_f32 v22, v22, v23
    v_add_f32 v24, v24, v25
    v_add_f32 v26, v26, v27
    v_add_f32 v28, v28, v29
    v_add_f32 v30, v30, v31
    v_add_f32 v32, v32, v33
    v_add_f32 v34, v34, v35
    v_add_f32 v20, v20, v22
    v_add_f32 v24, v24, v26
    v_add_f32 v28, v28, v30
    v_add_f32 v32, v32, v34
    v_add_f32 v20, v20, v24
    v_add_f32 v28, v28, v32
    v_add_f32 v20, v20, v28
    v_cvt_pk_bf16_f32 v20, v20, v20
    v_lshlrev_b32 v20, 16, v20
    v_add_f32 v21, 1.0, v20
    v_cvt_pk_bf16_f32 v21, v21, v21
    v_lshlrev_b32 v21, 16, v21
    s_sub_u32 s28, s2, 18
    s_cmp_lt_u32 s28, 18
    s_cselect_b32 s29, 1, 0
    s_sub_u32 s28, s2, 72
    s_cmp_lt_u32 s28, 18
    s_cselect_b32 s29, 1, s29
    s_cmp_eq_u32 s29, 1
    s_cbranch_scc0 p0_nop1
    v_mov_b32 v20, v21
p0_nop1:
    s_lshl_b32 s24, s2, 7
    buffer_store_dword v20, v5, s[20:23], s24 offen
    s_branch p0_end
p0_wt:
    s_load_dwordx4 s[8:11], s[0:1], 8
    s_sub_u32 s3, s2, 108
    s_and_b32 s24, s3, 7
    s_lshr_b32 s25, s3, 3
    s_lshl_b32 s26, s24, 3
    s_lshl_b32 s27, s25, 8
    s_add_u32 s26, s26, s27
    s_mul_i32 s26, s26, 578
    v_lshlrev_b32 v1, 4, v0
    s_waitcnt lgkmcnt(0)
    s_mov_b32 s12, s8
    s_mov_b32 s13, s9
    s_mov_b32 s14, 0x121000
    s_mov_b32 s15, 0x20000
    s_mov_b32 s16, s10
    s_mov_b32 s17, s11
    s_mov_b32 s18, 0x121000
    s_mov_b32 s19, 0x20000
    s_add_u32 s20, s4, 0x100000
    s_addc_u32 s21, s5, 0
    s_mov_b32 s22, 0x242000
    s_mov_b32 s23, 0x20000
    s_add_u32 s36, s4, 0x10000
    s_addc_u32 s37, s5, 0
    s_mov_b32 s38, 0x10000
    s_mov_b32 s39, 0x20000
    v_lshlrev_b32 v2, 2, v0
    v_mov_b32 v3, 0
    s_lshl_b32 s40, s3, 10
    buffer_store_dword v3, v2, s[36:39], s40 offen
    s_add_u32 s28, s26, 0
    s_add_u32 s29, s26, 36992
    s_add_u32 s30, s26, 73984
    s_add_u32 s31, s26, 110976
    buffer_load_dwordx4 v[8:11], v1, s[12:15], s28 offen
    buffer_load_dwordx4 v[12:15], v1, s[12:15], s29 offen
    buffer_load_dwordx4 v[16:19], v1, s[12:15], s30 offen
    buffer_load_dwordx4 v[20:23], v1, s[12:15], s31 offen
    buffer_load_dwordx4 v[24:27], v1, s[16:19], s28 offen
    buffer_load_dwordx4 v[28:31], v1, s[16:19], s29 offen
    buffer_load_dwordx4 v[32:35], v1, s[16:19], s30 offen
    buffer_load_dwordx4 v[36:39], v1, s[16:19], s31 offen
    v_cmp_gt_u32 vcc, 33, v0
    s_nop 0
    s_and_saveexec_b64 s[32:33], vcc
    s_cbranch_execz p0_wt_notail
    v_add_u32 v2, 4096, v1
    buffer_load_dwordx4 v[40:43], v2, s[12:15], s28 offen
    buffer_load_dwordx4 v[44:47], v2, s[12:15], s29 offen
    buffer_load_dwordx4 v[48:51], v2, s[12:15], s30 offen
    buffer_load_dwordx4 v[52:55], v2, s[12:15], s31 offen
    buffer_load_dwordx4 v[56:59], v2, s[16:19], s28 offen
    buffer_load_dwordx4 v[60:63], v2, s[16:19], s29 offen
    buffer_load_dwordx4 v[64:67], v2, s[16:19], s30 offen
    buffer_load_dwordx4 v[68:71], v2, s[16:19], s31 offen
    s_waitcnt vmcnt(0)
    ds_write_b128 v2, v[40:43] offset:0
    ds_write_b128 v2, v[44:47] offset:4624
    ds_write_b128 v2, v[48:51] offset:9248
    ds_write_b128 v2, v[52:55] offset:13872
    ds_write_b128 v2, v[56:59] offset:18496
    ds_write_b128 v2, v[60:63] offset:23120
    ds_write_b128 v2, v[64:67] offset:27744
    ds_write_b128 v2, v[68:71] offset:32368
p0_wt_notail:
    s_mov_b64 exec, s[32:33]
    s_waitcnt vmcnt(0)
    ds_write_b128 v1, v[8:11] offset:0
    ds_write_b128 v1, v[12:15] offset:4624
    ds_write_b128 v1, v[16:19] offset:9248
    ds_write_b128 v1, v[20:23] offset:13872
    ds_write_b128 v1, v[24:27] offset:18496
    ds_write_b128 v1, v[28:31] offset:23120
    ds_write_b128 v1, v[32:35] offset:27744
    ds_write_b128 v1, v[36:39] offset:32368
    v_and_b32 v3, 7, v0
    v_lshrrev_b32 v4, 3, v0
    s_movk_i32 s34, 578
    v_mul_lo_u32 v5, v3, s34
    v_lshl_add_u32 v5, v4, 1, v5
    v_lshlrev_b32 v6, 13, v4
    v_lshl_add_u32 v6, v3, 4, v6
    s_lshr_b32 s34, s24, 1
    s_lshl_b32 s34, s34, 1
    s_lshr_b32 s35, s25, 2
    s_add_u32 s34, s34, s35
    s_lshl_b32 s34, s34, 6
    s_and_b32 s35, s25, 3
    s_lshl_b32 s35, s35, 4
    s_add_u32 s34, s34, s35
    s_and_b32 s35, s24, 1
    s_lshl_b32 s35, s35, 3
    s_add_u32 s34, s34, s35
    s_lshl_b32 s34, s34, 4
    s_waitcnt lgkmcnt(0)
    s_barrier
    ds_read_u16 v8, v5 offset:0
    ds_read_u16 v12, v5 offset:18496
    ds_read_u16 v9, v5 offset:4624
    ds_read_u16 v13, v5 offset:23120
    ds_read_u16 v10, v5 offset:9248
    ds_read_u16 v14, v5 offset:27744
    ds_read_u16 v11, v5 offset:13872
    ds_read_u16 v15, v5 offset:32368
    ds_read_u16 v24, v5 offset:64
    ds_read_u16 v28, v5 offset:18560
    ds_read_u16 v25, v5 offset:4688
    ds_read_u16 v29, v5 offset:23184
    ds_read_u16 v26, v5 offset:9312
    ds_read_u16 v30, v5 offset:27808
    ds_read_u16 v27, v5 offset:13936
    ds_read_u16 v31, v5 offset:32432
    s_waitcnt lgkmcnt(8)
    v_lshl_or_b32 v16, v12, 16, v8
    v_lshl_or_b32 v17, v13, 16, v9
    v_lshl_or_b32 v18, v14, 16, v10
    v_lshl_or_b32 v19, v15, 16, v11
    buffer_store_dwordx4 v[16:19], v6, s[20:23], s34 offen
    s_add_u32 s34, s34, 262144
    ds_read_u16 v40, v5 offset:128
    ds_read_u16 v44, v5 offset:18624
    ds_read_u16 v41, v5 offset:4752
    ds_read_u16 v45, v5 offset:23248
    ds_read_u16 v42, v5 offset:9376
    ds_read_u16 v46, v5 offset:27872
    ds_read_u16 v43, v5 offset:14000
    ds_read_u16 v47, v5 offset:32496
    s_waitcnt lgkmcnt(8)
    v_lshl_or_b32 v32, v28, 16, v24
    v_lshl_or_b32 v33, v29, 16, v25
    v_lshl_or_b32 v34, v30, 16, v26
    v_lshl_or_b32 v35, v31, 16, v27
    buffer_store_dwordx4 v[32:35], v6, s[20:23], s34 offen
    s_add_u32 s34, s34, 262144
    ds_read_u16 v56, v5 offset:192
    ds_read_u16 v60, v5 offset:18688
    ds_read_u16 v57, v5 offset:4816
    ds_read_u16 v61, v5 offset:23312
    ds_read_u16 v58, v5 offset:9440
    ds_read_u16 v62, v5 offset:27936
    ds_read_u16 v59, v5 offset:14064
    ds_read_u16 v63, v5 offset:32560
    s_waitcnt lgkmcnt(8)
    v_lshl_or_b32 v48, v44, 16, v40
    v_lshl_or_b32 v49, v45, 16, v41
    v_lshl_or_b32 v50, v46, 16, v42
    v_lshl_or_b32 v51, v47, 16, v43
    buffer_store_dwordx4 v[48:51], v6, s[20:23], s34 offen
    s_add_u32 s34, s34, 262144
    ds_read_u16 v8, v5 offset:256
    ds_read_u16 v12, v5 offset:18752
    ds_read_u16 v9, v5 offset:4880
    ds_read_u16 v13, v5 offset:23376
    ds_read_u16 v10, v5 offset:9504
    ds_read_u16 v14, v5 offset:28000
    ds_read_u16 v11, v5 offset:14128
    ds_read_u16 v15, v5 offset:32624
    s_waitcnt lgkmcnt(8)
    v_lshl_or_b32 v64, v60, 16, v56
    v_lshl_or_b32 v65, v61, 16, v57
    v_lshl_or_b32 v66, v62, 16, v58
    v_lshl_or_b32 v67, v63, 16, v59
    buffer_store_dwordx4 v[64:67], v6, s[20:23], s34 offen
    s_add_u32 s34, s34, 262144
    ds_read_u16 v24, v5 offset:320
    ds_read_u16 v28, v5 offset:18816
    ds_read_u16 v25, v5 offset:4944
    ds_read_u16 v29, v5 offset:23440
    ds_read_u16 v26, v5 offset:9568
    ds_read_u16 v30, v5 offset:28064
    ds_read_u16 v27, v5 offset:14192
    ds_read_u16 v31, v5 offset:32688
    s_waitcnt lgkmcnt(8)
    v_lshl_or_b32 v16, v12, 16, v8
    v_lshl_or_b32 v17, v13, 16, v9
    v_lshl_or_b32 v18, v14, 16, v10
    v_lshl_or_b32 v19, v15, 16, v11
    buffer_store_dwordx4 v[16:19], v6, s[20:23], s34 offen
    s_add_u32 s34, s34, 262144
    ds_read_u16 v40, v5 offset:384
    ds_read_u16 v44, v5 offset:18880
    ds_read_u16 v41, v5 offset:5008
    ds_read_u16 v45, v5 offset:23504
    ds_read_u16 v42, v5 offset:9632
    ds_read_u16 v46, v5 offset:28128
    ds_read_u16 v43, v5 offset:14256
    ds_read_u16 v47, v5 offset:32752
    s_waitcnt lgkmcnt(8)
    v_lshl_or_b32 v32, v28, 16, v24
    v_lshl_or_b32 v33, v29, 16, v25
    v_lshl_or_b32 v34, v30, 16, v26
    v_lshl_or_b32 v35, v31, 16, v27
    buffer_store_dwordx4 v[32:35], v6, s[20:23], s34 offen
    s_add_u32 s34, s34, 262144
    ds_read_u16 v56, v5 offset:448
    ds_read_u16 v60, v5 offset:18944
    ds_read_u16 v57, v5 offset:5072
    ds_read_u16 v61, v5 offset:23568
    ds_read_u16 v58, v5 offset:9696
    ds_read_u16 v62, v5 offset:28192
    ds_read_u16 v59, v5 offset:14320
    ds_read_u16 v63, v5 offset:32816
    s_waitcnt lgkmcnt(8)
    v_lshl_or_b32 v48, v44, 16, v40
    v_lshl_or_b32 v49, v45, 16, v41
    v_lshl_or_b32 v50, v46, 16, v42
    v_lshl_or_b32 v51, v47, 16, v43
    buffer_store_dwordx4 v[48:51], v6, s[20:23], s34 offen
    s_add_u32 s34, s34, 262144
    ds_read_u16 v8, v5 offset:512
    ds_read_u16 v12, v5 offset:19008
    ds_read_u16 v9, v5 offset:5136
    ds_read_u16 v13, v5 offset:23632
    ds_read_u16 v10, v5 offset:9760
    ds_read_u16 v14, v5 offset:28256
    ds_read_u16 v11, v5 offset:14384
    ds_read_u16 v15, v5 offset:32880
    s_waitcnt lgkmcnt(8)
    v_lshl_or_b32 v64, v60, 16, v56
    v_lshl_or_b32 v65, v61, 16, v57
    v_lshl_or_b32 v66, v62, 16, v58
    v_lshl_or_b32 v67, v63, 16, v59
    buffer_store_dwordx4 v[64:67], v6, s[20:23], s34 offen
    s_add_u32 s34, s34, 262144
    ds_read_u16 v24, v5 offset:576
    ds_read_u16 v28, v5 offset:19072
    ds_read_u16 v25, v5 offset:5200
    ds_read_u16 v29, v5 offset:23696
    ds_read_u16 v26, v5 offset:9824
    ds_read_u16 v30, v5 offset:28320
    ds_read_u16 v27, v5 offset:14448
    ds_read_u16 v31, v5 offset:32944
    s_waitcnt lgkmcnt(8)
    v_lshl_or_b32 v16, v12, 16, v8
    v_lshl_or_b32 v17, v13, 16, v9
    v_lshl_or_b32 v18, v14, 16, v10
    v_lshl_or_b32 v19, v15, 16, v11
    buffer_store_dwordx4 v[16:19], v6, s[20:23], s34 offen
    s_add_u32 s34, s34, 262144
    s_waitcnt lgkmcnt(0)
    v_lshl_or_b32 v32, v28, 16, v24
    v_lshl_or_b32 v33, v29, 16, v25
    v_lshl_or_b32 v34, v30, 16, v26
    v_lshl_or_b32 v35, v31, 16, v27
    buffer_store_dwordx4 v[32:35], v6, s[20:23], s34 offen
p0_end:
    s_mov_b64 exec, -1
p0_done:
    s_endpgm
.globl p1_kernel
.p2align 8
.type p1_kernel,@function
p1_kernel:
    s_cmp_ge_u32 s2, 256
    s_cbranch_scc1 p1_done
    s_load_dwordx2 s[4:5], s[0:1], 96
    s_load_dwordx2 s[6:7], s[0:1], 0
    v_and_b32 v1, 63, v0
    v_lshrrev_b32 v2, 6, v0
    s_nop 0
    v_readfirstlane_b32 s3, v2
    s_and_b32 s24, s2, 7
    s_lshr_b32 s25, s2, 3
    s_and_b32 s26, s25, 3
    s_lshr_b32 s25, s25, 2
    s_lshl_b32 s25, s25, 3
    s_add_u32 s24, s24, s25
    s_and_b32 s25, s24, 3
    s_lshl_b32 s25, s25, 2
    s_add_u32 s26, s26, s25
    s_lshl_b32 s26, s26, 1
    s_lshr_b32 s27, s24, 2
    s_and_b32 s28, s3, 3
    s_lshr_b32 s29, s3, 2
    s_lshl_b32 s30, s27, 2
    s_add_u32 s30, s30, s28
    s_lshl_b32 s30, s30, 5
    s_add_u32 s30, s30, s26
    s_add_u32 s30, s30, s29
    s_mul_i32 s30, s30, 1152
    v_lshlrev_b32 v3, 1, v1
    v_lshlrev_b32 v4, 2, v1
    v_mov_b32 v8, 0
    v_mov_b32 v9, 0
    v_mov_b32 v10, 0
    v_mov_b32 v11, 0
    v_mov_b32 v12, 0
    v_mov_b32 v13, 0
    v_mov_b32 v14, 0
    v_mov_b32 v15, 0
    v_mov_b32 v16, 0
    s_movk_i32 s31, 2304
    s_mov_b32 s32, 0xffff0000
    s_waitcnt lgkmcnt(0)
    s_mov_b32 s8, s6
    s_mov_b32 s9, s7
    s_mov_b32 s10, 0x240000
    s_mov_b32 s11, 0x20000
    s_mov_b32 s12, s4
    s_mov_b32 s13, s5
    s_mov_b32 s14, 0x3600
    s_mov_b32 s15, 0x20000
    s_add_u32 s16, s4, 0x400000
    s_addc_u32 s17, s5, 0
    s_mov_b32 s18, 0x242000
    s_mov_b32 s19, 0x20000
    buffer_load_short_d16_hi v8, v3, s[8:11], s30 offen offset:0
    buffer_load_short_d16_hi v9, v3, s[8:11], s30 offen offset:128
    buffer_load_short_d16_hi v10, v3, s[8:11], s30 offen offset:256
    buffer_load_short_d16_hi v11, v3, s[8:11], s30 offen offset:384
    buffer_load_short_d16_hi v12, v3, s[8:11], s30 offen offset:512
    buffer_load_short_d16_hi v13, v3, s[8:11], s30 offen offset:640
    buffer_load_short_d16_hi v14, v3, s[8:11], s30 offen offset:768
    buffer_load_short_d16_hi v15, v3, s[8:11], s30 offen offset:896
    buffer_load_short_d16_hi v16, v3, s[8:11], s30 offen offset:1024
    buffer_load_dword v30, v4, s[12:15], s31 offen offset:0
    buffer_load_dword v31, v4, s[12:15], s31 offen offset:256
    buffer_load_dword v32, v4, s[12:15], s31 offen offset:512
    buffer_load_dword v33, v4, s[12:15], s31 offen offset:768
    buffer_load_dword v34, v4, s[12:15], s31 offen offset:1024
    buffer_load_dword v35, v4, s[12:15], s31 offen offset:1280
    buffer_load_dword v36, v4, s[12:15], s31 offen offset:1536
    buffer_load_dword v37, v4, s[12:15], s31 offen offset:1792
    buffer_load_dword v38, v4, s[12:15], s31 offen offset:2048
    buffer_load_dword v20, v4, s[12:15], 0 offen offset:0
    buffer_load_dword v21, v4, s[12:15], 0 offen offset:256
    buffer_load_dword v22, v4, s[12:15], 0 offen offset:512
    buffer_load_dword v23, v4, s[12:15], 0 offen offset:768
    buffer_load_dword v24, v4, s[12:15], 0 offen offset:1024
    buffer_load_dword v25, v4, s[12:15], 0 offen offset:1280
    buffer_load_dword v26, v4, s[12:15], 0 offen offset:1536
    buffer_load_dword v27, v4, s[12:15], 0 offen offset:1792
    buffer_load_dword v28, v4, s[12:15], 0 offen offset:2048
    v_and_b32 v5, 15, v1
    v_lshrrev_b32 v6, 4, v1
    s_lshl_b32 s33, s28, 4
    v_add_u32 v7, s33, v5
    v_cvt_f32_u32 v90, v7
    v_cvt_f32_u32 v91, v6
    v_mul_f32 v91, v91, v90
    v_mul_f32 v91, 0x3d800000, v91
    v_fmamk_f32 v80, v90, 0x00000000, v91
    v_cos_f32 v81, v80
    v_sin_f32 v82, v80
    v_fmamk_f32 v83, v90, 0x3c800000, v91
    v_cos_f32 v84, v83
    v_sin_f32 v85, v83
    v_cvt_pk_bf16_f32 v40, v81, v82
    v_cvt_pk_bf16_f32 v56, -v82, v81
    v_fmamk_f32 v80, v90, 0x3d000000, v91
    v_cos_f32 v81, v80
    v_sin_f32 v82, v80
    v_cvt_pk_bf16_f32 v41, v84, v85
    v_cvt_pk_bf16_f32 v57, -v85, v84
    v_fmamk_f32 v83, v90, 0x3d400000, v91
    v_cos_f32 v84, v83
    v_sin_f32 v85, v83
    v_cvt_pk_bf16_f32 v42, v81, v82
    v_cvt_pk_bf16_f32 v58, -v82, v81
    v_fmamk_f32 v80, v90, 0x3e800000, v91
    v_cos_f32 v81, v80
    v_sin_f32 v82, v80
    v_cvt_pk_bf16_f32 v43, v84, v85
    v_cvt_pk_bf16_f32 v59, -v85, v84
    v_fmamk_f32 v83, v90, 0x3e880000, v91
    v_cos_f32 v84, v83
    v_sin_f32 v85, v83
    v_cvt_pk_bf16_f32 v44, v81, v82
    v_cvt_pk_bf16_f32 v60, -v82, v81
    v_fmamk_f32 v80, v90, 0x3e900000, v91
    v_cos_f32 v81, v80
    v_sin_f32 v82, v80
    v_cvt_pk_bf16_f32 v45, v84, v85
    v_cvt_pk_bf16_f32 v61, -v85, v84
    v_fmamk_f32 v83, v90, 0x3e980000, v91
    v_cos_f32 v84, v83
    v_sin_f32 v85, v83
    v_cvt_pk_bf16_f32 v46, v81, v82
    v_cvt_pk_bf16_f32 v62, -v82, v81
    v_fmamk_f32 v80, v90, 0x3f000000, v91
    v_cos_f32 v81, v80
    v_sin_f32 v82, v80
    v_cvt_pk_bf16_f32 v47, v84, v85
    v_cvt_pk_bf16_f32 v63, -v85, v84
    v_fmamk_f32 v83, v90, 0x3f040000, v91
    v_cos_f32 v84, v83
    v_sin_f32 v85, v83
    v_cvt_pk_bf16_f32 v48, v81, v82
    v_cvt_pk_bf16_f32 v64, -v82, v81
    v_fmamk_f32 v80, v90, 0x3f080000, v91
    v_cos_f32 v81, v80
    v_sin_f32 v82, v80
    v_cvt_pk_bf16_f32 v49, v84, v85
    v_cvt_pk_bf16_f32 v65, -v85, v84
    v_fmamk_f32 v83, v90, 0x3f0c0000, v91
    v_cos_f32 v84, v83
    v_sin_f32 v85, v83
    v_cvt_pk_bf16_f32 v50, v81, v82
    v_cvt_pk_bf16_f32 v66, -v82, v81
    v_fmamk_f32 v80, v90, 0x3f400000, v91
    v_cos_f32 v81, v80
    v_sin_f32 v82, v80
    v_cvt_pk_bf16_f32 v51, v84, v85
    v_cvt_pk_bf16_f32 v67, -v85, v84
    v_fmamk_f32 v83, v90, 0x3f440000, v91
    v_cos_f32 v84, v83
    v_sin_f32 v85, v83
    v_cvt_pk_bf16_f32 v52, v81, v82
    v_cvt_pk_bf16_f32 v68, -v82, v81
    v_fmamk_f32 v80, v90, 0x3f480000, v91
    v_cos_f32 v81, v80
    v_sin_f32 v82, v80
    v_cvt_pk_bf16_f32 v53, v84, v85
    v_cvt_pk_bf16_f32 v69, -v85, v84
    v_fmamk_f32 v83, v90, 0x3f4c0000, v91
    v_cos_f32 v84, v83
    v_sin_f32 v85, v83
    v_cvt_pk_bf16_f32 v54, v81, v82
    v_cvt_pk_bf16_f32 v70, -v82, v81
    v_cvt_pk_bf16_f32 v55, v84, v85
    v_cvt_pk_bf16_f32 v71, -v85, v84
    v_cvt_f32_u32 v90, v1
    v_mul_f32 v81, 0x3ae38e39, v90
    v_mul_f32 v82, 0x3b638e39, v90
    v_mul_f32 v83, 0x3baaaaab, v90
    v_mul_f32 v84, 0x3be38e39, v90
    v_cos_f32 v72, v81
    v_sin_f32 v73, v81
    v_cos_f32 v74, v82
    v_sin_f32 v75, v82
    v_cos_f32 v76, v83
    v_sin_f32 v77, v83
    v_cos_f32 v78, v84
    v_sin_f32 v79, v84
    s_lshl_b32 s33, s29, 2
    s_add_u32 s33, s33, s28
    s_mul_i32 s33, s33, 272
    v_add_u32 v100, s33, v4
    s_mul_i32 s33, s29, 8704
    v_mul_u32_u24 v101, 272, v5
    v_lshl_add_u32 v101, v6, 4, v101
    v_add_u32 v101, s33, v101
    s_waitcnt vmcnt(18)
    v_add_f32 v88, v8, v9
    v_add_f32 v88, v88, v10
    v_add_f32 v88, v88, v11
    v_add_f32 v88, v88, v12
    v_add_f32 v88, v88, v13
    v_add_f32 v88, v88, v14
    v_add_f32 v88, v88, v15
    v_add_f32 v88, v88, v16
    s_nop 1
    v_add_f32_dpp v88, v88, v88 quad_perm:[1,0,3,2] row_mask:0xf bank_mask:0xf
    s_nop 1
    v_add_f32_dpp v88, v88, v88 quad_perm:[2,3,0,1] row_mask:0xf bank_mask:0xf
    s_nop 1
    v_add_f32_dpp v88, v88, v88 row_half_mirror row_mask:0xf bank_mask:0xf
    s_nop 1
    v_add_f32_dpp v88, v88, v88 row_mirror row_mask:0xf bank_mask:0xf
    v_mov_b32 v80, v88
    s_nop 1
    v_permlane16_swap_b32 v88, v80
    v_add_f32 v88, v88, v80
    v_mov_b32 v80, v88
    s_nop 1
    v_permlane32_swap_b32 v88, v80
    v_add_f32 v88, v88, v80
    v_mul_f32 v88, 0x3ae38e39, v88
    v_sub_f32 v80, v8, v88
    v_mul_f32 v89, v80, v80
    v_sub_f32 v81, v9, v88
    v_fmac_f32 v89, v81, v81
    v_sub_f32 v80, v10, v88
    v_fmac_f32 v89, v80, v80
    v_sub_f32 v81, v11, v88
    v_fmac_f32 v89, v81, v81
    v_sub_f32 v80, v12, v88
    v_fmac_f32 v89, v80, v80
    v_sub_f32 v81, v13, v88
    v_fmac_f32 v89, v81, v81
    v_sub_f32 v80, v14, v88
    v_fmac_f32 v89, v80, v80
    v_sub_f32 v81, v15, v88
    v_fmac_f32 v89, v81, v81
    v_sub_f32 v80, v16, v88
    v_fmac_f32 v89, v80, v80
    s_nop 1
    v_add_f32_dpp v89, v89, v89 quad_perm:[1,0,3,2] row_mask:0xf bank_mask:0xf
    s_nop 1
    v_add_f32_dpp v89, v89, v89 quad_perm:[2,3,0,1] row_mask:0xf bank_mask:0xf
    s_nop 1
    v_add_f32_dpp v89, v89, v89 row_half_mirror row_mask:0xf bank_mask:0xf
    s_nop 1
    v_add_f32_dpp v89, v89, v89 row_mirror row_mask:0xf bank_mask:0xf
    v_mov_b32 v80, v89
    s_nop 1
    v_permlane16_swap_b32 v89, v80
    v_add_f32 v89, v89, v80
    v_mov_b32 v80, v89
    s_nop 1
    v_permlane32_swap_b32 v89, v80
    v_add_f32 v89, v89, v80
    v_mul_f32 v89, 0x3ae38e39, v89
    v_cvt_pk_bf16_f32 v88, v88, v88
    v_lshlrev_b32 v88, 16, v88
    v_cvt_pk_bf16_f32 v89, v89, v89
    v_lshlrev_b32 v89, 16, v89
    v_add_f32 v89, 0x3727c5ac, v89
    v_cvt_pk_bf16_f32 v89, v89, v89
    v_lshlrev_b32 v89, 16, v89
    v_sqrt_f32 v89, v89
    s_nop 0
    v_cvt_pk_bf16_f32 v89, v89, v89
    v_lshlrev_b32 v89, 16, v89
    v_rcp_f32 v89, v89
    v_sub_f32 v8, v8, v88
    v_sub_f32 v9, v9, v88
    v_sub_f32 v10, v10, v88
    v_sub_f32 v11, v11, v88
    v_sub_f32 v12, v12, v88
    v_sub_f32 v13, v13, v88
    v_sub_f32 v14, v14, v88
    v_sub_f32 v15, v15, v88
    v_sub_f32 v16, v16, v88
    v_cvt_pk_bf16_f32 v80, v8, v9
    v_lshlrev_b32 v8, 16, v80
    v_and_b32 v9, s32, v80
    v_cvt_pk_bf16_f32 v81, v10, v11
    v_lshlrev_b32 v10, 16, v81
    v_and_b32 v11, s32, v81
    v_cvt_pk_bf16_f32 v80, v12, v13
    v_lshlrev_b32 v12, 16, v80
    v_and_b32 v13, s32, v80
    v_cvt_pk_bf16_f32 v81, v14, v15
    v_lshlrev_b32 v14, 16, v81
    v_and_b32 v15, s32, v81
    v_cvt_pk_bf16_f32 v16, v16, v16
    v_lshlrev_b32 v16, 16, v16
    v_mul_f32 v8, v8, v89
    v_mul_f32 v9, v9, v89
    v_mul_f32 v10, v10, v89
    v_mul_f32 v11, v11, v89
    v_mul_f32 v12, v12, v89
    v_mul_f32 v13, v13, v89
    v_mul_f32 v14, v14, v89
    v_mul_f32 v15, v15, v89
    v_mul_f32 v16, v16, v89
    v_cvt_pk_bf16_f32 v80, v8, v9
    v_lshlrev_b32 v8, 16, v80
    v_and_b32 v9, s32, v80
    v_cvt_pk_bf16_f32 v81, v10, v11
    v_lshlrev_b32 v10, 16, v81
    v_and_b32 v11, s32, v81
    v_cvt_pk_bf16_f32 v80, v12, v13
    v_lshlrev_b32 v12, 16, v80
    v_and_b32 v13, s32, v80
    v_cvt_pk_bf16_f32 v81, v14, v15
    v_lshlrev_b32 v14, 16, v81
    v_and_b32 v15, s32, v81
    v_cvt_pk_bf16_f32 v16, v16, v16
    v_lshlrev_b32 v16, 16, v16
    s_waitcnt vmcnt(0)
    v_mul_f32 v8, v8, v30
    v_mul_f32 v9, v9, v31
    v_mul_f32 v10, v10, v32
    v_mul_f32 v11, v11, v33
    v_mul_f32 v12, v12, v34
    v_mul_f32 v13, v13, v35
    v_mul_f32 v14, v14, v36
    v_mul_f32 v15, v15, v37
    v_mul_f32 v16, v16, v38
    v_cvt_pk_bf16_f32 v80, v8, v9
    v_lshlrev_b32 v8, 16, v80
    v_and_b32 v9, s32, v80
    v_cvt_pk_bf16_f32 v81, v10, v11
    v_lshlrev_b32 v10, 16, v81
    v_and_b32 v11, s32, v81
    v_cvt_pk_bf16_f32 v80, v12, v13
    v_lshlrev_b32 v12, 16, v80
    v_and_b32 v13, s32, v80
    v_cvt_pk_bf16_f32 v81, v14, v15
    v_lshlrev_b32 v14, 16, v81
    v_and_b32 v15, s32, v81
    v_cvt_pk_bf16_f32 v16, v16, v16
    v_lshlrev_b32 v16, 16, v16
    v_add_f32 v8, v8, v20
    v_add_f32 v9, v9, v21
    v_add_f32 v10, v10, v22
    v_add_f32 v11, v11, v23
    v_add_f32 v12, v12, v24
    v_add_f32 v13, v13, v25
    v_add_f32 v14, v14, v26
    v_add_f32 v15, v15, v27
    v_add_f32 v16, v16, v28
    v_cvt_pk_bf16_f32 v80, v8, v9
    v_lshlrev_b32 v8, 16, v80
    v_and_b32 v9, s32, v80
    v_cvt_pk_bf16_f32 v81, v10, v11
    v_lshlrev_b32 v10, 16, v81
    v_and_b32 v11, s32, v81
    v_cvt_pk_bf16_f32 v80, v12, v13
    v_lshlrev_b32 v12, 16, v80
    v_and_b32 v13, s32, v80
    v_cvt_pk_bf16_f32 v81, v14, v15
    v_lshlrev_b32 v14, 16, v81
    v_and_b32 v15, s32, v81
    v_cvt_pk_bf16_f32 v16, v16, v16
    v_lshlrev_b32 v16, 16, v16
    v_add_f32 v20, v9, v16
    v_sub_f32 v24, v9, v16
    v_add_f32 v21, v10, v15
    v_sub_f32 v25, v10, v15
    v_add_f32 v22, v11, v14
    v_sub_f32 v26, v11, v14
    v_add_f32 v23, v12, v13
    v_sub_f32 v27, v12, v13
    v_add_f32 v30, v8, v20
    v_add_f32 v30, v30, v21
    v_add_f32 v30, v30, v22
    v_add_f32 v30, v30, v23
    v_fmamk_f32 v31, v20, 0x3f441b7d, v8
    v_fmamk_f32 v31, v21, 0x3e31d0d4, v31
    v_fmamk_f32 v31, v22, 0xbf000000, v31
    v_fmamk_f32 v31, v23, 0xbf708fb2, v31
    v_mul_f32 v35, 0xbf248dbb, v24
    v_fmamk_f32 v35, v25, 0xbf7c1c5c, v35
    v_fmamk_f32 v35, v26, 0xbf5db3d7, v35
    v_fmamk_f32 v35, v27, 0xbeaf1d44, v35
    v_fmamk_f32 v32, v20, 0x3e31d0d4, v8
    v_fmamk_f32 v32, v21, 0xbf708fb2, v32
    v_fmamk_f32 v32, v22, 0xbf000000, v32
    v_fmamk_f32 v32, v23, 0x3f441b7d, v32
    v_mul_f32 v36, 0xbf7c1c5c, v24
    v_fmamk_f32 v36, v25, 0xbeaf1d44, v36
    v_fmamk_f32 v36, v26, 0x3f5db3d7, v36
    v_fmamk_f32 v36, v27, 0x3f248dbb, v36
    v_fmamk_f32 v33, v20, 0xbf000000, v8
    v_fmamk_f32 v33, v21, 0xbf000000, v33
    v_fmamk_f32 v33, v22, 0x3f800000, v33
    v_fmamk_f32 v33, v23, 0xbf000000, v33
    v_mul_f32 v37, 0xbf5db3d7, v24
    v_fmamk_f32 v37, v25, 0x3f5db3d7, v37
    v_fmamk_f32 v37, v27, 0xbf5db3d7, v37
    v_fmamk_f32 v34, v20, 0xbf708fb2, v8
    v_fmamk_f32 v34, v21, 0x3f441b7d, v34
    v_fmamk_f32 v34, v22, 0xbf000000, v34
    v_fmamk_f32 v34, v23, 0x3e31d0d4, v34
    v_mul_f32 v38, 0xbeaf1d44, v24
    v_fmamk_f32 v38, v25, 0x3f248dbb, v38
    v_fmamk_f32 v38, v26, 0xbf5db3d7, v38
    v_fmamk_f32 v38, v27, 0x3f7c1c5c, v38
    v_cvt_pk_bf16_f32 v8, v30, 0
    v_mul_f32 v80, v31, v72
    v_mul_f32 v81, v35, v72
    v_fmac_f32 v80, v35, v73
    v_fma_f32 v81, -v31, v73, v81
    v_cvt_pk_bf16_f32 v9, v80, v81
    v_mul_f32 v80, v32, v74
    v_mul_f32 v81, v36, v74
    v_fmac_f32 v80, v36, v75
    v_fma_f32 v81, -v32, v75, v81
    v_cvt_pk_bf16_f32 v10, v80, v81
    v_mul_f32 v80, v33, v76
    v_mul_f32 v81, v37, v76
    v_fmac_f32 v80, v37, v77
    v_fma_f32 v81, -v33, v77, v81
    v_cvt_pk_bf16_f32 v11, v80, v81
    v_mul_f32 v80, v34, v78
    v_mul_f32 v81, v38, v78
    v_fmac_f32 v80, v38, v79
    v_fma_f32 v81, -v34, v79, v81
    v_cvt_pk_bf16_f32 v12, v80, v81
    ds_write_b32 v100, v8 offset:0
    ds_write_b32 v100, v9 offset:2176
    ds_write_b32 v100, v10 offset:4352
    ds_write_b32 v100, v11 offset:6528
    ds_write_b32 v100, v12 offset:8704
    s_lshr_b32 s34, s26, 4
    s_lshl_b32 s34, s34, 2
    s_lshr_b32 s35, s27, 2
    s_add_u32 s34, s34, s35
    s_lshl_b32 s34, s34, 6
    s_and_b32 s35, s27, 3
    s_lshl_b32 s35, s35, 4
    s_add_u32 s34, s34, s35
    s_and_b32 s35, s26, 15
    s_add_u32 s34, s34, s35
    s_lshl_b32 s34, s34, 4
    s_cmp_lt_u32 s28, 2
    s_cselect_b32 s35, 1, -1
    s_cselect_b32 s36, 0, 576
    s_cselect_b32 s37, 0, 0x80000000
    s_lshl_b32 s38, s29, 3
    s_add_u32 s38, s38, 0
    v_add_u32 v104, s38, v6
    v_lshrrev_b32 v105, 1, v104
    v_mad_u32_u24 v106, v7, 9, v105
    v_mul_lo_u32 v106, v106, s35
    v_add_u32 v106, s36, v106
    v_and_b32 v107, 1, v104
    v_lshlrev_b32 v102, 13, v106
    v_lshl_add_u32 v102, v107, 4, v102
    v_cmp_lt_u32 vcc, 9, v104
    v_cmp_eq_u32 s[40:41], 0, v105
    v_cmp_lt_u32 s[42:43], 32, v7
    s_nop 0
    s_and_b64 s[40:41], s[40:41], s[42:43]
    s_or_b64 vcc, vcc, s[40:41]
    v_mov_b32 v107, 0x7f000000
    v_cndmask_b32 v102, v102, v107, vcc
    s_lshl_b32 s38, s29, 3
    s_add_u32 s38, s38, 4
    v_add_u32 v104, s38, v6
    v_lshrrev_b32 v105, 1, v104
    v_mad_u32_u24 v106, v7, 9, v105
    v_mul_lo_u32 v106, v106, s35
    v_add_u32 v106, s36, v106
    v_and_b32 v107, 1, v104
    v_lshlrev_b32 v103, 13, v106
    v_lshl_add_u32 v103, v107, 4, v103
    v_cmp_lt_u32 vcc, 9, v104
    v_cmp_eq_u32 s[40:41], 0, v105
    v_cmp_lt_u32 s[42:43], 32, v7
    s_nop 0
    s_and_b64 s[40:41], s[40:41], s[42:43]
    s_or_b64 vcc, vcc, s[40:41]
    v_mov_b32 v107, 0x7f000000
    v_cndmask_b32 v103, v103, v107, vcc
    s_waitcnt lgkmcnt(0)
    s_barrier
    ds_read_b128 v[8:11], v101 offset:0
    ds_read_b128 v[12:15], v101 offset:64
    ds_read_b128 v[16:19], v101 offset:128
    ds_read_b128 v[20:23], v101 offset:192
    s_cmp_eq_u32 s29, 1
    s_cbranch_scc1 p1_one
    ds_read_b128 v[24:27], v101 offset:4352
    ds_read_b128 v[28:31], v101 offset:4416
    ds_read_b128 v[32:35], v101 offset:4480
    ds_read_b128 v[36:39], v101 offset:4544
    s_waitcnt lgkmcnt(3)
    v_mfma_f32_16x16x32_bf16 v[116:119], v[24:27], v[40:43], 0
    v_mfma_f32_16x16x32_bf16 v[120:123], v[24:27], v[56:59], 0
    s_waitcnt lgkmcnt(2)
    v_mfma_f32_16x16x32_bf16 v[116:119], v[28:31], v[44:47], v[116:119]
    v_mfma_f32_16x16x32_bf16 v[120:123], v[28:31], v[60:63], v[120:123]
    s_waitcnt lgkmcnt(1)
    v_mfma_f32_16x16x32_bf16 v[116:119], v[32:35], v[48:51], v[116:119]
    v_mfma_f32_16x16x32_bf16 v[120:123], v[32:35], v[64:67], v[120:123]
    s_waitcnt lgkmcnt(0)
    v_mfma_f32_16x16x32_bf16 v[116:119], v[36:39], v[52:55], v[116:119]
    v_mfma_f32_16x16x32_bf16 v[120:123], v[36:39], v[68:71], v[120:123]
p1_one:
    s_waitcnt lgkmcnt(0)
    v_mfma_f32_16x16x32_bf16 v[108:111], v[8:11], v[40:43], 0
    v_mfma_f32_16x16x32_bf16 v[112:115], v[8:11], v[56:59], 0
    v_mfma_f32_16x16x32_bf16 v[108:111], v[12:15], v[44:47], v[108:111]
    v_mfma_f32_16x16x32_bf16 v[112:115], v[12:15], v[60:63], v[112:115]
    v_mfma_f32_16x16x32_bf16 v[108:111], v[16:19], v[48:51], v[108:111]
    v_mfma_f32_16x16x32_bf16 v[112:115], v[16:19], v[64:67], v[112:115]
    v_mfma_f32_16x16x32_bf16 v[108:111], v[20:23], v[52:55], v[108:111]
    v_mfma_f32_16x16x32_bf16 v[112:115], v[20:23], v[68:71], v[112:115]
    s_cmp_eq_u32 s29, 1
    s_cbranch_scc1 p1_one2
    v_cvt_pk_bf16_f32 v84, v116, v120
    v_xor_b32 v84, s37, v84
    v_cvt_pk_bf16_f32 v85, v117, v121
    v_xor_b32 v85, s37, v85
    v_cvt_pk_bf16_f32 v86, v118, v122
    v_xor_b32 v86, s37, v86
    v_cvt_pk_bf16_f32 v87, v119, v123
    v_xor_b32 v87, s37, v87
    buffer_store_dwordx4 v[84:87], v103, s[16:19], s34 offen
p1_one2:
    s_nop 5
    v_cvt_pk_bf16_f32 v80, v108, v112
    v_xor_b32 v80, s37, v80
    v_cvt_pk_bf16_f32 v81, v109, v113
    v_xor_b32 v81, s37, v81
    v_cvt_pk_bf16_f32 v82, v110, v114
    v_xor_b32 v82, s37, v82
    v_cvt_pk_bf16_f32 v83, v111, v115
    v_xor_b32 v83, s37, v83
    buffer_store_dwordx4 v[80:83], v102, s[16:19], s34 offen
p1_done:
    s_endpgm
.globl p2_kernel
.p2align 8
.type p2_kernel,@function
p2_kernel:
    s_cmp_ge_u32 s2, 289
    s_cbranch_scc1 p2_done
    s_load_dwordx2 s[4:5], s[0:1], 96
    v_and_b32 v1, 63, v0
    v_lshrrev_b32 v2, 6, v0
    s_nop 0
    v_readfirstlane_b32 s3, v2
    v_lshlrev_b32 v3, 4, v1
    s_lshl_b32 s24, s2, 13
    s_add_u32 s25, s24, 4096
    s_lshl_b32 s26, s3, 11
    s_add_u32 s26, s26, s24
    s_mov_b32 s32, 0xffff0000
    s_waitcnt lgkmcnt(0)
    s_add_u32 s8, s4, 0x400000
    s_addc_u32 s9, s5, 0
    s_mov_b32 s10, 0x242000
    s_mov_b32 s11, 0x20000
    s_add_u32 s12, s4, 0x100000
    s_addc_u32 s13, s5, 0
    s_mov_b32 s14, 0x242000
    s_mov_b32 s15, 0x20000
    s_add_u32 s16, s4, 0x700000
    s_addc_u32 s17, s5, 0
    s_mov_b32 s18, 0x242000
    s_mov_b32 s19, 0x20000
    buffer_load_dwordx4 v[8:11], v3, s[8:11], s24 offen offset:0
    buffer_load_dwordx4 v[12:15], v3, s[8:11], s24 offen offset:1024
    buffer_load_dwordx4 v[16:19], v3, s[8:11], s24 offen offset:2048
    buffer_load_dwordx4 v[20:23], v3, s[8:11], s24 offen offset:3072
    buffer_load_dwordx4 v[24:27], v3, s[8:11], s25 offen offset:0
    buffer_load_dwordx4 v[28:31], v3, s[8:11], s25 offen offset:1024
    buffer_load_dwordx4 v[32:35], v3, s[8:11], s25 offen offset:2048
    buffer_load_dwordx4 v[36:39], v3, s[8:11], s25 offen offset:3072
    buffer_load_dwordx4 v[40:43], v3, s[12:15], s26 offen offset:0
    buffer_load_dwordx4 v[44:47], v3, s[12:15], s26 offen offset:1024
    v_and_b32 v5, 15, v1
    v_lshrrev_b32 v6, 4, v1
    s_lshl_b32 s33, s3, 4
    v_add_u32 v7, s33, v5
    v_cvt_f32_u32 v164, v7
    v_cvt_f32_u32 v165, v6
    v_mul_f32 v166, v165, v164
    v_mul_f32 v166, 0x3d800000, v166
    v_fmamk_f32 v152, v164, 0x00000000, v166
    v_cos_f32 v153, v152
    v_sin_f32 v154, v152
    v_fmamk_f32 v155, v164, 0x3c800000, v166
    v_cos_f32 v156, v155
    v_sin_f32 v157, v155
    v_cvt_pk_bf16_f32 v48, v153, v154
    v_cvt_pk_bf16_f32 v64, -v154, v153
    v_fmamk_f32 v152, v164, 0x3d000000, v166
    v_cos_f32 v153, v152
    v_sin_f32 v154, v152
    v_cvt_pk_bf16_f32 v49, v156, v157
    v_cvt_pk_bf16_f32 v65, -v157, v156
    v_fmamk_f32 v155, v164, 0x3d400000, v166
    v_cos_f32 v156, v155
    v_sin_f32 v157, v155
    v_cvt_pk_bf16_f32 v50, v153, v154
    v_cvt_pk_bf16_f32 v66, -v154, v153
    v_fmamk_f32 v152, v164, 0x3e800000, v166
    v_cos_f32 v153, v152
    v_sin_f32 v154, v152
    v_cvt_pk_bf16_f32 v51, v156, v157
    v_cvt_pk_bf16_f32 v67, -v157, v156
    v_fmamk_f32 v155, v164, 0x3e880000, v166
    v_cos_f32 v156, v155
    v_sin_f32 v157, v155
    v_cvt_pk_bf16_f32 v52, v153, v154
    v_cvt_pk_bf16_f32 v68, -v154, v153
    v_fmamk_f32 v152, v164, 0x3e900000, v166
    v_cos_f32 v153, v152
    v_sin_f32 v154, v152
    v_cvt_pk_bf16_f32 v53, v156, v157
    v_cvt_pk_bf16_f32 v69, -v157, v156
    v_fmamk_f32 v155, v164, 0x3e980000, v166
    v_cos_f32 v156, v155
    v_sin_f32 v157, v155
    v_cvt_pk_bf16_f32 v54, v153, v154
    v_cvt_pk_bf16_f32 v70, -v154, v153
    v_fmamk_f32 v152, v164, 0x3f000000, v166
    v_cos_f32 v153, v152
    v_sin_f32 v154, v152
    v_cvt_pk_bf16_f32 v55, v156, v157
    v_cvt_pk_bf16_f32 v71, -v157, v156
    v_fmamk_f32 v155, v164, 0x3f040000, v166
    v_cos_f32 v156, v155
    v_sin_f32 v157, v155
    v_cvt_pk_bf16_f32 v56, v153, v154
    v_cvt_pk_bf16_f32 v72, -v154, v153
    v_fmamk_f32 v152, v164, 0x3f080000, v166
    v_cos_f32 v153, v152
    v_sin_f32 v154, v152
    v_cvt_pk_bf16_f32 v57, v156, v157
    v_cvt_pk_bf16_f32 v73, -v157, v156
    v_fmamk_f32 v155, v164, 0x3f0c0000, v166
    v_cos_f32 v156, v155
    v_sin_f32 v157, v155
    v_cvt_pk_bf16_f32 v58, v153, v154
    v_cvt_pk_bf16_f32 v74, -v154, v153
    v_fmamk_f32 v152, v164, 0x3f400000, v166
    v_cos_f32 v153, v152
    v_sin_f32 v154, v152
    v_cvt_pk_bf16_f32 v59, v156, v157
    v_cvt_pk_bf16_f32 v75, -v157, v156
    v_fmamk_f32 v155, v164, 0x3f440000, v166
    v_cos_f32 v156, v155
    v_sin_f32 v157, v155
    v_cvt_pk_bf16_f32 v60, v153, v154
    v_cvt_pk_bf16_f32 v76, -v154, v153
    v_fmamk_f32 v152, v164, 0x3f480000, v166
    v_cos_f32 v153, v152
    v_sin_f32 v154, v152
    v_cvt_pk_bf16_f32 v61, v156, v157
    v_cvt_pk_bf16_f32 v77, -v157, v156
    v_fmamk_f32 v155, v164, 0x3f4c0000, v166
    v_cos_f32 v156, v155
    v_sin_f32 v157, v155
    v_cvt_pk_bf16_f32 v62, v153, v154
    v_cvt_pk_bf16_f32 v78, -v154, v153
    v_cvt_pk_bf16_f32 v63, v156, v157
    v_cvt_pk_bf16_f32 v79, -v157, v156
    v_mul_f32 v166, 0x3d000000, v166
    v_fmamk_f32 v152, v164, 0x00000000, v166
    v_fmamk_f32 v153, v164, 0x3a000000, v166
    v_fmamk_f32 v154, v164, 0x3a800000, v166
    v_fmamk_f32 v155, v164, 0x3ac00000, v166
    v_cos_f32 v112, v152
    v_sin_f32 v113, v152
    v_cos_f32 v114, v153
    v_sin_f32 v115, v153
    v_cos_f32 v116, v154
    v_sin_f32 v117, v154
    v_cos_f32 v118, v155
    v_sin_f32 v119, v155
    v_fmamk_f32 v152, v164, 0x3c000000, v166
    v_fmamk_f32 v153, v164, 0x3c080000, v166
    v_fmamk_f32 v154, v164, 0x3c100000, v166
    v_fmamk_f32 v155, v164, 0x3c180000, v166
    v_cos_f32 v120, v152
    v_sin_f32 v121, v152
    v_cos_f32 v122, v153
    v_sin_f32 v123, v153
    v_cos_f32 v124, v154
    v_sin_f32 v125, v154
    v_cos_f32 v126, v155
    v_sin_f32 v127, v155
    v_add_u32 v164, 0, v5
    v_cvt_f32_u32 v164, v164
    v_mul_f32 v166, v165, v164
    v_mul_f32 v166, 0x3e000000, v166
    v_fmamk_f32 v152, v164, 0x00000000, v166
    v_fmamk_f32 v153, v164, 0x3d000000, v166
    v_fmamk_f32 v154, v164, 0x3d800000, v166
    v_fmamk_f32 v155, v164, 0x3dc00000, v166
    v_cos_f32 v156, v152
    v_sin_f32 v160, v152
    v_cos_f32 v157, v153
    v_sin_f32 v161, v153
    v_cos_f32 v158, v154
    v_sin_f32 v162, v154
    v_cos_f32 v159, v155
    v_sin_f32 v163, v155
    v_cvt_pk_bf16_f32 v80, v156, v157
    v_cvt_pk_bf16_f32 v81, v158, v159
    v_cvt_pk_bf16_f32 v98, v156, v157
    v_cvt_pk_bf16_f32 v99, v158, v159
    v_cvt_pk_bf16_f32 v82, v160, v161
    v_cvt_pk_bf16_f32 v83, v162, v163
    v_cvt_pk_bf16_f32 v96, -v160, -v161
    v_cvt_pk_bf16_f32 v97, -v162, -v163
    v_fmamk_f32 v152, v164, 0x3f000000, v166
    v_fmamk_f32 v153, v164, 0x3f080000, v166
    v_fmamk_f32 v154, v164, 0x3f100000, v166
    v_fmamk_f32 v155, v164, 0x3f180000, v166
    v_cos_f32 v156, v152
    v_sin_f32 v160, v152
    v_cos_f32 v157, v153
    v_sin_f32 v161, v153
    v_cos_f32 v158, v154
    v_sin_f32 v162, v154
    v_cos_f32 v159, v155
    v_sin_f32 v163, v155
    v_cvt_pk_bf16_f32 v84, v156, v157
    v_cvt_pk_bf16_f32 v85, v158, v159
    v_cvt_pk_bf16_f32 v102, v156, v157
    v_cvt_pk_bf16_f32 v103, v158, v159
    v_cvt_pk_bf16_f32 v86, v160, v161
    v_cvt_pk_bf16_f32 v87, v162, v163
    v_cvt_pk_bf16_f32 v100, -v160, -v161
    v_cvt_pk_bf16_f32 v101, -v162, -v163
    v_add_u32 v164, 16, v5
    v_cvt_f32_u32 v164, v164
    v_mul_f32 v166, v165, v164
    v_mul_f32 v166, 0x3e000000, v166
    v_fmamk_f32 v152, v164, 0x00000000, v166
    v_fmamk_f32 v153, v164, 0x3d000000, v166
    v_fmamk_f32 v154, v164, 0x3d800000, v166
    v_fmamk_f32 v155, v164, 0x3dc00000, v166
    v_cos_f32 v156, v152
    v_sin_f32 v160, v152
    v_cos_f32 v157, v153
    v_sin_f32 v161, v153
    v_cos_f32 v158, v154
    v_sin_f32 v162, v154
    v_cos_f32 v159, v155
    v_sin_f32 v163, v155
    v_cvt_pk_bf16_f32 v88, v156, v157
    v_cvt_pk_bf16_f32 v89, v158, v159
    v_cvt_pk_bf16_f32 v106, v156, v157
    v_cvt_pk_bf16_f32 v107, v158, v159
    v_cvt_pk_bf16_f32 v90, v160, v161
    v_cvt_pk_bf16_f32 v91, v162, v163
    v_cvt_pk_bf16_f32 v104, -v160, -v161
    v_cvt_pk_bf16_f32 v105, -v162, -v163
    v_fmamk_f32 v152, v164, 0x3f000000, v166
    v_fmamk_f32 v153, v164, 0x3f080000, v166
    v_fmamk_f32 v154, v164, 0x3f100000, v166
    v_fmamk_f32 v155, v164, 0x3f180000, v166
    v_cos_f32 v156, v152
    v_sin_f32 v160, v152
    v_cos_f32 v157, v153
    v_sin_f32 v161, v153
    v_cos_f32 v158, v154
    v_sin_f32 v162, v154
    v_cos_f32 v159, v155
    v_sin_f32 v163, v155
    v_cvt_pk_bf16_f32 v92, v156, v157
    v_cvt_pk_bf16_f32 v93, v158, v159
    v_cvt_pk_bf16_f32 v110, v156, v157
    v_cvt_pk_bf16_f32 v111, v158, v159
    v_cvt_pk_bf16_f32 v94, v160, v161
    v_cvt_pk_bf16_f32 v95, v162, v163
    v_cvt_pk_bf16_f32 v108, -v160, -v161
    v_cvt_pk_bf16_f32 v109, -v162, -v163
    v_mul_u32_u24 v4, 1088, v6
    v_lshl_add_u32 v4, v7, 2, v4
    v_mul_u32_u24 v2, 272, v5
    v_lshl_add_u32 v2, v6, 4, v2
    v_lshlrev_b32 v1, 7, v7
    v_lshl_add_u32 v1, v6, 4, v1
    s_waitcnt vmcnt(2)
    v_mfma_f32_16x16x32_bf16 v[128:131], v[8:11], v[48:51], 0
    v_mfma_f32_16x16x32_bf16 v[132:135], v[8:11], v[64:67], 0
    v_mfma_f32_16x16x32_bf16 v[136:139], v[24:27], v[48:51], 0
    v_mfma_f32_16x16x32_bf16 v[140:143], v[24:27], v[64:67], 0
    v_mfma_f32_16x16x32_bf16 v[128:131], v[12:15], v[52:55], v[128:131]
    v_mfma_f32_16x16x32_bf16 v[132:135], v[12:15], v[68:71], v[132:135]
    v_mfma_f32_16x16x32_bf16 v[136:139], v[28:31], v[52:55], v[136:139]
    v_mfma_f32_16x16x32_bf16 v[140:143], v[28:31], v[68:71], v[140:143]
    v_mfma_f32_16x16x32_bf16 v[128:131], v[16:19], v[56:59], v[128:131]
    v_mfma_f32_16x16x32_bf16 v[132:135], v[16:19], v[72:75], v[132:135]
    v_mfma_f32_16x16x32_bf16 v[136:139], v[32:35], v[56:59], v[136:139]
    v_mfma_f32_16x16x32_bf16 v[140:143], v[32:35], v[72:75], v[140:143]
    v_mfma_f32_16x16x32_bf16 v[128:131], v[20:23], v[60:63], v[128:131]
    v_mfma_f32_16x16x32_bf16 v[132:135], v[20:23], v[76:79], v[132:135]
    v_mfma_f32_16x16x32_bf16 v[136:139], v[36:39], v[60:63], v[136:139]
    v_mfma_f32_16x16x32_bf16 v[140:143], v[36:39], v[76:79], v[140:143]
    s_nop 4
    v_mul_f32 v152, v128, v112
    v_mul_f32 v153, v132, v112
    v_fmac_f32 v152, v132, v113
    v_fma_f32 v153, -v128, v113, v153
    v_mul_f32 v154, v129, v114
    v_mul_f32 v155, v133, v114
    v_fmac_f32 v154, v133, v115
    v_fma_f32 v155, -v129, v115, v155
    v_mul_f32 v156, v130, v116
    v_mul_f32 v157, v134, v116
    v_fmac_f32 v156, v134, v117
    v_fma_f32 v157, -v130, v117, v157
    v_mul_f32 v158, v131, v118
    v_mul_f32 v159, v135, v118
    v_fmac_f32 v158, v135, v119
    v_fma_f32 v159, -v131, v119, v159
    v_cvt_pk_bf16_f32 v144, v152, v154
    v_cvt_pk_bf16_f32 v145, v156, v158
    v_cvt_pk_bf16_f32 v146, v153, v155
    v_cvt_pk_bf16_f32 v147, v157, v159
    v_mul_f32 v152, v136, v120
    v_mul_f32 v153, v140, v120
    v_fmac_f32 v152, v140, v121
    v_fma_f32 v153, -v136, v121, v153
    v_mul_f32 v154, v137, v122
    v_mul_f32 v155, v141, v122
    v_fmac_f32 v154, v141, v123
    v_fma_f32 v155, -v137, v123, v155
    v_mul_f32 v156, v138, v124
    v_mul_f32 v157, v142, v124
    v_fmac_f32 v156, v142, v125
    v_fma_f32 v157, -v138, v125, v157
    v_mul_f32 v158, v139, v126
    v_mul_f32 v159, v143, v126
    v_fmac_f32 v158, v143, v127
    v_fma_f32 v159, -v139, v127, v159
    v_cvt_pk_bf16_f32 v148, v152, v154
    v_cvt_pk_bf16_f32 v149, v156, v158
    v_cvt_pk_bf16_f32 v150, v153, v155
    v_cvt_pk_bf16_f32 v151, v157, v159
    v_mfma_f32_16x16x32_bf16 v[128:131], v[80:83], v[144:147], 0
    v_mfma_f32_16x16x32_bf16 v[132:135], v[96:99], v[144:147], 0
    v_mfma_f32_16x16x32_bf16 v[136:139], v[88:91], v[144:147], 0
    v_mfma_f32_16x16x32_bf16 v[140:143], v[104:107], v[144:147], 0
    v_mfma_f32_16x16x32_bf16 v[128:131], v[84:87], v[148:151], v[128:131]
    v_mfma_f32_16x16x32_bf16 v[132:135], v[100:103], v[148:151], v[132:135]
    v_mfma_f32_16x16x32_bf16 v[136:139], v[92:95], v[148:151], v[136:139]
    v_mfma_f32_16x16x32_bf16 v[140:143], v[108:111], v[148:151], v[140:143]
    s_waitcnt vmcnt(0)
    v_lshlrev_b32 v160, 16, v40
    v_and_b32 v161, s32, v40
    s_nop 1
    v_mul_f32 v152, v128, v160
    v_mul_f32 v153, -v132, v160
    v_fma_f32 v152, -v132, v161, v152
    v_fma_f32 v153, -v128, v161, v153
    v_lshlrev_b32 v160, 16, v41
    v_and_b32 v161, s32, v41
    v_mul_f32 v154, v129, v160
    v_mul_f32 v155, -v133, v160
    v_fma_f32 v154, -v133, v161, v154
    v_fma_f32 v155, -v129, v161, v155
    v_lshlrev_b32 v160, 16, v42
    v_and_b32 v161, s32, v42
    v_mul_f32 v156, v130, v160
    v_mul_f32 v157, -v134, v160
    v_fma_f32 v156, -v134, v161, v156
    v_fma_f32 v157, -v130, v161, v157
    v_lshlrev_b32 v160, 16, v43
    v_and_b32 v161, s32, v43
    v_mul_f32 v158, v131, v160
    v_mul_f32 v159, -v135, v160
    v_fma_f32 v158, -v135, v161, v158
    v_fma_f32 v159, -v131, v161, v159
    v_cvt_pk_bf16_f32 v144, v152, v154
    v_cvt_pk_bf16_f32 v145, v156, v158
    v_cvt_pk_bf16_f32 v146, v153, v155
    v_cvt_pk_bf16_f32 v147, v157, v159
    v_lshlrev_b32 v160, 16, v44
    v_and_b32 v161, s32, v44
    v_mul_f32 v152, v136, v160
    v_mul_f32 v153, -v140, v160
    v_fma_f32 v152, -v140, v161, v152
    v_fma_f32 v153, -v136, v161, v153
    v_lshlrev_b32 v160, 16, v45
    v_and_b32 v161, s32, v45
    v_mul_f32 v154, v137, v160
    v_mul_f32 v155, -v141, v160
    v_fma_f32 v154, -v141, v161, v154
    v_fma_f32 v155, -v137, v161, v155
    v_lshlrev_b32 v160, 16, v46
    v_and_b32 v161, s32, v46
    v_mul_f32 v156, v138, v160
    v_mul_f32 v157, -v142, v160
    v_fma_f32 v156, -v142, v161, v156
    v_fma_f32 v157, -v138, v161, v157
    v_lshlrev_b32 v160, 16, v47
    v_and_b32 v161, s32, v47
    v_mul_f32 v158, v139, v160
    v_mul_f32 v159, -v143, v160
    v_fma_f32 v158, -v143, v161, v158
    v_fma_f32 v159, -v139, v161, v159
    v_cvt_pk_bf16_f32 v148, v152, v154
    v_cvt_pk_bf16_f32 v149, v156, v158
    v_cvt_pk_bf16_f32 v150, v153, v155
    v_cvt_pk_bf16_f32 v151, v157, v159
    v_mfma_f32_16x16x32_bf16 v[128:131], v[80:83], v[144:147], 0
    v_mfma_f32_16x16x32_bf16 v[132:135], v[96:99], v[144:147], 0
    v_mfma_f32_16x16x32_bf16 v[136:139], v[88:91], v[144:147], 0
    v_mfma_f32_16x16x32_bf16 v[140:143], v[104:107], v[144:147], 0
    v_mfma_f32_16x16x32_bf16 v[128:131], v[84:87], v[148:151], v[128:131]
    v_mfma_f32_16x16x32_bf16 v[132:135], v[100:103], v[148:151], v[132:135]
    v_mfma_f32_16x16x32_bf16 v[136:139], v[92:95], v[148:151], v[136:139]
    v_mfma_f32_16x16x32_bf16 v[140:143], v[108:111], v[148:151], v[140:143]
    s_nop 4
    v_mul_f32 v152, v128, v112
    v_mul_f32 v153, v132, v112
    v_fmac_f32 v152, v132, v113
    v_fma_f32 v153, -v128, v113, v153
    v_cvt_pk_bf16_f32 v156, v152, v153
    ds_write_b32 v4, v156 offset:0
    v_mul_f32 v154, v129, v114
    v_mul_f32 v155, v133, v114
    v_fmac_f32 v154, v133, v115
    v_fma_f32 v155, -v129, v115, v155
    v_cvt_pk_bf16_f32 v157, v154, v155
    ds_write_b32 v4, v157 offset:272
    v_mul_f32 v152, v130, v116
    v_mul_f32 v153, v134, v116
    v_fmac_f32 v152, v134, v117
    v_fma_f32 v153, -v130, v117, v153
    v_cvt_pk_bf16_f32 v158, v152, v153
    ds_write_b32 v4, v158 offset:544
    v_mul_f32 v154, v131, v118
    v_mul_f32 v155, v135, v118
    v_fmac_f32 v154, v135, v119
    v_fma_f32 v155, -v131, v119, v155
    v_cvt_pk_bf16_f32 v159, v154, v155
    ds_write_b32 v4, v159 offset:816
    v_mul_f32 v152, v136, v120
    v_mul_f32 v153, v140, v120
    v_fmac_f32 v152, v140, v121
    v_fma_f32 v153, -v136, v121, v153
    v_cvt_pk_bf16_f32 v156, v152, v153
    ds_write_b32 v4, v156 offset:4352
    v_mul_f32 v154, v137, v122
    v_mul_f32 v155, v141, v122
    v_fmac_f32 v154, v141, v123
    v_fma_f32 v155, -v137, v123, v155
    v_cvt_pk_bf16_f32 v157, v154, v155
    ds_write_b32 v4, v157 offset:4624
    v_mul_f32 v152, v138, v124
    v_mul_f32 v153, v142, v124
    v_fmac_f32 v152, v142, v125
    v_fma_f32 v153, -v138, v125, v153
    v_cvt_pk_bf16_f32 v158, v152, v153
    ds_write_b32 v4, v158 offset:4896
    v_mul_f32 v154, v139, v126
    v_mul_f32 v155, v143, v126
    v_fmac_f32 v154, v143, v127
    v_fma_f32 v155, -v139, v127, v155
    v_cvt_pk_bf16_f32 v159, v154, v155
    ds_write_b32 v4, v159 offset:5168
    s_waitcnt lgkmcnt(0)
    s_barrier
    ds_read_b128 v[8:11], v2 offset:0
    ds_read_b128 v[24:27], v2 offset:4352
    ds_read_b128 v[12:15], v2 offset:64
    ds_read_b128 v[28:31], v2 offset:4416
    ds_read_b128 v[16:19], v2 offset:128
    ds_read_b128 v[32:35], v2 offset:4480
    ds_read_b128 v[20:23], v2 offset:192
    ds_read_b128 v[36:39], v2 offset:4544
    s_waitcnt lgkmcnt(0)
    v_mfma_f32_16x16x32_bf16 v[128:131], v[8:11], v[48:51], 0
    v_mfma_f32_16x16x32_bf16 v[132:135], v[8:11], v[64:67], 0
    v_mfma_f32_16x16x32_bf16 v[136:139], v[24:27], v[48:51], 0
    v_mfma_f32_16x16x32_bf16 v[140:143], v[24:27], v[64:67], 0
    v_mfma_f32_16x16x32_bf16 v[128:131], v[12:15], v[52:55], v[128:131]
    v_mfma_f32_16x16x32_bf16 v[132:135], v[12:15], v[68:71], v[132:135]
    v_mfma_f32_16x16x32_bf16 v[136:139], v[28:31], v[52:55], v[136:139]
    v_mfma_f32_16x16x32_bf16 v[140:143], v[28:31], v[68:71], v[140:143]
    v_mfma_f32_16x16x32_bf16 v[128:131], v[16:19], v[56:59], v[128:131]
    v_mfma_f32_16x16x32_bf16 v[132:135], v[16:19], v[72:75], v[132:135]
    v_mfma_f32_16x16x32_bf16 v[136:139], v[32:35], v[56:59], v[136:139]
    v_mfma_f32_16x16x32_bf16 v[140:143], v[32:35], v[72:75], v[140:143]
    v_mfma_f32_16x16x32_bf16 v[128:131], v[20:23], v[60:63], v[128:131]
    v_mfma_f32_16x16x32_bf16 v[132:135], v[20:23], v[76:79], v[132:135]
    v_mfma_f32_16x16x32_bf16 v[136:139], v[36:39], v[60:63], v[136:139]
    v_mfma_f32_16x16x32_bf16 v[140:143], v[36:39], v[76:79], v[140:143]
    s_nop 4
    v_cvt_pk_bf16_f32 v152, v128, v129
    v_cvt_pk_bf16_f32 v153, v130, v131
    v_cvt_pk_bf16_f32 v154, v132, v133
    v_cvt_pk_bf16_f32 v155, v134, v135
    buffer_store_dwordx4 v[152:155], v1, s[16:19], s24 offen offset:0
    v_cvt_pk_bf16_f32 v156, v136, v137
    v_cvt_pk_bf16_f32 v157, v138, v139
    v_cvt_pk_bf16_f32 v158, v140, v141
    v_cvt_pk_bf16_f32 v159, v142, v143
    buffer_store_dwordx4 v[156:159], v1, s[16:19], s24 offen offset:64
p2_done:
    s_endpgm
.globl p3_kernel
.p2align 8
.type p3_kernel,@function
p3_kernel:
    s_cmp_ge_u32 s2, 256
    s_cbranch_scc1 p3_done
    s_load_dwordx2 s[4:5], s[0:1], 96
    s_load_dwordx2 s[6:7], s[0:1], 0
    v_and_b32 v1, 63, v0
    v_lshrrev_b32 v2, 6, v0
    s_nop 0
    v_readfirstlane_b32 s3, v2
    s_and_b32 s24, s2, 7
    s_lshr_b32 s25, s2, 3
    s_and_b32 s26, s25, 3
    s_lshr_b32 s25, s25, 2
    s_lshl_b32 s25, s25, 3
    s_add_u32 s24, s24, s25
    s_lshl_b32 s24, s24, 2
    s_add_u32 s24, s24, s26
    s_and_b32 s28, s3, 3
    s_lshr_b32 s29, s3, 2
    v_and_b32 v5, 15, v1
    v_lshrrev_b32 v6, 4, v1
    s_lshl_b32 s33, s28, 4
    v_add_u32 v7, s33, v5
    v_and_b32 v2, 1, v1
    v_lshrrev_b32 v3, 1, v1
    s_and_b32 s34, s3, 1
    s_lshl_b32 s35, s34, 5
    v_add_u32 v3, s35, v3
    s_cmp_eq_u32 s34, 0
    s_cselect_b32 s35, 1, -1
    s_cselect_b32 s36, 0, 576
    s_lshr_b32 s37, s3, 1
    v_mad_u32_u24 v92, v3, 9, s37
    v_mul_lo_u32 v92, v92, s35
    v_add_u32 v92, s36, v92
    v_lshlrev_b32 v92, 13, v92
    v_lshl_add_u32 v92, v2, 4, v92
    s_lshl_b32 s38, s24, 5
    s_lshl_b32 s39, s35, 15
    v_add_u32 v93, s39, v92
    v_mul_u32_u24 v94, 5760, v2
    v_lshl_add_u32 v94, v3, 3, v94
    s_mul_i32 s39, s37, 576
    v_add_u32 v94, s39, v94
    v_mul_u32_u24 v3, 1152, v6
    v_lshl_add_u32 v3, v7, 1, v3
    s_lshl_b32 s30, s24, 1
    s_add_u32 s30, s30, s29
    s_mul_i32 s30, s30, 4608
    v_lshlrev_b32 v4, 2, v7
    v_mov_b32 v8, 0
    v_mov_b32 v9, 0
    v_mov_b32 v10, 0
    v_mov_b32 v11, 0
    v_mov_b32 v12, 0
    v_mov_b32 v13, 0
    v_mov_b32 v14, 0
    v_mov_b32 v15, 0
    v_mov_b32 v16, 0
    s_movk_i32 s40, 4608
    s_movk_i32 s41, 6912
    s_movk_i32 s42, 9216
    s_mov_b32 s32, 0xffff0000
    s_waitcnt lgkmcnt(0)
    s_mov_b32 s8, s6
    s_mov_b32 s9, s7
    s_mov_b32 s10, 0x240000
    s_mov_b32 s11, 0x20000
    s_mov_b32 s12, s4
    s_mov_b32 s13, s5
    s_mov_b32 s14, 0x3600
    s_mov_b32 s15, 0x20000
    s_add_u32 s16, s4, 0x700000
    s_addc_u32 s17, s5, 0
    s_mov_b32 s18, 0x242000
    s_mov_b32 s19, 0x20000
    s_add_u32 s20, s4, 0xa00000
    s_addc_u32 s21, s5, 0
    s_mov_b32 s22, 0x240000
    s_mov_b32 s23, 0x20000
    s_add_u32 s44, s4, 0xd00000
    s_addc_u32 s45, s5, 0
    s_mov_b32 s46, 0x240000
    s_mov_b32 s47, 0x20000
    buffer_load_dwordx4 v[44:47], v92, s[16:19], s38 offen
    s_cmp_lt_u32 s3, 2
    s_cbranch_scc0 p3_noz2
    buffer_load_dwordx4 v[48:51], v93, s[16:19], s38 offen
p3_noz2:
    buffer_load_short_d16_hi v8, v3, s[8:11], s30 offen offset:0
    buffer_load_short_d16_hi v9, v3, s[8:11], s30 offen offset:128
    buffer_load_short_d16_hi v10, v3, s[8:11], s30 offen offset:256
    buffer_load_short_d16_hi v11, v3, s[8:11], s30 offen offset:384
    buffer_load_short_d16_hi v12, v3, s[8:11], s30 offen offset:512
    buffer_load_short_d16_hi v13, v3, s[8:11], s30 offen offset:640
    buffer_load_short_d16_hi v14, v3, s[8:11], s30 offen offset:768
    buffer_load_short_d16_hi v15, v3, s[8:11], s30 offen offset:896
    buffer_load_short_d16_hi v16, v3, s[8:11], s30 offen offset:1024
    buffer_load_dword v17, v4, s[12:15], s40 offen offset:0
    buffer_load_dword v18, v4, s[12:15], s40 offen offset:256
    buffer_load_dword v19, v4, s[12:15], s40 offen offset:512
    buffer_load_dword v20, v4, s[12:15], s40 offen offset:768
    buffer_load_dword v21, v4, s[12:15], s40 offen offset:1024
    buffer_load_dword v22, v4, s[12:15], s40 offen offset:1280
    buffer_load_dword v23, v4, s[12:15], s40 offen offset:1536
    buffer_load_dword v24, v4, s[12:15], s40 offen offset:1792
    buffer_load_dword v25, v4, s[12:15], s40 offen offset:2048
    buffer_load_dword v35, v4, s[12:15], s42 offen offset:0
    buffer_load_dword v36, v4, s[12:15], s42 offen offset:256
    buffer_load_dword v37, v4, s[12:15], s42 offen offset:512
    buffer_load_dword v38, v4, s[12:15], s42 offen offset:768
    buffer_load_dword v39, v4, s[12:15], s42 offen offset:1024
    buffer_load_dword v40, v4, s[12:15], s42 offen offset:1280
    buffer_load_dword v41, v4, s[12:15], s42 offen offset:1536
    buffer_load_dword v42, v4, s[12:15], s42 offen offset:1792
    buffer_load_dword v43, v4, s[12:15], s42 offen offset:2048
    buffer_load_dword v26, v4, s[12:15], s41 offen offset:0
    buffer_load_dword v27, v4, s[12:15], s41 offen offset:256
    buffer_load_dword v28, v4, s[12:15], s41 offen offset:512
    buffer_load_dword v29, v4, s[12:15], s41 offen offset:768
    buffer_load_dword v30, v4, s[12:15], s41 offen offset:1024
    buffer_load_dword v31, v4, s[12:15], s41 offen offset:1280
    buffer_load_dword v32, v4, s[12:15], s41 offen offset:1536
    buffer_load_dword v33, v4, s[12:15], s41 offen offset:1792
    buffer_load_dword v34, v4, s[12:15], s41 offen offset:2048
    v_mov_b32 v2, v94
    v_cvt_f32_u32 v120, v7
    v_cvt_f32_u32 v121, v6
    v_mul_f32 v121, v121, v120
    v_mul_f32 v121, 0x3d800000, v121
    v_fmamk_f32 v92, v120, 0x00000000, v121
    v_fmamk_f32 v93, v120, 0x3c800000, v121
    v_fmamk_f32 v94, v120, 0x3d000000, v121
    v_fmamk_f32 v95, v120, 0x3d400000, v121
    v_cos_f32 v96, v92
    v_sin_f32 v100, v92
    v_cos_f32 v97, v93
    v_sin_f32 v101, v93
    v_cos_f32 v98, v94
    v_sin_f32 v102, v94
    v_cos_f32 v99, v95
    v_sin_f32 v103, v95
    v_cvt_pk_bf16_f32 v52, v96, v97
    v_cvt_pk_bf16_f32 v53, v98, v99
    v_cvt_pk_bf16_f32 v70, -v96, -v97
    v_cvt_pk_bf16_f32 v71, -v98, -v99
    v_cvt_pk_bf16_f32 v54, v100, v101
    v_cvt_pk_bf16_f32 v55, v102, v103
    v_cvt_pk_bf16_f32 v68, v100, v101
    v_cvt_pk_bf16_f32 v69, v102, v103
    v_fmamk_f32 v92, v120, 0x3e800000, v121
    v_fmamk_f32 v93, v120, 0x3e880000, v121
    v_fmamk_f32 v94, v120, 0x3e900000, v121
    v_fmamk_f32 v95, v120, 0x3e980000, v121
    v_cos_f32 v96, v92
    v_sin_f32 v100, v92
    v_cos_f32 v97, v93
    v_sin_f32 v101, v93
    v_cos_f32 v98, v94
    v_sin_f32 v102, v94
    v_cos_f32 v99, v95
    v_sin_f32 v103, v95
    v_cvt_pk_bf16_f32 v56, v96, v97
    v_cvt_pk_bf16_f32 v57, v98, v99
    v_cvt_pk_bf16_f32 v74, -v96, -v97
    v_cvt_pk_bf16_f32 v75, -v98, -v99
    v_cvt_pk_bf16_f32 v58, v100, v101
    v_cvt_pk_bf16_f32 v59, v102, v103
    v_cvt_pk_bf16_f32 v72, v100, v101
    v_cvt_pk_bf16_f32 v73, v102, v103
    v_fmamk_f32 v92, v120, 0x3f000000, v121
    v_fmamk_f32 v93, v120, 0x3f040000, v121
    v_fmamk_f32 v94, v120, 0x3f080000, v121
    v_fmamk_f32 v95, v120, 0x3f0c0000, v121
    v_cos_f32 v96, v92
    v_sin_f32 v100, v92
    v_cos_f32 v97, v93
    v_sin_f32 v101, v93
    v_cos_f32 v98, v94
    v_sin_f32 v102, v94
    v_cos_f32 v99, v95
    v_sin_f32 v103, v95
    v_cvt_pk_bf16_f32 v60, v96, v97
    v_cvt_pk_bf16_f32 v61, v98, v99
    v_cvt_pk_bf16_f32 v78, v96, v97
    v_cvt_pk_bf16_f32 v79, v98, v99
    v_cvt_pk_bf16_f32 v62, -v100, -v101
    v_cvt_pk_bf16_f32 v63, -v102, -v103
    v_cvt_pk_bf16_f32 v76, v100, v101
    v_cvt_pk_bf16_f32 v77, v102, v103
    v_fmamk_f32 v92, v120, 0x3f400000, v121
    v_fmamk_f32 v93, v120, 0x3f440000, v121
    v_fmamk_f32 v94, v120, 0x3f480000, v121
    v_fmamk_f32 v95, v120, 0x3f4c0000, v121
    v_cos_f32 v96, v92
    v_sin_f32 v100, v92
    v_cos_f32 v97, v93
    v_sin_f32 v101, v93
    v_cos_f32 v98, v94
    v_sin_f32 v102, v94
    v_cos_f32 v99, v95
    v_sin_f32 v103, v95
    v_cvt_pk_bf16_f32 v64, v96, v97
    v_cvt_pk_bf16_f32 v65, v98, v99
    v_cvt_pk_bf16_f32 v82, v96, v97
    v_cvt_pk_bf16_f32 v83, v98, v99
    v_cvt_pk_bf16_f32 v66, -v100, -v101
    v_cvt_pk_bf16_f32 v67, -v102, -v103
    v_cvt_pk_bf16_f32 v80, v100, v101
    v_cvt_pk_bf16_f32 v81, v102, v103
    v_mul_f32 v93, 0x3ae38e39, v120
    v_mul_f32 v94, 0x3b638e39, v120
    v_mul_f32 v95, 0x3baaaaab, v120
    v_mul_f32 v96, 0x3be38e39, v120
    v_cos_f32 v84, v93
    v_sin_f32 v85, v93
    v_cos_f32 v86, v94
    v_sin_f32 v87, v94
    v_cos_f32 v88, v95
    v_sin_f32 v89, v95
    v_cos_f32 v90, v96
    v_sin_f32 v91, v96
    v_mul_f32 v84, 0x35e38e39, v84
    v_mul_f32 v85, 0x35e38e39, v85
    v_mul_f32 v86, 0x35e38e39, v86
    v_mul_f32 v87, 0x35e38e39, v87
    v_mul_f32 v88, 0x35e38e39, v88
    v_mul_f32 v89, 0x35e38e39, v89
    v_mul_f32 v90, 0x35e38e39, v90
    v_mul_f32 v91, 0x35e38e39, v91
    v_lshrrev_b32 v92, 2, v5
    v_lshl_add_u32 v92, v6, 2, v92
    v_lshlrev_b32 v92, 3, v92
    s_mul_i32 s39, s29, 5760
    v_add_u32 v122, s39, v92
    v_and_b32 v92, 3, v1
    v_add_u32 v92, 1, v92
    v_mul_u32_u24 v123, 72, v92
    v_lshl_add_u32 v123, v123, 3, v122
    s_waitcnt vmcnt(36)
    ds_write_b64 v2, v[44:45]
    ds_write_b64 v2, v[46:47] offset:2880
    s_cmp_lt_u32 s3, 2
    s_cbranch_scc0 p3_noz3
    ds_write_b64 v2, v[48:49] offset:2304
    ds_write_b64 v2, v[50:51] offset:5184
p3_noz3:
    s_waitcnt lgkmcnt(0)
    s_barrier
    ds_read_b64_tr_b16 v[92:93], v123 offset:0
    ds_read_b64_tr_b16 v[94:95], v123 offset:2880
    ds_read_b64_tr_b16 v[96:97], v123 offset:128
    ds_read_b64_tr_b16 v[98:99], v123 offset:3008
    ds_read_b64_tr_b16 v[100:101], v123 offset:256
    ds_read_b64_tr_b16 v[102:103], v123 offset:3136
    ds_read_b64_tr_b16 v[104:105], v123 offset:384
    ds_read_b64_tr_b16 v[106:107], v123 offset:3264
    ds_read_b64_tr_b16 v[44:45], v122 offset:0
    ds_read_b64_tr_b16 v[46:47], v122 offset:2880
    ds_read_b64_tr_b16 v[48:49], v122 offset:128
    ds_read_b64_tr_b16 v[50:51], v122 offset:3008
    ds_read_b64_tr_b16 v[124:125], v122 offset:256
    ds_read_b64_tr_b16 v[126:127], v122 offset:3136
    s_waitcnt lgkmcnt(12)
    v_mfma_f32_16x16x32_bf16 v[108:111], v[92:95], v[52:55], 0
    v_mfma_f32_16x16x32_bf16 v[112:115], v[92:95], v[68:71], 0
    s_waitcnt lgkmcnt(10)
    v_mfma_f32_16x16x32_bf16 v[108:111], v[96:99], v[56:59], v[108:111]
    v_mfma_f32_16x16x32_bf16 v[112:115], v[96:99], v[72:75], v[112:115]
    s_waitcnt lgkmcnt(8)
    v_mfma_f32_16x16x32_bf16 v[108:111], v[100:103], v[60:63], v[108:111]
    v_mfma_f32_16x16x32_bf16 v[112:115], v[100:103], v[76:79], v[112:115]
    s_waitcnt lgkmcnt(6)
    v_mfma_f32_16x16x32_bf16 v[108:111], v[104:107], v[64:67], v[108:111]
    v_mfma_f32_16x16x32_bf16 v[112:115], v[104:107], v[80:83], v[112:115]
    s_waitcnt lgkmcnt(4)
    v_mfma_f32_16x16x32_bf16 v[116:119], v[44:47], v[52:55], 0
    ds_read_b64_tr_b16 v[92:93], v122 offset:384
    ds_read_b64_tr_b16 v[94:95], v122 offset:3264
    s_waitcnt lgkmcnt(2)
    v_mfma_f32_16x16x32_bf16 v[116:119], v[48:51], v[56:59], v[116:119]
    v_mfma_f32_16x16x32_bf16 v[116:119], v[124:127], v[60:63], v[116:119]
    s_waitcnt lgkmcnt(0)
    v_mfma_f32_16x16x32_bf16 v[116:119], v[92:95], v[64:67], v[116:119]
    v_permlane32_swap_b32 v108, v110
    v_permlane32_swap_b32 v109, v111
    v_permlane32_swap_b32 v112, v114
    v_permlane32_swap_b32 v113, v115
    v_permlane16_swap_b32 v108, v109
    v_permlane16_swap_b32 v110, v111
    v_permlane16_swap_b32 v112, v113
    v_permlane16_swap_b32 v114, v115
    v_mul_f32 v92, v108, v84
    v_mul_f32 v93, v112, v84
    v_fma_f32 v92, -v112, v85, v92
    v_fmac_f32 v93, v108, v85
    v_mul_f32 v94, v109, v86
    v_mul_f32 v95, v113, v86
    v_fma_f32 v94, -v113, v87, v94
    v_fmac_f32 v95, v109, v87
    v_mul_f32 v96, v110, v88
    v_mul_f32 v97, v114, v88
    v_fma_f32 v96, -v114, v89, v96
    v_fmac_f32 v97, v110, v89
    v_mul_f32 v98, v111, v90
    v_mul_f32 v99, v115, v90
    v_fma_f32 v98, -v115, v91, v98
    v_fmac_f32 v99, v111, v91
    v_cmp_eq_u32 vcc, 1, v6
    s_nop 1
    v_cndmask_b32 v100, v116, v117, vcc
    v_cmp_eq_u32 vcc, 2, v6
    s_nop 1
    v_cndmask_b32 v100, v100, v118, vcc
    v_cmp_eq_u32 vcc, 3, v6
    s_nop 1
    v_cndmask_b32 v100, v100, v119, vcc
    v_mul_f32 v100, 0x35638e39, v100
    v_add_f32 v52, v100, v92
    v_add_f32 v52, v52, v94
    v_add_f32 v52, v52, v96
    v_add_f32 v52, v52, v98
    v_fmamk_f32 v68, v92, 0x3f441b7d, v100
    v_fmamk_f32 v68, v94, 0x3e31d0d4, v68
    v_fmamk_f32 v68, v96, 0xbf000000, v68
    v_fmamk_f32 v68, v98, 0xbf708fb2, v68
    v_mul_f32 v72, 0x3f248dbb, v93
    v_fmamk_f32 v72, v95, 0x3f7c1c5c, v72
    v_fmamk_f32 v72, v97, 0x3f5db3d7, v72
    v_fmamk_f32 v72, v99, 0x3eaf1d44, v72
    v_fmamk_f32 v69, v92, 0x3e31d0d4, v100
    v_fmamk_f32 v69, v94, 0xbf708fb2, v69
    v_fmamk_f32 v69, v96, 0xbf000000, v69
    v_fmamk_f32 v69, v98, 0x3f441b7d, v69
    v_mul_f32 v73, 0x3f7c1c5c, v93
    v_fmamk_f32 v73, v95, 0x3eaf1d44, v73
    v_fmamk_f32 v73, v97, 0xbf5db3d7, v73
    v_fmamk_f32 v73, v99, 0xbf248dbb, v73
    v_fmamk_f32 v70, v92, 0xbf000000, v100
    v_fmamk_f32 v70, v94, 0xbf000000, v70
    v_fmamk_f32 v70, v96, 0x3f800000, v70
    v_fmamk_f32 v70, v98, 0xbf000000, v70
    v_mul_f32 v74, 0x3f5db3d7, v93
    v_fmamk_f32 v74, v95, 0xbf5db3d7, v74
    v_fmamk_f32 v74, v99, 0x3f5db3d7, v74
    v_fmamk_f32 v71, v92, 0xbf708fb2, v100
    v_fmamk_f32 v71, v94, 0x3f441b7d, v71
    v_fmamk_f32 v71, v96, 0xbf000000, v71
    v_fmamk_f32 v71, v98, 0x3e31d0d4, v71
    v_mul_f32 v75, 0x3eaf1d44, v93
    v_fmamk_f32 v75, v95, 0xbf248dbb, v75
    v_fmamk_f32 v75, v97, 0x3f5db3d7, v75
    v_fmamk_f32 v75, v99, 0xbf7c1c5c, v75
    v_sub_f32 v53, v68, v72
    v_add_f32 v60, v68, v72
    v_sub_f32 v54, v69, v73
    v_add_f32 v59, v69, v73
    v_sub_f32 v55, v70, v74
    v_add_f32 v58, v70, v74
    v_sub_f32 v56, v71, v75
    v_add_f32 v57, v71, v75
    v_cvt_pk_bf16_f32 v92, v52, v53
    v_lshlrev_b32 v52, 16, v92
    v_and_b32 v53, s32, v92
    v_cvt_pk_bf16_f32 v93, v54, v55
    v_lshlrev_b32 v54, 16, v93
    v_and_b32 v55, s32, v93
    v_cvt_pk_bf16_f32 v92, v56, v57
    v_lshlrev_b32 v56, 16, v92
    v_and_b32 v57, s32, v92
    v_cvt_pk_bf16_f32 v93, v58, v59
    v_lshlrev_b32 v58, 16, v93
    v_and_b32 v59, s32, v93
    v_cvt_pk_bf16_f32 v60, v60, v60
    v_lshlrev_b32 v60, 16, v60
    s_waitcnt vmcnt(18)
    v_mul_f32 v52, v52, v17
    v_mul_f32 v53, v53, v18
    v_mul_f32 v54, v54, v19
    v_mul_f32 v55, v55, v20
    v_mul_f32 v56, v56, v21
    v_mul_f32 v57, v57, v22
    v_mul_f32 v58, v58, v23
    v_mul_f32 v59, v59, v24
    v_mul_f32 v60, v60, v25
    v_cvt_pk_bf16_f32 v92, v52, v53
    v_lshlrev_b32 v52, 16, v92
    v_and_b32 v53, s32, v92
    v_cvt_pk_bf16_f32 v93, v54, v55
    v_lshlrev_b32 v54, 16, v93
    v_and_b32 v55, s32, v93
    v_cvt_pk_bf16_f32 v92, v56, v57
    v_lshlrev_b32 v56, 16, v92
    v_and_b32 v57, s32, v92
    v_cvt_pk_bf16_f32 v93, v58, v59
    v_lshlrev_b32 v58, 16, v93
    v_and_b32 v59, s32, v93
    v_cvt_pk_bf16_f32 v60, v60, v60
    v_lshlrev_b32 v60, 16, v60
    v_add_f32 v8, v8, v52
    v_add_f32 v9, v9, v53
    v_add_f32 v10, v10, v54
    v_add_f32 v11, v11, v55
    v_add_f32 v12, v12, v56
    v_add_f32 v13, v13, v57
    v_add_f32 v14, v14, v58
    v_add_f32 v15, v15, v59
    v_add_f32 v16, v16, v60
    v_cvt_pk_bf16_f32 v92, v8, v9
    v_lshlrev_b32 v8, 16, v92
    v_and_b32 v9, s32, v92
    v_cvt_pk_bf16_f32 v93, v10, v11
    v_lshlrev_b32 v10, 16, v93
    v_and_b32 v11, s32, v93
    v_cvt_pk_bf16_f32 v92, v12, v13
    v_lshlrev_b32 v12, 16, v92
    v_and_b32 v13, s32, v92
    v_cvt_pk_bf16_f32 v93, v14, v15
    v_lshlrev_b32 v14, 16, v93
    v_and_b32 v15, s32, v93
    v_cvt_pk_bf16_f32 v16, v16, v16
    v_lshlrev_b32 v16, 16, v16
    buffer_store_short_d16_hi v8, v3, s[20:23], s30 offen offset:0
    buffer_store_short_d16_hi v9, v3, s[20:23], s30 offen offset:128
    buffer_store_short_d16_hi v10, v3, s[20:23], s30 offen offset:256
    buffer_store_short_d16_hi v11, v3, s[20:23], s30 offen offset:384
    buffer_store_short_d16_hi v12, v3, s[20:23], s30 offen offset:512
    buffer_store_short_d16_hi v13, v3, s[20:23], s30 offen offset:640
    buffer_store_short_d16_hi v14, v3, s[20:23], s30 offen offset:768
    buffer_store_short_d16_hi v15, v3, s[20:23], s30 offen offset:896
    buffer_store_short_d16_hi v16, v3, s[20:23], s30 offen offset:1024
    s_lshl_b32 s39, s29, 7
    s_add_u32 s39, s39, 11520
    v_lshl_add_u32 v122, v6, 5, s39
    s_lshl_b32 s39, s28, 3
    v_add_u32 v123, s39, v122
    v_cmp_eq_u32 s[48:49], 0, v5
    v_add_f32 v100, v8, v9
    v_add_f32 v100, v100, v10
    v_add_f32 v100, v100, v11
    v_add_f32 v100, v100, v12
    v_add_f32 v100, v100, v13
    v_add_f32 v100, v100, v14
    v_add_f32 v100, v100, v15
    v_add_f32 v100, v100, v16
    s_nop 1
    v_add_f32_dpp v100, v100, v100 quad_perm:[1,0,3,2] row_mask:0xf bank_mask:0xf
    s_nop 1
    v_add_f32_dpp v100, v100, v100 quad_perm:[2,3,0,1] row_mask:0xf bank_mask:0xf
    s_nop 1
    v_add_f32_dpp v100, v100, v100 row_half_mirror row_mask:0xf bank_mask:0xf
    s_nop 1
    v_add_f32_dpp v100, v100, v100 row_mirror row_mask:0xf bank_mask:0xf
    v_mul_f32 v102, 0x3be38e39, v100
    v_sub_f32 v92, v8, v102
    v_mul_f32 v101, v92, v92
    v_sub_f32 v93, v9, v102
    v_fmac_f32 v101, v93, v93
    v_sub_f32 v92, v10, v102
    v_fmac_f32 v101, v92, v92
    v_sub_f32 v93, v11, v102
    v_fmac_f32 v101, v93, v93
    v_sub_f32 v92, v12, v102
    v_fmac_f32 v101, v92, v92
    v_sub_f32 v93, v13, v102
    v_fmac_f32 v101, v93, v93
    v_sub_f32 v92, v14, v102
    v_fmac_f32 v101, v92, v92
    v_sub_f32 v93, v15, v102
    v_fmac_f32 v101, v93, v93
    v_sub_f32 v92, v16, v102
    v_fmac_f32 v101, v92, v92
    s_nop 1
    v_add_f32_dpp v101, v101, v101 quad_perm:[1,0,3,2] row_mask:0xf bank_mask:0xf
    s_nop 1
    v_add_f32_dpp v101, v101, v101 quad_perm:[2,3,0,1] row_mask:0xf bank_mask:0xf
    s_nop 1
    v_add_f32_dpp v101, v101, v101 row_half_mirror row_mask:0xf bank_mask:0xf
    s_nop 1
    v_add_f32_dpp v101, v101, v101 row_mirror row_mask:0xf bank_mask:0xf
    s_mov_b64 exec, s[48:49]
    ds_write_b64 v123, v[100:101] offset:0
    s_mov_b64 exec, -1
    s_waitcnt lgkmcnt(0)
    s_barrier
    ds_read_b128 v[92:95], v122 offset:0
    ds_read_b128 v[96:99], v122 offset:16
    s_waitcnt lgkmcnt(0)
    v_add_f32 v100, v92, v94
    v_add_f32 v102, v96, v98
    v_add_f32 v101, v93, v95
    v_add_f32 v103, v97, v99
    v_add_f32 v100, v100, v102
    v_add_f32 v101, v101, v103
    v_mul_f32 v100, 0x3ae38e39, v100
    v_mul_f32 v102, 0x43100000, v100
    v_sub_f32 v92, v92, v102
    v_mul_f32 v103, v92, v92
    v_sub_f32 v94, v94, v102
    v_fmac_f32 v103, v94, v94
    v_sub_f32 v96, v96, v102
    v_fmac_f32 v103, v96, v96
    v_sub_f32 v98, v98, v102
    v_fmac_f32 v103, v98, v98
    v_fmamk_f32 v101, v103, 0x3be38e39, v101
    v_mul_f32 v101, 0x3ae38e39, v101
    v_cvt_pk_bf16_f32 v100, v100, v100
    v_lshlrev_b32 v100, 16, v100
    v_cvt_pk_bf16_f32 v101, v101, v101
    v_lshlrev_b32 v101, 16, v101
    v_add_f32 v101, 0x3727c5ac, v101
    v_cvt_pk_bf16_f32 v101, v101, v101
    v_lshlrev_b32 v101, 16, v101
    v_sqrt_f32 v101, v101
    s_nop 0
    v_cvt_pk_bf16_f32 v101, v101, v101
    v_lshlrev_b32 v101, 16, v101
    v_rcp_f32 v101, v101
    v_sub_f32 v8, v8, v100
    v_sub_f32 v9, v9, v100
    v_sub_f32 v10, v10, v100
    v_sub_f32 v11, v11, v100
    v_sub_f32 v12, v12, v100
    v_sub_f32 v13, v13, v100
    v_sub_f32 v14, v14, v100
    v_sub_f32 v15, v15, v100
    v_sub_f32 v16, v16, v100
    v_cvt_pk_bf16_f32 v92, v8, v9
    v_lshlrev_b32 v8, 16, v92
    v_and_b32 v9, s32, v92
    v_cvt_pk_bf16_f32 v93, v10, v11
    v_lshlrev_b32 v10, 16, v93
    v_and_b32 v11, s32, v93
    v_cvt_pk_bf16_f32 v92, v12, v13
    v_lshlrev_b32 v12, 16, v92
    v_and_b32 v13, s32, v92
    v_cvt_pk_bf16_f32 v93, v14, v15
    v_lshlrev_b32 v14, 16, v93
    v_and_b32 v15, s32, v93
    v_cvt_pk_bf16_f32 v16, v16, v16
    v_lshlrev_b32 v16, 16, v16
    v_mul_f32 v8, v8, v101
    v_mul_f32 v9, v9, v101
    v_mul_f32 v10, v10, v101
    v_mul_f32 v11, v11, v101
    v_mul_f32 v12, v12, v101
    v_mul_f32 v13, v13, v101
    v_mul_f32 v14, v14, v101
    v_mul_f32 v15, v15, v101
    v_mul_f32 v16, v16, v101
    v_cvt_pk_bf16_f32 v92, v8, v9
    v_lshlrev_b32 v8, 16, v92
    v_and_b32 v9, s32, v92
    v_cvt_pk_bf16_f32 v93, v10, v11
    v_lshlrev_b32 v10, 16, v93
    v_and_b32 v11, s32, v93
    v_cvt_pk_bf16_f32 v92, v12, v13
    v_lshlrev_b32 v12, 16, v92
    v_and_b32 v13, s32, v92
    v_cvt_pk_bf16_f32 v93, v14, v15
    v_lshlrev_b32 v14, 16, v93
    v_and_b32 v15, s32, v93
    v_cvt_pk_bf16_f32 v16, v16, v16
    v_lshlrev_b32 v16, 16, v16
    s_waitcnt vmcnt(9)
    v_mul_f32 v8, v8, v35
    v_mul_f32 v9, v9, v36
    v_mul_f32 v10, v10, v37
    v_mul_f32 v11, v11, v38
    v_mul_f32 v12, v12, v39
    v_mul_f32 v13, v13, v40
    v_mul_f32 v14, v14, v41
    v_mul_f32 v15, v15, v42
    v_mul_f32 v16, v16, v43
    v_cvt_pk_bf16_f32 v92, v8, v9
    v_lshlrev_b32 v8, 16, v92
    v_and_b32 v9, s32, v92
    v_cvt_pk_bf16_f32 v93, v10, v11
    v_lshlrev_b32 v10, 16, v93
    v_and_b32 v11, s32, v93
    v_cvt_pk_bf16_f32 v92, v12, v13
    v_lshlrev_b32 v12, 16, v92
    v_and_b32 v13, s32, v92
    v_cvt_pk_bf16_f32 v93, v14, v15
    v_lshlrev_b32 v14, 16, v93
    v_and_b32 v15, s32, v93
    v_cvt_pk_bf16_f32 v16, v16, v16
    v_lshlrev_b32 v16, 16, v16
    v_add_f32 v8, v8, v26
    v_add_f32 v9, v9, v27
    v_add_f32 v10, v10, v28
    v_add_f32 v11, v11, v29
    v_add_f32 v12, v12, v30
    v_add_f32 v13, v13, v31
    v_add_f32 v14, v14, v32
    v_add_f32 v15, v15, v33
    v_add_f32 v16, v16, v34
    v_cvt_pk_bf16_f32 v92, v8, v9
    v_lshlrev_b32 v8, 16, v92
    v_and_b32 v9, s32, v92
    v_cvt_pk_bf16_f32 v93, v10, v11
    v_lshlrev_b32 v10, 16, v93
    v_and_b32 v11, s32, v93
    v_cvt_pk_bf16_f32 v92, v12, v13
    v_lshlrev_b32 v12, 16, v92
    v_and_b32 v13, s32, v92
    v_cvt_pk_bf16_f32 v93, v14, v15
    v_lshlrev_b32 v14, 16, v93
    v_and_b32 v15, s32, v93
    v_cvt_pk_bf16_f32 v16, v16, v16
    v_lshlrev_b32 v16, 16, v16
    v_add_f32 v100, v8, v9
    v_add_f32 v100, v100, v10
    v_add_f32 v100, v100, v11
    v_add_f32 v100, v100, v12
    v_add_f32 v100, v100, v13
    v_add_f32 v100, v100, v14
    v_add_f32 v100, v100, v15
    v_add_f32 v100, v100, v16
    s_nop 1
    v_add_f32_dpp v100, v100, v100 quad_perm:[1,0,3,2] row_mask:0xf bank_mask:0xf
    s_nop 1
    v_add_f32_dpp v100, v100, v100 quad_perm:[2,3,0,1] row_mask:0xf bank_mask:0xf
    s_nop 1
    v_add_f32_dpp v100, v100, v100 row_half_mirror row_mask:0xf bank_mask:0xf
    s_nop 1
    v_add_f32_dpp v100, v100, v100 row_mirror row_mask:0xf bank_mask:0xf
    v_mul_f32 v102, 0x3be38e39, v100
    v_sub_f32 v92, v8, v102
    v_mul_f32 v101, v92, v92
    v_sub_f32 v93, v9, v102
    v_fmac_f32 v101, v93, v93
    v_sub_f32 v92, v10, v102
    v_fmac_f32 v101, v92, v92
    v_sub_f32 v93, v11, v102
    v_fmac_f32 v101, v93, v93
    v_sub_f32 v92, v12, v102
    v_fmac_f32 v101, v92, v92
    v_sub_f32 v93, v13, v102
    v_fmac_f32 v101, v93, v93
    v_sub_f32 v92, v14, v102
    v_fmac_f32 v101, v92, v92
    v_sub_f32 v93, v15, v102
    v_fmac_f32 v101, v93, v93
    v_sub_f32 v92, v16, v102
    v_fmac_f32 v101, v92, v92
    s_nop 1
    v_add_f32_dpp v101, v101, v101 quad_perm:[1,0,3,2] row_mask:0xf bank_mask:0xf
    s_nop 1
    v_add_f32_dpp v101, v101, v101 quad_perm:[2,3,0,1] row_mask:0xf bank_mask:0xf
    s_nop 1
    v_add_f32_dpp v101, v101, v101 row_half_mirror row_mask:0xf bank_mask:0xf
    s_nop 1
    v_add_f32_dpp v101, v101, v101 row_mirror row_mask:0xf bank_mask:0xf
    s_mov_b64 exec, s[48:49]
    ds_write_b64 v123, v[100:101] offset:256
    s_mov_b64 exec, -1
    s_waitcnt lgkmcnt(0)
    s_barrier
    ds_read_b128 v[92:95], v122 offset:256
    ds_read_b128 v[96:99], v122 offset:272
    s_waitcnt lgkmcnt(0)
    v_add_f32 v100, v92, v94
    v_add_f32 v102, v96, v98
    v_add_f32 v101, v93, v95
    v_add_f32 v103, v97, v99
    v_add_f32 v100, v100, v102
    v_add_f32 v101, v101, v103
    v_mul_f32 v100, 0x3ae38e39, v100
    v_mul_f32 v102, 0x43100000, v100
    v_sub_f32 v92, v92, v102
    v_mul_f32 v103, v92, v92
    v_sub_f32 v94, v94, v102
    v_fmac_f32 v103, v94, v94
    v_sub_f32 v96, v96, v102
    v_fmac_f32 v103, v96, v96
    v_sub_f32 v98, v98, v102
    v_fmac_f32 v103, v98, v98
    v_fmamk_f32 v101, v103, 0x3be38e39, v101
    v_mul_f32 v101, 0x3ae38e39, v101
    v_cvt_pk_bf16_f32 v100, v100, v100
    v_lshlrev_b32 v100, 16, v100
    v_cvt_pk_bf16_f32 v101, v101, v101
    v_lshlrev_b32 v101, 16, v101
    v_add_f32 v101, 0x3727c5ac, v101
    v_cvt_pk_bf16_f32 v101, v101, v101
    v_lshlrev_b32 v101, 16, v101
    v_sqrt_f32 v101, v101
    s_nop 0
    v_cvt_pk_bf16_f32 v101, v101, v101
    v_lshlrev_b32 v101, 16, v101
    v_rcp_f32 v101, v101
    v_sub_f32 v8, v8, v100
    v_sub_f32 v9, v9, v100
    v_sub_f32 v10, v10, v100
    v_sub_f32 v11, v11, v100
    v_sub_f32 v12, v12, v100
    v_sub_f32 v13, v13, v100
    v_sub_f32 v14, v14, v100
    v_sub_f32 v15, v15, v100
    v_sub_f32 v16, v16, v100
    v_cvt_pk_bf16_f32 v92, v8, v9
    v_lshlrev_b32 v8, 16, v92
    v_and_b32 v9, s32, v92
    v_cvt_pk_bf16_f32 v93, v10, v11
    v_lshlrev_b32 v10, 16, v93
    v_and_b32 v11, s32, v93
    v_cvt_pk_bf16_f32 v92, v12, v13
    v_lshlrev_b32 v12, 16, v92
    v_and_b32 v13, s32, v92
    v_cvt_pk_bf16_f32 v93, v14, v15
    v_lshlrev_b32 v14, 16, v93
    v_and_b32 v15, s32, v93
    v_cvt_pk_bf16_f32 v16, v16, v16
    v_lshlrev_b32 v16, 16, v16
    v_mul_f32 v8, v8, v101
    v_mul_f32 v9, v9, v101
    v_mul_f32 v10, v10, v101
    v_mul_f32 v11, v11, v101
    v_mul_f32 v12, v12, v101
    v_mul_f32 v13, v13, v101
    v_mul_f32 v14, v14, v101
    v_mul_f32 v15, v15, v101
    v_mul_f32 v16, v16, v101
    v_cvt_pk_bf16_f32 v92, v8, v9
    v_lshlrev_b32 v8, 16, v92
    v_and_b32 v9, s32, v92
    v_cvt_pk_bf16_f32 v93, v10, v11
    v_lshlrev_b32 v10, 16, v93
    v_and_b32 v11, s32, v93
    v_cvt_pk_bf16_f32 v92, v12, v13
    v_lshlrev_b32 v12, 16, v92
    v_and_b32 v13, s32, v92
    v_cvt_pk_bf16_f32 v93, v14, v15
    v_lshlrev_b32 v14, 16, v93
    v_and_b32 v15, s32, v93
    v_cvt_pk_bf16_f32 v16, v16, v16
    v_lshlrev_b32 v16, 16, v16
    v_mov_b32 v17, 0
    v_permlane16_swap_b32 v8, v9
    v_permlane16_swap_b32 v10, v11
    v_permlane16_swap_b32 v12, v13
    v_permlane16_swap_b32 v14, v15
    v_permlane16_swap_b32 v16, v17
    v_cvt_pk_bf16_f32 v92, v8, v9
    v_cvt_pk_bf16_f32 v93, v10, v11
    v_cvt_pk_bf16_f32 v94, v12, v13
    v_cvt_pk_bf16_f32 v95, v14, v15
    v_cvt_pk_bf16_f32 v96, v16, v17
    v_mov_b32 v97, 0
    v_permlane32_swap_b32 v92, v93
    v_permlane32_swap_b32 v94, v95
    v_permlane32_swap_b32 v96, v97
    s_mul_i32 s39, s24, 1536
    s_lshl_b32 s43, s29, 3
    s_add_u32 s39, s39, s43
    s_mov_b32 s43, 391680
    v_lshl_add_u32 v100, v6, 6, v7
    v_add_u32 v100, 0, v100
    v_mul_u32_u24 v101, 683, v100
    v_lshrrev_b32 v101, 16, v101
    v_mul_lo_u32 v101, v101, s43
    v_lshl_add_u32 v102, v100, 4, v101
    buffer_store_dwordx2 v[92:93], v102, s[44:47], s39 offen
    v_lshl_add_u32 v100, v6, 6, v7
    v_add_u32 v100, 256, v100
    v_mul_u32_u24 v101, 683, v100
    v_lshrrev_b32 v101, 16, v101
    v_mul_lo_u32 v101, v101, s43
    v_lshl_add_u32 v103, v100, 4, v101
    buffer_store_dwordx2 v[94:95], v103, s[44:47], s39 offen
    v_lshl_add_u32 v100, v6, 6, v7
    v_add_u32 v100, 512, v100
    v_mul_u32_u24 v101, 683, v100
    v_lshrrev_b32 v101, 16, v101
    v_mul_lo_u32 v101, v101, s43
    v_lshl_add_u32 v104, v100, 4, v101
    buffer_store_dwordx2 v[96:97], v104, s[44:47], s39 offen
p3_done:
    s_endpgm
.globl g1_kernel
.p2align 8
.type g1_kernel,@function
g1_kernel:
    s_cmp_ge_u32 s2, 216
    s_cbranch_scc1 g1_done
    s_load_dwordx2 s[4:5], s[0:1], 96
    s_load_dwordx4 s[16:19], s[0:1], 32
    v_lshrrev_b32 v2, 6, v0
    s_nop 0
    v_readfirstlane_b32 s3, v2
    s_and_b32 s33, s2, 7
    s_mul_i32 s33, s33, 27
    s_lshr_b32 s34, s2, 3
    s_add_u32 s33, s33, s34
    s_mul_i32 s34, s33, 171
    s_lshr_b32 s34, s34, 10
    s_mul_i32 s35, s34, 6
    s_sub_u32 s35, s33, s35
    s_lshl_b32 s20, s34, 8
    s_mul_i32 s21, s35, 393216
    s_waitcnt lgkmcnt(0)
    s_cmp_lt_u32 s3, 4
    s_cbranch_scc1 g1_cons
    s_mov_b32 s8, s16
    s_mov_b32 s9, s17
    s_mov_b32 s10, 0x1200000
    s_mov_b32 s11, 0x20000
    s_add_u32 s12, s4, 0xd00000
    s_addc_u32 s13, s5, 0
    s_mov_b32 s14, 0x240000
    s_mov_b32 s15, 0x20000
    v_and_b32 v1, 63, v0
    v_lshrrev_b32 v2, 4, v1
    v_and_b32 v3, 15, v1
    v_lshlrev_b32 v4, 1, v2
    v_xor_b32 v4, v4, v3
    v_xor_b32 v5, 8, v4
    s_movk_i32 s22, 9216
    v_mul_lo_u32 v2, v2, s22
    v_lshl_add_u32 v4, v4, 4, v2
    v_lshl_add_u32 v5, v5, 4, v2
    v_lshlrev_b32 v6, 4, v1
    s_sub_u32 s23, s3, 4
    s_mul_i32 s24, s23, 147456
    s_add_u32 s20, s20, s24
    s_mul_i32 s24, s23, 3072
    s_add_u32 s21, s21, s24
    s_lshl_b32 s25, s23, 12
    s_add_u32 s26, s24, 16384
    s_mov_b32 s27, 0
    s_add_u32 m0, s27, s25
    s_nop 0
    buffer_load_dwordx4 v4, s[8:11], s20 offen offset:0 lds
    s_add_u32 s28, s20, 35840
    buffer_load_dwordx4 v4, s[8:11], s28 offen offset:1024 lds
    s_add_u32 s29, s20, 71680
    buffer_load_dwordx4 v5, s[8:11], s29 offen offset:2048 lds
    s_add_u32 s30, s20, 107520
    buffer_load_dwordx4 v5, s[8:11], s30 offen offset:3072 lds
    s_add_u32 m0, s27, s26
    s_add_u32 s20, s20, 589824
    buffer_load_dwordx4 v6, s[12:15], s21 offen offset:0 lds
    buffer_load_dwordx4 v6, s[12:15], s21 offen offset:1024 lds
    buffer_load_dwordx4 v6, s[12:15], s21 offen offset:2048 lds
    s_add_u32 s21, s21, 12288
    s_add_u32 s27, s27, 28672
    s_cmp_eq_u32 s27, 143360
    s_cselect_b32 s27, 0, s27
    s_add_u32 m0, s27, s25
    s_nop 0
    buffer_load_dwordx4 v4, s[8:11], s20 offen offset:0 lds
    s_add_u32 s28, s20, 35840
    buffer_load_dwordx4 v4, s[8:11], s28 offen offset:1024 lds
    s_add_u32 s29, s20, 71680
    buffer_load_dwordx4 v5, s[8:11], s29 offen offset:2048 lds
    s_add_u32 s30, s20, 107520
    buffer_load_dwordx4 v5, s[8:11], s30 offen offset:3072 lds
    s_add_u32 m0, s27, s26
    s_add_u32 s20, s20, 589824
    buffer_load_dwordx4 v6, s[12:15], s21 offen offset:0 lds
    buffer_load_dwordx4 v6, s[12:15], s21 offen offset:1024 lds
    buffer_load_dwordx4 v6, s[12:15], s21 offen offset:2048 lds
    s_add_u32 s21, s21, 12288
    s_add_u32 s27, s27, 28672
    s_cmp_eq_u32 s27, 143360
    s_cselect_b32 s27, 0, s27
    s_add_u32 m0, s27, s25
    s_nop 0
    buffer_load_dwordx4 v4, s[8:11], s20 offen offset:0 lds
    s_add_u32 s28, s20, 35840
    buffer_load_dwordx4 v4, s[8:11], s28 offen offset:1024 lds
    s_add_u32 s29, s20, 71680
    buffer_load_dwordx4 v5, s[8:11], s29 offen offset:2048 lds
    s_add_u32 s30, s20, 107520
    buffer_load_dwordx4 v5, s[8:11], s30 offen offset:3072 lds
    s_add_u32 m0, s27, s26
    s_add_u32 s20, s20, 589824
    buffer_load_dwordx4 v6, s[12:15], s21 offen offset:0 lds
    buffer_load_dwordx4 v6, s[12:15], s21 offen offset:1024 lds
    buffer_load_dwordx4 v6, s[12:15], s21 offen offset:2048 lds
    s_add_u32 s21, s21, 12288
    s_add_u32 s27, s27, 28672
    s_cmp_eq_u32 s27, 143360
    s_cselect_b32 s27, 0, s27
    s_add_u32 m0, s27, s25
    s_nop 0
    buffer_load_dwordx4 v4, s[8:11], s20 offen offset:0 lds
    s_add_u32 s28, s20, 35840
    buffer_load_dwordx4 v4, s[8:11], s28 offen offset:1024 lds
    s_add_u32 s29, s20, 71680
    buffer_load_dwordx4 v5, s[8:11], s29 offen offset:2048 lds
    s_add_u32 s30, s20, 107520
    buffer_load_dwordx4 v5, s[8:11], s30 offen offset:3072 lds
    s_add_u32 m0, s27, s26
    s_add_u32 s20, s20, 589824
    buffer_load_dwordx4 v6, s[12:15], s21 offen offset:0 lds
    buffer_load_dwordx4 v6, s[12:15], s21 offen offset:1024 lds
    buffer_load_dwordx4 v6, s[12:15], s21 offen offset:2048 lds
    s_add_u32 s21, s21, 12288
    s_add_u32 s27, s27, 28672
    s_cmp_eq_u32 s27, 143360
    s_cselect_b32 s27, 0, s27
    s_movk_i32 s31, 28
g1_ld_loop:
    s_waitcnt vmcnt(21)
    s_barrier
    s_add_u32 m0, s27, s25
    s_nop 0
    buffer_load_dwordx4 v4, s[8:11], s20 offen offset:0 lds
    s_add_u32 s28, s20, 35840
    buffer_load_dwordx4 v4, s[8:11], s28 offen offset:1024 lds
    s_add_u32 s29, s20, 71680
    buffer_load_dwordx4 v5, s[8:11], s29 offen offset:2048 lds
    s_add_u32 s30, s20, 107520
    buffer_load_dwordx4 v5, s[8:11], s30 offen offset:3072 lds
    s_add_u32 m0, s27, s26
    s_add_u32 s20, s20, 589824
    buffer_load_dwordx4 v6, s[12:15], s21 offen offset:0 lds
    buffer_load_dwordx4 v6, s[12:15], s21 offen offset:1024 lds
    buffer_load_dwordx4 v6, s[12:15], s21 offen offset:2048 lds
    s_add_u32 s21, s21, 12288
    s_add_u32 s27, s27, 28672
    s_cmp_eq_u32 s27, 143360
    s_cselect_b32 s27, 0, s27
    s_sub_u32 s31, s31, 1
    s_cmp_lg_u32 s31, 0
    s_cbranch_scc1 g1_ld_loop
    s_waitcnt vmcnt(21)
    s_barrier
    s_waitcnt vmcnt(14)
    s_barrier
    s_waitcnt vmcnt(7)
    s_barrier
    s_waitcnt vmcnt(0)
    s_barrier
    s_branch g1_done
g1_cons:
    s_mov_b32 s8, s18
    s_mov_b32 s9, s19
    s_mov_b32 s10, 0x2400
    s_mov_b32 s11, 0x20000
    s_add_u32 s12, s4, 0x1000000
    s_addc_u32 s13, s5, 0
    s_mov_b32 s14, 0x510000
    s_mov_b32 s15, 0x20000
    v_and_b32 v1, 63, v0
    v_and_b32 v5, 15, v1
    v_lshrrev_b32 v6, 4, v1
    s_and_b32 s36, s3, 1
    s_lshr_b32 s37, s3, 1
    s_lshl_b32 s38, s36, 7
    s_add_u32 s38, s38, s20
    v_lshlrev_b32 v7, 3, v6
    buffer_load_dwordx2 v[24:25], v7, s[8:11], s38 offen offset:0
    buffer_load_dwordx2 v[26:27], v7, s[8:11], s38 offen offset:32
    buffer_load_dwordx2 v[28:29], v7, s[8:11], s38 offen offset:64
    buffer_load_dwordx2 v[30:31], v7, s[8:11], s38 offen offset:96
    s_lshl_b32 s40, s36, 2
    s_add_u32 s40, s40, 0
    s_lshl_b32 s41, s36, 2
    s_add_u32 s41, s41, 1
    s_lshl_b32 s42, s36, 2
    s_add_u32 s42, s42, 2
    s_lshl_b32 s43, s36, 2
    s_add_u32 s43, s43, 3
    v_lshrrev_b32 v2, 2, v5
    v_and_b32 v3, 1, v6
    v_lshl_add_u32 v3, v3, 2, v2
    v_mad_u32_u24 v2, v6, 8, v2
    v_lshlrev_b32 v2, 8, v2
    v_and_b32 v4, 3, v1
    v_lshl_add_u32 v2, v4, 3, v2
    v_xor_b32 v4, s40, v3
    v_lshl_add_u32 v8, v4, 5, v2
    v_xor_b32 v4, s41, v3
    v_lshl_add_u32 v9, v4, 5, v2
    v_xor_b32 v4, s42, v3
    v_lshl_add_u32 v10, v4, 5, v2
    v_xor_b32 v4, s43, v3
    v_lshl_add_u32 v11, v4, 5, v2
    v_mul_u32_u24 v2, 1536, v6
    v_lshl_add_u32 v2, v5, 4, v2
    s_mul_i32 s38, s37, 768
    s_add_u32 s38, s38, 16384
    v_add_u32 v12, s38, v2
    v_mov_b32 v88, 0
    v_mov_b32 v89, 0
    v_mov_b32 v90, 0
    v_mov_b32 v91, 0
    v_mov_b32 v92, 0
    v_mov_b32 v93, 0
    v_mov_b32 v94, 0
    v_mov_b32 v95, 0
    v_mov_b32 v96, 0
    v_mov_b32 v97, 0
    v_mov_b32 v98, 0
    v_mov_b32 v99, 0
    v_mov_b32 v100, 0
    v_mov_b32 v101, 0
    v_mov_b32 v102, 0
    v_mov_b32 v103, 0
    v_mov_b32 v104, 0
    v_mov_b32 v105, 0
    v_mov_b32 v106, 0
    v_mov_b32 v107, 0
    v_mov_b32 v108, 0
    v_mov_b32 v109, 0
    v_mov_b32 v110, 0
    v_mov_b32 v111, 0
    v_mov_b32 v112, 0
    v_mov_b32 v113, 0
    v_mov_b32 v114, 0
    v_mov_b32 v115, 0
    v_mov_b32 v116, 0
    v_mov_b32 v117, 0
    v_mov_b32 v118, 0
    v_mov_b32 v119, 0
    v_mov_b32 v120, 0
    v_mov_b32 v121, 0
    v_mov_b32 v122, 0
    v_mov_b32 v123, 0
    v_mov_b32 v124, 0
    v_mov_b32 v125, 0
    v_mov_b32 v126, 0
    v_mov_b32 v127, 0
    v_mov_b32 v128, 0
    v_mov_b32 v129, 0
    v_mov_b32 v130, 0
    v_mov_b32 v131, 0
    v_mov_b32 v132, 0
    v_mov_b32 v133, 0
    v_mov_b32 v134, 0
    v_mov_b32 v135, 0
    s_mov_b32 s27, 0
    v_add_u32 v16, s27, v8
    v_add_u32 v17, s27, v9
    v_add_u32 v18, s27, v10
    v_add_u32 v19, s27, v11
    v_add_u32 v20, s27, v12
    s_movk_i32 s31, 31
    s_barrier
    ds_read_b64_tr_b16 v[32:33], v16 offset:0
    ds_read_b64_tr_b16 v[34:35], v16 offset:1024
    ds_read_b64_tr_b16 v[36:37], v17 offset:0
    ds_read_b64_tr_b16 v[38:39], v17 offset:1024
    ds_read_b64_tr_b16 v[40:41], v18 offset:0
    ds_read_b64_tr_b16 v[42:43], v18 offset:1024
    ds_read_b64_tr_b16 v[44:45], v19 offset:0
    ds_read_b64_tr_b16 v[46:47], v19 offset:1024
    ds_read_b128 v[48:51], v20 offset:0
    ds_read_b128 v[52:55], v20 offset:256
    ds_read_b128 v[56:59], v20 offset:512
g1_mm_loop:
    s_waitcnt lgkmcnt(0)
    ds_read_b64_tr_b16 v[60:61], v16 offset:8192
    ds_read_b64_tr_b16 v[62:63], v16 offset:9216
    ds_read_b64_tr_b16 v[64:65], v17 offset:8192
    ds_read_b64_tr_b16 v[66:67], v17 offset:9216
    ds_read_b64_tr_b16 v[68:69], v18 offset:8192
    ds_read_b64_tr_b16 v[70:71], v18 offset:9216
    ds_read_b64_tr_b16 v[72:73], v19 offset:8192
    ds_read_b64_tr_b16 v[74:75], v19 offset:9216
    ds_read_b128 v[76:79], v20 offset:6144
    ds_read_b128 v[80:83], v20 offset:6400
    ds_read_b128 v[84:87], v20 offset:6656
    v_mfma_f32_16x16x32_bf16 v[88:91], v[32:35], v[48:51], v[88:91]
    v_mfma_f32_16x16x32_bf16 v[100:103], v[36:39], v[48:51], v[100:103]
    v_mfma_f32_16x16x32_bf16 v[112:115], v[40:43], v[48:51], v[112:115]
    v_mfma_f32_16x16x32_bf16 v[124:127], v[44:47], v[48:51], v[124:127]
    v_mfma_f32_16x16x32_bf16 v[92:95], v[32:35], v[52:55], v[92:95]
    v_mfma_f32_16x16x32_bf16 v[104:107], v[36:39], v[52:55], v[104:107]
    v_mfma_f32_16x16x32_bf16 v[116:119], v[40:43], v[52:55], v[116:119]
    v_mfma_f32_16x16x32_bf16 v[128:131], v[44:47], v[52:55], v[128:131]
    v_mfma_f32_16x16x32_bf16 v[96:99], v[32:35], v[56:59], v[96:99]
    v_mfma_f32_16x16x32_bf16 v[108:111], v[36:39], v[56:59], v[108:111]
    v_mfma_f32_16x16x32_bf16 v[120:123], v[40:43], v[56:59], v[120:123]
    v_mfma_f32_16x16x32_bf16 v[132:135], v[44:47], v[56:59], v[132:135]
    s_add_u32 s27, s27, 28672
    s_cmp_eq_u32 s27, 143360
    s_cselect_b32 s27, 0, s27
    s_waitcnt lgkmcnt(0)
    v_add_u32 v16, s27, v8
    v_add_u32 v17, s27, v9
    v_add_u32 v18, s27, v10
    v_add_u32 v19, s27, v11
    v_add_u32 v20, s27, v12
    s_barrier
    ds_read_b64_tr_b16 v[32:33], v16 offset:0
    ds_read_b64_tr_b16 v[34:35], v16 offset:1024
    ds_read_b64_tr_b16 v[36:37], v17 offset:0
    ds_read_b64_tr_b16 v[38:39], v17 offset:1024
    ds_read_b64_tr_b16 v[40:41], v18 offset:0
    ds_read_b64_tr_b16 v[42:43], v18 offset:1024
    ds_read_b64_tr_b16 v[44:45], v19 offset:0
    ds_read_b64_tr_b16 v[46:47], v19 offset:1024
    ds_read_b128 v[48:51], v20 offset:0
    ds_read_b128 v[52:55], v20 offset:256
    ds_read_b128 v[56:59], v20 offset:512
    v_mfma_f32_16x16x32_bf16 v[88:91], v[60:63], v[76:79], v[88:91]
    v_mfma_f32_16x16x32_bf16 v[100:103], v[64:67], v[76:79], v[100:103]
    v_mfma_f32_16x16x32_bf16 v[112:115], v[68:71], v[76:79], v[112:115]
    v_mfma_f32_16x16x32_bf16 v[124:127], v[72:75], v[76:79], v[124:127]
    v_mfma_f32_16x16x32_bf16 v[92:95], v[60:63], v[80:83], v[92:95]
    v_mfma_f32_16x16x32_bf16 v[104:107], v[64:67], v[80:83], v[104:107]
    v_mfma_f32_16x16x32_bf16 v[116:119], v[68:71], v[80:83], v[116:119]
    v_mfma_f32_16x16x32_bf16 v[128:131], v[72:75], v[80:83], v[128:131]
    v_mfma_f32_16x16x32_bf16 v[96:99], v[60:63], v[84:87], v[96:99]
    v_mfma_f32_16x16x32_bf16 v[108:111], v[64:67], v[84:87], v[108:111]
    v_mfma_f32_16x16x32_bf16 v[120:123], v[68:71], v[84:87], v[120:123]
    v_mfma_f32_16x16x32_bf16 v[132:135], v[72:75], v[84:87], v[132:135]
    s_sub_u32 s31, s31, 1
    s_cmp_lg_u32 s31, 0
    s_cbranch_scc1 g1_mm_loop
    s_waitcnt lgkmcnt(0)
    ds_read_b64_tr_b16 v[60:61], v16 offset:8192
    ds_read_b64_tr_b16 v[62:63], v16 offset:9216
    ds_read_b64_tr_b16 v[64:65], v17 offset:8192
    ds_read_b64_tr_b16 v[66:67], v17 offset:9216
    ds_read_b64_tr_b16 v[68:69], v18 offset:8192
    ds_read_b64_tr_b16 v[70:71], v18 offset:9216
    ds_read_b64_tr_b16 v[72:73], v19 offset:8192
    ds_read_b64_tr_b16 v[74:75], v19 offset:9216
    ds_read_b128 v[76:79], v20 offset:6144
    ds_read_b128 v[80:83], v20 offset:6400
    ds_read_b128 v[84:87], v20 offset:6656
    v_mfma_f32_16x16x32_bf16 v[88:91], v[32:35], v[48:51], v[88:91]
    v_mfma_f32_16x16x32_bf16 v[100:103], v[36:39], v[48:51], v[100:103]
    v_mfma_f32_16x16x32_bf16 v[112:115], v[40:43], v[48:51], v[112:115]
    v_mfma_f32_16x16x32_bf16 v[124:127], v[44:47], v[48:51], v[124:127]
    v_mfma_f32_16x16x32_bf16 v[92:95], v[32:35], v[52:55], v[92:95]
    v_mfma_f32_16x16x32_bf16 v[104:107], v[36:39], v[52:55], v[104:107]
    v_mfma_f32_16x16x32_bf16 v[116:119], v[40:43], v[52:55], v[116:119]
    v_mfma_f32_16x16x32_bf16 v[128:131], v[44:47], v[52:55], v[128:131]
    v_mfma_f32_16x16x32_bf16 v[96:99], v[32:35], v[56:59], v[96:99]
    v_mfma_f32_16x16x32_bf16 v[108:111], v[36:39], v[56:59], v[108:111]
    v_mfma_f32_16x16x32_bf16 v[120:123], v[40:43], v[56:59], v[120:123]
    v_mfma_f32_16x16x32_bf16 v[132:135], v[44:47], v[56:59], v[132:135]
    s_waitcnt lgkmcnt(0)
    v_mfma_f32_16x16x32_bf16 v[88:91], v[60:63], v[76:79], v[88:91]
    v_mfma_f32_16x16x32_bf16 v[100:103], v[64:67], v[76:79], v[100:103]
    v_mfma_f32_16x16x32_bf16 v[112:115], v[68:71], v[76:79], v[112:115]
    v_mfma_f32_16x16x32_bf16 v[124:127], v[72:75], v[76:79], v[124:127]
    v_mfma_f32_16x16x32_bf16 v[92:95], v[60:63], v[80:83], v[92:95]
    v_mfma_f32_16x16x32_bf16 v[104:107], v[64:67], v[80:83], v[104:107]
    v_mfma_f32_16x16x32_bf16 v[116:119], v[68:71], v[80:83], v[116:119]
    v_mfma_f32_16x16x32_bf16 v[128:131], v[72:75], v[80:83], v[128:131]
    v_mfma_f32_16x16x32_bf16 v[96:99], v[60:63], v[84:87], v[96:99]
    v_mfma_f32_16x16x32_bf16 v[108:111], v[64:67], v[84:87], v[108:111]
    v_mfma_f32_16x16x32_bf16 v[120:123], v[68:71], v[84:87], v[120:123]
    v_mfma_f32_16x16x32_bf16 v[132:135], v[72:75], v[84:87], v[132:135]
    s_mov_b32 s32, 0xffff0000
    s_waitcnt vmcnt(0)
    v_lshlrev_b32 v32, 16, v24
    v_and_b32 v33, s32, v24
    v_lshlrev_b32 v34, 16, v25
    v_and_b32 v35, s32, v25
    v_lshlrev_b32 v36, 16, v26
    v_and_b32 v37, s32, v26
    v_lshlrev_b32 v38, 16, v27
    v_and_b32 v39, s32, v27
    v_lshlrev_b32 v40, 16, v28
    v_and_b32 v41, s32, v28
    v_lshlrev_b32 v42, 16, v29
    v_and_b32 v43, s32, v29
    v_lshlrev_b32 v44, 16, v30
    v_and_b32 v45, s32, v30
    v_lshlrev_b32 v46, 16, v31
    v_and_b32 v47, s32, v31
    v_lshlrev_b32 v7, 4, v1
    s_mul_i32 s38, s35, 6
    s_mul_i32 s39, s37, 3
    s_add_u32 s38, s38, s39
    s_lshl_b32 s39, s34, 2
    s_lshl_b32 s40, s36, 1
    s_add_u32 s39, s39, s40
    s_mul_i32 s39, s39, 9
    s_add_u32 s40, s38, 0
    s_mul_i32 s41, s40, 57
    s_lshr_b32 s41, s41, 9
    s_mul_i32 s41, s41, 1287
    s_add_u32 s40, s40, s41
    s_add_u32 s40, s40, s39
    s_lshl_b32 s44, s40, 10
    s_add_u32 s48, s44, 9216
    s_add_u32 s40, s38, 1
    s_mul_i32 s41, s40, 57
    s_lshr_b32 s41, s41, 9
    s_mul_i32 s41, s41, 1287
    s_add_u32 s40, s40, s41
    s_add_u32 s40, s40, s39
    s_lshl_b32 s45, s40, 10
    s_add_u32 s49, s45, 9216
    s_add_u32 s40, s38, 2
    s_mul_i32 s41, s40, 57
    s_lshr_b32 s41, s41, 9
    s_mul_i32 s41, s41, 1287
    s_add_u32 s40, s40, s41
    s_add_u32 s40, s40, s39
    s_lshl_b32 s46, s40, 10
    s_add_u32 s50, s46, 9216
    s_mov_b32 s53, 0xbdd2d3e8
    v_mov_b32 v68, 0xc0135761
    v_cvt_pk_bf16_f32 v60, v88, v89
    v_lshlrev_b32 v88, 16, v60
    v_and_b32 v89, s32, v60
    v_cvt_pk_bf16_f32 v61, v90, v91
    v_lshlrev_b32 v90, 16, v61
    v_and_b32 v91, s32, v61
    v_add_f32 v88, v88, v32
    v_add_f32 v89, v89, v33
    v_add_f32 v90, v90, v34
    v_add_f32 v91, v91, v35
    v_cvt_pk_bf16_f32 v60, v88, v89
    v_lshlrev_b32 v88, 16, v60
    v_and_b32 v89, s32, v60
    v_cvt_pk_bf16_f32 v61, v90, v91
    v_lshlrev_b32 v90, 16, v61
    v_and_b32 v91, s32, v61
    v_mul_f32 v64, v88, v88
    v_mul_f32 v65, v89, v89
    v_mul_f32 v66, v90, v90
    v_mul_f32 v67, v91, v91
    v_fma_f32 v64, v64, s53, v68
    v_fma_f32 v65, v65, s53, v68
    v_fma_f32 v66, v66, s53, v68
    v_fma_f32 v67, v67, s53, v68
    v_mul_f32 v64, v64, v88
    v_mul_f32 v65, v65, v89
    v_mul_f32 v66, v66, v90
    v_mul_f32 v67, v67, v91
    v_exp_f32 v64, v64
    v_exp_f32 v65, v65
    v_exp_f32 v66, v66
    v_exp_f32 v67, v67
    v_add_f32 v64, 1.0, v64
    v_add_f32 v65, 1.0, v65
    v_add_f32 v66, 1.0, v66
    v_add_f32 v67, 1.0, v67
    v_rcp_f32 v64, v64
    v_rcp_f32 v65, v65
    v_rcp_f32 v66, v66
    v_rcp_f32 v67, v67
    v_mul_f32 v88, v88, v64
    v_mul_f32 v89, v89, v65
    v_mul_f32 v90, v90, v66
    v_mul_f32 v91, v91, v67
    v_cvt_pk_bf16_f32 v72, v88, v89
    v_cvt_pk_bf16_f32 v73, v90, v91
    v_cvt_pk_bf16_f32 v60, v100, v101
    v_lshlrev_b32 v100, 16, v60
    v_and_b32 v101, s32, v60
    v_cvt_pk_bf16_f32 v61, v102, v103
    v_lshlrev_b32 v102, 16, v61
    v_and_b32 v103, s32, v61
    v_add_f32 v100, v100, v36
    v_add_f32 v101, v101, v37
    v_add_f32 v102, v102, v38
    v_add_f32 v103, v103, v39
    v_cvt_pk_bf16_f32 v60, v100, v101
    v_lshlrev_b32 v100, 16, v60
    v_and_b32 v101, s32, v60
    v_cvt_pk_bf16_f32 v61, v102, v103
    v_lshlrev_b32 v102, 16, v61
    v_and_b32 v103, s32, v61
    v_mul_f32 v64, v100, v100
    v_mul_f32 v65, v101, v101
    v_mul_f32 v66, v102, v102
    v_mul_f32 v67, v103, v103
    v_fma_f32 v64, v64, s53, v68
    v_fma_f32 v65, v65, s53, v68
    v_fma_f32 v66, v66, s53, v68
    v_fma_f32 v67, v67, s53, v68
    v_mul_f32 v64, v64, v100
    v_mul_f32 v65, v65, v101
    v_mul_f32 v66, v66, v102
    v_mul_f32 v67, v67, v103
    v_exp_f32 v64, v64
    v_exp_f32 v65, v65
    v_exp_f32 v66, v66
    v_exp_f32 v67, v67
    v_add_f32 v64, 1.0, v64
    v_add_f32 v65, 1.0, v65
    v_add_f32 v66, 1.0, v66
    v_add_f32 v67, 1.0, v67
    v_rcp_f32 v64, v64
    v_rcp_f32 v65, v65
    v_rcp_f32 v66, v66
    v_rcp_f32 v67, v67
    v_mul_f32 v100, v100, v64
    v_mul_f32 v101, v101, v65
    v_mul_f32 v102, v102, v66
    v_mul_f32 v103, v103, v67
    v_cvt_pk_bf16_f32 v74, v100, v101
    v_cvt_pk_bf16_f32 v75, v102, v103
    buffer_store_dwordx4 v[72:75], v7, s[12:15], s44 offen
    v_cvt_pk_bf16_f32 v60, v112, v113
    v_lshlrev_b32 v112, 16, v60
    v_and_b32 v113, s32, v60
    v_cvt_pk_bf16_f32 v61, v114, v115
    v_lshlrev_b32 v114, 16, v61
    v_and_b32 v115, s32, v61
    v_add_f32 v112, v112, v40
    v_add_f32 v113, v113, v41
    v_add_f32 v114, v114, v42
    v_add_f32 v115, v115, v43
    v_cvt_pk_bf16_f32 v60, v112, v113
    v_lshlrev_b32 v112, 16, v60
    v_and_b32 v113, s32, v60
    v_cvt_pk_bf16_f32 v61, v114, v115
    v_lshlrev_b32 v114, 16, v61
    v_and_b32 v115, s32, v61
    v_mul_f32 v64, v112, v112
    v_mul_f32 v65, v113, v113
    v_mul_f32 v66, v114, v114
    v_mul_f32 v67, v115, v115
    v_fma_f32 v64, v64, s53, v68
    v_fma_f32 v65, v65, s53, v68
    v_fma_f32 v66, v66, s53, v68
    v_fma_f32 v67, v67, s53, v68
    v_mul_f32 v64, v64, v112
    v_mul_f32 v65, v65, v113
    v_mul_f32 v66, v66, v114
    v_mul_f32 v67, v67, v115
    v_exp_f32 v64, v64
    v_exp_f32 v65, v65
    v_exp_f32 v66, v66
    v_exp_f32 v67, v67
    v_add_f32 v64, 1.0, v64
    v_add_f32 v65, 1.0, v65
    v_add_f32 v66, 1.0, v66
    v_add_f32 v67, 1.0, v67
    v_rcp_f32 v64, v64
    v_rcp_f32 v65, v65
    v_rcp_f32 v66, v66
    v_rcp_f32 v67, v67
    v_mul_f32 v112, v112, v64
    v_mul_f32 v113, v113, v65
    v_mul_f32 v114, v114, v66
    v_mul_f32 v115, v115, v67
    v_cvt_pk_bf16_f32 v76, v112, v113
    v_cvt_pk_bf16_f32 v77, v114, v115
    v_cvt_pk_bf16_f32 v60, v124, v125
    v_lshlrev_b32 v124, 16, v60
    v_and_b32 v125, s32, v60
    v_cvt_pk_bf16_f32 v61, v126, v127
    v_lshlrev_b32 v126, 16, v61
    v_and_b32 v127, s32, v61
    v_add_f32 v124, v124, v44
    v_add_f32 v125, v125, v45
    v_add_f32 v126, v126, v46
    v_add_f32 v127, v127, v47
    v_cvt_pk_bf16_f32 v60, v124, v125
    v_lshlrev_b32 v124, 16, v60
    v_and_b32 v125, s32, v60
    v_cvt_pk_bf16_f32 v61, v126, v127
    v_lshlrev_b32 v126, 16, v61
    v_and_b32 v127, s32, v61
    v_mul_f32 v64, v124, v124
    v_mul_f32 v65, v125, v125
    v_mul_f32 v66, v126, v126
    v_mul_f32 v67, v127, v127
    v_fma_f32 v64, v64, s53, v68
    v_fma_f32 v65, v65, s53, v68
    v_fma_f32 v66, v66, s53, v68
    v_fma_f32 v67, v67, s53, v68
    v_mul_f32 v64, v64, v124
    v_mul_f32 v65, v65, v125
    v_mul_f32 v66, v66, v126
    v_mul_f32 v67, v67, v127
    v_exp_f32 v64, v64
    v_exp_f32 v65, v65
    v_exp_f32 v66, v66
    v_exp_f32 v67, v67
    v_add_f32 v64, 1.0, v64
    v_add_f32 v65, 1.0, v65
    v_add_f32 v66, 1.0, v66
    v_add_f32 v67, 1.0, v67
    v_rcp_f32 v64, v64
    v_rcp_f32 v65, v65
    v_rcp_f32 v66, v66
    v_rcp_f32 v67, v67
    v_mul_f32 v124, v124, v64
    v_mul_f32 v125, v125, v65
    v_mul_f32 v126, v126, v66
    v_mul_f32 v127, v127, v67
    v_cvt_pk_bf16_f32 v78, v124, v125
    v_cvt_pk_bf16_f32 v79, v126, v127
    buffer_store_dwordx4 v[76:79], v7, s[12:15], s48 offen
    v_cvt_pk_bf16_f32 v60, v92, v93
    v_lshlrev_b32 v92, 16, v60
    v_and_b32 v93, s32, v60
    v_cvt_pk_bf16_f32 v61, v94, v95
    v_lshlrev_b32 v94, 16, v61
    v_and_b32 v95, s32, v61
    v_add_f32 v92, v92, v32
    v_add_f32 v93, v93, v33
    v_add_f32 v94, v94, v34
    v_add_f32 v95, v95, v35
    v_cvt_pk_bf16_f32 v60, v92, v93
    v_lshlrev_b32 v92, 16, v60
    v_and_b32 v93, s32, v60
    v_cvt_pk_bf16_f32 v61, v94, v95
    v_lshlrev_b32 v94, 16, v61
    v_and_b32 v95, s32, v61
    v_mul_f32 v64, v92, v92
    v_mul_f32 v65, v93, v93
    v_mul_f32 v66, v94, v94
    v_mul_f32 v67, v95, v95
    v_fma_f32 v64, v64, s53, v68
    v_fma_f32 v65, v65, s53, v68
    v_fma_f32 v66, v66, s53, v68
    v_fma_f32 v67, v67, s53, v68
    v_mul_f32 v64, v64, v92
    v_mul_f32 v65, v65, v93
    v_mul_f32 v66, v66, v94
    v_mul_f32 v67, v67, v95
    v_exp_f32 v64, v64
    v_exp_f32 v65, v65
    v_exp_f32 v66, v66
    v_exp_f32 v67, v67
    v_add_f32 v64, 1.0, v64
    v_add_f32 v65, 1.0, v65
    v_add_f32 v66, 1.0, v66
    v_add_f32 v67, 1.0, v67
    v_rcp_f32 v64, v64
    v_rcp_f32 v65, v65
    v_rcp_f32 v66, v66
    v_rcp_f32 v67, v67
    v_mul_f32 v92, v92, v64
    v_mul_f32 v93, v93, v65
    v_mul_f32 v94, v94, v66
    v_mul_f32 v95, v95, v67
    v_cvt_pk_bf16_f32 v72, v92, v93
    v_cvt_pk_bf16_f32 v73, v94, v95
    v_cvt_pk_bf16_f32 v60, v104, v105
    v_lshlrev_b32 v104, 16, v60
    v_and_b32 v105, s32, v60
    v_cvt_pk_bf16_f32 v61, v106, v107
    v_lshlrev_b32 v106, 16, v61
    v_and_b32 v107, s32, v61
    v_add_f32 v104, v104, v36
    v_add_f32 v105, v105, v37
    v_add_f32 v106, v106, v38
    v_add_f32 v107, v107, v39
    v_cvt_pk_bf16_f32 v60, v104, v105
    v_lshlrev_b32 v104, 16, v60
    v_and_b32 v105, s32, v60
    v_cvt_pk_bf16_f32 v61, v106, v107
    v_lshlrev_b32 v106, 16, v61
    v_and_b32 v107, s32, v61
    v_mul_f32 v64, v104, v104
    v_mul_f32 v65, v105, v105
    v_mul_f32 v66, v106, v106
    v_mul_f32 v67, v107, v107
    v_fma_f32 v64, v64, s53, v68
    v_fma_f32 v65, v65, s53, v68
    v_fma_f32 v66, v66, s53, v68
    v_fma_f32 v67, v67, s53, v68
    v_mul_f32 v64, v64, v104
    v_mul_f32 v65, v65, v105
    v_mul_f32 v66, v66, v106
    v_mul_f32 v67, v67, v107
    v_exp_f32 v64, v64
    v_exp_f32 v65, v65
    v_exp_f32 v66, v66
    v_exp_f32 v67, v67
    v_add_f32 v64, 1.0, v64
    v_add_f32 v65, 1.0, v65
    v_add_f32 v66, 1.0, v66
    v_add_f32 v67, 1.0, v67
    v_rcp_f32 v64, v64
    v_rcp_f32 v65, v65
    v_rcp_f32 v66, v66
    v_rcp_f32 v67, v67
    v_mul_f32 v104, v104, v64
    v_mul_f32 v105, v105, v65
    v_mul_f32 v106, v106, v66
    v_mul_f32 v107, v107, v67
    v_cvt_pk_bf16_f32 v74, v104, v105
    v_cvt_pk_bf16_f32 v75, v106, v107
    buffer_store_dwordx4 v[72:75], v7, s[12:15], s45 offen
    v_cvt_pk_bf16_f32 v60, v116, v117
    v_lshlrev_b32 v116, 16, v60
    v_and_b32 v117, s32, v60
    v_cvt_pk_bf16_f32 v61, v118, v119
    v_lshlrev_b32 v118, 16, v61
    v_and_b32 v119, s32, v61
    v_add_f32 v116, v116, v40
    v_add_f32 v117, v117, v41
    v_add_f32 v118, v118, v42
    v_add_f32 v119, v119, v43
    v_cvt_pk_bf16_f32 v60, v116, v117
    v_lshlrev_b32 v116, 16, v60
    v_and_b32 v117, s32, v60
    v_cvt_pk_bf16_f32 v61, v118, v119
    v_lshlrev_b32 v118, 16, v61
    v_and_b32 v119, s32, v61
    v_mul_f32 v64, v116, v116
    v_mul_f32 v65, v117, v117
    v_mul_f32 v66, v118, v118
    v_mul_f32 v67, v119, v119
    v_fma_f32 v64, v64, s53, v68
    v_fma_f32 v65, v65, s53, v68
    v_fma_f32 v66, v66, s53, v68
    v_fma_f32 v67, v67, s53, v68
    v_mul_f32 v64, v64, v116
    v_mul_f32 v65, v65, v117
    v_mul_f32 v66, v66, v118
    v_mul_f32 v67, v67, v119
    v_exp_f32 v64, v64
    v_exp_f32 v65, v65
    v_exp_f32 v66, v66
    v_exp_f32 v67, v67
    v_add_f32 v64, 1.0, v64
    v_add_f32 v65, 1.0, v65
    v_add_f32 v66, 1.0, v66
    v_add_f32 v67, 1.0, v67
    v_rcp_f32 v64, v64
    v_rcp_f32 v65, v65
    v_rcp_f32 v66, v66
    v_rcp_f32 v67, v67
    v_mul_f32 v116, v116, v64
    v_mul_f32 v117, v117, v65
    v_mul_f32 v118, v118, v66
    v_mul_f32 v119, v119, v67
    v_cvt_pk_bf16_f32 v76, v116, v117
    v_cvt_pk_bf16_f32 v77, v118, v119
    v_cvt_pk_bf16_f32 v60, v128, v129
    v_lshlrev_b32 v128, 16, v60
    v_and_b32 v129, s32, v60
    v_cvt_pk_bf16_f32 v61, v130, v131
    v_lshlrev_b32 v130, 16, v61
    v_and_b32 v131, s32, v61
    v_add_f32 v128, v128, v44
    v_add_f32 v129, v129, v45
    v_add_f32 v130, v130, v46
    v_add_f32 v131, v131, v47
    v_cvt_pk_bf16_f32 v60, v128, v129
    v_lshlrev_b32 v128, 16, v60
    v_and_b32 v129, s32, v60
    v_cvt_pk_bf16_f32 v61, v130, v131
    v_lshlrev_b32 v130, 16, v61
    v_and_b32 v131, s32, v61
    v_mul_f32 v64, v128, v128
    v_mul_f32 v65, v129, v129
    v_mul_f32 v66, v130, v130
    v_mul_f32 v67, v131, v131
    v_fma_f32 v64, v64, s53, v68
    v_fma_f32 v65, v65, s53, v68
    v_fma_f32 v66, v66, s53, v68
    v_fma_f32 v67, v67, s53, v68
    v_mul_f32 v64, v64, v128
    v_mul_f32 v65, v65, v129
    v_mul_f32 v66, v66, v130
    v_mul_f32 v67, v67, v131
    v_exp_f32 v64, v64
    v_exp_f32 v65, v65
    v_exp_f32 v66, v66
    v_exp_f32 v67, v67
    v_add_f32 v64, 1.0, v64
    v_add_f32 v65, 1.0, v65
    v_add_f32 v66, 1.0, v66
    v_add_f32 v67, 1.0, v67
    v_rcp_f32 v64, v64
    v_rcp_f32 v65, v65
    v_rcp_f32 v66, v66
    v_rcp_f32 v67, v67
    v_mul_f32 v128, v128, v64
    v_mul_f32 v129, v129, v65
    v_mul_f32 v130, v130, v66
    v_mul_f32 v131, v131, v67
    v_cvt_pk_bf16_f32 v78, v128, v129
    v_cvt_pk_bf16_f32 v79, v130, v131
    buffer_store_dwordx4 v[76:79], v7, s[12:15], s49 offen
    v_cvt_pk_bf16_f32 v60, v96, v97
    v_lshlrev_b32 v96, 16, v60
    v_and_b32 v97, s32, v60
    v_cvt_pk_bf16_f32 v61, v98, v99
    v_lshlrev_b32 v98, 16, v61
    v_and_b32 v99, s32, v61
    v_add_f32 v96, v96, v32
    v_add_f32 v97, v97, v33
    v_add_f32 v98, v98, v34
    v_add_f32 v99, v99, v35
    v_cvt_pk_bf16_f32 v60, v96, v97
    v_lshlrev_b32 v96, 16, v60
    v_and_b32 v97, s32, v60
    v_cvt_pk_bf16_f32 v61, v98, v99
    v_lshlrev_b32 v98, 16, v61
    v_and_b32 v99, s32, v61
    v_mul_f32 v64, v96, v96
    v_mul_f32 v65, v97, v97
    v_mul_f32 v66, v98, v98
    v_mul_f32 v67, v99, v99
    v_fma_f32 v64, v64, s53, v68
    v_fma_f32 v65, v65, s53, v68
    v_fma_f32 v66, v66, s53, v68
    v_fma_f32 v67, v67, s53, v68
    v_mul_f32 v64, v64, v96
    v_mul_f32 v65, v65, v97
    v_mul_f32 v66, v66, v98
    v_mul_f32 v67, v67, v99
    v_exp_f32 v64, v64
    v_exp_f32 v65, v65
    v_exp_f32 v66, v66
    v_exp_f32 v67, v67
    v_add_f32 v64, 1.0, v64
    v_add_f32 v65, 1.0, v65
    v_add_f32 v66, 1.0, v66
    v_add_f32 v67, 1.0, v67
    v_rcp_f32 v64, v64
    v_rcp_f32 v65, v65
    v_rcp_f32 v66, v66
    v_rcp_f32 v67, v67
    v_mul_f32 v96, v96, v64
    v_mul_f32 v97, v97, v65
    v_mul_f32 v98, v98, v66
    v_mul_f32 v99, v99, v67
    v_cvt_pk_bf16_f32 v72, v96, v97
    v_cvt_pk_bf16_f32 v73, v98, v99
    v_cvt_pk_bf16_f32 v60, v108, v109
    v_lshlrev_b32 v108, 16, v60
    v_and_b32 v109, s32, v60
    v_cvt_pk_bf16_f32 v61, v110, v111
    v_lshlrev_b32 v110, 16, v61
    v_and_b32 v111, s32, v61
    v_add_f32 v108, v108, v36
    v_add_f32 v109, v109, v37
    v_add_f32 v110, v110, v38
    v_add_f32 v111, v111, v39
    v_cvt_pk_bf16_f32 v60, v108, v109
    v_lshlrev_b32 v108, 16, v60
    v_and_b32 v109, s32, v60
    v_cvt_pk_bf16_f32 v61, v110, v111
    v_lshlrev_b32 v110, 16, v61
    v_and_b32 v111, s32, v61
    v_mul_f32 v64, v108, v108
    v_mul_f32 v65, v109, v109
    v_mul_f32 v66, v110, v110
    v_mul_f32 v67, v111, v111
    v_fma_f32 v64, v64, s53, v68
    v_fma_f32 v65, v65, s53, v68
    v_fma_f32 v66, v66, s53, v68
    v_fma_f32 v67, v67, s53, v68
    v_mul_f32 v64, v64, v108
    v_mul_f32 v65, v65, v109
    v_mul_f32 v66, v66, v110
    v_mul_f32 v67, v67, v111
    v_exp_f32 v64, v64
    v_exp_f32 v65, v65
    v_exp_f32 v66, v66
    v_exp_f32 v67, v67
    v_add_f32 v64, 1.0, v64
    v_add_f32 v65, 1.0, v65
    v_add_f32 v66, 1.0, v66
    v_add_f32 v67, 1.0, v67
    v_rcp_f32 v64, v64
    v_rcp_f32 v65, v65
    v_rcp_f32 v66, v66
    v_rcp_f32 v67, v67
    v_mul_f32 v108, v108, v64
    v_mul_f32 v109, v109, v65
    v_mul_f32 v110, v110, v66
    v_mul_f32 v111, v111, v67
    v_cvt_pk_bf16_f32 v74, v108, v109
    v_cvt_pk_bf16_f32 v75, v110, v111
    buffer_store_dwordx4 v[72:75], v7, s[12:15], s46 offen
    v_cvt_pk_bf16_f32 v60, v120, v121
    v_lshlrev_b32 v120, 16, v60
    v_and_b32 v121, s32, v60
    v_cvt_pk_bf16_f32 v61, v122, v123
    v_lshlrev_b32 v122, 16, v61
    v_and_b32 v123, s32, v61
    v_add_f32 v120, v120, v40
    v_add_f32 v121, v121, v41
    v_add_f32 v122, v122, v42
    v_add_f32 v123, v123, v43
    v_cvt_pk_bf16_f32 v60, v120, v121
    v_lshlrev_b32 v120, 16, v60
    v_and_b32 v121, s32, v60
    v_cvt_pk_bf16_f32 v61, v122, v123
    v_lshlrev_b32 v122, 16, v61
    v_and_b32 v123, s32, v61
    v_mul_f32 v64, v120, v120
    v_mul_f32 v65, v121, v121
    v_mul_f32 v66, v122, v122
    v_mul_f32 v67, v123, v123
    v_fma_f32 v64, v64, s53, v68
    v_fma_f32 v65, v65, s53, v68
    v_fma_f32 v66, v66, s53, v68
    v_fma_f32 v67, v67, s53, v68
    v_mul_f32 v64, v64, v120
    v_mul_f32 v65, v65, v121
    v_mul_f32 v66, v66, v122
    v_mul_f32 v67, v67, v123
    v_exp_f32 v64, v64
    v_exp_f32 v65, v65
    v_exp_f32 v66, v66
    v_exp_f32 v67, v67
    v_add_f32 v64, 1.0, v64
    v_add_f32 v65, 1.0, v65
    v_add_f32 v66, 1.0, v66
    v_add_f32 v67, 1.0, v67
    v_rcp_f32 v64, v64
    v_rcp_f32 v65, v65
    v_rcp_f32 v66, v66
    v_rcp_f32 v67, v67
    v_mul_f32 v120, v120, v64
    v_mul_f32 v121, v121, v65
    v_mul_f32 v122, v122, v66
    v_mul_f32 v123, v123, v67
    v_cvt_pk_bf16_f32 v76, v120, v121
    v_cvt_pk_bf16_f32 v77, v122, v123
    v_cvt_pk_bf16_f32 v60, v132, v133
    v_lshlrev_b32 v132, 16, v60
    v_and_b32 v133, s32, v60
    v_cvt_pk_bf16_f32 v61, v134, v135
    v_lshlrev_b32 v134, 16, v61
    v_and_b32 v135, s32, v61
    v_add_f32 v132, v132, v44
    v_add_f32 v133, v133, v45
    v_add_f32 v134, v134, v46
    v_add_f32 v135, v135, v47
    v_cvt_pk_bf16_f32 v60, v132, v133
    v_lshlrev_b32 v132, 16, v60
    v_and_b32 v133, s32, v60
    v_cvt_pk_bf16_f32 v61, v134, v135
    v_lshlrev_b32 v134, 16, v61
    v_and_b32 v135, s32, v61
    v_mul_f32 v64, v132, v132
    v_mul_f32 v65, v133, v133
    v_mul_f32 v66, v134, v134
    v_mul_f32 v67, v135, v135
    v_fma_f32 v64, v64, s53, v68
    v_fma_f32 v65, v65, s53, v68
    v_fma_f32 v66, v66, s53, v68
    v_fma_f32 v67, v67, s53, v68
    v_mul_f32 v64, v64, v132
    v_mul_f32 v65, v65, v133
    v_mul_f32 v66, v66, v134
    v_mul_f32 v67, v67, v135
    v_exp_f32 v64, v64
    v_exp_f32 v65, v65
    v_exp_f32 v66, v66
    v_exp_f32 v67, v67
    v_add_f32 v64, 1.0, v64
    v_add_f32 v65, 1.0, v65
    v_add_f32 v66, 1.0, v66
    v_add_f32 v67, 1.0, v67
    v_rcp_f32 v64, v64
    v_rcp_f32 v65, v65
    v_rcp_f32 v66, v66
    v_rcp_f32 v67, v67
    v_mul_f32 v132, v132, v64
    v_mul_f32 v133, v133, v65
    v_mul_f32 v134, v134, v66
    v_mul_f32 v135, v135, v67
    v_cvt_pk_bf16_f32 v78, v132, v133
    v_cvt_pk_bf16_f32 v79, v134, v135
    buffer_store_dwordx4 v[76:79], v7, s[12:15], s50 offen
g1_done:
    s_endpgm
.globl g2_kernel
.p2align 8
.type g2_kernel,@function
g2_kernel:
    s_cmp_ge_u32 s2, 256
    s_cbranch_scc1 g2_done
    s_load_dwordx2 s[4:5], s[0:1], 96
    s_load_dwordx4 s[16:19], s[0:1], 48
    s_load_dwordx2 s[6:7], s[0:1], 80
    v_lshrrev_b32 v2, 6, v0
    s_nop 0
    v_readfirstlane_b32 s3, v2
    s_and_b32 s33, s2, 7
    s_lshr_b32 s34, s2, 3
    s_lshr_b32 s35, s33, 1
    s_and_b32 s36, s33, 1
    s_lshl_b32 s36, s36, 3
    s_lshr_b32 s37, s34, 2
    s_add_u32 s36, s36, s37
    s_and_b32 s37, s34, 3
    s_mul_i32 s20, s35, 4718592
    s_lshl_b32 s38, s36, 8
    s_add_u32 s20, s20, s38
    s_mul_i32 s21, s37, 144
    s_mul_i32 s38, s35, 36
    s_add_u32 s21, s21, s38
    s_mul_i32 s21, s21, 9216
    s_waitcnt lgkmcnt(0)
    s_cmp_lt_u32 s3, 4
    s_cbranch_scc1 g2_cons
    s_mov_b32 s8, s16
    s_mov_b32 s9, s17
    s_mov_b32 s10, 0x1200000
    s_mov_b32 s11, 0x20000
    s_add_u32 s12, s4, 0x1000000
    s_addc_u32 s13, s5, 0
    s_mov_b32 s14, 0x510000
    s_mov_b32 s15, 0x20000
    v_and_b32 v1, 63, v0
    v_lshrrev_b32 v2, 4, v1
    v_and_b32 v3, 15, v1
    v_lshlrev_b32 v4, 1, v2
    v_xor_b32 v4, v4, v3
    v_xor_b32 v5, 8, v4
    s_movk_i32 s22, 4096
    v_mul_lo_u32 v2, v2, s22
    v_lshl_add_u32 v4, v4, 4, v2
    v_lshl_add_u32 v5, v5, 4, v2
    v_lshlrev_b32 v6, 4, v1
    s_sub_u32 s23, s3, 4
    s_mul_i32 s24, s23, 65536
    s_add_u32 s20, s20, s24
    s_mul_i32 s24, s23, 4608
    s_add_u32 s21, s21, s24
    s_lshl_b32 s25, s23, 12
    s_add_u32 s26, s24, 16384
    s_mov_b32 s27, 0
    s_add_u32 m0, s27, s25
    s_nop 0
    buffer_load_dwordx4 v4, s[8:11], s20 offen offset:0 lds
    s_add_u32 s28, s20, 15360
    buffer_load_dwordx4 v5, s[8:11], s28 offen offset:1024 lds
    s_add_u32 s29, s20, 30720
    buffer_load_dwordx4 v4, s[8:11], s29 offen offset:2048 lds
    s_add_u32 s30, s20, 46080
    buffer_load_dwordx4 v5, s[8:11], s30 offen offset:3072 lds
    s_add_u32 m0, s27, s26
    s_add_u32 s20, s20, 262144
    s_mov_b64 exec, 0xffffffff
    buffer_load_dwordx4 v6, s[12:15], s21 offen lds
    s_mov_b64 exec, -1
    buffer_load_dwordx4 v6, s[12:15], s21 offen offset:512 lds
    buffer_load_dwordx4 v6, s[12:15], s21 offen offset:1536 lds
    buffer_load_dwordx4 v6, s[12:15], s21 offen offset:2560 lds
    buffer_load_dwordx4 v6, s[12:15], s21 offen offset:3584 lds
    s_add_u32 s21, s21, 18432
    s_add_u32 s27, s27, 34816
    s_cmp_eq_u32 s27, 139264
    s_cselect_b32 s27, 0, s27
    s_add_u32 m0, s27, s25
    s_nop 0
    buffer_load_dwordx4 v4, s[8:11], s20 offen offset:0 lds
    s_add_u32 s28, s20, 15360
    buffer_load_dwordx4 v5, s[8:11], s28 offen offset:1024 lds
    s_add_u32 s29, s20, 30720
    buffer_load_dwordx4 v4, s[8:11], s29 offen offset:2048 lds
    s_add_u32 s30, s20, 46080
    buffer_load_dwordx4 v5, s[8:11], s30 offen offset:3072 lds
    s_add_u32 m0, s27, s26
    s_add_u32 s20, s20, 262144
    s_mov_b64 exec, 0xffffffff
    buffer_load_dwordx4 v6, s[12:15], s21 offen lds
    s_mov_b64 exec, -1
    buffer_load_dwordx4 v6, s[12:15], s21 offen offset:512 lds
    buffer_load_dwordx4 v6, s[12:15], s21 offen offset:1536 lds
    buffer_load_dwordx4 v6, s[12:15], s21 offen offset:2560 lds
    buffer_load_dwordx4 v6, s[12:15], s21 offen offset:3584 lds
    s_add_u32 s21, s21, 18432
    s_add_u32 s27, s27, 34816
    s_cmp_eq_u32 s27, 139264
    s_cselect_b32 s27, 0, s27
    s_add_u32 m0, s27, s25
    s_nop 0
    buffer_load_dwordx4 v4, s[8:11], s20 offen offset:0 lds
    s_add_u32 s28, s20, 15360
    buffer_load_dwordx4 v5, s[8:11], s28 offen offset:1024 lds
    s_add_u32 s29, s20, 30720
    buffer_load_dwordx4 v4, s[8:11], s29 offen offset:2048 lds
    s_add_u32 s30, s20, 46080
    buffer_load_dwordx4 v5, s[8:11], s30 offen offset:3072 lds
    s_add_u32 m0, s27, s26
    s_add_u32 s20, s20, 262144
    s_mov_b64 exec, 0xffffffff
    buffer_load_dwordx4 v6, s[12:15], s21 offen lds
    s_mov_b64 exec, -1
    buffer_load_dwordx4 v6, s[12:15], s21 offen offset:512 lds
    buffer_load_dwordx4 v6, s[12:15], s21 offen offset:1536 lds
    buffer_load_dwordx4 v6, s[12:15], s21 offen offset:2560 lds
    buffer_load_dwordx4 v6, s[12:15], s21 offen offset:3584 lds
    s_add_u32 s21, s21, 18432
    s_add_u32 s27, s27, 34816
    s_cmp_eq_u32 s27, 139264
    s_cselect_b32 s27, 0, s27
    s_movk_i32 s31, 15
g2_ld_loop:
    s_waitcnt vmcnt(18)
    s_barrier
    s_add_u32 m0, s27, s25
    s_nop 0
    buffer_load_dwordx4 v4, s[8:11], s20 offen offset:0 lds
    s_add_u32 s28, s20, 15360
    buffer_load_dwordx4 v5, s[8:11], s28 offen offset:1024 lds
    s_add_u32 s29, s20, 30720
    buffer_load_dwordx4 v4, s[8:11], s29 offen offset:2048 lds
    s_add_u32 s30, s20, 46080
    buffer_load_dwordx4 v5, s[8:11], s30 offen offset:3072 lds
    s_add_u32 m0, s27, s26
    s_add_u32 s20, s20, 262144
    s_mov_b64 exec, 0xffffffff
    buffer_load_dwordx4 v6, s[12:15], s21 offen lds
    s_mov_b64 exec, -1
    buffer_load_dwordx4 v6, s[12:15], s21 offen offset:512 lds
    buffer_load_dwordx4 v6, s[12:15], s21 offen offset:1536 lds
    buffer_load_dwordx4 v6, s[12:15], s21 offen offset:2560 lds
    buffer_load_dwordx4 v6, s[12:15], s21 offen offset:3584 lds
    s_add_u32 s21, s21, 18432
    s_add_u32 s27, s27, 34816
    s_cmp_eq_u32 s27, 139264
    s_cselect_b32 s27, 0, s27
    s_sub_u32 s31, s31, 1
    s_cmp_lg_u32 s31, 0
    s_cbranch_scc1 g2_ld_loop
    s_waitcnt vmcnt(18)
    s_barrier
    s_waitcnt vmcnt(9)
    s_barrier
    s_waitcnt vmcnt(0)
    s_barrier
    s_branch g2_done
g2_cons:
    s_mov_b32 s8, s18
    s_mov_b32 s9, s19
    s_mov_b32 s10, 0x1000
    s_mov_b32 s11, 0x20000
    s_mov_b32 s12, s4
    s_mov_b32 s13, s5
    s_mov_b32 s14, 0x3600
    s_mov_b32 s15, 0x20000
    s_add_u32 s56, s4, 0xa00000
    s_addc_u32 s57, s5, 0
    s_mov_b32 s58, 0x240000
    s_mov_b32 s59, 0x20000
    s_mov_b32 s60, s6
    s_mov_b32 s61, s7
    s_mov_b32 s62, 0x240000
    s_mov_b32 s63, 0x20000
    s_add_u32 s64, s4, 0x1800000
    s_addc_u32 s65, s5, 0
    s_mov_b32 s66, 0xc00000
    s_mov_b32 s67, 0x20000
    s_add_u32 s68, s4, 0x10000
    s_addc_u32 s69, s5, 0
    s_mov_b32 s70, 0x10000
    s_mov_b32 s71, 0x20000
    v_and_b32 v1, 63, v0
    v_and_b32 v5, 15, v1
    v_lshrrev_b32 v6, 4, v1
    s_lshr_b32 s38, s35, 1
    s_and_b32 s39, s35, 1
    s_lshl_b32 s40, s3, 1
    s_add_u32 s40, s40, s38
    s_xor_b32 s41, s40, 1
    v_lshrrev_b32 v2, 2, v5
    v_and_b32 v3, 1, v6
    v_lshl_add_u32 v3, v3, 2, v2
    v_mad_u32_u24 v2, v6, 4, v2
    v_lshlrev_b32 v2, 8, v2
    v_and_b32 v4, 3, v1
    v_lshl_add_u32 v2, v4, 3, v2
    v_xor_b32 v4, s40, v3
    v_lshl_add_u32 v8, v4, 5, v2
    v_xor_b32 v4, s41, v3
    v_lshl_add_u32 v9, v4, 5, v2
    v_lshlrev_b32 v7, 4, v1
    s_lshl_b32 s42, s39, 12
    s_add_u32 s43, s42, 16384
    v_add_u32 v10, s43, v7
    s_xor_b32 s43, s43, 4096
    v_add_u32 v11, s43, v7
    v_add_u32 v12, 24576, v7
    s_lshl_b32 s44, s36, 3
    s_add_u32 s44, s44, s40
    s_lshl_b32 s44, s44, 4
    v_add_u32 v2, s44, v5
    v_mov_b32 v214, 0
    v_lshlrev_b32 v3, 1, v2
    buffer_load_short_d16_hi v214, v3, s[8:11], 0 offen
    v_mul_u32_u24 v2, 1152, v2
    v_lshl_add_u32 v22, v6, 3, v2
    s_mul_i32 s45, s37, 288
    s_lshl_b32 s46, s39, 7
    s_add_u32 s46, s46, s45
    s_lshl_b32 s47, s39, 2
    s_add_u32 s47, s47, s45
    s_add_u32 s47, s47, 256
    buffer_load_dwordx2 v[184:185], v22, s[56:59], s46 offen offset:0
    buffer_load_dwordx2 v[186:187], v22, s[56:59], s46 offen offset:32
    buffer_load_dwordx2 v[188:189], v22, s[56:59], s46 offen offset:64
    buffer_load_dwordx2 v[190:191], v22, s[56:59], s46 offen offset:96
    buffer_load_dword v192, v22, s[56:59], s47 offen
    v_lshlrev_b32 v3, 4, v6
    s_lshl_b32 s48, s46, 1
    s_add_u32 s48, s48, 11520
    s_lshl_b32 s49, s47, 1
    s_add_u32 s49, s49, 11520
    buffer_load_dwordx4 v[194:197], v3, s[12:15], s48 offen offset:0
    buffer_load_dwordx4 v[198:201], v3, s[12:15], s48 offen offset:64
    buffer_load_dwordx4 v[202:205], v3, s[12:15], s48 offen offset:128
    buffer_load_dwordx4 v[206:209], v3, s[12:15], s48 offen offset:192
    buffer_load_dwordx2 v[210:211], v3, s[12:15], s49 offen
    v_mov_b32 v112, 0
    v_mov_b32 v113, 0
    v_mov_b32 v114, 0
    v_mov_b32 v115, 0
    v_mov_b32 v116, 0
    v_mov_b32 v117, 0
    v_mov_b32 v118, 0
    v_mov_b32 v119, 0
    v_mov_b32 v120, 0
    v_mov_b32 v121, 0
    v_mov_b32 v122, 0
    v_mov_b32 v123, 0
    v_mov_b32 v124, 0
    v_mov_b32 v125, 0
    v_mov_b32 v126, 0
    v_mov_b32 v127, 0
    v_mov_b32 v128, 0
    v_mov_b32 v129, 0
    v_mov_b32 v130, 0
    v_mov_b32 v131, 0
    v_mov_b32 v132, 0
    v_mov_b32 v133, 0
    v_mov_b32 v134, 0
    v_mov_b32 v135, 0
    v_mov_b32 v136, 0
    v_mov_b32 v137, 0
    v_mov_b32 v138, 0
    v_mov_b32 v139, 0
    v_mov_b32 v140, 0
    v_mov_b32 v141, 0
    v_mov_b32 v142, 0
    v_mov_b32 v143, 0
    v_mov_b32 v144, 0
    v_mov_b32 v145, 0
    v_mov_b32 v146, 0
    v_mov_b32 v147, 0
    v_mov_b32 v148, 0
    v_mov_b32 v149, 0
    v_mov_b32 v150, 0
    v_mov_b32 v151, 0
    v_mov_b32 v152, 0
    v_mov_b32 v153, 0
    v_mov_b32 v154, 0
    v_mov_b32 v155, 0
    v_mov_b32 v156, 0
    v_mov_b32 v157, 0
    v_mov_b32 v158, 0
    v_mov_b32 v159, 0
    v_mov_b32 v160, 0
    v_mov_b32 v161, 0
    v_mov_b32 v162, 0
    v_mov_b32 v163, 0
    v_mov_b32 v164, 0
    v_mov_b32 v165, 0
    v_mov_b32 v166, 0
    v_mov_b32 v167, 0
    v_mov_b32 v168, 0
    v_mov_b32 v169, 0
    v_mov_b32 v170, 0
    v_mov_b32 v171, 0
    v_mov_b32 v172, 0
    v_mov_b32 v173, 0
    v_mov_b32 v174, 0
    v_mov_b32 v175, 0
    v_mov_b32 v176, 0
    v_mov_b32 v177, 0
    v_mov_b32 v178, 0
    v_mov_b32 v179, 0
    v_mov_b32 v180, 0
    v_mov_b32 v181, 0
    v_mov_b32 v182, 0
    v_mov_b32 v183, 0
    s_mov_b32 s27, 0
    v_add_u32 v16, s27, v8
    v_add_u32 v17, s27, v9
    v_add_u32 v18, s27, v10
    v_add_u32 v19, s27, v11
    v_add_u32 v20, s27, v12
    s_movk_i32 s31, 17
    s_barrier
    ds_read_b64_tr_b16 v[24:25], v16 offset:0
    ds_read_b64_tr_b16 v[26:27], v16 offset:4096
    ds_read_b64_tr_b16 v[28:29], v17 offset:0
    ds_read_b64_tr_b16 v[30:31], v17 offset:4096
    ds_read_b128 v[32:35], v18 offset:0
    ds_read_b128 v[36:39], v18 offset:1024
    ds_read_b128 v[40:43], v18 offset:2048
    ds_read_b128 v[44:47], v18 offset:3072
    ds_read_b128 v[48:51], v19 offset:0
    ds_read_b128 v[52:55], v19 offset:1024
    ds_read_b128 v[56:59], v19 offset:2048
    ds_read_b128 v[60:63], v19 offset:3072
    ds_read_b128 v[64:67], v20 offset:0
g2_mm_loop:
    s_waitcnt lgkmcnt(0)
    ds_read_b64_tr_b16 v[68:69], v16 offset:8192
    ds_read_b64_tr_b16 v[70:71], v16 offset:12288
    ds_read_b64_tr_b16 v[72:73], v17 offset:8192
    ds_read_b64_tr_b16 v[74:75], v17 offset:12288
    ds_read_b128 v[76:79], v18 offset:9216
    ds_read_b128 v[80:83], v18 offset:10240
    ds_read_b128 v[84:87], v18 offset:11264
    ds_read_b128 v[88:91], v18 offset:12288
    ds_read_b128 v[92:95], v19 offset:9216
    ds_read_b128 v[96:99], v19 offset:10240
    ds_read_b128 v[100:103], v19 offset:11264
    ds_read_b128 v[104:107], v19 offset:12288
    ds_read_b128 v[108:111], v20 offset:9216
    v_mfma_f32_16x16x32_bf16 v[112:115], v[32:35], v[24:27], v[112:115]
    v_mfma_f32_16x16x32_bf16 v[148:151], v[32:35], v[28:31], v[148:151]
    v_mfma_f32_16x16x32_bf16 v[116:119], v[36:39], v[24:27], v[116:119]
    v_mfma_f32_16x16x32_bf16 v[152:155], v[36:39], v[28:31], v[152:155]
    v_mfma_f32_16x16x32_bf16 v[120:123], v[40:43], v[24:27], v[120:123]
    v_mfma_f32_16x16x32_bf16 v[156:159], v[40:43], v[28:31], v[156:159]
    v_mfma_f32_16x16x32_bf16 v[124:127], v[44:47], v[24:27], v[124:127]
    v_mfma_f32_16x16x32_bf16 v[160:163], v[44:47], v[28:31], v[160:163]
    v_mfma_f32_16x16x32_bf16 v[128:131], v[48:51], v[24:27], v[128:131]
    v_mfma_f32_16x16x32_bf16 v[164:167], v[48:51], v[28:31], v[164:167]
    v_mfma_f32_16x16x32_bf16 v[132:135], v[52:55], v[24:27], v[132:135]
    v_mfma_f32_16x16x32_bf16 v[168:171], v[52:55], v[28:31], v[168:171]
    v_mfma_f32_16x16x32_bf16 v[136:139], v[56:59], v[24:27], v[136:139]
    v_mfma_f32_16x16x32_bf16 v[172:175], v[56:59], v[28:31], v[172:175]
    v_mfma_f32_16x16x32_bf16 v[140:143], v[60:63], v[24:27], v[140:143]
    v_mfma_f32_16x16x32_bf16 v[176:179], v[60:63], v[28:31], v[176:179]
    v_mfma_f32_16x16x32_bf16 v[144:147], v[64:67], v[24:27], v[144:147]
    v_mfma_f32_16x16x32_bf16 v[180:183], v[64:67], v[28:31], v[180:183]
    s_add_u32 s27, s27, 34816
    s_cmp_eq_u32 s27, 139264
    s_cselect_b32 s27, 0, s27
    s_waitcnt lgkmcnt(0)
    v_add_u32 v16, s27, v8
    v_add_u32 v17, s27, v9
    v_add_u32 v18, s27, v10
    v_add_u32 v19, s27, v11
    v_add_u32 v20, s27, v12
    s_barrier
    ds_read_b64_tr_b16 v[24:25], v16 offset:0
    ds_read_b64_tr_b16 v[26:27], v16 offset:4096
    ds_read_b64_tr_b16 v[28:29], v17 offset:0
    ds_read_b64_tr_b16 v[30:31], v17 offset:4096
    ds_read_b128 v[32:35], v18 offset:0
    ds_read_b128 v[36:39], v18 offset:1024
    ds_read_b128 v[40:43], v18 offset:2048
    ds_read_b128 v[44:47], v18 offset:3072
    ds_read_b128 v[48:51], v19 offset:0
    ds_read_b128 v[52:55], v19 offset:1024
    ds_read_b128 v[56:59], v19 offset:2048
    ds_read_b128 v[60:63], v19 offset:3072
    ds_read_b128 v[64:67], v20 offset:0
    v_mfma_f32_16x16x32_bf16 v[112:115], v[76:79], v[68:71], v[112:115]
    v_mfma_f32_16x16x32_bf16 v[148:151], v[76:79], v[72:75], v[148:151]
    v_mfma_f32_16x16x32_bf16 v[116:119], v[80:83], v[68:71], v[116:119]
    v_mfma_f32_16x16x32_bf16 v[152:155], v[80:83], v[72:75], v[152:155]
    v_mfma_f32_16x16x32_bf16 v[120:123], v[84:87], v[68:71], v[120:123]
    v_mfma_f32_16x16x32_bf16 v[156:159], v[84:87], v[72:75], v[156:159]
    v_mfma_f32_16x16x32_bf16 v[124:127], v[88:91], v[68:71], v[124:127]
    v_mfma_f32_16x16x32_bf16 v[160:163], v[88:91], v[72:75], v[160:163]
    v_mfma_f32_16x16x32_bf16 v[128:131], v[92:95], v[68:71], v[128:131]
    v_mfma_f32_16x16x32_bf16 v[164:167], v[92:95], v[72:75], v[164:167]
    v_mfma_f32_16x16x32_bf16 v[132:135], v[96:99], v[68:71], v[132:135]
    v_mfma_f32_16x16x32_bf16 v[168:171], v[96:99], v[72:75], v[168:171]
    v_mfma_f32_16x16x32_bf16 v[136:139], v[100:103], v[68:71], v[136:139]
    v_mfma_f32_16x16x32_bf16 v[172:175], v[100:103], v[72:75], v[172:175]
    v_mfma_f32_16x16x32_bf16 v[140:143], v[104:107], v[68:71], v[140:143]
    v_mfma_f32_16x16x32_bf16 v[176:179], v[104:107], v[72:75], v[176:179]
    v_mfma_f32_16x16x32_bf16 v[144:147], v[108:111], v[68:71], v[144:147]
    v_mfma_f32_16x16x32_bf16 v[180:183], v[108:111], v[72:75], v[180:183]
    s_sub_u32 s31, s31, 1
    s_cmp_lg_u32 s31, 0
    s_cbranch_scc1 g2_mm_loop
    s_waitcnt lgkmcnt(0)
    ds_read_b64_tr_b16 v[68:69], v16 offset:8192
    ds_read_b64_tr_b16 v[70:71], v16 offset:12288
    ds_read_b64_tr_b16 v[72:73], v17 offset:8192
    ds_read_b64_tr_b16 v[74:75], v17 offset:12288
    ds_read_b128 v[76:79], v18 offset:9216
    ds_read_b128 v[80:83], v18 offset:10240
    ds_read_b128 v[84:87], v18 offset:11264
    ds_read_b128 v[88:91], v18 offset:12288
    ds_read_b128 v[92:95], v19 offset:9216
    ds_read_b128 v[96:99], v19 offset:10240
    ds_read_b128 v[100:103], v19 offset:11264
    ds_read_b128 v[104:107], v19 offset:12288
    ds_read_b128 v[108:111], v20 offset:9216
    v_mfma_f32_16x16x32_bf16 v[112:115], v[32:35], v[24:27], v[112:115]
    v_mfma_f32_16x16x32_bf16 v[148:151], v[32:35], v[28:31], v[148:151]
    v_mfma_f32_16x16x32_bf16 v[116:119], v[36:39], v[24:27], v[116:119]
    v_mfma_f32_16x16x32_bf16 v[152:155], v[36:39], v[28:31], v[152:155]
    v_mfma_f32_16x16x32_bf16 v[120:123], v[40:43], v[24:27], v[120:123]
    v_mfma_f32_16x16x32_bf16 v[156:159], v[40:43], v[28:31], v[156:159]
    v_mfma_f32_16x16x32_bf16 v[124:127], v[44:47], v[24:27], v[124:127]
    v_mfma_f32_16x16x32_bf16 v[160:163], v[44:47], v[28:31], v[160:163]
    v_mfma_f32_16x16x32_bf16 v[128:131], v[48:51], v[24:27], v[128:131]
    v_mfma_f32_16x16x32_bf16 v[164:167], v[48:51], v[28:31], v[164:167]
    v_mfma_f32_16x16x32_bf16 v[132:135], v[52:55], v[24:27], v[132:135]
    v_mfma_f32_16x16x32_bf16 v[168:171], v[52:55], v[28:31], v[168:171]
    v_mfma_f32_16x16x32_bf16 v[136:139], v[56:59], v[24:27], v[136:139]
    v_mfma_f32_16x16x32_bf16 v[172:175], v[56:59], v[28:31], v[172:175]
    v_mfma_f32_16x16x32_bf16 v[140:143], v[60:63], v[24:27], v[140:143]
    v_mfma_f32_16x16x32_bf16 v[176:179], v[60:63], v[28:31], v[176:179]
    v_mfma_f32_16x16x32_bf16 v[144:147], v[64:67], v[24:27], v[144:147]
    v_mfma_f32_16x16x32_bf16 v[180:183], v[64:67], v[28:31], v[180:183]
    s_waitcnt lgkmcnt(0)
    v_mfma_f32_16x16x32_bf16 v[112:115], v[76:79], v[68:71], v[112:115]
    v_mfma_f32_16x16x32_bf16 v[148:151], v[76:79], v[72:75], v[148:151]
    v_mfma_f32_16x16x32_bf16 v[116:119], v[80:83], v[68:71], v[116:119]
    v_mfma_f32_16x16x32_bf16 v[152:155], v[80:83], v[72:75], v[152:155]
    v_mfma_f32_16x16x32_bf16 v[120:123], v[84:87], v[68:71], v[120:123]
    v_mfma_f32_16x16x32_bf16 v[156:159], v[84:87], v[72:75], v[156:159]
    v_mfma_f32_16x16x32_bf16 v[124:127], v[88:91], v[68:71], v[124:127]
    v_mfma_f32_16x16x32_bf16 v[160:163], v[88:91], v[72:75], v[160:163]
    v_mfma_f32_16x16x32_bf16 v[128:131], v[92:95], v[68:71], v[128:131]
    v_mfma_f32_16x16x32_bf16 v[164:167], v[92:95], v[72:75], v[164:167]
    v_mfma_f32_16x16x32_bf16 v[132:135], v[96:99], v[68:71], v[132:135]
    v_mfma_f32_16x16x32_bf16 v[168:171], v[96:99], v[72:75], v[168:171]
    v_mfma_f32_16x16x32_bf16 v[136:139], v[100:103], v[68:71], v[136:139]
    v_mfma_f32_16x16x32_bf16 v[172:175], v[100:103], v[72:75], v[172:175]
    v_mfma_f32_16x16x32_bf16 v[140:143], v[104:107], v[68:71], v[140:143]
    v_mfma_f32_16x16x32_bf16 v[176:179], v[104:107], v[72:75], v[176:179]
    v_mfma_f32_16x16x32_bf16 v[144:147], v[108:111], v[68:71], v[144:147]
    v_mfma_f32_16x16x32_bf16 v[180:183], v[108:111], v[72:75], v[180:183]
    s_cmp_eq_u32 s39, 1
    s_cbranch_scc0 g2_noswap
    s_nop 4
    v_swap_b32 v144, v146
    v_swap_b32 v145, v147
    v_swap_b32 v180, v182
    v_swap_b32 v181, v183
g2_noswap:
    s_lshl_b32 s50, s37, 4
    s_add_u32 s50, s50, s36
    s_lshl_b32 s50, s50, 2
    s_add_u32 s50, s50, s3
    s_lshl_b32 s50, s50, 2
    v_lshlrev_b32 v23, 2, v1
    s_xor_b32 s51, s35, 1
    s_add_u32 s51, s51, s50
    s_lshl_b32 s51, s51, 2
    s_add_u32 s51, s51, s35
    s_mul_i32 s51, s51, 3072
    v_cvt_pk_bf16_f32 v24, v128, v129
    v_cvt_pk_bf16_f32 v25, v130, v131
    v_cvt_pk_bf16_f32 v26, v132, v133
    v_cvt_pk_bf16_f32 v27, v134, v135
    v_cvt_pk_bf16_f32 v28, v136, v137
    v_cvt_pk_bf16_f32 v29, v138, v139
    v_cvt_pk_bf16_f32 v30, v140, v141
    v_cvt_pk_bf16_f32 v31, v142, v143
    v_cvt_pk_bf16_f32 v32, v146, v147
    buffer_store_dwordx4 v[24:27], v7, s[64:67], s51 offen sc0 sc1
    buffer_store_dwordx4 v[28:31], v7, s[64:67], s51 offen offset:1024 sc0 sc1
    buffer_store_dword v32, v23, s[64:67], s51 offen offset:2048 sc0 sc1
    s_xor_b32 s51, s35, 2
    s_add_u32 s51, s51, s50
    s_lshl_b32 s51, s51, 2
    s_add_u32 s51, s51, s35
    s_mul_i32 s51, s51, 3072
    v_cvt_pk_bf16_f32 v36, v148, v149
    v_cvt_pk_bf16_f32 v37, v150, v151
    v_cvt_pk_bf16_f32 v38, v152, v153
    v_cvt_pk_bf16_f32 v39, v154, v155
    v_cvt_pk_bf16_f32 v40, v156, v157
    v_cvt_pk_bf16_f32 v41, v158, v159
    v_cvt_pk_bf16_f32 v42, v160, v161
    v_cvt_pk_bf16_f32 v43, v162, v163
    v_cvt_pk_bf16_f32 v44, v180, v181
    buffer_store_dwordx4 v[36:39], v7, s[64:67], s51 offen sc0 sc1
    buffer_store_dwordx4 v[40:43], v7, s[64:67], s51 offen offset:1024 sc0 sc1
    buffer_store_dword v44, v23, s[64:67], s51 offen offset:2048 sc0 sc1
    s_xor_b32 s51, s35, 3
    s_add_u32 s51, s51, s50
    s_lshl_b32 s51, s51, 2
    s_add_u32 s51, s51, s35
    s_mul_i32 s51, s51, 3072
    v_cvt_pk_bf16_f32 v48, v164, v165
    v_cvt_pk_bf16_f32 v49, v166, v167
    v_cvt_pk_bf16_f32 v50, v168, v169
    v_cvt_pk_bf16_f32 v51, v170, v171
    v_cvt_pk_bf16_f32 v52, v172, v173
    v_cvt_pk_bf16_f32 v53, v174, v175
    v_cvt_pk_bf16_f32 v54, v176, v177
    v_cvt_pk_bf16_f32 v55, v178, v179
    v_cvt_pk_bf16_f32 v56, v182, v183
    buffer_store_dwordx4 v[48:51], v7, s[64:67], s51 offen sc0 sc1
    buffer_store_dwordx4 v[52:55], v7, s[64:67], s51 offen offset:1024 sc0 sc1
    buffer_store_dword v56, v23, s[64:67], s51 offen offset:2048 sc0 sc1
    s_lshl_b32 s52, s50, 6
    s_lshl_b32 s53, s35, 2
    s_add_u32 s53, s53, s52
    v_lshlrev_b32 v2, 6, v1
    v_mov_b32 v3, 1
    s_waitcnt vmcnt(0)
    s_mov_b64 exec, 15
    buffer_store_dword v3, v2, s[68:71], s53 offen sc0 sc1
    s_mov_b64 exec, -1
    s_lshl_b32 s53, s35, 6
    s_add_u32 s53, s53, s52
    s_mov_b32 s54, 0
g2_poll:
    buffer_load_dwordx4 v[68:71], off, s[68:71], s53 sc0 sc1
    s_add_u32 s54, s54, 1
    s_waitcnt vmcnt(0)
    v_and_b32 v68, v68, v69
    v_and_b32 v70, v70, v71
    v_and_b32 v68, v68, v70
    s_nop 0
    v_readfirstlane_b32 s55, v68
    s_nop 0
    s_cmp_eq_u32 s55, 1
    s_cbranch_scc1 g2_ready
    s_cmp_lt_u32 s54, 0x40000
    s_cbranch_scc1 g2_poll
g2_ready:
    s_add_u32 s50, s50, s35
    s_lshl_b32 s50, s50, 2
    s_xor_b32 s51, s35, 1
    s_add_u32 s51, s51, s50
    s_mul_i32 s51, s51, 3072
    buffer_load_dwordx4 v[68:71], v7, s[64:67], s51 offen sc0 sc1
    buffer_load_dwordx4 v[72:75], v7, s[64:67], s51 offen offset:1024 sc0 sc1
    buffer_load_dword v76, v23, s[64:67], s51 offen offset:2048 sc0 sc1
    s_xor_b32 s51, s35, 2
    s_add_u32 s51, s51, s50
    s_mul_i32 s51, s51, 3072
    buffer_load_dwordx4 v[80:83], v7, s[64:67], s51 offen sc0 sc1
    buffer_load_dwordx4 v[84:87], v7, s[64:67], s51 offen offset:1024 sc0 sc1
    buffer_load_dword v88, v23, s[64:67], s51 offen offset:2048 sc0 sc1
    s_xor_b32 s51, s35, 3
    s_add_u32 s51, s51, s50
    s_mul_i32 s51, s51, 3072
    buffer_load_dwordx4 v[92:95], v7, s[64:67], s51 offen sc0 sc1
    buffer_load_dwordx4 v[96:99], v7, s[64:67], s51 offen offset:1024 sc0 sc1
    buffer_load_dword v100, v23, s[64:67], s51 offen offset:2048 sc0 sc1
    s_mov_b32 s32, 0xffff0000
    s_waitcnt vmcnt(6)
    v_lshlrev_b32 v24, 16, v68
    v_and_b32 v25, s32, v68
    v_add_f32 v112, v112, v24
    v_add_f32 v113, v113, v25
    v_lshlrev_b32 v24, 16, v69
    v_and_b32 v25, s32, v69
    v_add_f32 v114, v114, v24
    v_add_f32 v115, v115, v25
    v_lshlrev_b32 v24, 16, v70
    v_and_b32 v25, s32, v70
    v_add_f32 v116, v116, v24
    v_add_f32 v117, v117, v25
    v_lshlrev_b32 v24, 16, v71
    v_and_b32 v25, s32, v71
    v_add_f32 v118, v118, v24
    v_add_f32 v119, v119, v25
    v_lshlrev_b32 v24, 16, v72
    v_and_b32 v25, s32, v72
    v_add_f32 v120, v120, v24
    v_add_f32 v121, v121, v25
    v_lshlrev_b32 v24, 16, v73
    v_and_b32 v25, s32, v73
    v_add_f32 v122, v122, v24
    v_add_f32 v123, v123, v25
    v_lshlrev_b32 v24, 16, v74
    v_and_b32 v25, s32, v74
    v_add_f32 v124, v124, v24
    v_add_f32 v125, v125, v25
    v_lshlrev_b32 v24, 16, v75
    v_and_b32 v25, s32, v75
    v_add_f32 v126, v126, v24
    v_add_f32 v127, v127, v25
    v_lshlrev_b32 v24, 16, v76
    v_and_b32 v25, s32, v76
    v_add_f32 v144, v144, v24
    v_add_f32 v145, v145, v25
    s_waitcnt vmcnt(3)
    v_lshlrev_b32 v24, 16, v80
    v_and_b32 v25, s32, v80
    v_add_f32 v112, v112, v24
    v_add_f32 v113, v113, v25
    v_lshlrev_b32 v24, 16, v81
    v_and_b32 v25, s32, v81
    v_add_f32 v114, v114, v24
    v_add_f32 v115, v115, v25
    v_lshlrev_b32 v24, 16, v82
    v_and_b32 v25, s32, v82
    v_add_f32 v116, v116, v24
    v_add_f32 v117, v117, v25
    v_lshlrev_b32 v24, 16, v83
    v_and_b32 v25, s32, v83
    v_add_f32 v118, v118, v24
    v_add_f32 v119, v119, v25
    v_lshlrev_b32 v24, 16, v84
    v_and_b32 v25, s32, v84
    v_add_f32 v120, v120, v24
    v_add_f32 v121, v121, v25
    v_lshlrev_b32 v24, 16, v85
    v_and_b32 v25, s32, v85
    v_add_f32 v122, v122, v24
    v_add_f32 v123, v123, v25
    v_lshlrev_b32 v24, 16, v86
    v_and_b32 v25, s32, v86
    v_add_f32 v124, v124, v24
    v_add_f32 v125, v125, v25
    v_lshlrev_b32 v24, 16, v87
    v_and_b32 v25, s32, v87
    v_add_f32 v126, v126, v24
    v_add_f32 v127, v127, v25
    v_lshlrev_b32 v24, 16, v88
    v_and_b32 v25, s32, v88
    v_add_f32 v144, v144, v24
    v_add_f32 v145, v145, v25
    s_waitcnt vmcnt(0)
    v_lshlrev_b32 v24, 16, v92
    v_and_b32 v25, s32, v92
    v_add_f32 v112, v112, v24
    v_add_f32 v113, v113, v25
    v_lshlrev_b32 v24, 16, v93
    v_and_b32 v25, s32, v93
    v_add_f32 v114, v114, v24
    v_add_f32 v115, v115, v25
    v_lshlrev_b32 v24, 16, v94
    v_and_b32 v25, s32, v94
    v_add_f32 v116, v116, v24
    v_add_f32 v117, v117, v25
    v_lshlrev_b32 v24, 16, v95
    v_and_b32 v25, s32, v95
    v_add_f32 v118, v118, v24
    v_add_f32 v119, v119, v25
    v_lshlrev_b32 v24, 16, v96
    v_and_b32 v25, s32, v96
    v_add_f32 v120, v120, v24
    v_add_f32 v121, v121, v25
    v_lshlrev_b32 v24, 16, v97
    v_and_b32 v25, s32, v97
    v_add_f32 v122, v122, v24
    v_add_f32 v123, v123, v25
    v_lshlrev_b32 v24, 16, v98
    v_and_b32 v25, s32, v98
    v_add_f32 v124, v124, v24
    v_add_f32 v125, v125, v25
    v_lshlrev_b32 v24, 16, v99
    v_and_b32 v25, s32, v99
    v_add_f32 v126, v126, v24
    v_add_f32 v127, v127, v25
    v_lshlrev_b32 v24, 16, v100
    v_and_b32 v25, s32, v100
    v_add_f32 v144, v144, v24
    v_add_f32 v145, v145, v25
    v_cvt_pk_bf16_f32 v24, v112, v113
    v_lshlrev_b32 v112, 16, v24
    v_and_b32 v113, s32, v24
    v_cvt_pk_bf16_f32 v25, v114, v115
    v_lshlrev_b32 v114, 16, v25
    v_and_b32 v115, s32, v25
    v_cvt_pk_bf16_f32 v24, v116, v117
    v_lshlrev_b32 v116, 16, v24
    v_and_b32 v117, s32, v24
    v_cvt_pk_bf16_f32 v25, v118, v119
    v_lshlrev_b32 v118, 16, v25
    v_and_b32 v119, s32, v25
    v_cvt_pk_bf16_f32 v24, v120, v121
    v_lshlrev_b32 v120, 16, v24
    v_and_b32 v121, s32, v24
    v_cvt_pk_bf16_f32 v25, v122, v123
    v_lshlrev_b32 v122, 16, v25
    v_and_b32 v123, s32, v25
    v_cvt_pk_bf16_f32 v24, v124, v125
    v_lshlrev_b32 v124, 16, v24
    v_and_b32 v125, s32, v24
    v_cvt_pk_bf16_f32 v25, v126, v127
    v_lshlrev_b32 v126, 16, v25
    v_and_b32 v127, s32, v25
    v_cvt_pk_bf16_f32 v24, v144, v145
    v_lshlrev_b32 v144, 16, v24
    v_and_b32 v145, s32, v24
    v_add_f32 v112, v112, v214
    v_add_f32 v113, v113, v214
    v_add_f32 v114, v114, v214
    v_add_f32 v115, v115, v214
    v_add_f32 v116, v116, v214
    v_add_f32 v117, v117, v214
    v_add_f32 v118, v118, v214
    v_add_f32 v119, v119, v214
    v_add_f32 v120, v120, v214
    v_add_f32 v121, v121, v214
    v_add_f32 v122, v122, v214
    v_add_f32 v123, v123, v214
    v_add_f32 v124, v124, v214
    v_add_f32 v125, v125, v214
    v_add_f32 v126, v126, v214
    v_add_f32 v127, v127, v214
    v_add_f32 v144, v144, v214
    v_add_f32 v145, v145, v214
    v_cvt_pk_bf16_f32 v24, v112, v113
    v_lshlrev_b32 v112, 16, v24
    v_and_b32 v113, s32, v24
    v_cvt_pk_bf16_f32 v25, v114, v115
    v_lshlrev_b32 v114, 16, v25
    v_and_b32 v115, s32, v25
    v_cvt_pk_bf16_f32 v24, v116, v117
    v_lshlrev_b32 v116, 16, v24
    v_and_b32 v117, s32, v24
    v_cvt_pk_bf16_f32 v25, v118, v119
    v_lshlrev_b32 v118, 16, v25
    v_and_b32 v119, s32, v25
    v_cvt_pk_bf16_f32 v24, v120, v121
    v_lshlrev_b32 v120, 16, v24
    v_and_b32 v121, s32, v24
    v_cvt_pk_bf16_f32 v25, v122, v123
    v_lshlrev_b32 v122, 16, v25
    v_and_b32 v123, s32, v25
    v_cvt_pk_bf16_f32 v24, v124, v125
    v_lshlrev_b32 v124, 16, v24
    v_and_b32 v125, s32, v24
    v_cvt_pk_bf16_f32 v25, v126, v127
    v_lshlrev_b32 v126, 16, v25
    v_and_b32 v127, s32, v25
    v_cvt_pk_bf16_f32 v24, v144, v145
    v_lshlrev_b32 v144, 16, v24
    v_and_b32 v145, s32, v24
    v_mul_f32 v112, v112, v194
    v_mul_f32 v113, v113, v195
    v_mul_f32 v114, v114, v196
    v_mul_f32 v115, v115, v197
    v_mul_f32 v116, v116, v198
    v_mul_f32 v117, v117, v199
    v_mul_f32 v118, v118, v200
    v_mul_f32 v119, v119, v201
    v_mul_f32 v120, v120, v202
    v_mul_f32 v121, v121, v203
    v_mul_f32 v122, v122, v204
    v_mul_f32 v123, v123, v205
    v_mul_f32 v124, v124, v206
    v_mul_f32 v125, v125, v207
    v_mul_f32 v126, v126, v208
    v_mul_f32 v127, v127, v209
    v_mul_f32 v144, v144, v210
    v_mul_f32 v145, v145, v211
    v_cvt_pk_bf16_f32 v24, v112, v113
    v_lshlrev_b32 v112, 16, v24
    v_and_b32 v113, s32, v24
    v_cvt_pk_bf16_f32 v25, v114, v115
    v_lshlrev_b32 v114, 16, v25
    v_and_b32 v115, s32, v25
    v_cvt_pk_bf16_f32 v24, v116, v117
    v_lshlrev_b32 v116, 16, v24
    v_and_b32 v117, s32, v24
    v_cvt_pk_bf16_f32 v25, v118, v119
    v_lshlrev_b32 v118, 16, v25
    v_and_b32 v119, s32, v25
    v_cvt_pk_bf16_f32 v24, v120, v121
    v_lshlrev_b32 v120, 16, v24
    v_and_b32 v121, s32, v24
    v_cvt_pk_bf16_f32 v25, v122, v123
    v_lshlrev_b32 v122, 16, v25
    v_and_b32 v123, s32, v25
    v_cvt_pk_bf16_f32 v24, v124, v125
    v_lshlrev_b32 v124, 16, v24
    v_and_b32 v125, s32, v24
    v_cvt_pk_bf16_f32 v25, v126, v127
    v_lshlrev_b32 v126, 16, v25
    v_and_b32 v127, s32, v25
    v_cvt_pk_bf16_f32 v24, v144, v145
    v_lshlrev_b32 v144, 16, v24
    v_and_b32 v145, s32, v24
    v_lshlrev_b32 v24, 16, v184
    v_and_b32 v25, s32, v184
    v_add_f32 v112, v112, v24
    v_add_f32 v113, v113, v25
    v_cvt_pk_bf16_f32 v68, v112, v113
    v_lshlrev_b32 v24, 16, v185
    v_and_b32 v25, s32, v185
    v_add_f32 v114, v114, v24
    v_add_f32 v115, v115, v25
    v_cvt_pk_bf16_f32 v69, v114, v115
    v_lshlrev_b32 v24, 16, v186
    v_and_b32 v25, s32, v186
    v_add_f32 v116, v116, v24
    v_add_f32 v117, v117, v25
    v_cvt_pk_bf16_f32 v70, v116, v117
    v_lshlrev_b32 v24, 16, v187
    v_and_b32 v25, s32, v187
    v_add_f32 v118, v118, v24
    v_add_f32 v119, v119, v25
    v_cvt_pk_bf16_f32 v71, v118, v119
    v_lshlrev_b32 v24, 16, v188
    v_and_b32 v25, s32, v188
    v_add_f32 v120, v120, v24
    v_add_f32 v121, v121, v25
    v_cvt_pk_bf16_f32 v72, v120, v121
    v_lshlrev_b32 v24, 16, v189
    v_and_b32 v25, s32, v189
    v_add_f32 v122, v122, v24
    v_add_f32 v123, v123, v25
    v_cvt_pk_bf16_f32 v73, v122, v123
    v_lshlrev_b32 v24, 16, v190
    v_and_b32 v25, s32, v190
    v_add_f32 v124, v124, v24
    v_add_f32 v125, v125, v25
    v_cvt_pk_bf16_f32 v74, v124, v125
    v_lshlrev_b32 v24, 16, v191
    v_and_b32 v25, s32, v191
    v_add_f32 v126, v126, v24
    v_add_f32 v127, v127, v25
    v_cvt_pk_bf16_f32 v75, v126, v127
    v_lshlrev_b32 v24, 16, v192
    v_and_b32 v25, s32, v192
    v_add_f32 v144, v144, v24
    v_add_f32 v145, v145, v25
    v_cvt_pk_bf16_f32 v76, v144, v145
    buffer_store_dwordx2 v[68:69], v22, s[60:63], s46 offen offset:0
    buffer_store_dwordx2 v[70:71], v22, s[60:63], s46 offen offset:32
    buffer_store_dwordx2 v[72:73], v22, s[60:63], s46 offen offset:64
    buffer_store_dwordx2 v[74:75], v22, s[60:63], s46 offen offset:96
    buffer_store_dword v76, v22, s[60:63], s47 offen
g2_done:
    s_endpgm
.section .rodata,"a"
.p2align 6
.amdhsa_kernel p0_kernel
  .amdhsa_next_free_vgpr 80
  .amdhsa_next_free_sgpr 96
  .amdhsa_accum_offset 80
  .amdhsa_group_segment_fixed_size 0
  .amdhsa_kernarg_size 104
  .amdhsa_user_sgpr_count 2
  .amdhsa_user_sgpr_kernarg_segment_ptr 1
  .amdhsa_system_sgpr_workgroup_id_x 1
.end_amdhsa_kernel
.section .rodata,"a"
.p2align 6
.amdhsa_kernel p1_kernel
  .amdhsa_next_free_vgpr 128
  .amdhsa_next_free_sgpr 96
  .amdhsa_accum_offset 128
  .amdhsa_group_segment_fixed_size 0
  .amdhsa_kernarg_size 104
  .amdhsa_user_sgpr_count 2
  .amdhsa_user_sgpr_kernarg_segment_ptr 1
  .amdhsa_system_sgpr_workgroup_id_x 1
.end_amdhsa_kernel
.section .rodata,"a"
.p2align 6
.amdhsa_kernel p2_kernel
  .amdhsa_next_free_vgpr 168
  .amdhsa_next_free_sgpr 96
  .amdhsa_accum_offset 168
  .amdhsa_group_segment_fixed_size 0
  .amdhsa_kernarg_size 104
  .amdhsa_user_sgpr_count 2
  .amdhsa_user_sgpr_kernarg_segment_ptr 1
  .amdhsa_system_sgpr_workgroup_id_x 1
.end_amdhsa_kernel
.section .rodata,"a"
.p2align 6
.amdhsa_kernel p3_kernel
  .amdhsa_next_free_vgpr 128
  .amdhsa_next_free_sgpr 96
  .amdhsa_accum_offset 128
  .amdhsa_group_segment_fixed_size 0
  .amdhsa_kernarg_size 104
  .amdhsa_user_sgpr_count 2
  .amdhsa_user_sgpr_kernarg_segment_ptr 1
  .amdhsa_system_sgpr_workgroup_id_x 1
.end_amdhsa_kernel
.section .rodata,"a"
.p2align 6
.amdhsa_kernel g1_kernel
  .amdhsa_next_free_vgpr 144
  .amdhsa_next_free_sgpr 96
  .amdhsa_accum_offset 144
  .amdhsa_group_segment_fixed_size 0
  .amdhsa_kernarg_size 104
  .amdhsa_user_sgpr_count 2
  .amdhsa_user_sgpr_kernarg_segment_ptr 1
  .amdhsa_system_sgpr_workgroup_id_x 1
.end_amdhsa_kernel
.section .rodata,"a"
.p2align 6
.amdhsa_kernel g2_kernel
  .amdhsa_next_free_vgpr 224
  .amdhsa_next_free_sgpr 96
  .amdhsa_accum_offset 224
  .amdhsa_group_segment_fixed_size 0
  .amdhsa_kernarg_size 104
  .amdhsa_user_sgpr_count 2
  .amdhsa_user_sgpr_kernarg_segment_ptr 1
  .amdhsa_system_sgpr_workgroup_id_x 1
.end_amdhsa_kernel
```

```asm
; @launch kernel=p0_kernel grid=(256,1,1) block=(256,1,1) lds=37376
; @launch kernel=p1_kernel grid=(256,1,1) block=(512,1,1) lds=13056
; @launch kernel=p2_kernel grid=(289,1,1) block=(256,1,1) lds=8704
; @launch kernel=p3_kernel grid=(256,1,1) block=(512,1,1) lds=12032
; @launch kernel=g1_kernel grid=(256,1,1) block=(512,1,1) lds=143360
; @launch kernel=g2_kernel grid=(256,1,1) block=(512,1,1) lds=139264
.amdgcn_target "amdgcn-amd-amdhsa--gfx950"
.text
.globl p0_kernel
.p2align 8
.type p0_kernel,@function
p0_kernel:
    s_cmp_ge_u32 s2, 172
    s_cbranch_scc1 p0_pf
    s_load_dwordx2 s[4:5], s[0:1], 96
    s_cmp_ge_u32 s2, 108
    s_cbranch_scc1 p0_wt
    s_load_dwordx4 s[8:11], s[0:1], 64
    v_and_b32 v1, 3, v0
    v_lshrrev_b32 v2, 2, v0
    s_movk_i32 s3, 6912
    v_mul_lo_u32 v3, v2, s3
    v_lshl_add_u32 v3, v1, 4, v3
    v_lshlrev_b32 v4, 1, v2
    s_lshl_b32 s24, s2, 6
    v_mov_b32 v8, 0
    v_mov_b32 v9, 0
    v_mov_b32 v10, 0
    v_mov_b32 v11, 0
    v_mov_b32 v12, 0
    v_mov_b32 v13, 0
    v_mov_b32 v14, 0
    v_mov_b32 v15, 0
    v_mov_b32 v16, 0
    s_waitcnt lgkmcnt(0)
    s_mov_b32 s12, s8
    s_mov_b32 s13, s9
    s_mov_b32 s14, 0x480
    s_mov_b32 s15, 0x20000
    s_mov_b32 s16, s10
    s_mov_b32 s17, s11
    s_mov_b32 s18, 0x3cc000
    s_mov_b32 s19, 0x20000
    s_mov_b32 s20, s4
    s_mov_b32 s21, s5
    s_mov_b32 s22, 0x3600
    s_mov_b32 s23, 0x20000
    buffer_load_short_d16_hi v8, v4, s[12:15], 0 offen offset:0
    buffer_load_short_d16_hi v9, v4, s[12:15], 0 offen offset:128
    buffer_load_short_d16_hi v10, v4, s[12:15], 0 offen offset:256
    buffer_load_short_d16_hi v11, v4, s[12:15], 0 offen offset:384
    buffer_load_short_d16_hi v12, v4, s[12:15], 0 offen offset:512
    buffer_load_short_d16_hi v13, v4, s[12:15], 0 offen offset:640
    buffer_load_short_d16_hi v14, v4, s[12:15], 0 offen offset:768
    buffer_load_short_d16_hi v15, v4, s[12:15], 0 offen offset:896
    buffer_load_short_d16_hi v16, v4, s[12:15], 0 offen offset:1024
    buffer_load_dwordx4 v[20:23], v3, s[16:19], s24 offen
    s_add_u32 s24, s24, 442368
    buffer_load_dwordx4 v[24:27], v3, s[16:19], s24 offen
    s_add_u32 s24, s24, 442368
    buffer_load_dwordx4 v[28:31], v3, s[16:19], s24 offen
    s_add_u32 s24, s24, 442368
    buffer_load_dwordx4 v[32:35], v3, s[16:19], s24 offen
    s_add_u32 s24, s24, 442368
    buffer_load_dwordx4 v[36:39], v3, s[16:19], s24 offen
    s_add_u32 s24, s24, 442368
    buffer_load_dwordx4 v[40:43], v3, s[16:19], s24 offen
    s_add_u32 s24, s24, 442368
    buffer_load_dwordx4 v[44:47], v3, s[16:19], s24 offen
    s_add_u32 s24, s24, 442368
    buffer_load_dwordx4 v[48:51], v3, s[16:19], s24 offen
    s_add_u32 s24, s24, 442368
    buffer_load_dwordx4 v[52:55], v3, s[16:19], s24 offen
    s_mov_b32 s25, 0xffff0000
    v_mov_b32 v60, 0
    v_mov_b32 v61, 0
    v_mov_b32 v62, 0
    v_mov_b32 v63, 0
    v_mov_b32 v64, 0
    v_mov_b32 v65, 0
    v_mov_b32 v66, 0
    v_mov_b32 v67, 0
    s_waitcnt vmcnt(9)
    v_mul_f32 v70, 0xbfb8aa3b, v8
    v_exp_f32 v70, v70
    s_nop 0
    v_add_f32 v70, 1.0, v70
    v_rcp_f32 v70, v70
    s_nop 0
    v_mul_f32 v8, v8, v70
    v_cvt_pk_bf16_f32 v8, v8, v8
    v_lshlrev_b32 v8, 16, v8
    v_mul_f32 v71, 0xbfb8aa3b, v9
    v_exp_f32 v71, v71
    s_nop 0
    v_add_f32 v71, 1.0, v71
    v_rcp_f32 v71, v71
    s_nop 0
    v_mul_f32 v9, v9, v71
    v_cvt_pk_bf16_f32 v9, v9, v9
    v_lshlrev_b32 v9, 16, v9
    v_mul_f32 v70, 0xbfb8aa3b, v10
    v_exp_f32 v70, v70
    s_nop 0
    v_add_f32 v70, 1.0, v70
    v_rcp_f32 v70, v70
    s_nop 0
    v_mul_f32 v10, v10, v70
    v_cvt_pk_bf16_f32 v10, v10, v10
    v_lshlrev_b32 v10, 16, v10
    v_mul_f32 v71, 0xbfb8aa3b, v11
    v_exp_f32 v71, v71
    s_nop 0
    v_add_f32 v71, 1.0, v71
    v_rcp_f32 v71, v71
    s_nop 0
    v_mul_f32 v11, v11, v71
    v_cvt_pk_bf16_f32 v11, v11, v11
    v_lshlrev_b32 v11, 16, v11
    v_mul_f32 v70, 0xbfb8aa3b, v12
    v_exp_f32 v70, v70
    s_nop 0
    v_add_f32 v70, 1.0, v70
    v_rcp_f32 v70, v70
    s_nop 0
    v_mul_f32 v12, v12, v70
    v_cvt_pk_bf16_f32 v12, v12, v12
    v_lshlrev_b32 v12, 16, v12
    v_mul_f32 v71, 0xbfb8aa3b, v13
    v_exp_f32 v71, v71
    s_nop 0
    v_add_f32 v71, 1.0, v71
    v_rcp_f32 v71, v71
    s_nop 0
    v_mul_f32 v13, v13, v71
    v_cvt_pk_bf16_f32 v13, v13, v13
    v_lshlrev_b32 v13, 16, v13
    v_mul_f32 v70, 0xbfb8aa3b, v14
    v_exp_f32 v70, v70
    s_nop 0
    v_add_f32 v70, 1.0, v70
    v_rcp_f32 v70, v70
    s_nop 0
    v_mul_f32 v14, v14, v70
    v_cvt_pk_bf16_f32 v14, v14, v14
    v_lshlrev_b32 v14, 16, v14
    v_mul_f32 v71, 0xbfb8aa3b, v15
    v_exp_f32 v71, v71
    s_nop 0
    v_add_f32 v71, 1.0, v71
    v_rcp_f32 v71, v71
    s_nop 0
    v_mul_f32 v15, v15, v71
    v_cvt_pk_bf16_f32 v15, v15, v15
    v_lshlrev_b32 v15, 16, v15
    v_mul_f32 v70, 0xbfb8aa3b, v16
    v_exp_f32 v70, v70
    s_nop 0
    v_add_f32 v70, 1.0, v70
    v_rcp_f32 v70, v70
    s_nop 0
    v_mul_f32 v16, v16, v70
    v_cvt_pk_bf16_f32 v16, v16, v16
    v_lshlrev_b32 v16, 16, v16
    s_waitcnt vmcnt(8)
    v_lshlrev_b32 v72, 16, v20
    v_and_b32 v73, s25, v20
    v_fmac_f32 v60, v8, v72
    v_fmac_f32 v61, v8, v73
    v_lshlrev_b32 v72, 16, v21
    v_and_b32 v73, s25, v21
    v_fmac_f32 v62, v8, v72
    v_fmac_f32 v63, v8, v73
    v_lshlrev_b32 v72, 16, v22
    v_and_b32 v73, s25, v22
    v_fmac_f32 v64, v8, v72
    v_fmac_f32 v65, v8, v73
    v_lshlrev_b32 v72, 16, v23
    v_and_b32 v73, s25, v23
    v_fmac_f32 v66, v8, v72
    v_fmac_f32 v67, v8, v73
    s_waitcnt vmcnt(7)
    v_lshlrev_b32 v72, 16, v24
    v_and_b32 v73, s25, v24
    v_fmac_f32 v60, v9, v72
    v_fmac_f32 v61, v9, v73
    v_lshlrev_b32 v72, 16, v25
    v_and_b32 v73, s25, v25
    v_fmac_f32 v62, v9, v72
    v_fmac_f32 v63, v9, v73
    v_lshlrev_b32 v72, 16, v26
    v_and_b32 v73, s25, v26
    v_fmac_f32 v64, v9, v72
    v_fmac_f32 v65, v9, v73
    v_lshlrev_b32 v72, 16, v27
    v_and_b32 v73, s25, v27
    v_fmac_f32 v66, v9, v72
    v_fmac_f32 v67, v9, v73
    s_waitcnt vmcnt(6)
    v_lshlrev_b32 v72, 16, v28
    v_and_b32 v73, s25, v28
    v_fmac_f32 v60, v10, v72
    v_fmac_f32 v61, v10, v73
    v_lshlrev_b32 v72, 16, v29
    v_and_b32 v73, s25, v29
    v_fmac_f32 v62, v10, v72
    v_fmac_f32 v63, v10, v73
    v_lshlrev_b32 v72, 16, v30
    v_and_b32 v73, s25, v30
    v_fmac_f32 v64, v10, v72
    v_fmac_f32 v65, v10, v73
    v_lshlrev_b32 v72, 16, v31
    v_and_b32 v73, s25, v31
    v_fmac_f32 v66, v10, v72
    v_fmac_f32 v67, v10, v73
    s_waitcnt vmcnt(5)
    v_lshlrev_b32 v72, 16, v32
    v_and_b32 v73, s25, v32
    v_fmac_f32 v60, v11, v72
    v_fmac_f32 v61, v11, v73
    v_lshlrev_b32 v72, 16, v33
    v_and_b32 v73, s25, v33
    v_fmac_f32 v62, v11, v72
    v_fmac_f32 v63, v11, v73
    v_lshlrev_b32 v72, 16, v34
    v_and_b32 v73, s25, v34
    v_fmac_f32 v64, v11, v72
    v_fmac_f32 v65, v11, v73
    v_lshlrev_b32 v72, 16, v35
    v_and_b32 v73, s25, v35
    v_fmac_f32 v66, v11, v72
    v_fmac_f32 v67, v11, v73
    s_waitcnt vmcnt(4)
    v_lshlrev_b32 v72, 16, v36
    v_and_b32 v73, s25, v36
    v_fmac_f32 v60, v12, v72
    v_fmac_f32 v61, v12, v73
    v_lshlrev_b32 v72, 16, v37
    v_and_b32 v73, s25, v37
    v_fmac_f32 v62, v12, v72
    v_fmac_f32 v63, v12, v73
    v_lshlrev_b32 v72, 16, v38
    v_and_b32 v73, s25, v38
    v_fmac_f32 v64, v12, v72
    v_fmac_f32 v65, v12, v73
    v_lshlrev_b32 v72, 16, v39
    v_and_b32 v73, s25, v39
    v_fmac_f32 v66, v12, v72
    v_fmac_f32 v67, v12, v73
    s_waitcnt vmcnt(3)
    v_lshlrev_b32 v72, 16, v40
    v_and_b32 v73, s25, v40
    v_fmac_f32 v60, v13, v72
    v_fmac_f32 v61, v13, v73
    v_lshlrev_b32 v72, 16, v41
    v_and_b32 v73, s25, v41
    v_fmac_f32 v62, v13, v72
    v_fmac_f32 v63, v13, v73
    v_lshlrev_b32 v72, 16, v42
    v_and_b32 v73, s25, v42
    v_fmac_f32 v64, v13, v72
    v_fmac_f32 v65, v13, v73
    v_lshlrev_b32 v72, 16, v43
    v_and_b32 v73, s25, v43
    v_fmac_f32 v66, v13, v72
    v_fmac_f32 v67, v13, v73
    s_waitcnt vmcnt(2)
    v_lshlrev_b32 v72, 16, v44
    v_and_b32 v73, s25, v44
    v_fmac_f32 v60, v14, v72
    v_fmac_f32 v61, v14, v73
    v_lshlrev_b32 v72, 16, v45
    v_and_b32 v73, s25, v45
    v_fmac_f32 v62, v14, v72
    v_fmac_f32 v63, v14, v73
    v_lshlrev_b32 v72, 16, v46
    v_and_b32 v73, s25, v46
    v_fmac_f32 v64, v14, v72
    v_fmac_f32 v65, v14, v73
    v_lshlrev_b32 v72, 16, v47
    v_and_b32 v73, s25, v47
    v_fmac_f32 v66, v14, v72
    v_fmac_f32 v67, v14, v73
    s_waitcnt vmcnt(1)
    v_lshlrev_b32 v72, 16, v48
    v_and_b32 v73, s25, v48
    v_fmac_f32 v60, v15, v72
    v_fmac_f32 v61, v15, v73
    v_lshlrev_b32 v72, 16, v49
    v_and_b32 v73, s25, v49
    v_fmac_f32 v62, v15, v72
    v_fmac_f32 v63, v15, v73
    v_lshlrev_b32 v72, 16, v50
    v_and_b32 v73, s25, v50
    v_fmac_f32 v64, v15, v72
    v_fmac_f32 v65, v15, v73
    v_lshlrev_b32 v72, 16, v51
    v_and_b32 v73, s25, v51
    v_fmac_f32 v66, v15, v72
    v_fmac_f32 v67, v15, v73
    s_waitcnt vmcnt(0)
    v_lshlrev_b32 v72, 16, v52
    v_and_b32 v73, s25, v52
    v_fmac_f32 v60, v16, v72
    v_fmac_f32 v61, v16, v73
    v_lshlrev_b32 v72, 16, v53
    v_and_b32 v73, s25, v53
    v_fmac_f32 v62, v16, v72
    v_fmac_f32 v63, v16, v73
    v_lshlrev_b32 v72, 16, v54
    v_and_b32 v73, s25, v54
    v_fmac_f32 v64, v16, v72
    v_fmac_f32 v65, v16, v73
    v_lshlrev_b32 v72, 16, v55
    v_and_b32 v73, s25, v55
    v_fmac_f32 v66, v16, v72
    v_fmac_f32 v67, v16, v73
    v_add_f32_dpp v60, v60, v60 row_ror:4 row_mask:0xf bank_mask:0xf
    v_add_f32_dpp v61, v61, v61 row_ror:4 row_mask:0xf bank_mask:0xf
    v_add_f32_dpp v62, v62, v62 row_ror:4 row_mask:0xf bank_mask:0xf
    v_add_f32_dpp v63, v63, v63 row_ror:4 row_mask:0xf bank_mask:0xf
    v_add_f32_dpp v64, v64, v64 row_ror:4 row_mask:0xf bank_mask:0xf
    v_add_f32_dpp v65, v65, v65 row_ror:4 row_mask:0xf bank_mask:0xf
    v_add_f32_dpp v66, v66, v66 row_ror:4 row_mask:0xf bank_mask:0xf
    v_add_f32_dpp v67, v67, v67 row_ror:4 row_mask:0xf bank_mask:0xf
    v_add_f32_dpp v60, v60, v60 row_ror:8 row_mask:0xf bank_mask:0xf
    v_add_f32_dpp v61, v61, v61 row_ror:8 row_mask:0xf bank_mask:0xf
    v_add_f32_dpp v62, v62, v62 row_ror:8 row_mask:0xf bank_mask:0xf
    v_add_f32_dpp v63, v63, v63 row_ror:8 row_mask:0xf bank_mask:0xf
    v_add_f32_dpp v64, v64, v64 row_ror:8 row_mask:0xf bank_mask:0xf
    v_add_f32_dpp v65, v65, v65 row_ror:8 row_mask:0xf bank_mask:0xf
    v_add_f32_dpp v66, v66, v66 row_ror:8 row_mask:0xf bank_mask:0xf
    v_add_f32_dpp v67, v67, v67 row_ror:8 row_mask:0xf bank_mask:0xf
    v_lshrrev_b32 v5, 4, v0
    v_lshlrev_b32 v5, 7, v5
    v_lshl_add_u32 v5, v1, 5, v5
    v_and_b32 v6, 15, v0
    v_cmp_gt_u32 vcc, 4, v6
    s_nop 0
    s_and_saveexec_b64 s[26:27], vcc
    ds_write_b128 v5, v[60:63]
    ds_write_b128 v5, v[64:67] offset:16
    s_mov_b64 exec, s[26:27]
    s_waitcnt lgkmcnt(0)
    s_barrier
    v_cmp_gt_u32 vcc, 32, v0
    s_nop 0
    s_and_saveexec_b64 s[26:27], vcc
    s_cbranch_execz p0_end
    v_lshlrev_b32 v5, 2, v0
    ds_read_b32 v20, v5 offset:0
    ds_read_b32 v21, v5 offset:128
    ds_read_b32 v22, v5 offset:256
    ds_read_b32 v23, v5 offset:384
    ds_read_b32 v24, v5 offset:512
    ds_read_b32 v25, v5 offset:640
    ds_read_b32 v26, v5 offset:768
    ds_read_b32 v27, v5 offset:896
    ds_read_b32 v28, v5 offset:1024
    ds_read_b32 v29, v5 offset:1152
    ds_read_b32 v30, v5 offset:1280
    ds_read_b32 v31, v5 offset:1408
    ds_read_b32 v32, v5 offset:1536
    ds_read_b32 v33, v5 offset:1664
    ds_read_b32 v34, v5 offset:1792
    ds_read_b32 v35, v5 offset:1920
    s_waitcnt lgkmcnt(0)
    v_add_f32 v20, v20, v21
    v_add_f32 v22, v22, v23
    v_add_f32 v24, v24, v25
    v_add_f32 v26, v26, v27
    v_add_f32 v28, v28, v29
    v_add_f32 v30, v30, v31
    v_add_f32 v32, v32, v33
    v_add_f32 v34, v34, v35
    v_add_f32 v20, v20, v22
    v_add_f32 v24, v24, v26
    v_add_f32 v28, v28, v30
    v_add_f32 v32, v32, v34
    v_add_f32 v20, v20, v24
    v_add_f32 v28, v28, v32
    v_add_f32 v20, v20, v28
    v_cvt_pk_bf16_f32 v20, v20, v20
    v_lshlrev_b32 v20, 16, v20
    v_add_f32 v21, 1.0, v20
    v_cvt_pk_bf16_f32 v21, v21, v21
    v_lshlrev_b32 v21, 16, v21
    s_sub_u32 s28, s2, 18
    s_cmp_lt_u32 s28, 18
    s_cselect_b32 s29, 1, 0
    s_sub_u32 s28, s2, 72
    s_cmp_lt_u32 s28, 18
    s_cselect_b32 s29, 1, s29
    s_cmp_eq_u32 s29, 1
    s_cbranch_scc0 p0_nop1
    v_mov_b32 v20, v21
p0_nop1:
    s_lshl_b32 s24, s2, 7
    buffer_store_dword v20, v5, s[20:23], s24 offen
    s_branch p0_end
p0_wt:
    s_load_dwordx4 s[8:11], s[0:1], 8
    s_sub_u32 s3, s2, 108
    s_and_b32 s24, s3, 7
    s_lshr_b32 s25, s3, 3
    s_lshl_b32 s26, s24, 3
    s_lshl_b32 s27, s25, 8
    s_add_u32 s26, s26, s27
    s_mul_i32 s26, s26, 578
    v_lshlrev_b32 v1, 4, v0
    s_waitcnt lgkmcnt(0)
    s_mov_b32 s12, s8
    s_mov_b32 s13, s9
    s_mov_b32 s14, 0x121000
    s_mov_b32 s15, 0x20000
    s_mov_b32 s16, s10
    s_mov_b32 s17, s11
    s_mov_b32 s18, 0x121000
    s_mov_b32 s19, 0x20000
    s_add_u32 s20, s4, 0x100000
    s_addc_u32 s21, s5, 0
    s_mov_b32 s22, 0x242000
    s_mov_b32 s23, 0x20000
    s_add_u32 s36, s4, 0x10000
    s_addc_u32 s37, s5, 0
    s_mov_b32 s38, 0x10000
    s_mov_b32 s39, 0x20000
    v_lshlrev_b32 v2, 2, v0
    v_mov_b32 v3, 0
    s_lshl_b32 s40, s3, 10
    buffer_store_dword v3, v2, s[36:39], s40 offen
    s_add_u32 s28, s26, 0
    s_add_u32 s29, s26, 36992
    s_add_u32 s30, s26, 73984
    s_add_u32 s31, s26, 110976
    buffer_load_dwordx4 v[8:11], v1, s[12:15], s28 offen
    buffer_load_dwordx4 v[12:15], v1, s[12:15], s29 offen
    buffer_load_dwordx4 v[16:19], v1, s[12:15], s30 offen
    buffer_load_dwordx4 v[20:23], v1, s[12:15], s31 offen
    buffer_load_dwordx4 v[24:27], v1, s[16:19], s28 offen
    buffer_load_dwordx4 v[28:31], v1, s[16:19], s29 offen
    buffer_load_dwordx4 v[32:35], v1, s[16:19], s30 offen
    buffer_load_dwordx4 v[36:39], v1, s[16:19], s31 offen
    v_cmp_gt_u32 vcc, 33, v0
    s_nop 0
    s_and_saveexec_b64 s[32:33], vcc
    s_cbranch_execz p0_wt_notail
    v_add_u32 v2, 4096, v1
    buffer_load_dwordx4 v[40:43], v2, s[12:15], s28 offen
    buffer_load_dwordx4 v[44:47], v2, s[12:15], s29 offen
    buffer_load_dwordx4 v[48:51], v2, s[12:15], s30 offen
    buffer_load_dwordx4 v[52:55], v2, s[12:15], s31 offen
    buffer_load_dwordx4 v[56:59], v2, s[16:19], s28 offen
    buffer_load_dwordx4 v[60:63], v2, s[16:19], s29 offen
    buffer_load_dwordx4 v[64:67], v2, s[16:19], s30 offen
    buffer_load_dwordx4 v[68:71], v2, s[16:19], s31 offen
    s_waitcnt vmcnt(0)
    ds_write_b128 v2, v[40:43] offset:0
    ds_write_b128 v2, v[44:47] offset:4624
    ds_write_b128 v2, v[48:51] offset:9248
    ds_write_b128 v2, v[52:55] offset:13872
    ds_write_b128 v2, v[56:59] offset:18496
    ds_write_b128 v2, v[60:63] offset:23120
    ds_write_b128 v2, v[64:67] offset:27744
    ds_write_b128 v2, v[68:71] offset:32368
p0_wt_notail:
    s_mov_b64 exec, s[32:33]
    s_waitcnt vmcnt(0)
    ds_write_b128 v1, v[8:11] offset:0
    ds_write_b128 v1, v[12:15] offset:4624
    ds_write_b128 v1, v[16:19] offset:9248
    ds_write_b128 v1, v[20:23] offset:13872
    ds_write_b128 v1, v[24:27] offset:18496
    ds_write_b128 v1, v[28:31] offset:23120
    ds_write_b128 v1, v[32:35] offset:27744
    ds_write_b128 v1, v[36:39] offset:32368
    v_and_b32 v3, 7, v0
    v_lshrrev_b32 v4, 3, v0
    s_movk_i32 s34, 578
    v_mul_lo_u32 v5, v3, s34
    v_lshl_add_u32 v5, v4, 1, v5
    v_lshlrev_b32 v6, 13, v4
    v_lshl_add_u32 v6, v3, 4, v6
    s_lshr_b32 s34, s24, 1
    s_lshl_b32 s34, s34, 1
    s_lshr_b32 s35, s25, 2
    s_add_u32 s34, s34, s35
    s_lshl_b32 s34, s34, 6
    s_and_b32 s35, s25, 3
    s_lshl_b32 s35, s35, 4
    s_add_u32 s34, s34, s35
    s_and_b32 s35, s24, 1
    s_lshl_b32 s35, s35, 3
    s_add_u32 s34, s34, s35
    s_lshl_b32 s34, s34, 4
    s_waitcnt lgkmcnt(0)
    s_barrier
    ds_read_u16 v8, v5 offset:0
    ds_read_u16 v12, v5 offset:18496
    ds_read_u16 v9, v5 offset:4624
    ds_read_u16 v13, v5 offset:23120
    ds_read_u16 v10, v5 offset:9248
    ds_read_u16 v14, v5 offset:27744
    ds_read_u16 v11, v5 offset:13872
    ds_read_u16 v15, v5 offset:32368
    ds_read_u16 v24, v5 offset:64
    ds_read_u16 v28, v5 offset:18560
    ds_read_u16 v25, v5 offset:4688
    ds_read_u16 v29, v5 offset:23184
    ds_read_u16 v26, v5 offset:9312
    ds_read_u16 v30, v5 offset:27808
    ds_read_u16 v27, v5 offset:13936
    ds_read_u16 v31, v5 offset:32432
    s_waitcnt lgkmcnt(8)
    v_lshl_or_b32 v16, v12, 16, v8
    v_lshl_or_b32 v17, v13, 16, v9
    v_lshl_or_b32 v18, v14, 16, v10
    v_lshl_or_b32 v19, v15, 16, v11
    buffer_store_dwordx4 v[16:19], v6, s[20:23], s34 offen
    s_add_u32 s34, s34, 262144
    ds_read_u16 v40, v5 offset:128
    ds_read_u16 v44, v5 offset:18624
    ds_read_u16 v41, v5 offset:4752
    ds_read_u16 v45, v5 offset:23248
    ds_read_u16 v42, v5 offset:9376
    ds_read_u16 v46, v5 offset:27872
    ds_read_u16 v43, v5 offset:14000
    ds_read_u16 v47, v5 offset:32496
    s_waitcnt lgkmcnt(8)
    v_lshl_or_b32 v32, v28, 16, v24
    v_lshl_or_b32 v33, v29, 16, v25
    v_lshl_or_b32 v34, v30, 16, v26
    v_lshl_or_b32 v35, v31, 16, v27
    buffer_store_dwordx4 v[32:35], v6, s[20:23], s34 offen
    s_add_u32 s34, s34, 262144
    ds_read_u16 v56, v5 offset:192
    ds_read_u16 v60, v5 offset:18688
    ds_read_u16 v57, v5 offset:4816
    ds_read_u16 v61, v5 offset:23312
    ds_read_u16 v58, v5 offset:9440
    ds_read_u16 v62, v5 offset:27936
    ds_read_u16 v59, v5 offset:14064
    ds_read_u16 v63, v5 offset:32560
    s_waitcnt lgkmcnt(8)
    v_lshl_or_b32 v48, v44, 16, v40
    v_lshl_or_b32 v49, v45, 16, v41
    v_lshl_or_b32 v50, v46, 16, v42
    v_lshl_or_b32 v51, v47, 16, v43
    buffer_store_dwordx4 v[48:51], v6, s[20:23], s34 offen
    s_add_u32 s34, s34, 262144
    ds_read_u16 v8, v5 offset:256
    ds_read_u16 v12, v5 offset:18752
    ds_read_u16 v9, v5 offset:4880
    ds_read_u16 v13, v5 offset:23376
    ds_read_u16 v10, v5 offset:9504
    ds_read_u16 v14, v5 offset:28000
    ds_read_u16 v11, v5 offset:14128
    ds_read_u16 v15, v5 offset:32624
    s_waitcnt lgkmcnt(8)
    v_lshl_or_b32 v64, v60, 16, v56
    v_lshl_or_b32 v65, v61, 16, v57
    v_lshl_or_b32 v66, v62, 16, v58
    v_lshl_or_b32 v67, v63, 16, v59
    buffer_store_dwordx4 v[64:67], v6, s[20:23], s34 offen
    s_add_u32 s34, s34, 262144
    ds_read_u16 v24, v5 offset:320
    ds_read_u16 v28, v5 offset:18816
    ds_read_u16 v25, v5 offset:4944
    ds_read_u16 v29, v5 offset:23440
    ds_read_u16 v26, v5 offset:9568
    ds_read_u16 v30, v5 offset:28064
    ds_read_u16 v27, v5 offset:14192
    ds_read_u16 v31, v5 offset:32688
    s_waitcnt lgkmcnt(8)
    v_lshl_or_b32 v16, v12, 16, v8
    v_lshl_or_b32 v17, v13, 16, v9
    v_lshl_or_b32 v18, v14, 16, v10
    v_lshl_or_b32 v19, v15, 16, v11
    buffer_store_dwordx4 v[16:19], v6, s[20:23], s34 offen
    s_add_u32 s34, s34, 262144
    ds_read_u16 v40, v5 offset:384
    ds_read_u16 v44, v5 offset:18880
    ds_read_u16 v41, v5 offset:5008
    ds_read_u16 v45, v5 offset:23504
    ds_read_u16 v42, v5 offset:9632
    ds_read_u16 v46, v5 offset:28128
    ds_read_u16 v43, v5 offset:14256
    ds_read_u16 v47, v5 offset:32752
    s_waitcnt lgkmcnt(8)
    v_lshl_or_b32 v32, v28, 16, v24
    v_lshl_or_b32 v33, v29, 16, v25
    v_lshl_or_b32 v34, v30, 16, v26
    v_lshl_or_b32 v35, v31, 16, v27
    buffer_store_dwordx4 v[32:35], v6, s[20:23], s34 offen
    s_add_u32 s34, s34, 262144
    ds_read_u16 v56, v5 offset:448
    ds_read_u16 v60, v5 offset:18944
    ds_read_u16 v57, v5 offset:5072
    ds_read_u16 v61, v5 offset:23568
    ds_read_u16 v58, v5 offset:9696
    ds_read_u16 v62, v5 offset:28192
    ds_read_u16 v59, v5 offset:14320
    ds_read_u16 v63, v5 offset:32816
    s_waitcnt lgkmcnt(8)
    v_lshl_or_b32 v48, v44, 16, v40
    v_lshl_or_b32 v49, v45, 16, v41
    v_lshl_or_b32 v50, v46, 16, v42
    v_lshl_or_b32 v51, v47, 16, v43
    buffer_store_dwordx4 v[48:51], v6, s[20:23], s34 offen
    s_add_u32 s34, s34, 262144
    ds_read_u16 v8, v5 offset:512
    ds_read_u16 v12, v5 offset:19008
    ds_read_u16 v9, v5 offset:5136
    ds_read_u16 v13, v5 offset:23632
    ds_read_u16 v10, v5 offset:9760
    ds_read_u16 v14, v5 offset:28256
    ds_read_u16 v11, v5 offset:14384
    ds_read_u16 v15, v5 offset:32880
    s_waitcnt lgkmcnt(8)
    v_lshl_or_b32 v64, v60, 16, v56
    v_lshl_or_b32 v65, v61, 16, v57
    v_lshl_or_b32 v66, v62, 16, v58
    v_lshl_or_b32 v67, v63, 16, v59
    buffer_store_dwordx4 v[64:67], v6, s[20:23], s34 offen
    s_add_u32 s34, s34, 262144
    ds_read_u16 v24, v5 offset:576
    ds_read_u16 v28, v5 offset:19072
    ds_read_u16 v25, v5 offset:5200
    ds_read_u16 v29, v5 offset:23696
    ds_read_u16 v26, v5 offset:9824
    ds_read_u16 v30, v5 offset:28320
    ds_read_u16 v27, v5 offset:14448
    ds_read_u16 v31, v5 offset:32944
    s_waitcnt lgkmcnt(8)
    v_lshl_or_b32 v16, v12, 16, v8
    v_lshl_or_b32 v17, v13, 16, v9
    v_lshl_or_b32 v18, v14, 16, v10
    v_lshl_or_b32 v19, v15, 16, v11
    buffer_store_dwordx4 v[16:19], v6, s[20:23], s34 offen
    s_add_u32 s34, s34, 262144
    s_waitcnt lgkmcnt(0)
    v_lshl_or_b32 v32, v28, 16, v24
    v_lshl_or_b32 v33, v29, 16, v25
    v_lshl_or_b32 v34, v30, 16, v26
    v_lshl_or_b32 v35, v31, 16, v27
    buffer_store_dwordx4 v[32:35], v6, s[20:23], s34 offen
    s_branch p0_end
p0_pf:
    s_sub_u32 s3, s2, 176
    s_cmp_ge_u32 s3, 80
    s_cbranch_scc1 p0_done
    v_and_b32 v1, 63, v0
    v_lshrrev_b32 v2, 6, v0
    s_nop 0
    v_readfirstlane_b32 s4, v2
    s_lshr_b32 s5, s3, 3
    s_lshl_b32 s5, s5, 2
    s_add_u32 s5, s5, s4
    s_and_b32 s3, s2, 7
    s_load_dwordx2 s[8:9], s[0:1], 32
    s_mul_i32 s12, s3, 4617
    s_lshr_b32 s12, s12, 10
    s_lshl_b32 s12, s12, 8
    v_mul_u32_u24 v2, 26, v1
    v_lshrrev_b32 v2, 8, v2
    v_mul_u32_u24 v3, 7936, v2
    v_lshl_add_u32 v2, v1, 7, v3
    s_add_u32 s13, 0, s5
    s_mul_i32 s13, s13, 55296
    s_add_u32 s13, s13, s12
    s_waitcnt lgkmcnt(0)
    s_mov_b32 s10, 0x1200000
    s_mov_b32 s11, 0x20000
    buffer_load_dword v4, v2, s[8:11], s13 offen
    s_add_u32 s13, s13, 2211840
    buffer_load_dword v4, v2, s[8:11], s13 offen
    s_add_u32 s13, s13, 2211840
    buffer_load_dword v4, v2, s[8:11], s13 offen
    s_add_u32 s13, s13, 2211840
p0_end:
    s_mov_b64 exec, -1
p0_done:
    s_endpgm
.globl p1_kernel
.p2align 8
.type p1_kernel,@function
p1_kernel:
    s_cmp_ge_u32 s2, 256
    s_cbranch_scc1 p1_done
    s_load_dwordx2 s[4:5], s[0:1], 96
    s_load_dwordx2 s[6:7], s[0:1], 0
    v_and_b32 v1, 63, v0
    v_lshrrev_b32 v2, 6, v0
    s_nop 0
    v_readfirstlane_b32 s3, v2
    s_and_b32 s24, s2, 7
    s_lshr_b32 s25, s2, 3
    s_and_b32 s26, s25, 3
    s_lshr_b32 s25, s25, 2
    s_lshl_b32 s25, s25, 3
    s_add_u32 s24, s24, s25
    s_and_b32 s25, s24, 3
    s_lshl_b32 s25, s25, 2
    s_add_u32 s26, s26, s25
    s_lshl_b32 s26, s26, 1
    s_lshr_b32 s27, s24, 2
    s_and_b32 s28, s3, 3
    s_lshr_b32 s29, s3, 2
    s_lshl_b32 s30, s27, 2
    s_add_u32 s30, s30, s28
    s_lshl_b32 s30, s30, 5
    s_add_u32 s30, s30, s26
    s_add_u32 s30, s30, s29
    s_mul_i32 s30, s30, 1152
    v_lshlrev_b32 v3, 1, v1
    v_lshlrev_b32 v4, 2, v1
    v_mov_b32 v8, 0
    v_mov_b32 v9, 0
    v_mov_b32 v10, 0
    v_mov_b32 v11, 0
    v_mov_b32 v12, 0
    v_mov_b32 v13, 0
    v_mov_b32 v14, 0
    v_mov_b32 v15, 0
    v_mov_b32 v16, 0
    s_movk_i32 s31, 2304
    s_mov_b32 s32, 0xffff0000
    s_waitcnt lgkmcnt(0)
    s_mov_b32 s8, s6
    s_mov_b32 s9, s7
    s_mov_b32 s10, 0x240000
    s_mov_b32 s11, 0x20000
    s_mov_b32 s12, s4
    s_mov_b32 s13, s5
    s_mov_b32 s14, 0x3600
    s_mov_b32 s15, 0x20000
    s_add_u32 s16, s4, 0x400000
    s_addc_u32 s17, s5, 0
    s_mov_b32 s18, 0x242000
    s_mov_b32 s19, 0x20000
    buffer_load_short_d16_hi v8, v3, s[8:11], s30 offen offset:0
    buffer_load_short_d16_hi v9, v3, s[8:11], s30 offen offset:128
    buffer_load_short_d16_hi v10, v3, s[8:11], s30 offen offset:256
    buffer_load_short_d16_hi v11, v3, s[8:11], s30 offen offset:384
    buffer_load_short_d16_hi v12, v3, s[8:11], s30 offen offset:512
    buffer_load_short_d16_hi v13, v3, s[8:11], s30 offen offset:640
    buffer_load_short_d16_hi v14, v3, s[8:11], s30 offen offset:768
    buffer_load_short_d16_hi v15, v3, s[8:11], s30 offen offset:896
    buffer_load_short_d16_hi v16, v3, s[8:11], s30 offen offset:1024
    buffer_load_dword v30, v4, s[12:15], s31 offen offset:0
    buffer_load_dword v31, v4, s[12:15], s31 offen offset:256
    buffer_load_dword v32, v4, s[12:15], s31 offen offset:512
    buffer_load_dword v33, v4, s[12:15], s31 offen offset:768
    buffer_load_dword v34, v4, s[12:15], s31 offen offset:1024
    buffer_load_dword v35, v4, s[12:15], s31 offen offset:1280
    buffer_load_dword v36, v4, s[12:15], s31 offen offset:1536
    buffer_load_dword v37, v4, s[12:15], s31 offen offset:1792
    buffer_load_dword v38, v4, s[12:15], s31 offen offset:2048
    buffer_load_dword v20, v4, s[12:15], 0 offen offset:0
    buffer_load_dword v21, v4, s[12:15], 0 offen offset:256
    buffer_load_dword v22, v4, s[12:15], 0 offen offset:512
    buffer_load_dword v23, v4, s[12:15], 0 offen offset:768
    buffer_load_dword v24, v4, s[12:15], 0 offen offset:1024
    buffer_load_dword v25, v4, s[12:15], 0 offen offset:1280
    buffer_load_dword v26, v4, s[12:15], 0 offen offset:1536
    buffer_load_dword v27, v4, s[12:15], 0 offen offset:1792
    buffer_load_dword v28, v4, s[12:15], 0 offen offset:2048
    v_and_b32 v5, 15, v1
    v_lshrrev_b32 v6, 4, v1
    s_lshl_b32 s33, s28, 4
    v_add_u32 v7, s33, v5
    v_cvt_f32_u32 v90, v7
    v_cvt_f32_u32 v91, v6
    v_mul_f32 v91, v91, v90
    v_mul_f32 v91, 0x3d800000, v91
    v_fmamk_f32 v80, v90, 0x00000000, v91
    v_cos_f32 v81, v80
    v_sin_f32 v82, v80
    v_fmamk_f32 v83, v90, 0x3c800000, v91
    v_cos_f32 v84, v83
    v_sin_f32 v85, v83
    v_cvt_pk_bf16_f32 v40, v81, v82
    v_cvt_pk_bf16_f32 v56, -v82, v81
    v_fmamk_f32 v80, v90, 0x3d000000, v91
    v_cos_f32 v81, v80
    v_sin_f32 v82, v80
    v_cvt_pk_bf16_f32 v41, v84, v85
    v_cvt_pk_bf16_f32 v57, -v85, v84
    v_fmamk_f32 v83, v90, 0x3d400000, v91
    v_cos_f32 v84, v83
    v_sin_f32 v85, v83
    v_cvt_pk_bf16_f32 v42, v81, v82
    v_cvt_pk_bf16_f32 v58, -v82, v81
    v_fmamk_f32 v80, v90, 0x3e800000, v91
    v_cos_f32 v81, v80
    v_sin_f32 v82, v80
    v_cvt_pk_bf16_f32 v43, v84, v85
    v_cvt_pk_bf16_f32 v59, -v85, v84
    v_fmamk_f32 v83, v90, 0x3e880000, v91
    v_cos_f32 v84, v83
    v_sin_f32 v85, v83
    v_cvt_pk_bf16_f32 v44, v81, v82
    v_cvt_pk_bf16_f32 v60, -v82, v81
    v_fmamk_f32 v80, v90, 0x3e900000, v91
    v_cos_f32 v81, v80
    v_sin_f32 v82, v80
    v_cvt_pk_bf16_f32 v45, v84, v85
    v_cvt_pk_bf16_f32 v61, -v85, v84
    v_fmamk_f32 v83, v90, 0x3e980000, v91
    v_cos_f32 v84, v83
    v_sin_f32 v85, v83
    v_cvt_pk_bf16_f32 v46, v81, v82
    v_cvt_pk_bf16_f32 v62, -v82, v81
    v_fmamk_f32 v80, v90, 0x3f000000, v91
    v_cos_f32 v81, v80
    v_sin_f32 v82, v80
    v_cvt_pk_bf16_f32 v47, v84, v85
    v_cvt_pk_bf16_f32 v63, -v85, v84
    v_fmamk_f32 v83, v90, 0x3f040000, v91
    v_cos_f32 v84, v83
    v_sin_f32 v85, v83
    v_cvt_pk_bf16_f32 v48, v81, v82
    v_cvt_pk_bf16_f32 v64, -v82, v81
    v_fmamk_f32 v80, v90, 0x3f080000, v91
    v_cos_f32 v81, v80
    v_sin_f32 v82, v80
    v_cvt_pk_bf16_f32 v49, v84, v85
    v_cvt_pk_bf16_f32 v65, -v85, v84
    v_fmamk_f32 v83, v90, 0x3f0c0000, v91
    v_cos_f32 v84, v83
    v_sin_f32 v85, v83
    v_cvt_pk_bf16_f32 v50, v81, v82
    v_cvt_pk_bf16_f32 v66, -v82, v81
    v_fmamk_f32 v80, v90, 0x3f400000, v91
    v_cos_f32 v81, v80
    v_sin_f32 v82, v80
    v_cvt_pk_bf16_f32 v51, v84, v85
    v_cvt_pk_bf16_f32 v67, -v85, v84
    v_fmamk_f32 v83, v90, 0x3f440000, v91
    v_cos_f32 v84, v83
    v_sin_f32 v85, v83
    v_cvt_pk_bf16_f32 v52, v81, v82
    v_cvt_pk_bf16_f32 v68, -v82, v81
    v_fmamk_f32 v80, v90, 0x3f480000, v91
    v_cos_f32 v81, v80
    v_sin_f32 v82, v80
    v_cvt_pk_bf16_f32 v53, v84, v85
    v_cvt_pk_bf16_f32 v69, -v85, v84
    v_fmamk_f32 v83, v90, 0x3f4c0000, v91
    v_cos_f32 v84, v83
    v_sin_f32 v85, v83
    v_cvt_pk_bf16_f32 v54, v81, v82
    v_cvt_pk_bf16_f32 v70, -v82, v81
    v_cvt_pk_bf16_f32 v55, v84, v85
    v_cvt_pk_bf16_f32 v71, -v85, v84
    v_cvt_f32_u32 v90, v1
    v_mul_f32 v81, 0x3ae38e39, v90
    v_mul_f32 v82, 0x3b638e39, v90
    v_mul_f32 v83, 0x3baaaaab, v90
    v_mul_f32 v84, 0x3be38e39, v90
    v_cos_f32 v72, v81
    v_sin_f32 v73, v81
    v_cos_f32 v74, v82
    v_sin_f32 v75, v82
    v_cos_f32 v76, v83
    v_sin_f32 v77, v83
    v_cos_f32 v78, v84
    v_sin_f32 v79, v84
    s_lshl_b32 s33, s29, 2
    s_add_u32 s33, s33, s28
    s_mul_i32 s33, s33, 272
    v_add_u32 v100, s33, v4
    s_mul_i32 s33, s29, 8704
    v_mul_u32_u24 v101, 272, v5
    v_lshl_add_u32 v101, v6, 4, v101
    v_add_u32 v101, s33, v101
    s_waitcnt vmcnt(18)
    v_add_f32 v88, v8, v9
    v_add_f32 v88, v88, v10
    v_add_f32 v88, v88, v11
    v_add_f32 v88, v88, v12
    v_add_f32 v88, v88, v13
    v_add_f32 v88, v88, v14
    v_add_f32 v88, v88, v15
    v_add_f32 v88, v88, v16
    s_nop 1
    v_add_f32_dpp v88, v88, v88 quad_perm:[1,0,3,2] row_mask:0xf bank_mask:0xf
    s_nop 1
    v_add_f32_dpp v88, v88, v88 quad_perm:[2,3,0,1] row_mask:0xf bank_mask:0xf
    s_nop 1
    v_add_f32_dpp v88, v88, v88 row_half_mirror row_mask:0xf bank_mask:0xf
    s_nop 1
    v_add_f32_dpp v88, v88, v88 row_mirror row_mask:0xf bank_mask:0xf
    v_mov_b32 v80, v88
    s_nop 1
    v_permlane16_swap_b32 v88, v80
    v_add_f32 v88, v88, v80
    v_mov_b32 v80, v88
    s_nop 1
    v_permlane32_swap_b32 v88, v80
    v_add_f32 v88, v88, v80
    v_mul_f32 v88, 0x3ae38e39, v88
    v_sub_f32 v80, v8, v88
    v_mul_f32 v89, v80, v80
    v_sub_f32 v81, v9, v88
    v_fmac_f32 v89, v81, v81
    v_sub_f32 v80, v10, v88
    v_fmac_f32 v89, v80, v80
    v_sub_f32 v81, v11, v88
    v_fmac_f32 v89, v81, v81
    v_sub_f32 v80, v12, v88
    v_fmac_f32 v89, v80, v80
    v_sub_f32 v81, v13, v88
    v_fmac_f32 v89, v81, v81
    v_sub_f32 v80, v14, v88
    v_fmac_f32 v89, v80, v80
    v_sub_f32 v81, v15, v88
    v_fmac_f32 v89, v81, v81
    v_sub_f32 v80, v16, v88
    v_fmac_f32 v89, v80, v80
    s_nop 1
    v_add_f32_dpp v89, v89, v89 quad_perm:[1,0,3,2] row_mask:0xf bank_mask:0xf
    s_nop 1
    v_add_f32_dpp v89, v89, v89 quad_perm:[2,3,0,1] row_mask:0xf bank_mask:0xf
    s_nop 1
    v_add_f32_dpp v89, v89, v89 row_half_mirror row_mask:0xf bank_mask:0xf
    s_nop 1
    v_add_f32_dpp v89, v89, v89 row_mirror row_mask:0xf bank_mask:0xf
    v_mov_b32 v80, v89
    s_nop 1
    v_permlane16_swap_b32 v89, v80
    v_add_f32 v89, v89, v80
    v_mov_b32 v80, v89
    s_nop 1
    v_permlane32_swap_b32 v89, v80
    v_add_f32 v89, v89, v80
    v_mul_f32 v89, 0x3ae38e39, v89
    v_cvt_pk_bf16_f32 v88, v88, v88
    v_lshlrev_b32 v88, 16, v88
    v_cvt_pk_bf16_f32 v89, v89, v89
    v_lshlrev_b32 v89, 16, v89
    v_add_f32 v89, 0x3727c5ac, v89
    v_cvt_pk_bf16_f32 v89, v89, v89
    v_lshlrev_b32 v89, 16, v89
    v_sqrt_f32 v89, v89
    s_nop 0
    v_cvt_pk_bf16_f32 v89, v89, v89
    v_lshlrev_b32 v89, 16, v89
    v_rcp_f32 v89, v89
    v_sub_f32 v8, v8, v88
    v_sub_f32 v9, v9, v88
    v_sub_f32 v10, v10, v88
    v_sub_f32 v11, v11, v88
    v_sub_f32 v12, v12, v88
    v_sub_f32 v13, v13, v88
    v_sub_f32 v14, v14, v88
    v_sub_f32 v15, v15, v88
    v_sub_f32 v16, v16, v88
    v_cvt_pk_bf16_f32 v80, v8, v9
    v_lshlrev_b32 v8, 16, v80
    v_and_b32 v9, s32, v80
    v_cvt_pk_bf16_f32 v81, v10, v11
    v_lshlrev_b32 v10, 16, v81
    v_and_b32 v11, s32, v81
    v_cvt_pk_bf16_f32 v80, v12, v13
    v_lshlrev_b32 v12, 16, v80
    v_and_b32 v13, s32, v80
    v_cvt_pk_bf16_f32 v81, v14, v15
    v_lshlrev_b32 v14, 16, v81
    v_and_b32 v15, s32, v81
    v_cvt_pk_bf16_f32 v16, v16, v16
    v_lshlrev_b32 v16, 16, v16
    v_mul_f32 v8, v8, v89
    v_mul_f32 v9, v9, v89
    v_mul_f32 v10, v10, v89
    v_mul_f32 v11, v11, v89
    v_mul_f32 v12, v12, v89
    v_mul_f32 v13, v13, v89
    v_mul_f32 v14, v14, v89
    v_mul_f32 v15, v15, v89
    v_mul_f32 v16, v16, v89
    v_cvt_pk_bf16_f32 v80, v8, v9
    v_lshlrev_b32 v8, 16, v80
    v_and_b32 v9, s32, v80
    v_cvt_pk_bf16_f32 v81, v10, v11
    v_lshlrev_b32 v10, 16, v81
    v_and_b32 v11, s32, v81
    v_cvt_pk_bf16_f32 v80, v12, v13
    v_lshlrev_b32 v12, 16, v80
    v_and_b32 v13, s32, v80
    v_cvt_pk_bf16_f32 v81, v14, v15
    v_lshlrev_b32 v14, 16, v81
    v_and_b32 v15, s32, v81
    v_cvt_pk_bf16_f32 v16, v16, v16
    v_lshlrev_b32 v16, 16, v16
    s_waitcnt vmcnt(0)
    s_mul_i32 s54, s3, 32
    s_lshr_b32 s55, s2, 3
    s_add_u32 s54, s54, s55
    s_and_b32 s55, s2, 7
    s_load_dwordx2 s[48:49], s[0:1], 32
    s_mul_i32 s52, s55, 4617
    s_lshr_b32 s52, s52, 10
    s_lshl_b32 s52, s52, 8
    v_mul_u32_u24 v104, 26, v1
    v_lshrrev_b32 v104, 8, v104
    v_mul_u32_u24 v105, 7936, v104
    v_lshl_add_u32 v104, v1, 7, v105
    s_add_u32 s53, 120, s54
    s_mul_i32 s53, s53, 55296
    s_add_u32 s53, s53, s52
    s_waitcnt lgkmcnt(0)
    s_mov_b32 s50, 0x1200000
    s_mov_b32 s51, 0x20000
    s_cmp_lt_u32 s54, 64
    s_cbranch_scc0 pfskip_1
    buffer_load_dword v128, v104, s[48:51], s53 offen
pfskip_1:
    v_mul_f32 v8, v8, v30
    v_mul_f32 v9, v9, v31
    v_mul_f32 v10, v10, v32
    v_mul_f32 v11, v11, v33
    v_mul_f32 v12, v12, v34
    v_mul_f32 v13, v13, v35
    v_mul_f32 v14, v14, v36
    v_mul_f32 v15, v15, v37
    v_mul_f32 v16, v16, v38
    v_cvt_pk_bf16_f32 v80, v8, v9
    v_lshlrev_b32 v8, 16, v80
    v_and_b32 v9, s32, v80
    v_cvt_pk_bf16_f32 v81, v10, v11
    v_lshlrev_b32 v10, 16, v81
    v_and_b32 v11, s32, v81
    v_cvt_pk_bf16_f32 v80, v12, v13
    v_lshlrev_b32 v12, 16, v80
    v_and_b32 v13, s32, v80
    v_cvt_pk_bf16_f32 v81, v14, v15
    v_lshlrev_b32 v14, 16, v81
    v_and_b32 v15, s32, v81
    v_cvt_pk_bf16_f32 v16, v16, v16
    v_lshlrev_b32 v16, 16, v16
    v_add_f32 v8, v8, v20
    v_add_f32 v9, v9, v21
    v_add_f32 v10, v10, v22
    v_add_f32 v11, v11, v23
    v_add_f32 v12, v12, v24
    v_add_f32 v13, v13, v25
    v_add_f32 v14, v14, v26
    v_add_f32 v15, v15, v27
    v_add_f32 v16, v16, v28
    v_cvt_pk_bf16_f32 v80, v8, v9
    v_lshlrev_b32 v8, 16, v80
    v_and_b32 v9, s32, v80
    v_cvt_pk_bf16_f32 v81, v10, v11
    v_lshlrev_b32 v10, 16, v81
    v_and_b32 v11, s32, v81
    v_cvt_pk_bf16_f32 v80, v12, v13
    v_lshlrev_b32 v12, 16, v80
    v_and_b32 v13, s32, v80
    v_cvt_pk_bf16_f32 v81, v14, v15
    v_lshlrev_b32 v14, 16, v81
    v_and_b32 v15, s32, v81
    v_cvt_pk_bf16_f32 v16, v16, v16
    v_lshlrev_b32 v16, 16, v16
    v_add_f32 v20, v9, v16
    v_sub_f32 v24, v9, v16
    v_add_f32 v21, v10, v15
    v_sub_f32 v25, v10, v15
    v_add_f32 v22, v11, v14
    v_sub_f32 v26, v11, v14
    v_add_f32 v23, v12, v13
    v_sub_f32 v27, v12, v13
    v_add_f32 v30, v8, v20
    v_add_f32 v30, v30, v21
    v_add_f32 v30, v30, v22
    v_add_f32 v30, v30, v23
    v_fmamk_f32 v31, v20, 0x3f441b7d, v8
    v_fmamk_f32 v31, v21, 0x3e31d0d4, v31
    v_fmamk_f32 v31, v22, 0xbf000000, v31
    v_fmamk_f32 v31, v23, 0xbf708fb2, v31
    v_mul_f32 v35, 0xbf248dbb, v24
    v_fmamk_f32 v35, v25, 0xbf7c1c5c, v35
    v_fmamk_f32 v35, v26, 0xbf5db3d7, v35
    v_fmamk_f32 v35, v27, 0xbeaf1d44, v35
    v_fmamk_f32 v32, v20, 0x3e31d0d4, v8
    v_fmamk_f32 v32, v21, 0xbf708fb2, v32
    v_fmamk_f32 v32, v22, 0xbf000000, v32
    v_fmamk_f32 v32, v23, 0x3f441b7d, v32
    v_mul_f32 v36, 0xbf7c1c5c, v24
    v_fmamk_f32 v36, v25, 0xbeaf1d44, v36
    v_fmamk_f32 v36, v26, 0x3f5db3d7, v36
    v_fmamk_f32 v36, v27, 0x3f248dbb, v36
    v_fmamk_f32 v33, v20, 0xbf000000, v8
    v_fmamk_f32 v33, v21, 0xbf000000, v33
    v_fmamk_f32 v33, v22, 0x3f800000, v33
    v_fmamk_f32 v33, v23, 0xbf000000, v33
    v_mul_f32 v37, 0xbf5db3d7, v24
    v_fmamk_f32 v37, v25, 0x3f5db3d7, v37
    v_fmamk_f32 v37, v27, 0xbf5db3d7, v37
    v_fmamk_f32 v34, v20, 0xbf708fb2, v8
    v_fmamk_f32 v34, v21, 0x3f441b7d, v34
    v_fmamk_f32 v34, v22, 0xbf000000, v34
    v_fmamk_f32 v34, v23, 0x3e31d0d4, v34
    v_mul_f32 v38, 0xbeaf1d44, v24
    v_fmamk_f32 v38, v25, 0x3f248dbb, v38
    v_fmamk_f32 v38, v26, 0xbf5db3d7, v38
    v_fmamk_f32 v38, v27, 0x3f7c1c5c, v38
    v_cvt_pk_bf16_f32 v8, v30, 0
    v_mul_f32 v80, v31, v72
    v_mul_f32 v81, v35, v72
    v_fmac_f32 v80, v35, v73
    v_fma_f32 v81, -v31, v73, v81
    v_cvt_pk_bf16_f32 v9, v80, v81
    v_mul_f32 v80, v32, v74
    v_mul_f32 v81, v36, v74
    v_fmac_f32 v80, v36, v75
    v_fma_f32 v81, -v32, v75, v81
    v_cvt_pk_bf16_f32 v10, v80, v81
    v_mul_f32 v80, v33, v76
    v_mul_f32 v81, v37, v76
    v_fmac_f32 v80, v37, v77
    v_fma_f32 v81, -v33, v77, v81
    v_cvt_pk_bf16_f32 v11, v80, v81
    v_mul_f32 v80, v34, v78
    v_mul_f32 v81, v38, v78
    v_fmac_f32 v80, v38, v79
    v_fma_f32 v81, -v34, v79, v81
    v_cvt_pk_bf16_f32 v12, v80, v81
    ds_write_b32 v100, v8 offset:0
    ds_write_b32 v100, v9 offset:2176
    ds_write_b32 v100, v10 offset:4352
    ds_write_b32 v100, v11 offset:6528
    ds_write_b32 v100, v12 offset:8704
    s_lshr_b32 s34, s26, 4
    s_lshl_b32 s34, s34, 2
    s_lshr_b32 s35, s27, 2
    s_add_u32 s34, s34, s35
    s_lshl_b32 s34, s34, 6
    s_and_b32 s35, s27, 3
    s_lshl_b32 s35, s35, 4
    s_add_u32 s34, s34, s35
    s_and_b32 s35, s26, 15
    s_add_u32 s34, s34, s35
    s_lshl_b32 s34, s34, 4
    s_cmp_lt_u32 s28, 2
    s_cselect_b32 s35, 1, -1
    s_cselect_b32 s36, 0, 576
    s_cselect_b32 s37, 0, 0x80000000
    s_lshl_b32 s38, s29, 3
    s_add_u32 s38, s38, 0
    v_add_u32 v104, s38, v6
    v_lshrrev_b32 v105, 1, v104
    v_mad_u32_u24 v106, v7, 9, v105
    v_mul_lo_u32 v106, v106, s35
    v_add_u32 v106, s36, v106
    v_and_b32 v107, 1, v104
    v_lshlrev_b32 v102, 13, v106
    v_lshl_add_u32 v102, v107, 4, v102
    v_cmp_lt_u32 vcc, 9, v104
    v_cmp_eq_u32 s[40:41], 0, v105
    v_cmp_lt_u32 s[42:43], 32, v7
    s_nop 0
    s_and_b64 s[40:41], s[40:41], s[42:43]
    s_or_b64 vcc, vcc, s[40:41]
    v_mov_b32 v107, 0x7f000000
    v_cndmask_b32 v102, v102, v107, vcc
    s_lshl_b32 s38, s29, 3
    s_add_u32 s38, s38, 4
    v_add_u32 v104, s38, v6
    v_lshrrev_b32 v105, 1, v104
    v_mad_u32_u24 v106, v7, 9, v105
    v_mul_lo_u32 v106, v106, s35
    v_add_u32 v106, s36, v106
    v_and_b32 v107, 1, v104
    v_lshlrev_b32 v103, 13, v106
    v_lshl_add_u32 v103, v107, 4, v103
    v_cmp_lt_u32 vcc, 9, v104
    v_cmp_eq_u32 s[40:41], 0, v105
    v_cmp_lt_u32 s[42:43], 32, v7
    s_nop 0
    s_and_b64 s[40:41], s[40:41], s[42:43]
    s_or_b64 vcc, vcc, s[40:41]
    v_mov_b32 v107, 0x7f000000
    v_cndmask_b32 v103, v103, v107, vcc
    s_waitcnt lgkmcnt(0)
    s_barrier
    ds_read_b128 v[8:11], v101 offset:0
    ds_read_b128 v[12:15], v101 offset:64
    ds_read_b128 v[16:19], v101 offset:128
    ds_read_b128 v[20:23], v101 offset:192
    s_cmp_eq_u32 s29, 1
    s_cbranch_scc1 p1_one
    ds_read_b128 v[24:27], v101 offset:4352
    ds_read_b128 v[28:31], v101 offset:4416
    ds_read_b128 v[32:35], v101 offset:4480
    ds_read_b128 v[36:39], v101 offset:4544
    s_waitcnt lgkmcnt(3)
    v_mfma_f32_16x16x32_bf16 v[116:119], v[24:27], v[40:43], 0
    v_mfma_f32_16x16x32_bf16 v[120:123], v[24:27], v[56:59], 0
    s_waitcnt lgkmcnt(2)
    v_mfma_f32_16x16x32_bf16 v[116:119], v[28:31], v[44:47], v[116:119]
    v_mfma_f32_16x16x32_bf16 v[120:123], v[28:31], v[60:63], v[120:123]
    s_waitcnt lgkmcnt(1)
    v_mfma_f32_16x16x32_bf16 v[116:119], v[32:35], v[48:51], v[116:119]
    v_mfma_f32_16x16x32_bf16 v[120:123], v[32:35], v[64:67], v[120:123]
    s_waitcnt lgkmcnt(0)
    v_mfma_f32_16x16x32_bf16 v[116:119], v[36:39], v[52:55], v[116:119]
    v_mfma_f32_16x16x32_bf16 v[120:123], v[36:39], v[68:71], v[120:123]
p1_one:
    s_waitcnt lgkmcnt(0)
    v_mfma_f32_16x16x32_bf16 v[108:111], v[8:11], v[40:43], 0
    v_mfma_f32_16x16x32_bf16 v[112:115], v[8:11], v[56:59], 0
    v_mfma_f32_16x16x32_bf16 v[108:111], v[12:15], v[44:47], v[108:111]
    v_mfma_f32_16x16x32_bf16 v[112:115], v[12:15], v[60:63], v[112:115]
    v_mfma_f32_16x16x32_bf16 v[108:111], v[16:19], v[48:51], v[108:111]
    v_mfma_f32_16x16x32_bf16 v[112:115], v[16:19], v[64:67], v[112:115]
    v_mfma_f32_16x16x32_bf16 v[108:111], v[20:23], v[52:55], v[108:111]
    v_mfma_f32_16x16x32_bf16 v[112:115], v[20:23], v[68:71], v[112:115]
    s_cmp_eq_u32 s29, 1
    s_cbranch_scc1 p1_one2
    v_cvt_pk_bf16_f32 v84, v116, v120
    v_xor_b32 v84, s37, v84
    v_cvt_pk_bf16_f32 v85, v117, v121
    v_xor_b32 v85, s37, v85
    v_cvt_pk_bf16_f32 v86, v118, v122
    v_xor_b32 v86, s37, v86
    v_cvt_pk_bf16_f32 v87, v119, v123
    v_xor_b32 v87, s37, v87
    buffer_store_dwordx4 v[84:87], v103, s[16:19], s34 offen
p1_one2:
    s_nop 5
    v_cvt_pk_bf16_f32 v80, v108, v112
    v_xor_b32 v80, s37, v80
    v_cvt_pk_bf16_f32 v81, v109, v113
    v_xor_b32 v81, s37, v81
    v_cvt_pk_bf16_f32 v82, v110, v114
    v_xor_b32 v82, s37, v82
    v_cvt_pk_bf16_f32 v83, v111, v115
    v_xor_b32 v83, s37, v83
    buffer_store_dwordx4 v[80:83], v102, s[16:19], s34 offen
p1_done:
    s_endpgm
.globl p2_kernel
.p2align 8
.type p2_kernel,@function
p2_kernel:
    s_cmp_ge_u32 s2, 289
    s_cbranch_scc1 p2_done
    s_load_dwordx2 s[4:5], s[0:1], 96
    v_and_b32 v1, 63, v0
    v_lshrrev_b32 v2, 6, v0
    s_nop 0
    v_readfirstlane_b32 s3, v2
    v_lshlrev_b32 v3, 4, v1
    s_lshl_b32 s24, s2, 13
    s_add_u32 s25, s24, 4096
    s_lshl_b32 s26, s3, 11
    s_add_u32 s26, s26, s24
    s_mov_b32 s32, 0xffff0000
    s_waitcnt lgkmcnt(0)
    s_add_u32 s8, s4, 0x400000
    s_addc_u32 s9, s5, 0
    s_mov_b32 s10, 0x242000
    s_mov_b32 s11, 0x20000
    s_add_u32 s12, s4, 0x100000
    s_addc_u32 s13, s5, 0
    s_mov_b32 s14, 0x242000
    s_mov_b32 s15, 0x20000
    s_add_u32 s16, s4, 0x700000
    s_addc_u32 s17, s5, 0
    s_mov_b32 s18, 0x242000
    s_mov_b32 s19, 0x20000
    buffer_load_dwordx4 v[8:11], v3, s[8:11], s24 offen offset:0
    buffer_load_dwordx4 v[12:15], v3, s[8:11], s24 offen offset:1024
    buffer_load_dwordx4 v[16:19], v3, s[8:11], s24 offen offset:2048
    buffer_load_dwordx4 v[20:23], v3, s[8:11], s24 offen offset:3072
    buffer_load_dwordx4 v[24:27], v3, s[8:11], s25 offen offset:0
    buffer_load_dwordx4 v[28:31], v3, s[8:11], s25 offen offset:1024
    buffer_load_dwordx4 v[32:35], v3, s[8:11], s25 offen offset:2048
    buffer_load_dwordx4 v[36:39], v3, s[8:11], s25 offen offset:3072
    buffer_load_dwordx4 v[40:43], v3, s[12:15], s26 offen offset:0
    buffer_load_dwordx4 v[44:47], v3, s[12:15], s26 offen offset:1024
    v_and_b32 v5, 15, v1
    v_lshrrev_b32 v6, 4, v1
    s_lshl_b32 s33, s3, 4
    v_add_u32 v7, s33, v5
    v_cvt_f32_u32 v164, v7
    v_cvt_f32_u32 v165, v6
    v_mul_f32 v166, v165, v164
    v_mul_f32 v166, 0x3d800000, v166
    v_fmamk_f32 v152, v164, 0x00000000, v166
    v_cos_f32 v153, v152
    v_sin_f32 v154, v152
    v_fmamk_f32 v155, v164, 0x3c800000, v166
    v_cos_f32 v156, v155
    v_sin_f32 v157, v155
    v_cvt_pk_bf16_f32 v48, v153, v154
    v_cvt_pk_bf16_f32 v64, -v154, v153
    v_fmamk_f32 v152, v164, 0x3d000000, v166
    v_cos_f32 v153, v152
    v_sin_f32 v154, v152
    v_cvt_pk_bf16_f32 v49, v156, v157
    v_cvt_pk_bf16_f32 v65, -v157, v156
    v_fmamk_f32 v155, v164, 0x3d400000, v166
    v_cos_f32 v156, v155
    v_sin_f32 v157, v155
    v_cvt_pk_bf16_f32 v50, v153, v154
    v_cvt_pk_bf16_f32 v66, -v154, v153
    v_fmamk_f32 v152, v164, 0x3e800000, v166
    v_cos_f32 v153, v152
    v_sin_f32 v154, v152
    v_cvt_pk_bf16_f32 v51, v156, v157
    v_cvt_pk_bf16_f32 v67, -v157, v156
    v_fmamk_f32 v155, v164, 0x3e880000, v166
    v_cos_f32 v156, v155
    v_sin_f32 v157, v155
    v_cvt_pk_bf16_f32 v52, v153, v154
    v_cvt_pk_bf16_f32 v68, -v154, v153
    v_fmamk_f32 v152, v164, 0x3e900000, v166
    v_cos_f32 v153, v152
    v_sin_f32 v154, v152
    v_cvt_pk_bf16_f32 v53, v156, v157
    v_cvt_pk_bf16_f32 v69, -v157, v156
    v_fmamk_f32 v155, v164, 0x3e980000, v166
    v_cos_f32 v156, v155
    v_sin_f32 v157, v155
    v_cvt_pk_bf16_f32 v54, v153, v154
    v_cvt_pk_bf16_f32 v70, -v154, v153
    v_fmamk_f32 v152, v164, 0x3f000000, v166
    v_cos_f32 v153, v152
    v_sin_f32 v154, v152
    v_cvt_pk_bf16_f32 v55, v156, v157
    v_cvt_pk_bf16_f32 v71, -v157, v156
    v_fmamk_f32 v155, v164, 0x3f040000, v166
    v_cos_f32 v156, v155
    v_sin_f32 v157, v155
    v_cvt_pk_bf16_f32 v56, v153, v154
    v_cvt_pk_bf16_f32 v72, -v154, v153
    v_fmamk_f32 v152, v164, 0x3f080000, v166
    v_cos_f32 v153, v152
    v_sin_f32 v154, v152
    v_cvt_pk_bf16_f32 v57, v156, v157
    v_cvt_pk_bf16_f32 v73, -v157, v156
    v_fmamk_f32 v155, v164, 0x3f0c0000, v166
    v_cos_f32 v156, v155
    v_sin_f32 v157, v155
    v_cvt_pk_bf16_f32 v58, v153, v154
    v_cvt_pk_bf16_f32 v74, -v154, v153
    v_fmamk_f32 v152, v164, 0x3f400000, v166
    v_cos_f32 v153, v152
    v_sin_f32 v154, v152
    v_cvt_pk_bf16_f32 v59, v156, v157
    v_cvt_pk_bf16_f32 v75, -v157, v156
    v_fmamk_f32 v155, v164, 0x3f440000, v166
    v_cos_f32 v156, v155
    v_sin_f32 v157, v155
    v_cvt_pk_bf16_f32 v60, v153, v154
    v_cvt_pk_bf16_f32 v76, -v154, v153
    v_fmamk_f32 v152, v164, 0x3f480000, v166
    v_cos_f32 v153, v152
    v_sin_f32 v154, v152
    v_cvt_pk_bf16_f32 v61, v156, v157
    v_cvt_pk_bf16_f32 v77, -v157, v156
    v_fmamk_f32 v155, v164, 0x3f4c0000, v166
    v_cos_f32 v156, v155
    v_sin_f32 v157, v155
    v_cvt_pk_bf16_f32 v62, v153, v154
    v_cvt_pk_bf16_f32 v78, -v154, v153
    v_cvt_pk_bf16_f32 v63, v156, v157
    v_cvt_pk_bf16_f32 v79, -v157, v156
    v_mul_f32 v166, 0x3d000000, v166
    v_fmamk_f32 v152, v164, 0x00000000, v166
    v_fmamk_f32 v153, v164, 0x3a000000, v166
    v_fmamk_f32 v154, v164, 0x3a800000, v166
    v_fmamk_f32 v155, v164, 0x3ac00000, v166
    v_cos_f32 v112, v152
    v_sin_f32 v113, v152
    v_cos_f32 v114, v153
    v_sin_f32 v115, v153
    v_cos_f32 v116, v154
    v_sin_f32 v117, v154
    v_cos_f32 v118, v155
    v_sin_f32 v119, v155
    v_fmamk_f32 v152, v164, 0x3c000000, v166
    v_fmamk_f32 v153, v164, 0x3c080000, v166
    v_fmamk_f32 v154, v164, 0x3c100000, v166
    v_fmamk_f32 v155, v164, 0x3c180000, v166
    v_cos_f32 v120, v152
    v_sin_f32 v121, v152
    v_cos_f32 v122, v153
    v_sin_f32 v123, v153
    v_cos_f32 v124, v154
    v_sin_f32 v125, v154
    v_cos_f32 v126, v155
    v_sin_f32 v127, v155
    v_add_u32 v164, 0, v5
    v_cvt_f32_u32 v164, v164
    v_mul_f32 v166, v165, v164
    v_mul_f32 v166, 0x3e000000, v166
    v_fmamk_f32 v152, v164, 0x00000000, v166
    v_fmamk_f32 v153, v164, 0x3d000000, v166
    v_fmamk_f32 v154, v164, 0x3d800000, v166
    v_fmamk_f32 v155, v164, 0x3dc00000, v166
    v_cos_f32 v156, v152
    v_sin_f32 v160, v152
    v_cos_f32 v157, v153
    v_sin_f32 v161, v153
    v_cos_f32 v158, v154
    v_sin_f32 v162, v154
    v_cos_f32 v159, v155
    v_sin_f32 v163, v155
    v_cvt_pk_bf16_f32 v80, v156, v157
    v_cvt_pk_bf16_f32 v81, v158, v159
    v_cvt_pk_bf16_f32 v98, v156, v157
    v_cvt_pk_bf16_f32 v99, v158, v159
    v_cvt_pk_bf16_f32 v82, v160, v161
    v_cvt_pk_bf16_f32 v83, v162, v163
    v_cvt_pk_bf16_f32 v96, -v160, -v161
    v_cvt_pk_bf16_f32 v97, -v162, -v163
    v_fmamk_f32 v152, v164, 0x3f000000, v166
    v_fmamk_f32 v153, v164, 0x3f080000, v166
    v_fmamk_f32 v154, v164, 0x3f100000, v166
    v_fmamk_f32 v155, v164, 0x3f180000, v166
    v_cos_f32 v156, v152
    v_sin_f32 v160, v152
    v_cos_f32 v157, v153
    v_sin_f32 v161, v153
    v_cos_f32 v158, v154
    v_sin_f32 v162, v154
    v_cos_f32 v159, v155
    v_sin_f32 v163, v155
    v_cvt_pk_bf16_f32 v84, v156, v157
    v_cvt_pk_bf16_f32 v85, v158, v159
    v_cvt_pk_bf16_f32 v102, v156, v157
    v_cvt_pk_bf16_f32 v103, v158, v159
    v_cvt_pk_bf16_f32 v86, v160, v161
    v_cvt_pk_bf16_f32 v87, v162, v163
    v_cvt_pk_bf16_f32 v100, -v160, -v161
    v_cvt_pk_bf16_f32 v101, -v162, -v163
    v_add_u32 v164, 16, v5
    v_cvt_f32_u32 v164, v164
    v_mul_f32 v166, v165, v164
    v_mul_f32 v166, 0x3e000000, v166
    v_fmamk_f32 v152, v164, 0x00000000, v166
    v_fmamk_f32 v153, v164, 0x3d000000, v166
    v_fmamk_f32 v154, v164, 0x3d800000, v166
    v_fmamk_f32 v155, v164, 0x3dc00000, v166
    v_cos_f32 v156, v152
    v_sin_f32 v160, v152
    v_cos_f32 v157, v153
    v_sin_f32 v161, v153
    v_cos_f32 v158, v154
    v_sin_f32 v162, v154
    v_cos_f32 v159, v155
    v_sin_f32 v163, v155
    v_cvt_pk_bf16_f32 v88, v156, v157
    v_cvt_pk_bf16_f32 v89, v158, v159
    v_cvt_pk_bf16_f32 v106, v156, v157
    v_cvt_pk_bf16_f32 v107, v158, v159
    v_cvt_pk_bf16_f32 v90, v160, v161
    v_cvt_pk_bf16_f32 v91, v162, v163
    v_cvt_pk_bf16_f32 v104, -v160, -v161
    v_cvt_pk_bf16_f32 v105, -v162, -v163
    v_fmamk_f32 v152, v164, 0x3f000000, v166
    v_fmamk_f32 v153, v164, 0x3f080000, v166
    v_fmamk_f32 v154, v164, 0x3f100000, v166
    v_fmamk_f32 v155, v164, 0x3f180000, v166
    v_cos_f32 v156, v152
    v_sin_f32 v160, v152
    v_cos_f32 v157, v153
    v_sin_f32 v161, v153
    v_cos_f32 v158, v154
    v_sin_f32 v162, v154
    v_cos_f32 v159, v155
    v_sin_f32 v163, v155
    v_cvt_pk_bf16_f32 v92, v156, v157
    v_cvt_pk_bf16_f32 v93, v158, v159
    v_cvt_pk_bf16_f32 v110, v156, v157
    v_cvt_pk_bf16_f32 v111, v158, v159
    v_cvt_pk_bf16_f32 v94, v160, v161
    v_cvt_pk_bf16_f32 v95, v162, v163
    v_cvt_pk_bf16_f32 v108, -v160, -v161
    v_cvt_pk_bf16_f32 v109, -v162, -v163
    v_mul_u32_u24 v4, 1088, v6
    v_lshl_add_u32 v4, v7, 2, v4
    v_mul_u32_u24 v2, 272, v5
    v_lshl_add_u32 v2, v6, 4, v2
    v_lshlrev_b32 v1, 7, v7
    v_lshl_add_u32 v1, v6, 4, v1
    s_waitcnt vmcnt(2)
    v_mfma_f32_16x16x32_bf16 v[128:131], v[8:11], v[48:51], 0
    v_mfma_f32_16x16x32_bf16 v[132:135], v[8:11], v[64:67], 0
    v_mfma_f32_16x16x32_bf16 v[136:139], v[24:27], v[48:51], 0
    v_mfma_f32_16x16x32_bf16 v[140:143], v[24:27], v[64:67], 0
    v_mfma_f32_16x16x32_bf16 v[128:131], v[12:15], v[52:55], v[128:131]
    v_mfma_f32_16x16x32_bf16 v[132:135], v[12:15], v[68:71], v[132:135]
    v_mfma_f32_16x16x32_bf16 v[136:139], v[28:31], v[52:55], v[136:139]
    v_mfma_f32_16x16x32_bf16 v[140:143], v[28:31], v[68:71], v[140:143]
    v_mfma_f32_16x16x32_bf16 v[128:131], v[16:19], v[56:59], v[128:131]
    v_mfma_f32_16x16x32_bf16 v[132:135], v[16:19], v[72:75], v[132:135]
    v_mfma_f32_16x16x32_bf16 v[136:139], v[32:35], v[56:59], v[136:139]
    v_mfma_f32_16x16x32_bf16 v[140:143], v[32:35], v[72:75], v[140:143]
    v_mfma_f32_16x16x32_bf16 v[128:131], v[20:23], v[60:63], v[128:131]
    v_mfma_f32_16x16x32_bf16 v[132:135], v[20:23], v[76:79], v[132:135]
    v_mfma_f32_16x16x32_bf16 v[136:139], v[36:39], v[60:63], v[136:139]
    v_mfma_f32_16x16x32_bf16 v[140:143], v[36:39], v[76:79], v[140:143]
    s_nop 4
    v_mul_f32 v152, v128, v112
    v_mul_f32 v153, v132, v112
    v_fmac_f32 v152, v132, v113
    v_fma_f32 v153, -v128, v113, v153
    v_mul_f32 v154, v129, v114
    v_mul_f32 v155, v133, v114
    v_fmac_f32 v154, v133, v115
    v_fma_f32 v155, -v129, v115, v155
    v_mul_f32 v156, v130, v116
    v_mul_f32 v157, v134, v116
    v_fmac_f32 v156, v134, v117
    v_fma_f32 v157, -v130, v117, v157
    v_mul_f32 v158, v131, v118
    v_mul_f32 v159, v135, v118
    v_fmac_f32 v158, v135, v119
    v_fma_f32 v159, -v131, v119, v159
    v_cvt_pk_bf16_f32 v144, v152, v154
    v_cvt_pk_bf16_f32 v145, v156, v158
    v_cvt_pk_bf16_f32 v146, v153, v155
    v_cvt_pk_bf16_f32 v147, v157, v159
    v_mul_f32 v152, v136, v120
    v_mul_f32 v153, v140, v120
    v_fmac_f32 v152, v140, v121
    v_fma_f32 v153, -v136, v121, v153
    v_mul_f32 v154, v137, v122
    v_mul_f32 v155, v141, v122
    v_fmac_f32 v154, v141, v123
    v_fma_f32 v155, -v137, v123, v155
    v_mul_f32 v156, v138, v124
    v_mul_f32 v157, v142, v124
    v_fmac_f32 v156, v142, v125
    v_fma_f32 v157, -v138, v125, v157
    v_mul_f32 v158, v139, v126
    v_mul_f32 v159, v143, v126
    v_fmac_f32 v158, v143, v127
    v_fma_f32 v159, -v139, v127, v159
    v_cvt_pk_bf16_f32 v148, v152, v154
    v_cvt_pk_bf16_f32 v149, v156, v158
    v_cvt_pk_bf16_f32 v150, v153, v155
    v_cvt_pk_bf16_f32 v151, v157, v159
    v_mfma_f32_16x16x32_bf16 v[128:131], v[80:83], v[144:147], 0
    v_mfma_f32_16x16x32_bf16 v[132:135], v[96:99], v[144:147], 0
    v_mfma_f32_16x16x32_bf16 v[136:139], v[88:91], v[144:147], 0
    v_mfma_f32_16x16x32_bf16 v[140:143], v[104:107], v[144:147], 0
    v_mfma_f32_16x16x32_bf16 v[128:131], v[84:87], v[148:151], v[128:131]
    v_mfma_f32_16x16x32_bf16 v[132:135], v[100:103], v[148:151], v[132:135]
    v_mfma_f32_16x16x32_bf16 v[136:139], v[92:95], v[148:151], v[136:139]
    v_mfma_f32_16x16x32_bf16 v[140:143], v[108:111], v[148:151], v[140:143]
    s_waitcnt vmcnt(0)
    v_and_b32 v1, 63, v0
    s_mul_i32 s54, s3, 36
    s_lshr_b32 s55, s2, 3
    s_add_u32 s54, s54, s55
    s_and_b32 s55, s2, 7
    s_load_dwordx2 s[48:49], s[0:1], 32
    s_mul_i32 s52, s55, 4617
    s_lshr_b32 s52, s52, 10
    s_lshl_b32 s52, s52, 8
    v_mul_u32_u24 v162, 26, v1
    v_lshrrev_b32 v162, 8, v162
    v_mul_u32_u24 v163, 7936, v162
    v_lshl_add_u32 v162, v1, 7, v163
    s_add_u32 s53, 184, s54
    s_mul_i32 s53, s53, 55296
    s_add_u32 s53, s53, s52
    s_waitcnt lgkmcnt(0)
    s_mov_b32 s50, 0x1200000
    s_mov_b32 s51, 0x20000
    s_cmp_lt_u32 s54, 72
    s_cbranch_scc0 pfskip_2
    buffer_load_dword v168, v162, s[48:51], s53 offen
pfskip_2:
    v_lshlrev_b32 v1, 7, v7
    v_lshl_add_u32 v1, v6, 4, v1
    v_lshlrev_b32 v160, 16, v40
    v_and_b32 v161, s32, v40
    v_mul_f32 v152, v128, v160
    v_mul_f32 v153, -v132, v160
    v_fma_f32 v152, -v132, v161, v152
    v_fma_f32 v153, -v128, v161, v153
    v_lshlrev_b32 v160, 16, v41
    v_and_b32 v161, s32, v41
    v_mul_f32 v154, v129, v160
    v_mul_f32 v155, -v133, v160
    v_fma_f32 v154, -v133, v161, v154
    v_fma_f32 v155, -v129, v161, v155
    v_lshlrev_b32 v160, 16, v42
    v_and_b32 v161, s32, v42
    v_mul_f32 v156, v130, v160
    v_mul_f32 v157, -v134, v160
    v_fma_f32 v156, -v134, v161, v156
    v_fma_f32 v157, -v130, v161, v157
    v_lshlrev_b32 v160, 16, v43
    v_and_b32 v161, s32, v43
    v_mul_f32 v158, v131, v160
    v_mul_f32 v159, -v135, v160
    v_fma_f32 v158, -v135, v161, v158
    v_fma_f32 v159, -v131, v161, v159
    v_cvt_pk_bf16_f32 v144, v152, v154
    v_cvt_pk_bf16_f32 v145, v156, v158
    v_cvt_pk_bf16_f32 v146, v153, v155
    v_cvt_pk_bf16_f32 v147, v157, v159
    v_lshlrev_b32 v160, 16, v44
    v_and_b32 v161, s32, v44
    v_mul_f32 v152, v136, v160
    v_mul_f32 v153, -v140, v160
    v_fma_f32 v152, -v140, v161, v152
    v_fma_f32 v153, -v136, v161, v153
    v_lshlrev_b32 v160, 16, v45
    v_and_b32 v161, s32, v45
    v_mul_f32 v154, v137, v160
    v_mul_f32 v155, -v141, v160
    v_fma_f32 v154, -v141, v161, v154
    v_fma_f32 v155, -v137, v161, v155
    v_lshlrev_b32 v160, 16, v46
    v_and_b32 v161, s32, v46
    v_mul_f32 v156, v138, v160
    v_mul_f32 v157, -v142, v160
    v_fma_f32 v156, -v142, v161, v156
    v_fma_f32 v157, -v138, v161, v157
    v_lshlrev_b32 v160, 16, v47
    v_and_b32 v161, s32, v47
    v_mul_f32 v158, v139, v160
    v_mul_f32 v159, -v143, v160
    v_fma_f32 v158, -v143, v161, v158
    v_fma_f32 v159, -v139, v161, v159
    v_cvt_pk_bf16_f32 v148, v152, v154
    v_cvt_pk_bf16_f32 v149, v156, v158
    v_cvt_pk_bf16_f32 v150, v153, v155
    v_cvt_pk_bf16_f32 v151, v157, v159
    v_mfma_f32_16x16x32_bf16 v[128:131], v[80:83], v[144:147], 0
    v_mfma_f32_16x16x32_bf16 v[132:135], v[96:99], v[144:147], 0
    v_mfma_f32_16x16x32_bf16 v[136:139], v[88:91], v[144:147], 0
    v_mfma_f32_16x16x32_bf16 v[140:143], v[104:107], v[144:147], 0
    v_mfma_f32_16x16x32_bf16 v[128:131], v[84:87], v[148:151], v[128:131]
    v_mfma_f32_16x16x32_bf16 v[132:135], v[100:103], v[148:151], v[132:135]
    v_mfma_f32_16x16x32_bf16 v[136:139], v[92:95], v[148:151], v[136:139]
    v_mfma_f32_16x16x32_bf16 v[140:143], v[108:111], v[148:151], v[140:143]
    s_nop 4
    v_mul_f32 v152, v128, v112
    v_mul_f32 v153, v132, v112
    v_fmac_f32 v152, v132, v113
    v_fma_f32 v153, -v128, v113, v153
    v_cvt_pk_bf16_f32 v156, v152, v153
    ds_write_b32 v4, v156 offset:0
    v_mul_f32 v154, v129, v114
    v_mul_f32 v155, v133, v114
    v_fmac_f32 v154, v133, v115
    v_fma_f32 v155, -v129, v115, v155
    v_cvt_pk_bf16_f32 v157, v154, v155
    ds_write_b32 v4, v157 offset:272
    v_mul_f32 v152, v130, v116
    v_mul_f32 v153, v134, v116
    v_fmac_f32 v152, v134, v117
    v_fma_f32 v153, -v130, v117, v153
    v_cvt_pk_bf16_f32 v158, v152, v153
    ds_write_b32 v4, v158 offset:544
    v_mul_f32 v154, v131, v118
    v_mul_f32 v155, v135, v118
    v_fmac_f32 v154, v135, v119
    v_fma_f32 v155, -v131, v119, v155
    v_cvt_pk_bf16_f32 v159, v154, v155
    ds_write_b32 v4, v159 offset:816
    v_mul_f32 v152, v136, v120
    v_mul_f32 v153, v140, v120
    v_fmac_f32 v152, v140, v121
    v_fma_f32 v153, -v136, v121, v153
    v_cvt_pk_bf16_f32 v156, v152, v153
    ds_write_b32 v4, v156 offset:4352
    v_mul_f32 v154, v137, v122
    v_mul_f32 v155, v141, v122
    v_fmac_f32 v154, v141, v123
    v_fma_f32 v155, -v137, v123, v155
    v_cvt_pk_bf16_f32 v157, v154, v155
    ds_write_b32 v4, v157 offset:4624
    v_mul_f32 v152, v138, v124
    v_mul_f32 v153, v142, v124
    v_fmac_f32 v152, v142, v125
    v_fma_f32 v153, -v138, v125, v153
    v_cvt_pk_bf16_f32 v158, v152, v153
    ds_write_b32 v4, v158 offset:4896
    v_mul_f32 v154, v139, v126
    v_mul_f32 v155, v143, v126
    v_fmac_f32 v154, v143, v127
    v_fma_f32 v155, -v139, v127, v155
    v_cvt_pk_bf16_f32 v159, v154, v155
    ds_write_b32 v4, v159 offset:5168
    s_waitcnt lgkmcnt(0)
    s_barrier
    ds_read_b128 v[8:11], v2 offset:0
    ds_read_b128 v[24:27], v2 offset:4352
    ds_read_b128 v[12:15], v2 offset:64
    ds_read_b128 v[28:31], v2 offset:4416
    ds_read_b128 v[16:19], v2 offset:128
    ds_read_b128 v[32:35], v2 offset:4480
    ds_read_b128 v[20:23], v2 offset:192
    ds_read_b128 v[36:39], v2 offset:4544
    s_waitcnt lgkmcnt(0)
    v_mfma_f32_16x16x32_bf16 v[128:131], v[8:11], v[48:51], 0
    v_mfma_f32_16x16x32_bf16 v[132:135], v[8:11], v[64:67], 0
    v_mfma_f32_16x16x32_bf16 v[136:139], v[24:27], v[48:51], 0
    v_mfma_f32_16x16x32_bf16 v[140:143], v[24:27], v[64:67], 0
    v_mfma_f32_16x16x32_bf16 v[128:131], v[12:15], v[52:55], v[128:131]
    v_mfma_f32_16x16x32_bf16 v[132:135], v[12:15], v[68:71], v[132:135]
    v_mfma_f32_16x16x32_bf16 v[136:139], v[28:31], v[52:55], v[136:139]
    v_mfma_f32_16x16x32_bf16 v[140:143], v[28:31], v[68:71], v[140:143]
    v_mfma_f32_16x16x32_bf16 v[128:131], v[16:19], v[56:59], v[128:131]
    v_mfma_f32_16x16x32_bf16 v[132:135], v[16:19], v[72:75], v[132:135]
    v_mfma_f32_16x16x32_bf16 v[136:139], v[32:35], v[56:59], v[136:139]
    v_mfma_f32_16x16x32_bf16 v[140:143], v[32:35], v[72:75], v[140:143]
    v_mfma_f32_16x16x32_bf16 v[128:131], v[20:23], v[60:63], v[128:131]
    v_mfma_f32_16x16x32_bf16 v[132:135], v[20:23], v[76:79], v[132:135]
    v_mfma_f32_16x16x32_bf16 v[136:139], v[36:39], v[60:63], v[136:139]
    v_mfma_f32_16x16x32_bf16 v[140:143], v[36:39], v[76:79], v[140:143]
    s_nop 4
    v_cvt_pk_bf16_f32 v152, v128, v129
    v_cvt_pk_bf16_f32 v153, v130, v131
    v_cvt_pk_bf16_f32 v154, v132, v133
    v_cvt_pk_bf16_f32 v155, v134, v135
    buffer_store_dwordx4 v[152:155], v1, s[16:19], s24 offen offset:0
    v_cvt_pk_bf16_f32 v156, v136, v137
    v_cvt_pk_bf16_f32 v157, v138, v139
    v_cvt_pk_bf16_f32 v158, v140, v141
    v_cvt_pk_bf16_f32 v159, v142, v143
    buffer_store_dwordx4 v[156:159], v1, s[16:19], s24 offen offset:64
p2_done:
    s_endpgm
.globl p3_kernel
.p2align 8
.type p3_kernel,@function
p3_kernel:
    s_cmp_ge_u32 s2, 256
    s_cbranch_scc1 p3_done
    s_load_dwordx2 s[4:5], s[0:1], 96
    s_load_dwordx2 s[6:7], s[0:1], 0
    v_and_b32 v1, 63, v0
    v_lshrrev_b32 v2, 6, v0
    s_nop 0
    v_readfirstlane_b32 s3, v2
    s_and_b32 s24, s2, 7
    s_lshr_b32 s25, s2, 3
    s_and_b32 s26, s25, 3
    s_lshr_b32 s25, s25, 2
    s_lshl_b32 s25, s25, 3
    s_add_u32 s24, s24, s25
    s_lshl_b32 s24, s24, 2
    s_add_u32 s24, s24, s26
    s_and_b32 s28, s3, 3
    s_lshr_b32 s29, s3, 2
    v_and_b32 v5, 15, v1
    v_lshrrev_b32 v6, 4, v1
    s_lshl_b32 s33, s28, 4
    v_add_u32 v7, s33, v5
    v_and_b32 v2, 1, v1
    v_lshrrev_b32 v3, 1, v1
    s_and_b32 s34, s3, 1
    s_lshl_b32 s35, s34, 5
    v_add_u32 v3, s35, v3
    s_cmp_eq_u32 s34, 0
    s_cselect_b32 s35, 1, -1
    s_cselect_b32 s36, 0, 576
    s_lshr_b32 s37, s3, 1
    v_mad_u32_u24 v92, v3, 9, s37
    v_mul_lo_u32 v92, v92, s35
    v_add_u32 v92, s36, v92
    v_lshlrev_b32 v92, 13, v92
    v_lshl_add_u32 v92, v2, 4, v92
    s_lshl_b32 s38, s24, 5
    s_lshl_b32 s39, s35, 15
    v_add_u32 v93, s39, v92
    v_mul_u32_u24 v94, 5760, v2
    v_lshl_add_u32 v94, v3, 3, v94
    s_mul_i32 s39, s37, 576
    v_add_u32 v94, s39, v94
    v_mul_u32_u24 v3, 1152, v6
    v_lshl_add_u32 v3, v7, 1, v3
    s_lshl_b32 s30, s24, 1
    s_add_u32 s30, s30, s29
    s_mul_i32 s30, s30, 4608
    v_lshlrev_b32 v4, 2, v7
    v_mov_b32 v8, 0
    v_mov_b32 v9, 0
    v_mov_b32 v10, 0
    v_mov_b32 v11, 0
    v_mov_b32 v12, 0
    v_mov_b32 v13, 0
    v_mov_b32 v14, 0
    v_mov_b32 v15, 0
    v_mov_b32 v16, 0
    s_movk_i32 s40, 4608
    s_movk_i32 s41, 6912
    s_movk_i32 s42, 9216
    s_mov_b32 s32, 0xffff0000
    s_waitcnt lgkmcnt(0)
    s_mov_b32 s8, s6
    s_mov_b32 s9, s7
    s_mov_b32 s10, 0x240000
    s_mov_b32 s11, 0x20000
    s_mov_b32 s12, s4
    s_mov_b32 s13, s5
    s_mov_b32 s14, 0x3600
    s_mov_b32 s15, 0x20000
    s_add_u32 s16, s4, 0x700000
    s_addc_u32 s17, s5, 0
    s_mov_b32 s18, 0x242000
    s_mov_b32 s19, 0x20000
    s_add_u32 s20, s4, 0xa00000
    s_addc_u32 s21, s5, 0
    s_mov_b32 s22, 0x240000
    s_mov_b32 s23, 0x20000
    s_add_u32 s44, s4, 0xd00000
    s_addc_u32 s45, s5, 0
    s_mov_b32 s46, 0x240000
    s_mov_b32 s47, 0x20000
    buffer_load_dwordx4 v[44:47], v92, s[16:19], s38 offen
    s_cmp_lt_u32 s3, 2
    s_cbranch_scc0 p3_noz2
    buffer_load_dwordx4 v[48:51], v93, s[16:19], s38 offen
p3_noz2:
    buffer_load_short_d16_hi v8, v3, s[8:11], s30 offen offset:0
    buffer_load_short_d16_hi v9, v3, s[8:11], s30 offen offset:128
    buffer_load_short_d16_hi v10, v3, s[8:11], s30 offen offset:256
    buffer_load_short_d16_hi v11, v3, s[8:11], s30 offen offset:384
    buffer_load_short_d16_hi v12, v3, s[8:11], s30 offen offset:512
    buffer_load_short_d16_hi v13, v3, s[8:11], s30 offen offset:640
    buffer_load_short_d16_hi v14, v3, s[8:11], s30 offen offset:768
    buffer_load_short_d16_hi v15, v3, s[8:11], s30 offen offset:896
    buffer_load_short_d16_hi v16, v3, s[8:11], s30 offen offset:1024
    buffer_load_dword v17, v4, s[12:15], s40 offen offset:0
    buffer_load_dword v18, v4, s[12:15], s40 offen offset:256
    buffer_load_dword v19, v4, s[12:15], s40 offen offset:512
    buffer_load_dword v20, v4, s[12:15], s40 offen offset:768
    buffer_load_dword v21, v4, s[12:15], s40 offen offset:1024
    buffer_load_dword v22, v4, s[12:15], s40 offen offset:1280
    buffer_load_dword v23, v4, s[12:15], s40 offen offset:1536
    buffer_load_dword v24, v4, s[12:15], s40 offen offset:1792
    buffer_load_dword v25, v4, s[12:15], s40 offen offset:2048
    buffer_load_dword v35, v4, s[12:15], s42 offen offset:0
    buffer_load_dword v36, v4, s[12:15], s42 offen offset:256
    buffer_load_dword v37, v4, s[12:15], s42 offen offset:512
    buffer_load_dword v38, v4, s[12:15], s42 offen offset:768
    buffer_load_dword v39, v4, s[12:15], s42 offen offset:1024
    buffer_load_dword v40, v4, s[12:15], s42 offen offset:1280
    buffer_load_dword v41, v4, s[12:15], s42 offen offset:1536
    buffer_load_dword v42, v4, s[12:15], s42 offen offset:1792
    buffer_load_dword v43, v4, s[12:15], s42 offen offset:2048
    buffer_load_dword v26, v4, s[12:15], s41 offen offset:0
    buffer_load_dword v27, v4, s[12:15], s41 offen offset:256
    buffer_load_dword v28, v4, s[12:15], s41 offen offset:512
    buffer_load_dword v29, v4, s[12:15], s41 offen offset:768
    buffer_load_dword v30, v4, s[12:15], s41 offen offset:1024
    buffer_load_dword v31, v4, s[12:15], s41 offen offset:1280
    buffer_load_dword v32, v4, s[12:15], s41 offen offset:1536
    buffer_load_dword v33, v4, s[12:15], s41 offen offset:1792
    buffer_load_dword v34, v4, s[12:15], s41 offen offset:2048
    v_mov_b32 v2, v94
    v_cvt_f32_u32 v120, v7
    v_cvt_f32_u32 v121, v6
    v_mul_f32 v121, v121, v120
    v_mul_f32 v121, 0x3d800000, v121
    v_fmamk_f32 v92, v120, 0x00000000, v121
    v_fmamk_f32 v93, v120, 0x3c800000, v121
    v_fmamk_f32 v94, v120, 0x3d000000, v121
    v_fmamk_f32 v95, v120, 0x3d400000, v121
    v_cos_f32 v96, v92
    v_sin_f32 v100, v92
    v_cos_f32 v97, v93
    v_sin_f32 v101, v93
    v_cos_f32 v98, v94
    v_sin_f32 v102, v94
    v_cos_f32 v99, v95
    v_sin_f32 v103, v95
    v_cvt_pk_bf16_f32 v52, v96, v97
    v_cvt_pk_bf16_f32 v53, v98, v99
    v_cvt_pk_bf16_f32 v70, -v96, -v97
    v_cvt_pk_bf16_f32 v71, -v98, -v99
    v_cvt_pk_bf16_f32 v54, v100, v101
    v_cvt_pk_bf16_f32 v55, v102, v103
    v_cvt_pk_bf16_f32 v68, v100, v101
    v_cvt_pk_bf16_f32 v69, v102, v103
    v_fmamk_f32 v92, v120, 0x3e800000, v121
    v_fmamk_f32 v93, v120, 0x3e880000, v121
    v_fmamk_f32 v94, v120, 0x3e900000, v121
    v_fmamk_f32 v95, v120, 0x3e980000, v121
    v_cos_f32 v96, v92
    v_sin_f32 v100, v92
    v_cos_f32 v97, v93
    v_sin_f32 v101, v93
    v_cos_f32 v98, v94
    v_sin_f32 v102, v94
    v_cos_f32 v99, v95
    v_sin_f32 v103, v95
    v_cvt_pk_bf16_f32 v56, v96, v97
    v_cvt_pk_bf16_f32 v57, v98, v99
    v_cvt_pk_bf16_f32 v74, -v96, -v97
    v_cvt_pk_bf16_f32 v75, -v98, -v99
    v_cvt_pk_bf16_f32 v58, v100, v101
    v_cvt_pk_bf16_f32 v59, v102, v103
    v_cvt_pk_bf16_f32 v72, v100, v101
    v_cvt_pk_bf16_f32 v73, v102, v103
    v_fmamk_f32 v92, v120, 0x3f000000, v121
    v_fmamk_f32 v93, v120, 0x3f040000, v121
    v_fmamk_f32 v94, v120, 0x3f080000, v121
    v_fmamk_f32 v95, v120, 0x3f0c0000, v121
    v_cos_f32 v96, v92
    v_sin_f32 v100, v92
    v_cos_f32 v97, v93
    v_sin_f32 v101, v93
    v_cos_f32 v98, v94
    v_sin_f32 v102, v94
    v_cos_f32 v99, v95
    v_sin_f32 v103, v95
    v_cvt_pk_bf16_f32 v60, v96, v97
    v_cvt_pk_bf16_f32 v61, v98, v99
    v_cvt_pk_bf16_f32 v78, v96, v97
    v_cvt_pk_bf16_f32 v79, v98, v99
    v_cvt_pk_bf16_f32 v62, -v100, -v101
    v_cvt_pk_bf16_f32 v63, -v102, -v103
    v_cvt_pk_bf16_f32 v76, v100, v101
    v_cvt_pk_bf16_f32 v77, v102, v103
    v_fmamk_f32 v92, v120, 0x3f400000, v121
    v_fmamk_f32 v93, v120, 0x3f440000, v121
    v_fmamk_f32 v94, v120, 0x3f480000, v121
    v_fmamk_f32 v95, v120, 0x3f4c0000, v121
    v_cos_f32 v96, v92
    v_sin_f32 v100, v92
    v_cos_f32 v97, v93
    v_sin_f32 v101, v93
    v_cos_f32 v98, v94
    v_sin_f32 v102, v94
    v_cos_f32 v99, v95
    v_sin_f32 v103, v95
    v_cvt_pk_bf16_f32 v64, v96, v97
    v_cvt_pk_bf16_f32 v65, v98, v99
    v_cvt_pk_bf16_f32 v82, v96, v97
    v_cvt_pk_bf16_f32 v83, v98, v99
    v_cvt_pk_bf16_f32 v66, -v100, -v101
    v_cvt_pk_bf16_f32 v67, -v102, -v103
    v_cvt_pk_bf16_f32 v80, v100, v101
    v_cvt_pk_bf16_f32 v81, v102, v103
    v_mul_f32 v93, 0x3ae38e39, v120
    v_mul_f32 v94, 0x3b638e39, v120
    v_mul_f32 v95, 0x3baaaaab, v120
    v_mul_f32 v96, 0x3be38e39, v120
    v_cos_f32 v84, v93
    v_sin_f32 v85, v93
    v_cos_f32 v86, v94
    v_sin_f32 v87, v94
    v_cos_f32 v88, v95
    v_sin_f32 v89, v95
    v_cos_f32 v90, v96
    v_sin_f32 v91, v96
    v_mul_f32 v84, 0x35e38e39, v84
    v_mul_f32 v85, 0x35e38e39, v85
    v_mul_f32 v86, 0x35e38e39, v86
    v_mul_f32 v87, 0x35e38e39, v87
    v_mul_f32 v88, 0x35e38e39, v88
    v_mul_f32 v89, 0x35e38e39, v89
    v_mul_f32 v90, 0x35e38e39, v90
    v_mul_f32 v91, 0x35e38e39, v91
    v_lshrrev_b32 v92, 2, v5
    v_lshl_add_u32 v92, v6, 2, v92
    v_lshlrev_b32 v92, 3, v92
    s_mul_i32 s39, s29, 5760
    v_add_u32 v122, s39, v92
    v_and_b32 v92, 3, v1
    v_add_u32 v92, 1, v92
    v_mul_u32_u24 v123, 72, v92
    v_lshl_add_u32 v123, v123, 3, v122
    s_waitcnt vmcnt(36)
    ds_write_b64 v2, v[44:45]
    ds_write_b64 v2, v[46:47] offset:2880
    s_cmp_lt_u32 s3, 2
    s_cbranch_scc0 p3_noz3
    ds_write_b64 v2, v[48:49] offset:2304
    ds_write_b64 v2, v[50:51] offset:5184
p3_noz3:
    s_waitcnt lgkmcnt(0)
    s_barrier
    s_waitcnt vmcnt(0)
    s_mul_i32 s58, s3, 32
    s_lshr_b32 s59, s2, 3
    s_add_u32 s58, s58, s59
    s_and_b32 s59, s2, 7
    s_load_dwordx2 s[52:53], s[0:1], 32
    s_mul_i32 s56, s59, 4617
    s_lshr_b32 s56, s56, 10
    s_lshl_b32 s56, s56, 8
    v_mul_u32_u24 v124, 26, v1
    v_lshrrev_b32 v124, 8, v124
    v_mul_u32_u24 v125, 7936, v124
    v_lshl_add_u32 v124, v1, 7, v125
    s_add_u32 s57, 256, s58
    s_mul_i32 s57, s57, 55296
    s_add_u32 s57, s57, s56
    s_waitcnt lgkmcnt(0)
    s_mov_b32 s54, 0x1200000
    s_mov_b32 s55, 0x20000
    s_cmp_lt_u32 s58, 86
    s_cbranch_scc0 pfskip_3
    buffer_load_dword v128, v124, s[52:55], s57 offen
pfskip_3:
    ds_read_b64_tr_b16 v[92:93], v123 offset:0
    ds_read_b64_tr_b16 v[94:95], v123 offset:2880
    ds_read_b64_tr_b16 v[96:97], v123 offset:128
    ds_read_b64_tr_b16 v[98:99], v123 offset:3008
    ds_read_b64_tr_b16 v[100:101], v123 offset:256
    ds_read_b64_tr_b16 v[102:103], v123 offset:3136
    ds_read_b64_tr_b16 v[104:105], v123 offset:384
    ds_read_b64_tr_b16 v[106:107], v123 offset:3264
    ds_read_b64_tr_b16 v[44:45], v122 offset:0
    ds_read_b64_tr_b16 v[46:47], v122 offset:2880
    ds_read_b64_tr_b16 v[48:49], v122 offset:128
    ds_read_b64_tr_b16 v[50:51], v122 offset:3008
    ds_read_b64_tr_b16 v[124:125], v122 offset:256
    ds_read_b64_tr_b16 v[126:127], v122 offset:3136
    s_waitcnt lgkmcnt(12)
    v_mfma_f32_16x16x32_bf16 v[108:111], v[92:95], v[52:55], 0
    v_mfma_f32_16x16x32_bf16 v[112:115], v[92:95], v[68:71], 0
    s_waitcnt lgkmcnt(10)
    v_mfma_f32_16x16x32_bf16 v[108:111], v[96:99], v[56:59], v[108:111]
    v_mfma_f32_16x16x32_bf16 v[112:115], v[96:99], v[72:75], v[112:115]
    s_waitcnt lgkmcnt(8)
    v_mfma_f32_16x16x32_bf16 v[108:111], v[100:103], v[60:63], v[108:111]
    v_mfma_f32_16x16x32_bf16 v[112:115], v[100:103], v[76:79], v[112:115]
    s_waitcnt lgkmcnt(6)
    v_mfma_f32_16x16x32_bf16 v[108:111], v[104:107], v[64:67], v[108:111]
    v_mfma_f32_16x16x32_bf16 v[112:115], v[104:107], v[80:83], v[112:115]
    s_waitcnt lgkmcnt(4)
    v_mfma_f32_16x16x32_bf16 v[116:119], v[44:47], v[52:55], 0
    ds_read_b64_tr_b16 v[92:93], v122 offset:384
    ds_read_b64_tr_b16 v[94:95], v122 offset:3264
    s_waitcnt lgkmcnt(2)
    v_mfma_f32_16x16x32_bf16 v[116:119], v[48:51], v[56:59], v[116:119]
    v_mfma_f32_16x16x32_bf16 v[116:119], v[124:127], v[60:63], v[116:119]
    s_waitcnt lgkmcnt(0)
    v_mfma_f32_16x16x32_bf16 v[116:119], v[92:95], v[64:67], v[116:119]
    v_permlane32_swap_b32 v108, v110
    v_permlane32_swap_b32 v109, v111
    v_permlane32_swap_b32 v112, v114
    v_permlane32_swap_b32 v113, v115
    v_permlane16_swap_b32 v108, v109
    v_permlane16_swap_b32 v110, v111
    v_permlane16_swap_b32 v112, v113
    v_permlane16_swap_b32 v114, v115
    v_mul_f32 v92, v108, v84
    v_mul_f32 v93, v112, v84
    v_fma_f32 v92, -v112, v85, v92
    v_fmac_f32 v93, v108, v85
    v_mul_f32 v94, v109, v86
    v_mul_f32 v95, v113, v86
    v_fma_f32 v94, -v113, v87, v94
    v_fmac_f32 v95, v109, v87
    v_mul_f32 v96, v110, v88
    v_mul_f32 v97, v114, v88
    v_fma_f32 v96, -v114, v89, v96
    v_fmac_f32 v97, v110, v89
    v_mul_f32 v98, v111, v90
    v_mul_f32 v99, v115, v90
    v_fma_f32 v98, -v115, v91, v98
    v_fmac_f32 v99, v111, v91
    v_cmp_eq_u32 vcc, 1, v6
    s_nop 1
    v_cndmask_b32 v100, v116, v117, vcc
    v_cmp_eq_u32 vcc, 2, v6
    s_nop 1
    v_cndmask_b32 v100, v100, v118, vcc
    v_cmp_eq_u32 vcc, 3, v6
    s_nop 1
    v_cndmask_b32 v100, v100, v119, vcc
    v_mul_f32 v100, 0x35638e39, v100
    v_add_f32 v52, v100, v92
    v_add_f32 v52, v52, v94
    v_add_f32 v52, v52, v96
    v_add_f32 v52, v52, v98
    v_fmamk_f32 v68, v92, 0x3f441b7d, v100
    v_fmamk_f32 v68, v94, 0x3e31d0d4, v68
    v_fmamk_f32 v68, v96, 0xbf000000, v68
    v_fmamk_f32 v68, v98, 0xbf708fb2, v68
    v_mul_f32 v72, 0x3f248dbb, v93
    v_fmamk_f32 v72, v95, 0x3f7c1c5c, v72
    v_fmamk_f32 v72, v97, 0x3f5db3d7, v72
    v_fmamk_f32 v72, v99, 0x3eaf1d44, v72
    v_fmamk_f32 v69, v92, 0x3e31d0d4, v100
    v_fmamk_f32 v69, v94, 0xbf708fb2, v69
    v_fmamk_f32 v69, v96, 0xbf000000, v69
    v_fmamk_f32 v69, v98, 0x3f441b7d, v69
    v_mul_f32 v73, 0x3f7c1c5c, v93
    v_fmamk_f32 v73, v95, 0x3eaf1d44, v73
    v_fmamk_f32 v73, v97, 0xbf5db3d7, v73
    v_fmamk_f32 v73, v99, 0xbf248dbb, v73
    v_fmamk_f32 v70, v92, 0xbf000000, v100
    v_fmamk_f32 v70, v94, 0xbf000000, v70
    v_fmamk_f32 v70, v96, 0x3f800000, v70
    v_fmamk_f32 v70, v98, 0xbf000000, v70
    v_mul_f32 v74, 0x3f5db3d7, v93
    v_fmamk_f32 v74, v95, 0xbf5db3d7, v74
    v_fmamk_f32 v74, v99, 0x3f5db3d7, v74
    v_fmamk_f32 v71, v92, 0xbf708fb2, v100
    v_fmamk_f32 v71, v94, 0x3f441b7d, v71
    v_fmamk_f32 v71, v96, 0xbf000000, v71
    v_fmamk_f32 v71, v98, 0x3e31d0d4, v71
    v_mul_f32 v75, 0x3eaf1d44, v93
    v_fmamk_f32 v75, v95, 0xbf248dbb, v75
    v_fmamk_f32 v75, v97, 0x3f5db3d7, v75
    v_fmamk_f32 v75, v99, 0xbf7c1c5c, v75
    v_sub_f32 v53, v68, v72
    v_add_f32 v60, v68, v72
    v_sub_f32 v54, v69, v73
    v_add_f32 v59, v69, v73
    v_sub_f32 v55, v70, v74
    v_add_f32 v58, v70, v74
    v_sub_f32 v56, v71, v75
    v_add_f32 v57, v71, v75
    v_cvt_pk_bf16_f32 v92, v52, v53
    v_lshlrev_b32 v52, 16, v92
    v_and_b32 v53, s32, v92
    v_cvt_pk_bf16_f32 v93, v54, v55
    v_lshlrev_b32 v54, 16, v93
    v_and_b32 v55, s32, v93
    v_cvt_pk_bf16_f32 v92, v56, v57
    v_lshlrev_b32 v56, 16, v92
    v_and_b32 v57, s32, v92
    v_cvt_pk_bf16_f32 v93, v58, v59
    v_lshlrev_b32 v58, 16, v93
    v_and_b32 v59, s32, v93
    v_cvt_pk_bf16_f32 v60, v60, v60
    v_lshlrev_b32 v60, 16, v60
    s_waitcnt vmcnt(58)
    v_mul_f32 v52, v52, v17
    v_mul_f32 v53, v53, v18
    v_mul_f32 v54, v54, v19
    v_mul_f32 v55, v55, v20
    v_mul_f32 v56, v56, v21
    v_mul_f32 v57, v57, v22
    v_mul_f32 v58, v58, v23
    v_mul_f32 v59, v59, v24
    v_mul_f32 v60, v60, v25
    v_cvt_pk_bf16_f32 v92, v52, v53
    v_lshlrev_b32 v52, 16, v92
    v_and_b32 v53, s32, v92
    v_cvt_pk_bf16_f32 v93, v54, v55
    v_lshlrev_b32 v54, 16, v93
    v_and_b32 v55, s32, v93
    v_cvt_pk_bf16_f32 v92, v56, v57
    v_lshlrev_b32 v56, 16, v92
    v_and_b32 v57, s32, v92
    v_cvt_pk_bf16_f32 v93, v58, v59
    v_lshlrev_b32 v58, 16, v93
    v_and_b32 v59, s32, v93
    v_cvt_pk_bf16_f32 v60, v60, v60
    v_lshlrev_b32 v60, 16, v60
    v_add_f32 v8, v8, v52
    v_add_f32 v9, v9, v53
    v_add_f32 v10, v10, v54
    v_add_f32 v11, v11, v55
    v_add_f32 v12, v12, v56
    v_add_f32 v13, v13, v57
    v_add_f32 v14, v14, v58
    v_add_f32 v15, v15, v59
    v_add_f32 v16, v16, v60
    v_cvt_pk_bf16_f32 v92, v8, v9
    v_lshlrev_b32 v8, 16, v92
    v_and_b32 v9, s32, v92
    v_cvt_pk_bf16_f32 v93, v10, v11
    v_lshlrev_b32 v10, 16, v93
    v_and_b32 v11, s32, v93
    v_cvt_pk_bf16_f32 v92, v12, v13
    v_lshlrev_b32 v12, 16, v92
    v_and_b32 v13, s32, v92
    v_cvt_pk_bf16_f32 v93, v14, v15
    v_lshlrev_b32 v14, 16, v93
    v_and_b32 v15, s32, v93
    v_cvt_pk_bf16_f32 v16, v16, v16
    v_lshlrev_b32 v16, 16, v16
    buffer_store_short_d16_hi v8, v3, s[20:23], s30 offen offset:0
    buffer_store_short_d16_hi v9, v3, s[20:23], s30 offen offset:128
    buffer_store_short_d16_hi v10, v3, s[20:23], s30 offen offset:256
    buffer_store_short_d16_hi v11, v3, s[20:23], s30 offen offset:384
    buffer_store_short_d16_hi v12, v3, s[20:23], s30 offen offset:512
    buffer_store_short_d16_hi v13, v3, s[20:23], s30 offen offset:640
    buffer_store_short_d16_hi v14, v3, s[20:23], s30 offen offset:768
    buffer_store_short_d16_hi v15, v3, s[20:23], s30 offen offset:896
    buffer_store_short_d16_hi v16, v3, s[20:23], s30 offen offset:1024
    s_lshl_b32 s39, s29, 7
    s_add_u32 s39, s39, 11520
    v_lshl_add_u32 v122, v6, 5, s39
    s_lshl_b32 s39, s28, 3
    v_add_u32 v123, s39, v122
    v_cmp_eq_u32 s[48:49], 0, v5
    v_add_f32 v100, v8, v9
    v_add_f32 v100, v100, v10
    v_add_f32 v100, v100, v11
    v_add_f32 v100, v100, v12
    v_add_f32 v100, v100, v13
    v_add_f32 v100, v100, v14
    v_add_f32 v100, v100, v15
    v_add_f32 v100, v100, v16
    s_nop 1
    v_add_f32_dpp v100, v100, v100 quad_perm:[1,0,3,2] row_mask:0xf bank_mask:0xf
    s_nop 1
    v_add_f32_dpp v100, v100, v100 quad_perm:[2,3,0,1] row_mask:0xf bank_mask:0xf
    s_nop 1
    v_add_f32_dpp v100, v100, v100 row_half_mirror row_mask:0xf bank_mask:0xf
    s_nop 1
    v_add_f32_dpp v100, v100, v100 row_mirror row_mask:0xf bank_mask:0xf
    v_mul_f32 v102, 0x3be38e39, v100
    v_sub_f32 v92, v8, v102
    v_mul_f32 v101, v92, v92
    v_sub_f32 v93, v9, v102
    v_fmac_f32 v101, v93, v93
    v_sub_f32 v92, v10, v102
    v_fmac_f32 v101, v92, v92
    v_sub_f32 v93, v11, v102
    v_fmac_f32 v101, v93, v93
    v_sub_f32 v92, v12, v102
    v_fmac_f32 v101, v92, v92
    v_sub_f32 v93, v13, v102
    v_fmac_f32 v101, v93, v93
    v_sub_f32 v92, v14, v102
    v_fmac_f32 v101, v92, v92
    v_sub_f32 v93, v15, v102
    v_fmac_f32 v101, v93, v93
    v_sub_f32 v92, v16, v102
    v_fmac_f32 v101, v92, v92
    s_nop 1
    v_add_f32_dpp v101, v101, v101 quad_perm:[1,0,3,2] row_mask:0xf bank_mask:0xf
    s_nop 1
    v_add_f32_dpp v101, v101, v101 quad_perm:[2,3,0,1] row_mask:0xf bank_mask:0xf
    s_nop 1
    v_add_f32_dpp v101, v101, v101 row_half_mirror row_mask:0xf bank_mask:0xf
    s_nop 1
    v_add_f32_dpp v101, v101, v101 row_mirror row_mask:0xf bank_mask:0xf
    s_mov_b64 exec, s[48:49]
    ds_write_b64 v123, v[100:101] offset:0
    s_mov_b64 exec, -1
    s_waitcnt lgkmcnt(0)
    s_barrier
    ds_read_b128 v[92:95], v122 offset:0
    ds_read_b128 v[96:99], v122 offset:16
    s_waitcnt lgkmcnt(0)
    v_add_f32 v100, v92, v94
    v_add_f32 v102, v96, v98
    v_add_f32 v101, v93, v95
    v_add_f32 v103, v97, v99
    v_add_f32 v100, v100, v102
    v_add_f32 v101, v101, v103
    v_mul_f32 v100, 0x3ae38e39, v100
    v_mul_f32 v102, 0x43100000, v100
    v_sub_f32 v92, v92, v102
    v_mul_f32 v103, v92, v92
    v_sub_f32 v94, v94, v102
    v_fmac_f32 v103, v94, v94
    v_sub_f32 v96, v96, v102
    v_fmac_f32 v103, v96, v96
    v_sub_f32 v98, v98, v102
    v_fmac_f32 v103, v98, v98
    v_fmamk_f32 v101, v103, 0x3be38e39, v101
    v_mul_f32 v101, 0x3ae38e39, v101
    v_cvt_pk_bf16_f32 v100, v100, v100
    v_lshlrev_b32 v100, 16, v100
    v_cvt_pk_bf16_f32 v101, v101, v101
    v_lshlrev_b32 v101, 16, v101
    v_add_f32 v101, 0x3727c5ac, v101
    v_cvt_pk_bf16_f32 v101, v101, v101
    v_lshlrev_b32 v101, 16, v101
    v_sqrt_f32 v101, v101
    s_nop 0
    v_cvt_pk_bf16_f32 v101, v101, v101
    v_lshlrev_b32 v101, 16, v101
    v_rcp_f32 v101, v101
    v_sub_f32 v8, v8, v100
    v_sub_f32 v9, v9, v100
    v_sub_f32 v10, v10, v100
    v_sub_f32 v11, v11, v100
    v_sub_f32 v12, v12, v100
    v_sub_f32 v13, v13, v100
    v_sub_f32 v14, v14, v100
    v_sub_f32 v15, v15, v100
    v_sub_f32 v16, v16, v100
    v_cvt_pk_bf16_f32 v92, v8, v9
    v_lshlrev_b32 v8, 16, v92
    v_and_b32 v9, s32, v92
    v_cvt_pk_bf16_f32 v93, v10, v11
    v_lshlrev_b32 v10, 16, v93
    v_and_b32 v11, s32, v93
    v_cvt_pk_bf16_f32 v92, v12, v13
    v_lshlrev_b32 v12, 16, v92
    v_and_b32 v13, s32, v92
    v_cvt_pk_bf16_f32 v93, v14, v15
    v_lshlrev_b32 v14, 16, v93
    v_and_b32 v15, s32, v93
    v_cvt_pk_bf16_f32 v16, v16, v16
    v_lshlrev_b32 v16, 16, v16
    v_mul_f32 v8, v8, v101
    v_mul_f32 v9, v9, v101
    v_mul_f32 v10, v10, v101
    v_mul_f32 v11, v11, v101
    v_mul_f32 v12, v12, v101
    v_mul_f32 v13, v13, v101
    v_mul_f32 v14, v14, v101
    v_mul_f32 v15, v15, v101
    v_mul_f32 v16, v16, v101
    v_cvt_pk_bf16_f32 v92, v8, v9
    v_lshlrev_b32 v8, 16, v92
    v_and_b32 v9, s32, v92
    v_cvt_pk_bf16_f32 v93, v10, v11
    v_lshlrev_b32 v10, 16, v93
    v_and_b32 v11, s32, v93
    v_cvt_pk_bf16_f32 v92, v12, v13
    v_lshlrev_b32 v12, 16, v92
    v_and_b32 v13, s32, v92
    v_cvt_pk_bf16_f32 v93, v14, v15
    v_lshlrev_b32 v14, 16, v93
    v_and_b32 v15, s32, v93
    v_cvt_pk_bf16_f32 v16, v16, v16
    v_lshlrev_b32 v16, 16, v16
    s_waitcnt vmcnt(49)
    v_mul_f32 v8, v8, v35
    v_mul_f32 v9, v9, v36
    v_mul_f32 v10, v10, v37
    v_mul_f32 v11, v11, v38
    v_mul_f32 v12, v12, v39
    v_mul_f32 v13, v13, v40
    v_mul_f32 v14, v14, v41
    v_mul_f32 v15, v15, v42
    v_mul_f32 v16, v16, v43
    v_cvt_pk_bf16_f32 v92, v8, v9
    v_lshlrev_b32 v8, 16, v92
    v_and_b32 v9, s32, v92
    v_cvt_pk_bf16_f32 v93, v10, v11
    v_lshlrev_b32 v10, 16, v93
    v_and_b32 v11, s32, v93
    v_cvt_pk_bf16_f32 v92, v12, v13
    v_lshlrev_b32 v12, 16, v92
    v_and_b32 v13, s32, v92
    v_cvt_pk_bf16_f32 v93, v14, v15
    v_lshlrev_b32 v14, 16, v93
    v_and_b32 v15, s32, v93
    v_cvt_pk_bf16_f32 v16, v16, v16
    v_lshlrev_b32 v16, 16, v16
    v_add_f32 v8, v8, v26
    v_add_f32 v9, v9, v27
    v_add_f32 v10, v10, v28
    v_add_f32 v11, v11, v29
    v_add_f32 v12, v12, v30
    v_add_f32 v13, v13, v31
    v_add_f32 v14, v14, v32
    v_add_f32 v15, v15, v33
    v_add_f32 v16, v16, v34
    v_cvt_pk_bf16_f32 v92, v8, v9
    v_lshlrev_b32 v8, 16, v92
    v_and_b32 v9, s32, v92
    v_cvt_pk_bf16_f32 v93, v10, v11
    v_lshlrev_b32 v10, 16, v93
    v_and_b32 v11, s32, v93
    v_cvt_pk_bf16_f32 v92, v12, v13
    v_lshlrev_b32 v12, 16, v92
    v_and_b32 v13, s32, v92
    v_cvt_pk_bf16_f32 v93, v14, v15
    v_lshlrev_b32 v14, 16, v93
    v_and_b32 v15, s32, v93
    v_cvt_pk_bf16_f32 v16, v16, v16
    v_lshlrev_b32 v16, 16, v16
    v_add_f32 v100, v8, v9
    v_add_f32 v100, v100, v10
    v_add_f32 v100, v100, v11
    v_add_f32 v100, v100, v12
    v_add_f32 v100, v100, v13
    v_add_f32 v100, v100, v14
    v_add_f32 v100, v100, v15
    v_add_f32 v100, v100, v16
    s_nop 1
    v_add_f32_dpp v100, v100, v100 quad_perm:[1,0,3,2] row_mask:0xf bank_mask:0xf
    s_nop 1
    v_add_f32_dpp v100, v100, v100 quad_perm:[2,3,0,1] row_mask:0xf bank_mask:0xf
    s_nop 1
    v_add_f32_dpp v100, v100, v100 row_half_mirror row_mask:0xf bank_mask:0xf
    s_nop 1
    v_add_f32_dpp v100, v100, v100 row_mirror row_mask:0xf bank_mask:0xf
    v_mul_f32 v102, 0x3be38e39, v100
    v_sub_f32 v92, v8, v102
    v_mul_f32 v101, v92, v92
    v_sub_f32 v93, v9, v102
    v_fmac_f32 v101, v93, v93
    v_sub_f32 v92, v10, v102
    v_fmac_f32 v101, v92, v92
    v_sub_f32 v93, v11, v102
    v_fmac_f32 v101, v93, v93
    v_sub_f32 v92, v12, v102
    v_fmac_f32 v101, v92, v92
    v_sub_f32 v93, v13, v102
    v_fmac_f32 v101, v93, v93
    v_sub_f32 v92, v14, v102
    v_fmac_f32 v101, v92, v92
    v_sub_f32 v93, v15, v102
    v_fmac_f32 v101, v93, v93
    v_sub_f32 v92, v16, v102
    v_fmac_f32 v101, v92, v92
    s_nop 1
    v_add_f32_dpp v101, v101, v101 quad_perm:[1,0,3,2] row_mask:0xf bank_mask:0xf
    s_nop 1
    v_add_f32_dpp v101, v101, v101 quad_perm:[2,3,0,1] row_mask:0xf bank_mask:0xf
    s_nop 1
    v_add_f32_dpp v101, v101, v101 row_half_mirror row_mask:0xf bank_mask:0xf
    s_nop 1
    v_add_f32_dpp v101, v101, v101 row_mirror row_mask:0xf bank_mask:0xf
    s_mov_b64 exec, s[48:49]
    ds_write_b64 v123, v[100:101] offset:256
    s_mov_b64 exec, -1
    s_waitcnt lgkmcnt(0)
    s_barrier
    ds_read_b128 v[92:95], v122 offset:256
    ds_read_b128 v[96:99], v122 offset:272
    s_waitcnt lgkmcnt(0)
    v_add_f32 v100, v92, v94
    v_add_f32 v102, v96, v98
    v_add_f32 v101, v93, v95
    v_add_f32 v103, v97, v99
    v_add_f32 v100, v100, v102
    v_add_f32 v101, v101, v103
    v_mul_f32 v100, 0x3ae38e39, v100
    v_mul_f32 v102, 0x43100000, v100
    v_sub_f32 v92, v92, v102
    v_mul_f32 v103, v92, v92
    v_sub_f32 v94, v94, v102
    v_fmac_f32 v103, v94, v94
    v_sub_f32 v96, v96, v102
    v_fmac_f32 v103, v96, v96
    v_sub_f32 v98, v98, v102
    v_fmac_f32 v103, v98, v98
    v_fmamk_f32 v101, v103, 0x3be38e39, v101
    v_mul_f32 v101, 0x3ae38e39, v101
    v_cvt_pk_bf16_f32 v100, v100, v100
    v_lshlrev_b32 v100, 16, v100
    v_cvt_pk_bf16_f32 v101, v101, v101
    v_lshlrev_b32 v101, 16, v101
    v_add_f32 v101, 0x3727c5ac, v101
    v_cvt_pk_bf16_f32 v101, v101, v101
    v_lshlrev_b32 v101, 16, v101
    v_sqrt_f32 v101, v101
    s_nop 0
    v_cvt_pk_bf16_f32 v101, v101, v101
    v_lshlrev_b32 v101, 16, v101
    v_rcp_f32 v101, v101
    v_sub_f32 v8, v8, v100
    v_sub_f32 v9, v9, v100
    v_sub_f32 v10, v10, v100
    v_sub_f32 v11, v11, v100
    v_sub_f32 v12, v12, v100
    v_sub_f32 v13, v13, v100
    v_sub_f32 v14, v14, v100
    v_sub_f32 v15, v15, v100
    v_sub_f32 v16, v16, v100
    v_cvt_pk_bf16_f32 v92, v8, v9
    v_lshlrev_b32 v8, 16, v92
    v_and_b32 v9, s32, v92
    v_cvt_pk_bf16_f32 v93, v10, v11
    v_lshlrev_b32 v10, 16, v93
    v_and_b32 v11, s32, v93
    v_cvt_pk_bf16_f32 v92, v12, v13
    v_lshlrev_b32 v12, 16, v92
    v_and_b32 v13, s32, v92
    v_cvt_pk_bf16_f32 v93, v14, v15
    v_lshlrev_b32 v14, 16, v93
    v_and_b32 v15, s32, v93
    v_cvt_pk_bf16_f32 v16, v16, v16
    v_lshlrev_b32 v16, 16, v16
    v_mul_f32 v8, v8, v101
    v_mul_f32 v9, v9, v101
    v_mul_f32 v10, v10, v101
    v_mul_f32 v11, v11, v101
    v_mul_f32 v12, v12, v101
    v_mul_f32 v13, v13, v101
    v_mul_f32 v14, v14, v101
    v_mul_f32 v15, v15, v101
    v_mul_f32 v16, v16, v101
    v_cvt_pk_bf16_f32 v92, v8, v9
    v_lshlrev_b32 v8, 16, v92
    v_and_b32 v9, s32, v92
    v_cvt_pk_bf16_f32 v93, v10, v11
    v_lshlrev_b32 v10, 16, v93
    v_and_b32 v11, s32, v93
    v_cvt_pk_bf16_f32 v92, v12, v13
    v_lshlrev_b32 v12, 16, v92
    v_and_b32 v13, s32, v92
    v_cvt_pk_bf16_f32 v93, v14, v15
    v_lshlrev_b32 v14, 16, v93
    v_and_b32 v15, s32, v93
    v_cvt_pk_bf16_f32 v16, v16, v16
    v_lshlrev_b32 v16, 16, v16
    v_mov_b32 v17, 0
    v_permlane16_swap_b32 v8, v9
    v_permlane16_swap_b32 v10, v11
    v_permlane16_swap_b32 v12, v13
    v_permlane16_swap_b32 v14, v15
    v_permlane16_swap_b32 v16, v17
    v_cvt_pk_bf16_f32 v92, v8, v9
    v_cvt_pk_bf16_f32 v93, v10, v11
    v_cvt_pk_bf16_f32 v94, v12, v13
    v_cvt_pk_bf16_f32 v95, v14, v15
    v_cvt_pk_bf16_f32 v96, v16, v17
    v_mov_b32 v97, 0
    v_permlane32_swap_b32 v92, v93
    v_permlane32_swap_b32 v94, v95
    v_permlane32_swap_b32 v96, v97
    s_mul_i32 s39, s24, 1536
    s_lshl_b32 s43, s29, 3
    s_add_u32 s39, s39, s43
    s_mov_b32 s43, 391680
    v_lshl_add_u32 v100, v6, 6, v7
    v_add_u32 v100, 0, v100
    v_mul_u32_u24 v101, 683, v100
    v_lshrrev_b32 v101, 16, v101
    v_mul_lo_u32 v101, v101, s43
    v_lshl_add_u32 v102, v100, 4, v101
    buffer_store_dwordx2 v[92:93], v102, s[44:47], s39 offen
    v_lshl_add_u32 v100, v6, 6, v7
    v_add_u32 v100, 256, v100
    v_mul_u32_u24 v101, 683, v100
    v_lshrrev_b32 v101, 16, v101
    v_mul_lo_u32 v101, v101, s43
    v_lshl_add_u32 v103, v100, 4, v101
    buffer_store_dwordx2 v[94:95], v103, s[44:47], s39 offen
    v_lshl_add_u32 v100, v6, 6, v7
    v_add_u32 v100, 512, v100
    v_mul_u32_u24 v101, 683, v100
    v_lshrrev_b32 v101, 16, v101
    v_mul_lo_u32 v101, v101, s43
    v_lshl_add_u32 v104, v100, 4, v101
    buffer_store_dwordx2 v[96:97], v104, s[44:47], s39 offen
p3_done:
    s_endpgm
.globl g1_kernel
.p2align 8
.type g1_kernel,@function
g1_kernel:
    s_cmp_ge_u32 s2, 216
    s_cbranch_scc1 g1_pf
    s_load_dwordx2 s[4:5], s[0:1], 96
    s_load_dwordx4 s[16:19], s[0:1], 32
    v_lshrrev_b32 v2, 6, v0
    s_nop 0
    v_readfirstlane_b32 s3, v2
    s_and_b32 s33, s2, 7
    s_mul_i32 s33, s33, 27
    s_lshr_b32 s34, s2, 3
    s_add_u32 s33, s33, s34
    s_mul_i32 s34, s33, 171
    s_lshr_b32 s34, s34, 10
    s_mul_i32 s35, s34, 6
    s_sub_u32 s35, s33, s35
    s_lshl_b32 s20, s34, 8
    s_mul_i32 s21, s35, 393216
    s_waitcnt lgkmcnt(0)
    s_cmp_lt_u32 s3, 4
    s_cbranch_scc1 g1_cons
    s_mov_b32 s8, s16
    s_mov_b32 s9, s17
    s_mov_b32 s10, 0x1200000
    s_mov_b32 s11, 0x20000
    s_add_u32 s12, s4, 0xd00000
    s_addc_u32 s13, s5, 0
    s_mov_b32 s14, 0x240000
    s_mov_b32 s15, 0x20000
    v_and_b32 v1, 63, v0
    v_lshrrev_b32 v2, 4, v1
    v_and_b32 v3, 15, v1
    v_lshlrev_b32 v4, 1, v2
    v_xor_b32 v4, v4, v3
    v_xor_b32 v5, 8, v4
    s_movk_i32 s22, 9216
    v_mul_lo_u32 v2, v2, s22
    v_lshl_add_u32 v4, v4, 4, v2
    v_lshl_add_u32 v5, v5, 4, v2
    v_lshlrev_b32 v6, 4, v1
    s_sub_u32 s23, s3, 4
    s_mul_i32 s24, s23, 147456
    s_add_u32 s20, s20, s24
    s_mul_i32 s24, s23, 3072
    s_add_u32 s21, s21, s24
    s_lshl_b32 s25, s23, 12
    s_add_u32 s26, s24, 16384
    s_mov_b32 s27, 0
    s_add_u32 m0, s27, s25
    s_nop 0
    buffer_load_dwordx4 v4, s[8:11], s20 offen offset:0 lds
    s_add_u32 s28, s20, 35840
    buffer_load_dwordx4 v4, s[8:11], s28 offen offset:1024 lds
    s_add_u32 s29, s20, 71680
    buffer_load_dwordx4 v5, s[8:11], s29 offen offset:2048 lds
    s_add_u32 s30, s20, 107520
    buffer_load_dwordx4 v5, s[8:11], s30 offen offset:3072 lds
    s_add_u32 m0, s27, s26
    s_add_u32 s20, s20, 589824
    buffer_load_dwordx4 v6, s[12:15], s21 offen offset:0 lds
    buffer_load_dwordx4 v6, s[12:15], s21 offen offset:1024 lds
    buffer_load_dwordx4 v6, s[12:15], s21 offen offset:2048 lds
    s_add_u32 s21, s21, 12288
    s_add_u32 s27, s27, 28672
    s_cmp_eq_u32 s27, 143360
    s_cselect_b32 s27, 0, s27
    s_add_u32 m0, s27, s25
    s_nop 0
    buffer_load_dwordx4 v4, s[8:11], s20 offen offset:0 lds
    s_add_u32 s28, s20, 35840
    buffer_load_dwordx4 v4, s[8:11], s28 offen offset:1024 lds
    s_add_u32 s29, s20, 71680
    buffer_load_dwordx4 v5, s[8:11], s29 offen offset:2048 lds
    s_add_u32 s30, s20, 107520
    buffer_load_dwordx4 v5, s[8:11], s30 offen offset:3072 lds
    s_add_u32 m0, s27, s26
    s_add_u32 s20, s20, 589824
    buffer_load_dwordx4 v6, s[12:15], s21 offen offset:0 lds
    buffer_load_dwordx4 v6, s[12:15], s21 offen offset:1024 lds
    buffer_load_dwordx4 v6, s[12:15], s21 offen offset:2048 lds
    s_add_u32 s21, s21, 12288
    s_add_u32 s27, s27, 28672
    s_cmp_eq_u32 s27, 143360
    s_cselect_b32 s27, 0, s27
    s_add_u32 m0, s27, s25
    s_nop 0
    buffer_load_dwordx4 v4, s[8:11], s20 offen offset:0 lds
    s_add_u32 s28, s20, 35840
    buffer_load_dwordx4 v4, s[8:11], s28 offen offset:1024 lds
    s_add_u32 s29, s20, 71680
    buffer_load_dwordx4 v5, s[8:11], s29 offen offset:2048 lds
    s_add_u32 s30, s20, 107520
    buffer_load_dwordx4 v5, s[8:11], s30 offen offset:3072 lds
    s_add_u32 m0, s27, s26
    s_add_u32 s20, s20, 589824
    buffer_load_dwordx4 v6, s[12:15], s21 offen offset:0 lds
    buffer_load_dwordx4 v6, s[12:15], s21 offen offset:1024 lds
    buffer_load_dwordx4 v6, s[12:15], s21 offen offset:2048 lds
    s_add_u32 s21, s21, 12288
    s_add_u32 s27, s27, 28672
    s_cmp_eq_u32 s27, 143360
    s_cselect_b32 s27, 0, s27
    s_add_u32 m0, s27, s25
    s_nop 0
    buffer_load_dwordx4 v4, s[8:11], s20 offen offset:0 lds
    s_add_u32 s28, s20, 35840
    buffer_load_dwordx4 v4, s[8:11], s28 offen offset:1024 lds
    s_add_u32 s29, s20, 71680
    buffer_load_dwordx4 v5, s[8:11], s29 offen offset:2048 lds
    s_add_u32 s30, s20, 107520
    buffer_load_dwordx4 v5, s[8:11], s30 offen offset:3072 lds
    s_add_u32 m0, s27, s26
    s_add_u32 s20, s20, 589824
    buffer_load_dwordx4 v6, s[12:15], s21 offen offset:0 lds
    buffer_load_dwordx4 v6, s[12:15], s21 offen offset:1024 lds
    buffer_load_dwordx4 v6, s[12:15], s21 offen offset:2048 lds
    s_add_u32 s21, s21, 12288
    s_add_u32 s27, s27, 28672
    s_cmp_eq_u32 s27, 143360
    s_cselect_b32 s27, 0, s27
    s_movk_i32 s31, 28
g1_ld_loop:
    s_waitcnt vmcnt(21)
    s_barrier
    s_add_u32 m0, s27, s25
    s_nop 0
    buffer_load_dwordx4 v4, s[8:11], s20 offen offset:0 lds
    s_add_u32 s28, s20, 35840
    buffer_load_dwordx4 v4, s[8:11], s28 offen offset:1024 lds
    s_add_u32 s29, s20, 71680
    buffer_load_dwordx4 v5, s[8:11], s29 offen offset:2048 lds
    s_add_u32 s30, s20, 107520
    buffer_load_dwordx4 v5, s[8:11], s30 offen offset:3072 lds
    s_add_u32 m0, s27, s26
    s_add_u32 s20, s20, 589824
    buffer_load_dwordx4 v6, s[12:15], s21 offen offset:0 lds
    buffer_load_dwordx4 v6, s[12:15], s21 offen offset:1024 lds
    buffer_load_dwordx4 v6, s[12:15], s21 offen offset:2048 lds
    s_add_u32 s21, s21, 12288
    s_add_u32 s27, s27, 28672
    s_cmp_eq_u32 s27, 143360
    s_cselect_b32 s27, 0, s27
    s_sub_u32 s31, s31, 1
    s_cmp_lg_u32 s31, 0
    s_cbranch_scc1 g1_ld_loop
    s_waitcnt vmcnt(21)
    s_barrier
    s_waitcnt vmcnt(14)
    s_barrier
    s_waitcnt vmcnt(7)
    s_barrier
    s_waitcnt vmcnt(0)
    s_barrier
    s_branch g1_done
g1_cons:
    s_mov_b32 s8, s18
    s_mov_b32 s9, s19
    s_mov_b32 s10, 0x2400
    s_mov_b32 s11, 0x20000
    s_add_u32 s12, s4, 0x1000000
    s_addc_u32 s13, s5, 0
    s_mov_b32 s14, 0x510000
    s_mov_b32 s15, 0x20000
    v_and_b32 v1, 63, v0
    v_and_b32 v5, 15, v1
    v_lshrrev_b32 v6, 4, v1
    s_and_b32 s36, s3, 1
    s_lshr_b32 s37, s3, 1
    s_lshl_b32 s38, s36, 7
    s_add_u32 s38, s38, s20
    v_lshlrev_b32 v7, 3, v6
    buffer_load_dwordx2 v[24:25], v7, s[8:11], s38 offen offset:0
    buffer_load_dwordx2 v[26:27], v7, s[8:11], s38 offen offset:32
    buffer_load_dwordx2 v[28:29], v7, s[8:11], s38 offen offset:64
    buffer_load_dwordx2 v[30:31], v7, s[8:11], s38 offen offset:96
    s_lshl_b32 s40, s36, 2
    s_add_u32 s40, s40, 0
    s_lshl_b32 s41, s36, 2
    s_add_u32 s41, s41, 1
    s_lshl_b32 s42, s36, 2
    s_add_u32 s42, s42, 2
    s_lshl_b32 s43, s36, 2
    s_add_u32 s43, s43, 3
    v_lshrrev_b32 v2, 2, v5
    v_and_b32 v3, 1, v6
    v_lshl_add_u32 v3, v3, 2, v2
    v_mad_u32_u24 v2, v6, 8, v2
    v_lshlrev_b32 v2, 8, v2
    v_and_b32 v4, 3, v1
    v_lshl_add_u32 v2, v4, 3, v2
    v_xor_b32 v4, s40, v3
    v_lshl_add_u32 v8, v4, 5, v2
    v_xor_b32 v4, s41, v3
    v_lshl_add_u32 v9, v4, 5, v2
    v_xor_b32 v4, s42, v3
    v_lshl_add_u32 v10, v4, 5, v2
    v_xor_b32 v4, s43, v3
    v_lshl_add_u32 v11, v4, 5, v2
    v_mul_u32_u24 v2, 1536, v6
    v_lshl_add_u32 v2, v5, 4, v2
    s_mul_i32 s38, s37, 768
    s_add_u32 s38, s38, 16384
    v_add_u32 v12, s38, v2
    v_mov_b32 v88, 0
    v_mov_b32 v89, 0
    v_mov_b32 v90, 0
    v_mov_b32 v91, 0
    v_mov_b32 v92, 0
    v_mov_b32 v93, 0
    v_mov_b32 v94, 0
    v_mov_b32 v95, 0
    v_mov_b32 v96, 0
    v_mov_b32 v97, 0
    v_mov_b32 v98, 0
    v_mov_b32 v99, 0
    v_mov_b32 v100, 0
    v_mov_b32 v101, 0
    v_mov_b32 v102, 0
    v_mov_b32 v103, 0
    v_mov_b32 v104, 0
    v_mov_b32 v105, 0
    v_mov_b32 v106, 0
    v_mov_b32 v107, 0
    v_mov_b32 v108, 0
    v_mov_b32 v109, 0
    v_mov_b32 v110, 0
    v_mov_b32 v111, 0
    v_mov_b32 v112, 0
    v_mov_b32 v113, 0
    v_mov_b32 v114, 0
    v_mov_b32 v115, 0
    v_mov_b32 v116, 0
    v_mov_b32 v117, 0
    v_mov_b32 v118, 0
    v_mov_b32 v119, 0
    v_mov_b32 v120, 0
    v_mov_b32 v121, 0
    v_mov_b32 v122, 0
    v_mov_b32 v123, 0
    v_mov_b32 v124, 0
    v_mov_b32 v125, 0
    v_mov_b32 v126, 0
    v_mov_b32 v127, 0
    v_mov_b32 v128, 0
    v_mov_b32 v129, 0
    v_mov_b32 v130, 0
    v_mov_b32 v131, 0
    v_mov_b32 v132, 0
    v_mov_b32 v133, 0
    v_mov_b32 v134, 0
    v_mov_b32 v135, 0
    s_mov_b32 s27, 0
    v_add_u32 v16, s27, v8
    v_add_u32 v17, s27, v9
    v_add_u32 v18, s27, v10
    v_add_u32 v19, s27, v11
    v_add_u32 v20, s27, v12
    s_movk_i32 s31, 31
    s_barrier
    ds_read_b128 v[48:51], v20 offset:0
    ds_read_b64_tr_b16 v[32:33], v16 offset:0
    ds_read_b64_tr_b16 v[34:35], v16 offset:1024
    ds_read_b64_tr_b16 v[36:37], v17 offset:0
    ds_read_b64_tr_b16 v[38:39], v17 offset:1024
    ds_read_b64_tr_b16 v[40:41], v18 offset:0
    ds_read_b64_tr_b16 v[42:43], v18 offset:1024
    ds_read_b64_tr_b16 v[44:45], v19 offset:0
    ds_read_b64_tr_b16 v[46:47], v19 offset:1024
    ds_read_b128 v[52:55], v20 offset:256
    ds_read_b128 v[56:59], v20 offset:512
g1_mm_loop:
    s_waitcnt lgkmcnt(0)
    v_mfma_f32_16x16x32_bf16 v[88:91], v[32:35], v[48:51], v[88:91]
    ds_read_b128 v[76:79], v20 offset:6144
    ds_read_b64_tr_b16 v[60:61], v16 offset:8192
    v_mfma_f32_16x16x32_bf16 v[100:103], v[36:39], v[48:51], v[100:103]
    ds_read_b64_tr_b16 v[62:63], v16 offset:9216
    ds_read_b64_tr_b16 v[64:65], v17 offset:8192
    v_mfma_f32_16x16x32_bf16 v[112:115], v[40:43], v[48:51], v[112:115]
    ds_read_b64_tr_b16 v[66:67], v17 offset:9216
    ds_read_b64_tr_b16 v[68:69], v18 offset:8192
    v_mfma_f32_16x16x32_bf16 v[124:127], v[44:47], v[48:51], v[124:127]
    ds_read_b64_tr_b16 v[70:71], v18 offset:9216
    ds_read_b64_tr_b16 v[72:73], v19 offset:8192
    v_mfma_f32_16x16x32_bf16 v[92:95], v[32:35], v[52:55], v[92:95]
    ds_read_b64_tr_b16 v[74:75], v19 offset:9216
    ds_read_b128 v[80:83], v20 offset:6400
    v_mfma_f32_16x16x32_bf16 v[104:107], v[36:39], v[52:55], v[104:107]
    ds_read_b128 v[84:87], v20 offset:6656
    s_add_u32 s27, s27, 28672
    v_mfma_f32_16x16x32_bf16 v[116:119], v[40:43], v[52:55], v[116:119]
    s_cmp_eq_u32 s27, 143360
    s_cselect_b32 s27, 0, s27
    v_mfma_f32_16x16x32_bf16 v[128:131], v[44:47], v[52:55], v[128:131]
    v_add_u32 v16, s27, v8
    v_add_u32 v17, s27, v9
    v_mfma_f32_16x16x32_bf16 v[96:99], v[32:35], v[56:59], v[96:99]
    v_add_u32 v18, s27, v10
    v_add_u32 v19, s27, v11
    v_mfma_f32_16x16x32_bf16 v[108:111], v[36:39], v[56:59], v[108:111]
    v_add_u32 v20, s27, v12
    s_waitcnt lgkmcnt(0)
    v_mfma_f32_16x16x32_bf16 v[120:123], v[40:43], v[56:59], v[120:123]
    s_barrier
    v_mfma_f32_16x16x32_bf16 v[132:135], v[44:47], v[56:59], v[132:135]
    v_mfma_f32_16x16x32_bf16 v[88:91], v[60:63], v[76:79], v[88:91]
    ds_read_b128 v[48:51], v20 offset:0
    ds_read_b64_tr_b16 v[32:33], v16 offset:0
    v_mfma_f32_16x16x32_bf16 v[100:103], v[64:67], v[76:79], v[100:103]
    ds_read_b64_tr_b16 v[34:35], v16 offset:1024
    ds_read_b64_tr_b16 v[36:37], v17 offset:0
    v_mfma_f32_16x16x32_bf16 v[112:115], v[68:71], v[76:79], v[112:115]
    ds_read_b64_tr_b16 v[38:39], v17 offset:1024
    ds_read_b64_tr_b16 v[40:41], v18 offset:0
    v_mfma_f32_16x16x32_bf16 v[124:127], v[72:75], v[76:79], v[124:127]
    ds_read_b64_tr_b16 v[42:43], v18 offset:1024
    ds_read_b64_tr_b16 v[44:45], v19 offset:0
    v_mfma_f32_16x16x32_bf16 v[92:95], v[60:63], v[80:83], v[92:95]
    ds_read_b64_tr_b16 v[46:47], v19 offset:1024
    ds_read_b128 v[52:55], v20 offset:256
    v_mfma_f32_16x16x32_bf16 v[104:107], v[64:67], v[80:83], v[104:107]
    ds_read_b128 v[56:59], v20 offset:512
    s_sub_u32 s31, s31, 1
    v_mfma_f32_16x16x32_bf16 v[116:119], v[68:71], v[80:83], v[116:119]
    s_cmp_lg_u32 s31, 0
    v_mfma_f32_16x16x32_bf16 v[128:131], v[72:75], v[80:83], v[128:131]
    v_mfma_f32_16x16x32_bf16 v[96:99], v[60:63], v[84:87], v[96:99]
    v_mfma_f32_16x16x32_bf16 v[108:111], v[64:67], v[84:87], v[108:111]
    v_mfma_f32_16x16x32_bf16 v[120:123], v[68:71], v[84:87], v[120:123]
    v_mfma_f32_16x16x32_bf16 v[132:135], v[72:75], v[84:87], v[132:135]
    s_cbranch_scc1 g1_mm_loop
    s_waitcnt lgkmcnt(0)
    v_mfma_f32_16x16x32_bf16 v[88:91], v[32:35], v[48:51], v[88:91]
    ds_read_b128 v[76:79], v20 offset:6144
    ds_read_b64_tr_b16 v[60:61], v16 offset:8192
    v_mfma_f32_16x16x32_bf16 v[100:103], v[36:39], v[48:51], v[100:103]
    ds_read_b64_tr_b16 v[62:63], v16 offset:9216
    ds_read_b64_tr_b16 v[64:65], v17 offset:8192
    v_mfma_f32_16x16x32_bf16 v[112:115], v[40:43], v[48:51], v[112:115]
    ds_read_b64_tr_b16 v[66:67], v17 offset:9216
    ds_read_b64_tr_b16 v[68:69], v18 offset:8192
    v_mfma_f32_16x16x32_bf16 v[124:127], v[44:47], v[48:51], v[124:127]
    ds_read_b64_tr_b16 v[70:71], v18 offset:9216
    ds_read_b64_tr_b16 v[72:73], v19 offset:8192
    v_mfma_f32_16x16x32_bf16 v[92:95], v[32:35], v[52:55], v[92:95]
    ds_read_b64_tr_b16 v[74:75], v19 offset:9216
    ds_read_b128 v[80:83], v20 offset:6400
    v_mfma_f32_16x16x32_bf16 v[104:107], v[36:39], v[52:55], v[104:107]
    ds_read_b128 v[84:87], v20 offset:6656
    v_mfma_f32_16x16x32_bf16 v[116:119], v[40:43], v[52:55], v[116:119]
    v_mfma_f32_16x16x32_bf16 v[128:131], v[44:47], v[52:55], v[128:131]
    v_mfma_f32_16x16x32_bf16 v[96:99], v[32:35], v[56:59], v[96:99]
    v_mfma_f32_16x16x32_bf16 v[108:111], v[36:39], v[56:59], v[108:111]
    v_mfma_f32_16x16x32_bf16 v[120:123], v[40:43], v[56:59], v[120:123]
    v_mfma_f32_16x16x32_bf16 v[132:135], v[44:47], v[56:59], v[132:135]
    s_waitcnt lgkmcnt(0)
    v_mfma_f32_16x16x32_bf16 v[88:91], v[60:63], v[76:79], v[88:91]
    v_mfma_f32_16x16x32_bf16 v[100:103], v[64:67], v[76:79], v[100:103]
    v_mfma_f32_16x16x32_bf16 v[112:115], v[68:71], v[76:79], v[112:115]
    v_mfma_f32_16x16x32_bf16 v[124:127], v[72:75], v[76:79], v[124:127]
    v_mfma_f32_16x16x32_bf16 v[92:95], v[60:63], v[80:83], v[92:95]
    v_mfma_f32_16x16x32_bf16 v[104:107], v[64:67], v[80:83], v[104:107]
    v_mfma_f32_16x16x32_bf16 v[116:119], v[68:71], v[80:83], v[116:119]
    v_mfma_f32_16x16x32_bf16 v[128:131], v[72:75], v[80:83], v[128:131]
    v_mfma_f32_16x16x32_bf16 v[96:99], v[60:63], v[84:87], v[96:99]
    v_mfma_f32_16x16x32_bf16 v[108:111], v[64:67], v[84:87], v[108:111]
    v_mfma_f32_16x16x32_bf16 v[120:123], v[68:71], v[84:87], v[120:123]
    v_mfma_f32_16x16x32_bf16 v[132:135], v[72:75], v[84:87], v[132:135]
    s_mov_b32 s32, 0xffff0000
    s_waitcnt vmcnt(0)
    v_lshlrev_b32 v32, 16, v24
    v_and_b32 v33, s32, v24
    v_lshlrev_b32 v34, 16, v25
    v_and_b32 v35, s32, v25
    v_lshlrev_b32 v36, 16, v26
    v_and_b32 v37, s32, v26
    v_lshlrev_b32 v38, 16, v27
    v_and_b32 v39, s32, v27
    v_lshlrev_b32 v40, 16, v28
    v_and_b32 v41, s32, v28
    v_lshlrev_b32 v42, 16, v29
    v_and_b32 v43, s32, v29
    v_lshlrev_b32 v44, 16, v30
    v_and_b32 v45, s32, v30
    v_lshlrev_b32 v46, 16, v31
    v_and_b32 v47, s32, v31
    v_lshlrev_b32 v7, 4, v1
    s_mul_i32 s38, s35, 6
    s_mul_i32 s39, s37, 3
    s_add_u32 s38, s38, s39
    s_lshl_b32 s39, s34, 2
    s_lshl_b32 s40, s36, 1
    s_add_u32 s39, s39, s40
    s_mul_i32 s39, s39, 9
    s_add_u32 s40, s38, 0
    s_mul_i32 s41, s40, 57
    s_lshr_b32 s41, s41, 9
    s_mul_i32 s41, s41, 1287
    s_add_u32 s40, s40, s41
    s_add_u32 s40, s40, s39
    s_lshl_b32 s44, s40, 10
    s_add_u32 s48, s44, 9216
    s_add_u32 s40, s38, 1
    s_mul_i32 s41, s40, 57
    s_lshr_b32 s41, s41, 9
    s_mul_i32 s41, s41, 1287
    s_add_u32 s40, s40, s41
    s_add_u32 s40, s40, s39
    s_lshl_b32 s45, s40, 10
    s_add_u32 s49, s45, 9216
    s_add_u32 s40, s38, 2
    s_mul_i32 s41, s40, 57
    s_lshr_b32 s41, s41, 9
    s_mul_i32 s41, s41, 1287
    s_add_u32 s40, s40, s41
    s_add_u32 s40, s40, s39
    s_lshl_b32 s46, s40, 10
    s_add_u32 s50, s46, 9216
    s_mov_b32 s53, 0xbdd2d3e8
    v_mov_b32 v68, 0xc0135761
    v_cvt_pk_bf16_f32 v60, v88, v89
    v_lshlrev_b32 v88, 16, v60
    v_and_b32 v89, s32, v60
    v_cvt_pk_bf16_f32 v61, v90, v91
    v_lshlrev_b32 v90, 16, v61
    v_and_b32 v91, s32, v61
    v_add_f32 v88, v88, v32
    v_add_f32 v89, v89, v33
    v_add_f32 v90, v90, v34
    v_add_f32 v91, v91, v35
    v_cvt_pk_bf16_f32 v60, v88, v89
    v_lshlrev_b32 v88, 16, v60
    v_and_b32 v89, s32, v60
    v_cvt_pk_bf16_f32 v61, v90, v91
    v_lshlrev_b32 v90, 16, v61
    v_and_b32 v91, s32, v61
    v_mul_f32 v64, v88, v88
    v_mul_f32 v65, v89, v89
    v_mul_f32 v66, v90, v90
    v_mul_f32 v67, v91, v91
    v_fma_f32 v64, v64, s53, v68
    v_fma_f32 v65, v65, s53, v68
    v_fma_f32 v66, v66, s53, v68
    v_fma_f32 v67, v67, s53, v68
    v_mul_f32 v64, v64, v88
    v_mul_f32 v65, v65, v89
    v_mul_f32 v66, v66, v90
    v_mul_f32 v67, v67, v91
    v_exp_f32 v64, v64
    v_exp_f32 v65, v65
    v_exp_f32 v66, v66
    v_exp_f32 v67, v67
    v_add_f32 v64, 1.0, v64
    v_add_f32 v65, 1.0, v65
    v_add_f32 v66, 1.0, v66
    v_add_f32 v67, 1.0, v67
    v_rcp_f32 v64, v64
    v_rcp_f32 v65, v65
    v_rcp_f32 v66, v66
    v_rcp_f32 v67, v67
    v_mul_f32 v88, v88, v64
    v_mul_f32 v89, v89, v65
    v_mul_f32 v90, v90, v66
    v_mul_f32 v91, v91, v67
    v_cvt_pk_bf16_f32 v72, v88, v89
    v_cvt_pk_bf16_f32 v73, v90, v91
    v_cvt_pk_bf16_f32 v60, v100, v101
    v_lshlrev_b32 v100, 16, v60
    v_and_b32 v101, s32, v60
    v_cvt_pk_bf16_f32 v61, v102, v103
    v_lshlrev_b32 v102, 16, v61
    v_and_b32 v103, s32, v61
    v_add_f32 v100, v100, v36
    v_add_f32 v101, v101, v37
    v_add_f32 v102, v102, v38
    v_add_f32 v103, v103, v39
    v_cvt_pk_bf16_f32 v60, v100, v101
    v_lshlrev_b32 v100, 16, v60
    v_and_b32 v101, s32, v60
    v_cvt_pk_bf16_f32 v61, v102, v103
    v_lshlrev_b32 v102, 16, v61
    v_and_b32 v103, s32, v61
    v_mul_f32 v64, v100, v100
    v_mul_f32 v65, v101, v101
    v_mul_f32 v66, v102, v102
    v_mul_f32 v67, v103, v103
    v_fma_f32 v64, v64, s53, v68
    v_fma_f32 v65, v65, s53, v68
    v_fma_f32 v66, v66, s53, v68
    v_fma_f32 v67, v67, s53, v68
    v_mul_f32 v64, v64, v100
    v_mul_f32 v65, v65, v101
    v_mul_f32 v66, v66, v102
    v_mul_f32 v67, v67, v103
    v_exp_f32 v64, v64
    v_exp_f32 v65, v65
    v_exp_f32 v66, v66
    v_exp_f32 v67, v67
    v_add_f32 v64, 1.0, v64
    v_add_f32 v65, 1.0, v65
    v_add_f32 v66, 1.0, v66
    v_add_f32 v67, 1.0, v67
    v_rcp_f32 v64, v64
    v_rcp_f32 v65, v65
    v_rcp_f32 v66, v66
    v_rcp_f32 v67, v67
    v_mul_f32 v100, v100, v64
    v_mul_f32 v101, v101, v65
    v_mul_f32 v102, v102, v66
    v_mul_f32 v103, v103, v67
    v_cvt_pk_bf16_f32 v74, v100, v101
    v_cvt_pk_bf16_f32 v75, v102, v103
    buffer_store_dwordx4 v[72:75], v7, s[12:15], s44 offen
    v_cvt_pk_bf16_f32 v60, v112, v113
    v_lshlrev_b32 v112, 16, v60
    v_and_b32 v113, s32, v60
    v_cvt_pk_bf16_f32 v61, v114, v115
    v_lshlrev_b32 v114, 16, v61
    v_and_b32 v115, s32, v61
    v_add_f32 v112, v112, v40
    v_add_f32 v113, v113, v41
    v_add_f32 v114, v114, v42
    v_add_f32 v115, v115, v43
    v_cvt_pk_bf16_f32 v60, v112, v113
    v_lshlrev_b32 v112, 16, v60
    v_and_b32 v113, s32, v60
    v_cvt_pk_bf16_f32 v61, v114, v115
    v_lshlrev_b32 v114, 16, v61
    v_and_b32 v115, s32, v61
    v_mul_f32 v64, v112, v112
    v_mul_f32 v65, v113, v113
    v_mul_f32 v66, v114, v114
    v_mul_f32 v67, v115, v115
    v_fma_f32 v64, v64, s53, v68
    v_fma_f32 v65, v65, s53, v68
    v_fma_f32 v66, v66, s53, v68
    v_fma_f32 v67, v67, s53, v68
    v_mul_f32 v64, v64, v112
    v_mul_f32 v65, v65, v113
    v_mul_f32 v66, v66, v114
    v_mul_f32 v67, v67, v115
    v_exp_f32 v64, v64
    v_exp_f32 v65, v65
    v_exp_f32 v66, v66
    v_exp_f32 v67, v67
    v_add_f32 v64, 1.0, v64
    v_add_f32 v65, 1.0, v65
    v_add_f32 v66, 1.0, v66
    v_add_f32 v67, 1.0, v67
    v_rcp_f32 v64, v64
    v_rcp_f32 v65, v65
    v_rcp_f32 v66, v66
    v_rcp_f32 v67, v67
    v_mul_f32 v112, v112, v64
    v_mul_f32 v113, v113, v65
    v_mul_f32 v114, v114, v66
    v_mul_f32 v115, v115, v67
    v_cvt_pk_bf16_f32 v76, v112, v113
    v_cvt_pk_bf16_f32 v77, v114, v115
    v_cvt_pk_bf16_f32 v60, v124, v125
    v_lshlrev_b32 v124, 16, v60
    v_and_b32 v125, s32, v60
    v_cvt_pk_bf16_f32 v61, v126, v127
    v_lshlrev_b32 v126, 16, v61
    v_and_b32 v127, s32, v61
    v_add_f32 v124, v124, v44
    v_add_f32 v125, v125, v45
    v_add_f32 v126, v126, v46
    v_add_f32 v127, v127, v47
    v_cvt_pk_bf16_f32 v60, v124, v125
    v_lshlrev_b32 v124, 16, v60
    v_and_b32 v125, s32, v60
    v_cvt_pk_bf16_f32 v61, v126, v127
    v_lshlrev_b32 v126, 16, v61
    v_and_b32 v127, s32, v61
    v_mul_f32 v64, v124, v124
    v_mul_f32 v65, v125, v125
    v_mul_f32 v66, v126, v126
    v_mul_f32 v67, v127, v127
    v_fma_f32 v64, v64, s53, v68
    v_fma_f32 v65, v65, s53, v68
    v_fma_f32 v66, v66, s53, v68
    v_fma_f32 v67, v67, s53, v68
    v_mul_f32 v64, v64, v124
    v_mul_f32 v65, v65, v125
    v_mul_f32 v66, v66, v126
    v_mul_f32 v67, v67, v127
    v_exp_f32 v64, v64
    v_exp_f32 v65, v65
    v_exp_f32 v66, v66
    v_exp_f32 v67, v67
    v_add_f32 v64, 1.0, v64
    v_add_f32 v65, 1.0, v65
    v_add_f32 v66, 1.0, v66
    v_add_f32 v67, 1.0, v67
    v_rcp_f32 v64, v64
    v_rcp_f32 v65, v65
    v_rcp_f32 v66, v66
    v_rcp_f32 v67, v67
    v_mul_f32 v124, v124, v64
    v_mul_f32 v125, v125, v65
    v_mul_f32 v126, v126, v66
    v_mul_f32 v127, v127, v67
    v_cvt_pk_bf16_f32 v78, v124, v125
    v_cvt_pk_bf16_f32 v79, v126, v127
    buffer_store_dwordx4 v[76:79], v7, s[12:15], s48 offen
    v_cvt_pk_bf16_f32 v60, v92, v93
    v_lshlrev_b32 v92, 16, v60
    v_and_b32 v93, s32, v60
    v_cvt_pk_bf16_f32 v61, v94, v95
    v_lshlrev_b32 v94, 16, v61
    v_and_b32 v95, s32, v61
    v_add_f32 v92, v92, v32
    v_add_f32 v93, v93, v33
    v_add_f32 v94, v94, v34
    v_add_f32 v95, v95, v35
    v_cvt_pk_bf16_f32 v60, v92, v93
    v_lshlrev_b32 v92, 16, v60
    v_and_b32 v93, s32, v60
    v_cvt_pk_bf16_f32 v61, v94, v95
    v_lshlrev_b32 v94, 16, v61
    v_and_b32 v95, s32, v61
    v_mul_f32 v64, v92, v92
    v_mul_f32 v65, v93, v93
    v_mul_f32 v66, v94, v94
    v_mul_f32 v67, v95, v95
    v_fma_f32 v64, v64, s53, v68
    v_fma_f32 v65, v65, s53, v68
    v_fma_f32 v66, v66, s53, v68
    v_fma_f32 v67, v67, s53, v68
    v_mul_f32 v64, v64, v92
    v_mul_f32 v65, v65, v93
    v_mul_f32 v66, v66, v94
    v_mul_f32 v67, v67, v95
    v_exp_f32 v64, v64
    v_exp_f32 v65, v65
    v_exp_f32 v66, v66
    v_exp_f32 v67, v67
    v_add_f32 v64, 1.0, v64
    v_add_f32 v65, 1.0, v65
    v_add_f32 v66, 1.0, v66
    v_add_f32 v67, 1.0, v67
    v_rcp_f32 v64, v64
    v_rcp_f32 v65, v65
    v_rcp_f32 v66, v66
    v_rcp_f32 v67, v67
    v_mul_f32 v92, v92, v64
    v_mul_f32 v93, v93, v65
    v_mul_f32 v94, v94, v66
    v_mul_f32 v95, v95, v67
    v_cvt_pk_bf16_f32 v72, v92, v93
    v_cvt_pk_bf16_f32 v73, v94, v95
    v_cvt_pk_bf16_f32 v60, v104, v105
    v_lshlrev_b32 v104, 16, v60
    v_and_b32 v105, s32, v60
    v_cvt_pk_bf16_f32 v61, v106, v107
    v_lshlrev_b32 v106, 16, v61
    v_and_b32 v107, s32, v61
    v_add_f32 v104, v104, v36
    v_add_f32 v105, v105, v37
    v_add_f32 v106, v106, v38
    v_add_f32 v107, v107, v39
    v_cvt_pk_bf16_f32 v60, v104, v105
    v_lshlrev_b32 v104, 16, v60
    v_and_b32 v105, s32, v60
    v_cvt_pk_bf16_f32 v61, v106, v107
    v_lshlrev_b32 v106, 16, v61
    v_and_b32 v107, s32, v61
    v_mul_f32 v64, v104, v104
    v_mul_f32 v65, v105, v105
    v_mul_f32 v66, v106, v106
    v_mul_f32 v67, v107, v107
    v_fma_f32 v64, v64, s53, v68
    v_fma_f32 v65, v65, s53, v68
    v_fma_f32 v66, v66, s53, v68
    v_fma_f32 v67, v67, s53, v68
    v_mul_f32 v64, v64, v104
    v_mul_f32 v65, v65, v105
    v_mul_f32 v66, v66, v106
    v_mul_f32 v67, v67, v107
    v_exp_f32 v64, v64
    v_exp_f32 v65, v65
    v_exp_f32 v66, v66
    v_exp_f32 v67, v67
    v_add_f32 v64, 1.0, v64
    v_add_f32 v65, 1.0, v65
    v_add_f32 v66, 1.0, v66
    v_add_f32 v67, 1.0, v67
    v_rcp_f32 v64, v64
    v_rcp_f32 v65, v65
    v_rcp_f32 v66, v66
    v_rcp_f32 v67, v67
    v_mul_f32 v104, v104, v64
    v_mul_f32 v105, v105, v65
    v_mul_f32 v106, v106, v66
    v_mul_f32 v107, v107, v67
    v_cvt_pk_bf16_f32 v74, v104, v105
    v_cvt_pk_bf16_f32 v75, v106, v107
    buffer_store_dwordx4 v[72:75], v7, s[12:15], s45 offen
    v_cvt_pk_bf16_f32 v60, v116, v117
    v_lshlrev_b32 v116, 16, v60
    v_and_b32 v117, s32, v60
    v_cvt_pk_bf16_f32 v61, v118, v119
    v_lshlrev_b32 v118, 16, v61
    v_and_b32 v119, s32, v61
    v_add_f32 v116, v116, v40
    v_add_f32 v117, v117, v41
    v_add_f32 v118, v118, v42
    v_add_f32 v119, v119, v43
    v_cvt_pk_bf16_f32 v60, v116, v117
    v_lshlrev_b32 v116, 16, v60
    v_and_b32 v117, s32, v60
    v_cvt_pk_bf16_f32 v61, v118, v119
    v_lshlrev_b32 v118, 16, v61
    v_and_b32 v119, s32, v61
    v_mul_f32 v64, v116, v116
    v_mul_f32 v65, v117, v117
    v_mul_f32 v66, v118, v118
    v_mul_f32 v67, v119, v119
    v_fma_f32 v64, v64, s53, v68
    v_fma_f32 v65, v65, s53, v68
    v_fma_f32 v66, v66, s53, v68
    v_fma_f32 v67, v67, s53, v68
    v_mul_f32 v64, v64, v116
    v_mul_f32 v65, v65, v117
    v_mul_f32 v66, v66, v118
    v_mul_f32 v67, v67, v119
    v_exp_f32 v64, v64
    v_exp_f32 v65, v65
    v_exp_f32 v66, v66
    v_exp_f32 v67, v67
    v_add_f32 v64, 1.0, v64
    v_add_f32 v65, 1.0, v65
    v_add_f32 v66, 1.0, v66
    v_add_f32 v67, 1.0, v67
    v_rcp_f32 v64, v64
    v_rcp_f32 v65, v65
    v_rcp_f32 v66, v66
    v_rcp_f32 v67, v67
    v_mul_f32 v116, v116, v64
    v_mul_f32 v117, v117, v65
    v_mul_f32 v118, v118, v66
    v_mul_f32 v119, v119, v67
    v_cvt_pk_bf16_f32 v76, v116, v117
    v_cvt_pk_bf16_f32 v77, v118, v119
    v_cvt_pk_bf16_f32 v60, v128, v129
    v_lshlrev_b32 v128, 16, v60
    v_and_b32 v129, s32, v60
    v_cvt_pk_bf16_f32 v61, v130, v131
    v_lshlrev_b32 v130, 16, v61
    v_and_b32 v131, s32, v61
    v_add_f32 v128, v128, v44
    v_add_f32 v129, v129, v45
    v_add_f32 v130, v130, v46
    v_add_f32 v131, v131, v47
    v_cvt_pk_bf16_f32 v60, v128, v129
    v_lshlrev_b32 v128, 16, v60
    v_and_b32 v129, s32, v60
    v_cvt_pk_bf16_f32 v61, v130, v131
    v_lshlrev_b32 v130, 16, v61
    v_and_b32 v131, s32, v61
    v_mul_f32 v64, v128, v128
    v_mul_f32 v65, v129, v129
    v_mul_f32 v66, v130, v130
    v_mul_f32 v67, v131, v131
    v_fma_f32 v64, v64, s53, v68
    v_fma_f32 v65, v65, s53, v68
    v_fma_f32 v66, v66, s53, v68
    v_fma_f32 v67, v67, s53, v68
    v_mul_f32 v64, v64, v128
    v_mul_f32 v65, v65, v129
    v_mul_f32 v66, v66, v130
    v_mul_f32 v67, v67, v131
    v_exp_f32 v64, v64
    v_exp_f32 v65, v65
    v_exp_f32 v66, v66
    v_exp_f32 v67, v67
    v_add_f32 v64, 1.0, v64
    v_add_f32 v65, 1.0, v65
    v_add_f32 v66, 1.0, v66
    v_add_f32 v67, 1.0, v67
    v_rcp_f32 v64, v64
    v_rcp_f32 v65, v65
    v_rcp_f32 v66, v66
    v_rcp_f32 v67, v67
    v_mul_f32 v128, v128, v64
    v_mul_f32 v129, v129, v65
    v_mul_f32 v130, v130, v66
    v_mul_f32 v131, v131, v67
    v_cvt_pk_bf16_f32 v78, v128, v129
    v_cvt_pk_bf16_f32 v79, v130, v131
    buffer_store_dwordx4 v[76:79], v7, s[12:15], s49 offen
    v_cvt_pk_bf16_f32 v60, v96, v97
    v_lshlrev_b32 v96, 16, v60
    v_and_b32 v97, s32, v60
    v_cvt_pk_bf16_f32 v61, v98, v99
    v_lshlrev_b32 v98, 16, v61
    v_and_b32 v99, s32, v61
    v_add_f32 v96, v96, v32
    v_add_f32 v97, v97, v33
    v_add_f32 v98, v98, v34
    v_add_f32 v99, v99, v35
    v_cvt_pk_bf16_f32 v60, v96, v97
    v_lshlrev_b32 v96, 16, v60
    v_and_b32 v97, s32, v60
    v_cvt_pk_bf16_f32 v61, v98, v99
    v_lshlrev_b32 v98, 16, v61
    v_and_b32 v99, s32, v61
    v_mul_f32 v64, v96, v96
    v_mul_f32 v65, v97, v97
    v_mul_f32 v66, v98, v98
    v_mul_f32 v67, v99, v99
    v_fma_f32 v64, v64, s53, v68
    v_fma_f32 v65, v65, s53, v68
    v_fma_f32 v66, v66, s53, v68
    v_fma_f32 v67, v67, s53, v68
    v_mul_f32 v64, v64, v96
    v_mul_f32 v65, v65, v97
    v_mul_f32 v66, v66, v98
    v_mul_f32 v67, v67, v99
    v_exp_f32 v64, v64
    v_exp_f32 v65, v65
    v_exp_f32 v66, v66
    v_exp_f32 v67, v67
    v_add_f32 v64, 1.0, v64
    v_add_f32 v65, 1.0, v65
    v_add_f32 v66, 1.0, v66
    v_add_f32 v67, 1.0, v67
    v_rcp_f32 v64, v64
    v_rcp_f32 v65, v65
    v_rcp_f32 v66, v66
    v_rcp_f32 v67, v67
    v_mul_f32 v96, v96, v64
    v_mul_f32 v97, v97, v65
    v_mul_f32 v98, v98, v66
    v_mul_f32 v99, v99, v67
    v_cvt_pk_bf16_f32 v72, v96, v97
    v_cvt_pk_bf16_f32 v73, v98, v99
    v_cvt_pk_bf16_f32 v60, v108, v109
    v_lshlrev_b32 v108, 16, v60
    v_and_b32 v109, s32, v60
    v_cvt_pk_bf16_f32 v61, v110, v111
    v_lshlrev_b32 v110, 16, v61
    v_and_b32 v111, s32, v61
    v_add_f32 v108, v108, v36
    v_add_f32 v109, v109, v37
    v_add_f32 v110, v110, v38
    v_add_f32 v111, v111, v39
    v_cvt_pk_bf16_f32 v60, v108, v109
    v_lshlrev_b32 v108, 16, v60
    v_and_b32 v109, s32, v60
    v_cvt_pk_bf16_f32 v61, v110, v111
    v_lshlrev_b32 v110, 16, v61
    v_and_b32 v111, s32, v61
    v_mul_f32 v64, v108, v108
    v_mul_f32 v65, v109, v109
    v_mul_f32 v66, v110, v110
    v_mul_f32 v67, v111, v111
    v_fma_f32 v64, v64, s53, v68
    v_fma_f32 v65, v65, s53, v68
    v_fma_f32 v66, v66, s53, v68
    v_fma_f32 v67, v67, s53, v68
    v_mul_f32 v64, v64, v108
    v_mul_f32 v65, v65, v109
    v_mul_f32 v66, v66, v110
    v_mul_f32 v67, v67, v111
    v_exp_f32 v64, v64
    v_exp_f32 v65, v65
    v_exp_f32 v66, v66
    v_exp_f32 v67, v67
    v_add_f32 v64, 1.0, v64
    v_add_f32 v65, 1.0, v65
    v_add_f32 v66, 1.0, v66
    v_add_f32 v67, 1.0, v67
    v_rcp_f32 v64, v64
    v_rcp_f32 v65, v65
    v_rcp_f32 v66, v66
    v_rcp_f32 v67, v67
    v_mul_f32 v108, v108, v64
    v_mul_f32 v109, v109, v65
    v_mul_f32 v110, v110, v66
    v_mul_f32 v111, v111, v67
    v_cvt_pk_bf16_f32 v74, v108, v109
    v_cvt_pk_bf16_f32 v75, v110, v111
    buffer_store_dwordx4 v[72:75], v7, s[12:15], s46 offen
    v_cvt_pk_bf16_f32 v60, v120, v121
    v_lshlrev_b32 v120, 16, v60
    v_and_b32 v121, s32, v60
    v_cvt_pk_bf16_f32 v61, v122, v123
    v_lshlrev_b32 v122, 16, v61
    v_and_b32 v123, s32, v61
    v_add_f32 v120, v120, v40
    v_add_f32 v121, v121, v41
    v_add_f32 v122, v122, v42
    v_add_f32 v123, v123, v43
    v_cvt_pk_bf16_f32 v60, v120, v121
    v_lshlrev_b32 v120, 16, v60
    v_and_b32 v121, s32, v60
    v_cvt_pk_bf16_f32 v61, v122, v123
    v_lshlrev_b32 v122, 16, v61
    v_and_b32 v123, s32, v61
    v_mul_f32 v64, v120, v120
    v_mul_f32 v65, v121, v121
    v_mul_f32 v66, v122, v122
    v_mul_f32 v67, v123, v123
    v_fma_f32 v64, v64, s53, v68
    v_fma_f32 v65, v65, s53, v68
    v_fma_f32 v66, v66, s53, v68
    v_fma_f32 v67, v67, s53, v68
    v_mul_f32 v64, v64, v120
    v_mul_f32 v65, v65, v121
    v_mul_f32 v66, v66, v122
    v_mul_f32 v67, v67, v123
    v_exp_f32 v64, v64
    v_exp_f32 v65, v65
    v_exp_f32 v66, v66
    v_exp_f32 v67, v67
    v_add_f32 v64, 1.0, v64
    v_add_f32 v65, 1.0, v65
    v_add_f32 v66, 1.0, v66
    v_add_f32 v67, 1.0, v67
    v_rcp_f32 v64, v64
    v_rcp_f32 v65, v65
    v_rcp_f32 v66, v66
    v_rcp_f32 v67, v67
    v_mul_f32 v120, v120, v64
    v_mul_f32 v121, v121, v65
    v_mul_f32 v122, v122, v66
    v_mul_f32 v123, v123, v67
    v_cvt_pk_bf16_f32 v76, v120, v121
    v_cvt_pk_bf16_f32 v77, v122, v123
    v_cvt_pk_bf16_f32 v60, v132, v133
    v_lshlrev_b32 v132, 16, v60
    v_and_b32 v133, s32, v60
    v_cvt_pk_bf16_f32 v61, v134, v135
    v_lshlrev_b32 v134, 16, v61
    v_and_b32 v135, s32, v61
    v_add_f32 v132, v132, v44
    v_add_f32 v133, v133, v45
    v_add_f32 v134, v134, v46
    v_add_f32 v135, v135, v47
    v_cvt_pk_bf16_f32 v60, v132, v133
    v_lshlrev_b32 v132, 16, v60
    v_and_b32 v133, s32, v60
    v_cvt_pk_bf16_f32 v61, v134, v135
    v_lshlrev_b32 v134, 16, v61
    v_and_b32 v135, s32, v61
    v_mul_f32 v64, v132, v132
    v_mul_f32 v65, v133, v133
    v_mul_f32 v66, v134, v134
    v_mul_f32 v67, v135, v135
    v_fma_f32 v64, v64, s53, v68
    v_fma_f32 v65, v65, s53, v68
    v_fma_f32 v66, v66, s53, v68
    v_fma_f32 v67, v67, s53, v68
    v_mul_f32 v64, v64, v132
    v_mul_f32 v65, v65, v133
    v_mul_f32 v66, v66, v134
    v_mul_f32 v67, v67, v135
    v_exp_f32 v64, v64
    v_exp_f32 v65, v65
    v_exp_f32 v66, v66
    v_exp_f32 v67, v67
    v_add_f32 v64, 1.0, v64
    v_add_f32 v65, 1.0, v65
    v_add_f32 v66, 1.0, v66
    v_add_f32 v67, 1.0, v67
    v_rcp_f32 v64, v64
    v_rcp_f32 v65, v65
    v_rcp_f32 v66, v66
    v_rcp_f32 v67, v67
    v_mul_f32 v132, v132, v64
    v_mul_f32 v133, v133, v65
    v_mul_f32 v134, v134, v66
    v_mul_f32 v135, v135, v67
    v_cvt_pk_bf16_f32 v78, v132, v133
    v_cvt_pk_bf16_f32 v79, v134, v135
    buffer_store_dwordx4 v[76:79], v7, s[12:15], s50 offen
g1_done:
    s_endpgm
g1_pf:
    s_cmp_ge_u32 s2, 256
    s_cbranch_scc1 g1_done
    v_and_b32 v1, 63, v0
    v_lshrrev_b32 v2, 6, v0
    s_nop 0
    v_readfirstlane_b32 s4, v2
    s_sub_u32 s5, s2, 216
    s_lshr_b32 s5, s5, 3
    s_lshl_b32 s5, s5, 3
    s_add_u32 s5, s5, s4
    s_and_b32 s3, s2, 7
    s_load_dwordx2 s[8:9], s[0:1], 48
    s_and_b32 s12, s3, 1
    s_lshl_b32 s12, s12, 11
    s_lshr_b32 s13, s3, 1
    s_mul_i32 s13, s13, 4718592
    s_add_u32 s12, s12, s13
    s_add_u32 s13, 0, s5
    s_lshl_b32 s13, s13, 14
    s_add_u32 s13, s13, s12
    v_lshrrev_b32 v2, 4, v1
    v_lshlrev_b32 v2, 12, v2
    v_and_b32 v3, 15, v1
    v_lshl_add_u32 v2, v3, 7, v2
    s_waitcnt lgkmcnt(0)
    s_mov_b32 s10, 0x1200000
    s_mov_b32 s11, 0x20000
    buffer_load_dword v4, v2, s[8:11], s13 offen
    s_add_u32 s13, s13, 655360
    s_waitcnt vmcnt(0)
    buffer_load_dword v4, v2, s[8:11], s13 offen
    s_add_u32 s13, s13, 655360
    s_waitcnt vmcnt(0)
    buffer_load_dword v4, v2, s[8:11], s13 offen
    s_add_u32 s13, s13, 655360
    s_waitcnt vmcnt(0)
    buffer_load_dword v4, v2, s[8:11], s13 offen
    s_add_u32 s13, s13, 655360
    s_waitcnt vmcnt(0)
    buffer_load_dword v4, v2, s[8:11], s13 offen
    s_add_u32 s13, s13, 655360
    s_waitcnt vmcnt(0)
    buffer_load_dword v4, v2, s[8:11], s13 offen
    s_add_u32 s13, s13, 655360
    s_waitcnt vmcnt(0)
    buffer_load_dword v4, v2, s[8:11], s13 offen
    s_add_u32 s13, s13, 655360
    s_cmp_lt_u32 s5, 8
    s_cbranch_scc0 pfskip_4
    s_waitcnt vmcnt(0)
    buffer_load_dword v4, v2, s[8:11], s13 offen
pfskip_4:
    s_endpgm
.globl g2_kernel
.p2align 8
.type g2_kernel,@function
g2_kernel:
    s_cmp_ge_u32 s2, 256
    s_cbranch_scc1 g2_done
    s_load_dwordx2 s[4:5], s[0:1], 96
    s_load_dwordx4 s[16:19], s[0:1], 48
    s_load_dwordx2 s[6:7], s[0:1], 80
    v_lshrrev_b32 v2, 6, v0
    s_nop 0
    v_readfirstlane_b32 s3, v2
    s_and_b32 s33, s2, 7
    s_lshr_b32 s34, s2, 3
    s_lshr_b32 s35, s33, 1
    s_and_b32 s36, s33, 1
    s_lshl_b32 s36, s36, 3
    s_lshr_b32 s37, s34, 2
    s_add_u32 s36, s36, s37
    s_and_b32 s37, s34, 3
    s_mul_i32 s20, s35, 4718592
    s_lshl_b32 s38, s36, 8
    s_add_u32 s20, s20, s38
    s_mul_i32 s21, s37, 144
    s_mul_i32 s38, s35, 36
    s_add_u32 s21, s21, s38
    s_mul_i32 s21, s21, 9216
    s_waitcnt lgkmcnt(0)
    s_cmp_lt_u32 s3, 4
    s_cbranch_scc1 g2_cons
    s_mov_b32 s8, s16
    s_mov_b32 s9, s17
    s_mov_b32 s10, 0x1200000
    s_mov_b32 s11, 0x20000
    s_add_u32 s12, s4, 0x1000000
    s_addc_u32 s13, s5, 0
    s_mov_b32 s14, 0x510000
    s_mov_b32 s15, 0x20000
    v_and_b32 v1, 63, v0
    v_lshrrev_b32 v2, 4, v1
    v_and_b32 v3, 15, v1
    v_lshlrev_b32 v4, 1, v2
    v_xor_b32 v4, v4, v3
    v_xor_b32 v5, 8, v4
    s_movk_i32 s22, 4096
    v_mul_lo_u32 v2, v2, s22
    v_lshl_add_u32 v4, v4, 4, v2
    v_lshl_add_u32 v5, v5, 4, v2
    v_lshlrev_b32 v6, 4, v1
    s_sub_u32 s23, s3, 4
    s_mul_i32 s24, s23, 65536
    s_add_u32 s20, s20, s24
    s_mul_i32 s24, s23, 4608
    s_add_u32 s21, s21, s24
    s_lshl_b32 s25, s23, 12
    s_add_u32 s26, s24, 16384
    s_mov_b32 s27, 0
    s_add_u32 m0, s27, s25
    s_nop 0
    buffer_load_dwordx4 v4, s[8:11], s20 offen offset:0 lds
    s_add_u32 s28, s20, 15360
    buffer_load_dwordx4 v5, s[8:11], s28 offen offset:1024 lds
    s_add_u32 s29, s20, 30720
    buffer_load_dwordx4 v4, s[8:11], s29 offen offset:2048 lds
    s_add_u32 s30, s20, 46080
    buffer_load_dwordx4 v5, s[8:11], s30 offen offset:3072 lds
    s_add_u32 m0, s27, s26
    s_add_u32 s20, s20, 262144
    s_mov_b64 exec, 0xffffffff
    buffer_load_dwordx4 v6, s[12:15], s21 offen lds
    s_mov_b64 exec, -1
    buffer_load_dwordx4 v6, s[12:15], s21 offen offset:512 lds
    buffer_load_dwordx4 v6, s[12:15], s21 offen offset:1536 lds
    buffer_load_dwordx4 v6, s[12:15], s21 offen offset:2560 lds
    buffer_load_dwordx4 v6, s[12:15], s21 offen offset:3584 lds
    s_add_u32 s21, s21, 18432
    s_add_u32 s27, s27, 34816
    s_cmp_eq_u32 s27, 139264
    s_cselect_b32 s27, 0, s27
    s_add_u32 m0, s27, s25
    s_nop 0
    buffer_load_dwordx4 v4, s[8:11], s20 offen offset:0 lds
    s_add_u32 s28, s20, 15360
    buffer_load_dwordx4 v5, s[8:11], s28 offen offset:1024 lds
    s_add_u32 s29, s20, 30720
    buffer_load_dwordx4 v4, s[8:11], s29 offen offset:2048 lds
    s_add_u32 s30, s20, 46080
    buffer_load_dwordx4 v5, s[8:11], s30 offen offset:3072 lds
    s_add_u32 m0, s27, s26
    s_add_u32 s20, s20, 262144
    s_mov_b64 exec, 0xffffffff
    buffer_load_dwordx4 v6, s[12:15], s21 offen lds
    s_mov_b64 exec, -1
    buffer_load_dwordx4 v6, s[12:15], s21 offen offset:512 lds
    buffer_load_dwordx4 v6, s[12:15], s21 offen offset:1536 lds
    buffer_load_dwordx4 v6, s[12:15], s21 offen offset:2560 lds
    buffer_load_dwordx4 v6, s[12:15], s21 offen offset:3584 lds
    s_add_u32 s21, s21, 18432
    s_add_u32 s27, s27, 34816
    s_cmp_eq_u32 s27, 139264
    s_cselect_b32 s27, 0, s27
    s_add_u32 m0, s27, s25
    s_nop 0
    buffer_load_dwordx4 v4, s[8:11], s20 offen offset:0 lds
    s_add_u32 s28, s20, 15360
    buffer_load_dwordx4 v5, s[8:11], s28 offen offset:1024 lds
    s_add_u32 s29, s20, 30720
    buffer_load_dwordx4 v4, s[8:11], s29 offen offset:2048 lds
    s_add_u32 s30, s20, 46080
    buffer_load_dwordx4 v5, s[8:11], s30 offen offset:3072 lds
    s_add_u32 m0, s27, s26
    s_add_u32 s20, s20, 262144
    s_mov_b64 exec, 0xffffffff
    buffer_load_dwordx4 v6, s[12:15], s21 offen lds
    s_mov_b64 exec, -1
    buffer_load_dwordx4 v6, s[12:15], s21 offen offset:512 lds
    buffer_load_dwordx4 v6, s[12:15], s21 offen offset:1536 lds
    buffer_load_dwordx4 v6, s[12:15], s21 offen offset:2560 lds
    buffer_load_dwordx4 v6, s[12:15], s21 offen offset:3584 lds
    s_add_u32 s21, s21, 18432
    s_add_u32 s27, s27, 34816
    s_cmp_eq_u32 s27, 139264
    s_cselect_b32 s27, 0, s27
    s_movk_i32 s31, 15
g2_ld_loop:
    s_waitcnt vmcnt(18)
    s_barrier
    s_add_u32 m0, s27, s25
    s_nop 0
    buffer_load_dwordx4 v4, s[8:11], s20 offen offset:0 lds
    s_add_u32 s28, s20, 15360
    buffer_load_dwordx4 v5, s[8:11], s28 offen offset:1024 lds
    s_add_u32 s29, s20, 30720
    buffer_load_dwordx4 v4, s[8:11], s29 offen offset:2048 lds
    s_add_u32 s30, s20, 46080
    buffer_load_dwordx4 v5, s[8:11], s30 offen offset:3072 lds
    s_add_u32 m0, s27, s26
    s_add_u32 s20, s20, 262144
    s_mov_b64 exec, 0xffffffff
    buffer_load_dwordx4 v6, s[12:15], s21 offen lds
    s_mov_b64 exec, -1
    buffer_load_dwordx4 v6, s[12:15], s21 offen offset:512 lds
    buffer_load_dwordx4 v6, s[12:15], s21 offen offset:1536 lds
    buffer_load_dwordx4 v6, s[12:15], s21 offen offset:2560 lds
    buffer_load_dwordx4 v6, s[12:15], s21 offen offset:3584 lds
    s_add_u32 s21, s21, 18432
    s_add_u32 s27, s27, 34816
    s_cmp_eq_u32 s27, 139264
    s_cselect_b32 s27, 0, s27
    s_sub_u32 s31, s31, 1
    s_cmp_lg_u32 s31, 0
    s_cbranch_scc1 g2_ld_loop
    s_waitcnt vmcnt(18)
    s_barrier
    s_waitcnt vmcnt(9)
    s_barrier
    s_waitcnt vmcnt(0)
    s_barrier
    s_branch g2_done
g2_cons:
    s_mov_b32 s8, s18
    s_mov_b32 s9, s19
    s_mov_b32 s10, 0x1000
    s_mov_b32 s11, 0x20000
    s_mov_b32 s12, s4
    s_mov_b32 s13, s5
    s_mov_b32 s14, 0x3600
    s_mov_b32 s15, 0x20000
    s_add_u32 s56, s4, 0xa00000
    s_addc_u32 s57, s5, 0
    s_mov_b32 s58, 0x240000
    s_mov_b32 s59, 0x20000
    s_mov_b32 s60, s6
    s_mov_b32 s61, s7
    s_mov_b32 s62, 0x240000
    s_mov_b32 s63, 0x20000
    s_add_u32 s64, s4, 0x1800000
    s_addc_u32 s65, s5, 0
    s_mov_b32 s66, 0xc00000
    s_mov_b32 s67, 0x20000
    s_add_u32 s68, s4, 0x10000
    s_addc_u32 s69, s5, 0
    s_mov_b32 s70, 0x10000
    s_mov_b32 s71, 0x20000
    v_and_b32 v1, 63, v0
    v_and_b32 v5, 15, v1
    v_lshrrev_b32 v6, 4, v1
    s_lshr_b32 s38, s35, 1
    s_and_b32 s39, s35, 1
    s_lshl_b32 s40, s3, 1
    s_add_u32 s40, s40, s38
    s_xor_b32 s41, s40, 1
    v_lshrrev_b32 v2, 2, v5
    v_and_b32 v3, 1, v6
    v_lshl_add_u32 v3, v3, 2, v2
    v_mad_u32_u24 v2, v6, 4, v2
    v_lshlrev_b32 v2, 8, v2
    v_and_b32 v4, 3, v1
    v_lshl_add_u32 v2, v4, 3, v2
    v_xor_b32 v4, s40, v3
    v_lshl_add_u32 v8, v4, 5, v2
    v_xor_b32 v4, s41, v3
    v_lshl_add_u32 v9, v4, 5, v2
    v_lshlrev_b32 v7, 4, v1
    s_lshl_b32 s42, s39, 12
    s_add_u32 s43, s42, 16384
    v_add_u32 v10, s43, v7
    s_xor_b32 s43, s43, 4096
    v_add_u32 v11, s43, v7
    v_add_u32 v12, 24576, v7
    s_lshl_b32 s44, s36, 3
    s_add_u32 s44, s44, s40
    s_lshl_b32 s44, s44, 4
    v_add_u32 v2, s44, v5
    v_mov_b32 v214, 0
    v_lshlrev_b32 v3, 1, v2
    buffer_load_short_d16_hi v214, v3, s[8:11], 0 offen
    v_mul_u32_u24 v2, 1152, v2
    v_lshl_add_u32 v22, v6, 3, v2
    s_mul_i32 s45, s37, 288
    s_lshl_b32 s46, s39, 7
    s_add_u32 s46, s46, s45
    s_lshl_b32 s47, s39, 2
    s_add_u32 s47, s47, s45
    s_add_u32 s47, s47, 256
    buffer_load_dwordx2 v[184:185], v22, s[56:59], s46 offen offset:0
    buffer_load_dwordx2 v[186:187], v22, s[56:59], s46 offen offset:32
    buffer_load_dwordx2 v[188:189], v22, s[56:59], s46 offen offset:64
    buffer_load_dwordx2 v[190:191], v22, s[56:59], s46 offen offset:96
    buffer_load_dword v192, v22, s[56:59], s47 offen
    v_lshlrev_b32 v3, 4, v6
    s_lshl_b32 s48, s46, 1
    s_add_u32 s48, s48, 11520
    s_lshl_b32 s49, s47, 1
    s_add_u32 s49, s49, 11520
    buffer_load_dwordx4 v[194:197], v3, s[12:15], s48 offen offset:0
    buffer_load_dwordx4 v[198:201], v3, s[12:15], s48 offen offset:64
    buffer_load_dwordx4 v[202:205], v3, s[12:15], s48 offen offset:128
    buffer_load_dwordx4 v[206:209], v3, s[12:15], s48 offen offset:192
    buffer_load_dwordx2 v[210:211], v3, s[12:15], s49 offen
    v_mov_b32 v112, 0
    v_mov_b32 v113, 0
    v_mov_b32 v114, 0
    v_mov_b32 v115, 0
    v_mov_b32 v116, 0
    v_mov_b32 v117, 0
    v_mov_b32 v118, 0
    v_mov_b32 v119, 0
    v_mov_b32 v120, 0
    v_mov_b32 v121, 0
    v_mov_b32 v122, 0
    v_mov_b32 v123, 0
    v_mov_b32 v124, 0
    v_mov_b32 v125, 0
    v_mov_b32 v126, 0
    v_mov_b32 v127, 0
    v_mov_b32 v128, 0
    v_mov_b32 v129, 0
    v_mov_b32 v130, 0
    v_mov_b32 v131, 0
    v_mov_b32 v132, 0
    v_mov_b32 v133, 0
    v_mov_b32 v134, 0
    v_mov_b32 v135, 0
    v_mov_b32 v136, 0
    v_mov_b32 v137, 0
    v_mov_b32 v138, 0
    v_mov_b32 v139, 0
    v_mov_b32 v140, 0
    v_mov_b32 v141, 0
    v_mov_b32 v142, 0
    v_mov_b32 v143, 0
    v_mov_b32 v144, 0
    v_mov_b32 v145, 0
    v_mov_b32 v146, 0
    v_mov_b32 v147, 0
    v_mov_b32 v148, 0
    v_mov_b32 v149, 0
    v_mov_b32 v150, 0
    v_mov_b32 v151, 0
    v_mov_b32 v152, 0
    v_mov_b32 v153, 0
    v_mov_b32 v154, 0
    v_mov_b32 v155, 0
    v_mov_b32 v156, 0
    v_mov_b32 v157, 0
    v_mov_b32 v158, 0
    v_mov_b32 v159, 0
    v_mov_b32 v160, 0
    v_mov_b32 v161, 0
    v_mov_b32 v162, 0
    v_mov_b32 v163, 0
    v_mov_b32 v164, 0
    v_mov_b32 v165, 0
    v_mov_b32 v166, 0
    v_mov_b32 v167, 0
    v_mov_b32 v168, 0
    v_mov_b32 v169, 0
    v_mov_b32 v170, 0
    v_mov_b32 v171, 0
    v_mov_b32 v172, 0
    v_mov_b32 v173, 0
    v_mov_b32 v174, 0
    v_mov_b32 v175, 0
    v_mov_b32 v176, 0
    v_mov_b32 v177, 0
    v_mov_b32 v178, 0
    v_mov_b32 v179, 0
    v_mov_b32 v180, 0
    v_mov_b32 v181, 0
    v_mov_b32 v182, 0
    v_mov_b32 v183, 0
    s_mov_b32 s27, 0
    v_add_u32 v16, s27, v8
    v_add_u32 v17, s27, v9
    v_add_u32 v18, s27, v10
    v_add_u32 v19, s27, v11
    v_add_u32 v20, s27, v12
    s_movk_i32 s31, 17
    s_barrier
    ds_read_b128 v[32:35], v18 offset:0
    ds_read_b64_tr_b16 v[24:25], v16 offset:0
    ds_read_b64_tr_b16 v[26:27], v16 offset:4096
    ds_read_b64_tr_b16 v[28:29], v17 offset:0
    ds_read_b64_tr_b16 v[30:31], v17 offset:4096
    ds_read_b128 v[36:39], v18 offset:1024
    ds_read_b128 v[40:43], v18 offset:2048
    ds_read_b128 v[44:47], v18 offset:3072
    ds_read_b128 v[48:51], v19 offset:0
    ds_read_b128 v[52:55], v19 offset:1024
    ds_read_b128 v[56:59], v19 offset:2048
    ds_read_b128 v[60:63], v19 offset:3072
    ds_read_b128 v[64:67], v20 offset:0
g2_mm_loop:
    s_waitcnt lgkmcnt(0)
    v_mfma_f32_16x16x32_bf16 v[112:115], v[32:35], v[24:27], v[112:115]
    ds_read_b128 v[76:79], v18 offset:9216
    ds_read_b64_tr_b16 v[68:69], v16 offset:8192
    v_mfma_f32_16x16x32_bf16 v[148:151], v[32:35], v[28:31], v[148:151]
    ds_read_b64_tr_b16 v[70:71], v16 offset:12288
    ds_read_b64_tr_b16 v[72:73], v17 offset:8192
    v_mfma_f32_16x16x32_bf16 v[116:119], v[36:39], v[24:27], v[116:119]
    ds_read_b64_tr_b16 v[74:75], v17 offset:12288
    ds_read_b128 v[80:83], v18 offset:10240
    v_mfma_f32_16x16x32_bf16 v[152:155], v[36:39], v[28:31], v[152:155]
    ds_read_b128 v[84:87], v18 offset:11264
    ds_read_b128 v[88:91], v18 offset:12288
    v_mfma_f32_16x16x32_bf16 v[120:123], v[40:43], v[24:27], v[120:123]
    ds_read_b128 v[92:95], v19 offset:9216
    ds_read_b128 v[96:99], v19 offset:10240
    v_mfma_f32_16x16x32_bf16 v[156:159], v[40:43], v[28:31], v[156:159]
    ds_read_b128 v[100:103], v19 offset:11264
    ds_read_b128 v[104:107], v19 offset:12288
    v_mfma_f32_16x16x32_bf16 v[124:127], v[44:47], v[24:27], v[124:127]
    ds_read_b128 v[108:111], v20 offset:9216
    s_add_u32 s27, s27, 34816
    v_mfma_f32_16x16x32_bf16 v[160:163], v[44:47], v[28:31], v[160:163]
    s_cmp_eq_u32 s27, 139264
    s_cselect_b32 s27, 0, s27
    v_mfma_f32_16x16x32_bf16 v[128:131], v[48:51], v[24:27], v[128:131]
    v_add_u32 v16, s27, v8
    v_add_u32 v17, s27, v9
    v_mfma_f32_16x16x32_bf16 v[164:167], v[48:51], v[28:31], v[164:167]
    v_add_u32 v18, s27, v10
    v_add_u32 v19, s27, v11
    v_mfma_f32_16x16x32_bf16 v[132:135], v[52:55], v[24:27], v[132:135]
    v_add_u32 v20, s27, v12
    v_mfma_f32_16x16x32_bf16 v[168:171], v[52:55], v[28:31], v[168:171]
    v_mfma_f32_16x16x32_bf16 v[136:139], v[56:59], v[24:27], v[136:139]
    v_mfma_f32_16x16x32_bf16 v[172:175], v[56:59], v[28:31], v[172:175]
    v_mfma_f32_16x16x32_bf16 v[140:143], v[60:63], v[24:27], v[140:143]
    v_mfma_f32_16x16x32_bf16 v[176:179], v[60:63], v[28:31], v[176:179]
    s_waitcnt lgkmcnt(0)
    s_barrier
    v_mfma_f32_16x16x32_bf16 v[144:147], v[64:67], v[24:27], v[144:147]
    v_mfma_f32_16x16x32_bf16 v[180:183], v[64:67], v[28:31], v[180:183]
    v_mfma_f32_16x16x32_bf16 v[112:115], v[76:79], v[68:71], v[112:115]
    ds_read_b128 v[32:35], v18 offset:0
    ds_read_b64_tr_b16 v[24:25], v16 offset:0
    v_mfma_f32_16x16x32_bf16 v[148:151], v[76:79], v[72:75], v[148:151]
    ds_read_b64_tr_b16 v[26:27], v16 offset:4096
    ds_read_b64_tr_b16 v[28:29], v17 offset:0
    v_mfma_f32_16x16x32_bf16 v[116:119], v[80:83], v[68:71], v[116:119]
    ds_read_b64_tr_b16 v[30:31], v17 offset:4096
    ds_read_b128 v[36:39], v18 offset:1024
    v_mfma_f32_16x16x32_bf16 v[152:155], v[80:83], v[72:75], v[152:155]
    ds_read_b128 v[40:43], v18 offset:2048
    ds_read_b128 v[44:47], v18 offset:3072
    v_mfma_f32_16x16x32_bf16 v[120:123], v[84:87], v[68:71], v[120:123]
    ds_read_b128 v[48:51], v19 offset:0
    ds_read_b128 v[52:55], v19 offset:1024
    v_mfma_f32_16x16x32_bf16 v[156:159], v[84:87], v[72:75], v[156:159]
    ds_read_b128 v[56:59], v19 offset:2048
    ds_read_b128 v[60:63], v19 offset:3072
    v_mfma_f32_16x16x32_bf16 v[124:127], v[88:91], v[68:71], v[124:127]
    ds_read_b128 v[64:67], v20 offset:0
    s_sub_u32 s31, s31, 1
    v_mfma_f32_16x16x32_bf16 v[160:163], v[88:91], v[72:75], v[160:163]
    s_cmp_lg_u32 s31, 0
    v_mfma_f32_16x16x32_bf16 v[128:131], v[92:95], v[68:71], v[128:131]
    v_mfma_f32_16x16x32_bf16 v[164:167], v[92:95], v[72:75], v[164:167]
    v_mfma_f32_16x16x32_bf16 v[132:135], v[96:99], v[68:71], v[132:135]
    v_mfma_f32_16x16x32_bf16 v[168:171], v[96:99], v[72:75], v[168:171]
    v_mfma_f32_16x16x32_bf16 v[136:139], v[100:103], v[68:71], v[136:139]
    v_mfma_f32_16x16x32_bf16 v[172:175], v[100:103], v[72:75], v[172:175]
    v_mfma_f32_16x16x32_bf16 v[140:143], v[104:107], v[68:71], v[140:143]
    v_mfma_f32_16x16x32_bf16 v[176:179], v[104:107], v[72:75], v[176:179]
    v_mfma_f32_16x16x32_bf16 v[144:147], v[108:111], v[68:71], v[144:147]
    v_mfma_f32_16x16x32_bf16 v[180:183], v[108:111], v[72:75], v[180:183]
    s_cbranch_scc1 g2_mm_loop
    s_waitcnt lgkmcnt(0)
    v_mfma_f32_16x16x32_bf16 v[112:115], v[32:35], v[24:27], v[112:115]
    ds_read_b128 v[76:79], v18 offset:9216
    ds_read_b64_tr_b16 v[68:69], v16 offset:8192
    v_mfma_f32_16x16x32_bf16 v[148:151], v[32:35], v[28:31], v[148:151]
    ds_read_b64_tr_b16 v[70:71], v16 offset:12288
    ds_read_b64_tr_b16 v[72:73], v17 offset:8192
    v_mfma_f32_16x16x32_bf16 v[116:119], v[36:39], v[24:27], v[116:119]
    ds_read_b64_tr_b16 v[74:75], v17 offset:12288
    ds_read_b128 v[80:83], v18 offset:10240
    v_mfma_f32_16x16x32_bf16 v[152:155], v[36:39], v[28:31], v[152:155]
    ds_read_b128 v[84:87], v18 offset:11264
    ds_read_b128 v[88:91], v18 offset:12288
    v_mfma_f32_16x16x32_bf16 v[120:123], v[40:43], v[24:27], v[120:123]
    ds_read_b128 v[92:95], v19 offset:9216
    ds_read_b128 v[96:99], v19 offset:10240
    v_mfma_f32_16x16x32_bf16 v[156:159], v[40:43], v[28:31], v[156:159]
    ds_read_b128 v[100:103], v19 offset:11264
    ds_read_b128 v[104:107], v19 offset:12288
    v_mfma_f32_16x16x32_bf16 v[124:127], v[44:47], v[24:27], v[124:127]
    ds_read_b128 v[108:111], v20 offset:9216
    v_mfma_f32_16x16x32_bf16 v[160:163], v[44:47], v[28:31], v[160:163]
    v_mfma_f32_16x16x32_bf16 v[128:131], v[48:51], v[24:27], v[128:131]
    v_mfma_f32_16x16x32_bf16 v[164:167], v[48:51], v[28:31], v[164:167]
    v_mfma_f32_16x16x32_bf16 v[132:135], v[52:55], v[24:27], v[132:135]
    v_mfma_f32_16x16x32_bf16 v[168:171], v[52:55], v[28:31], v[168:171]
    v_mfma_f32_16x16x32_bf16 v[136:139], v[56:59], v[24:27], v[136:139]
    v_mfma_f32_16x16x32_bf16 v[172:175], v[56:59], v[28:31], v[172:175]
    v_mfma_f32_16x16x32_bf16 v[140:143], v[60:63], v[24:27], v[140:143]
    v_mfma_f32_16x16x32_bf16 v[176:179], v[60:63], v[28:31], v[176:179]
    v_mfma_f32_16x16x32_bf16 v[144:147], v[64:67], v[24:27], v[144:147]
    v_mfma_f32_16x16x32_bf16 v[180:183], v[64:67], v[28:31], v[180:183]
    s_waitcnt lgkmcnt(0)
    v_mfma_f32_16x16x32_bf16 v[112:115], v[76:79], v[68:71], v[112:115]
    v_mfma_f32_16x16x32_bf16 v[148:151], v[76:79], v[72:75], v[148:151]
    v_mfma_f32_16x16x32_bf16 v[116:119], v[80:83], v[68:71], v[116:119]
    v_mfma_f32_16x16x32_bf16 v[152:155], v[80:83], v[72:75], v[152:155]
    v_mfma_f32_16x16x32_bf16 v[120:123], v[84:87], v[68:71], v[120:123]
    v_mfma_f32_16x16x32_bf16 v[156:159], v[84:87], v[72:75], v[156:159]
    v_mfma_f32_16x16x32_bf16 v[124:127], v[88:91], v[68:71], v[124:127]
    v_mfma_f32_16x16x32_bf16 v[160:163], v[88:91], v[72:75], v[160:163]
    v_mfma_f32_16x16x32_bf16 v[128:131], v[92:95], v[68:71], v[128:131]
    v_mfma_f32_16x16x32_bf16 v[164:167], v[92:95], v[72:75], v[164:167]
    v_mfma_f32_16x16x32_bf16 v[132:135], v[96:99], v[68:71], v[132:135]
    v_mfma_f32_16x16x32_bf16 v[168:171], v[96:99], v[72:75], v[168:171]
    v_mfma_f32_16x16x32_bf16 v[136:139], v[100:103], v[68:71], v[136:139]
    v_mfma_f32_16x16x32_bf16 v[172:175], v[100:103], v[72:75], v[172:175]
    v_mfma_f32_16x16x32_bf16 v[140:143], v[104:107], v[68:71], v[140:143]
    v_mfma_f32_16x16x32_bf16 v[176:179], v[104:107], v[72:75], v[176:179]
    v_mfma_f32_16x16x32_bf16 v[144:147], v[108:111], v[68:71], v[144:147]
    v_mfma_f32_16x16x32_bf16 v[180:183], v[108:111], v[72:75], v[180:183]
    s_cmp_eq_u32 s39, 1
    s_cbranch_scc0 g2_noswap
    s_nop 4
    v_swap_b32 v144, v146
    v_swap_b32 v145, v147
    v_swap_b32 v180, v182
    v_swap_b32 v181, v183
g2_noswap:
    s_lshl_b32 s50, s37, 4
    s_add_u32 s50, s50, s36
    s_lshl_b32 s50, s50, 2
    s_add_u32 s50, s50, s3
    s_lshl_b32 s50, s50, 2
    v_lshlrev_b32 v23, 2, v1
    s_xor_b32 s51, s35, 1
    s_add_u32 s51, s51, s50
    s_lshl_b32 s51, s51, 2
    s_add_u32 s51, s51, s35
    s_mul_i32 s51, s51, 3072
    v_cvt_pk_bf16_f32 v24, v128, v129
    v_cvt_pk_bf16_f32 v25, v130, v131
    v_cvt_pk_bf16_f32 v26, v132, v133
    v_cvt_pk_bf16_f32 v27, v134, v135
    v_cvt_pk_bf16_f32 v28, v136, v137
    v_cvt_pk_bf16_f32 v29, v138, v139
    v_cvt_pk_bf16_f32 v30, v140, v141
    v_cvt_pk_bf16_f32 v31, v142, v143
    v_cvt_pk_bf16_f32 v32, v146, v147
    buffer_store_dwordx4 v[24:27], v7, s[64:67], s51 offen sc0 sc1
    buffer_store_dwordx4 v[28:31], v7, s[64:67], s51 offen offset:1024 sc0 sc1
    buffer_store_dword v32, v23, s[64:67], s51 offen offset:2048 sc0 sc1
    s_xor_b32 s51, s35, 2
    s_add_u32 s51, s51, s50
    s_lshl_b32 s51, s51, 2
    s_add_u32 s51, s51, s35
    s_mul_i32 s51, s51, 3072
    v_cvt_pk_bf16_f32 v36, v148, v149
    v_cvt_pk_bf16_f32 v37, v150, v151
    v_cvt_pk_bf16_f32 v38, v152, v153
    v_cvt_pk_bf16_f32 v39, v154, v155
    v_cvt_pk_bf16_f32 v40, v156, v157
    v_cvt_pk_bf16_f32 v41, v158, v159
    v_cvt_pk_bf16_f32 v42, v160, v161
    v_cvt_pk_bf16_f32 v43, v162, v163
    v_cvt_pk_bf16_f32 v44, v180, v181
    buffer_store_dwordx4 v[36:39], v7, s[64:67], s51 offen sc0 sc1
    buffer_store_dwordx4 v[40:43], v7, s[64:67], s51 offen offset:1024 sc0 sc1
    buffer_store_dword v44, v23, s[64:67], s51 offen offset:2048 sc0 sc1
    s_xor_b32 s51, s35, 3
    s_add_u32 s51, s51, s50
    s_lshl_b32 s51, s51, 2
    s_add_u32 s51, s51, s35
    s_mul_i32 s51, s51, 3072
    v_cvt_pk_bf16_f32 v48, v164, v165
    v_cvt_pk_bf16_f32 v49, v166, v167
    v_cvt_pk_bf16_f32 v50, v168, v169
    v_cvt_pk_bf16_f32 v51, v170, v171
    v_cvt_pk_bf16_f32 v52, v172, v173
    v_cvt_pk_bf16_f32 v53, v174, v175
    v_cvt_pk_bf16_f32 v54, v176, v177
    v_cvt_pk_bf16_f32 v55, v178, v179
    v_cvt_pk_bf16_f32 v56, v182, v183
    buffer_store_dwordx4 v[48:51], v7, s[64:67], s51 offen sc0 sc1
    buffer_store_dwordx4 v[52:55], v7, s[64:67], s51 offen offset:1024 sc0 sc1
    buffer_store_dword v56, v23, s[64:67], s51 offen offset:2048 sc0 sc1
    s_lshl_b32 s52, s50, 6
    s_lshl_b32 s53, s35, 2
    s_add_u32 s53, s53, s52
    v_lshlrev_b32 v2, 6, v1
    v_mov_b32 v3, 1
    s_waitcnt vmcnt(0)
    s_mov_b64 exec, 15
    buffer_store_dword v3, v2, s[68:71], s53 offen sc0 sc1
    s_mov_b64 exec, -1
    s_lshl_b32 s53, s35, 6
    s_add_u32 s53, s53, s52
    s_mov_b32 s54, 0
g2_poll:
    buffer_load_dwordx4 v[68:71], off, s[68:71], s53 sc0 sc1
    s_add_u32 s54, s54, 1
    s_waitcnt vmcnt(0)
    v_and_b32 v68, v68, v69
    v_and_b32 v70, v70, v71
    v_and_b32 v68, v68, v70
    s_nop 0
    v_readfirstlane_b32 s55, v68
    s_nop 0
    s_cmp_eq_u32 s55, 1
    s_cbranch_scc1 g2_ready
    s_cmp_lt_u32 s54, 0x40000
    s_cbranch_scc1 g2_poll
g2_ready:
    s_add_u32 s50, s50, s35
    s_lshl_b32 s50, s50, 2
    s_xor_b32 s51, s35, 1
    s_add_u32 s51, s51, s50
    s_mul_i32 s51, s51, 3072
    buffer_load_dwordx4 v[68:71], v7, s[64:67], s51 offen sc0 sc1
    buffer_load_dwordx4 v[72:75], v7, s[64:67], s51 offen offset:1024 sc0 sc1
    buffer_load_dword v76, v23, s[64:67], s51 offen offset:2048 sc0 sc1
    s_xor_b32 s51, s35, 2
    s_add_u32 s51, s51, s50
    s_mul_i32 s51, s51, 3072
    buffer_load_dwordx4 v[80:83], v7, s[64:67], s51 offen sc0 sc1
    buffer_load_dwordx4 v[84:87], v7, s[64:67], s51 offen offset:1024 sc0 sc1
    buffer_load_dword v88, v23, s[64:67], s51 offen offset:2048 sc0 sc1
    s_xor_b32 s51, s35, 3
    s_add_u32 s51, s51, s50
    s_mul_i32 s51, s51, 3072
    buffer_load_dwordx4 v[92:95], v7, s[64:67], s51 offen sc0 sc1
    buffer_load_dwordx4 v[96:99], v7, s[64:67], s51 offen offset:1024 sc0 sc1
    buffer_load_dword v100, v23, s[64:67], s51 offen offset:2048 sc0 sc1
    s_mov_b32 s32, 0xffff0000
    s_waitcnt vmcnt(6)
    v_lshlrev_b32 v24, 16, v68
    v_and_b32 v25, s32, v68
    v_add_f32 v112, v112, v24
    v_add_f32 v113, v113, v25
    v_lshlrev_b32 v24, 16, v69
    v_and_b32 v25, s32, v69
    v_add_f32 v114, v114, v24
    v_add_f32 v115, v115, v25
    v_lshlrev_b32 v24, 16, v70
    v_and_b32 v25, s32, v70
    v_add_f32 v116, v116, v24
    v_add_f32 v117, v117, v25
    v_lshlrev_b32 v24, 16, v71
    v_and_b32 v25, s32, v71
    v_add_f32 v118, v118, v24
    v_add_f32 v119, v119, v25
    v_lshlrev_b32 v24, 16, v72
    v_and_b32 v25, s32, v72
    v_add_f32 v120, v120, v24
    v_add_f32 v121, v121, v25
    v_lshlrev_b32 v24, 16, v73
    v_and_b32 v25, s32, v73
    v_add_f32 v122, v122, v24
    v_add_f32 v123, v123, v25
    v_lshlrev_b32 v24, 16, v74
    v_and_b32 v25, s32, v74
    v_add_f32 v124, v124, v24
    v_add_f32 v125, v125, v25
    v_lshlrev_b32 v24, 16, v75
    v_and_b32 v25, s32, v75
    v_add_f32 v126, v126, v24
    v_add_f32 v127, v127, v25
    v_lshlrev_b32 v24, 16, v76
    v_and_b32 v25, s32, v76
    v_add_f32 v144, v144, v24
    v_add_f32 v145, v145, v25
    s_waitcnt vmcnt(3)
    v_lshlrev_b32 v24, 16, v80
    v_and_b32 v25, s32, v80
    v_add_f32 v112, v112, v24
    v_add_f32 v113, v113, v25
    v_lshlrev_b32 v24, 16, v81
    v_and_b32 v25, s32, v81
    v_add_f32 v114, v114, v24
    v_add_f32 v115, v115, v25
    v_lshlrev_b32 v24, 16, v82
    v_and_b32 v25, s32, v82
    v_add_f32 v116, v116, v24
    v_add_f32 v117, v117, v25
    v_lshlrev_b32 v24, 16, v83
    v_and_b32 v25, s32, v83
    v_add_f32 v118, v118, v24
    v_add_f32 v119, v119, v25
    v_lshlrev_b32 v24, 16, v84
    v_and_b32 v25, s32, v84
    v_add_f32 v120, v120, v24
    v_add_f32 v121, v121, v25
    v_lshlrev_b32 v24, 16, v85
    v_and_b32 v25, s32, v85
    v_add_f32 v122, v122, v24
    v_add_f32 v123, v123, v25
    v_lshlrev_b32 v24, 16, v86
    v_and_b32 v25, s32, v86
    v_add_f32 v124, v124, v24
    v_add_f32 v125, v125, v25
    v_lshlrev_b32 v24, 16, v87
    v_and_b32 v25, s32, v87
    v_add_f32 v126, v126, v24
    v_add_f32 v127, v127, v25
    v_lshlrev_b32 v24, 16, v88
    v_and_b32 v25, s32, v88
    v_add_f32 v144, v144, v24
    v_add_f32 v145, v145, v25
    s_waitcnt vmcnt(0)
    v_lshlrev_b32 v24, 16, v92
    v_and_b32 v25, s32, v92
    v_add_f32 v112, v112, v24
    v_add_f32 v113, v113, v25
    v_lshlrev_b32 v24, 16, v93
    v_and_b32 v25, s32, v93
    v_add_f32 v114, v114, v24
    v_add_f32 v115, v115, v25
    v_lshlrev_b32 v24, 16, v94
    v_and_b32 v25, s32, v94
    v_add_f32 v116, v116, v24
    v_add_f32 v117, v117, v25
    v_lshlrev_b32 v24, 16, v95
    v_and_b32 v25, s32, v95
    v_add_f32 v118, v118, v24
    v_add_f32 v119, v119, v25
    v_lshlrev_b32 v24, 16, v96
    v_and_b32 v25, s32, v96
    v_add_f32 v120, v120, v24
    v_add_f32 v121, v121, v25
    v_lshlrev_b32 v24, 16, v97
    v_and_b32 v25, s32, v97
    v_add_f32 v122, v122, v24
    v_add_f32 v123, v123, v25
    v_lshlrev_b32 v24, 16, v98
    v_and_b32 v25, s32, v98
    v_add_f32 v124, v124, v24
    v_add_f32 v125, v125, v25
    v_lshlrev_b32 v24, 16, v99
    v_and_b32 v25, s32, v99
    v_add_f32 v126, v126, v24
    v_add_f32 v127, v127, v25
    v_lshlrev_b32 v24, 16, v100
    v_and_b32 v25, s32, v100
    v_add_f32 v144, v144, v24
    v_add_f32 v145, v145, v25
    v_cvt_pk_bf16_f32 v24, v112, v113
    v_lshlrev_b32 v112, 16, v24
    v_and_b32 v113, s32, v24
    v_cvt_pk_bf16_f32 v25, v114, v115
    v_lshlrev_b32 v114, 16, v25
    v_and_b32 v115, s32, v25
    v_cvt_pk_bf16_f32 v24, v116, v117
    v_lshlrev_b32 v116, 16, v24
    v_and_b32 v117, s32, v24
    v_cvt_pk_bf16_f32 v25, v118, v119
    v_lshlrev_b32 v118, 16, v25
    v_and_b32 v119, s32, v25
    v_cvt_pk_bf16_f32 v24, v120, v121
    v_lshlrev_b32 v120, 16, v24
    v_and_b32 v121, s32, v24
    v_cvt_pk_bf16_f32 v25, v122, v123
    v_lshlrev_b32 v122, 16, v25
    v_and_b32 v123, s32, v25
    v_cvt_pk_bf16_f32 v24, v124, v125
    v_lshlrev_b32 v124, 16, v24
    v_and_b32 v125, s32, v24
    v_cvt_pk_bf16_f32 v25, v126, v127
    v_lshlrev_b32 v126, 16, v25
    v_and_b32 v127, s32, v25
    v_cvt_pk_bf16_f32 v24, v144, v145
    v_lshlrev_b32 v144, 16, v24
    v_and_b32 v145, s32, v24
    v_add_f32 v112, v112, v214
    v_add_f32 v113, v113, v214
    v_add_f32 v114, v114, v214
    v_add_f32 v115, v115, v214
    v_add_f32 v116, v116, v214
    v_add_f32 v117, v117, v214
    v_add_f32 v118, v118, v214
    v_add_f32 v119, v119, v214
    v_add_f32 v120, v120, v214
    v_add_f32 v121, v121, v214
    v_add_f32 v122, v122, v214
    v_add_f32 v123, v123, v214
    v_add_f32 v124, v124, v214
    v_add_f32 v125, v125, v214
    v_add_f32 v126, v126, v214
    v_add_f32 v127, v127, v214
    v_add_f32 v144, v144, v214
    v_add_f32 v145, v145, v214
    v_cvt_pk_bf16_f32 v24, v112, v113
    v_lshlrev_b32 v112, 16, v24
    v_and_b32 v113, s32, v24
    v_cvt_pk_bf16_f32 v25, v114, v115
    v_lshlrev_b32 v114, 16, v25
    v_and_b32 v115, s32, v25
    v_cvt_pk_bf16_f32 v24, v116, v117
    v_lshlrev_b32 v116, 16, v24
    v_and_b32 v117, s32, v24
    v_cvt_pk_bf16_f32 v25, v118, v119
    v_lshlrev_b32 v118, 16, v25
    v_and_b32 v119, s32, v25
    v_cvt_pk_bf16_f32 v24, v120, v121
    v_lshlrev_b32 v120, 16, v24
    v_and_b32 v121, s32, v24
    v_cvt_pk_bf16_f32 v25, v122, v123
    v_lshlrev_b32 v122, 16, v25
    v_and_b32 v123, s32, v25
    v_cvt_pk_bf16_f32 v24, v124, v125
    v_lshlrev_b32 v124, 16, v24
    v_and_b32 v125, s32, v24
    v_cvt_pk_bf16_f32 v25, v126, v127
    v_lshlrev_b32 v126, 16, v25
    v_and_b32 v127, s32, v25
    v_cvt_pk_bf16_f32 v24, v144, v145
    v_lshlrev_b32 v144, 16, v24
    v_and_b32 v145, s32, v24
    v_mul_f32 v112, v112, v194
    v_mul_f32 v113, v113, v195
    v_mul_f32 v114, v114, v196
    v_mul_f32 v115, v115, v197
    v_mul_f32 v116, v116, v198
    v_mul_f32 v117, v117, v199
    v_mul_f32 v118, v118, v200
    v_mul_f32 v119, v119, v201
    v_mul_f32 v120, v120, v202
    v_mul_f32 v121, v121, v203
    v_mul_f32 v122, v122, v204
    v_mul_f32 v123, v123, v205
    v_mul_f32 v124, v124, v206
    v_mul_f32 v125, v125, v207
    v_mul_f32 v126, v126, v208
    v_mul_f32 v127, v127, v209
    v_mul_f32 v144, v144, v210
    v_mul_f32 v145, v145, v211
    v_cvt_pk_bf16_f32 v24, v112, v113
    v_lshlrev_b32 v112, 16, v24
    v_and_b32 v113, s32, v24
    v_cvt_pk_bf16_f32 v25, v114, v115
    v_lshlrev_b32 v114, 16, v25
    v_and_b32 v115, s32, v25
    v_cvt_pk_bf16_f32 v24, v116, v117
    v_lshlrev_b32 v116, 16, v24
    v_and_b32 v117, s32, v24
    v_cvt_pk_bf16_f32 v25, v118, v119
    v_lshlrev_b32 v118, 16, v25
    v_and_b32 v119, s32, v25
    v_cvt_pk_bf16_f32 v24, v120, v121
    v_lshlrev_b32 v120, 16, v24
    v_and_b32 v121, s32, v24
    v_cvt_pk_bf16_f32 v25, v122, v123
    v_lshlrev_b32 v122, 16, v25
    v_and_b32 v123, s32, v25
    v_cvt_pk_bf16_f32 v24, v124, v125
    v_lshlrev_b32 v124, 16, v24
    v_and_b32 v125, s32, v24
    v_cvt_pk_bf16_f32 v25, v126, v127
    v_lshlrev_b32 v126, 16, v25
    v_and_b32 v127, s32, v25
    v_cvt_pk_bf16_f32 v24, v144, v145
    v_lshlrev_b32 v144, 16, v24
    v_and_b32 v145, s32, v24
    v_lshlrev_b32 v24, 16, v184
    v_and_b32 v25, s32, v184
    v_add_f32 v112, v112, v24
    v_add_f32 v113, v113, v25
    v_cvt_pk_bf16_f32 v68, v112, v113
    v_lshlrev_b32 v24, 16, v185
    v_and_b32 v25, s32, v185
    v_add_f32 v114, v114, v24
    v_add_f32 v115, v115, v25
    v_cvt_pk_bf16_f32 v69, v114, v115
    v_lshlrev_b32 v24, 16, v186
    v_and_b32 v25, s32, v186
    v_add_f32 v116, v116, v24
    v_add_f32 v117, v117, v25
    v_cvt_pk_bf16_f32 v70, v116, v117
    v_lshlrev_b32 v24, 16, v187
    v_and_b32 v25, s32, v187
    v_add_f32 v118, v118, v24
    v_add_f32 v119, v119, v25
    v_cvt_pk_bf16_f32 v71, v118, v119
    v_lshlrev_b32 v24, 16, v188
    v_and_b32 v25, s32, v188
    v_add_f32 v120, v120, v24
    v_add_f32 v121, v121, v25
    v_cvt_pk_bf16_f32 v72, v120, v121
    v_lshlrev_b32 v24, 16, v189
    v_and_b32 v25, s32, v189
    v_add_f32 v122, v122, v24
    v_add_f32 v123, v123, v25
    v_cvt_pk_bf16_f32 v73, v122, v123
    v_lshlrev_b32 v24, 16, v190
    v_and_b32 v25, s32, v190
    v_add_f32 v124, v124, v24
    v_add_f32 v125, v125, v25
    v_cvt_pk_bf16_f32 v74, v124, v125
    v_lshlrev_b32 v24, 16, v191
    v_and_b32 v25, s32, v191
    v_add_f32 v126, v126, v24
    v_add_f32 v127, v127, v25
    v_cvt_pk_bf16_f32 v75, v126, v127
    v_lshlrev_b32 v24, 16, v192
    v_and_b32 v25, s32, v192
    v_add_f32 v144, v144, v24
    v_add_f32 v145, v145, v25
    v_cvt_pk_bf16_f32 v76, v144, v145
    buffer_store_dwordx2 v[68:69], v22, s[60:63], s46 offen offset:0
    buffer_store_dwordx2 v[70:71], v22, s[60:63], s46 offen offset:32
    buffer_store_dwordx2 v[72:73], v22, s[60:63], s46 offen offset:64
    buffer_store_dwordx2 v[74:75], v22, s[60:63], s46 offen offset:96
    buffer_store_dword v76, v22, s[60:63], s47 offen
g2_done:
    s_endpgm
.section .rodata,"a"
.p2align 6
.amdhsa_kernel p0_kernel
  .amdhsa_next_free_vgpr 80
  .amdhsa_next_free_sgpr 96
  .amdhsa_accum_offset 80
  .amdhsa_group_segment_fixed_size 0
  .amdhsa_kernarg_size 104
  .amdhsa_user_sgpr_count 2
  .amdhsa_user_sgpr_kernarg_segment_ptr 1
  .amdhsa_system_sgpr_workgroup_id_x 1
.end_amdhsa_kernel
.section .rodata,"a"
.p2align 6
.amdhsa_kernel p1_kernel
  .amdhsa_next_free_vgpr 136
  .amdhsa_next_free_sgpr 96
  .amdhsa_accum_offset 136
  .amdhsa_group_segment_fixed_size 0
  .amdhsa_kernarg_size 104
  .amdhsa_user_sgpr_count 2
  .amdhsa_user_sgpr_kernarg_segment_ptr 1
  .amdhsa_system_sgpr_workgroup_id_x 1
.end_amdhsa_kernel
.section .rodata,"a"
.p2align 6
.amdhsa_kernel p2_kernel
  .amdhsa_next_free_vgpr 176
  .amdhsa_next_free_sgpr 96
  .amdhsa_accum_offset 176
  .amdhsa_group_segment_fixed_size 0
  .amdhsa_kernarg_size 104
  .amdhsa_user_sgpr_count 2
  .amdhsa_user_sgpr_kernarg_segment_ptr 1
  .amdhsa_system_sgpr_workgroup_id_x 1
.end_amdhsa_kernel
.section .rodata,"a"
.p2align 6
.amdhsa_kernel p3_kernel
  .amdhsa_next_free_vgpr 136
  .amdhsa_next_free_sgpr 96
  .amdhsa_accum_offset 136
  .amdhsa_group_segment_fixed_size 0
  .amdhsa_kernarg_size 104
  .amdhsa_user_sgpr_count 2
  .amdhsa_user_sgpr_kernarg_segment_ptr 1
  .amdhsa_system_sgpr_workgroup_id_x 1
.end_amdhsa_kernel
.section .rodata,"a"
.p2align 6
.amdhsa_kernel g1_kernel
  .amdhsa_next_free_vgpr 144
  .amdhsa_next_free_sgpr 96
  .amdhsa_accum_offset 144
  .amdhsa_group_segment_fixed_size 0
  .amdhsa_kernarg_size 104
  .amdhsa_user_sgpr_count 2
  .amdhsa_user_sgpr_kernarg_segment_ptr 1
  .amdhsa_system_sgpr_workgroup_id_x 1
.end_amdhsa_kernel
.section .rodata,"a"
.p2align 6
.amdhsa_kernel g2_kernel
  .amdhsa_next_free_vgpr 224
  .amdhsa_next_free_sgpr 96
  .amdhsa_accum_offset 224
  .amdhsa_group_segment_fixed_size 0
  .amdhsa_kernarg_size 104
  .amdhsa_user_sgpr_count 2
  .amdhsa_user_sgpr_kernarg_segment_ptr 1
  .amdhsa_system_sgpr_workgroup_id_x 1
.end_amdhsa_kernel
```

```asm
; @launch kernel=f_kernel grid=(256,1,1) block=(512,1,1) lds=163840
.amdgcn_target "amdgcn-amd-amdhsa--gfx950"
.text
.globl f_kernel
.p2align 8
.type f_kernel,@function
f_kernel:
    s_cmp_ge_u32 s2, 256
    s_cbranch_scc1 f_done
    s_load_dwordx2 s[16:17], s[0:1], 64
    s_load_dwordx2 s[20:21], s[0:1], 72
    s_load_dwordx2 s[28:29], s[0:1], 96
    s_load_dwordx2 s[4:5], s[0:1], 0
    s_load_dwordx2 s[8:9], s[0:1], 8
    s_load_dwordx2 s[12:13], s[0:1], 16
    s_load_dwordx2 s[24:25], s[0:1], 88
    s_load_dwordx2 s[32:33], s[0:1], 32
    s_mov_b32 s18, 0x480
    s_mov_b32 s19, 0x20000
    s_mov_b32 s22, 0x3cc000
    s_mov_b32 s23, 0x20000
    s_mov_b32 s30, 0x3000000
    s_mov_b32 s31, 0x20000
    s_mov_b32 s6, 0x240000
    s_mov_b32 s7, 0x20000
    s_mov_b32 s10, 0x121000
    s_mov_b32 s11, 0x20000
    s_mov_b32 s14, 0x121000
    s_mov_b32 s15, 0x20000
    s_mov_b32 s26, 0x100
    s_mov_b32 s27, 0x20000
    s_mov_b32 s34, 0x1200000
    s_mov_b32 s35, 0x20000
    v_and_b32 v1, 63, v0
    v_lshrrev_b32 v2, 6, v0
    s_nop 0
    v_readfirstlane_b32 s3, v2
    v_and_b32 v5, 15, v1
    v_lshrrev_b32 v6, 4, v1
    s_and_b32 s36, s2, 7
    s_lshr_b32 s37, s2, 3
    s_lshl_b32 s38, s36, 5
    s_add_u32 s38, s38, s37
    s_and_b32 s39, s3, 3
    s_lshr_b32 s40, s3, 2
    s_sub_u32 s41, s2, 64
    s_mul_i32 s43, s41, 171
    s_lshr_b32 s43, s43, 9
    s_mul_i32 s44, s43, 3
    s_sub_u32 s44, s41, s44
    v_lshrrev_b32 v2, 3, v0
    v_and_b32 v3, 7, v0
    v_mul_u32_u24 v4, 6912, v2
    v_lshl_add_u32 v3, v3, 4, v4
    v_lshlrev_b32 v2, 1, v2
    s_mul_i32 s45, s44, 384
    s_mul_i32 s46, s44, 1327104
    s_lshl_b32 s47, s43, 7
    s_add_u32 s46, s46, s47
    s_cmp_lt_u32 s41, 54
    s_cselect_b32 s48, 1, 2
    s_mul_i32 s48, s48, 4608
    s_mul_i32 s48, s48, s44
    s_lshl_b32 s47, s43, 8
    s_add_u32 s48, s48, s47
    s_cmp_lt_u32 s41, 54
    s_movk_i32 s47, 19968
    s_cselect_b32 s47, 0, s47
    s_add_u32 s48, s48, s47
    s_add_u32 s48, s48, 131072
    v_lshlrev_b32 v125, 2, v1
    v_lshlrev_b32 v109, 4, v1
    v_mov_b32 v68, -1
    v_mov_b32 v69, -1
    v_mov_b32 v70, -1
    v_mov_b32 v71, -1
    v_mov_b32 v44, 0
    v_mov_b32 v45, 0
    v_mov_b32 v46, 0
    s_bfe_u32 s49, s2, 0x10001
    s_lshl_b32 s49, s49, 3
    s_bfe_u32 s50, s2, 0x30003
    s_add_u32 s49, s49, s50
    s_bfe_u32 s50, s2, 0x10002
    s_lshl_b32 s50, s50, 2
    s_lshr_b32 s51, s2, 6
    s_add_u32 s50, s50, s51
    s_lshl_b32 s50, s50, 1
    s_and_b32 s51, s2, 1
    s_add_u32 s50, s50, s51
    s_lshl_b32 s56, s49, 4
    s_add_u32 s56, s56, s50
    s_lshl_b32 s49, s49, 2
    s_add_u32 s49, s49, s39
    s_lshl_b32 s49, s49, 4
    s_add_u32 s49, s49, s50
    s_lshl_b32 s49, s49, 1
    s_add_u32 s49, s49, s40
    s_mul_i32 s49, s49, 1152
    s_lshl_b32 s50, s39, 4
    v_add_u32 v7, s50, v5
    s_mul_i32 s55, s3, 1184
    s_sub_u32 s51, s2, 254
    s_cmp_lt_u32 s51, 2
    s_cselect_b32 s50, s3, 0
    s_cmp_eq_u32 s50, 6
    s_waitcnt lgkmcnt(0)
    s_cbranch_scc0 f_nolead
    s_mul_i32 s50, s51, 12288
    s_add_u32 s50, s50, 131072
    buffer_store_dwordx4 v[68:71], v109, s[28:31], s50 offen offset:0 sc1
    buffer_store_dwordx4 v[68:71], v109, s[28:31], s50 offen offset:1024 sc1
    buffer_store_dwordx4 v[68:71], v109, s[28:31], s50 offen offset:2048 sc1
    buffer_store_dwordx4 v[68:71], v109, s[28:31], s50 offen offset:3072 sc1
    s_add_u32 s50, s50, 4096
    buffer_store_dwordx4 v[68:71], v109, s[28:31], s50 offen offset:0 sc1
    buffer_store_dwordx4 v[68:71], v109, s[28:31], s50 offen offset:1024 sc1
    buffer_store_dwordx4 v[68:71], v109, s[28:31], s50 offen offset:2048 sc1
    buffer_store_dwordx4 v[68:71], v109, s[28:31], s50 offen offset:3072 sc1
    s_add_u32 s50, s50, 4096
    buffer_store_dwordx4 v[68:71], v109, s[28:31], s50 offen offset:0 sc1
    buffer_store_dwordx4 v[68:71], v109, s[28:31], s50 offen offset:1024 sc1
    buffer_store_dwordx4 v[68:71], v109, s[28:31], s50 offen offset:2048 sc1
    buffer_store_dwordx4 v[68:71], v109, s[28:31], s50 offen offset:3072 sc1
    s_lshl_b32 s50, s51, 7
    s_waitcnt vmcnt(0)
    s_mov_b64 exec, 1
    buffer_store_dword v68, off, s[24:27], s50 sc1
    s_mov_b64 exec, -1
f_nolead:
    s_cmp_eq_u32 s3, 7
    s_cbranch_scc0 f_noslot
    s_sub_u32 s50, s2, 118
    s_cmp_lt_u32 s50, 136
    s_cbranch_scc0 f_noslot
    s_mul_i32 s50, s2, 20480
    s_add_u32 s50, s50, 1777664
    buffer_store_dwordx4 v[68:71], v109, s[28:31], s50 offen offset:0 sc1
    buffer_store_dwordx4 v[68:71], v109, s[28:31], s50 offen offset:1024 sc1
    buffer_store_dwordx4 v[68:71], v109, s[28:31], s50 offen offset:2048 sc1
    buffer_store_dwordx4 v[68:71], v109, s[28:31], s50 offen offset:3072 sc1
    s_add_u32 s50, s50, 4096
    buffer_store_dwordx4 v[68:71], v109, s[28:31], s50 offen offset:0 sc1
    buffer_store_dwordx4 v[68:71], v109, s[28:31], s50 offen offset:1024 sc1
    buffer_store_dwordx4 v[68:71], v109, s[28:31], s50 offen offset:2048 sc1
    buffer_store_dwordx4 v[68:71], v109, s[28:31], s50 offen offset:3072 sc1
    s_add_u32 s50, s50, 4096
    buffer_store_dwordx4 v[68:71], v109, s[28:31], s50 offen offset:0 sc1
    buffer_store_dwordx4 v[68:71], v109, s[28:31], s50 offen offset:1024 sc1
    buffer_store_dwordx4 v[68:71], v109, s[28:31], s50 offen offset:2048 sc1
    buffer_store_dwordx4 v[68:71], v109, s[28:31], s50 offen offset:3072 sc1
    s_add_u32 s50, s50, 4096
    buffer_store_dwordx4 v[68:71], v109, s[28:31], s50 offen offset:0 sc1
    buffer_store_dwordx4 v[68:71], v109, s[28:31], s50 offen offset:1024 sc1
    buffer_store_dwordx4 v[68:71], v109, s[28:31], s50 offen offset:2048 sc1
    buffer_store_dwordx4 v[68:71], v109, s[28:31], s50 offen offset:3072 sc1
    s_add_u32 s50, s50, 4096
    buffer_store_dwordx4 v[68:71], v109, s[28:31], s50 offen offset:0 sc1
    buffer_store_dwordx4 v[68:71], v109, s[28:31], s50 offen offset:1024 sc1
    buffer_store_dwordx4 v[68:71], v109, s[28:31], s50 offen offset:2048 sc1
    buffer_store_dwordx4 v[68:71], v109, s[28:31], s50 offen offset:3072 sc1
f_noslot:
    s_cmp_lt_u32 s41, 162
    s_cbranch_scc0 f_nogemv1
    buffer_load_short_d16_hi v44, v2, s[16:19], s45 offen offset:0
    buffer_load_short_d16_hi v45, v2, s[16:19], s45 offen offset:128
    buffer_load_short_d16_hi v46, v2, s[16:19], s45 offen offset:256
    buffer_load_dwordx4 v[48:51], v3, s[20:23], s46 offen
    s_add_u32 s46, s46, 442368
    buffer_load_dwordx4 v[52:55], v3, s[20:23], s46 offen
    s_add_u32 s46, s46, 442368
    buffer_load_dwordx4 v[56:59], v3, s[20:23], s46 offen
    s_branch f_issue2
f_nogemv1:
    s_cmp_lt_u32 s2, 64
    s_cbranch_scc0 f_issue2
    s_lshl_b32 s50, s37, 2
    s_add_u32 s50, s50, s39
    s_lshl_b32 s50, s50, 3
    s_add_u32 s50, s50, s36
    s_mul_i32 s50, s50, 4624
    v_add_u32 v2, s50, v109
    v_add_u32 v3, 4096, v2
    s_mul_i32 s50, s3, 5120
    s_add_u32 m0, s50, 27904
    s_cmp_eq_u32 s40, 0
    s_cbranch_scc1 f_wt_re
    s_mov_b32 s8, s12
    s_mov_b32 s9, s13
f_wt_re:
    buffer_load_dwordx4 v2, s[8:11], 0 offen offset:0 lds
    buffer_load_dwordx4 v2, s[8:11], 0 offen offset:1024 lds
    buffer_load_dwordx4 v2, s[8:11], 0 offen offset:2048 lds
    buffer_load_dwordx4 v2, s[8:11], 0 offen offset:3072 lds
    s_add_u32 m0, m0, 4096
    s_mov_b32 exec_hi, 1
    buffer_load_dwordx4 v3, s[8:11], 0 offen lds
    s_mov_b64 exec, -1
f_issue2:
    s_add_u32 m0, s55, 73728
    s_nop 0
    buffer_load_dwordx4 v109, s[4:7], s49 offen lds
    s_mov_b64 exec, 0xff
    buffer_load_dwordx4 v109, s[4:7], s49 offen offset:1024 lds
    s_mov_b64 exec, -1
    v_cvt_f32_u32 v84, v7
    v_cvt_f32_u32 v85, v6
    v_mul_f32 v86, v85, v84
    v_mul_f32 v86, 0x3d800000, v86
    v_fmamk_f32 v72, v84, 0x00000000, v86
    v_cos_f32 v73, v72
    v_sin_f32 v74, v72
    v_fmamk_f32 v75, v84, 0x3c800000, v86
    v_cos_f32 v76, v75
    v_sin_f32 v77, v75
    v_cvt_pk_bf16_f32 v128, v73, v74
    v_cvt_pk_bf16_f32 v144, -v74, v73
    v_fmamk_f32 v72, v84, 0x3d000000, v86
    v_cos_f32 v73, v72
    v_sin_f32 v74, v72
    v_cvt_pk_bf16_f32 v129, v76, v77
    v_cvt_pk_bf16_f32 v145, -v77, v76
    v_fmamk_f32 v75, v84, 0x3d400000, v86
    v_cos_f32 v76, v75
    v_sin_f32 v77, v75
    v_cvt_pk_bf16_f32 v130, v73, v74
    v_cvt_pk_bf16_f32 v146, -v74, v73
    v_fmamk_f32 v72, v84, 0x3e800000, v86
    v_cos_f32 v73, v72
    v_sin_f32 v74, v72
    v_cvt_pk_bf16_f32 v131, v76, v77
    v_cvt_pk_bf16_f32 v147, -v77, v76
    v_fmamk_f32 v75, v84, 0x3e880000, v86
    v_cos_f32 v76, v75
    v_sin_f32 v77, v75
    v_cvt_pk_bf16_f32 v132, v73, v74
    v_cvt_pk_bf16_f32 v148, -v74, v73
    v_fmamk_f32 v72, v84, 0x3e900000, v86
    v_cos_f32 v73, v72
    v_sin_f32 v74, v72
    v_cvt_pk_bf16_f32 v133, v76, v77
    v_cvt_pk_bf16_f32 v149, -v77, v76
    v_fmamk_f32 v75, v84, 0x3e980000, v86
    v_cos_f32 v76, v75
    v_sin_f32 v77, v75
    v_cvt_pk_bf16_f32 v134, v73, v74
    v_cvt_pk_bf16_f32 v150, -v74, v73
    v_fmamk_f32 v72, v84, 0x3f000000, v86
    v_cos_f32 v73, v72
    v_sin_f32 v74, v72
    v_cvt_pk_bf16_f32 v135, v76, v77
    v_cvt_pk_bf16_f32 v151, -v77, v76
    v_fmamk_f32 v75, v84, 0x3f040000, v86
    v_cos_f32 v76, v75
    v_sin_f32 v77, v75
    v_cvt_pk_bf16_f32 v136, v73, v74
    v_cvt_pk_bf16_f32 v152, -v74, v73
    v_fmamk_f32 v72, v84, 0x3f080000, v86
    v_cos_f32 v73, v72
    v_sin_f32 v74, v72
    v_cvt_pk_bf16_f32 v137, v76, v77
    v_cvt_pk_bf16_f32 v153, -v77, v76
    v_fmamk_f32 v75, v84, 0x3f0c0000, v86
    v_cos_f32 v76, v75
    v_sin_f32 v77, v75
    v_cvt_pk_bf16_f32 v138, v73, v74
    v_cvt_pk_bf16_f32 v154, -v74, v73
    v_fmamk_f32 v72, v84, 0x3f400000, v86
    v_cos_f32 v73, v72
    v_sin_f32 v74, v72
    v_cvt_pk_bf16_f32 v139, v76, v77
    v_cvt_pk_bf16_f32 v155, -v77, v76
    v_fmamk_f32 v75, v84, 0x3f440000, v86
    v_cos_f32 v76, v75
    v_sin_f32 v77, v75
    v_cvt_pk_bf16_f32 v140, v73, v74
    v_cvt_pk_bf16_f32 v156, -v74, v73
    v_fmamk_f32 v72, v84, 0x3f480000, v86
    v_cos_f32 v73, v72
    v_sin_f32 v74, v72
    v_cvt_pk_bf16_f32 v141, v76, v77
    v_cvt_pk_bf16_f32 v157, -v77, v76
    v_fmamk_f32 v75, v84, 0x3f4c0000, v86
    v_cos_f32 v76, v75
    v_sin_f32 v77, v75
    v_cvt_pk_bf16_f32 v142, v73, v74
    v_cvt_pk_bf16_f32 v158, -v74, v73
    v_cvt_pk_bf16_f32 v143, v76, v77
    v_cvt_pk_bf16_f32 v159, -v77, v76
    v_mul_u32_u24 v118, 1152, v6
    v_lshl_add_u32 v118, v7, 1, v118
    s_lshl_b32 s52, s38, 1
    s_add_u32 s52, s52, s40
    s_mul_i32 s52, s52, 4608
    s_lshl_b32 s49, s38, 3
    s_add_u32 s49, s49, s3
    s_mul_i32 s49, s49, 1152
    v_mov_b32 v8, 0
    v_mov_b32 v9, 0
    v_mov_b32 v10, 0
    v_mov_b32 v11, 0
    v_mov_b32 v12, 0
    v_mov_b32 v13, 0
    v_mov_b32 v14, 0
    v_mov_b32 v15, 0
    v_mov_b32 v16, 0
    v_mov_b32 v18, 0
    v_mov_b32 v19, 0
    v_mov_b32 v20, 0
    v_mov_b32 v21, 0
    v_mov_b32 v22, 0
    v_mov_b32 v23, 0
    v_mov_b32 v24, 0
    v_mov_b32 v25, 0
    v_mov_b32 v26, 0
    v_lshlrev_b32 v2, 4, v0
    s_add_u32 s53, s38, 64
    s_lshl_b32 s50, s53, 13
    s_add_u32 s50, s50, 7340032
    buffer_store_dwordx4 v[68:71], v2, s[28:31], s50 offen sc1
    s_lshl_b32 s54, s36, 2
    s_add_u32 s54, s54, s37
    s_cmp_lt_u32 s2, 32
    s_cselect_b32 s54, s54, -1
    s_cmp_eq_u32 s2, 32
    s_cselect_b32 s54, 32, s54
    s_cmp_eq_u32 s40, 0
    s_cselect_b32 s42, s53, s54
    s_cmp_lt_u32 s2, 33
    s_cbranch_scc0 f_nozp2
    s_lshl_b32 s50, s54, 13
    s_add_u32 s50, s50, 7340032
    buffer_store_dwordx4 v[68:71], v2, s[28:31], s50 offen sc1
f_nozp2:
    s_cmp_eq_u32 s3, 6
    s_cbranch_scc0 f_nofl
    s_lshl_b32 s50, s2, 10
    s_add_u32 s50, s50, 262144
    buffer_store_dwordx4 v[18:21], v109, s[28:31], s50 offen sc1
f_nofl:
    v_cvt_f32_u32 v82, v1
    v_mul_f32 v73, 0x3ae38e39, v82
    v_mul_f32 v74, 0x3b638e39, v82
    v_mul_f32 v75, 0x3baaaaab, v82
    v_mul_f32 v76, 0x3be38e39, v82
    v_cos_f32 v208, v73
    v_sin_f32 v212, v73
    v_cos_f32 v209, v74
    v_sin_f32 v213, v74
    v_cos_f32 v210, v75
    v_sin_f32 v214, v75
    v_cos_f32 v211, v76
    v_sin_f32 v215, v76
    s_lshl_b32 s50, s40, 2
    s_add_u32 s50, s50, s39
    s_mul_i32 s50, s50, 272
    s_add_u32 s50, s50, 14848
    v_add_u32 v104, s50, v125
    v_mul_u32_u24 v2, 272, v5
    v_lshl_add_u32 v2, v6, 4, v2
    s_mul_i32 s50, s40, 8704
    s_add_u32 s51, s50, 14848
    v_add_u32 v105, s51, v2
    s_add_u32 s51, s50, 44288
    v_add_u32 v111, s51, v2
    v_mul_u32_u24 v2, 1088, v6
    v_lshl_add_u32 v2, v7, 2, v2
    v_add_u32 v110, s51, v2
    v_lshrrev_b32 v2, 1, v6
    v_lshl_add_u32 v2, v2, 6, v7
    v_and_b32 v3, 1, v6
    v_lshlrev_b32 v3, 4, v3
    v_lshl_add_u32 v2, v2, 5, v3
    s_lshl_b32 s50, s40, 13
    v_add_u32 v106, s50, v2
    v_add_u32 v107, 4096, v2
    v_cmp_lt_u32 vcc, 1, v6
    s_cmp_eq_u32 s40, 1
    s_cselect_b64 s[50:51], vcc, 0
    v_mov_b32 v3, 0x7f000000
    v_cndmask_b32 v106, v106, v3, s[50:51]
    s_mul_i32 s56, s56, 10240
    s_add_u32 s56, s56, 4194304
    v_lshrrev_b32 v2, 1, v5
    v_lshl_add_u32 v2, v6, 4, v2
    v_mul_u32_u24 v2, 10240, v2
    v_and_b32 v3, 1, v5
    v_lshl_add_u32 v108, v3, 4, v2
    v_lshlrev_b32 v2, 6, v7
    v_lshl_add_u32 v112, v6, 4, v2
    v_lshrrev_b32 v2, 1, v1
    s_and_b32 s50, s3, 1
    s_lshl_b32 s50, s50, 5
    v_add_u32 v2, s50, v2
    v_and_b32 v3, 1, v1
    s_lshr_b32 s51, s3, 1
    v_mul_u32_u24 v4, 5760, v3
    v_lshl_add_u32 v4, v2, 3, v4
    s_mul_i32 s50, s51, 576
    s_add_u32 s50, s50, 61696
    v_add_u32 v115, s50, v4
    v_lshlrev_b32 v3, 4, v3
    v_lshl_add_u32 v114, v2, 13, v3
    v_add_u32 v114, 2097152, v114
    v_sub_u32 v4, 64, v2
    v_min_u32 v4, v4, v2
    s_cmp_eq_u32 s51, 0
    s_cselect_b64 vcc, -1, 0
    v_cndmask_b32 v2, v2, v4, vcc
    s_lshl_b32 s51, s51, 19
    v_lshl_add_u32 v113, v2, 13, v3
    v_add_u32 v113, s51, v113
    v_lshrrev_b32 v2, 2, v5
    v_lshl_add_u32 v2, v6, 2, v2
    v_lshlrev_b32 v2, 3, v2
    s_mul_i32 s50, s40, 5760
    s_add_u32 s50, s50, 61696
    v_add_u32 v117, s50, v2
    v_and_b32 v2, 3, v1
    v_add_u32 v2, 1, v2
    v_mul_u32_u24 v2, 576, v2
    v_add_u32 v116, v2, v117
    s_lshl_b32 s50, s40, 7
    s_add_u32 s50, s50, 73216
    v_lshl_add_u32 v119, v6, 5, s50
    s_lshl_b32 s50, s39, 3
    v_add_u32 v120, s50, v119
    s_mov_b32 s50, 391680
    v_lshl_add_u32 v2, v6, 6, v7
    s_lshl_b32 s51, s40, 3
    s_add_u32 s51, s51, 61696
    v_lshl_add_u32 v121, v2, 4, s51
    v_mul_u32_u24 v3, 683, v0
    v_lshrrev_b32 v3, 16, v3
    v_mul_lo_u32 v3, v3, s50
    v_lshl_add_u32 v122, v0, 4, v3
    v_add_u32 v2, 256, v0
    v_mul_u32_u24 v3, 683, v2
    v_lshrrev_b32 v3, 16, v3
    v_mul_lo_u32 v3, v3, s50
    v_lshl_add_u32 v118, v2, 4, v3
    v_add_u32 v123, 1966592, v109
    v_lshlrev_b32 v124, 2, v7
    v_mul_u32_u24 v2, 1184, v6
    v_lshl_add_u32 v2, v7, 1, v2
    s_mul_i32 s50, s40, 4736
    s_add_u32 s50, s50, 83200
    v_add_u32 v127, s50, v2
    s_and_b32 s50, s2, 1
    s_mul_i32 s50, s50, 1152
    v_cmp_lt_u32 vcc, 431, v0
    v_mov_b32 v3, s50
    s_nop 0
    v_cndmask_b32 v3, 0, v3, vcc
    v_lshl_add_u32 v126, v0, 4, v3
    s_mul_i32 s57, s36, 4617
    s_lshr_b32 s57, s57, 10
    s_lshl_b32 s57, s57, 8
    v_mul_u32_u24 v2, 26, v1
    v_lshrrev_b32 v2, 8, v2
    v_mul_u32_u24 v2, 7936, v2
    v_lshl_add_u32 v17, v1, 7, v2
    s_cmp_lt_u32 s41, 162
    s_cbranch_scc0 f_other
    s_mov_b32 s47, 0xffff0000
    s_waitcnt vmcnt(6)
    v_mul_f32 v72, 0xbfb8aa3b, v44
    v_mul_f32 v73, 0xbfb8aa3b, v45
    v_mul_f32 v74, 0xbfb8aa3b, v46
    v_exp_f32 v72, v72
    v_exp_f32 v73, v73
    v_exp_f32 v74, v74
    v_add_f32 v72, 1.0, v72
    v_add_f32 v73, 1.0, v73
    v_add_f32 v74, 1.0, v74
    v_rcp_f32 v72, v72
    v_rcp_f32 v73, v73
    v_rcp_f32 v74, v74
    v_mul_f32 v44, v44, v72
    v_mul_f32 v45, v45, v73
    v_mul_f32 v46, v46, v74
    v_cvt_pk_bf16_f32 v72, v44, v45
    v_lshlrev_b32 v44, 16, v72
    v_and_b32 v45, s47, v72
    v_cvt_pk_bf16_f32 v46, v46, v46
    v_lshlrev_b32 v46, 16, v46
    s_waitcnt vmcnt(5)
    v_lshlrev_b32 v72, 16, v48
    v_and_b32 v73, s47, v48
    v_mul_f32 v60, v44, v72
    v_mul_f32 v61, v44, v73
    v_lshlrev_b32 v74, 16, v49
    v_and_b32 v75, s47, v49
    v_mul_f32 v62, v44, v74
    v_mul_f32 v63, v44, v75
    v_lshlrev_b32 v72, 16, v50
    v_and_b32 v73, s47, v50
    v_mul_f32 v64, v44, v72
    v_mul_f32 v65, v44, v73
    v_lshlrev_b32 v74, 16, v51
    v_and_b32 v75, s47, v51
    v_mul_f32 v66, v44, v74
    v_mul_f32 v67, v44, v75
    s_waitcnt vmcnt(4)
    v_lshlrev_b32 v72, 16, v52
    v_and_b32 v73, s47, v52
    v_fmac_f32 v60, v45, v72
    v_fmac_f32 v61, v45, v73
    v_lshlrev_b32 v74, 16, v53
    v_and_b32 v75, s47, v53
    v_fmac_f32 v62, v45, v74
    v_fmac_f32 v63, v45, v75
    v_lshlrev_b32 v72, 16, v54
    v_and_b32 v73, s47, v54
    v_fmac_f32 v64, v45, v72
    v_fmac_f32 v65, v45, v73
    v_lshlrev_b32 v74, 16, v55
    v_and_b32 v75, s47, v55
    v_fmac_f32 v66, v45, v74
    v_fmac_f32 v67, v45, v75
    s_waitcnt vmcnt(3)
    v_lshlrev_b32 v72, 16, v56
    v_and_b32 v73, s47, v56
    v_fmac_f32 v60, v46, v72
    v_fmac_f32 v61, v46, v73
    v_lshlrev_b32 v74, 16, v57
    v_and_b32 v75, s47, v57
    v_fmac_f32 v62, v46, v74
    v_fmac_f32 v63, v46, v75
    v_lshlrev_b32 v72, 16, v58
    v_and_b32 v73, s47, v58
    v_fmac_f32 v64, v46, v72
    v_fmac_f32 v65, v46, v73
    v_lshlrev_b32 v74, 16, v59
    v_and_b32 v75, s47, v59
    v_fmac_f32 v66, v46, v74
    v_fmac_f32 v67, v46, v75
    v_permlane16_swap_b32 v60, v61
    v_permlane16_swap_b32 v62, v63
    v_permlane16_swap_b32 v64, v65
    v_permlane16_swap_b32 v66, v67
    v_add_f32 v60, v60, v61
    v_add_f32 v62, v62, v63
    v_add_f32 v64, v64, v65
    v_add_f32 v66, v66, v67
    v_permlane32_swap_b32 v60, v62
    s_nop 0
    v_permlane32_swap_b32 v64, v66
    v_add_f32 v60, v60, v62
    v_add_f32 v64, v64, v66
    s_nop 0
    v_add_f32_dpp v60, v60, v60 row_ror:8 row_mask:0xf bank_mask:0xf
    v_add_f32_dpp v64, v64, v64 row_ror:8 row_mask:0xf bank_mask:0xf
    v_cmp_lt_u32 vcc, 7, v5
    s_nop 1
    v_cndmask_b32 v60, v60, v64, vcc
    v_and_b32 v2, 7, v5
    v_lshrrev_b32 v3, 3, v5
    v_lshl_add_u32 v2, v2, 1, v3
    v_lshl_add_u32 v2, v2, 2, v6
    s_lshl_b32 s50, s3, 8
    s_add_u32 s50, s50, 4608
    v_lshl_add_u32 v2, v2, 2, s50
    ds_write_b32 v2, v60
    s_cmp_eq_u32 s3, 7
    s_cbranch_scc0 f_nochka
    s_mov_b64 exec, 3
    v_lshlrev_b32 v2, 7, v1
    s_mov_b32 s50, 0
f_an2a:
    buffer_load_dword v3, v2, s[24:27], 0 offen sc1
    s_add_u32 s50, s50, 1
    s_waitcnt vmcnt(0)
    v_cmp_eq_u32 vcc, 0, v3
    s_nop 1
    s_cbranch_vccz f_an2a_ok
    s_sleep 2
    s_cmp_lt_u32 s50, 30000
    s_cbranch_scc1 f_an2a
f_an2a_ok:
    s_mov_b64 exec, -1
    s_sub_u32 s50, s2, 118
    s_cmp_lt_u32 s50, 136
    s_cbranch_scc0 f_nochka
    s_lshl_b32 s50, s50, 6
    s_add_u32 s50, s50, 144896
    s_mov_b64 exec, 1
    buffer_store_dword v1, off, s[28:31], s50 sc1
    s_mov_b64 exec, -1
f_nochka:
    s_waitcnt lgkmcnt(0)
    s_barrier
    s_cmp_eq_u32 s3, 7
    s_cbranch_scc0 f_nogemv2
    ds_read2st64_b32 v[60:61], v125 offset0:18 offset1:19
    ds_read2st64_b32 v[62:63], v125 offset0:20 offset1:21
    ds_read2st64_b32 v[64:65], v125 offset0:22 offset1:23
    ds_read2st64_b32 v[66:67], v125 offset0:24 offset1:25
    s_waitcnt lgkmcnt(0)
    v_pk_add_f32 v[60:61], v[60:61], v[62:63]
    v_pk_add_f32 v[64:65], v[64:65], v[66:67]
    v_pk_add_f32 v[60:61], v[60:61], v[64:65]
    v_add_f32 v60, v60, v61
    buffer_store_dword v60, v125, s[28:31], s48 offen sc1
    s_branch f_nogemv2
f_other:
    s_cmp_lt_u32 s2, 64
    s_cbranch_scc1 f_wt1
    s_waitcnt vmcnt(0)
    s_cmp_eq_u32 s3, 7
    s_cbranch_scc0 f_nochkb
    s_mov_b64 exec, 3
    v_lshlrev_b32 v2, 7, v1
    s_mov_b32 s50, 0
f_an2b:
    buffer_load_dword v3, v2, s[24:27], 0 offen sc1
    s_add_u32 s50, s50, 1
    s_waitcnt vmcnt(0)
    v_cmp_eq_u32 vcc, 0, v3
    s_nop 1
    s_cbranch_vccz f_an2b_ok
    s_sleep 2
    s_cmp_lt_u32 s50, 30000
    s_cbranch_scc1 f_an2b
f_an2b_ok:
    s_mov_b64 exec, -1
    s_sub_u32 s50, s2, 118
    s_cmp_lt_u32 s50, 136
    s_cbranch_scc0 f_nochkb
    s_lshl_b32 s50, s50, 6
    s_add_u32 s50, s50, 144896
    s_mov_b64 exec, 1
    buffer_store_dword v1, off, s[28:31], s50 sc1
    s_mov_b64 exec, -1
f_nochkb:
    s_branch f_ln
f_wt1:
    s_waitcnt vmcnt(3)
    s_barrier
f_wt2:
    v_and_b32 v3, 7, v0
    v_lshrrev_b32 v4, 3, v0
    v_mul_u32_u24 v2, 578, v3
    v_lshl_add_u32 v2, v4, 1, v2
    v_add_u32 v2, 27904, v2
    v_lshlrev_b32 v3, 4, v3
    v_lshl_add_u32 v3, v4, 13, v3
    s_lshr_b32 s50, s36, 1
    s_lshl_b32 s50, s50, 1
    s_lshr_b32 s51, s37, 2
    s_add_u32 s50, s50, s51
    s_lshl_b32 s50, s50, 2
    s_and_b32 s51, s37, 3
    s_add_u32 s50, s50, s51
    s_lshl_b32 s50, s50, 1
    s_and_b32 s51, s36, 1
    s_add_u32 s50, s50, s51
    s_lshl_b32 s50, s50, 7
    s_add_u32 s50, s50, 1048576
    ds_read_u16 v28, v2 offset:0
    ds_read_u16 v32, v2 offset:20480
    ds_read_u16 v29, v2 offset:5120
    ds_read_u16 v33, v2 offset:25600
    ds_read_u16 v30, v2 offset:10240
    ds_read_u16 v34, v2 offset:30720
    ds_read_u16 v31, v2 offset:15360
    ds_read_u16 v35, v2 offset:35840
    s_waitcnt vmcnt(1)
    ds_read_u16 v36, v2 offset:128
    ds_read_u16 v40, v2 offset:20608
    ds_read_u16 v37, v2 offset:5248
    ds_read_u16 v41, v2 offset:25728
    ds_read_u16 v38, v2 offset:10368
    ds_read_u16 v42, v2 offset:30848
    ds_read_u16 v39, v2 offset:15488
    ds_read_u16 v43, v2 offset:35968
    s_waitcnt lgkmcnt(8)
    v_lshl_or_b32 v52, v32, 16, v28
    v_lshl_or_b32 v53, v33, 16, v29
    v_lshl_or_b32 v54, v34, 16, v30
    v_lshl_or_b32 v55, v35, 16, v31
    buffer_store_dwordx4 v[52:55], v3, s[28:31], s50 offen sc1
    s_add_u32 s50, s50, 524288
    ds_read_u16 v44, v2 offset:256
    ds_read_u16 v48, v2 offset:20736
    ds_read_u16 v45, v2 offset:5376
    ds_read_u16 v49, v2 offset:25856
    ds_read_u16 v46, v2 offset:10496
    ds_read_u16 v50, v2 offset:30976
    ds_read_u16 v47, v2 offset:15616
    ds_read_u16 v51, v2 offset:36096
    s_waitcnt lgkmcnt(8)
    v_lshl_or_b32 v56, v40, 16, v36
    v_lshl_or_b32 v57, v41, 16, v37
    v_lshl_or_b32 v58, v42, 16, v38
    v_lshl_or_b32 v59, v43, 16, v39
    buffer_store_dwordx4 v[56:59], v3, s[28:31], s50 offen sc1
    s_add_u32 s50, s50, 524288
    ds_read_u16 v28, v2 offset:384
    ds_read_u16 v32, v2 offset:20864
    ds_read_u16 v29, v2 offset:5504
    ds_read_u16 v33, v2 offset:25984
    ds_read_u16 v30, v2 offset:10624
    ds_read_u16 v34, v2 offset:31104
    ds_read_u16 v31, v2 offset:15744
    ds_read_u16 v35, v2 offset:36224
    s_waitcnt lgkmcnt(8)
    v_lshl_or_b32 v52, v48, 16, v44
    v_lshl_or_b32 v53, v49, 16, v45
    v_lshl_or_b32 v54, v50, 16, v46
    v_lshl_or_b32 v55, v51, 16, v47
    buffer_store_dwordx4 v[52:55], v3, s[28:31], s50 offen sc1
    s_add_u32 s50, s50, 524288
    ds_read_u16 v36, v2 offset:512
    ds_read_u16 v40, v2 offset:20992
    ds_read_u16 v37, v2 offset:5632
    ds_read_u16 v41, v2 offset:26112
    ds_read_u16 v38, v2 offset:10752
    ds_read_u16 v42, v2 offset:31232
    ds_read_u16 v39, v2 offset:15872
    ds_read_u16 v43, v2 offset:36352
    s_waitcnt lgkmcnt(8)
    v_lshl_or_b32 v56, v32, 16, v28
    v_lshl_or_b32 v57, v33, 16, v29
    v_lshl_or_b32 v58, v34, 16, v30
    v_lshl_or_b32 v59, v35, 16, v31
    buffer_store_dwordx4 v[56:59], v3, s[28:31], s50 offen sc1
    s_add_u32 s50, s50, 524288
    s_waitcnt lgkmcnt(0)
    v_lshl_or_b32 v52, v40, 16, v36
    v_lshl_or_b32 v53, v41, 16, v37
    v_lshl_or_b32 v54, v42, 16, v38
    v_lshl_or_b32 v55, v43, 16, v39
    v_cmp_gt_u32 vcc, 33, v4
    v_mov_b32 v4, 0x7f000000
    s_nop 0
    v_cndmask_b32 v3, v4, v3, vcc
    buffer_store_dwordx4 v[52:55], v3, s[28:31], s50 offen sc1
    s_branch f_ln
f_nogemv2:
    s_waitcnt vmcnt(1)
f_ln:
    v_lshlrev_b32 v2, 1, v1
    s_add_u32 s50, s55, 73728
    v_add_u32 v2, s50, v2
    ds_read_u16_d16_hi v8, v2 offset:0
    ds_read_u16_d16_hi v9, v2 offset:128
    ds_read_u16_d16_hi v10, v2 offset:256
    ds_read_u16_d16_hi v11, v2 offset:384
    ds_read_u16_d16_hi v12, v2 offset:512
    ds_read_u16_d16_hi v13, v2 offset:640
    ds_read_u16_d16_hi v14, v2 offset:768
    ds_read_u16_d16_hi v15, v2 offset:896
    ds_read_u16_d16_hi v16, v2 offset:1024
    s_waitcnt lgkmcnt(0)
    v_add_f32 v80, v8, v9
    v_add_f32 v80, v80, v10
    v_add_f32 v80, v80, v11
    v_add_f32 v80, v80, v12
    v_add_f32 v80, v80, v13
    v_add_f32 v80, v80, v14
    v_add_f32 v80, v80, v15
    v_add_f32 v80, v80, v16
    s_nop 1
    v_add_f32_dpp v80, v80, v80 quad_perm:[1,0,3,2] row_mask:0xf bank_mask:0xf
    s_nop 1
    v_add_f32_dpp v80, v80, v80 quad_perm:[2,3,0,1] row_mask:0xf bank_mask:0xf
    s_nop 1
    v_add_f32_dpp v80, v80, v80 row_half_mirror row_mask:0xf bank_mask:0xf
    s_nop 1
    v_add_f32_dpp v80, v80, v80 row_mirror row_mask:0xf bank_mask:0xf
    v_mov_b32 v72, v80
    s_nop 1
    v_permlane16_swap_b32 v80, v72
    v_add_f32 v80, v80, v72
    v_mov_b32 v72, v80
    s_nop 1
    v_permlane32_swap_b32 v80, v72
    v_add_f32 v80, v80, v72
    v_mul_f32 v80, 0x3ae38e39, v80
    v_sub_f32 v8, v8, v80
    v_sub_f32 v9, v9, v80
    v_sub_f32 v10, v10, v80
    v_sub_f32 v11, v11, v80
    v_sub_f32 v12, v12, v80
    v_sub_f32 v13, v13, v80
    v_sub_f32 v14, v14, v80
    v_sub_f32 v15, v15, v80
    v_sub_f32 v16, v16, v80
    v_mul_f32 v81, v8, v8
    v_fmac_f32 v81, v9, v9
    v_fmac_f32 v81, v10, v10
    v_fmac_f32 v81, v11, v11
    v_fmac_f32 v81, v12, v12
    v_fmac_f32 v81, v13, v13
    v_fmac_f32 v81, v14, v14
    v_fmac_f32 v81, v15, v15
    v_fmac_f32 v81, v16, v16
    s_nop 1
    v_add_f32_dpp v81, v81, v81 quad_perm:[1,0,3,2] row_mask:0xf bank_mask:0xf
    s_nop 1
    v_add_f32_dpp v81, v81, v81 quad_perm:[2,3,0,1] row_mask:0xf bank_mask:0xf
    s_nop 1
    v_add_f32_dpp v81, v81, v81 row_half_mirror row_mask:0xf bank_mask:0xf
    s_nop 1
    v_add_f32_dpp v81, v81, v81 row_mirror row_mask:0xf bank_mask:0xf
    v_mov_b32 v72, v81
    s_nop 1
    v_permlane16_swap_b32 v81, v72
    v_add_f32 v81, v81, v72
    v_mov_b32 v72, v81
    s_nop 1
    v_permlane32_swap_b32 v81, v72
    v_add_f32 v81, v81, v72
    v_mov_b32 v72, 0x3727c5ac
    v_fmamk_f32 v81, v81, 0x3ae38e39, v72
    v_rsq_f32 v81, v81
    s_nop 0
    v_mul_f32 v8, v8, v81
    v_mul_f32 v9, v9, v81
    v_mul_f32 v10, v10, v81
    v_mul_f32 v11, v11, v81
    v_mul_f32 v12, v12, v81
    v_mul_f32 v13, v13, v81
    v_mul_f32 v14, v14, v81
    v_mul_f32 v15, v15, v81
    v_mul_f32 v16, v16, v81
    v_cvt_f32_u32 v84, v7
    v_cvt_f32_u32 v85, v6
    v_mul_f32 v86, v85, v84
    v_mul_f32 v86, 0x3d800000, v86
    v_mul_f32 v86, 0x3d000000, v86
    v_fmamk_f32 v72, v84, 0x00000000, v86
    v_fmamk_f32 v73, v84, 0x3a000000, v86
    v_fmamk_f32 v74, v84, 0x3a800000, v86
    v_fmamk_f32 v75, v84, 0x3ac00000, v86
    v_cos_f32 v192, v72
    v_sin_f32 v200, v72
    v_cos_f32 v193, v73
    v_sin_f32 v201, v73
    v_cos_f32 v194, v74
    v_sin_f32 v202, v74
    v_cos_f32 v195, v75
    v_sin_f32 v203, v75
    v_fmamk_f32 v72, v84, 0x3c000000, v86
    v_fmamk_f32 v73, v84, 0x3c080000, v86
    v_fmamk_f32 v74, v84, 0x3c100000, v86
    v_fmamk_f32 v75, v84, 0x3c180000, v86
    v_cos_f32 v196, v72
    v_sin_f32 v204, v72
    v_cos_f32 v197, v73
    v_sin_f32 v205, v73
    v_cos_f32 v198, v74
    v_sin_f32 v206, v74
    v_cos_f32 v199, v75
    v_sin_f32 v207, v75
    v_add_u32 v84, 0, v5
    v_cvt_f32_u32 v84, v84
    v_mul_f32 v86, v85, v84
    v_mul_f32 v86, 0x3e000000, v86
    v_fmamk_f32 v72, v84, 0x00000000, v86
    v_fmamk_f32 v73, v84, 0x3d000000, v86
    v_fmamk_f32 v74, v84, 0x3d800000, v86
    v_fmamk_f32 v75, v84, 0x3dc00000, v86
    v_cos_f32 v76, v72
    v_sin_f32 v80, v72
    v_cos_f32 v77, v73
    v_sin_f32 v81, v73
    v_cos_f32 v78, v74
    v_sin_f32 v82, v74
    v_cos_f32 v79, v75
    v_sin_f32 v83, v75
    v_cvt_pk_bf16_f32 v160, v76, v77
    v_cvt_pk_bf16_f32 v161, v78, v79
    v_cvt_pk_bf16_f32 v178, v76, v77
    v_cvt_pk_bf16_f32 v179, v78, v79
    v_cvt_pk_bf16_f32 v162, v80, v81
    v_cvt_pk_bf16_f32 v163, v82, v83
    v_cvt_pk_bf16_f32 v176, -v80, -v81
    v_cvt_pk_bf16_f32 v177, -v82, -v83
    v_fmamk_f32 v72, v84, 0x3f000000, v86
    v_fmamk_f32 v73, v84, 0x3f080000, v86
    v_fmamk_f32 v74, v84, 0x3f100000, v86
    v_fmamk_f32 v75, v84, 0x3f180000, v86
    v_cos_f32 v76, v72
    v_sin_f32 v80, v72
    v_cos_f32 v77, v73
    v_sin_f32 v81, v73
    v_cos_f32 v78, v74
    v_sin_f32 v82, v74
    v_cos_f32 v79, v75
    v_sin_f32 v83, v75
    v_cvt_pk_bf16_f32 v164, v76, v77
    v_cvt_pk_bf16_f32 v165, v78, v79
    v_cvt_pk_bf16_f32 v182, v76, v77
    v_cvt_pk_bf16_f32 v183, v78, v79
    v_cvt_pk_bf16_f32 v166, v80, v81
    v_cvt_pk_bf16_f32 v167, v82, v83
    v_cvt_pk_bf16_f32 v180, -v80, -v81
    v_cvt_pk_bf16_f32 v181, -v82, -v83
    v_add_u32 v84, 16, v5
    v_cvt_f32_u32 v84, v84
    v_mul_f32 v86, v85, v84
    v_mul_f32 v86, 0x3e000000, v86
    v_fmamk_f32 v72, v84, 0x00000000, v86
    v_fmamk_f32 v73, v84, 0x3d000000, v86
    v_fmamk_f32 v74, v84, 0x3d800000, v86
    v_fmamk_f32 v75, v84, 0x3dc00000, v86
    v_cos_f32 v76, v72
    v_sin_f32 v80, v72
    v_cos_f32 v77, v73
    v_sin_f32 v81, v73
    v_cos_f32 v78, v74
    v_sin_f32 v82, v74
    v_cos_f32 v79, v75
    v_sin_f32 v83, v75
    v_cvt_pk_bf16_f32 v168, v76, v77
    v_cvt_pk_bf16_f32 v169, v78, v79
    v_cvt_pk_bf16_f32 v186, v76, v77
    v_cvt_pk_bf16_f32 v187, v78, v79
    v_cvt_pk_bf16_f32 v170, v80, v81
    v_cvt_pk_bf16_f32 v171, v82, v83
    v_cvt_pk_bf16_f32 v184, -v80, -v81
    v_cvt_pk_bf16_f32 v185, -v82, -v83
    v_fmamk_f32 v72, v84, 0x3f000000, v86
    v_fmamk_f32 v73, v84, 0x3f080000, v86
    v_fmamk_f32 v74, v84, 0x3f100000, v86
    v_fmamk_f32 v75, v84, 0x3f180000, v86
    v_cos_f32 v76, v72
    v_sin_f32 v80, v72
    v_cos_f32 v77, v73
    v_sin_f32 v81, v73
    v_cos_f32 v78, v74
    v_sin_f32 v82, v74
    v_cos_f32 v79, v75
    v_sin_f32 v83, v75
    v_cvt_pk_bf16_f32 v172, v76, v77
    v_cvt_pk_bf16_f32 v173, v78, v79
    v_cvt_pk_bf16_f32 v190, v76, v77
    v_cvt_pk_bf16_f32 v191, v78, v79
    v_cvt_pk_bf16_f32 v174, v80, v81
    v_cvt_pk_bf16_f32 v175, v82, v83
    v_cvt_pk_bf16_f32 v188, -v80, -v81
    v_cvt_pk_bf16_f32 v189, -v82, -v83
    s_cmp_lt_u32 s3, 3
    s_cbranch_scc1 f_stage
    v_cvt_f32_u32 v84, v7
    v_cvt_f32_u32 v85, v6
    v_mul_f32 v85, v85, v84
    v_mul_f32 v85, 0x3d800000, v85
    v_fmamk_f32 v72, v84, 0x00000000, v85
    v_fmamk_f32 v73, v84, 0x3c800000, v85
    v_fmamk_f32 v74, v84, 0x3d000000, v85
    v_fmamk_f32 v75, v84, 0x3d400000, v85
    v_cos_f32 v76, v72
    v_sin_f32 v80, v72
    v_cos_f32 v77, v73
    v_sin_f32 v81, v73
    v_cos_f32 v78, v74
    v_sin_f32 v82, v74
    v_cos_f32 v79, v75
    v_sin_f32 v83, v75
    v_cvt_pk_bf16_f32 v216, v76, v77
    v_cvt_pk_bf16_f32 v217, v78, v79
    v_cvt_pk_bf16_f32 v234, -v76, -v77
    v_cvt_pk_bf16_f32 v235, -v78, -v79
    v_cvt_pk_bf16_f32 v218, v80, v81
    v_cvt_pk_bf16_f32 v219, v82, v83
    v_cvt_pk_bf16_f32 v232, v80, v81
    v_cvt_pk_bf16_f32 v233, v82, v83
    v_fmamk_f32 v72, v84, 0x3e800000, v85
    v_fmamk_f32 v73, v84, 0x3e880000, v85
    v_fmamk_f32 v74, v84, 0x3e900000, v85
    v_fmamk_f32 v75, v84, 0x3e980000, v85
    v_cos_f32 v76, v72
    v_sin_f32 v80, v72
    v_cos_f32 v77, v73
    v_sin_f32 v81, v73
    v_cos_f32 v78, v74
    v_sin_f32 v82, v74
    v_cos_f32 v79, v75
    v_sin_f32 v83, v75
    v_cvt_pk_bf16_f32 v220, v76, v77
    v_cvt_pk_bf16_f32 v221, v78, v79
    v_cvt_pk_bf16_f32 v238, -v76, -v77
    v_cvt_pk_bf16_f32 v239, -v78, -v79
    v_cvt_pk_bf16_f32 v222, v80, v81
    v_cvt_pk_bf16_f32 v223, v82, v83
    v_cvt_pk_bf16_f32 v236, v80, v81
    v_cvt_pk_bf16_f32 v237, v82, v83
    v_fmamk_f32 v72, v84, 0x3f000000, v85
    v_fmamk_f32 v73, v84, 0x3f040000, v85
    v_fmamk_f32 v74, v84, 0x3f080000, v85
    v_fmamk_f32 v75, v84, 0x3f0c0000, v85
    v_cos_f32 v76, v72
    v_sin_f32 v80, v72
    v_cos_f32 v77, v73
    v_sin_f32 v81, v73
    v_cos_f32 v78, v74
    v_sin_f32 v82, v74
    v_cos_f32 v79, v75
    v_sin_f32 v83, v75
    v_cvt_pk_bf16_f32 v224, v76, v77
    v_cvt_pk_bf16_f32 v225, v78, v79
    v_cvt_pk_bf16_f32 v242, v76, v77
    v_cvt_pk_bf16_f32 v243, v78, v79
    v_cvt_pk_bf16_f32 v226, -v80, -v81
    v_cvt_pk_bf16_f32 v227, -v82, -v83
    v_cvt_pk_bf16_f32 v240, v80, v81
    v_cvt_pk_bf16_f32 v241, v82, v83
    v_fmamk_f32 v72, v84, 0x3f400000, v85
    v_fmamk_f32 v73, v84, 0x3f440000, v85
    v_fmamk_f32 v74, v84, 0x3f480000, v85
    v_fmamk_f32 v75, v84, 0x3f4c0000, v85
    v_cos_f32 v76, v72
    v_sin_f32 v80, v72
    v_cos_f32 v77, v73
    v_sin_f32 v81, v73
    v_cos_f32 v78, v74
    v_sin_f32 v82, v74
    v_cos_f32 v79, v75
    v_sin_f32 v83, v75
    v_cvt_pk_bf16_f32 v228, v76, v77
    v_cvt_pk_bf16_f32 v229, v78, v79
    v_cvt_pk_bf16_f32 v246, v76, v77
    v_cvt_pk_bf16_f32 v247, v78, v79
    v_cvt_pk_bf16_f32 v230, -v80, -v81
    v_cvt_pk_bf16_f32 v231, -v82, -v83
    v_cvt_pk_bf16_f32 v244, v80, v81
    v_cvt_pk_bf16_f32 v245, v82, v83
    v_mul_f32 v73, 0x3ae38e39, v84
    v_mul_f32 v74, 0x3b638e39, v84
    v_mul_f32 v75, 0x3baaaaab, v84
    v_mul_f32 v76, 0x3be38e39, v84
    v_cos_f32 v248, v73
    v_sin_f32 v252, v73
    v_cos_f32 v249, v74
    v_sin_f32 v253, v74
    v_cos_f32 v250, v75
    v_sin_f32 v254, v75
    v_cos_f32 v251, v76
    v_sin_f32 v255, v76
    v_mul_f32 v248, 0x35e38e39, v248
    v_mul_f32 v249, 0x35e38e39, v249
    v_mul_f32 v250, 0x35e38e39, v250
    v_mul_f32 v251, 0x35e38e39, v251
    v_mul_f32 v252, 0x35e38e39, v252
    v_mul_f32 v253, 0x35e38e39, v253
    v_mul_f32 v254, 0x35e38e39, v254
    v_mul_f32 v255, 0x35e38e39, v255
    s_cmp_eq_u32 s3, 3
    s_cbranch_scc0 f_nofp
    s_cmp_ge_u32 s2, 226
    s_cbranch_scc0 f_nosl3
    s_sleep 20
f_nosl3:
    s_mov_b64 exec, 3
    v_lshlrev_b32 v2, 7, v1
    s_mov_b32 s50, 0
f_an4:
    buffer_load_dword v3, v2, s[24:27], 0 offen sc1
    s_add_u32 s50, s50, 1
    s_waitcnt vmcnt(0)
    v_cmp_eq_u32 vcc, 0, v3
    s_nop 1
    s_cbranch_vccz f_an4_ok
    s_sleep 2
    s_cmp_lt_u32 s50, 30000
    s_cbranch_scc1 f_an4
f_an4_ok:
    s_mov_b64 exec, -1
    v_lshlrev_b32 v2, 6, v1
    v_min_u32 v3, 448, v2
    s_mov_b32 s51, 144896
    s_mov_b32 s47, 148992
    s_mov_b32 s46, 153088
    s_mov_b32 s50, 0
f_pf:
    buffer_load_dword v48, v2, s[28:31], s51 offen sc1
    buffer_load_dword v49, v2, s[28:31], s47 offen sc1
    buffer_load_dword v50, v3, s[28:31], s46 offen sc1
    s_add_u32 s50, s50, 1
    s_waitcnt vmcnt(0)
    v_max3_u32 v51, v48, v49, v50
    v_cmp_eq_u32 vcc, -1, v51
    s_nop 0
    s_and_b64 exec, vcc, vcc
    s_cbranch_scc0 f_pf_ok
    s_cmp_lt_u32 s50, 30000
    s_cbranch_scc1 f_pf
f_pf_ok:
    s_mov_b64 exec, -1
f_nofp:
    s_branch f_staged
f_stage:
    s_waitcnt vmcnt(0)
    s_cmp_ge_u32 s2, 226
    s_cbranch_scc0 f_nosl0
    s_sleep 20
f_nosl0:
    s_mov_b64 exec, 3
    v_lshlrev_b32 v2, 7, v1
    s_mov_b32 s50, 0
f_an3:
    buffer_load_dword v3, v2, s[24:27], 0 offen sc1
    s_add_u32 s50, s50, 1
    s_waitcnt vmcnt(0)
    v_cmp_eq_u32 vcc, 0, v3
    s_nop 1
    s_cbranch_vccz f_an3_ok
    s_sleep 2
    s_cmp_lt_u32 s50, 30000
    s_cbranch_scc1 f_an3
f_an3_ok:
    s_mov_b64 exec, -1
    v_mul_u32_u24 v2, 24, v0
    s_mov_b32 s44, 0x20000
    s_mov_b32 s45, 0x21200
    s_mov_b32 s46, 0x22400
    v_cmp_lt_u32 vcc, 95, v0
    s_nop 1
    v_cndmask_b32 v3, 0, 1.0, vcc
    s_mov_b32 s47, 0xffff0000
    s_mov_b32 s50, 0
f_mp:
    buffer_load_dwordx4 v[84:87], v2, s[28:31], s44 offen sc1
    buffer_load_dwordx2 v[88:89], v2, s[28:31], s44 offen offset:16 sc1
    buffer_load_dwordx4 v[90:93], v2, s[28:31], s45 offen sc1
    buffer_load_dwordx2 v[94:95], v2, s[28:31], s45 offen offset:16 sc1
    buffer_load_dwordx4 v[96:99], v2, s[28:31], s46 offen sc1
    buffer_load_dwordx2 v[100:101], v2, s[28:31], s46 offen offset:16 sc1
    s_add_u32 s50, s50, 1
    s_waitcnt vmcnt(0)
    v_max3_u32 v72, v84, v85, v86
    v_max3_u32 v72, v72, v87, v88
    v_max3_u32 v72, v72, v89, v90
    v_max3_u32 v72, v72, v91, v92
    v_max3_u32 v72, v72, v93, v94
    v_max3_u32 v72, v72, v95, v96
    v_max3_u32 v72, v72, v97, v98
    v_max3_u32 v72, v72, v99, v100
    v_max_u32 v72, v72, v101
    v_cmp_eq_u32 vcc, -1, v72
    s_nop 0
    s_and_b64 exec, vcc, vcc
    s_cbranch_scc0 f_mp_ok
    s_cmp_lt_u32 s50, 30000
    s_cbranch_scc1 f_mp
f_mp_ok:
    s_mov_b64 exec, -1
    v_pk_add_f32 v[84:85], v[84:85], v[90:91]
    v_pk_add_f32 v[86:87], v[86:87], v[92:93]
    v_pk_add_f32 v[88:89], v[88:89], v[94:95]
    v_pk_add_f32 v[84:85], v[84:85], v[96:97]
    v_pk_add_f32 v[86:87], v[86:87], v[98:99]
    v_pk_add_f32 v[88:89], v[88:89], v[100:101]
    v_cvt_pk_bf16_f32 v72, v84, v85
    v_lshlrev_b32 v84, 16, v72
    v_and_b32 v85, s47, v72
    v_cvt_pk_bf16_f32 v73, v86, v87
    v_lshlrev_b32 v86, 16, v73
    v_and_b32 v87, s47, v73
    v_cvt_pk_bf16_f32 v72, v88, v89
    v_lshlrev_b32 v88, 16, v72
    v_and_b32 v89, s47, v72
    v_add_f32 v84, v84, v3
    v_add_f32 v85, v85, v3
    v_add_f32 v86, v86, v3
    v_add_f32 v87, v87, v3
    v_add_f32 v88, v88, v3
    v_add_f32 v89, v89, v3
    v_cvt_pk_bf16_f32 v72, v84, v85
    v_lshlrev_b32 v84, 16, v72
    v_and_b32 v85, s47, v72
    v_cvt_pk_bf16_f32 v73, v86, v87
    v_lshlrev_b32 v86, 16, v73
    v_and_b32 v87, s47, v73
    v_cvt_pk_bf16_f32 v72, v88, v89
    v_lshlrev_b32 v88, 16, v72
    v_and_b32 v89, s47, v72
    ds_write_b64 v2, v[84:85] offset:0
    ds_write_b64 v2, v[86:87] offset:8
    ds_write_b64 v2, v[88:89] offset:16
f_staged:
    s_load_dwordx2 s[8:9], s[0:1], 48
    s_mov_b32 s10, 0x1200000
    s_load_dwordx2 s[12:13], s[0:1], 56
    s_mov_b32 s14, 0x1000
    s_load_dwordx2 s[16:17], s[0:1], 80
    s_mov_b32 s18, 0x240000
    s_load_dwordx2 s[20:21], s[0:1], 40
    s_mov_b32 s22, 0x2400
    s_waitcnt lgkmcnt(0)
    s_barrier
    ds_read2st64_b32 v[36:37], v125 offset0:8 offset1:9
    ds_read2st64_b32 v[38:39], v125 offset0:10 offset1:11
    ds_read2st64_b32 v[40:41], v125 offset0:12 offset1:13
    ds_read2st64_b32 v[42:43], v125 offset0:14 offset1:15
    ds_read2st64_b32 v[44:45], v125 offset0:16 offset1:17
    ds_read2st64_b32 v[28:29], v125 offset0:0 offset1:1
    ds_read2st64_b32 v[30:31], v125 offset0:2 offset1:3
    ds_read2st64_b32 v[32:33], v125 offset0:4 offset1:5
    ds_read2st64_b32 v[34:35], v125 offset0:6 offset1:7
    s_waitcnt lgkmcnt(3)
    v_fma_f32 v8, v8, v37, v28
    v_fma_f32 v9, v9, v38, v29
    s_waitcnt lgkmcnt(2)
    v_fma_f32 v10, v10, v39, v30
    v_fma_f32 v11, v11, v40, v31
    s_waitcnt lgkmcnt(1)
    v_fma_f32 v12, v12, v41, v32
    v_fma_f32 v13, v13, v42, v33
    s_waitcnt lgkmcnt(0)
    v_fma_f32 v14, v14, v43, v34
    v_fma_f32 v15, v15, v44, v35
    v_fma_f32 v16, v16, v45, v36
    v_add_f32 v48, v9, v16
    v_sub_f32 v52, v9, v16
    v_add_f32 v49, v10, v15
    v_sub_f32 v53, v10, v15
    v_add_f32 v50, v11, v14
    v_sub_f32 v54, v11, v14
    v_add_f32 v51, v12, v13
    v_sub_f32 v55, v12, v13
    v_add_f32 v64, v8, v48
    v_add_f32 v65, v49, v50
    v_add_f32 v64, v64, v51
    v_add_f32 v64, v64, v65
    v_fmamk_f32 v56, v48, 0x3f441b7d, v8
    v_fmamk_f32 v57, v48, 0x3e31d0d4, v8
    v_fmamk_f32 v58, v48, 0xbf000000, v8
    v_fmamk_f32 v59, v48, 0xbf708fb2, v8
    v_fmamk_f32 v56, v49, 0x3e31d0d4, v56
    v_fmamk_f32 v57, v49, 0xbf708fb2, v57
    v_fmamk_f32 v58, v49, 0xbf000000, v58
    v_fmamk_f32 v59, v49, 0x3f441b7d, v59
    v_fmamk_f32 v56, v50, 0xbf000000, v56
    v_fmamk_f32 v57, v50, 0xbf000000, v57
    v_fmamk_f32 v58, v50, 0x3f800000, v58
    v_fmamk_f32 v59, v50, 0xbf000000, v59
    v_fmamk_f32 v56, v51, 0xbf708fb2, v56
    v_fmamk_f32 v57, v51, 0x3f441b7d, v57
    v_fmamk_f32 v58, v51, 0xbf000000, v58
    v_fmamk_f32 v59, v51, 0x3e31d0d4, v59
    v_mul_f32 v60, 0xbf248dbb, v52
    v_mul_f32 v61, 0xbf7c1c5c, v52
    v_mul_f32 v62, 0xbf5db3d7, v52
    v_mul_f32 v63, 0xbeaf1d44, v52
    v_fmamk_f32 v60, v53, 0xbf7c1c5c, v60
    v_fmamk_f32 v61, v53, 0xbeaf1d44, v61
    v_fmamk_f32 v62, v53, 0x3f5db3d7, v62
    v_fmamk_f32 v63, v53, 0x3f248dbb, v63
    v_fmamk_f32 v60, v54, 0xbf5db3d7, v60
    v_fmamk_f32 v61, v54, 0x3f5db3d7, v61
    v_fmamk_f32 v63, v54, 0xbf5db3d7, v63
    v_fmamk_f32 v60, v55, 0xbeaf1d44, v60
    v_fmamk_f32 v61, v55, 0x3f248dbb, v61
    v_fmamk_f32 v62, v55, 0xbf5db3d7, v62
    v_fmamk_f32 v63, v55, 0x3f7c1c5c, v63
    v_cvt_pk_bf16_f32 v64, v64, 0
    ds_write_b32 v104, v64
    v_pk_mul_f32 v[68:69], v[56:57], v[208:209]
    v_pk_mul_f32 v[72:73], v[60:61], v[208:209]
    v_pk_mul_f32 v[70:71], v[58:59], v[210:211]
    v_pk_mul_f32 v[74:75], v[62:63], v[210:211]
    v_pk_fma_f32 v[68:69], v[60:61], v[212:213], v[68:69]
    v_pk_fma_f32 v[72:73], v[56:57], v[212:213], v[72:73] neg_lo:[1,0,0] neg_hi:[1,0,0]
    v_pk_fma_f32 v[70:71], v[62:63], v[214:215], v[70:71]
    v_pk_fma_f32 v[74:75], v[58:59], v[214:215], v[74:75] neg_lo:[1,0,0] neg_hi:[1,0,0]
    v_cvt_pk_bf16_f32 v9, v68, v72
    ds_write_b32 v104, v9 offset:2176
    v_cvt_pk_bf16_f32 v10, v69, v73
    ds_write_b32 v104, v10 offset:4352
    v_cvt_pk_bf16_f32 v11, v70, v74
    ds_write_b32 v104, v11 offset:6528
    v_cvt_pk_bf16_f32 v12, v71, v75
    ds_write_b32 v104, v12 offset:8704
    s_cmp_lt_u32 s39, 2
    s_cselect_b32 s47, 0, 0x80000000
    s_waitcnt vmcnt(0) lgkmcnt(0)
    s_barrier
    ds_read_b128 v[28:31], v105 offset:0
    ds_read_b128 v[32:35], v105 offset:64
    ds_read_b128 v[36:39], v105 offset:128
    ds_read_b128 v[40:43], v105 offset:192
    s_cmp_eq_u32 s40, 1
    s_cbranch_scc1 f_p1_one
    ds_read_b128 v[44:47], v105 offset:4352
    ds_read_b128 v[48:51], v105 offset:4416
    ds_read_b128 v[52:55], v105 offset:4480
    ds_read_b128 v[56:59], v105 offset:4544
    s_waitcnt lgkmcnt(7)
    v_mfma_f32_16x16x32_bf16 v[60:63], v[28:31], v[128:131], 0
    v_mfma_f32_16x16x32_bf16 v[64:67], v[28:31], v[144:147], 0
    s_waitcnt lgkmcnt(6)
    v_mfma_f32_16x16x32_bf16 v[60:63], v[32:35], v[132:135], v[60:63]
    v_mfma_f32_16x16x32_bf16 v[64:67], v[32:35], v[148:151], v[64:67]
    s_waitcnt lgkmcnt(5)
    v_mfma_f32_16x16x32_bf16 v[60:63], v[36:39], v[136:139], v[60:63]
    v_mfma_f32_16x16x32_bf16 v[64:67], v[36:39], v[152:155], v[64:67]
    s_waitcnt lgkmcnt(4)
    v_mfma_f32_16x16x32_bf16 v[60:63], v[40:43], v[140:143], v[60:63]
    v_mfma_f32_16x16x32_bf16 v[64:67], v[40:43], v[156:159], v[64:67]
    s_waitcnt lgkmcnt(3)
    v_mfma_f32_16x16x32_bf16 v[68:71], v[44:47], v[128:131], 0
    v_mfma_f32_16x16x32_bf16 v[72:75], v[44:47], v[144:147], 0
    s_waitcnt lgkmcnt(2)
    v_mfma_f32_16x16x32_bf16 v[68:71], v[48:51], v[132:135], v[68:71]
    v_mfma_f32_16x16x32_bf16 v[72:75], v[48:51], v[148:151], v[72:75]
    s_waitcnt lgkmcnt(1)
    v_mfma_f32_16x16x32_bf16 v[68:71], v[52:55], v[136:139], v[68:71]
    v_mfma_f32_16x16x32_bf16 v[72:75], v[52:55], v[152:155], v[72:75]
    s_waitcnt lgkmcnt(0)
    v_mfma_f32_16x16x32_bf16 v[68:71], v[56:59], v[140:143], v[68:71]
    v_mfma_f32_16x16x32_bf16 v[72:75], v[56:59], v[156:159], v[72:75]
    v_cvt_pk_bf16_f32 v76, v60, v64
    v_cvt_pk_bf16_f32 v77, v61, v65
    v_cvt_pk_bf16_f32 v78, v62, v66
    v_cvt_pk_bf16_f32 v79, v63, v67
    v_xor_b32 v76, s47, v76
    v_xor_b32 v77, s47, v77
    v_xor_b32 v78, s47, v78
    v_xor_b32 v79, s47, v79
    buffer_store_dwordx4 v[76:79], v106, s[28:31], s56 offen sc1
    v_cvt_pk_bf16_f32 v80, v68, v72
    v_cvt_pk_bf16_f32 v81, v69, v73
    v_cvt_pk_bf16_f32 v82, v70, v74
    v_cvt_pk_bf16_f32 v83, v71, v75
    v_xor_b32 v80, s47, v80
    v_xor_b32 v81, s47, v81
    v_xor_b32 v82, s47, v82
    v_xor_b32 v83, s47, v83
    buffer_store_dwordx4 v[80:83], v107, s[28:31], s56 offen sc1
    s_branch f_p1_join
f_p1_one:
    s_waitcnt lgkmcnt(3)
    v_mfma_f32_16x16x32_bf16 v[60:63], v[28:31], v[128:131], 0
    v_mfma_f32_16x16x32_bf16 v[64:67], v[28:31], v[144:147], 0
    s_waitcnt lgkmcnt(2)
    v_mfma_f32_16x16x32_bf16 v[60:63], v[32:35], v[132:135], v[60:63]
    v_mfma_f32_16x16x32_bf16 v[64:67], v[32:35], v[148:151], v[64:67]
    s_waitcnt lgkmcnt(1)
    v_mfma_f32_16x16x32_bf16 v[60:63], v[36:39], v[136:139], v[60:63]
    v_mfma_f32_16x16x32_bf16 v[64:67], v[36:39], v[152:155], v[64:67]
    s_waitcnt lgkmcnt(0)
    v_mfma_f32_16x16x32_bf16 v[60:63], v[40:43], v[140:143], v[60:63]
    v_mfma_f32_16x16x32_bf16 v[64:67], v[40:43], v[156:159], v[64:67]
    s_nop 7
    v_cvt_pk_bf16_f32 v76, v60, v64
    v_cvt_pk_bf16_f32 v77, v61, v65
    v_cvt_pk_bf16_f32 v78, v62, v66
    v_cvt_pk_bf16_f32 v79, v63, v67
    v_xor_b32 v76, s47, v76
    v_xor_b32 v77, s47, v77
    v_xor_b32 v78, s47, v78
    v_xor_b32 v79, s47, v79
    buffer_store_dwordx4 v[76:79], v106, s[28:31], s56 offen sc1
f_p1_join:
    s_cmp_lt_u32 s3, 3
    s_cbranch_scc0 f_c3done
    v_cvt_f32_u32 v96, v7
    v_cvt_f32_u32 v97, v6
    v_mul_f32 v97, v97, v96
    v_mul_f32 v97, 0x3d800000, v97
    v_fmamk_f32 v84, v96, 0x00000000, v97
    v_fmamk_f32 v85, v96, 0x3c800000, v97
    v_fmamk_f32 v86, v96, 0x3d000000, v97
    v_fmamk_f32 v87, v96, 0x3d400000, v97
    v_cos_f32 v88, v84
    v_sin_f32 v92, v84
    v_cos_f32 v89, v85
    v_sin_f32 v93, v85
    v_cos_f32 v90, v86
    v_sin_f32 v94, v86
    v_cos_f32 v91, v87
    v_sin_f32 v95, v87
    v_cvt_pk_bf16_f32 v216, v88, v89
    v_cvt_pk_bf16_f32 v217, v90, v91
    v_cvt_pk_bf16_f32 v234, -v88, -v89
    v_cvt_pk_bf16_f32 v235, -v90, -v91
    v_cvt_pk_bf16_f32 v218, v92, v93
    v_cvt_pk_bf16_f32 v219, v94, v95
    v_cvt_pk_bf16_f32 v232, v92, v93
    v_cvt_pk_bf16_f32 v233, v94, v95
    v_fmamk_f32 v84, v96, 0x3e800000, v97
    v_fmamk_f32 v85, v96, 0x3e880000, v97
    v_fmamk_f32 v86, v96, 0x3e900000, v97
    v_fmamk_f32 v87, v96, 0x3e980000, v97
    v_cos_f32 v88, v84
    v_sin_f32 v92, v84
    v_cos_f32 v89, v85
    v_sin_f32 v93, v85
    v_cos_f32 v90, v86
    v_sin_f32 v94, v86
    v_cos_f32 v91, v87
    v_sin_f32 v95, v87
    v_cvt_pk_bf16_f32 v220, v88, v89
    v_cvt_pk_bf16_f32 v221, v90, v91
    v_cvt_pk_bf16_f32 v238, -v88, -v89
    v_cvt_pk_bf16_f32 v239, -v90, -v91
    v_cvt_pk_bf16_f32 v222, v92, v93
    v_cvt_pk_bf16_f32 v223, v94, v95
    v_cvt_pk_bf16_f32 v236, v92, v93
    v_cvt_pk_bf16_f32 v237, v94, v95
    v_fmamk_f32 v84, v96, 0x3f000000, v97
    v_fmamk_f32 v85, v96, 0x3f040000, v97
    v_fmamk_f32 v86, v96, 0x3f080000, v97
    v_fmamk_f32 v87, v96, 0x3f0c0000, v97
    v_cos_f32 v88, v84
    v_sin_f32 v92, v84
    v_cos_f32 v89, v85
    v_sin_f32 v93, v85
    v_cos_f32 v90, v86
    v_sin_f32 v94, v86
    v_cos_f32 v91, v87
    v_sin_f32 v95, v87
    v_cvt_pk_bf16_f32 v224, v88, v89
    v_cvt_pk_bf16_f32 v225, v90, v91
    v_cvt_pk_bf16_f32 v242, v88, v89
    v_cvt_pk_bf16_f32 v243, v90, v91
    v_cvt_pk_bf16_f32 v226, -v92, -v93
    v_cvt_pk_bf16_f32 v227, -v94, -v95
    v_cvt_pk_bf16_f32 v240, v92, v93
    v_cvt_pk_bf16_f32 v241, v94, v95
    v_fmamk_f32 v84, v96, 0x3f400000, v97
    v_fmamk_f32 v85, v96, 0x3f440000, v97
    v_fmamk_f32 v86, v96, 0x3f480000, v97
    v_fmamk_f32 v87, v96, 0x3f4c0000, v97
    v_cos_f32 v88, v84
    v_sin_f32 v92, v84
    v_cos_f32 v89, v85
    v_sin_f32 v93, v85
    v_cos_f32 v90, v86
    v_sin_f32 v94, v86
    v_cos_f32 v91, v87
    v_sin_f32 v95, v87
    v_cvt_pk_bf16_f32 v228, v88, v89
    v_cvt_pk_bf16_f32 v229, v90, v91
    v_cvt_pk_bf16_f32 v246, v88, v89
    v_cvt_pk_bf16_f32 v247, v90, v91
    v_cvt_pk_bf16_f32 v230, -v92, -v93
    v_cvt_pk_bf16_f32 v231, -v94, -v95
    v_cvt_pk_bf16_f32 v244, v92, v93
    v_cvt_pk_bf16_f32 v245, v94, v95
    v_mul_f32 v85, 0x3ae38e39, v96
    v_mul_f32 v86, 0x3b638e39, v96
    v_mul_f32 v87, 0x3baaaaab, v96
    v_mul_f32 v88, 0x3be38e39, v96
    v_cos_f32 v248, v85
    v_sin_f32 v252, v85
    v_cos_f32 v249, v86
    v_sin_f32 v253, v86
    v_cos_f32 v250, v87
    v_sin_f32 v254, v87
    v_cos_f32 v251, v88
    v_sin_f32 v255, v88
    v_mul_f32 v248, 0x35e38e39, v248
    v_mul_f32 v249, 0x35e38e39, v249
    v_mul_f32 v250, 0x35e38e39, v250
    v_mul_f32 v251, 0x35e38e39, v251
    v_mul_f32 v252, 0x35e38e39, v252
    v_mul_f32 v253, 0x35e38e39, v253
    v_mul_f32 v254, 0x35e38e39, v254
    v_mul_f32 v255, 0x35e38e39, v255
f_c3done:
    s_mul_i32 s63, s36, 27
    s_add_u32 s63, s63, s37
    s_mul_i32 s62, s63, 171
    s_lshr_b32 s62, s62, 10
    s_mul_i32 s60, s62, 6
    s_sub_u32 s63, s63, s60
    s_lshl_b32 s60, s62, 8
    s_mul_i32 s61, s39, 147456
    s_add_u32 s60, s60, s61
    s_mul_i32 s61, s63, 393216
    s_mul_i32 s24, s39, 3072
    s_add_u32 s61, s61, s24
    s_add_u32 s61, s61, 13631488
    s_lshl_b32 s24, s39, 12
    s_add_u32 s24, s24, 98304
    v_lshrrev_b32 v2, 4, v1
    v_and_b32 v3, 15, v1
    v_lshlrev_b32 v9, 1, v2
    v_xor_b32 v9, v9, v3
    v_xor_b32 v10, 8, v9
    v_mul_u32_u24 v2, 9216, v2
    v_lshl_add_u32 v9, v9, 4, v2
    v_lshl_add_u32 v10, v10, 4, v2
    v_lshlrev_b32 v14, 4, v1
    v_lshlrev_b32 v15, 2, v1
    s_cmp_eq_u32 s42, -1
    s_cbranch_scc1 f_p2_idle
    s_and_b32 s50, s39, 1
    s_lshl_b32 s50, s50, 4
    s_lshr_b32 s51, s39, 1
    s_add_u32 s50, s50, s51
    s_mul_i32 s50, s50, 81920
    s_lshl_b32 s51, s42, 5
    s_add_u32 s50, s50, s51
    s_add_u32 s44, s50, 4194304
    s_add_u32 s45, s44, 655360
    s_lshl_b32 s50, s3, 11
    s_add_u32 s50, s50, 27904
    v_add_u32 v2, s50, v109
    s_lshl_b32 s50, s40, 13
    s_add_u32 s50, s50, 27904
    v_add_u32 v3, s50, v109
    s_lshr_b32 s50, s42, 6
    s_and_b32 s51, s42, 63
    s_mul_i32 s46, s51, 9
    s_add_u32 s46, s46, s50
    s_sub_u32 s50, 576, s46
    s_cmp_lt_u32 s51, 32
    s_cselect_b32 s46, s46, s50
    s_lshl_b32 s46, s46, 13
    s_lshl_b32 s50, s39, 11
    s_add_u32 s46, s46, s50
    s_add_u32 s46, s46, 1048576
    s_lshl_b32 s48, s42, 13
    s_add_u32 s48, s48, 7340032
    s_mov_b32 s47, 0xffff0000
    s_waitcnt vmcnt(0)
    s_mov_b32 s50, 0
f_hb:
    buffer_load_dwordx4 v[28:31], v108, s[28:31], s44 offen sc1
    buffer_load_dwordx4 v[32:35], v108, s[28:31], s45 offen sc1
    s_add_u32 s50, s50, 1
    s_waitcnt vmcnt(0)
    v_max3_u32 v84, v28, v29, v30
    v_max3_u32 v84, v84, v31, v32
    v_max3_u32 v84, v84, v33, v34
    v_max_u32 v84, v84, v35
    v_cmp_eq_u32 vcc, -1, v84
    s_nop 0
    s_and_b64 exec, vcc, vcc
    s_cbranch_scc0 f_hb_ok
    s_cmp_lt_u32 s50, 30000
    s_cbranch_scc1 f_hb
f_hb_ok:
    s_mov_b64 exec, -1
    buffer_load_dwordx4 v[96:99], v109, s[28:31], s46 offen offset:0 sc1
    buffer_load_dwordx4 v[100:103], v109, s[28:31], s46 offen offset:1024 sc1
    ds_write_b128 v2, v[28:31] offset:0
    ds_write_b128 v2, v[32:35] offset:1024
    s_waitcnt lgkmcnt(0)
    s_barrier
    s_add_u32 m0, s55, 83200
    s_nop 0
    buffer_load_dwordx4 v109, s[4:7], s49 offen lds
    s_mov_b64 exec, 0xff
    buffer_load_dwordx4 v109, s[4:7], s49 offen offset:1024 lds
    s_mov_b64 exec, -1
    ds_read_b128 v[28:31], v3 offset:0
    ds_read_b128 v[44:47], v3 offset:4096
    ds_read_b128 v[32:35], v3 offset:1024
    ds_read_b128 v[48:51], v3 offset:5120
    ds_read_b128 v[36:39], v3 offset:2048
    ds_read_b128 v[52:55], v3 offset:6144
    ds_read_b128 v[40:43], v3 offset:3072
    ds_read_b128 v[56:59], v3 offset:7168
    s_waitcnt lgkmcnt(7)
    v_mfma_f32_16x16x32_bf16 v[60:63], v[28:31], v[128:131], 0
    v_mfma_f32_16x16x32_bf16 v[64:67], v[28:31], v[144:147], 0
    s_waitcnt lgkmcnt(6)
    v_mfma_f32_16x16x32_bf16 v[68:71], v[44:47], v[128:131], 0
    v_mfma_f32_16x16x32_bf16 v[72:75], v[44:47], v[144:147], 0
    s_waitcnt lgkmcnt(5)
    v_mfma_f32_16x16x32_bf16 v[60:63], v[32:35], v[132:135], v[60:63]
    v_mfma_f32_16x16x32_bf16 v[64:67], v[32:35], v[148:151], v[64:67]
    s_waitcnt lgkmcnt(4)
    v_mfma_f32_16x16x32_bf16 v[68:71], v[48:51], v[132:135], v[68:71]
    v_mfma_f32_16x16x32_bf16 v[72:75], v[48:51], v[148:151], v[72:75]
    s_waitcnt lgkmcnt(3)
    v_mfma_f32_16x16x32_bf16 v[60:63], v[36:39], v[136:139], v[60:63]
    v_mfma_f32_16x16x32_bf16 v[64:67], v[36:39], v[152:155], v[64:67]
    s_waitcnt lgkmcnt(2)
    v_mfma_f32_16x16x32_bf16 v[68:71], v[52:55], v[136:139], v[68:71]
    v_mfma_f32_16x16x32_bf16 v[72:75], v[52:55], v[152:155], v[72:75]
    s_waitcnt lgkmcnt(1)
    v_mfma_f32_16x16x32_bf16 v[60:63], v[40:43], v[140:143], v[60:63]
    v_mfma_f32_16x16x32_bf16 v[64:67], v[40:43], v[156:159], v[64:67]
    s_waitcnt lgkmcnt(0)
    v_mfma_f32_16x16x32_bf16 v[68:71], v[56:59], v[140:143], v[68:71]
    v_mfma_f32_16x16x32_bf16 v[72:75], v[56:59], v[156:159], v[72:75]
    s_nop 3
    v_pk_mul_f32 v[84:85], v[60:61], v[192:193]
    v_pk_mul_f32 v[88:89], v[64:65], v[192:193]
    v_pk_mul_f32 v[86:87], v[62:63], v[194:195]
    v_pk_mul_f32 v[90:91], v[66:67], v[194:195]
    v_pk_fma_f32 v[84:85], v[64:65], v[200:201], v[84:85]
    v_pk_fma_f32 v[88:89], v[60:61], v[200:201], v[88:89] neg_lo:[1,0,0] neg_hi:[1,0,0]
    v_pk_fma_f32 v[86:87], v[66:67], v[202:203], v[86:87]
    v_pk_fma_f32 v[90:91], v[62:63], v[202:203], v[90:91] neg_lo:[1,0,0] neg_hi:[1,0,0]
    v_cvt_pk_bf16_f32 v76, v84, v85
    v_cvt_pk_bf16_f32 v77, v86, v87
    v_cvt_pk_bf16_f32 v78, v88, v89
    v_cvt_pk_bf16_f32 v79, v90, v91
    v_pk_mul_f32 v[84:85], v[68:69], v[196:197]
    v_pk_mul_f32 v[88:89], v[72:73], v[196:197]
    v_pk_mul_f32 v[86:87], v[70:71], v[198:199]
    v_pk_mul_f32 v[90:91], v[74:75], v[198:199]
    v_pk_fma_f32 v[84:85], v[72:73], v[204:205], v[84:85]
    v_pk_fma_f32 v[88:89], v[68:69], v[204:205], v[88:89] neg_lo:[1,0,0] neg_hi:[1,0,0]
    v_pk_fma_f32 v[86:87], v[74:75], v[206:207], v[86:87]
    v_pk_fma_f32 v[90:91], v[70:71], v[206:207], v[90:91] neg_lo:[1,0,0] neg_hi:[1,0,0]
    v_cvt_pk_bf16_f32 v80, v84, v85
    v_cvt_pk_bf16_f32 v81, v86, v87
    v_cvt_pk_bf16_f32 v82, v88, v89
    v_cvt_pk_bf16_f32 v83, v90, v91
    v_mfma_f32_16x16x32_bf16 v[60:63], v[160:163], v[76:79], 0
    v_mfma_f32_16x16x32_bf16 v[64:67], v[176:179], v[76:79], 0
    v_mfma_f32_16x16x32_bf16 v[68:71], v[168:171], v[76:79], 0
    v_mfma_f32_16x16x32_bf16 v[72:75], v[184:187], v[76:79], 0
    v_mfma_f32_16x16x32_bf16 v[60:63], v[164:167], v[80:83], v[60:63]
    v_mfma_f32_16x16x32_bf16 v[64:67], v[180:183], v[80:83], v[64:67]
    v_mfma_f32_16x16x32_bf16 v[68:71], v[172:175], v[80:83], v[68:71]
    v_mfma_f32_16x16x32_bf16 v[72:75], v[188:191], v[80:83], v[72:75]
    s_waitcnt vmcnt(2)
    v_lshlrev_b32 v28, 16, v96
    v_and_b32 v36, s47, v96
    v_lshlrev_b32 v29, 16, v97
    v_and_b32 v37, s47, v97
    v_lshlrev_b32 v30, 16, v98
    v_and_b32 v38, s47, v98
    v_lshlrev_b32 v31, 16, v99
    v_and_b32 v39, s47, v99
    v_lshlrev_b32 v32, 16, v100
    v_and_b32 v40, s47, v100
    v_lshlrev_b32 v33, 16, v101
    v_and_b32 v41, s47, v101
    v_lshlrev_b32 v34, 16, v102
    v_and_b32 v42, s47, v102
    v_lshlrev_b32 v35, 16, v103
    v_and_b32 v43, s47, v103
    v_pk_mul_f32 v[84:85], v[60:61], v[28:29]
    v_pk_mul_f32 v[88:89], v[64:65], v[28:29] neg_lo:[1,0] neg_hi:[1,0]
    v_pk_mul_f32 v[86:87], v[62:63], v[30:31]
    v_pk_mul_f32 v[90:91], v[66:67], v[30:31] neg_lo:[1,0] neg_hi:[1,0]
    v_pk_fma_f32 v[84:85], v[64:65], v[36:37], v[84:85] neg_lo:[1,0,0] neg_hi:[1,0,0]
    v_pk_fma_f32 v[88:89], v[60:61], v[36:37], v[88:89] neg_lo:[1,0,0] neg_hi:[1,0,0]
    v_pk_fma_f32 v[86:87], v[66:67], v[38:39], v[86:87] neg_lo:[1,0,0] neg_hi:[1,0,0]
    v_pk_fma_f32 v[90:91], v[62:63], v[38:39], v[90:91] neg_lo:[1,0,0] neg_hi:[1,0,0]
    v_cvt_pk_bf16_f32 v76, v84, v85
    v_cvt_pk_bf16_f32 v77, v86, v87
    v_cvt_pk_bf16_f32 v78, v88, v89
    v_cvt_pk_bf16_f32 v79, v90, v91
    v_pk_mul_f32 v[84:85], v[68:69], v[32:33]
    v_pk_mul_f32 v[88:89], v[72:73], v[32:33] neg_lo:[1,0] neg_hi:[1,0]
    v_pk_mul_f32 v[86:87], v[70:71], v[34:35]
    v_pk_mul_f32 v[90:91], v[74:75], v[34:35] neg_lo:[1,0] neg_hi:[1,0]
    v_pk_fma_f32 v[84:85], v[72:73], v[40:41], v[84:85] neg_lo:[1,0,0] neg_hi:[1,0,0]
    v_pk_fma_f32 v[88:89], v[68:69], v[40:41], v[88:89] neg_lo:[1,0,0] neg_hi:[1,0,0]
    v_pk_fma_f32 v[86:87], v[74:75], v[42:43], v[86:87] neg_lo:[1,0,0] neg_hi:[1,0,0]
    v_pk_fma_f32 v[90:91], v[70:71], v[42:43], v[90:91] neg_lo:[1,0,0] neg_hi:[1,0,0]
    v_cvt_pk_bf16_f32 v80, v84, v85
    v_cvt_pk_bf16_f32 v81, v86, v87
    v_cvt_pk_bf16_f32 v82, v88, v89
    v_cvt_pk_bf16_f32 v83, v90, v91
    v_mfma_f32_16x16x32_bf16 v[60:63], v[160:163], v[76:79], 0
    v_mfma_f32_16x16x32_bf16 v[64:67], v[176:179], v[76:79], 0
    v_mfma_f32_16x16x32_bf16 v[68:71], v[168:171], v[76:79], 0
    v_mfma_f32_16x16x32_bf16 v[72:75], v[184:187], v[76:79], 0
    v_mfma_f32_16x16x32_bf16 v[60:63], v[164:167], v[80:83], v[60:63]
    v_mfma_f32_16x16x32_bf16 v[64:67], v[180:183], v[80:83], v[64:67]
    v_mfma_f32_16x16x32_bf16 v[68:71], v[172:175], v[80:83], v[68:71]
    v_mfma_f32_16x16x32_bf16 v[72:75], v[188:191], v[80:83], v[72:75]
    s_nop 4
    v_pk_mul_f32 v[84:85], v[60:61], v[192:193]
    v_pk_mul_f32 v[88:89], v[64:65], v[192:193]
    v_pk_mul_f32 v[86:87], v[62:63], v[194:195]
    v_pk_mul_f32 v[90:91], v[66:67], v[194:195]
    v_pk_fma_f32 v[84:85], v[64:65], v[200:201], v[84:85]
    v_pk_fma_f32 v[88:89], v[60:61], v[200:201], v[88:89] neg_lo:[1,0,0] neg_hi:[1,0,0]
    v_pk_fma_f32 v[86:87], v[66:67], v[202:203], v[86:87]
    v_pk_fma_f32 v[90:91], v[62:63], v[202:203], v[90:91] neg_lo:[1,0,0] neg_hi:[1,0,0]
    v_cvt_pk_bf16_f32 v92, v84, v88
    ds_write_b32 v110, v92 offset:0
    v_cvt_pk_bf16_f32 v93, v85, v89
    ds_write_b32 v110, v93 offset:272
    v_cvt_pk_bf16_f32 v94, v86, v90
    ds_write_b32 v110, v94 offset:544
    v_cvt_pk_bf16_f32 v95, v87, v91
    ds_write_b32 v110, v95 offset:816
    v_pk_mul_f32 v[84:85], v[68:69], v[196:197]
    v_pk_mul_f32 v[88:89], v[72:73], v[196:197]
    v_pk_mul_f32 v[86:87], v[70:71], v[198:199]
    v_pk_mul_f32 v[90:91], v[74:75], v[198:199]
    v_pk_fma_f32 v[84:85], v[72:73], v[204:205], v[84:85]
    v_pk_fma_f32 v[88:89], v[68:69], v[204:205], v[88:89] neg_lo:[1,0,0] neg_hi:[1,0,0]
    v_pk_fma_f32 v[86:87], v[74:75], v[206:207], v[86:87]
    v_pk_fma_f32 v[90:91], v[70:71], v[206:207], v[90:91] neg_lo:[1,0,0] neg_hi:[1,0,0]
    v_cvt_pk_bf16_f32 v92, v84, v88
    ds_write_b32 v110, v92 offset:4352
    v_cvt_pk_bf16_f32 v93, v85, v89
    ds_write_b32 v110, v93 offset:4624
    v_cvt_pk_bf16_f32 v94, v86, v90
    ds_write_b32 v110, v94 offset:4896
    v_cvt_pk_bf16_f32 v95, v87, v91
    ds_write_b32 v110, v95 offset:5168
    s_waitcnt lgkmcnt(0)
    s_barrier
    ds_read_b128 v[28:31], v111 offset:0
    ds_read_b128 v[44:47], v111 offset:4352
    ds_read_b128 v[32:35], v111 offset:64
    ds_read_b128 v[48:51], v111 offset:4416
    ds_read_b128 v[36:39], v111 offset:128
    ds_read_b128 v[52:55], v111 offset:4480
    ds_read_b128 v[40:43], v111 offset:192
    ds_read_b128 v[56:59], v111 offset:4544
    s_waitcnt lgkmcnt(7)
    v_mfma_f32_16x16x32_bf16 v[60:63], v[28:31], v[128:131], 0
    v_mfma_f32_16x16x32_bf16 v[64:67], v[28:31], v[144:147], 0
    s_waitcnt lgkmcnt(6)
    v_mfma_f32_16x16x32_bf16 v[68:71], v[44:47], v[128:131], 0
    v_mfma_f32_16x16x32_bf16 v[72:75], v[44:47], v[144:147], 0
    s_waitcnt lgkmcnt(5)
    v_mfma_f32_16x16x32_bf16 v[60:63], v[32:35], v[132:135], v[60:63]
    v_mfma_f32_16x16x32_bf16 v[64:67], v[32:35], v[148:151], v[64:67]
    s_waitcnt lgkmcnt(4)
    v_mfma_f32_16x16x32_bf16 v[68:71], v[48:51], v[132:135], v[68:71]
    v_mfma_f32_16x16x32_bf16 v[72:75], v[48:51], v[148:151], v[72:75]
    s_waitcnt lgkmcnt(3)
    v_mfma_f32_16x16x32_bf16 v[60:63], v[36:39], v[136:139], v[60:63]
    v_mfma_f32_16x16x32_bf16 v[64:67], v[36:39], v[152:155], v[64:67]
    s_waitcnt lgkmcnt(2)
    v_mfma_f32_16x16x32_bf16 v[68:71], v[52:55], v[136:139], v[68:71]
    v_mfma_f32_16x16x32_bf16 v[72:75], v[52:55], v[152:155], v[72:75]
    s_waitcnt lgkmcnt(1)
    v_mfma_f32_16x16x32_bf16 v[60:63], v[40:43], v[140:143], v[60:63]
    v_mfma_f32_16x16x32_bf16 v[64:67], v[40:43], v[156:159], v[64:67]
    s_waitcnt lgkmcnt(0)
    v_mfma_f32_16x16x32_bf16 v[68:71], v[56:59], v[140:143], v[68:71]
    v_mfma_f32_16x16x32_bf16 v[72:75], v[56:59], v[156:159], v[72:75]
    s_nop 3
    v_cvt_pk_bf16_f32 v84, v60, v61
    v_cvt_pk_bf16_f32 v85, v62, v63
    v_cvt_pk_bf16_f32 v86, v64, v65
    v_cvt_pk_bf16_f32 v87, v66, v67
    buffer_store_dwordx4 v[84:87], v112, s[28:31], s48 offen sc1
    v_cvt_pk_bf16_f32 v88, v68, v69
    v_cvt_pk_bf16_f32 v89, v70, v71
    v_cvt_pk_bf16_f32 v90, v72, v73
    v_cvt_pk_bf16_f32 v91, v74, v75
    s_add_u32 s48, s48, 4096
    buffer_store_dwordx4 v[88:91], v112, s[28:31], s48 offen sc1
    s_branch f_p2_done
f_p2_idle:
    s_barrier
    s_add_u32 m0, s55, 83200
    s_nop 0
    buffer_load_dwordx4 v109, s[4:7], s49 offen lds
    s_mov_b64 exec, 0xff
    buffer_load_dwordx4 v109, s[4:7], s49 offen offset:1024 lds
    s_mov_b64 exec, -1
    s_cmp_lt_u32 s2, 216
    s_cbranch_scc0 f_pla
    s_mov_b32 m0, s24
    s_nop 0
    buffer_load_dwordx4 v9, s[32:35], s60 offen offset:0 lds
    s_add_u32 s25, s60, 35840
    buffer_load_dwordx4 v9, s[32:35], s25 offen offset:1024 lds
    s_add_u32 s26, s60, 71680
    buffer_load_dwordx4 v10, s[32:35], s26 offen offset:2048 lds
    s_add_u32 s27, s60, 107520
    buffer_load_dwordx4 v10, s[32:35], s27 offen offset:3072 lds
    s_add_u32 s60, s60, 589824
    s_add_u32 s24, s24, 16384
    s_mov_b32 m0, s24
    s_nop 0
    buffer_load_dwordx4 v9, s[32:35], s60 offen offset:0 lds
    s_add_u32 s25, s60, 35840
    buffer_load_dwordx4 v9, s[32:35], s25 offen offset:1024 lds
    s_add_u32 s26, s60, 71680
    buffer_load_dwordx4 v10, s[32:35], s26 offen offset:2048 lds
    s_add_u32 s27, s60, 107520
    buffer_load_dwordx4 v10, s[32:35], s27 offen offset:3072 lds
    s_add_u32 s60, s60, 589824
    s_add_u32 s24, s24, 16384
f_pla:
    s_barrier
f_p2_done:
    s_mov_b32 s44, 0x26000
    s_mov_b32 s45, 0x28400
    s_mov_b32 s46, 0x2a800
    buffer_load_dwordx4 v[28:31], v126, s[28:31], s44 offen
    buffer_load_dwordx4 v[32:35], v126, s[28:31], s45 offen
    buffer_load_dwordx4 v[36:39], v126, s[28:31], s46 offen
    s_bfe_u32 s50, s38, 0x10001
    s_lshl_b32 s50, s50, 6
    s_lshr_b32 s51, s38, 2
    s_add_u32 s50, s50, s51
    s_lshl_b32 s50, s50, 1
    s_and_b32 s51, s38, 1
    s_add_u32 s50, s50, s51
    s_lshl_b32 s50, s50, 5
    s_add_u32 s48, s50, 7340032
    v_subrev_u32 v2, 288, v0
    v_cmp_gt_u32 vcc, 144, v2
    s_nop 1
    v_cndmask_b32 v3, 0, 1.0, vcc
    v_lshlrev_b32 v2, 4, v0
    s_mov_b32 s47, 0xffff0000
    s_waitcnt vmcnt(0)
    v_pk_add_f32 v[28:29], v[28:29], v[32:33]
    v_pk_add_f32 v[30:31], v[30:31], v[34:35]
    v_pk_add_f32 v[28:29], v[28:29], v[36:37]
    v_pk_add_f32 v[30:31], v[30:31], v[38:39]
    v_cvt_pk_bf16_f32 v48, v28, v29
    v_lshlrev_b32 v28, 16, v48
    v_and_b32 v29, s47, v48
    v_cvt_pk_bf16_f32 v49, v30, v31
    v_lshlrev_b32 v30, 16, v49
    v_and_b32 v31, s47, v49
    v_add_f32 v28, v28, v3
    v_add_f32 v29, v29, v3
    v_add_f32 v30, v30, v3
    v_add_f32 v31, v31, v3
    v_cvt_pk_bf16_f32 v48, v28, v29
    v_lshlrev_b32 v28, 16, v48
    v_and_b32 v29, s47, v48
    v_cvt_pk_bf16_f32 v49, v30, v31
    v_lshlrev_b32 v30, 16, v49
    v_and_b32 v31, s47, v49
    ds_write_b128 v2, v[28:31] offset:6656
    s_cmp_ge_u32 s2, 254
    s_cselect_b32 s50, s3, 0
    s_cmp_ge_u32 s50, 6
    s_cbranch_scc0 f_nogb
    v_subrev_u32 v2, 432, v0
    v_cmp_gt_u32 vcc, 72, v2
    v_mov_b32 v3, 0x7f000000
    s_nop 0
    v_cndmask_b32 v2, v3, v126, vcc
    s_movk_i32 s50, 4608
    buffer_store_dwordx4 v[28:31], v2, s[28:31], s50 offen sc1
    s_waitcnt vmcnt(0)
f_nogb:
    s_cmp_lt_u32 s2, 33
    s_cbranch_scc1 f_nozsl
    s_sleep 16
f_nozsl:
    s_cmp_lt_u32 s3, 2
    s_cbranch_scc1 f_z2
    s_mov_b32 s50, 0
f_za:
    buffer_load_dwordx4 v[40:43], v113, s[28:31], s48 offen sc1
    s_add_u32 s50, s50, 1
    s_waitcnt vmcnt(0)
    v_max3_u32 v48, v40, v41, v42
    v_max_u32 v48, v48, v43
    v_cmp_eq_u32 vcc, -1, v48
    s_nop 0
    s_and_b64 exec, vcc, vcc
    s_cbranch_scc0 f_za_ok
    s_cmp_lt_u32 s50, 30000
    s_cbranch_scc1 f_za
f_za_ok:
    s_mov_b64 exec, -1
    s_branch f_zj
f_z2:
    s_mov_b32 s50, 0
f_zb:
    buffer_load_dwordx4 v[40:43], v113, s[28:31], s48 offen sc1
    buffer_load_dwordx4 v[44:47], v114, s[28:31], s48 offen sc1
    s_add_u32 s50, s50, 1
    s_waitcnt vmcnt(0)
    v_max3_u32 v48, v40, v41, v42
    v_max3_u32 v48, v48, v43, v44
    v_max3_u32 v48, v48, v45, v46
    v_max_u32 v48, v48, v47
    v_cmp_eq_u32 vcc, -1, v48
    s_nop 0
    s_and_b64 exec, vcc, vcc
    s_cbranch_scc0 f_zb_ok
    s_cmp_lt_u32 s50, 30000
    s_cbranch_scc1 f_zb
f_zb_ok:
    s_mov_b64 exec, -1
    ds_write_b64 v115, v[44:45] offset:2304
    ds_write_b64 v115, v[46:47] offset:5184
f_zj:
    ds_write_b64 v115, v[40:41]
    ds_write_b64 v115, v[42:43] offset:2880
    s_cmp_lt_u32 s3, 4
    s_cbranch_scc1 f_plb_done
    s_cmp_lt_u32 s2, 33
    s_cbranch_scc0 f_plb
    s_cmp_lt_u32 s2, 216
    s_cbranch_scc0 f_plb0
    s_mov_b32 m0, s24
    s_nop 0
    buffer_load_dwordx4 v9, s[32:35], s60 offen offset:0 lds
    s_add_u32 s25, s60, 35840
    buffer_load_dwordx4 v9, s[32:35], s25 offen offset:1024 lds
    s_add_u32 s26, s60, 71680
    buffer_load_dwordx4 v10, s[32:35], s26 offen offset:2048 lds
    s_add_u32 s27, s60, 107520
    buffer_load_dwordx4 v10, s[32:35], s27 offen offset:3072 lds
    s_add_u32 s60, s60, 589824
    s_add_u32 s24, s24, 16384
    s_mov_b32 m0, s24
    s_nop 0
    buffer_load_dwordx4 v9, s[32:35], s60 offen offset:0 lds
    s_add_u32 s25, s60, 35840
    buffer_load_dwordx4 v9, s[32:35], s25 offen offset:1024 lds
    s_add_u32 s26, s60, 71680
    buffer_load_dwordx4 v10, s[32:35], s26 offen offset:2048 lds
    s_add_u32 s27, s60, 107520
    buffer_load_dwordx4 v10, s[32:35], s27 offen offset:3072 lds
    s_add_u32 s60, s60, 589824
    s_add_u32 s24, s24, 16384
f_plb0:
f_plb:
    s_cmp_lt_u32 s2, 216
    s_cbranch_scc0 f_plb1
    s_mov_b32 m0, s24
    s_nop 0
    buffer_load_dwordx4 v9, s[32:35], s60 offen offset:0 lds
    s_add_u32 s25, s60, 35840
    buffer_load_dwordx4 v9, s[32:35], s25 offen offset:1024 lds
    s_add_u32 s26, s60, 71680
    buffer_load_dwordx4 v10, s[32:35], s26 offen offset:2048 lds
    s_add_u32 s27, s60, 107520
    buffer_load_dwordx4 v10, s[32:35], s27 offen offset:3072 lds
    s_add_u32 s60, s60, 589824
    s_add_u32 s24, s24, 16384
    s_mov_b32 m0, s24
    s_nop 0
    buffer_load_dwordx4 v9, s[32:35], s60 offen offset:0 lds
    s_add_u32 s25, s60, 35840
    buffer_load_dwordx4 v9, s[32:35], s25 offen offset:1024 lds
    s_add_u32 s26, s60, 71680
    buffer_load_dwordx4 v10, s[32:35], s26 offen offset:2048 lds
    s_add_u32 s27, s60, 107520
    buffer_load_dwordx4 v10, s[32:35], s27 offen offset:3072 lds
    s_add_u32 s60, s60, 589824
    s_add_u32 s24, s24, 16384
f_plb1:
f_plb_done:
    s_cmp_lt_u32 s3, 4
    s_cbranch_scc1 f_not3
    s_lshl_b32 s50, s37, 2
    s_add_u32 s50, s50, s39
    s_add_u32 s58, s50, 43
    s_mul_i32 s58, s58, 55296
    s_add_u32 s58, s58, s57
    buffer_load_dword v8, v17, s[32:35], s58 offen
    s_add_u32 s58, s58, 7077888
    s_cmp_lt_u32 s50, 50
    s_cbranch_scc0 ftch_5
    buffer_load_dword v8, v17, s[32:35], s58 offen
ftch_5:
f_not3:
    v_cmp_eq_u32 s[44:45], 1, v6
    v_cmp_eq_u32 s[50:51], 2, v6
    v_cmp_eq_u32 s[58:59], 3, v6
    s_waitcnt lgkmcnt(0)
    s_barrier
    ds_read_b64_tr_b16 v[28:29], v116 offset:0
    ds_read_b64_tr_b16 v[30:31], v116 offset:2880
    ds_read_b64_tr_b16 v[32:33], v116 offset:128
    ds_read_b64_tr_b16 v[34:35], v116 offset:3008
    ds_read_b64_tr_b16 v[36:37], v116 offset:256
    ds_read_b64_tr_b16 v[38:39], v116 offset:3136
    ds_read_b64_tr_b16 v[40:41], v116 offset:384
    ds_read_b64_tr_b16 v[42:43], v116 offset:3264
    ds_read_b64_tr_b16 v[44:45], v117 offset:0
    ds_read_b64_tr_b16 v[46:47], v117 offset:2880
    ds_read_b64_tr_b16 v[48:49], v117 offset:128
    ds_read_b64_tr_b16 v[50:51], v117 offset:3008
    ds_read_b64_tr_b16 v[52:53], v117 offset:256
    ds_read_b64_tr_b16 v[54:55], v117 offset:3136
    ds_read_b64_tr_b16 v[56:57], v117 offset:384
    ds_read_b64_tr_b16 v[58:59], v117 offset:3264
    s_waitcnt lgkmcnt(14)
    v_mfma_f32_16x16x32_bf16 v[60:63], v[28:31], v[216:219], 0
    v_mfma_f32_16x16x32_bf16 v[64:67], v[28:31], v[232:235], 0
    s_waitcnt lgkmcnt(12)
    v_mfma_f32_16x16x32_bf16 v[60:63], v[32:35], v[220:223], v[60:63]
    v_mfma_f32_16x16x32_bf16 v[64:67], v[32:35], v[236:239], v[64:67]
    s_waitcnt lgkmcnt(10)
    v_mfma_f32_16x16x32_bf16 v[60:63], v[36:39], v[224:227], v[60:63]
    v_mfma_f32_16x16x32_bf16 v[64:67], v[36:39], v[240:243], v[64:67]
    s_waitcnt lgkmcnt(8)
    v_mfma_f32_16x16x32_bf16 v[60:63], v[40:43], v[228:231], v[60:63]
    v_mfma_f32_16x16x32_bf16 v[64:67], v[40:43], v[244:247], v[64:67]
    s_waitcnt lgkmcnt(6)
    v_mfma_f32_16x16x32_bf16 v[68:71], v[44:47], v[216:219], 0
    s_waitcnt lgkmcnt(4)
    v_mfma_f32_16x16x32_bf16 v[68:71], v[48:51], v[220:223], v[68:71]
    s_waitcnt lgkmcnt(2)
    v_mfma_f32_16x16x32_bf16 v[68:71], v[52:55], v[224:227], v[68:71]
    s_waitcnt lgkmcnt(0)
    v_mfma_f32_16x16x32_bf16 v[68:71], v[56:59], v[228:231], v[68:71]
    ds_read_u16_d16_hi v18, v127 offset:0
    ds_read_u16_d16_hi v19, v127 offset:128
    ds_read_u16_d16_hi v20, v127 offset:256
    ds_read_u16_d16_hi v21, v127 offset:384
    ds_read_u16_d16_hi v22, v127 offset:512
    ds_read_u16_d16_hi v23, v127 offset:640
    ds_read_u16_d16_hi v24, v127 offset:768
    ds_read_u16_d16_hi v25, v127 offset:896
    ds_read_u16_d16_hi v26, v127 offset:1024
    ds_read2st64_b32 v[72:73], v124 offset0:26 offset1:27
    ds_read2st64_b32 v[74:75], v124 offset0:28 offset1:29
    ds_read2st64_b32 v[76:77], v124 offset0:30 offset1:31
    ds_read2st64_b32 v[78:79], v124 offset0:32 offset1:33
    ds_read2st64_b32 v[80:81], v124 offset0:34 offset1:35
    ds_read2st64_b32 v[82:83], v124 offset0:36 offset1:37
    ds_read2st64_b32 v[84:85], v124 offset0:38 offset1:39
    ds_read2st64_b32 v[86:87], v124 offset0:40 offset1:41
    ds_read2st64_b32 v[88:89], v124 offset0:42 offset1:43
    ds_read2st64_b32 v[90:91], v124 offset0:44 offset1:45
    ds_read2st64_b32 v[92:93], v124 offset0:46 offset1:47
    ds_read2st64_b32 v[94:95], v124 offset0:48 offset1:49
    ds_read2st64_b32 v[96:97], v124 offset0:50 offset1:51
    ds_read_b32 v98, v124 offset:13312
    v_permlane32_swap_b32 v60, v62
    v_permlane32_swap_b32 v61, v63
    v_permlane32_swap_b32 v64, v66
    v_permlane32_swap_b32 v65, v67
    v_permlane16_swap_b32 v60, v61
    v_permlane16_swap_b32 v62, v63
    v_permlane16_swap_b32 v64, v65
    v_permlane16_swap_b32 v66, v67
    v_pk_mul_f32 v[28:29], v[60:61], v[248:249]
    v_pk_mul_f32 v[32:33], v[64:65], v[248:249]
    v_pk_mul_f32 v[30:31], v[62:63], v[250:251]
    v_pk_mul_f32 v[34:35], v[66:67], v[250:251]
    v_pk_fma_f32 v[28:29], v[64:65], v[252:253], v[28:29] neg_lo:[1,0,0] neg_hi:[1,0,0]
    v_pk_fma_f32 v[32:33], v[60:61], v[252:253], v[32:33]
    v_pk_fma_f32 v[30:31], v[66:67], v[254:255], v[30:31] neg_lo:[1,0,0] neg_hi:[1,0,0]
    v_pk_fma_f32 v[34:35], v[62:63], v[254:255], v[34:35]
    v_cndmask_b32 v36, v68, v69, s[44:45]
    v_cndmask_b32 v36, v36, v70, s[50:51]
    v_cndmask_b32 v36, v36, v71, s[58:59]
    v_mul_f32 v36, 0x35638e39, v36
    v_add_f32 v37, v36, v28
    v_add_f32 v38, v29, v30
    v_add_f32 v37, v37, v31
    v_add_f32 v37, v37, v38
    v_fmamk_f32 v40, v28, 0x3f441b7d, v36
    v_fmamk_f32 v41, v28, 0x3e31d0d4, v36
    v_fmamk_f32 v42, v28, 0xbf000000, v36
    v_fmamk_f32 v43, v28, 0xbf708fb2, v36
    v_fmamk_f32 v40, v29, 0x3e31d0d4, v40
    v_fmamk_f32 v41, v29, 0xbf708fb2, v41
    v_fmamk_f32 v42, v29, 0xbf000000, v42
    v_fmamk_f32 v43, v29, 0x3f441b7d, v43
    v_fmamk_f32 v40, v30, 0xbf000000, v40
    v_fmamk_f32 v41, v30, 0xbf000000, v41
    v_fmamk_f32 v42, v30, 0x3f800000, v42
    v_fmamk_f32 v43, v30, 0xbf000000, v43
    v_fmamk_f32 v40, v31, 0xbf708fb2, v40
    v_fmamk_f32 v41, v31, 0x3f441b7d, v41
    v_fmamk_f32 v42, v31, 0xbf000000, v42
    v_fmamk_f32 v43, v31, 0x3e31d0d4, v43
    v_mul_f32 v44, 0x3f248dbb, v32
    v_mul_f32 v45, 0x3f7c1c5c, v32
    v_mul_f32 v46, 0x3f5db3d7, v32
    v_mul_f32 v47, 0x3eaf1d44, v32
    v_fmamk_f32 v44, v33, 0x3f7c1c5c, v44
    v_fmamk_f32 v45, v33, 0x3eaf1d44, v45
    v_fmamk_f32 v46, v33, 0xbf5db3d7, v46
    v_fmamk_f32 v47, v33, 0xbf248dbb, v47
    v_fmamk_f32 v44, v34, 0x3f5db3d7, v44
    v_fmamk_f32 v45, v34, 0xbf5db3d7, v45
    v_fmamk_f32 v47, v34, 0x3f5db3d7, v47
    v_fmamk_f32 v44, v35, 0x3eaf1d44, v44
    v_fmamk_f32 v45, v35, 0xbf248dbb, v45
    v_fmamk_f32 v46, v35, 0x3f5db3d7, v46
    v_fmamk_f32 v47, v35, 0xbf7c1c5c, v47
    s_waitcnt lgkmcnt(9)
    v_fmac_f32 v18, v37, v72
    v_sub_f32 v50, v40, v44
    v_add_f32 v51, v40, v44
    v_fmac_f32 v19, v50, v73
    v_fmac_f32 v26, v51, v80
    v_sub_f32 v48, v41, v45
    v_add_f32 v49, v41, v45
    v_fmac_f32 v20, v48, v74
    v_fmac_f32 v25, v49, v79
    v_sub_f32 v50, v42, v46
    v_add_f32 v51, v42, v46
    v_fmac_f32 v21, v50, v75
    v_fmac_f32 v24, v51, v78
    v_sub_f32 v48, v43, v47
    v_add_f32 v49, v43, v47
    v_fmac_f32 v22, v48, v76
    v_fmac_f32 v23, v49, v77
    v_cvt_pk_bf16_f32 v60, v18, v19
    v_cvt_pk_bf16_f32 v61, v20, v21
    v_cvt_pk_bf16_f32 v62, v22, v23
    v_cvt_pk_bf16_f32 v63, v24, v25
    v_cvt_pk_bf16_f32 v64, v26, v26
    v_lshlrev_b32 v18, 16, v60
    v_and_b32 v19, s47, v60
    v_lshlrev_b32 v20, 16, v61
    v_and_b32 v21, s47, v61
    v_lshlrev_b32 v22, 16, v62
    v_and_b32 v23, s47, v62
    v_lshlrev_b32 v24, 16, v63
    v_and_b32 v25, s47, v63
    v_lshlrev_b32 v26, 16, v64
    ds_write_b16 v127, v60 offset:0
    ds_write_b16_d16_hi v127, v60 offset:128
    ds_write_b16 v127, v61 offset:256
    ds_write_b16_d16_hi v127, v61 offset:384
    ds_write_b16 v127, v62 offset:512
    ds_write_b16_d16_hi v127, v62 offset:640
    ds_write_b16 v127, v63 offset:768
    ds_write_b16_d16_hi v127, v63 offset:896
    ds_write_b16 v127, v64 offset:1024
    s_add_u32 s52, s49, 10485760
    s_add_u32 s50, s55, 83200
    v_add_u32 v2, s50, v109
    v_cmp_eq_u32 s[44:45], 0, v5
    v_add_f32 v56, v18, v19
    v_mul_f32 v57, v18, v18
    v_fmac_f32 v57, v19, v19
    v_add_f32 v56, v56, v20
    v_fmac_f32 v57, v20, v20
    v_add_f32 v56, v56, v21
    v_fmac_f32 v57, v21, v21
    v_add_f32 v56, v56, v22
    v_fmac_f32 v57, v22, v22
    v_add_f32 v56, v56, v23
    v_fmac_f32 v57, v23, v23
    v_add_f32 v56, v56, v24
    v_fmac_f32 v57, v24, v24
    v_add_f32 v56, v56, v25
    v_fmac_f32 v57, v25, v25
    v_add_f32 v56, v56, v26
    v_fmac_f32 v57, v26, v26
    s_nop 0
    v_add_f32_dpp v56, v56, v56 quad_perm:[1,0,3,2] row_mask:0xf bank_mask:0xf
    v_add_f32_dpp v57, v57, v57 quad_perm:[1,0,3,2] row_mask:0xf bank_mask:0xf
    s_nop 0
    v_add_f32_dpp v56, v56, v56 quad_perm:[2,3,0,1] row_mask:0xf bank_mask:0xf
    v_add_f32_dpp v57, v57, v57 quad_perm:[2,3,0,1] row_mask:0xf bank_mask:0xf
    s_nop 0
    v_add_f32_dpp v56, v56, v56 row_half_mirror row_mask:0xf bank_mask:0xf
    v_add_f32_dpp v57, v57, v57 row_half_mirror row_mask:0xf bank_mask:0xf
    s_nop 0
    v_add_f32_dpp v56, v56, v56 row_mirror row_mask:0xf bank_mask:0xf
    v_add_f32_dpp v57, v57, v57 row_mirror row_mask:0xf bank_mask:0xf
    s_mov_b64 exec, s[44:45]
    ds_write_b64 v120, v[56:57] offset:0
    s_mov_b64 exec, -1
    s_waitcnt lgkmcnt(0)
    s_barrier
    ds_read_b128 v[48:51], v119 offset:0
    ds_read_b128 v[52:55], v119 offset:16
    v_mov_b32 v58, 0x3727c5ac
    s_waitcnt lgkmcnt(0)
    s_cmp_lt_u32 s3, 4
    s_cbranch_scc0 f_nox1r
    ds_read_b128 v[28:31], v2 offset:0
    ds_read_b128 v[32:35], v2 offset:1024
    ds_read_b128 v[36:39], v2 offset:4736
    ds_read_b128 v[40:43], v2 offset:5760
f_nox1r:
    v_pk_add_f32 v[48:49], v[48:49], v[50:51]
    v_pk_add_f32 v[52:53], v[52:53], v[54:55]
    v_pk_add_f32 v[48:49], v[48:49], v[52:53]
    v_mul_f32 v56, 0x3ae38e39, v48
    v_fmamk_f32 v57, v49, 0x3ae38e39, v58
    v_fma_f32 v57, -v56, v56, v57
    v_rsq_f32 v57, v57
    s_nop 0
    v_mul_f32 v56, -v56, v57
    v_fma_f32 v18, v18, v57, v56
    v_fma_f32 v19, v19, v57, v56
    v_fma_f32 v20, v20, v57, v56
    v_fma_f32 v21, v21, v57, v56
    v_fma_f32 v22, v22, v57, v56
    v_fma_f32 v23, v23, v57, v56
    v_fma_f32 v24, v24, v57, v56
    v_fma_f32 v25, v25, v57, v56
    v_fma_f32 v26, v26, v57, v56
    s_cmp_lt_u32 s3, 4
    s_cbranch_scc0 f_nox1s
    s_add_u32 s50, s52, 4608
    s_waitcnt lgkmcnt(0)
    buffer_store_dwordx4 v[28:31], v109, s[28:31], s52 offen sc1
    buffer_store_dwordx4 v[36:39], v109, s[28:31], s50 offen sc1
    s_mov_b64 exec, 0xff
    buffer_store_dwordx4 v[32:35], v109, s[28:31], s52 offen offset:1024 sc1
    buffer_store_dwordx4 v[40:43], v109, s[28:31], s50 offen offset:1024 sc1
    s_mov_b64 exec, -1
f_nox1s:
    v_fma_f32 v18, v18, v90, v81
    v_fma_f32 v19, v19, v91, v82
    v_fma_f32 v20, v20, v92, v83
    v_fma_f32 v21, v21, v93, v84
    v_fma_f32 v22, v22, v94, v85
    v_fma_f32 v23, v23, v95, v86
    v_fma_f32 v24, v24, v96, v87
    v_fma_f32 v25, v25, v97, v88
    v_fma_f32 v26, v26, v98, v89
    v_add_f32 v56, v18, v19
    v_mul_f32 v57, v18, v18
    v_fmac_f32 v57, v19, v19
    v_add_f32 v56, v56, v20
    v_fmac_f32 v57, v20, v20
    v_add_f32 v56, v56, v21
    v_fmac_f32 v57, v21, v21
    v_add_f32 v56, v56, v22
    v_fmac_f32 v57, v22, v22
    v_add_f32 v56, v56, v23
    v_fmac_f32 v57, v23, v23
    v_add_f32 v56, v56, v24
    v_fmac_f32 v57, v24, v24
    v_add_f32 v56, v56, v25
    v_fmac_f32 v57, v25, v25
    v_add_f32 v56, v56, v26
    v_fmac_f32 v57, v26, v26
    s_nop 0
    v_add_f32_dpp v56, v56, v56 quad_perm:[1,0,3,2] row_mask:0xf bank_mask:0xf
    v_add_f32_dpp v57, v57, v57 quad_perm:[1,0,3,2] row_mask:0xf bank_mask:0xf
    s_nop 0
    v_add_f32_dpp v56, v56, v56 quad_perm:[2,3,0,1] row_mask:0xf bank_mask:0xf
    v_add_f32_dpp v57, v57, v57 quad_perm:[2,3,0,1] row_mask:0xf bank_mask:0xf
    s_nop 0
    v_add_f32_dpp v56, v56, v56 row_half_mirror row_mask:0xf bank_mask:0xf
    v_add_f32_dpp v57, v57, v57 row_half_mirror row_mask:0xf bank_mask:0xf
    s_nop 0
    v_add_f32_dpp v56, v56, v56 row_mirror row_mask:0xf bank_mask:0xf
    v_add_f32_dpp v57, v57, v57 row_mirror row_mask:0xf bank_mask:0xf
    s_mov_b64 exec, s[44:45]
    ds_write_b64 v120, v[56:57] offset:256
    s_mov_b64 exec, -1
    s_waitcnt lgkmcnt(0)
    s_barrier
    ds_read_b128 v[48:51], v119 offset:256
    ds_read_b128 v[52:55], v119 offset:272
    v_mov_b32 v58, 0x3727c5ac
    s_waitcnt lgkmcnt(0)
    v_pk_add_f32 v[48:49], v[48:49], v[50:51]
    v_pk_add_f32 v[52:53], v[52:53], v[54:55]
    v_pk_add_f32 v[48:49], v[48:49], v[52:53]
    v_mul_f32 v56, 0x3ae38e39, v48
    v_fmamk_f32 v57, v49, 0x3ae38e39, v58
    v_fma_f32 v57, -v56, v56, v57
    v_rsq_f32 v57, v57
    s_nop 0
    v_mul_f32 v56, -v56, v57
    v_fma_f32 v18, v18, v57, v56
    v_fma_f32 v19, v19, v57, v56
    v_fma_f32 v20, v20, v57, v56
    v_fma_f32 v21, v21, v57, v56
    v_fma_f32 v22, v22, v57, v56
    v_fma_f32 v23, v23, v57, v56
    v_fma_f32 v24, v24, v57, v56
    v_fma_f32 v25, v25, v57, v56
    v_fma_f32 v26, v26, v57, v56
    v_mov_b32 v27, 0
    v_permlane16_swap_b32 v18, v19
    v_permlane16_swap_b32 v20, v21
    v_permlane16_swap_b32 v22, v23
    v_permlane16_swap_b32 v24, v25
    v_permlane16_swap_b32 v26, v27
    v_cvt_pk_bf16_f32 v28, v18, v19
    v_cvt_pk_bf16_f32 v29, v20, v21
    v_cvt_pk_bf16_f32 v30, v22, v23
    v_cvt_pk_bf16_f32 v31, v24, v25
    v_cvt_pk_bf16_f32 v32, v26, v27
    v_mov_b32 v33, 0
    v_permlane32_swap_b32 v28, v29
    v_permlane32_swap_b32 v30, v31
    v_permlane32_swap_b32 v32, v33
    s_mul_i32 s50, s38, 1536
    ds_write_b64 v121, v[28:29]
    ds_write_b64 v121, v[30:31] offset:4096
    s_mov_b64 exec, 0xffff
    ds_write_b64 v121, v[32:33] offset:8192
    s_mov_b64 exec, -1
    s_add_u32 s50, s50, 13631488
    v_lshlrev_b32 v2, 4, v0
    v_add_u32 v3, 8192, v2
    v_add_u32 v4, 8192, v109
    s_waitcnt lgkmcnt(0)
    s_barrier
    s_cmp_lt_u32 s3, 4
    s_cbranch_scc0 f_h2none
    ds_read_b128 v[28:31], v2 offset:61696
    ds_read_b128 v[32:35], v3 offset:57600
    s_cmp_eq_u32 s3, 1
    s_cbranch_scc0 f_h2one
    ds_read_b128 v[36:39], v4 offset:61696
    s_waitcnt lgkmcnt(0)
    buffer_store_dwordx4 v[36:39], v123, s[28:31], s50 offen sc1
f_h2one:
    s_waitcnt lgkmcnt(1)
    buffer_store_dwordx4 v[28:31], v122, s[28:31], s50 offen sc1
    s_waitcnt lgkmcnt(0)
    buffer_store_dwordx4 v[32:35], v118, s[28:31], s50 offen sc1
    s_waitcnt vmcnt(0)
f_h2none:
    v_mov_b32 v3, 1
    s_lshl_b32 s50, s38, 10
    s_add_u32 s50, s50, 262400
    s_barrier
    s_cmp_eq_u32 s3, 0
    s_cbranch_scc0 t_noflag
    s_mov_b64 exec, 1
    buffer_store_dword v3, off, s[28:31], s50 sc1
    s_mov_b64 exec, -1
t_noflag:
    s_cmp_ge_u32 s2, 216
    s_cbranch_scc1 t_spare
    s_cmp_lt_u32 s3, 4
    s_cbranch_scc1 t_cons
    v_lshrrev_b32 v2, 1, v1
    v_lshlrev_b32 v2, 13, v2
    v_and_b32 v3, 1, v1
    v_lshl_add_u32 v2, v3, 10, v2
    s_lshl_b32 s50, s39, 11
    s_add_u32 s50, s50, 262400
    s_mul_i32 s5, s63, 393216
    s_add_u32 s5, s5, 14024704
    s_mul_i32 s4, s39, 3072
    s_add_u32 s4, s4, 12288
    s_mov_b32 s51, 0
g1_fp:
    buffer_load_dword v3, v2, s[28:31], s50 offen sc1
    s_add_u32 s51, s51, 1
    s_waitcnt vmcnt(0)
    v_cmp_eq_u32 vcc, 0, v3
    s_nop 0
    s_and_b64 exec, vcc, vcc
    s_cbranch_scc0 g1_fp_ok
    s_sleep 1
    s_cmp_lt_u32 s51, 30000
    s_cbranch_scc1 g1_fp
g1_fp_ok:
    s_mov_b64 exec, -1
    s_mov_b32 m0, s4
    s_nop 0
    buffer_load_dwordx4 v14, s[28:31], s61 offen offset:0 lds
    buffer_load_dwordx4 v14, s[28:31], s61 offen offset:1024 lds
    buffer_load_dwordx4 v14, s[28:31], s61 offen offset:2048 lds
    s_add_u32 s61, s61, 12288
    s_add_u32 s4, s4, 12288
    s_mov_b32 m0, s4
    s_nop 0
    buffer_load_dwordx4 v14, s[28:31], s61 offen offset:0 lds
    buffer_load_dwordx4 v14, s[28:31], s61 offen offset:1024 lds
    buffer_load_dwordx4 v14, s[28:31], s61 offen offset:2048 lds
    s_add_u32 s61, s61, 12288
    s_add_u32 s4, s4, 12288
    s_mov_b32 m0, s4
    s_nop 0
    buffer_load_dwordx4 v14, s[28:31], s61 offen offset:0 lds
    buffer_load_dwordx4 v14, s[28:31], s61 offen offset:1024 lds
    buffer_load_dwordx4 v14, s[28:31], s61 offen offset:2048 lds
    s_add_u32 s61, s61, 12288
    s_add_u32 s4, s4, 12288
    s_mov_b32 m0, s4
    s_nop 0
    buffer_load_dwordx4 v14, s[28:31], s61 offen offset:0 lds
    buffer_load_dwordx4 v14, s[28:31], s61 offen offset:1024 lds
    buffer_load_dwordx4 v14, s[28:31], s61 offen offset:2048 lds
    s_add_u32 s61, s61, 12288
    s_add_u32 s4, s4, 12288
    s_sub_u32 s24, s24, 81920
    s_sub_u32 s4, s4, 61440
    s_waitcnt vmcnt(9)
    s_barrier
    s_mov_b32 m0, s24
    s_nop 0
    buffer_load_dwordx4 v9, s[32:35], s60 offen offset:0 lds
    s_add_u32 s25, s60, 35840
    buffer_load_dwordx4 v9, s[32:35], s25 offen offset:1024 lds
    s_add_u32 s26, s60, 71680
    buffer_load_dwordx4 v10, s[32:35], s26 offen offset:2048 lds
    s_add_u32 s27, s60, 107520
    buffer_load_dwordx4 v10, s[32:35], s27 offen offset:3072 lds
    s_add_u32 s60, s60, 589824
    s_mov_b32 m0, s4
    s_nop 0
    buffer_load_dwordx4 v14, s[28:31], s61 offen offset:0 lds
    buffer_load_dwordx4 v14, s[28:31], s61 offen offset:1024 lds
    buffer_load_dwordx4 v14, s[28:31], s61 offen offset:2048 lds
    s_add_u32 s61, s61, 12288
    s_add_u32 s4, s4, 12288
    s_add_u32 s24, s24, 16384
    s_cmp_ge_u32 s24, 163840
    s_cselect_b32 s25, 81920, 0
    s_cselect_b32 s26, 61440, 0
    s_sub_u32 s24, s24, s25
    s_sub_u32 s4, s4, s26
    s_waitcnt vmcnt(13)
    s_barrier
    s_mov_b32 m0, s24
    s_nop 0
    buffer_load_dwordx4 v9, s[32:35], s60 offen offset:0 lds
    s_add_u32 s25, s60, 35840
    buffer_load_dwordx4 v9, s[32:35], s25 offen offset:1024 lds
    s_add_u32 s26, s60, 71680
    buffer_load_dwordx4 v10, s[32:35], s26 offen offset:2048 lds
    s_add_u32 s27, s60, 107520
    buffer_load_dwordx4 v10, s[32:35], s27 offen offset:3072 lds
    s_add_u32 s60, s60, 589824
    s_mov_b32 m0, s4
    s_nop 0
    buffer_load_dwordx4 v14, s[28:31], s61 offen offset:0 lds
    buffer_load_dwordx4 v14, s[28:31], s61 offen offset:1024 lds
    buffer_load_dwordx4 v14, s[28:31], s61 offen offset:2048 lds
    s_add_u32 s61, s61, 12288
    s_add_u32 s4, s4, 12288
    s_add_u32 s24, s24, 16384
    s_cmp_ge_u32 s24, 163840
    s_cselect_b32 s25, 81920, 0
    s_cselect_b32 s26, 61440, 0
    s_sub_u32 s24, s24, s25
    s_sub_u32 s4, s4, s26
    s_waitcnt vmcnt(17)
    s_barrier
    s_mov_b32 m0, s24
    s_nop 0
    buffer_load_dwordx4 v9, s[32:35], s60 offen offset:0 lds
    s_add_u32 s25, s60, 35840
    buffer_load_dwordx4 v9, s[32:35], s25 offen offset:1024 lds
    s_add_u32 s26, s60, 71680
    buffer_load_dwordx4 v10, s[32:35], s26 offen offset:2048 lds
    s_add_u32 s27, s60, 107520
    buffer_load_dwordx4 v10, s[32:35], s27 offen offset:3072 lds
    s_add_u32 s60, s60, 589824
    s_mov_b32 m0, s4
    s_nop 0
    buffer_load_dwordx4 v14, s[28:31], s61 offen offset:0 lds
    buffer_load_dwordx4 v14, s[28:31], s61 offen offset:1024 lds
    buffer_load_dwordx4 v14, s[28:31], s61 offen offset:2048 lds
    s_add_u32 s61, s61, 12288
    s_add_u32 s4, s4, 12288
    s_add_u32 s24, s24, 16384
    s_cmp_ge_u32 s24, 163840
    s_cselect_b32 s25, 81920, 0
    s_cselect_b32 s26, 61440, 0
    s_sub_u32 s24, s24, s25
    s_sub_u32 s4, s4, s26
    s_movk_i32 s59, 25
g1_ld_loop:
    s_waitcnt vmcnt(21)
    s_barrier
    s_mov_b32 m0, s24
    s_nop 0
    buffer_load_dwordx4 v9, s[32:35], s60 offen offset:0 lds
    s_add_u32 s25, s60, 35840
    buffer_load_dwordx4 v9, s[32:35], s25 offen offset:1024 lds
    s_add_u32 s26, s60, 71680
    buffer_load_dwordx4 v10, s[32:35], s26 offen offset:2048 lds
    s_add_u32 s27, s60, 107520
    buffer_load_dwordx4 v10, s[32:35], s27 offen offset:3072 lds
    s_add_u32 s60, s60, 589824
    s_mov_b32 m0, s4
    s_nop 0
    buffer_load_dwordx4 v14, s[28:31], s61 offen offset:0 lds
    buffer_load_dwordx4 v14, s[28:31], s61 offen offset:1024 lds
    buffer_load_dwordx4 v14, s[28:31], s61 offen offset:2048 lds
    s_add_u32 s61, s61, 12288
    s_add_u32 s4, s4, 12288
    s_add_u32 s24, s24, 16384
    s_cmp_ge_u32 s24, 163840
    s_cselect_b32 s25, 81920, 0
    s_cselect_b32 s26, 61440, 0
    s_sub_u32 s24, s24, s25
    s_sub_u32 s4, s4, s26
    s_sub_u32 s59, s59, 1
    s_cmp_lg_u32 s59, 0
    s_cbranch_scc1 g1_ld_loop
    s_waitcnt vmcnt(21)
    s_barrier
    s_waitcnt vmcnt(14)
    s_barrier
    s_waitcnt vmcnt(7)
    s_barrier
    s_waitcnt vmcnt(0)
    s_barrier
t_ld2:
    s_lshr_b32 s44, s36, 1
    s_and_b32 s45, s36, 1
    s_lshl_b32 s45, s45, 3
    s_lshr_b32 s46, s37, 2
    s_add_u32 s45, s45, s46
    s_and_b32 s46, s37, 3
    v_lshrrev_b32 v2, 4, v1
    v_and_b32 v3, 15, v1
    v_lshlrev_b32 v9, 1, v2
    v_xor_b32 v9, v9, v3
    v_xor_b32 v10, 8, v9
    v_mul_u32_u24 v2, 4096, v2
    v_lshl_add_u32 v9, v9, 4, v2
    v_lshl_add_u32 v10, v10, 4, v2
    s_mul_i32 s60, s44, 4718592
    s_lshl_b32 s50, s45, 8
    s_add_u32 s60, s60, s50
    s_mul_i32 s50, s39, 65536
    s_add_u32 s60, s60, s50
    s_mul_i32 s61, s46, 144
    s_mul_i32 s50, s44, 36
    s_add_u32 s61, s61, s50
    s_mul_i32 s61, s61, 9216
    s_add_u32 s61, s61, 16777216
    s_add_u32 s5, s61, 331776
    s_add_u32 s6, s44, 1
    s_mul_i32 s6, s6, 4718592
    s_mul_i32 s4, s39, 4608
    s_add_u32 s61, s61, s4
    s_add_u32 s4, s4, 16384
    s_lshl_b32 s24, s39, 12
    v_min_u32 v2, 35, v1
    v_and_b32 v3, 1, v2
    s_mul_i32 s50, s46, 3
    s_and_b32 s51, s39, 1
    s_add_u32 s50, s50, s51
    v_add_u32 v3, s50, v3
    v_lshrrev_b32 v4, 2, v2
    v_mul_u32_u24 v4, 6, v4
    v_lshrrev_b32 v7, 1, v3
    v_add_u32 v4, v4, v7
    v_and_b32 v3, 1, v3
    v_lshlrev_b32 v3, 1, v3
    v_bfe_u32 v2, v2, 1, 1
    v_add_u32 v3, v3, v2
    v_lshlrev_b32 v3, 7, v3
    v_lshl_add_u32 v2, v4, 10, v3
    s_mul_i32 s50, s44, 55296
    s_add_u32 s50, s50, 262528
    s_cmp_lt_u32 s2, 216
    s_cbranch_scc0 g2_ld_nobar
    s_barrier
g2_ld_nobar:
    s_mov_b32 m0, s24
    s_nop 0
    buffer_load_dwordx4 v9, s[8:11], s60 offen offset:0 lds
    s_add_u32 s25, s60, 15360
    buffer_load_dwordx4 v10, s[8:11], s25 offen offset:1024 lds
    s_add_u32 s26, s60, 30720
    buffer_load_dwordx4 v9, s[8:11], s26 offen offset:2048 lds
    s_add_u32 s27, s60, 46080
    buffer_load_dwordx4 v10, s[8:11], s27 offen offset:3072 lds
    s_add_u32 s60, s60, 262144
    s_add_u32 s24, s24, 34816
    s_mov_b32 m0, s24
    s_nop 0
    buffer_load_dwordx4 v9, s[8:11], s60 offen offset:0 lds
    s_add_u32 s25, s60, 15360
    buffer_load_dwordx4 v10, s[8:11], s25 offen offset:1024 lds
    s_add_u32 s26, s60, 30720
    buffer_load_dwordx4 v9, s[8:11], s26 offen offset:2048 lds
    s_add_u32 s27, s60, 46080
    buffer_load_dwordx4 v10, s[8:11], s27 offen offset:3072 lds
    s_add_u32 s60, s60, 262144
    s_add_u32 s24, s24, 34816
    s_mov_b32 m0, s24
    s_nop 0
    buffer_load_dwordx4 v9, s[8:11], s60 offen offset:0 lds
    s_add_u32 s25, s60, 15360
    buffer_load_dwordx4 v10, s[8:11], s25 offen offset:1024 lds
    s_add_u32 s26, s60, 30720
    buffer_load_dwordx4 v9, s[8:11], s26 offen offset:2048 lds
    s_add_u32 s27, s60, 46080
    buffer_load_dwordx4 v10, s[8:11], s27 offen offset:3072 lds
    s_add_u32 s60, s60, 262144
    s_add_u32 s24, s24, 34816
    s_mov_b32 s51, 0
g2_fp:
    buffer_load_dword v3, v2, s[28:31], s50 offen sc1
    s_add_u32 s51, s51, 1
    s_waitcnt vmcnt(0)
    v_cmp_eq_u32 vcc, 0, v3
    s_nop 0
    s_and_b64 exec, vcc, vcc
    s_cbranch_scc0 g2_fp_ok
    s_sleep 2
    s_cmp_lt_u32 s51, 30000
    s_cbranch_scc1 g2_fp
g2_fp_ok:
    s_mov_b64 exec, -1
    s_mov_b32 m0, s4
    s_mov_b64 exec, 0xffffffff
    buffer_load_dwordx4 v14, s[28:31], s61 offen lds
    s_mov_b64 exec, -1
    buffer_load_dwordx4 v14, s[28:31], s61 offen offset:512 lds
    buffer_load_dwordx4 v14, s[28:31], s61 offen offset:1536 lds
    buffer_load_dwordx4 v14, s[28:31], s61 offen offset:2560 lds
    buffer_load_dwordx4 v14, s[28:31], s61 offen offset:3584 lds
    s_add_u32 s61, s61, 18432
    s_add_u32 s4, s4, 34816
    s_mov_b32 m0, s4
    s_mov_b64 exec, 0xffffffff
    buffer_load_dwordx4 v14, s[28:31], s61 offen lds
    s_mov_b64 exec, -1
    buffer_load_dwordx4 v14, s[28:31], s61 offen offset:512 lds
    buffer_load_dwordx4 v14, s[28:31], s61 offen offset:1536 lds
    buffer_load_dwordx4 v14, s[28:31], s61 offen offset:2560 lds
    buffer_load_dwordx4 v14, s[28:31], s61 offen offset:3584 lds
    s_add_u32 s61, s61, 18432
    s_add_u32 s4, s4, 34816
    s_mov_b32 m0, s4
    s_mov_b64 exec, 0xffffffff
    buffer_load_dwordx4 v14, s[28:31], s61 offen lds
    s_mov_b64 exec, -1
    buffer_load_dwordx4 v14, s[28:31], s61 offen offset:512 lds
    buffer_load_dwordx4 v14, s[28:31], s61 offen offset:1536 lds
    buffer_load_dwordx4 v14, s[28:31], s61 offen offset:2560 lds
    buffer_load_dwordx4 v14, s[28:31], s61 offen offset:3584 lds
    s_add_u32 s61, s61, 18432
    s_add_u32 s4, s4, 34816
    s_waitcnt vmcnt(10)
    s_barrier
    s_mov_b32 m0, s24
    s_nop 0
    buffer_load_dwordx4 v9, s[8:11], s60 offen offset:0 lds
    s_add_u32 s25, s60, 15360
    buffer_load_dwordx4 v10, s[8:11], s25 offen offset:1024 lds
    s_add_u32 s26, s60, 30720
    buffer_load_dwordx4 v9, s[8:11], s26 offen offset:2048 lds
    s_add_u32 s27, s60, 46080
    buffer_load_dwordx4 v10, s[8:11], s27 offen offset:3072 lds
    s_add_u32 s60, s60, 262144
    s_mov_b32 m0, s4
    s_mov_b64 exec, 0xffffffff
    buffer_load_dwordx4 v14, s[28:31], s61 offen lds
    s_mov_b64 exec, -1
    buffer_load_dwordx4 v14, s[28:31], s61 offen offset:512 lds
    buffer_load_dwordx4 v14, s[28:31], s61 offen offset:1536 lds
    buffer_load_dwordx4 v14, s[28:31], s61 offen offset:2560 lds
    buffer_load_dwordx4 v14, s[28:31], s61 offen offset:3584 lds
    s_add_u32 s61, s61, 18432
    s_add_u32 s4, s4, 34816
    s_add_u32 s24, s24, 34816
    s_cmp_ge_u32 s24, 139264
    s_cselect_b32 s25, 139264, 0
    s_sub_u32 s24, s24, s25
    s_sub_u32 s4, s4, s25
    s_waitcnt vmcnt(14)
    s_barrier
    s_mov_b32 m0, s24
    s_nop 0
    buffer_load_dwordx4 v9, s[8:11], s60 offen offset:0 lds
    s_add_u32 s25, s60, 15360
    buffer_load_dwordx4 v10, s[8:11], s25 offen offset:1024 lds
    s_add_u32 s26, s60, 30720
    buffer_load_dwordx4 v9, s[8:11], s26 offen offset:2048 lds
    s_add_u32 s27, s60, 46080
    buffer_load_dwordx4 v10, s[8:11], s27 offen offset:3072 lds
    s_add_u32 s60, s60, 262144
    s_mov_b32 m0, s4
    s_mov_b64 exec, 0xffffffff
    buffer_load_dwordx4 v14, s[28:31], s61 offen lds
    s_mov_b64 exec, -1
    buffer_load_dwordx4 v14, s[28:31], s61 offen offset:512 lds
    buffer_load_dwordx4 v14, s[28:31], s61 offen offset:1536 lds
    buffer_load_dwordx4 v14, s[28:31], s61 offen offset:2560 lds
    buffer_load_dwordx4 v14, s[28:31], s61 offen offset:3584 lds
    s_add_u32 s61, s61, 18432
    s_add_u32 s4, s4, 34816
    s_add_u32 s24, s24, 34816
    s_cmp_ge_u32 s24, 139264
    s_cselect_b32 s25, 139264, 0
    s_sub_u32 s24, s24, s25
    s_sub_u32 s4, s4, s25
    s_movk_i32 s59, 13
g2_ld_loop:
    s_waitcnt vmcnt(18)
    s_barrier
    s_mov_b32 m0, s24
    s_nop 0
    buffer_load_dwordx4 v9, s[8:11], s60 offen offset:0 lds
    s_add_u32 s25, s60, 15360
    buffer_load_dwordx4 v10, s[8:11], s25 offen offset:1024 lds
    s_add_u32 s26, s60, 30720
    buffer_load_dwordx4 v9, s[8:11], s26 offen offset:2048 lds
    s_add_u32 s27, s60, 46080
    buffer_load_dwordx4 v10, s[8:11], s27 offen offset:3072 lds
    s_add_u32 s60, s60, 262144
    s_mov_b32 m0, s4
    s_mov_b64 exec, 0xffffffff
    buffer_load_dwordx4 v14, s[28:31], s61 offen lds
    s_mov_b64 exec, -1
    buffer_load_dwordx4 v14, s[28:31], s61 offen offset:512 lds
    buffer_load_dwordx4 v14, s[28:31], s61 offen offset:1536 lds
    buffer_load_dwordx4 v14, s[28:31], s61 offen offset:2560 lds
    buffer_load_dwordx4 v14, s[28:31], s61 offen offset:3584 lds
    s_add_u32 s61, s61, 18432
    s_add_u32 s4, s4, 34816
    s_add_u32 s24, s24, 34816
    s_cmp_ge_u32 s24, 139264
    s_cselect_b32 s25, 139264, 0
    s_sub_u32 s24, s24, s25
    s_sub_u32 s4, s4, s25
    s_sub_u32 s59, s59, 1
    s_cmp_lg_u32 s59, 0
    s_cbranch_scc1 g2_ld_loop
    s_waitcnt vmcnt(18)
    s_barrier
    s_waitcnt vmcnt(9)
    s_barrier
    s_waitcnt vmcnt(0)
    s_barrier
    s_branch t_end
t_spare:
    s_sub_u32 s50, s37, 27
    s_lshl_b32 s50, s50, 3
    s_add_u32 s50, s50, s3
    s_add_u32 s58, s50, 221
    s_mul_i32 s58, s58, 55296
    s_add_u32 s58, s58, s57
    s_cmp_lt_u32 s50, 120
    s_cbranch_scc0 t4_6
    buffer_load_dword v8, v17, s[32:35], s58 offen
t4_6:
    s_add_u32 s58, s58, 2211840
    s_cmp_lt_u32 s50, 80
    s_cbranch_scc0 t4_7
    buffer_load_dword v8, v17, s[32:35], s58 offen
t4_7:
    s_add_u32 s58, s58, 2211840
    s_cmp_lt_u32 s50, 40
    s_cbranch_scc0 t4_8
    s_waitcnt vmcnt(1)
    buffer_load_dword v8, v17, s[32:35], s58 offen
t4_8:
    s_add_u32 s58, s58, 2211840
    s_and_b32 s51, s36, 1
    s_lshl_b32 s51, s51, 11
    s_lshr_b32 s52, s36, 1
    s_mul_i32 s52, s52, 4718592
    s_add_u32 s51, s51, s52
    s_add_u32 s52, 0, s50
    s_lshl_b32 s52, s52, 14
    s_add_u32 s52, s52, s51
    v_lshrrev_b32 v2, 4, v1
    v_lshlrev_b32 v2, 12, v2
    v_and_b32 v3, 15, v1
    v_lshl_add_u32 v2, v3, 7, v2
    buffer_load_dword v4, v2, s[8:11], s52 offen
    s_add_u32 s52, s52, 655360
    s_waitcnt vmcnt(0)
    buffer_load_dword v4, v2, s[8:11], s52 offen
    s_add_u32 s52, s52, 655360
    s_waitcnt vmcnt(0)
    buffer_load_dword v4, v2, s[8:11], s52 offen
    s_add_u32 s52, s52, 655360
    s_waitcnt vmcnt(0)
    buffer_load_dword v4, v2, s[8:11], s52 offen
    s_add_u32 s52, s52, 655360
    s_waitcnt vmcnt(0)
    buffer_load_dword v4, v2, s[8:11], s52 offen
    s_add_u32 s52, s52, 655360
    s_waitcnt vmcnt(0)
    buffer_load_dword v4, v2, s[8:11], s52 offen
    s_add_u32 s52, s52, 655360
    s_waitcnt vmcnt(0)
    buffer_load_dword v4, v2, s[8:11], s52 offen
    s_add_u32 s52, s52, 655360
    s_cmp_lt_u32 s50, 8
    s_cbranch_scc0 pfskip_9
    s_waitcnt vmcnt(0)
    buffer_load_dword v4, v2, s[8:11], s52 offen
pfskip_9:
    s_waitcnt vmcnt(0)
    s_cmp_lt_u32 s3, 4
    s_cbranch_scc1 t_cons2
    s_branch t_ld2
t_cons:
    s_and_b32 s46, s3, 1
    s_lshr_b32 s47, s3, 1
    s_lshl_b32 s48, s46, 7
    s_lshl_b32 s49, s62, 8
    s_add_u32 s48, s48, s49
    v_lshlrev_b32 v7, 3, v6
    buffer_load_dwordx2 v[24:25], v7, s[20:23], s48 offen offset:0
    buffer_load_dwordx2 v[26:27], v7, s[20:23], s48 offen offset:32
    buffer_load_dwordx2 v[28:29], v7, s[20:23], s48 offen offset:64
    buffer_load_dwordx2 v[30:31], v7, s[20:23], s48 offen offset:96
    s_lshl_b32 s40, s46, 2
    s_add_u32 s40, s40, 0
    s_lshl_b32 s41, s46, 2
    s_add_u32 s41, s41, 1
    s_lshl_b32 s42, s46, 2
    s_add_u32 s42, s42, 2
    s_lshl_b32 s43, s46, 2
    s_add_u32 s43, s43, 3
    v_lshrrev_b32 v2, 2, v5
    v_and_b32 v3, 1, v6
    v_lshl_add_u32 v3, v3, 2, v2
    v_mad_u32_u24 v2, v6, 8, v2
    v_lshlrev_b32 v2, 8, v2
    v_and_b32 v4, 3, v1
    v_lshl_add_u32 v2, v4, 3, v2
    v_xor_b32 v4, s40, v3
    v_lshl_add_u32 v8, v4, 5, v2
    v_xor_b32 v4, s41, v3
    v_lshl_add_u32 v9, v4, 5, v2
    v_xor_b32 v4, s42, v3
    v_lshl_add_u32 v10, v4, 5, v2
    v_xor_b32 v4, s43, v3
    v_lshl_add_u32 v11, v4, 5, v2
    v_mul_u32_u24 v2, 1536, v6
    v_lshl_add_u32 v2, v5, 4, v2
    s_mul_i32 s48, s47, 768
    v_add_u32 v12, s48, v2
    s_mul_i32 s48, s63, 6
    s_mul_i32 s49, s47, 3
    s_add_u32 s48, s48, s49
    s_lshl_b32 s49, s62, 2
    s_lshl_b32 s50, s46, 1
    s_add_u32 s49, s49, s50
    s_mul_i32 s49, s49, 9
    s_add_u32 s50, s48, 0
    s_mul_i32 s51, s50, 57
    s_lshr_b32 s51, s51, 9
    s_mul_i32 s51, s51, 1287
    s_add_u32 s50, s50, s51
    s_add_u32 s50, s50, s49
    s_lshl_b32 s50, s50, 10
    s_add_u32 s52, s50, 16777216
    s_add_u32 s55, s50, 16786432
    s_add_u32 s50, s48, 1
    s_mul_i32 s51, s50, 57
    s_lshr_b32 s51, s51, 9
    s_mul_i32 s51, s51, 1287
    s_add_u32 s50, s50, s51
    s_add_u32 s50, s50, s49
    s_lshl_b32 s50, s50, 10
    s_add_u32 s53, s50, 16777216
    s_add_u32 s56, s50, 16786432
    s_add_u32 s50, s48, 2
    s_mul_i32 s51, s50, 57
    s_lshr_b32 s51, s51, 9
    s_mul_i32 s51, s51, 1287
    s_add_u32 s50, s50, s51
    s_add_u32 s50, s50, s49
    s_lshl_b32 s50, s50, 10
    s_add_u32 s54, s50, 16777216
    s_add_u32 s57, s50, 16786432
    s_mul_i32 s58, s62, 6
    s_add_u32 s58, s58, s63
    s_lshl_b32 s58, s58, 3
    s_add_u32 s58, s58, s3
    s_lshl_b32 s58, s58, 7
    s_add_u32 s58, s58, 262528
    v_mov_b32 v88, 0
    v_mov_b32 v89, 0
    v_mov_b32 v90, 0
    v_mov_b32 v91, 0
    v_mov_b32 v92, 0
    v_mov_b32 v93, 0
    v_mov_b32 v94, 0
    v_mov_b32 v95, 0
    v_mov_b32 v96, 0
    v_mov_b32 v97, 0
    v_mov_b32 v98, 0
    v_mov_b32 v99, 0
    v_mov_b32 v100, 0
    v_mov_b32 v101, 0
    v_mov_b32 v102, 0
    v_mov_b32 v103, 0
    v_mov_b32 v104, 0
    v_mov_b32 v105, 0
    v_mov_b32 v106, 0
    v_mov_b32 v107, 0
    v_mov_b32 v108, 0
    v_mov_b32 v109, 0
    v_mov_b32 v110, 0
    v_mov_b32 v111, 0
    v_mov_b32 v112, 0
    v_mov_b32 v113, 0
    v_mov_b32 v114, 0
    v_mov_b32 v115, 0
    v_mov_b32 v116, 0
    v_mov_b32 v117, 0
    v_mov_b32 v118, 0
    v_mov_b32 v119, 0
    v_mov_b32 v120, 0
    v_mov_b32 v121, 0
    v_mov_b32 v122, 0
    v_mov_b32 v123, 0
    v_mov_b32 v124, 0
    v_mov_b32 v125, 0
    v_mov_b32 v126, 0
    v_mov_b32 v127, 0
    v_mov_b32 v128, 0
    v_mov_b32 v129, 0
    v_mov_b32 v130, 0
    v_mov_b32 v131, 0
    v_mov_b32 v132, 0
    v_mov_b32 v133, 0
    v_mov_b32 v134, 0
    v_mov_b32 v135, 0
    s_mov_b32 s24, 98304
    s_mov_b32 s4, 12288
    v_add_u32 v16, s24, v8
    v_add_u32 v17, s24, v9
    v_add_u32 v18, s24, v10
    v_add_u32 v19, s24, v11
    v_add_u32 v20, s4, v12
    s_movk_i32 s59, 31
    s_barrier
    ds_read_b128 v[48:51], v20 offset:0
    ds_read_b64_tr_b16 v[32:33], v16 offset:0
    ds_read_b64_tr_b16 v[34:35], v16 offset:1024
    ds_read_b64_tr_b16 v[36:37], v17 offset:0
    ds_read_b64_tr_b16 v[38:39], v17 offset:1024
    ds_read_b64_tr_b16 v[40:41], v18 offset:0
    ds_read_b64_tr_b16 v[42:43], v18 offset:1024
    ds_read_b64_tr_b16 v[44:45], v19 offset:0
    ds_read_b64_tr_b16 v[46:47], v19 offset:1024
    ds_read_b128 v[52:55], v20 offset:256
    ds_read_b128 v[56:59], v20 offset:512
g1_mm_loop:
    s_waitcnt lgkmcnt(0)
    v_mfma_f32_16x16x32_bf16 v[88:91], v[32:35], v[48:51], v[88:91]
    ds_read_b128 v[76:79], v20 offset:6144
    ds_read_b64_tr_b16 v[60:61], v16 offset:8192
    v_mfma_f32_16x16x32_bf16 v[100:103], v[36:39], v[48:51], v[100:103]
    ds_read_b64_tr_b16 v[62:63], v16 offset:9216
    ds_read_b64_tr_b16 v[64:65], v17 offset:8192
    v_mfma_f32_16x16x32_bf16 v[112:115], v[40:43], v[48:51], v[112:115]
    ds_read_b64_tr_b16 v[66:67], v17 offset:9216
    ds_read_b64_tr_b16 v[68:69], v18 offset:8192
    v_mfma_f32_16x16x32_bf16 v[124:127], v[44:47], v[48:51], v[124:127]
    ds_read_b64_tr_b16 v[70:71], v18 offset:9216
    ds_read_b64_tr_b16 v[72:73], v19 offset:8192
    v_mfma_f32_16x16x32_bf16 v[92:95], v[32:35], v[52:55], v[92:95]
    ds_read_b64_tr_b16 v[74:75], v19 offset:9216
    ds_read_b128 v[80:83], v20 offset:6400
    v_mfma_f32_16x16x32_bf16 v[104:107], v[36:39], v[52:55], v[104:107]
    ds_read_b128 v[84:87], v20 offset:6656
    s_add_u32 s24, s24, 16384
    v_mfma_f32_16x16x32_bf16 v[116:119], v[40:43], v[52:55], v[116:119]
    s_add_u32 s4, s4, 12288
    s_cmp_eq_u32 s24, 163840
    v_mfma_f32_16x16x32_bf16 v[128:131], v[44:47], v[52:55], v[128:131]
    s_cselect_b32 s24, 81920, s24
    s_cselect_b32 s4, 0, s4
    v_mfma_f32_16x16x32_bf16 v[96:99], v[32:35], v[56:59], v[96:99]
    v_add_u32 v16, s24, v8
    v_add_u32 v17, s24, v9
    v_mfma_f32_16x16x32_bf16 v[108:111], v[36:39], v[56:59], v[108:111]
    v_add_u32 v18, s24, v10
    v_add_u32 v19, s24, v11
    v_mfma_f32_16x16x32_bf16 v[120:123], v[40:43], v[56:59], v[120:123]
    v_add_u32 v20, s4, v12
    s_waitcnt lgkmcnt(0)
    v_mfma_f32_16x16x32_bf16 v[132:135], v[44:47], v[56:59], v[132:135]
    s_barrier
    v_mfma_f32_16x16x32_bf16 v[88:91], v[60:63], v[76:79], v[88:91]
    ds_read_b128 v[48:51], v20 offset:0
    ds_read_b64_tr_b16 v[32:33], v16 offset:0
    v_mfma_f32_16x16x32_bf16 v[100:103], v[64:67], v[76:79], v[100:103]
    ds_read_b64_tr_b16 v[34:35], v16 offset:1024
    ds_read_b64_tr_b16 v[36:37], v17 offset:0
    v_mfma_f32_16x16x32_bf16 v[112:115], v[68:71], v[76:79], v[112:115]
    ds_read_b64_tr_b16 v[38:39], v17 offset:1024
    ds_read_b64_tr_b16 v[40:41], v18 offset:0
    v_mfma_f32_16x16x32_bf16 v[124:127], v[72:75], v[76:79], v[124:127]
    ds_read_b64_tr_b16 v[42:43], v18 offset:1024
    ds_read_b64_tr_b16 v[44:45], v19 offset:0
    v_mfma_f32_16x16x32_bf16 v[92:95], v[60:63], v[80:83], v[92:95]
    ds_read_b64_tr_b16 v[46:47], v19 offset:1024
    ds_read_b128 v[52:55], v20 offset:256
    v_mfma_f32_16x16x32_bf16 v[104:107], v[64:67], v[80:83], v[104:107]
    ds_read_b128 v[56:59], v20 offset:512
    s_sub_u32 s59, s59, 1
    v_mfma_f32_16x16x32_bf16 v[116:119], v[68:71], v[80:83], v[116:119]
    s_cmp_lg_u32 s59, 0
    v_mfma_f32_16x16x32_bf16 v[128:131], v[72:75], v[80:83], v[128:131]
    v_mfma_f32_16x16x32_bf16 v[96:99], v[60:63], v[84:87], v[96:99]
    v_mfma_f32_16x16x32_bf16 v[108:111], v[64:67], v[84:87], v[108:111]
    v_mfma_f32_16x16x32_bf16 v[120:123], v[68:71], v[84:87], v[120:123]
    v_mfma_f32_16x16x32_bf16 v[132:135], v[72:75], v[84:87], v[132:135]
    s_cbranch_scc1 g1_mm_loop
    s_waitcnt lgkmcnt(0)
    v_mfma_f32_16x16x32_bf16 v[88:91], v[32:35], v[48:51], v[88:91]
    ds_read_b128 v[76:79], v20 offset:6144
    ds_read_b64_tr_b16 v[60:61], v16 offset:8192
    v_mfma_f32_16x16x32_bf16 v[100:103], v[36:39], v[48:51], v[100:103]
    ds_read_b64_tr_b16 v[62:63], v16 offset:9216
    ds_read_b64_tr_b16 v[64:65], v17 offset:8192
    v_mfma_f32_16x16x32_bf16 v[112:115], v[40:43], v[48:51], v[112:115]
    ds_read_b64_tr_b16 v[66:67], v17 offset:9216
    ds_read_b64_tr_b16 v[68:69], v18 offset:8192
    v_mfma_f32_16x16x32_bf16 v[124:127], v[44:47], v[48:51], v[124:127]
    ds_read_b64_tr_b16 v[70:71], v18 offset:9216
    ds_read_b64_tr_b16 v[72:73], v19 offset:8192
    v_mfma_f32_16x16x32_bf16 v[92:95], v[32:35], v[52:55], v[92:95]
    ds_read_b64_tr_b16 v[74:75], v19 offset:9216
    ds_read_b128 v[80:83], v20 offset:6400
    v_mfma_f32_16x16x32_bf16 v[104:107], v[36:39], v[52:55], v[104:107]
    ds_read_b128 v[84:87], v20 offset:6656
    v_mfma_f32_16x16x32_bf16 v[116:119], v[40:43], v[52:55], v[116:119]
    v_mfma_f32_16x16x32_bf16 v[128:131], v[44:47], v[52:55], v[128:131]
    v_mfma_f32_16x16x32_bf16 v[96:99], v[32:35], v[56:59], v[96:99]
    v_mfma_f32_16x16x32_bf16 v[108:111], v[36:39], v[56:59], v[108:111]
    v_mfma_f32_16x16x32_bf16 v[120:123], v[40:43], v[56:59], v[120:123]
    v_mfma_f32_16x16x32_bf16 v[132:135], v[44:47], v[56:59], v[132:135]
    s_waitcnt lgkmcnt(0)
    s_barrier
    v_mfma_f32_16x16x32_bf16 v[88:91], v[60:63], v[76:79], v[88:91]
    v_mfma_f32_16x16x32_bf16 v[100:103], v[64:67], v[76:79], v[100:103]
    v_mfma_f32_16x16x32_bf16 v[112:115], v[68:71], v[76:79], v[112:115]
    v_mfma_f32_16x16x32_bf16 v[124:127], v[72:75], v[76:79], v[124:127]
    v_mfma_f32_16x16x32_bf16 v[92:95], v[60:63], v[80:83], v[92:95]
    v_mfma_f32_16x16x32_bf16 v[104:107], v[64:67], v[80:83], v[104:107]
    v_mfma_f32_16x16x32_bf16 v[116:119], v[68:71], v[80:83], v[116:119]
    v_mfma_f32_16x16x32_bf16 v[128:131], v[72:75], v[80:83], v[128:131]
    v_mfma_f32_16x16x32_bf16 v[96:99], v[60:63], v[84:87], v[96:99]
    v_mfma_f32_16x16x32_bf16 v[108:111], v[64:67], v[84:87], v[108:111]
    v_mfma_f32_16x16x32_bf16 v[120:123], v[68:71], v[84:87], v[120:123]
    v_mfma_f32_16x16x32_bf16 v[132:135], v[72:75], v[84:87], v[132:135]
    s_mov_b32 s42, 0xffff0000
    s_waitcnt vmcnt(0)
    v_lshlrev_b32 v32, 16, v24
    v_and_b32 v33, s42, v24
    v_lshlrev_b32 v34, 16, v25
    v_and_b32 v35, s42, v25
    v_lshlrev_b32 v36, 16, v26
    v_and_b32 v37, s42, v26
    v_lshlrev_b32 v38, 16, v27
    v_and_b32 v39, s42, v27
    v_lshlrev_b32 v40, 16, v28
    v_and_b32 v41, s42, v28
    v_lshlrev_b32 v42, 16, v29
    v_and_b32 v43, s42, v29
    v_lshlrev_b32 v44, 16, v30
    v_and_b32 v45, s42, v30
    v_lshlrev_b32 v46, 16, v31
    v_and_b32 v47, s42, v31
    s_mov_b32 s43, 0xbdd2d3e8
    v_mov_b32 v68, 0xc0135761
    v_add_f32 v88, v88, v32
    v_add_f32 v89, v89, v33
    v_add_f32 v90, v90, v34
    v_add_f32 v91, v91, v35
    v_mul_f32 v64, v88, v88
    v_mul_f32 v65, v89, v89
    v_mul_f32 v66, v90, v90
    v_mul_f32 v67, v91, v91
    v_fma_f32 v64, v64, s43, v68
    v_fma_f32 v65, v65, s43, v68
    v_fma_f32 v66, v66, s43, v68
    v_fma_f32 v67, v67, s43, v68
    v_mul_f32 v64, v64, v88
    v_mul_f32 v65, v65, v89
    v_mul_f32 v66, v66, v90
    v_mul_f32 v67, v67, v91
    v_exp_f32 v64, v64
    v_exp_f32 v65, v65
    v_exp_f32 v66, v66
    v_exp_f32 v67, v67
    v_add_f32 v64, 1.0, v64
    v_add_f32 v65, 1.0, v65
    v_add_f32 v66, 1.0, v66
    v_add_f32 v67, 1.0, v67
    v_rcp_f32 v64, v64
    v_rcp_f32 v65, v65
    v_rcp_f32 v66, v66
    v_rcp_f32 v67, v67
    v_mul_f32 v88, v88, v64
    v_mul_f32 v89, v89, v65
    v_mul_f32 v90, v90, v66
    v_mul_f32 v91, v91, v67
    v_cvt_pk_bf16_f32 v72, v88, v89
    v_cvt_pk_bf16_f32 v73, v90, v91
    v_add_f32 v100, v100, v36
    v_add_f32 v101, v101, v37
    v_add_f32 v102, v102, v38
    v_add_f32 v103, v103, v39
    v_mul_f32 v64, v100, v100
    v_mul_f32 v65, v101, v101
    v_mul_f32 v66, v102, v102
    v_mul_f32 v67, v103, v103
    v_fma_f32 v64, v64, s43, v68
    v_fma_f32 v65, v65, s43, v68
    v_fma_f32 v66, v66, s43, v68
    v_fma_f32 v67, v67, s43, v68
    v_mul_f32 v64, v64, v100
    v_mul_f32 v65, v65, v101
    v_mul_f32 v66, v66, v102
    v_mul_f32 v67, v67, v103
    v_exp_f32 v64, v64
    v_exp_f32 v65, v65
    v_exp_f32 v66, v66
    v_exp_f32 v67, v67
    v_add_f32 v64, 1.0, v64
    v_add_f32 v65, 1.0, v65
    v_add_f32 v66, 1.0, v66
    v_add_f32 v67, 1.0, v67
    v_rcp_f32 v64, v64
    v_rcp_f32 v65, v65
    v_rcp_f32 v66, v66
    v_rcp_f32 v67, v67
    v_mul_f32 v100, v100, v64
    v_mul_f32 v101, v101, v65
    v_mul_f32 v102, v102, v66
    v_mul_f32 v103, v103, v67
    v_cvt_pk_bf16_f32 v74, v100, v101
    v_cvt_pk_bf16_f32 v75, v102, v103
    buffer_store_dwordx4 v[72:75], v14, s[28:31], s52 offen sc1
    v_add_f32 v112, v112, v40
    v_add_f32 v113, v113, v41
    v_add_f32 v114, v114, v42
    v_add_f32 v115, v115, v43
    v_mul_f32 v64, v112, v112
    v_mul_f32 v65, v113, v113
    v_mul_f32 v66, v114, v114
    v_mul_f32 v67, v115, v115
    v_fma_f32 v64, v64, s43, v68
    v_fma_f32 v65, v65, s43, v68
    v_fma_f32 v66, v66, s43, v68
    v_fma_f32 v67, v67, s43, v68
    v_mul_f32 v64, v64, v112
    v_mul_f32 v65, v65, v113
    v_mul_f32 v66, v66, v114
    v_mul_f32 v67, v67, v115
    v_exp_f32 v64, v64
    v_exp_f32 v65, v65
    v_exp_f32 v66, v66
    v_exp_f32 v67, v67
    v_add_f32 v64, 1.0, v64
    v_add_f32 v65, 1.0, v65
    v_add_f32 v66, 1.0, v66
    v_add_f32 v67, 1.0, v67
    v_rcp_f32 v64, v64
    v_rcp_f32 v65, v65
    v_rcp_f32 v66, v66
    v_rcp_f32 v67, v67
    v_mul_f32 v112, v112, v64
    v_mul_f32 v113, v113, v65
    v_mul_f32 v114, v114, v66
    v_mul_f32 v115, v115, v67
    v_cvt_pk_bf16_f32 v76, v112, v113
    v_cvt_pk_bf16_f32 v77, v114, v115
    v_add_f32 v124, v124, v44
    v_add_f32 v125, v125, v45
    v_add_f32 v126, v126, v46
    v_add_f32 v127, v127, v47
    v_mul_f32 v64, v124, v124
    v_mul_f32 v65, v125, v125
    v_mul_f32 v66, v126, v126
    v_mul_f32 v67, v127, v127
    v_fma_f32 v64, v64, s43, v68
    v_fma_f32 v65, v65, s43, v68
    v_fma_f32 v66, v66, s43, v68
    v_fma_f32 v67, v67, s43, v68
    v_mul_f32 v64, v64, v124
    v_mul_f32 v65, v65, v125
    v_mul_f32 v66, v66, v126
    v_mul_f32 v67, v67, v127
    v_exp_f32 v64, v64
    v_exp_f32 v65, v65
    v_exp_f32 v66, v66
    v_exp_f32 v67, v67
    v_add_f32 v64, 1.0, v64
    v_add_f32 v65, 1.0, v65
    v_add_f32 v66, 1.0, v66
    v_add_f32 v67, 1.0, v67
    v_rcp_f32 v64, v64
    v_rcp_f32 v65, v65
    v_rcp_f32 v66, v66
    v_rcp_f32 v67, v67
    v_mul_f32 v124, v124, v64
    v_mul_f32 v125, v125, v65
    v_mul_f32 v126, v126, v66
    v_mul_f32 v127, v127, v67
    v_cvt_pk_bf16_f32 v78, v124, v125
    v_cvt_pk_bf16_f32 v79, v126, v127
    buffer_store_dwordx4 v[76:79], v14, s[28:31], s55 offen sc1
    v_add_f32 v92, v92, v32
    v_add_f32 v93, v93, v33
    v_add_f32 v94, v94, v34
    v_add_f32 v95, v95, v35
    v_mul_f32 v64, v92, v92
    v_mul_f32 v65, v93, v93
    v_mul_f32 v66, v94, v94
    v_mul_f32 v67, v95, v95
    v_fma_f32 v64, v64, s43, v68
    v_fma_f32 v65, v65, s43, v68
    v_fma_f32 v66, v66, s43, v68
    v_fma_f32 v67, v67, s43, v68
    v_mul_f32 v64, v64, v92
    v_mul_f32 v65, v65, v93
    v_mul_f32 v66, v66, v94
    v_mul_f32 v67, v67, v95
    v_exp_f32 v64, v64
    v_exp_f32 v65, v65
    v_exp_f32 v66, v66
    v_exp_f32 v67, v67
    v_add_f32 v64, 1.0, v64
    v_add_f32 v65, 1.0, v65
    v_add_f32 v66, 1.0, v66
    v_add_f32 v67, 1.0, v67
    v_rcp_f32 v64, v64
    v_rcp_f32 v65, v65
    v_rcp_f32 v66, v66
    v_rcp_f32 v67, v67
    v_mul_f32 v92, v92, v64
    v_mul_f32 v93, v93, v65
    v_mul_f32 v94, v94, v66
    v_mul_f32 v95, v95, v67
    v_cvt_pk_bf16_f32 v72, v92, v93
    v_cvt_pk_bf16_f32 v73, v94, v95
    v_add_f32 v104, v104, v36
    v_add_f32 v105, v105, v37
    v_add_f32 v106, v106, v38
    v_add_f32 v107, v107, v39
    v_mul_f32 v64, v104, v104
    v_mul_f32 v65, v105, v105
    v_mul_f32 v66, v106, v106
    v_mul_f32 v67, v107, v107
    v_fma_f32 v64, v64, s43, v68
    v_fma_f32 v65, v65, s43, v68
    v_fma_f32 v66, v66, s43, v68
    v_fma_f32 v67, v67, s43, v68
    v_mul_f32 v64, v64, v104
    v_mul_f32 v65, v65, v105
    v_mul_f32 v66, v66, v106
    v_mul_f32 v67, v67, v107
    v_exp_f32 v64, v64
    v_exp_f32 v65, v65
    v_exp_f32 v66, v66
    v_exp_f32 v67, v67
    v_add_f32 v64, 1.0, v64
    v_add_f32 v65, 1.0, v65
    v_add_f32 v66, 1.0, v66
    v_add_f32 v67, 1.0, v67
    v_rcp_f32 v64, v64
    v_rcp_f32 v65, v65
    v_rcp_f32 v66, v66
    v_rcp_f32 v67, v67
    v_mul_f32 v104, v104, v64
    v_mul_f32 v105, v105, v65
    v_mul_f32 v106, v106, v66
    v_mul_f32 v107, v107, v67
    v_cvt_pk_bf16_f32 v74, v104, v105
    v_cvt_pk_bf16_f32 v75, v106, v107
    buffer_store_dwordx4 v[72:75], v14, s[28:31], s53 offen sc1
    v_add_f32 v116, v116, v40
    v_add_f32 v117, v117, v41
    v_add_f32 v118, v118, v42
    v_add_f32 v119, v119, v43
    v_mul_f32 v64, v116, v116
    v_mul_f32 v65, v117, v117
    v_mul_f32 v66, v118, v118
    v_mul_f32 v67, v119, v119
    v_fma_f32 v64, v64, s43, v68
    v_fma_f32 v65, v65, s43, v68
    v_fma_f32 v66, v66, s43, v68
    v_fma_f32 v67, v67, s43, v68
    v_mul_f32 v64, v64, v116
    v_mul_f32 v65, v65, v117
    v_mul_f32 v66, v66, v118
    v_mul_f32 v67, v67, v119
    v_exp_f32 v64, v64
    v_exp_f32 v65, v65
    v_exp_f32 v66, v66
    v_exp_f32 v67, v67
    v_add_f32 v64, 1.0, v64
    v_add_f32 v65, 1.0, v65
    v_add_f32 v66, 1.0, v66
    v_add_f32 v67, 1.0, v67
    v_rcp_f32 v64, v64
    v_rcp_f32 v65, v65
    v_rcp_f32 v66, v66
    v_rcp_f32 v67, v67
    v_mul_f32 v116, v116, v64
    v_mul_f32 v117, v117, v65
    v_mul_f32 v118, v118, v66
    v_mul_f32 v119, v119, v67
    v_cvt_pk_bf16_f32 v76, v116, v117
    v_cvt_pk_bf16_f32 v77, v118, v119
    v_add_f32 v128, v128, v44
    v_add_f32 v129, v129, v45
    v_add_f32 v130, v130, v46
    v_add_f32 v131, v131, v47
    v_mul_f32 v64, v128, v128
    v_mul_f32 v65, v129, v129
    v_mul_f32 v66, v130, v130
    v_mul_f32 v67, v131, v131
    v_fma_f32 v64, v64, s43, v68
    v_fma_f32 v65, v65, s43, v68
    v_fma_f32 v66, v66, s43, v68
    v_fma_f32 v67, v67, s43, v68
    v_mul_f32 v64, v64, v128
    v_mul_f32 v65, v65, v129
    v_mul_f32 v66, v66, v130
    v_mul_f32 v67, v67, v131
    v_exp_f32 v64, v64
    v_exp_f32 v65, v65
    v_exp_f32 v66, v66
    v_exp_f32 v67, v67
    v_add_f32 v64, 1.0, v64
    v_add_f32 v65, 1.0, v65
    v_add_f32 v66, 1.0, v66
    v_add_f32 v67, 1.0, v67
    v_rcp_f32 v64, v64
    v_rcp_f32 v65, v65
    v_rcp_f32 v66, v66
    v_rcp_f32 v67, v67
    v_mul_f32 v128, v128, v64
    v_mul_f32 v129, v129, v65
    v_mul_f32 v130, v130, v66
    v_mul_f32 v131, v131, v67
    v_cvt_pk_bf16_f32 v78, v128, v129
    v_cvt_pk_bf16_f32 v79, v130, v131
    buffer_store_dwordx4 v[76:79], v14, s[28:31], s56 offen sc1
    v_add_f32 v96, v96, v32
    v_add_f32 v97, v97, v33
    v_add_f32 v98, v98, v34
    v_add_f32 v99, v99, v35
    v_mul_f32 v64, v96, v96
    v_mul_f32 v65, v97, v97
    v_mul_f32 v66, v98, v98
    v_mul_f32 v67, v99, v99
    v_fma_f32 v64, v64, s43, v68
    v_fma_f32 v65, v65, s43, v68
    v_fma_f32 v66, v66, s43, v68
    v_fma_f32 v67, v67, s43, v68
    v_mul_f32 v64, v64, v96
    v_mul_f32 v65, v65, v97
    v_mul_f32 v66, v66, v98
    v_mul_f32 v67, v67, v99
    v_exp_f32 v64, v64
    v_exp_f32 v65, v65
    v_exp_f32 v66, v66
    v_exp_f32 v67, v67
    v_add_f32 v64, 1.0, v64
    v_add_f32 v65, 1.0, v65
    v_add_f32 v66, 1.0, v66
    v_add_f32 v67, 1.0, v67
    v_rcp_f32 v64, v64
    v_rcp_f32 v65, v65
    v_rcp_f32 v66, v66
    v_rcp_f32 v67, v67
    v_mul_f32 v96, v96, v64
    v_mul_f32 v97, v97, v65
    v_mul_f32 v98, v98, v66
    v_mul_f32 v99, v99, v67
    v_cvt_pk_bf16_f32 v72, v96, v97
    v_cvt_pk_bf16_f32 v73, v98, v99
    v_add_f32 v108, v108, v36
    v_add_f32 v109, v109, v37
    v_add_f32 v110, v110, v38
    v_add_f32 v111, v111, v39
    v_mul_f32 v64, v108, v108
    v_mul_f32 v65, v109, v109
    v_mul_f32 v66, v110, v110
    v_mul_f32 v67, v111, v111
    v_fma_f32 v64, v64, s43, v68
    v_fma_f32 v65, v65, s43, v68
    v_fma_f32 v66, v66, s43, v68
    v_fma_f32 v67, v67, s43, v68
    v_mul_f32 v64, v64, v108
    v_mul_f32 v65, v65, v109
    v_mul_f32 v66, v66, v110
    v_mul_f32 v67, v67, v111
    v_exp_f32 v64, v64
    v_exp_f32 v65, v65
    v_exp_f32 v66, v66
    v_exp_f32 v67, v67
    v_add_f32 v64, 1.0, v64
    v_add_f32 v65, 1.0, v65
    v_add_f32 v66, 1.0, v66
    v_add_f32 v67, 1.0, v67
    v_rcp_f32 v64, v64
    v_rcp_f32 v65, v65
    v_rcp_f32 v66, v66
    v_rcp_f32 v67, v67
    v_mul_f32 v108, v108, v64
    v_mul_f32 v109, v109, v65
    v_mul_f32 v110, v110, v66
    v_mul_f32 v111, v111, v67
    v_cvt_pk_bf16_f32 v74, v108, v109
    v_cvt_pk_bf16_f32 v75, v110, v111
    buffer_store_dwordx4 v[72:75], v14, s[28:31], s54 offen sc1
    v_add_f32 v120, v120, v40
    v_add_f32 v121, v121, v41
    v_add_f32 v122, v122, v42
    v_add_f32 v123, v123, v43
    v_mul_f32 v64, v120, v120
    v_mul_f32 v65, v121, v121
    v_mul_f32 v66, v122, v122
    v_mul_f32 v67, v123, v123
    v_fma_f32 v64, v64, s43, v68
    v_fma_f32 v65, v65, s43, v68
    v_fma_f32 v66, v66, s43, v68
    v_fma_f32 v67, v67, s43, v68
    v_mul_f32 v64, v64, v120
    v_mul_f32 v65, v65, v121
    v_mul_f32 v66, v66, v122
    v_mul_f32 v67, v67, v123
    v_exp_f32 v64, v64
    v_exp_f32 v65, v65
    v_exp_f32 v66, v66
    v_exp_f32 v67, v67
    v_add_f32 v64, 1.0, v64
    v_add_f32 v65, 1.0, v65
    v_add_f32 v66, 1.0, v66
    v_add_f32 v67, 1.0, v67
    v_rcp_f32 v64, v64
    v_rcp_f32 v65, v65
    v_rcp_f32 v66, v66
    v_rcp_f32 v67, v67
    v_mul_f32 v120, v120, v64
    v_mul_f32 v121, v121, v65
    v_mul_f32 v122, v122, v66
    v_mul_f32 v123, v123, v67
    v_cvt_pk_bf16_f32 v76, v120, v121
    v_cvt_pk_bf16_f32 v77, v122, v123
    v_add_f32 v132, v132, v44
    v_add_f32 v133, v133, v45
    v_add_f32 v134, v134, v46
    v_add_f32 v135, v135, v47
    v_mul_f32 v64, v132, v132
    v_mul_f32 v65, v133, v133
    v_mul_f32 v66, v134, v134
    v_mul_f32 v67, v135, v135
    v_fma_f32 v64, v64, s43, v68
    v_fma_f32 v65, v65, s43, v68
    v_fma_f32 v66, v66, s43, v68
    v_fma_f32 v67, v67, s43, v68
    v_mul_f32 v64, v64, v132
    v_mul_f32 v65, v65, v133
    v_mul_f32 v66, v66, v134
    v_mul_f32 v67, v67, v135
    v_exp_f32 v64, v64
    v_exp_f32 v65, v65
    v_exp_f32 v66, v66
    v_exp_f32 v67, v67
    v_add_f32 v64, 1.0, v64
    v_add_f32 v65, 1.0, v65
    v_add_f32 v66, 1.0, v66
    v_add_f32 v67, 1.0, v67
    v_rcp_f32 v64, v64
    v_rcp_f32 v65, v65
    v_rcp_f32 v66, v66
    v_rcp_f32 v67, v67
    v_mul_f32 v132, v132, v64
    v_mul_f32 v133, v133, v65
    v_mul_f32 v134, v134, v66
    v_mul_f32 v135, v135, v67
    v_cvt_pk_bf16_f32 v78, v132, v133
    v_cvt_pk_bf16_f32 v79, v134, v135
    buffer_store_dwordx4 v[76:79], v14, s[28:31], s57 offen sc1
    v_mov_b32 v3, 1
    s_waitcnt vmcnt(0)
    s_mov_b64 exec, 1
    buffer_store_dword v3, off, s[28:31], s58 sc1
    s_mov_b64 exec, -1
t_cons2:
    s_lshr_b32 s44, s36, 1
    s_and_b32 s45, s36, 1
    s_lshl_b32 s45, s45, 3
    s_lshr_b32 s46, s37, 2
    s_add_u32 s45, s45, s46
    s_and_b32 s46, s37, 3
    s_lshr_b32 s47, s44, 1
    s_and_b32 s48, s44, 1
    s_lshl_b32 s40, s3, 1
    s_add_u32 s40, s40, s47
    s_xor_b32 s41, s40, 1
    v_lshrrev_b32 v2, 2, v5
    v_and_b32 v3, 1, v6
    v_lshl_add_u32 v3, v3, 2, v2
    v_mad_u32_u24 v2, v6, 4, v2
    v_lshlrev_b32 v2, 8, v2
    v_and_b32 v4, 3, v1
    v_lshl_add_u32 v2, v4, 3, v2
    v_xor_b32 v4, s40, v3
    v_lshl_add_u32 v8, v4, 5, v2
    v_xor_b32 v4, s41, v3
    v_lshl_add_u32 v9, v4, 5, v2
    s_lshl_b32 s42, s48, 12
    s_add_u32 s43, s42, 16384
    v_add_u32 v10, s43, v14
    s_xor_b32 s43, s43, 4096
    v_add_u32 v11, s43, v14
    v_add_u32 v12, 24576, v14
    s_lshl_b32 s49, s45, 3
    s_add_u32 s49, s49, s40
    s_lshl_b32 s49, s49, 4
    v_add_u32 v2, s49, v5
    v_mov_b32 v230, 0
    v_lshlrev_b32 v3, 1, v2
    buffer_load_short_d16_hi v230, v3, s[12:15], 0 offen
    v_mul_u32_u24 v2, 1152, v2
    v_lshl_add_u32 v22, v6, 3, v2
    s_mul_i32 s49, s46, 288
    s_lshl_b32 s52, s48, 7
    s_add_u32 s52, s52, s49
    s_lshl_b32 s53, s48, 2
    s_add_u32 s53, s53, s49
    s_add_u32 s53, s53, 256
    s_add_u32 s54, s52, 10485760
    s_add_u32 s55, s53, 10485760
    v_lshlrev_b32 v3, 4, v6
    s_lshl_b32 s56, s52, 1
    s_add_u32 s56, s56, 11520
    s_lshl_b32 s57, s53, 1
    s_add_u32 s57, s57, 11520
    s_cmp_lt_u32 s2, 216
    s_cbranch_scc0 g2_late_ops
    buffer_load_dwordx2 v[200:201], v22, s[28:31], s54 offen offset:0
    buffer_load_dwordx2 v[202:203], v22, s[28:31], s54 offen offset:32
    buffer_load_dwordx2 v[204:205], v22, s[28:31], s54 offen offset:64
    buffer_load_dwordx2 v[206:207], v22, s[28:31], s54 offen offset:96
    buffer_load_dword v208, v22, s[28:31], s55 offen
    buffer_load_dwordx4 v[210:213], v3, s[28:31], s56 offen offset:0
    buffer_load_dwordx4 v[214:217], v3, s[28:31], s56 offen offset:64
    buffer_load_dwordx4 v[218:221], v3, s[28:31], s56 offen offset:128
    buffer_load_dwordx4 v[222:225], v3, s[28:31], s56 offen offset:192
    buffer_load_dwordx2 v[226:227], v3, s[28:31], s57 offen
g2_late_ops:
    v_mov_b32 v128, 0
    v_mov_b32 v129, 0
    v_mov_b32 v130, 0
    v_mov_b32 v131, 0
    v_mov_b32 v132, 0
    v_mov_b32 v133, 0
    v_mov_b32 v134, 0
    v_mov_b32 v135, 0
    v_mov_b32 v136, 0
    v_mov_b32 v137, 0
    v_mov_b32 v138, 0
    v_mov_b32 v139, 0
    v_mov_b32 v140, 0
    v_mov_b32 v141, 0
    v_mov_b32 v142, 0
    v_mov_b32 v143, 0
    v_mov_b32 v144, 0
    v_mov_b32 v145, 0
    v_mov_b32 v146, 0
    v_mov_b32 v147, 0
    v_mov_b32 v148, 0
    v_mov_b32 v149, 0
    v_mov_b32 v150, 0
    v_mov_b32 v151, 0
    v_mov_b32 v152, 0
    v_mov_b32 v153, 0
    v_mov_b32 v154, 0
    v_mov_b32 v155, 0
    v_mov_b32 v156, 0
    v_mov_b32 v157, 0
    v_mov_b32 v158, 0
    v_mov_b32 v159, 0
    v_mov_b32 v160, 0
    v_mov_b32 v161, 0
    v_mov_b32 v162, 0
    v_mov_b32 v163, 0
    v_mov_b32 v164, 0
    v_mov_b32 v165, 0
    v_mov_b32 v166, 0
    v_mov_b32 v167, 0
    v_mov_b32 v168, 0
    v_mov_b32 v169, 0
    v_mov_b32 v170, 0
    v_mov_b32 v171, 0
    v_mov_b32 v172, 0
    v_mov_b32 v173, 0
    v_mov_b32 v174, 0
    v_mov_b32 v175, 0
    v_mov_b32 v176, 0
    v_mov_b32 v177, 0
    v_mov_b32 v178, 0
    v_mov_b32 v179, 0
    v_mov_b32 v180, 0
    v_mov_b32 v181, 0
    v_mov_b32 v182, 0
    v_mov_b32 v183, 0
    v_mov_b32 v184, 0
    v_mov_b32 v185, 0
    v_mov_b32 v186, 0
    v_mov_b32 v187, 0
    v_mov_b32 v188, 0
    v_mov_b32 v189, 0
    v_mov_b32 v190, 0
    v_mov_b32 v191, 0
    v_mov_b32 v192, 0
    v_mov_b32 v193, 0
    v_mov_b32 v194, 0
    v_mov_b32 v195, 0
    v_mov_b32 v196, 0
    v_mov_b32 v197, 0
    v_mov_b32 v198, 0
    v_mov_b32 v199, 0
    s_mov_b32 s24, 0
    v_add_u32 v16, s24, v8
    v_add_u32 v17, s24, v9
    v_add_u32 v18, s24, v10
    v_add_u32 v19, s24, v11
    v_add_u32 v20, s24, v12
    s_movk_i32 s59, 17
    s_barrier
    ds_read_b128 v[32:35], v18 offset:0
    ds_read_b64_tr_b16 v[24:25], v16 offset:0
    ds_read_b64_tr_b16 v[26:27], v16 offset:4096
    ds_read_b64_tr_b16 v[28:29], v17 offset:0
    ds_read_b64_tr_b16 v[30:31], v17 offset:4096
    ds_read_b128 v[36:39], v18 offset:1024
    ds_read_b128 v[40:43], v18 offset:2048
    ds_read_b128 v[44:47], v18 offset:3072
    ds_read_b128 v[48:51], v19 offset:0
    ds_read_b128 v[52:55], v19 offset:1024
    ds_read_b128 v[56:59], v19 offset:2048
    ds_read_b128 v[60:63], v19 offset:3072
    ds_read_b128 v[64:67], v20 offset:0
    s_cmp_lt_u32 s2, 216
    s_cbranch_scc1 g2_late_done
    buffer_load_dwordx2 v[200:201], v22, s[28:31], s54 offen offset:0
    buffer_load_dwordx2 v[202:203], v22, s[28:31], s54 offen offset:32
    buffer_load_dwordx2 v[204:205], v22, s[28:31], s54 offen offset:64
    buffer_load_dwordx2 v[206:207], v22, s[28:31], s54 offen offset:96
    buffer_load_dword v208, v22, s[28:31], s55 offen
    buffer_load_dwordx4 v[210:213], v3, s[28:31], s56 offen offset:0
    buffer_load_dwordx4 v[214:217], v3, s[28:31], s56 offen offset:64
    buffer_load_dwordx4 v[218:221], v3, s[28:31], s56 offen offset:128
    buffer_load_dwordx4 v[222:225], v3, s[28:31], s56 offen offset:192
    buffer_load_dwordx2 v[226:227], v3, s[28:31], s57 offen
g2_late_done:
g2_mm_loop:
    s_waitcnt lgkmcnt(0)
    v_mfma_f32_16x16x32_bf16 v[128:131], v[32:35], v[24:27], v[128:131]
    ds_read_b128 v[76:79], v18 offset:9216
    ds_read_b64_tr_b16 v[68:69], v16 offset:8192
    v_mfma_f32_16x16x32_bf16 v[164:167], v[32:35], v[28:31], v[164:167]
    ds_read_b64_tr_b16 v[70:71], v16 offset:12288
    ds_read_b64_tr_b16 v[72:73], v17 offset:8192
    v_mfma_f32_16x16x32_bf16 v[132:135], v[36:39], v[24:27], v[132:135]
    ds_read_b64_tr_b16 v[74:75], v17 offset:12288
    ds_read_b128 v[80:83], v18 offset:10240
    v_mfma_f32_16x16x32_bf16 v[168:171], v[36:39], v[28:31], v[168:171]
    ds_read_b128 v[84:87], v18 offset:11264
    ds_read_b128 v[88:91], v18 offset:12288
    v_mfma_f32_16x16x32_bf16 v[136:139], v[40:43], v[24:27], v[136:139]
    ds_read_b128 v[92:95], v19 offset:9216
    ds_read_b128 v[96:99], v19 offset:10240
    v_mfma_f32_16x16x32_bf16 v[172:175], v[40:43], v[28:31], v[172:175]
    ds_read_b128 v[100:103], v19 offset:11264
    ds_read_b128 v[104:107], v19 offset:12288
    v_mfma_f32_16x16x32_bf16 v[140:143], v[44:47], v[24:27], v[140:143]
    ds_read_b128 v[108:111], v20 offset:9216
    s_add_u32 s24, s24, 34816
    v_mfma_f32_16x16x32_bf16 v[176:179], v[44:47], v[28:31], v[176:179]
    s_cmp_eq_u32 s24, 139264
    s_cselect_b32 s24, 0, s24
    v_mfma_f32_16x16x32_bf16 v[144:147], v[48:51], v[24:27], v[144:147]
    v_add_u32 v16, s24, v8
    v_add_u32 v17, s24, v9
    v_mfma_f32_16x16x32_bf16 v[180:183], v[48:51], v[28:31], v[180:183]
    v_add_u32 v18, s24, v10
    v_add_u32 v19, s24, v11
    v_mfma_f32_16x16x32_bf16 v[148:151], v[52:55], v[24:27], v[148:151]
    v_add_u32 v20, s24, v12
    v_mfma_f32_16x16x32_bf16 v[184:187], v[52:55], v[28:31], v[184:187]
    v_mfma_f32_16x16x32_bf16 v[152:155], v[56:59], v[24:27], v[152:155]
    v_mfma_f32_16x16x32_bf16 v[188:191], v[56:59], v[28:31], v[188:191]
    v_mfma_f32_16x16x32_bf16 v[156:159], v[60:63], v[24:27], v[156:159]
    v_mfma_f32_16x16x32_bf16 v[192:195], v[60:63], v[28:31], v[192:195]
    s_waitcnt lgkmcnt(0)
    s_barrier
    v_mfma_f32_16x16x32_bf16 v[160:163], v[64:67], v[24:27], v[160:163]
    v_mfma_f32_16x16x32_bf16 v[196:199], v[64:67], v[28:31], v[196:199]
    v_mfma_f32_16x16x32_bf16 v[128:131], v[76:79], v[68:71], v[128:131]
    ds_read_b128 v[32:35], v18 offset:0
    ds_read_b64_tr_b16 v[24:25], v16 offset:0
    v_mfma_f32_16x16x32_bf16 v[164:167], v[76:79], v[72:75], v[164:167]
    ds_read_b64_tr_b16 v[26:27], v16 offset:4096
    ds_read_b64_tr_b16 v[28:29], v17 offset:0
    v_mfma_f32_16x16x32_bf16 v[132:135], v[80:83], v[68:71], v[132:135]
    ds_read_b64_tr_b16 v[30:31], v17 offset:4096
    ds_read_b128 v[36:39], v18 offset:1024
    v_mfma_f32_16x16x32_bf16 v[168:171], v[80:83], v[72:75], v[168:171]
    ds_read_b128 v[40:43], v18 offset:2048
    ds_read_b128 v[44:47], v18 offset:3072
    v_mfma_f32_16x16x32_bf16 v[136:139], v[84:87], v[68:71], v[136:139]
    ds_read_b128 v[48:51], v19 offset:0
    ds_read_b128 v[52:55], v19 offset:1024
    v_mfma_f32_16x16x32_bf16 v[172:175], v[84:87], v[72:75], v[172:175]
    ds_read_b128 v[56:59], v19 offset:2048
    ds_read_b128 v[60:63], v19 offset:3072
    v_mfma_f32_16x16x32_bf16 v[140:143], v[88:91], v[68:71], v[140:143]
    ds_read_b128 v[64:67], v20 offset:0
    s_sub_u32 s59, s59, 1
    v_mfma_f32_16x16x32_bf16 v[176:179], v[88:91], v[72:75], v[176:179]
    s_cmp_lg_u32 s59, 0
    v_mfma_f32_16x16x32_bf16 v[144:147], v[92:95], v[68:71], v[144:147]
    v_mfma_f32_16x16x32_bf16 v[180:183], v[92:95], v[72:75], v[180:183]
    v_mfma_f32_16x16x32_bf16 v[148:151], v[96:99], v[68:71], v[148:151]
    v_mfma_f32_16x16x32_bf16 v[184:187], v[96:99], v[72:75], v[184:187]
    v_mfma_f32_16x16x32_bf16 v[152:155], v[100:103], v[68:71], v[152:155]
    v_mfma_f32_16x16x32_bf16 v[188:191], v[100:103], v[72:75], v[188:191]
    v_mfma_f32_16x16x32_bf16 v[156:159], v[104:107], v[68:71], v[156:159]
    v_mfma_f32_16x16x32_bf16 v[192:195], v[104:107], v[72:75], v[192:195]
    v_mfma_f32_16x16x32_bf16 v[160:163], v[108:111], v[68:71], v[160:163]
    v_mfma_f32_16x16x32_bf16 v[196:199], v[108:111], v[72:75], v[196:199]
    s_cbranch_scc1 g2_mm_loop
    s_waitcnt lgkmcnt(0)
    v_mfma_f32_16x16x32_bf16 v[128:131], v[32:35], v[24:27], v[128:131]
    ds_read_b128 v[76:79], v18 offset:9216
    ds_read_b64_tr_b16 v[68:69], v16 offset:8192
    v_mfma_f32_16x16x32_bf16 v[164:167], v[32:35], v[28:31], v[164:167]
    ds_read_b64_tr_b16 v[70:71], v16 offset:12288
    ds_read_b64_tr_b16 v[72:73], v17 offset:8192
    v_mfma_f32_16x16x32_bf16 v[132:135], v[36:39], v[24:27], v[132:135]
    ds_read_b64_tr_b16 v[74:75], v17 offset:12288
    ds_read_b128 v[80:83], v18 offset:10240
    v_mfma_f32_16x16x32_bf16 v[168:171], v[36:39], v[28:31], v[168:171]
    ds_read_b128 v[84:87], v18 offset:11264
    ds_read_b128 v[88:91], v18 offset:12288
    v_mfma_f32_16x16x32_bf16 v[136:139], v[40:43], v[24:27], v[136:139]
    ds_read_b128 v[92:95], v19 offset:9216
    ds_read_b128 v[96:99], v19 offset:10240
    v_mfma_f32_16x16x32_bf16 v[172:175], v[40:43], v[28:31], v[172:175]
    ds_read_b128 v[100:103], v19 offset:11264
    ds_read_b128 v[104:107], v19 offset:12288
    v_mfma_f32_16x16x32_bf16 v[140:143], v[44:47], v[24:27], v[140:143]
    ds_read_b128 v[108:111], v20 offset:9216
    v_mfma_f32_16x16x32_bf16 v[176:179], v[44:47], v[28:31], v[176:179]
    v_mfma_f32_16x16x32_bf16 v[144:147], v[48:51], v[24:27], v[144:147]
    v_mfma_f32_16x16x32_bf16 v[180:183], v[48:51], v[28:31], v[180:183]
    v_mfma_f32_16x16x32_bf16 v[148:151], v[52:55], v[24:27], v[148:151]
    v_mfma_f32_16x16x32_bf16 v[184:187], v[52:55], v[28:31], v[184:187]
    v_mfma_f32_16x16x32_bf16 v[152:155], v[56:59], v[24:27], v[152:155]
    v_mfma_f32_16x16x32_bf16 v[188:191], v[56:59], v[28:31], v[188:191]
    v_mfma_f32_16x16x32_bf16 v[156:159], v[60:63], v[24:27], v[156:159]
    v_mfma_f32_16x16x32_bf16 v[192:195], v[60:63], v[28:31], v[192:195]
    v_mfma_f32_16x16x32_bf16 v[160:163], v[64:67], v[24:27], v[160:163]
    v_mfma_f32_16x16x32_bf16 v[196:199], v[64:67], v[28:31], v[196:199]
    s_waitcnt lgkmcnt(0)
    v_mfma_f32_16x16x32_bf16 v[128:131], v[76:79], v[68:71], v[128:131]
    v_mfma_f32_16x16x32_bf16 v[164:167], v[76:79], v[72:75], v[164:167]
    v_mfma_f32_16x16x32_bf16 v[132:135], v[80:83], v[68:71], v[132:135]
    v_mfma_f32_16x16x32_bf16 v[168:171], v[80:83], v[72:75], v[168:171]
    v_mfma_f32_16x16x32_bf16 v[136:139], v[84:87], v[68:71], v[136:139]
    v_mfma_f32_16x16x32_bf16 v[172:175], v[84:87], v[72:75], v[172:175]
    v_mfma_f32_16x16x32_bf16 v[140:143], v[88:91], v[68:71], v[140:143]
    v_mfma_f32_16x16x32_bf16 v[176:179], v[88:91], v[72:75], v[176:179]
    v_mfma_f32_16x16x32_bf16 v[144:147], v[92:95], v[68:71], v[144:147]
    v_mfma_f32_16x16x32_bf16 v[180:183], v[92:95], v[72:75], v[180:183]
    v_mfma_f32_16x16x32_bf16 v[148:151], v[96:99], v[68:71], v[148:151]
    v_mfma_f32_16x16x32_bf16 v[184:187], v[96:99], v[72:75], v[184:187]
    v_mfma_f32_16x16x32_bf16 v[152:155], v[100:103], v[68:71], v[152:155]
    v_mfma_f32_16x16x32_bf16 v[188:191], v[100:103], v[72:75], v[188:191]
    v_mfma_f32_16x16x32_bf16 v[156:159], v[104:107], v[68:71], v[156:159]
    v_mfma_f32_16x16x32_bf16 v[192:195], v[104:107], v[72:75], v[192:195]
    v_mfma_f32_16x16x32_bf16 v[160:163], v[108:111], v[68:71], v[160:163]
    v_mfma_f32_16x16x32_bf16 v[196:199], v[108:111], v[72:75], v[196:199]
    s_cmp_eq_u32 s48, 1
    s_cbranch_scc0 g2_noswap
    s_nop 4
    v_swap_b32 v160, v162
    v_swap_b32 v161, v163
    v_swap_b32 v196, v198
    v_swap_b32 v197, v199
g2_noswap:
    s_lshl_b32 s50, s46, 4
    s_add_u32 s50, s50, s45
    s_lshl_b32 s50, s50, 2
    s_add_u32 s50, s50, s3
    s_lshl_b32 s58, s50, 10
    s_add_u32 s58, s58, 262144
    s_lshl_b32 s50, s50, 2
    s_xor_b32 s51, s44, 1
    s_add_u32 s51, s51, s50
    s_lshl_b32 s51, s51, 2
    s_add_u32 s51, s51, s44
    s_mul_i32 s51, s51, 3072
    s_add_u32 s51, s51, 25165824
    v_cvt_pk_bf16_f32 v24, v144, v145
    v_cvt_pk_bf16_f32 v25, v146, v147
    v_cvt_pk_bf16_f32 v26, v148, v149
    v_cvt_pk_bf16_f32 v27, v150, v151
    v_cvt_pk_bf16_f32 v28, v152, v153
    v_cvt_pk_bf16_f32 v29, v154, v155
    v_cvt_pk_bf16_f32 v30, v156, v157
    v_cvt_pk_bf16_f32 v31, v158, v159
    v_cvt_pk_bf16_f32 v32, v162, v163
    buffer_store_dwordx4 v[24:27], v14, s[28:31], s51 offen sc0 sc1
    buffer_store_dwordx4 v[28:31], v14, s[28:31], s51 offen offset:1024 sc0 sc1
    buffer_store_dword v32, v15, s[28:31], s51 offen offset:2048 sc0 sc1
    s_xor_b32 s51, s44, 2
    s_add_u32 s51, s51, s50
    s_lshl_b32 s51, s51, 2
    s_add_u32 s51, s51, s44
    s_mul_i32 s51, s51, 3072
    s_add_u32 s51, s51, 25165824
    v_cvt_pk_bf16_f32 v36, v164, v165
    v_cvt_pk_bf16_f32 v37, v166, v167
    v_cvt_pk_bf16_f32 v38, v168, v169
    v_cvt_pk_bf16_f32 v39, v170, v171
    v_cvt_pk_bf16_f32 v40, v172, v173
    v_cvt_pk_bf16_f32 v41, v174, v175
    v_cvt_pk_bf16_f32 v42, v176, v177
    v_cvt_pk_bf16_f32 v43, v178, v179
    v_cvt_pk_bf16_f32 v44, v196, v197
    buffer_store_dwordx4 v[36:39], v14, s[28:31], s51 offen sc0 sc1
    buffer_store_dwordx4 v[40:43], v14, s[28:31], s51 offen offset:1024 sc0 sc1
    buffer_store_dword v44, v15, s[28:31], s51 offen offset:2048 sc0 sc1
    s_xor_b32 s51, s44, 3
    s_add_u32 s51, s51, s50
    s_lshl_b32 s51, s51, 2
    s_add_u32 s51, s51, s44
    s_mul_i32 s51, s51, 3072
    s_add_u32 s51, s51, 25165824
    v_cvt_pk_bf16_f32 v48, v180, v181
    v_cvt_pk_bf16_f32 v49, v182, v183
    v_cvt_pk_bf16_f32 v50, v184, v185
    v_cvt_pk_bf16_f32 v51, v186, v187
    v_cvt_pk_bf16_f32 v52, v188, v189
    v_cvt_pk_bf16_f32 v53, v190, v191
    v_cvt_pk_bf16_f32 v54, v192, v193
    v_cvt_pk_bf16_f32 v55, v194, v195
    v_cvt_pk_bf16_f32 v56, v198, v199
    buffer_store_dwordx4 v[48:51], v14, s[28:31], s51 offen sc0 sc1
    buffer_store_dwordx4 v[52:55], v14, s[28:31], s51 offen offset:1024 sc0 sc1
    buffer_store_dword v56, v15, s[28:31], s51 offen offset:2048 sc0 sc1
    s_lshl_b32 s51, s44, 2
    s_add_u32 s51, s51, s58
    v_lshlrev_b32 v2, 6, v1
    v_mov_b32 v3, 1
    s_waitcnt vmcnt(0)
    s_mov_b64 exec, 15
    buffer_store_dword v3, v2, s[28:31], s51 offen sc0 sc1
    s_mov_b64 exec, -1
    s_lshl_b32 s51, s44, 6
    s_add_u32 s51, s51, s58
    s_mov_b32 s49, 0
g2_poll:
    buffer_load_dwordx4 v[68:71], off, s[28:31], s51 sc0 sc1
    s_add_u32 s49, s49, 1
    s_waitcnt vmcnt(0)
    v_and_b32 v68, v68, v69
    v_and_b32 v70, v70, v71
    v_and_b32 v68, v68, v70
    s_nop 0
    v_readfirstlane_b32 s47, v68
    s_nop 0
    s_cmp_eq_u32 s47, 1
    s_cbranch_scc1 g2_ready
    s_cmp_lt_u32 s49, 30000
    s_cbranch_scc1 g2_poll
g2_ready:
    s_add_u32 s50, s50, s44
    s_lshl_b32 s50, s50, 2
    s_xor_b32 s51, s44, 1
    s_add_u32 s51, s51, s50
    s_mul_i32 s51, s51, 3072
    s_add_u32 s51, s51, 25165824
    buffer_load_dwordx4 v[68:71], v14, s[28:31], s51 offen sc0 sc1
    buffer_load_dwordx4 v[72:75], v14, s[28:31], s51 offen offset:1024 sc0 sc1
    buffer_load_dword v76, v15, s[28:31], s51 offen offset:2048 sc0 sc1
    s_xor_b32 s51, s44, 2
    s_add_u32 s51, s51, s50
    s_mul_i32 s51, s51, 3072
    s_add_u32 s51, s51, 25165824
    buffer_load_dwordx4 v[80:83], v14, s[28:31], s51 offen sc0 sc1
    buffer_load_dwordx4 v[84:87], v14, s[28:31], s51 offen offset:1024 sc0 sc1
    buffer_load_dword v88, v15, s[28:31], s51 offen offset:2048 sc0 sc1
    s_xor_b32 s51, s44, 3
    s_add_u32 s51, s51, s50
    s_mul_i32 s51, s51, 3072
    s_add_u32 s51, s51, 25165824
    buffer_load_dwordx4 v[92:95], v14, s[28:31], s51 offen sc0 sc1
    buffer_load_dwordx4 v[96:99], v14, s[28:31], s51 offen offset:1024 sc0 sc1
    buffer_load_dword v100, v15, s[28:31], s51 offen offset:2048 sc0 sc1
    s_mov_b32 s42, 0xffff0000
    v_add_f32 v128, v128, v230
    v_add_f32 v129, v129, v230
    v_add_f32 v130, v130, v230
    v_add_f32 v131, v131, v230
    v_add_f32 v132, v132, v230
    v_add_f32 v133, v133, v230
    v_add_f32 v134, v134, v230
    v_add_f32 v135, v135, v230
    v_add_f32 v136, v136, v230
    v_add_f32 v137, v137, v230
    v_add_f32 v138, v138, v230
    v_add_f32 v139, v139, v230
    v_add_f32 v140, v140, v230
    v_add_f32 v141, v141, v230
    v_add_f32 v142, v142, v230
    v_add_f32 v143, v143, v230
    v_add_f32 v160, v160, v230
    v_add_f32 v161, v161, v230
    v_lshlrev_b32 v32, 16, v200
    v_and_b32 v33, s42, v200
    v_lshlrev_b32 v34, 16, v201
    v_and_b32 v35, s42, v201
    v_lshlrev_b32 v36, 16, v202
    v_and_b32 v37, s42, v202
    v_lshlrev_b32 v38, 16, v203
    v_and_b32 v39, s42, v203
    v_lshlrev_b32 v40, 16, v204
    v_and_b32 v41, s42, v204
    v_lshlrev_b32 v42, 16, v205
    v_and_b32 v43, s42, v205
    v_lshlrev_b32 v44, 16, v206
    v_and_b32 v45, s42, v206
    v_lshlrev_b32 v46, 16, v207
    v_and_b32 v47, s42, v207
    v_lshlrev_b32 v48, 16, v208
    v_and_b32 v49, s42, v208
    s_waitcnt vmcnt(6)
    v_lshlrev_b32 v24, 16, v68
    v_and_b32 v25, s42, v68
    v_add_f32 v128, v128, v24
    v_add_f32 v129, v129, v25
    v_lshlrev_b32 v26, 16, v69
    v_and_b32 v27, s42, v69
    v_add_f32 v130, v130, v26
    v_add_f32 v131, v131, v27
    v_lshlrev_b32 v24, 16, v70
    v_and_b32 v25, s42, v70
    v_add_f32 v132, v132, v24
    v_add_f32 v133, v133, v25
    v_lshlrev_b32 v26, 16, v71
    v_and_b32 v27, s42, v71
    v_add_f32 v134, v134, v26
    v_add_f32 v135, v135, v27
    v_lshlrev_b32 v24, 16, v72
    v_and_b32 v25, s42, v72
    v_add_f32 v136, v136, v24
    v_add_f32 v137, v137, v25
    v_lshlrev_b32 v26, 16, v73
    v_and_b32 v27, s42, v73
    v_add_f32 v138, v138, v26
    v_add_f32 v139, v139, v27
    v_lshlrev_b32 v24, 16, v74
    v_and_b32 v25, s42, v74
    v_add_f32 v140, v140, v24
    v_add_f32 v141, v141, v25
    v_lshlrev_b32 v26, 16, v75
    v_and_b32 v27, s42, v75
    v_add_f32 v142, v142, v26
    v_add_f32 v143, v143, v27
    v_lshlrev_b32 v24, 16, v76
    v_and_b32 v25, s42, v76
    v_add_f32 v160, v160, v24
    v_add_f32 v161, v161, v25
    s_waitcnt vmcnt(3)
    v_lshlrev_b32 v24, 16, v80
    v_and_b32 v25, s42, v80
    v_add_f32 v128, v128, v24
    v_add_f32 v129, v129, v25
    v_lshlrev_b32 v26, 16, v81
    v_and_b32 v27, s42, v81
    v_add_f32 v130, v130, v26
    v_add_f32 v131, v131, v27
    v_lshlrev_b32 v24, 16, v82
    v_and_b32 v25, s42, v82
    v_add_f32 v132, v132, v24
    v_add_f32 v133, v133, v25
    v_lshlrev_b32 v26, 16, v83
    v_and_b32 v27, s42, v83
    v_add_f32 v134, v134, v26
    v_add_f32 v135, v135, v27
    v_lshlrev_b32 v24, 16, v84
    v_and_b32 v25, s42, v84
    v_add_f32 v136, v136, v24
    v_add_f32 v137, v137, v25
    v_lshlrev_b32 v26, 16, v85
    v_and_b32 v27, s42, v85
    v_add_f32 v138, v138, v26
    v_add_f32 v139, v139, v27
    v_lshlrev_b32 v24, 16, v86
    v_and_b32 v25, s42, v86
    v_add_f32 v140, v140, v24
    v_add_f32 v141, v141, v25
    v_lshlrev_b32 v26, 16, v87
    v_and_b32 v27, s42, v87
    v_add_f32 v142, v142, v26
    v_add_f32 v143, v143, v27
    v_lshlrev_b32 v24, 16, v88
    v_and_b32 v25, s42, v88
    v_add_f32 v160, v160, v24
    v_add_f32 v161, v161, v25
    s_waitcnt vmcnt(0)
    v_lshlrev_b32 v24, 16, v92
    v_and_b32 v25, s42, v92
    v_add_f32 v128, v128, v24
    v_add_f32 v129, v129, v25
    v_lshlrev_b32 v26, 16, v93
    v_and_b32 v27, s42, v93
    v_add_f32 v130, v130, v26
    v_add_f32 v131, v131, v27
    v_lshlrev_b32 v24, 16, v94
    v_and_b32 v25, s42, v94
    v_add_f32 v132, v132, v24
    v_add_f32 v133, v133, v25
    v_lshlrev_b32 v26, 16, v95
    v_and_b32 v27, s42, v95
    v_add_f32 v134, v134, v26
    v_add_f32 v135, v135, v27
    v_lshlrev_b32 v24, 16, v96
    v_and_b32 v25, s42, v96
    v_add_f32 v136, v136, v24
    v_add_f32 v137, v137, v25
    v_lshlrev_b32 v26, 16, v97
    v_and_b32 v27, s42, v97
    v_add_f32 v138, v138, v26
    v_add_f32 v139, v139, v27
    v_lshlrev_b32 v24, 16, v98
    v_and_b32 v25, s42, v98
    v_add_f32 v140, v140, v24
    v_add_f32 v141, v141, v25
    v_lshlrev_b32 v26, 16, v99
    v_and_b32 v27, s42, v99
    v_add_f32 v142, v142, v26
    v_add_f32 v143, v143, v27
    v_lshlrev_b32 v24, 16, v100
    v_and_b32 v25, s42, v100
    v_add_f32 v160, v160, v24
    v_add_f32 v161, v161, v25
    v_fma_f32 v128, v128, v210, v32
    v_fma_f32 v129, v129, v211, v33
    v_cvt_pk_bf16_f32 v68, v128, v129
    v_fma_f32 v130, v130, v212, v34
    v_fma_f32 v131, v131, v213, v35
    v_cvt_pk_bf16_f32 v69, v130, v131
    v_fma_f32 v132, v132, v214, v36
    v_fma_f32 v133, v133, v215, v37
    v_cvt_pk_bf16_f32 v70, v132, v133
    v_fma_f32 v134, v134, v216, v38
    v_fma_f32 v135, v135, v217, v39
    v_cvt_pk_bf16_f32 v71, v134, v135
    v_fma_f32 v136, v136, v218, v40
    v_fma_f32 v137, v137, v219, v41
    v_cvt_pk_bf16_f32 v72, v136, v137
    v_fma_f32 v138, v138, v220, v42
    v_fma_f32 v139, v139, v221, v43
    v_cvt_pk_bf16_f32 v73, v138, v139
    v_fma_f32 v140, v140, v222, v44
    v_fma_f32 v141, v141, v223, v45
    v_cvt_pk_bf16_f32 v74, v140, v141
    v_fma_f32 v142, v142, v224, v46
    v_fma_f32 v143, v143, v225, v47
    v_cvt_pk_bf16_f32 v75, v142, v143
    v_fma_f32 v160, v160, v226, v48
    v_fma_f32 v161, v161, v227, v49
    v_cvt_pk_bf16_f32 v76, v160, v161
    buffer_store_dwordx2 v[68:69], v22, s[16:19], s52 offen offset:0
    buffer_store_dwordx2 v[70:71], v22, s[16:19], s52 offen offset:32
    buffer_store_dwordx2 v[72:73], v22, s[16:19], s52 offen offset:64
    buffer_store_dwordx2 v[74:75], v22, s[16:19], s52 offen offset:96
    buffer_store_dword v76, v22, s[16:19], s53 offen
t_end:
f_done:
    s_endpgm
.section .rodata,"a"
.p2align 6
.amdhsa_kernel f_kernel
  .amdhsa_next_free_vgpr 256
  .amdhsa_next_free_sgpr 100
  .amdhsa_accum_offset 256
  .amdhsa_group_segment_fixed_size 0
  .amdhsa_kernarg_size 104
  .amdhsa_user_sgpr_count 2
  .amdhsa_user_sgpr_kernarg_segment_ptr 1
  .amdhsa_system_sgpr_workgroup_id_x 1
.end_amdhsa_kernel
```

```asm
; @launch kernel=f_kernel grid=(256,1,1) block=(512,1,1) lds=163840
.amdgcn_target "amdgcn-amd-amdhsa--gfx950"
.text
.globl f_kernel
.p2align 8
.type f_kernel,@function
f_kernel:
    s_cmp_ge_u32 s2, 256
    s_cbranch_scc1 f_done
    s_load_dwordx2 s[16:17], s[0:1], 64
    s_load_dwordx2 s[20:21], s[0:1], 72
    s_load_dwordx2 s[28:29], s[0:1], 96
    s_load_dwordx2 s[4:5], s[0:1], 0
    s_load_dwordx2 s[8:9], s[0:1], 8
    s_load_dwordx2 s[12:13], s[0:1], 16
    s_load_dwordx2 s[24:25], s[0:1], 88
    s_load_dwordx2 s[32:33], s[0:1], 32
    s_mov_b32 s18, 0x480
    s_mov_b32 s19, 0x20000
    s_mov_b32 s22, 0x3cc000
    s_mov_b32 s23, 0x20000
    s_mov_b32 s30, 0x3000000
    s_mov_b32 s31, 0x20000
    s_mov_b32 s6, 0x240000
    s_mov_b32 s7, 0x20000
    s_mov_b32 s10, 0x121000
    s_mov_b32 s11, 0x20000
    s_mov_b32 s14, 0x121000
    s_mov_b32 s15, 0x20000
    s_mov_b32 s26, 0x100
    s_mov_b32 s27, 0x20000
    s_mov_b32 s34, 0x1200000
    s_mov_b32 s35, 0x20000
    v_and_b32 v1, 63, v0
    v_lshrrev_b32 v2, 6, v0
    s_nop 0
    v_readfirstlane_b32 s3, v2
    v_and_b32 v5, 15, v1
    v_lshrrev_b32 v6, 4, v1
    s_and_b32 s36, s2, 7
    s_lshr_b32 s37, s2, 3
    s_lshr_b32 s38, s37, 3
    s_sub_u32 s38, 3, s38
    s_lshl_b32 s38, s38, 3
    s_add_u32 s38, s38, s36
    s_lshl_b32 s38, s38, 3
    s_and_b32 s39, s37, 7
    s_add_u32 s38, s38, s39
    s_and_b32 s39, s3, 3
    s_lshr_b32 s40, s3, 2
    s_sub_u32 s41, s2, 64
    s_mul_i32 s43, s41, 171
    s_lshr_b32 s43, s43, 9
    s_mul_i32 s44, s43, 3
    s_sub_u32 s44, s41, s44
    v_lshrrev_b32 v2, 3, v0
    v_and_b32 v3, 7, v0
    v_mul_u32_u24 v4, 6912, v2
    v_lshl_add_u32 v3, v3, 4, v4
    v_lshlrev_b32 v2, 1, v2
    s_mul_i32 s45, s44, 384
    s_mul_i32 s46, s44, 1327104
    s_lshl_b32 s47, s43, 7
    s_add_u32 s46, s46, s47
    s_cmp_lt_u32 s41, 54
    s_cselect_b32 s48, 1, 2
    s_mul_i32 s48, s48, 4608
    s_mul_i32 s48, s48, s44
    s_lshl_b32 s47, s43, 8
    s_add_u32 s48, s48, s47
    s_cmp_lt_u32 s41, 54
    s_movk_i32 s47, 19968
    s_cselect_b32 s47, 0, s47
    s_add_u32 s48, s48, s47
    s_add_u32 s48, s48, 131072
    v_lshlrev_b32 v125, 2, v1
    v_lshlrev_b32 v109, 4, v1
    v_mov_b32 v68, -1
    v_mov_b32 v69, -1
    v_mov_b32 v70, -1
    v_mov_b32 v71, -1
    v_mov_b32 v44, 0
    v_mov_b32 v45, 0
    v_mov_b32 v46, 0
    s_bfe_u32 s49, s2, 0x10001
    s_lshl_b32 s49, s49, 3
    s_bfe_u32 s50, s2, 0x30003
    s_add_u32 s49, s49, s50
    s_bfe_u32 s50, s2, 0x10002
    s_lshl_b32 s50, s50, 2
    s_lshr_b32 s51, s2, 6
    s_add_u32 s50, s50, s51
    s_lshl_b32 s50, s50, 1
    s_and_b32 s51, s2, 1
    s_add_u32 s50, s50, s51
    s_lshl_b32 s56, s49, 4
    s_add_u32 s56, s56, s50
    s_lshl_b32 s49, s49, 2
    s_add_u32 s49, s49, s39
    s_lshl_b32 s49, s49, 4
    s_add_u32 s49, s49, s50
    s_lshl_b32 s49, s49, 1
    s_add_u32 s49, s49, s40
    s_mul_i32 s49, s49, 1152
    s_lshl_b32 s50, s39, 4
    v_add_u32 v7, s50, v5
    s_mul_i32 s55, s3, 1184
    s_sub_u32 s51, s2, 254
    s_cmp_lt_u32 s51, 2
    s_cselect_b32 s50, s3, 0
    s_cmp_eq_u32 s50, 6
    s_waitcnt lgkmcnt(0)
    s_cbranch_scc0 f_nolead
    s_mul_i32 s50, s51, 12288
    s_add_u32 s50, s50, 131072
    buffer_store_dwordx4 v[68:71], v109, s[28:31], s50 offen offset:0 sc1
    buffer_store_dwordx4 v[68:71], v109, s[28:31], s50 offen offset:1024 sc1
    buffer_store_dwordx4 v[68:71], v109, s[28:31], s50 offen offset:2048 sc1
    buffer_store_dwordx4 v[68:71], v109, s[28:31], s50 offen offset:3072 sc1
    s_add_u32 s50, s50, 4096
    buffer_store_dwordx4 v[68:71], v109, s[28:31], s50 offen offset:0 sc1
    buffer_store_dwordx4 v[68:71], v109, s[28:31], s50 offen offset:1024 sc1
    buffer_store_dwordx4 v[68:71], v109, s[28:31], s50 offen offset:2048 sc1
    buffer_store_dwordx4 v[68:71], v109, s[28:31], s50 offen offset:3072 sc1
    s_add_u32 s50, s50, 4096
    buffer_store_dwordx4 v[68:71], v109, s[28:31], s50 offen offset:0 sc1
    buffer_store_dwordx4 v[68:71], v109, s[28:31], s50 offen offset:1024 sc1
    buffer_store_dwordx4 v[68:71], v109, s[28:31], s50 offen offset:2048 sc1
    buffer_store_dwordx4 v[68:71], v109, s[28:31], s50 offen offset:3072 sc1
    s_lshl_b32 s50, s51, 7
    s_memrealtime s[46:47]
    s_waitcnt vmcnt(0) lgkmcnt(0)
    s_or_b32 s46, s46, 1
    v_mov_b32 v4, s46
    s_mov_b64 exec, 1
    buffer_store_dword v4, off, s[24:27], s50 sc1
    s_mov_b64 exec, -1
f_nolead:
    s_cmp_eq_u32 s3, 7
    s_cbranch_scc0 f_noslot
    s_sub_u32 s50, s2, 118
    s_cmp_lt_u32 s50, 136
    s_cbranch_scc0 f_noslot
    s_mul_i32 s50, s2, 20480
    s_add_u32 s50, s50, 1777664
    buffer_store_dwordx4 v[68:71], v109, s[28:31], s50 offen offset:0 sc1
    buffer_store_dwordx4 v[68:71], v109, s[28:31], s50 offen offset:1024 sc1
    buffer_store_dwordx4 v[68:71], v109, s[28:31], s50 offen offset:2048 sc1
    buffer_store_dwordx4 v[68:71], v109, s[28:31], s50 offen offset:3072 sc1
    s_add_u32 s50, s50, 4096
    buffer_store_dwordx4 v[68:71], v109, s[28:31], s50 offen offset:0 sc1
    buffer_store_dwordx4 v[68:71], v109, s[28:31], s50 offen offset:1024 sc1
    buffer_store_dwordx4 v[68:71], v109, s[28:31], s50 offen offset:2048 sc1
    buffer_store_dwordx4 v[68:71], v109, s[28:31], s50 offen offset:3072 sc1
    s_add_u32 s50, s50, 4096
    buffer_store_dwordx4 v[68:71], v109, s[28:31], s50 offen offset:0 sc1
    buffer_store_dwordx4 v[68:71], v109, s[28:31], s50 offen offset:1024 sc1
    buffer_store_dwordx4 v[68:71], v109, s[28:31], s50 offen offset:2048 sc1
    buffer_store_dwordx4 v[68:71], v109, s[28:31], s50 offen offset:3072 sc1
    s_add_u32 s50, s50, 4096
    buffer_store_dwordx4 v[68:71], v109, s[28:31], s50 offen offset:0 sc1
    buffer_store_dwordx4 v[68:71], v109, s[28:31], s50 offen offset:1024 sc1
    buffer_store_dwordx4 v[68:71], v109, s[28:31], s50 offen offset:2048 sc1
    buffer_store_dwordx4 v[68:71], v109, s[28:31], s50 offen offset:3072 sc1
    s_add_u32 s50, s50, 4096
    buffer_store_dwordx4 v[68:71], v109, s[28:31], s50 offen offset:0 sc1
    buffer_store_dwordx4 v[68:71], v109, s[28:31], s50 offen offset:1024 sc1
    buffer_store_dwordx4 v[68:71], v109, s[28:31], s50 offen offset:2048 sc1
    buffer_store_dwordx4 v[68:71], v109, s[28:31], s50 offen offset:3072 sc1
f_noslot:
    s_cmp_lt_u32 s41, 162
    s_cbranch_scc0 f_nogemv1
    buffer_load_short_d16_hi v44, v2, s[16:19], s45 offen offset:0
    buffer_load_short_d16_hi v45, v2, s[16:19], s45 offen offset:128
    buffer_load_short_d16_hi v46, v2, s[16:19], s45 offen offset:256
    buffer_load_dwordx4 v[48:51], v3, s[20:23], s46 offen
    s_add_u32 s46, s46, 442368
    buffer_load_dwordx4 v[52:55], v3, s[20:23], s46 offen
    s_add_u32 s46, s46, 442368
    buffer_load_dwordx4 v[56:59], v3, s[20:23], s46 offen
    s_branch f_issue2
f_nogemv1:
    s_cmp_lt_u32 s2, 64
    s_cbranch_scc0 f_issue2
    s_lshl_b32 s50, s37, 2
    s_add_u32 s50, s50, s39
    s_lshl_b32 s50, s50, 3
    s_add_u32 s50, s50, s36
    s_mul_i32 s50, s50, 4624
    v_add_u32 v2, s50, v109
    v_add_u32 v3, 4096, v2
    s_mul_i32 s50, s3, 5120
    s_add_u32 m0, s50, 27904
    s_cmp_eq_u32 s40, 0
    s_cbranch_scc1 f_wt_re
    s_mov_b32 s8, s12
    s_mov_b32 s9, s13
f_wt_re:
    buffer_load_dwordx4 v2, s[8:11], 0 offen offset:0 lds
    buffer_load_dwordx4 v2, s[8:11], 0 offen offset:1024 lds
    buffer_load_dwordx4 v2, s[8:11], 0 offen offset:2048 lds
    buffer_load_dwordx4 v2, s[8:11], 0 offen offset:3072 lds
    s_add_u32 m0, m0, 4096
    s_mov_b32 exec_hi, 1
    buffer_load_dwordx4 v3, s[8:11], 0 offen lds
    s_mov_b64 exec, -1
f_issue2:
    s_add_u32 m0, s55, 73728
    s_nop 0
    buffer_load_dwordx4 v109, s[4:7], s49 offen lds
    s_mov_b64 exec, 0xff
    buffer_load_dwordx4 v109, s[4:7], s49 offen offset:1024 lds
    s_mov_b64 exec, -1
    v_cvt_f32_u32 v84, v7
    v_cvt_f32_u32 v85, v6
    v_mul_f32 v86, v85, v84
    v_mul_f32 v86, 0x3d800000, v86
    v_fmamk_f32 v72, v84, 0x00000000, v86
    v_cos_f32 v73, v72
    v_sin_f32 v74, v72
    v_fmamk_f32 v75, v84, 0x3c800000, v86
    v_cos_f32 v76, v75
    v_sin_f32 v77, v75
    v_cvt_pk_bf16_f32 v128, v73, v74
    v_cvt_pk_bf16_f32 v144, -v74, v73
    v_fmamk_f32 v72, v84, 0x3d000000, v86
    v_cos_f32 v73, v72
    v_sin_f32 v74, v72
    v_cvt_pk_bf16_f32 v129, v76, v77
    v_cvt_pk_bf16_f32 v145, -v77, v76
    v_fmamk_f32 v75, v84, 0x3d400000, v86
    v_cos_f32 v76, v75
    v_sin_f32 v77, v75
    v_cvt_pk_bf16_f32 v130, v73, v74
    v_cvt_pk_bf16_f32 v146, -v74, v73
    v_fmamk_f32 v72, v84, 0x3e800000, v86
    v_cos_f32 v73, v72
    v_sin_f32 v74, v72
    v_cvt_pk_bf16_f32 v131, v76, v77
    v_cvt_pk_bf16_f32 v147, -v77, v76
    v_fmamk_f32 v75, v84, 0x3e880000, v86
    v_cos_f32 v76, v75
    v_sin_f32 v77, v75
    v_cvt_pk_bf16_f32 v132, v73, v74
    v_cvt_pk_bf16_f32 v148, -v74, v73
    v_fmamk_f32 v72, v84, 0x3e900000, v86
    v_cos_f32 v73, v72
    v_sin_f32 v74, v72
    v_cvt_pk_bf16_f32 v133, v76, v77
    v_cvt_pk_bf16_f32 v149, -v77, v76
    v_fmamk_f32 v75, v84, 0x3e980000, v86
    v_cos_f32 v76, v75
    v_sin_f32 v77, v75
    v_cvt_pk_bf16_f32 v134, v73, v74
    v_cvt_pk_bf16_f32 v150, -v74, v73
    v_fmamk_f32 v72, v84, 0x3f000000, v86
    v_cos_f32 v73, v72
    v_sin_f32 v74, v72
    v_cvt_pk_bf16_f32 v135, v76, v77
    v_cvt_pk_bf16_f32 v151, -v77, v76
    v_fmamk_f32 v75, v84, 0x3f040000, v86
    v_cos_f32 v76, v75
    v_sin_f32 v77, v75
    v_cvt_pk_bf16_f32 v136, v73, v74
    v_cvt_pk_bf16_f32 v152, -v74, v73
    v_fmamk_f32 v72, v84, 0x3f080000, v86
    v_cos_f32 v73, v72
    v_sin_f32 v74, v72
    v_cvt_pk_bf16_f32 v137, v76, v77
    v_cvt_pk_bf16_f32 v153, -v77, v76
    v_fmamk_f32 v75, v84, 0x3f0c0000, v86
    v_cos_f32 v76, v75
    v_sin_f32 v77, v75
    v_cvt_pk_bf16_f32 v138, v73, v74
    v_cvt_pk_bf16_f32 v154, -v74, v73
    v_fmamk_f32 v72, v84, 0x3f400000, v86
    v_cos_f32 v73, v72
    v_sin_f32 v74, v72
    v_cvt_pk_bf16_f32 v139, v76, v77
    v_cvt_pk_bf16_f32 v155, -v77, v76
    v_fmamk_f32 v75, v84, 0x3f440000, v86
    v_cos_f32 v76, v75
    v_sin_f32 v77, v75
    v_cvt_pk_bf16_f32 v140, v73, v74
    v_cvt_pk_bf16_f32 v156, -v74, v73
    v_fmamk_f32 v72, v84, 0x3f480000, v86
    v_cos_f32 v73, v72
    v_sin_f32 v74, v72
    v_cvt_pk_bf16_f32 v141, v76, v77
    v_cvt_pk_bf16_f32 v157, -v77, v76
    v_fmamk_f32 v75, v84, 0x3f4c0000, v86
    v_cos_f32 v76, v75
    v_sin_f32 v77, v75
    v_cvt_pk_bf16_f32 v142, v73, v74
    v_cvt_pk_bf16_f32 v158, -v74, v73
    v_cvt_pk_bf16_f32 v143, v76, v77
    v_cvt_pk_bf16_f32 v159, -v77, v76
    v_mul_u32_u24 v118, 1152, v6
    v_lshl_add_u32 v118, v7, 1, v118
    s_lshl_b32 s52, s38, 1
    s_add_u32 s52, s52, s40
    s_mul_i32 s52, s52, 4608
    s_lshl_b32 s49, s38, 3
    s_add_u32 s49, s49, s3
    s_mul_i32 s49, s49, 1152
    v_mov_b32 v8, 0
    v_mov_b32 v9, 0
    v_mov_b32 v10, 0
    v_mov_b32 v11, 0
    v_mov_b32 v12, 0
    v_mov_b32 v13, 0
    v_mov_b32 v14, 0
    v_mov_b32 v15, 0
    v_mov_b32 v16, 0
    v_mov_b32 v18, 0
    v_mov_b32 v19, 0
    v_mov_b32 v20, 0
    v_mov_b32 v21, 0
    v_mov_b32 v22, 0
    v_mov_b32 v23, 0
    v_mov_b32 v24, 0
    v_mov_b32 v25, 0
    v_mov_b32 v26, 0
    v_lshlrev_b32 v2, 4, v0
    s_add_u32 s53, s38, 64
    s_lshl_b32 s50, s53, 13
    s_add_u32 s50, s50, 7340032
    buffer_store_dwordx4 v[68:71], v2, s[28:31], s50 offen sc1
    s_lshl_b32 s54, s36, 2
    s_add_u32 s54, s54, s37
    s_cmp_lt_u32 s2, 32
    s_cselect_b32 s54, s54, -1
    s_cmp_eq_u32 s2, 32
    s_cselect_b32 s54, 32, s54
    s_cmp_eq_u32 s40, 0
    s_cselect_b32 s42, s53, s54
    s_cmp_lt_u32 s2, 33
    s_cbranch_scc0 f_nozp2
    s_lshl_b32 s50, s54, 13
    s_add_u32 s50, s50, 7340032
    buffer_store_dwordx4 v[68:71], v2, s[28:31], s50 offen sc1
f_nozp2:
    s_cmp_eq_u32 s3, 6
    s_cbranch_scc0 f_nofl
    s_lshl_b32 s50, s2, 10
    s_add_u32 s50, s50, 262144
    buffer_store_dwordx4 v[18:21], v109, s[28:31], s50 offen sc1
f_nofl:
    v_cvt_f32_u32 v82, v1
    v_mul_f32 v73, 0x3ae38e39, v82
    v_mul_f32 v74, 0x3b638e39, v82
    v_mul_f32 v75, 0x3baaaaab, v82
    v_mul_f32 v76, 0x3be38e39, v82
    v_cos_f32 v208, v73
    v_sin_f32 v212, v73
    v_cos_f32 v209, v74
    v_sin_f32 v213, v74
    v_cos_f32 v210, v75
    v_sin_f32 v214, v75
    v_cos_f32 v211, v76
    v_sin_f32 v215, v76
    s_lshl_b32 s50, s40, 2
    s_add_u32 s50, s50, s39
    s_mul_i32 s50, s50, 272
    s_add_u32 s50, s50, 14848
    v_add_u32 v104, s50, v125
    v_mul_u32_u24 v2, 272, v5
    v_lshl_add_u32 v2, v6, 4, v2
    s_mul_i32 s50, s40, 8704
    s_add_u32 s51, s50, 14848
    v_add_u32 v105, s51, v2
    s_add_u32 s51, s50, 44288
    v_add_u32 v111, s51, v2
    v_mul_u32_u24 v2, 1088, v6
    v_lshl_add_u32 v2, v7, 2, v2
    v_add_u32 v110, s51, v2
    v_lshrrev_b32 v2, 1, v6
    v_lshl_add_u32 v2, v2, 6, v7
    v_and_b32 v3, 1, v6
    v_lshlrev_b32 v3, 4, v3
    v_lshl_add_u32 v2, v2, 5, v3
    s_lshl_b32 s50, s40, 13
    v_add_u32 v106, s50, v2
    v_add_u32 v107, 4096, v2
    v_cmp_lt_u32 vcc, 1, v6
    s_cmp_eq_u32 s40, 1
    s_cselect_b64 s[50:51], vcc, 0
    v_mov_b32 v3, 0x7f000000
    v_cndmask_b32 v106, v106, v3, s[50:51]
    s_mul_i32 s56, s56, 10240
    s_add_u32 s56, s56, 4194304
    v_lshrrev_b32 v2, 1, v5
    v_lshl_add_u32 v2, v6, 4, v2
    v_mul_u32_u24 v2, 10240, v2
    v_and_b32 v3, 1, v5
    v_lshl_add_u32 v108, v3, 4, v2
    v_lshlrev_b32 v2, 6, v7
    v_lshl_add_u32 v112, v6, 4, v2
    v_lshrrev_b32 v2, 1, v1
    s_and_b32 s50, s3, 1
    s_lshl_b32 s50, s50, 5
    v_add_u32 v2, s50, v2
    v_and_b32 v3, 1, v1
    s_lshr_b32 s51, s3, 1
    v_mul_u32_u24 v4, 5760, v3
    v_lshl_add_u32 v4, v2, 3, v4
    s_mul_i32 s50, s51, 576
    s_add_u32 s50, s50, 61696
    v_add_u32 v115, s50, v4
    v_lshlrev_b32 v3, 4, v3
    v_lshl_add_u32 v114, v2, 13, v3
    v_add_u32 v114, 2097152, v114
    v_sub_u32 v4, 64, v2
    v_min_u32 v4, v4, v2
    s_cmp_eq_u32 s51, 0
    s_cselect_b64 vcc, -1, 0
    v_cndmask_b32 v2, v2, v4, vcc
    s_lshl_b32 s51, s51, 19
    v_lshl_add_u32 v113, v2, 13, v3
    v_add_u32 v113, s51, v113
    v_lshrrev_b32 v2, 2, v5
    v_lshl_add_u32 v2, v6, 2, v2
    v_lshlrev_b32 v2, 3, v2
    s_mul_i32 s50, s40, 5760
    s_add_u32 s50, s50, 61696
    v_add_u32 v117, s50, v2
    v_and_b32 v2, 3, v1
    v_add_u32 v2, 1, v2
    v_mul_u32_u24 v2, 576, v2
    v_add_u32 v116, v2, v117
    s_lshl_b32 s50, s40, 7
    s_add_u32 s50, s50, 73216
    v_lshl_add_u32 v119, v6, 5, s50
    s_lshl_b32 s50, s39, 3
    v_add_u32 v120, s50, v119
    s_mov_b32 s50, 391680
    v_lshl_add_u32 v2, v6, 6, v7
    s_lshl_b32 s51, s40, 3
    s_add_u32 s51, s51, 61696
    v_lshl_add_u32 v121, v2, 4, s51
    v_mul_u32_u24 v3, 683, v0
    v_lshrrev_b32 v3, 16, v3
    v_mul_lo_u32 v3, v3, s50
    v_lshl_add_u32 v122, v0, 4, v3
    v_add_u32 v2, 256, v0
    v_mul_u32_u24 v3, 683, v2
    v_lshrrev_b32 v3, 16, v3
    v_mul_lo_u32 v3, v3, s50
    v_lshl_add_u32 v118, v2, 4, v3
    v_add_u32 v123, 1966592, v109
    v_lshlrev_b32 v124, 2, v7
    v_mul_u32_u24 v2, 1184, v6
    v_lshl_add_u32 v2, v7, 1, v2
    s_mul_i32 s50, s40, 4736
    s_add_u32 s50, s50, 83200
    v_add_u32 v127, s50, v2
    s_and_b32 s50, s2, 1
    s_mul_i32 s50, s50, 1152
    v_cmp_lt_u32 vcc, 431, v0
    v_mov_b32 v3, s50
    s_nop 0
    v_cndmask_b32 v3, 0, v3, vcc
    v_lshl_add_u32 v126, v0, 4, v3
    s_mul_i32 s57, s36, 4617
    s_lshr_b32 s57, s57, 10
    s_lshl_b32 s57, s57, 8
    v_mul_u32_u24 v2, 26, v1
    v_lshrrev_b32 v2, 8, v2
    v_mul_u32_u24 v2, 7936, v2
    v_lshl_add_u32 v17, v1, 7, v2
    s_cmp_lt_u32 s38, 64
    s_cbranch_scc0 f_noh2p
    s_mul_i32 s50, s38, 1536
    s_add_u32 s50, s50, 13631488
    buffer_store_dwordx4 v[68:71], v122, s[28:31], s50 offen sc1
    s_cmp_eq_u32 s3, 1
    s_cbranch_scc0 f_noh2p
    buffer_store_dwordx4 v[68:71], v123, s[28:31], s50 offen sc1
f_noh2p:
    s_cmp_lt_u32 s41, 162
    s_cbranch_scc0 f_other
    s_mov_b32 s47, 0xffff0000
    s_waitcnt vmcnt(6)
    v_mul_f32 v72, 0xbfb8aa3b, v44
    v_mul_f32 v73, 0xbfb8aa3b, v45
    v_mul_f32 v74, 0xbfb8aa3b, v46
    v_exp_f32 v72, v72
    v_exp_f32 v73, v73
    v_exp_f32 v74, v74
    v_add_f32 v72, 1.0, v72
    v_add_f32 v73, 1.0, v73
    v_add_f32 v74, 1.0, v74
    v_rcp_f32 v72, v72
    v_rcp_f32 v73, v73
    v_rcp_f32 v74, v74
    v_mul_f32 v44, v44, v72
    v_mul_f32 v45, v45, v73
    v_mul_f32 v46, v46, v74
    v_cvt_pk_bf16_f32 v72, v44, v45
    v_lshlrev_b32 v44, 16, v72
    v_and_b32 v45, s47, v72
    v_cvt_pk_bf16_f32 v46, v46, v46
    v_lshlrev_b32 v46, 16, v46
    s_waitcnt vmcnt(5)
    v_lshlrev_b32 v72, 16, v48
    v_and_b32 v73, s47, v48
    v_mul_f32 v60, v44, v72
    v_mul_f32 v61, v44, v73
    v_lshlrev_b32 v74, 16, v49
    v_and_b32 v75, s47, v49
    v_mul_f32 v62, v44, v74
    v_mul_f32 v63, v44, v75
    v_lshlrev_b32 v72, 16, v50
    v_and_b32 v73, s47, v50
    v_mul_f32 v64, v44, v72
    v_mul_f32 v65, v44, v73
    v_lshlrev_b32 v74, 16, v51
    v_and_b32 v75, s47, v51
    v_mul_f32 v66, v44, v74
    v_mul_f32 v67, v44, v75
    s_waitcnt vmcnt(4)
    v_lshlrev_b32 v72, 16, v52
    v_and_b32 v73, s47, v52
    v_fmac_f32 v60, v45, v72
    v_fmac_f32 v61, v45, v73
    v_lshlrev_b32 v74, 16, v53
    v_and_b32 v75, s47, v53
    v_fmac_f32 v62, v45, v74
    v_fmac_f32 v63, v45, v75
    v_lshlrev_b32 v72, 16, v54
    v_and_b32 v73, s47, v54
    v_fmac_f32 v64, v45, v72
    v_fmac_f32 v65, v45, v73
    v_lshlrev_b32 v74, 16, v55
    v_and_b32 v75, s47, v55
    v_fmac_f32 v66, v45, v74
    v_fmac_f32 v67, v45, v75
    s_waitcnt vmcnt(3)
    v_lshlrev_b32 v72, 16, v56
    v_and_b32 v73, s47, v56
    v_fmac_f32 v60, v46, v72
    v_fmac_f32 v61, v46, v73
    v_lshlrev_b32 v74, 16, v57
    v_and_b32 v75, s47, v57
    v_fmac_f32 v62, v46, v74
    v_fmac_f32 v63, v46, v75
    v_lshlrev_b32 v72, 16, v58
    v_and_b32 v73, s47, v58
    v_fmac_f32 v64, v46, v72
    v_fmac_f32 v65, v46, v73
    v_lshlrev_b32 v74, 16, v59
    v_and_b32 v75, s47, v59
    v_fmac_f32 v66, v46, v74
    v_fmac_f32 v67, v46, v75
    v_permlane16_swap_b32 v60, v61
    v_permlane16_swap_b32 v62, v63
    v_permlane16_swap_b32 v64, v65
    v_permlane16_swap_b32 v66, v67
    v_add_f32 v60, v60, v61
    v_add_f32 v62, v62, v63
    v_add_f32 v64, v64, v65
    v_add_f32 v66, v66, v67
    v_permlane32_swap_b32 v60, v62
    s_nop 0
    v_permlane32_swap_b32 v64, v66
    v_add_f32 v60, v60, v62
    v_add_f32 v64, v64, v66
    s_nop 0
    v_add_f32_dpp v60, v60, v60 row_ror:8 row_mask:0xf bank_mask:0xf
    v_add_f32_dpp v64, v64, v64 row_ror:8 row_mask:0xf bank_mask:0xf
    v_cmp_lt_u32 vcc, 7, v5
    s_nop 1
    v_cndmask_b32 v60, v60, v64, vcc
    v_and_b32 v2, 7, v5
    v_lshrrev_b32 v3, 3, v5
    v_lshl_add_u32 v2, v2, 1, v3
    v_lshl_add_u32 v2, v2, 2, v6
    s_lshl_b32 s50, s3, 8
    s_add_u32 s50, s50, 4608
    v_lshl_add_u32 v2, v2, 2, s50
    ds_write_b32 v2, v60
    s_cmp_eq_u32 s3, 7
    s_cbranch_scc0 f_nochka
    s_mov_b64 exec, 3
    v_lshlrev_b32 v2, 7, v1
    s_mov_b32 s50, 0
f_an2a:
    buffer_load_dword v3, v2, s[24:27], 0 offen sc1
    s_add_u32 s50, s50, 1
    s_waitcnt vmcnt(0)
    v_cmp_eq_u32 vcc, 0, v3
    s_nop 1
    s_cbranch_vccz f_an2a_ok
    s_sleep 2
    s_cmp_lt_u32 s50, 30000
    s_cbranch_scc1 f_an2a
f_an2a_ok:
    s_mov_b64 exec, -1
    s_sub_u32 s50, s2, 118
    s_cmp_lt_u32 s50, 136
    s_cbranch_scc0 f_nochka
    s_lshl_b32 s50, s50, 6
    s_add_u32 s50, s50, 144896
    s_mov_b64 exec, 1
    buffer_store_dword v1, off, s[28:31], s50 sc1
    s_mov_b64 exec, -1
f_nochka:
    s_waitcnt lgkmcnt(0)
    s_barrier
    s_cmp_eq_u32 s3, 7
    s_cbranch_scc0 f_nogemv2
    ds_read2st64_b32 v[60:61], v125 offset0:18 offset1:19
    ds_read2st64_b32 v[62:63], v125 offset0:20 offset1:21
    ds_read2st64_b32 v[64:65], v125 offset0:22 offset1:23
    ds_read2st64_b32 v[66:67], v125 offset0:24 offset1:25
    s_waitcnt lgkmcnt(0)
    v_pk_add_f32 v[60:61], v[60:61], v[62:63]
    v_pk_add_f32 v[64:65], v[64:65], v[66:67]
    v_pk_add_f32 v[60:61], v[60:61], v[64:65]
    v_add_f32 v60, v60, v61
    buffer_store_dword v60, v125, s[28:31], s48 offen sc1
    s_branch f_nogemv2
f_other:
    s_cmp_lt_u32 s2, 64
    s_cbranch_scc1 f_wt1
    s_waitcnt vmcnt(0)
    s_cmp_eq_u32 s3, 7
    s_cbranch_scc0 f_nochkb
    s_mov_b64 exec, 3
    v_lshlrev_b32 v2, 7, v1
    s_mov_b32 s50, 0
f_an2b:
    buffer_load_dword v3, v2, s[24:27], 0 offen sc1
    s_add_u32 s50, s50, 1
    s_waitcnt vmcnt(0)
    v_cmp_eq_u32 vcc, 0, v3
    s_nop 1
    s_cbranch_vccz f_an2b_ok
    s_sleep 2
    s_cmp_lt_u32 s50, 30000
    s_cbranch_scc1 f_an2b
f_an2b_ok:
    s_mov_b64 exec, -1
    s_sub_u32 s50, s2, 118
    s_cmp_lt_u32 s50, 136
    s_cbranch_scc0 f_nochkb
    s_lshl_b32 s50, s50, 6
    s_add_u32 s50, s50, 144896
    s_mov_b64 exec, 1
    buffer_store_dword v1, off, s[28:31], s50 sc1
    s_mov_b64 exec, -1
f_nochkb:
    s_branch f_ln
f_wt1:
    s_waitcnt vmcnt(3)
    s_barrier
f_wt2:
    v_and_b32 v3, 7, v0
    v_lshrrev_b32 v4, 3, v0
    v_mul_u32_u24 v2, 578, v3
    v_lshl_add_u32 v2, v4, 1, v2
    v_add_u32 v2, 27904, v2
    v_lshlrev_b32 v3, 4, v3
    v_lshl_add_u32 v3, v4, 13, v3
    s_lshr_b32 s50, s36, 1
    s_lshl_b32 s50, s50, 1
    s_lshr_b32 s51, s37, 2
    s_add_u32 s50, s50, s51
    s_lshl_b32 s50, s50, 2
    s_and_b32 s51, s37, 3
    s_add_u32 s50, s50, s51
    s_lshl_b32 s50, s50, 1
    s_and_b32 s51, s36, 1
    s_add_u32 s50, s50, s51
    s_lshl_b32 s50, s50, 7
    s_add_u32 s50, s50, 1048576
    ds_read_u16 v28, v2 offset:0
    ds_read_u16 v32, v2 offset:20480
    ds_read_u16 v29, v2 offset:5120
    ds_read_u16 v33, v2 offset:25600
    ds_read_u16 v30, v2 offset:10240
    ds_read_u16 v34, v2 offset:30720
    ds_read_u16 v31, v2 offset:15360
    ds_read_u16 v35, v2 offset:35840
    s_waitcnt vmcnt(1)
    ds_read_u16 v36, v2 offset:128
    ds_read_u16 v40, v2 offset:20608
    ds_read_u16 v37, v2 offset:5248
    ds_read_u16 v41, v2 offset:25728
    ds_read_u16 v38, v2 offset:10368
    ds_read_u16 v42, v2 offset:30848
    ds_read_u16 v39, v2 offset:15488
    ds_read_u16 v43, v2 offset:35968
    s_waitcnt lgkmcnt(8)
    v_lshl_or_b32 v52, v32, 16, v28
    v_lshl_or_b32 v53, v33, 16, v29
    v_lshl_or_b32 v54, v34, 16, v30
    v_lshl_or_b32 v55, v35, 16, v31
    buffer_store_dwordx4 v[52:55], v3, s[28:31], s50 offen sc1
    s_add_u32 s50, s50, 524288
    ds_read_u16 v44, v2 offset:256
    ds_read_u16 v48, v2 offset:20736
    ds_read_u16 v45, v2 offset:5376
    ds_read_u16 v49, v2 offset:25856
    ds_read_u16 v46, v2 offset:10496
    ds_read_u16 v50, v2 offset:30976
    ds_read_u16 v47, v2 offset:15616
    ds_read_u16 v51, v2 offset:36096
    s_waitcnt lgkmcnt(8)
    v_lshl_or_b32 v56, v40, 16, v36
    v_lshl_or_b32 v57, v41, 16, v37
    v_lshl_or_b32 v58, v42, 16, v38
    v_lshl_or_b32 v59, v43, 16, v39
    buffer_store_dwordx4 v[56:59], v3, s[28:31], s50 offen sc1
    s_add_u32 s50, s50, 524288
    ds_read_u16 v28, v2 offset:384
    ds_read_u16 v32, v2 offset:20864
    ds_read_u16 v29, v2 offset:5504
    ds_read_u16 v33, v2 offset:25984
    ds_read_u16 v30, v2 offset:10624
    ds_read_u16 v34, v2 offset:31104
    ds_read_u16 v31, v2 offset:15744
    ds_read_u16 v35, v2 offset:36224
    s_waitcnt lgkmcnt(8)
    v_lshl_or_b32 v52, v48, 16, v44
    v_lshl_or_b32 v53, v49, 16, v45
    v_lshl_or_b32 v54, v50, 16, v46
    v_lshl_or_b32 v55, v51, 16, v47
    buffer_store_dwordx4 v[52:55], v3, s[28:31], s50 offen sc1
    s_add_u32 s50, s50, 524288
    ds_read_u16 v36, v2 offset:512
    ds_read_u16 v40, v2 offset:20992
    ds_read_u16 v37, v2 offset:5632
    ds_read_u16 v41, v2 offset:26112
    ds_read_u16 v38, v2 offset:10752
    ds_read_u16 v42, v2 offset:31232
    ds_read_u16 v39, v2 offset:15872
    ds_read_u16 v43, v2 offset:36352
    s_waitcnt lgkmcnt(8)
    v_lshl_or_b32 v56, v32, 16, v28
    v_lshl_or_b32 v57, v33, 16, v29
    v_lshl_or_b32 v58, v34, 16, v30
    v_lshl_or_b32 v59, v35, 16, v31
    buffer_store_dwordx4 v[56:59], v3, s[28:31], s50 offen sc1
    s_add_u32 s50, s50, 524288
    s_waitcnt lgkmcnt(0)
    v_lshl_or_b32 v52, v40, 16, v36
    v_lshl_or_b32 v53, v41, 16, v37
    v_lshl_or_b32 v54, v42, 16, v38
    v_lshl_or_b32 v55, v43, 16, v39
    v_cmp_gt_u32 vcc, 33, v4
    v_mov_b32 v4, 0x7f000000
    s_nop 0
    v_cndmask_b32 v3, v4, v3, vcc
    buffer_store_dwordx4 v[52:55], v3, s[28:31], s50 offen sc1
    s_branch f_ln
f_nogemv2:
    s_waitcnt vmcnt(1)
f_ln:
    v_lshlrev_b32 v2, 1, v1
    s_add_u32 s50, s55, 73728
    v_add_u32 v2, s50, v2
    ds_read_u16_d16_hi v8, v2 offset:0
    ds_read_u16_d16_hi v9, v2 offset:128
    ds_read_u16_d16_hi v10, v2 offset:256
    ds_read_u16_d16_hi v11, v2 offset:384
    ds_read_u16_d16_hi v12, v2 offset:512
    ds_read_u16_d16_hi v13, v2 offset:640
    ds_read_u16_d16_hi v14, v2 offset:768
    ds_read_u16_d16_hi v15, v2 offset:896
    ds_read_u16_d16_hi v16, v2 offset:1024
    s_waitcnt lgkmcnt(0)
    v_add_f32 v80, v8, v9
    v_add_f32 v80, v80, v10
    v_add_f32 v80, v80, v11
    v_add_f32 v80, v80, v12
    v_add_f32 v80, v80, v13
    v_add_f32 v80, v80, v14
    v_add_f32 v80, v80, v15
    v_add_f32 v80, v80, v16
    s_nop 1
    v_add_f32_dpp v80, v80, v80 quad_perm:[1,0,3,2] row_mask:0xf bank_mask:0xf
    s_nop 1
    v_add_f32_dpp v80, v80, v80 quad_perm:[2,3,0,1] row_mask:0xf bank_mask:0xf
    s_nop 1
    v_add_f32_dpp v80, v80, v80 row_half_mirror row_mask:0xf bank_mask:0xf
    s_nop 1
    v_add_f32_dpp v80, v80, v80 row_mirror row_mask:0xf bank_mask:0xf
    v_mov_b32 v72, v80
    s_nop 1
    v_permlane16_swap_b32 v80, v72
    v_add_f32 v80, v80, v72
    v_mov_b32 v72, v80
    s_nop 1
    v_permlane32_swap_b32 v80, v72
    v_add_f32 v80, v80, v72
    v_mul_f32 v80, 0x3ae38e39, v80
    v_sub_f32 v8, v8, v80
    v_sub_f32 v9, v9, v80
    v_sub_f32 v10, v10, v80
    v_sub_f32 v11, v11, v80
    v_sub_f32 v12, v12, v80
    v_sub_f32 v13, v13, v80
    v_sub_f32 v14, v14, v80
    v_sub_f32 v15, v15, v80
    v_sub_f32 v16, v16, v80
    v_mul_f32 v81, v8, v8
    v_fmac_f32 v81, v9, v9
    v_fmac_f32 v81, v10, v10
    v_fmac_f32 v81, v11, v11
    v_fmac_f32 v81, v12, v12
    v_fmac_f32 v81, v13, v13
    v_fmac_f32 v81, v14, v14
    v_fmac_f32 v81, v15, v15
    v_fmac_f32 v81, v16, v16
    s_nop 1
    v_add_f32_dpp v81, v81, v81 quad_perm:[1,0,3,2] row_mask:0xf bank_mask:0xf
    s_nop 1
    v_add_f32_dpp v81, v81, v81 quad_perm:[2,3,0,1] row_mask:0xf bank_mask:0xf
    s_nop 1
    v_add_f32_dpp v81, v81, v81 row_half_mirror row_mask:0xf bank_mask:0xf
    s_nop 1
    v_add_f32_dpp v81, v81, v81 row_mirror row_mask:0xf bank_mask:0xf
    v_mov_b32 v72, v81
    s_nop 1
    v_permlane16_swap_b32 v81, v72
    v_add_f32 v81, v81, v72
    v_mov_b32 v72, v81
    s_nop 1
    v_permlane32_swap_b32 v81, v72
    v_add_f32 v81, v81, v72
    v_mov_b32 v72, 0x3727c5ac
    v_fmamk_f32 v81, v81, 0x3ae38e39, v72
    v_rsq_f32 v81, v81
    s_nop 0
    v_mul_f32 v8, v8, v81
    v_mul_f32 v9, v9, v81
    v_mul_f32 v10, v10, v81
    v_mul_f32 v11, v11, v81
    v_mul_f32 v12, v12, v81
    v_mul_f32 v13, v13, v81
    v_mul_f32 v14, v14, v81
    v_mul_f32 v15, v15, v81
    v_mul_f32 v16, v16, v81
    v_cvt_f32_u32 v84, v7
    v_cvt_f32_u32 v85, v6
    v_mul_f32 v86, v85, v84
    v_mul_f32 v86, 0x3d800000, v86
    v_mul_f32 v86, 0x3d000000, v86
    v_fmamk_f32 v72, v84, 0x00000000, v86
    v_fmamk_f32 v73, v84, 0x3a000000, v86
    v_fmamk_f32 v74, v84, 0x3a800000, v86
    v_fmamk_f32 v75, v84, 0x3ac00000, v86
    v_cos_f32 v192, v72
    v_sin_f32 v200, v72
    v_cos_f32 v193, v73
    v_sin_f32 v201, v73
    v_cos_f32 v194, v74
    v_sin_f32 v202, v74
    v_cos_f32 v195, v75
    v_sin_f32 v203, v75
    v_fmamk_f32 v72, v84, 0x3c000000, v86
    v_fmamk_f32 v73, v84, 0x3c080000, v86
    v_fmamk_f32 v74, v84, 0x3c100000, v86
    v_fmamk_f32 v75, v84, 0x3c180000, v86
    v_cos_f32 v196, v72
    v_sin_f32 v204, v72
    v_cos_f32 v197, v73
    v_sin_f32 v205, v73
    v_cos_f32 v198, v74
    v_sin_f32 v206, v74
    v_cos_f32 v199, v75
    v_sin_f32 v207, v75
    v_add_u32 v84, 0, v5
    v_cvt_f32_u32 v84, v84
    v_mul_f32 v86, v85, v84
    v_mul_f32 v86, 0x3e000000, v86
    v_fmamk_f32 v72, v84, 0x00000000, v86
    v_fmamk_f32 v73, v84, 0x3d000000, v86
    v_fmamk_f32 v74, v84, 0x3d800000, v86
    v_fmamk_f32 v75, v84, 0x3dc00000, v86
    v_cos_f32 v76, v72
    v_sin_f32 v80, v72
    v_cos_f32 v77, v73
    v_sin_f32 v81, v73
    v_cos_f32 v78, v74
    v_sin_f32 v82, v74
    v_cos_f32 v79, v75
    v_sin_f32 v83, v75
    v_cvt_pk_bf16_f32 v160, v76, v77
    v_cvt_pk_bf16_f32 v161, v78, v79
    v_cvt_pk_bf16_f32 v178, v76, v77
    v_cvt_pk_bf16_f32 v179, v78, v79
    v_cvt_pk_bf16_f32 v162, v80, v81
    v_cvt_pk_bf16_f32 v163, v82, v83
    v_cvt_pk_bf16_f32 v176, -v80, -v81
    v_cvt_pk_bf16_f32 v177, -v82, -v83
    v_fmamk_f32 v72, v84, 0x3f000000, v86
    v_fmamk_f32 v73, v84, 0x3f080000, v86
    v_fmamk_f32 v74, v84, 0x3f100000, v86
    v_fmamk_f32 v75, v84, 0x3f180000, v86
    v_cos_f32 v76, v72
    v_sin_f32 v80, v72
    v_cos_f32 v77, v73
    v_sin_f32 v81, v73
    v_cos_f32 v78, v74
    v_sin_f32 v82, v74
    v_cos_f32 v79, v75
    v_sin_f32 v83, v75
    v_cvt_pk_bf16_f32 v164, v76, v77
    v_cvt_pk_bf16_f32 v165, v78, v79
    v_cvt_pk_bf16_f32 v182, v76, v77
    v_cvt_pk_bf16_f32 v183, v78, v79
    v_cvt_pk_bf16_f32 v166, v80, v81
    v_cvt_pk_bf16_f32 v167, v82, v83
    v_cvt_pk_bf16_f32 v180, -v80, -v81
    v_cvt_pk_bf16_f32 v181, -v82, -v83
    v_add_u32 v84, 16, v5
    v_cvt_f32_u32 v84, v84
    v_mul_f32 v86, v85, v84
    v_mul_f32 v86, 0x3e000000, v86
    v_fmamk_f32 v72, v84, 0x00000000, v86
    v_fmamk_f32 v73, v84, 0x3d000000, v86
    v_fmamk_f32 v74, v84, 0x3d800000, v86
    v_fmamk_f32 v75, v84, 0x3dc00000, v86
    v_cos_f32 v76, v72
    v_sin_f32 v80, v72
    v_cos_f32 v77, v73
    v_sin_f32 v81, v73
    v_cos_f32 v78, v74
    v_sin_f32 v82, v74
    v_cos_f32 v79, v75
    v_sin_f32 v83, v75
    v_cvt_pk_bf16_f32 v168, v76, v77
    v_cvt_pk_bf16_f32 v169, v78, v79
    v_cvt_pk_bf16_f32 v186, v76, v77
    v_cvt_pk_bf16_f32 v187, v78, v79
    v_cvt_pk_bf16_f32 v170, v80, v81
    v_cvt_pk_bf16_f32 v171, v82, v83
    v_cvt_pk_bf16_f32 v184, -v80, -v81
    v_cvt_pk_bf16_f32 v185, -v82, -v83
    v_fmamk_f32 v72, v84, 0x3f000000, v86
    v_fmamk_f32 v73, v84, 0x3f080000, v86
    v_fmamk_f32 v74, v84, 0x3f100000, v86
    v_fmamk_f32 v75, v84, 0x3f180000, v86
    v_cos_f32 v76, v72
    v_sin_f32 v80, v72
    v_cos_f32 v77, v73
    v_sin_f32 v81, v73
    v_cos_f32 v78, v74
    v_sin_f32 v82, v74
    v_cos_f32 v79, v75
    v_sin_f32 v83, v75
    v_cvt_pk_bf16_f32 v172, v76, v77
    v_cvt_pk_bf16_f32 v173, v78, v79
    v_cvt_pk_bf16_f32 v190, v76, v77
    v_cvt_pk_bf16_f32 v191, v78, v79
    v_cvt_pk_bf16_f32 v174, v80, v81
    v_cvt_pk_bf16_f32 v175, v82, v83
    v_cvt_pk_bf16_f32 v188, -v80, -v81
    v_cvt_pk_bf16_f32 v189, -v82, -v83
    s_cmp_lt_u32 s3, 3
    s_cbranch_scc1 f_stage
    v_cvt_f32_u32 v84, v7
    v_cvt_f32_u32 v85, v6
    v_mul_f32 v85, v85, v84
    v_mul_f32 v85, 0x3d800000, v85
    v_fmamk_f32 v72, v84, 0x00000000, v85
    v_fmamk_f32 v73, v84, 0x3c800000, v85
    v_fmamk_f32 v74, v84, 0x3d000000, v85
    v_fmamk_f32 v75, v84, 0x3d400000, v85
    v_cos_f32 v76, v72
    v_sin_f32 v80, v72
    v_cos_f32 v77, v73
    v_sin_f32 v81, v73
    v_cos_f32 v78, v74
    v_sin_f32 v82, v74
    v_cos_f32 v79, v75
    v_sin_f32 v83, v75
    v_cvt_pk_bf16_f32 v216, v76, v77
    v_cvt_pk_bf16_f32 v217, v78, v79
    v_cvt_pk_bf16_f32 v234, -v76, -v77
    v_cvt_pk_bf16_f32 v235, -v78, -v79
    v_cvt_pk_bf16_f32 v218, v80, v81
    v_cvt_pk_bf16_f32 v219, v82, v83
    v_cvt_pk_bf16_f32 v232, v80, v81
    v_cvt_pk_bf16_f32 v233, v82, v83
    v_fmamk_f32 v72, v84, 0x3e800000, v85
    v_fmamk_f32 v73, v84, 0x3e880000, v85
    v_fmamk_f32 v74, v84, 0x3e900000, v85
    v_fmamk_f32 v75, v84, 0x3e980000, v85
    v_cos_f32 v76, v72
    v_sin_f32 v80, v72
    v_cos_f32 v77, v73
    v_sin_f32 v81, v73
    v_cos_f32 v78, v74
    v_sin_f32 v82, v74
    v_cos_f32 v79, v75
    v_sin_f32 v83, v75
    v_cvt_pk_bf16_f32 v220, v76, v77
    v_cvt_pk_bf16_f32 v221, v78, v79
    v_cvt_pk_bf16_f32 v238, -v76, -v77
    v_cvt_pk_bf16_f32 v239, -v78, -v79
    v_cvt_pk_bf16_f32 v222, v80, v81
    v_cvt_pk_bf16_f32 v223, v82, v83
    v_cvt_pk_bf16_f32 v236, v80, v81
    v_cvt_pk_bf16_f32 v237, v82, v83
    v_fmamk_f32 v72, v84, 0x3f000000, v85
    v_fmamk_f32 v73, v84, 0x3f040000, v85
    v_fmamk_f32 v74, v84, 0x3f080000, v85
    v_fmamk_f32 v75, v84, 0x3f0c0000, v85
    v_cos_f32 v76, v72
    v_sin_f32 v80, v72
    v_cos_f32 v77, v73
    v_sin_f32 v81, v73
    v_cos_f32 v78, v74
    v_sin_f32 v82, v74
    v_cos_f32 v79, v75
    v_sin_f32 v83, v75
    v_cvt_pk_bf16_f32 v224, v76, v77
    v_cvt_pk_bf16_f32 v225, v78, v79
    v_cvt_pk_bf16_f32 v242, v76, v77
    v_cvt_pk_bf16_f32 v243, v78, v79
    v_cvt_pk_bf16_f32 v226, -v80, -v81
    v_cvt_pk_bf16_f32 v227, -v82, -v83
    v_cvt_pk_bf16_f32 v240, v80, v81
    v_cvt_pk_bf16_f32 v241, v82, v83
    v_fmamk_f32 v72, v84, 0x3f400000, v85
    v_fmamk_f32 v73, v84, 0x3f440000, v85
    v_fmamk_f32 v74, v84, 0x3f480000, v85
    v_fmamk_f32 v75, v84, 0x3f4c0000, v85
    v_cos_f32 v76, v72
    v_sin_f32 v80, v72
    v_cos_f32 v77, v73
    v_sin_f32 v81, v73
    v_cos_f32 v78, v74
    v_sin_f32 v82, v74
    v_cos_f32 v79, v75
    v_sin_f32 v83, v75
    v_cvt_pk_bf16_f32 v228, v76, v77
    v_cvt_pk_bf16_f32 v229, v78, v79
    v_cvt_pk_bf16_f32 v246, v76, v77
    v_cvt_pk_bf16_f32 v247, v78, v79
    v_cvt_pk_bf16_f32 v230, -v80, -v81
    v_cvt_pk_bf16_f32 v231, -v82, -v83
    v_cvt_pk_bf16_f32 v244, v80, v81
    v_cvt_pk_bf16_f32 v245, v82, v83
    v_mul_f32 v73, 0x3ae38e39, v84
    v_mul_f32 v74, 0x3b638e39, v84
    v_mul_f32 v75, 0x3baaaaab, v84
    v_mul_f32 v76, 0x3be38e39, v84
    v_cos_f32 v248, v73
    v_sin_f32 v252, v73
    v_cos_f32 v249, v74
    v_sin_f32 v253, v74
    v_cos_f32 v250, v75
    v_sin_f32 v254, v75
    v_cos_f32 v251, v76
    v_sin_f32 v255, v76
    v_mul_f32 v248, 0x35e38e39, v248
    v_mul_f32 v249, 0x35e38e39, v249
    v_mul_f32 v250, 0x35e38e39, v250
    v_mul_f32 v251, 0x35e38e39, v251
    v_mul_f32 v252, 0x35e38e39, v252
    v_mul_f32 v253, 0x35e38e39, v253
    v_mul_f32 v254, 0x35e38e39, v254
    v_mul_f32 v255, 0x35e38e39, v255
    s_cmp_eq_u32 s3, 3
    s_cbranch_scc0 f_nofp
    s_cmp_ge_u32 s2, 226
    s_cbranch_scc0 f_nosl3
    s_sleep 20
f_nosl3:
    s_mov_b64 exec, 3
    v_lshlrev_b32 v2, 7, v1
    s_mov_b32 s50, 0
f_an4:
    buffer_load_dword v3, v2, s[24:27], 0 offen sc1
    s_add_u32 s50, s50, 1
    s_waitcnt vmcnt(0)
    v_cmp_eq_u32 vcc, 0, v3
    s_nop 1
    s_cbranch_vccz f_an4_ok
    s_sleep 2
    s_cmp_lt_u32 s50, 30000
    s_cbranch_scc1 f_an4
f_an4_ok:
    v_readfirstlane_b32 s26, v3
    s_mov_b64 exec, -1
    v_lshlrev_b32 v2, 6, v1
    v_min_u32 v3, 448, v2
    s_mov_b32 s51, 144896
    s_mov_b32 s47, 148992
    s_mov_b32 s46, 153088
    s_mov_b32 s50, 0
f_pf:
    buffer_load_dword v48, v2, s[28:31], s51 offen sc1
    buffer_load_dword v49, v2, s[28:31], s47 offen sc1
    buffer_load_dword v50, v3, s[28:31], s46 offen sc1
    s_add_u32 s50, s50, 1
    s_waitcnt vmcnt(0)
    v_max3_u32 v51, v48, v49, v50
    v_cmp_eq_u32 vcc, -1, v51
    s_nop 0
    s_and_b64 exec, vcc, vcc
    s_cbranch_scc0 f_pf_ok
    s_cmp_lt_u32 s50, 30000
    s_cbranch_scc1 f_pf
f_pf_ok:
    s_mov_b64 exec, -1
f_nofp:
    s_branch f_staged
f_stage:
    s_waitcnt vmcnt(0)
    s_cmp_ge_u32 s2, 226
    s_cbranch_scc0 f_nosl0
    s_sleep 20
f_nosl0:
    s_mov_b64 exec, 3
    v_lshlrev_b32 v2, 7, v1
    s_mov_b32 s50, 0
f_an3:
    buffer_load_dword v3, v2, s[24:27], 0 offen sc1
    s_add_u32 s50, s50, 1
    s_waitcnt vmcnt(0)
    v_cmp_eq_u32 vcc, 0, v3
    s_nop 1
    s_cbranch_vccz f_an3_ok
    s_sleep 2
    s_cmp_lt_u32 s50, 30000
    s_cbranch_scc1 f_an3
f_an3_ok:
    v_readfirstlane_b32 s26, v3
    s_mov_b64 exec, -1
    v_mul_u32_u24 v2, 24, v0
    s_mov_b32 s44, 0x20000
    s_mov_b32 s45, 0x21200
    s_mov_b32 s46, 0x22400
    v_cmp_lt_u32 vcc, 95, v0
    s_nop 1
    v_cndmask_b32 v3, 0, 1.0, vcc
    s_mov_b32 s47, 0xffff0000
    s_mov_b32 s50, 0
f_mp:
    buffer_load_dwordx4 v[84:87], v2, s[28:31], s44 offen sc1
    buffer_load_dwordx2 v[88:89], v2, s[28:31], s44 offen offset:16 sc1
    buffer_load_dwordx4 v[90:93], v2, s[28:31], s45 offen sc1
    buffer_load_dwordx2 v[94:95], v2, s[28:31], s45 offen offset:16 sc1
    buffer_load_dwordx4 v[96:99], v2, s[28:31], s46 offen sc1
    buffer_load_dwordx2 v[100:101], v2, s[28:31], s46 offen offset:16 sc1
    s_add_u32 s50, s50, 1
    s_waitcnt vmcnt(0)
    v_max3_u32 v72, v84, v85, v86
    v_max3_u32 v72, v72, v87, v88
    v_max3_u32 v72, v72, v89, v90
    v_max3_u32 v72, v72, v91, v92
    v_max3_u32 v72, v72, v93, v94
    v_max3_u32 v72, v72, v95, v96
    v_max3_u32 v72, v72, v97, v98
    v_max3_u32 v72, v72, v99, v100
    v_max_u32 v72, v72, v101
    v_cmp_eq_u32 vcc, -1, v72
    s_nop 0
    s_and_b64 exec, vcc, vcc
    s_cbranch_scc0 f_mp_ok
    s_cmp_lt_u32 s50, 30000
    s_cbranch_scc1 f_mp
f_mp_ok:
    s_mov_b64 exec, -1
    v_pk_add_f32 v[84:85], v[84:85], v[90:91]
    v_pk_add_f32 v[86:87], v[86:87], v[92:93]
    v_pk_add_f32 v[88:89], v[88:89], v[94:95]
    v_pk_add_f32 v[84:85], v[84:85], v[96:97]
    v_pk_add_f32 v[86:87], v[86:87], v[98:99]
    v_pk_add_f32 v[88:89], v[88:89], v[100:101]
    v_cvt_pk_bf16_f32 v72, v84, v85
    v_lshlrev_b32 v84, 16, v72
    v_and_b32 v85, s47, v72
    v_cvt_pk_bf16_f32 v73, v86, v87
    v_lshlrev_b32 v86, 16, v73
    v_and_b32 v87, s47, v73
    v_cvt_pk_bf16_f32 v72, v88, v89
    v_lshlrev_b32 v88, 16, v72
    v_and_b32 v89, s47, v72
    v_add_f32 v84, v84, v3
    v_add_f32 v85, v85, v3
    v_add_f32 v86, v86, v3
    v_add_f32 v87, v87, v3
    v_add_f32 v88, v88, v3
    v_add_f32 v89, v89, v3
    v_cvt_pk_bf16_f32 v72, v84, v85
    v_lshlrev_b32 v84, 16, v72
    v_and_b32 v85, s47, v72
    v_cvt_pk_bf16_f32 v73, v86, v87
    v_lshlrev_b32 v86, 16, v73
    v_and_b32 v87, s47, v73
    v_cvt_pk_bf16_f32 v72, v88, v89
    v_lshlrev_b32 v88, 16, v72
    v_and_b32 v89, s47, v72
    ds_write_b64 v2, v[84:85] offset:0
    ds_write_b64 v2, v[86:87] offset:8
    ds_write_b64 v2, v[88:89] offset:16
f_staged:
    s_load_dwordx2 s[8:9], s[0:1], 48
    s_mov_b32 s10, 0x1200000
    s_load_dwordx2 s[12:13], s[0:1], 56
    s_mov_b32 s14, 0x1000
    s_load_dwordx2 s[16:17], s[0:1], 80
    s_mov_b32 s18, 0x240000
    s_load_dwordx2 s[20:21], s[0:1], 40
    s_mov_b32 s22, 0x2400
    s_waitcnt lgkmcnt(0)
    s_barrier
    ds_read2st64_b32 v[36:37], v125 offset0:8 offset1:9
    ds_read2st64_b32 v[38:39], v125 offset0:10 offset1:11
    ds_read2st64_b32 v[40:41], v125 offset0:12 offset1:13
    ds_read2st64_b32 v[42:43], v125 offset0:14 offset1:15
    ds_read2st64_b32 v[44:45], v125 offset0:16 offset1:17
    ds_read2st64_b32 v[28:29], v125 offset0:0 offset1:1
    ds_read2st64_b32 v[30:31], v125 offset0:2 offset1:3
    ds_read2st64_b32 v[32:33], v125 offset0:4 offset1:5
    ds_read2st64_b32 v[34:35], v125 offset0:6 offset1:7
    s_waitcnt lgkmcnt(3)
    v_fma_f32 v8, v8, v37, v28
    v_fma_f32 v9, v9, v38, v29
    s_waitcnt lgkmcnt(2)
    v_fma_f32 v10, v10, v39, v30
    v_fma_f32 v11, v11, v40, v31
    s_waitcnt lgkmcnt(1)
    v_fma_f32 v12, v12, v41, v32
    v_fma_f32 v13, v13, v42, v33
    s_waitcnt lgkmcnt(0)
    v_fma_f32 v14, v14, v43, v34
    v_fma_f32 v15, v15, v44, v35
    v_fma_f32 v16, v16, v45, v36
    v_add_f32 v48, v9, v16
    v_sub_f32 v52, v9, v16
    v_add_f32 v49, v10, v15
    v_sub_f32 v53, v10, v15
    v_add_f32 v50, v11, v14
    v_sub_f32 v54, v11, v14
    v_add_f32 v51, v12, v13
    v_sub_f32 v55, v12, v13
    v_add_f32 v64, v8, v48
    v_add_f32 v65, v49, v50
    v_add_f32 v64, v64, v51
    v_add_f32 v64, v64, v65
    v_fmamk_f32 v56, v48, 0x3f441b7d, v8
    v_fmamk_f32 v57, v48, 0x3e31d0d4, v8
    v_fmamk_f32 v58, v48, 0xbf000000, v8
    v_fmamk_f32 v59, v48, 0xbf708fb2, v8
    v_fmamk_f32 v56, v49, 0x3e31d0d4, v56
    v_fmamk_f32 v57, v49, 0xbf708fb2, v57
    v_fmamk_f32 v58, v49, 0xbf000000, v58
    v_fmamk_f32 v59, v49, 0x3f441b7d, v59
    v_fmamk_f32 v56, v50, 0xbf000000, v56
    v_fmamk_f32 v57, v50, 0xbf000000, v57
    v_fmamk_f32 v58, v50, 0x3f800000, v58
    v_fmamk_f32 v59, v50, 0xbf000000, v59
    v_fmamk_f32 v56, v51, 0xbf708fb2, v56
    v_fmamk_f32 v57, v51, 0x3f441b7d, v57
    v_fmamk_f32 v58, v51, 0xbf000000, v58
    v_fmamk_f32 v59, v51, 0x3e31d0d4, v59
    v_mul_f32 v60, 0xbf248dbb, v52
    v_mul_f32 v61, 0xbf7c1c5c, v52
    v_mul_f32 v62, 0xbf5db3d7, v52
    v_mul_f32 v63, 0xbeaf1d44, v52
    v_fmamk_f32 v60, v53, 0xbf7c1c5c, v60
    v_fmamk_f32 v61, v53, 0xbeaf1d44, v61
    v_fmamk_f32 v62, v53, 0x3f5db3d7, v62
    v_fmamk_f32 v63, v53, 0x3f248dbb, v63
    v_fmamk_f32 v60, v54, 0xbf5db3d7, v60
    v_fmamk_f32 v61, v54, 0x3f5db3d7, v61
    v_fmamk_f32 v63, v54, 0xbf5db3d7, v63
    v_fmamk_f32 v60, v55, 0xbeaf1d44, v60
    v_fmamk_f32 v61, v55, 0x3f248dbb, v61
    v_fmamk_f32 v62, v55, 0xbf5db3d7, v62
    v_fmamk_f32 v63, v55, 0x3f7c1c5c, v63
    v_cvt_pk_bf16_f32 v64, v64, 0
    ds_write_b32 v104, v64
    v_pk_mul_f32 v[68:69], v[56:57], v[208:209]
    v_pk_mul_f32 v[72:73], v[60:61], v[208:209]
    v_pk_mul_f32 v[70:71], v[58:59], v[210:211]
    v_pk_mul_f32 v[74:75], v[62:63], v[210:211]
    v_pk_fma_f32 v[68:69], v[60:61], v[212:213], v[68:69]
    v_pk_fma_f32 v[72:73], v[56:57], v[212:213], v[72:73] neg_lo:[1,0,0] neg_hi:[1,0,0]
    v_pk_fma_f32 v[70:71], v[62:63], v[214:215], v[70:71]
    v_pk_fma_f32 v[74:75], v[58:59], v[214:215], v[74:75] neg_lo:[1,0,0] neg_hi:[1,0,0]
    v_cvt_pk_bf16_f32 v9, v68, v72
    ds_write_b32 v104, v9 offset:2176
    v_cvt_pk_bf16_f32 v10, v69, v73
    ds_write_b32 v104, v10 offset:4352
    v_cvt_pk_bf16_f32 v11, v70, v74
    ds_write_b32 v104, v11 offset:6528
    v_cvt_pk_bf16_f32 v12, v71, v75
    ds_write_b32 v104, v12 offset:8704
    s_cmp_lt_u32 s39, 2
    s_cselect_b32 s47, 0, 0x80000000
    s_waitcnt vmcnt(0) lgkmcnt(0)
    s_barrier
    ds_read_b128 v[28:31], v105 offset:0
    ds_read_b128 v[32:35], v105 offset:64
    ds_read_b128 v[36:39], v105 offset:128
    ds_read_b128 v[40:43], v105 offset:192
    s_cmp_eq_u32 s40, 1
    s_cbranch_scc1 f_p1_one
    ds_read_b128 v[44:47], v105 offset:4352
    ds_read_b128 v[48:51], v105 offset:4416
    ds_read_b128 v[52:55], v105 offset:4480
    ds_read_b128 v[56:59], v105 offset:4544
    s_waitcnt lgkmcnt(7)
    v_mfma_f32_16x16x32_bf16 v[60:63], v[28:31], v[128:131], 0
    v_mfma_f32_16x16x32_bf16 v[64:67], v[28:31], v[144:147], 0
    s_waitcnt lgkmcnt(6)
    v_mfma_f32_16x16x32_bf16 v[60:63], v[32:35], v[132:135], v[60:63]
    v_mfma_f32_16x16x32_bf16 v[64:67], v[32:35], v[148:151], v[64:67]
    s_waitcnt lgkmcnt(5)
    v_mfma_f32_16x16x32_bf16 v[60:63], v[36:39], v[136:139], v[60:63]
    v_mfma_f32_16x16x32_bf16 v[64:67], v[36:39], v[152:155], v[64:67]
    s_waitcnt lgkmcnt(4)
    v_mfma_f32_16x16x32_bf16 v[60:63], v[40:43], v[140:143], v[60:63]
    v_mfma_f32_16x16x32_bf16 v[64:67], v[40:43], v[156:159], v[64:67]
    s_waitcnt lgkmcnt(3)
    v_mfma_f32_16x16x32_bf16 v[68:71], v[44:47], v[128:131], 0
    v_mfma_f32_16x16x32_bf16 v[72:75], v[44:47], v[144:147], 0
    s_waitcnt lgkmcnt(2)
    v_mfma_f32_16x16x32_bf16 v[68:71], v[48:51], v[132:135], v[68:71]
    v_mfma_f32_16x16x32_bf16 v[72:75], v[48:51], v[148:151], v[72:75]
    s_waitcnt lgkmcnt(1)
    v_mfma_f32_16x16x32_bf16 v[68:71], v[52:55], v[136:139], v[68:71]
    v_mfma_f32_16x16x32_bf16 v[72:75], v[52:55], v[152:155], v[72:75]
    s_waitcnt lgkmcnt(0)
    v_mfma_f32_16x16x32_bf16 v[68:71], v[56:59], v[140:143], v[68:71]
    v_mfma_f32_16x16x32_bf16 v[72:75], v[56:59], v[156:159], v[72:75]
    v_cvt_pk_bf16_f32 v76, v60, v64
    v_cvt_pk_bf16_f32 v77, v61, v65
    v_cvt_pk_bf16_f32 v78, v62, v66
    v_cvt_pk_bf16_f32 v79, v63, v67
    v_xor_b32 v76, s47, v76
    v_xor_b32 v77, s47, v77
    v_xor_b32 v78, s47, v78
    v_xor_b32 v79, s47, v79
    buffer_store_dwordx4 v[76:79], v106, s[28:31], s56 offen sc1
    v_cvt_pk_bf16_f32 v80, v68, v72
    v_cvt_pk_bf16_f32 v81, v69, v73
    v_cvt_pk_bf16_f32 v82, v70, v74
    v_cvt_pk_bf16_f32 v83, v71, v75
    v_xor_b32 v80, s47, v80
    v_xor_b32 v81, s47, v81
    v_xor_b32 v82, s47, v82
    v_xor_b32 v83, s47, v83
    buffer_store_dwordx4 v[80:83], v107, s[28:31], s56 offen sc1
    s_branch f_p1_join
f_p1_one:
    s_waitcnt lgkmcnt(3)
    v_mfma_f32_16x16x32_bf16 v[60:63], v[28:31], v[128:131], 0
    v_mfma_f32_16x16x32_bf16 v[64:67], v[28:31], v[144:147], 0
    s_waitcnt lgkmcnt(2)
    v_mfma_f32_16x16x32_bf16 v[60:63], v[32:35], v[132:135], v[60:63]
    v_mfma_f32_16x16x32_bf16 v[64:67], v[32:35], v[148:151], v[64:67]
    s_waitcnt lgkmcnt(1)
    v_mfma_f32_16x16x32_bf16 v[60:63], v[36:39], v[136:139], v[60:63]
    v_mfma_f32_16x16x32_bf16 v[64:67], v[36:39], v[152:155], v[64:67]
    s_waitcnt lgkmcnt(0)
    v_mfma_f32_16x16x32_bf16 v[60:63], v[40:43], v[140:143], v[60:63]
    v_mfma_f32_16x16x32_bf16 v[64:67], v[40:43], v[156:159], v[64:67]
    s_nop 7
    v_cvt_pk_bf16_f32 v76, v60, v64
    v_cvt_pk_bf16_f32 v77, v61, v65
    v_cvt_pk_bf16_f32 v78, v62, v66
    v_cvt_pk_bf16_f32 v79, v63, v67
    v_xor_b32 v76, s47, v76
    v_xor_b32 v77, s47, v77
    v_xor_b32 v78, s47, v78
    v_xor_b32 v79, s47, v79
    buffer_store_dwordx4 v[76:79], v106, s[28:31], s56 offen sc1
f_p1_join:
    s_cmp_lt_u32 s3, 3
    s_cbranch_scc0 f_c3done
    v_cvt_f32_u32 v96, v7
    v_cvt_f32_u32 v97, v6
    v_mul_f32 v97, v97, v96
    v_mul_f32 v97, 0x3d800000, v97
    v_fmamk_f32 v84, v96, 0x00000000, v97
    v_fmamk_f32 v85, v96, 0x3c800000, v97
    v_fmamk_f32 v86, v96, 0x3d000000, v97
    v_fmamk_f32 v87, v96, 0x3d400000, v97
    v_cos_f32 v88, v84
    v_sin_f32 v92, v84
    v_cos_f32 v89, v85
    v_sin_f32 v93, v85
    v_cos_f32 v90, v86
    v_sin_f32 v94, v86
    v_cos_f32 v91, v87
    v_sin_f32 v95, v87
    v_cvt_pk_bf16_f32 v216, v88, v89
    v_cvt_pk_bf16_f32 v217, v90, v91
    v_cvt_pk_bf16_f32 v234, -v88, -v89
    v_cvt_pk_bf16_f32 v235, -v90, -v91
    v_cvt_pk_bf16_f32 v218, v92, v93
    v_cvt_pk_bf16_f32 v219, v94, v95
    v_cvt_pk_bf16_f32 v232, v92, v93
    v_cvt_pk_bf16_f32 v233, v94, v95
    v_fmamk_f32 v84, v96, 0x3e800000, v97
    v_fmamk_f32 v85, v96, 0x3e880000, v97
    v_fmamk_f32 v86, v96, 0x3e900000, v97
    v_fmamk_f32 v87, v96, 0x3e980000, v97
    v_cos_f32 v88, v84
    v_sin_f32 v92, v84
    v_cos_f32 v89, v85
    v_sin_f32 v93, v85
    v_cos_f32 v90, v86
    v_sin_f32 v94, v86
    v_cos_f32 v91, v87
    v_sin_f32 v95, v87
    v_cvt_pk_bf16_f32 v220, v88, v89
    v_cvt_pk_bf16_f32 v221, v90, v91
    v_cvt_pk_bf16_f32 v238, -v88, -v89
    v_cvt_pk_bf16_f32 v239, -v90, -v91
    v_cvt_pk_bf16_f32 v222, v92, v93
    v_cvt_pk_bf16_f32 v223, v94, v95
    v_cvt_pk_bf16_f32 v236, v92, v93
    v_cvt_pk_bf16_f32 v237, v94, v95
    v_fmamk_f32 v84, v96, 0x3f000000, v97
    v_fmamk_f32 v85, v96, 0x3f040000, v97
    v_fmamk_f32 v86, v96, 0x3f080000, v97
    v_fmamk_f32 v87, v96, 0x3f0c0000, v97
    v_cos_f32 v88, v84
    v_sin_f32 v92, v84
    v_cos_f32 v89, v85
    v_sin_f32 v93, v85
    v_cos_f32 v90, v86
    v_sin_f32 v94, v86
    v_cos_f32 v91, v87
    v_sin_f32 v95, v87
    v_cvt_pk_bf16_f32 v224, v88, v89
    v_cvt_pk_bf16_f32 v225, v90, v91
    v_cvt_pk_bf16_f32 v242, v88, v89
    v_cvt_pk_bf16_f32 v243, v90, v91
    v_cvt_pk_bf16_f32 v226, -v92, -v93
    v_cvt_pk_bf16_f32 v227, -v94, -v95
    v_cvt_pk_bf16_f32 v240, v92, v93
    v_cvt_pk_bf16_f32 v241, v94, v95
    v_fmamk_f32 v84, v96, 0x3f400000, v97
    v_fmamk_f32 v85, v96, 0x3f440000, v97
    v_fmamk_f32 v86, v96, 0x3f480000, v97
    v_fmamk_f32 v87, v96, 0x3f4c0000, v97
    v_cos_f32 v88, v84
    v_sin_f32 v92, v84
    v_cos_f32 v89, v85
    v_sin_f32 v93, v85
    v_cos_f32 v90, v86
    v_sin_f32 v94, v86
    v_cos_f32 v91, v87
    v_sin_f32 v95, v87
    v_cvt_pk_bf16_f32 v228, v88, v89
    v_cvt_pk_bf16_f32 v229, v90, v91
    v_cvt_pk_bf16_f32 v246, v88, v89
    v_cvt_pk_bf16_f32 v247, v90, v91
    v_cvt_pk_bf16_f32 v230, -v92, -v93
    v_cvt_pk_bf16_f32 v231, -v94, -v95
    v_cvt_pk_bf16_f32 v244, v92, v93
    v_cvt_pk_bf16_f32 v245, v94, v95
    v_mul_f32 v85, 0x3ae38e39, v96
    v_mul_f32 v86, 0x3b638e39, v96
    v_mul_f32 v87, 0x3baaaaab, v96
    v_mul_f32 v88, 0x3be38e39, v96
    v_cos_f32 v248, v85
    v_sin_f32 v252, v85
    v_cos_f32 v249, v86
    v_sin_f32 v253, v86
    v_cos_f32 v250, v87
    v_sin_f32 v254, v87
    v_cos_f32 v251, v88
    v_sin_f32 v255, v88
    v_mul_f32 v248, 0x35e38e39, v248
    v_mul_f32 v249, 0x35e38e39, v249
    v_mul_f32 v250, 0x35e38e39, v250
    v_mul_f32 v251, 0x35e38e39, v251
    v_mul_f32 v252, 0x35e38e39, v252
    v_mul_f32 v253, 0x35e38e39, v253
    v_mul_f32 v254, 0x35e38e39, v254
    v_mul_f32 v255, 0x35e38e39, v255
f_c3done:
    s_mul_i32 s63, s36, 27
    s_add_u32 s63, s63, s37
    s_mul_i32 s62, s63, 171
    s_lshr_b32 s62, s62, 10
    s_mul_i32 s60, s62, 6
    s_sub_u32 s63, s63, s60
    s_lshl_b32 s60, s62, 8
    s_mul_i32 s61, s39, 147456
    s_add_u32 s60, s60, s61
    s_mul_i32 s61, s63, 393216
    s_mul_i32 s24, s39, 3072
    s_add_u32 s61, s61, s24
    s_add_u32 s61, s61, 13631488
    s_lshl_b32 s24, s39, 12
    s_add_u32 s24, s24, 98304
    v_lshrrev_b32 v2, 4, v1
    v_and_b32 v3, 15, v1
    v_lshlrev_b32 v9, 1, v2
    v_xor_b32 v9, v9, v3
    v_xor_b32 v10, 8, v9
    v_mul_u32_u24 v2, 9216, v2
    v_lshl_add_u32 v9, v9, 4, v2
    v_lshl_add_u32 v10, v10, 4, v2
    v_lshlrev_b32 v14, 4, v1
    v_lshlrev_b32 v15, 2, v1
    s_cmp_eq_u32 s42, -1
    s_cbranch_scc1 f_p2_idle
    s_and_b32 s50, s39, 1
    s_lshl_b32 s50, s50, 4
    s_lshr_b32 s51, s39, 1
    s_add_u32 s50, s50, s51
    s_mul_i32 s50, s50, 81920
    s_lshl_b32 s51, s42, 5
    s_add_u32 s50, s50, s51
    s_add_u32 s44, s50, 4194304
    s_add_u32 s45, s44, 655360
    s_lshl_b32 s50, s3, 11
    s_add_u32 s50, s50, 27904
    v_add_u32 v2, s50, v109
    s_lshl_b32 s50, s40, 13
    s_add_u32 s50, s50, 27904
    v_add_u32 v3, s50, v109
    s_lshr_b32 s50, s42, 6
    s_and_b32 s51, s42, 63
    s_mul_i32 s46, s51, 9
    s_add_u32 s46, s46, s50
    s_sub_u32 s50, 576, s46
    s_cmp_lt_u32 s51, 32
    s_cselect_b32 s46, s46, s50
    s_lshl_b32 s46, s46, 13
    s_lshl_b32 s50, s39, 11
    s_add_u32 s46, s46, s50
    s_add_u32 s46, s46, 1048576
    s_lshl_b32 s48, s42, 13
    s_add_u32 s48, s48, 7340032
    s_mov_b32 s47, 0xffff0000
    s_waitcnt vmcnt(0)
    s_mov_b32 s50, 0
f_hb:
    buffer_load_dwordx4 v[28:31], v108, s[28:31], s44 offen sc1
    buffer_load_dwordx4 v[32:35], v108, s[28:31], s45 offen sc1
    s_add_u32 s50, s50, 1
    s_waitcnt vmcnt(0)
    v_max3_u32 v84, v28, v29, v30
    v_max3_u32 v84, v84, v31, v32
    v_max3_u32 v84, v84, v33, v34
    v_max_u32 v84, v84, v35
    v_cmp_eq_u32 vcc, -1, v84
    s_nop 0
    s_and_b64 exec, vcc, vcc
    s_cbranch_scc0 f_hb_ok
    s_cmp_lt_u32 s50, 30000
    s_cbranch_scc1 f_hb
f_hb_ok:
    s_mov_b64 exec, -1
    buffer_load_dwordx4 v[96:99], v109, s[28:31], s46 offen offset:0 sc1
    buffer_load_dwordx4 v[100:103], v109, s[28:31], s46 offen offset:1024 sc1
    ds_write_b128 v2, v[28:31] offset:0
    ds_write_b128 v2, v[32:35] offset:1024
    s_waitcnt lgkmcnt(0)
    s_barrier
    s_add_u32 m0, s55, 83200
    s_nop 0
    buffer_load_dwordx4 v109, s[4:7], s49 offen lds
    s_mov_b64 exec, 0xff
    buffer_load_dwordx4 v109, s[4:7], s49 offen offset:1024 lds
    s_mov_b64 exec, -1
    ds_read_b128 v[28:31], v3 offset:0
    ds_read_b128 v[44:47], v3 offset:4096
    ds_read_b128 v[32:35], v3 offset:1024
    ds_read_b128 v[48:51], v3 offset:5120
    ds_read_b128 v[36:39], v3 offset:2048
    ds_read_b128 v[52:55], v3 offset:6144
    ds_read_b128 v[40:43], v3 offset:3072
    ds_read_b128 v[56:59], v3 offset:7168
    s_waitcnt lgkmcnt(7)
    v_mfma_f32_16x16x32_bf16 v[60:63], v[28:31], v[128:131], 0
    v_mfma_f32_16x16x32_bf16 v[64:67], v[28:31], v[144:147], 0
    s_waitcnt lgkmcnt(6)
    v_mfma_f32_16x16x32_bf16 v[68:71], v[44:47], v[128:131], 0
    v_mfma_f32_16x16x32_bf16 v[72:75], v[44:47], v[144:147], 0
    s_waitcnt lgkmcnt(5)
    v_mfma_f32_16x16x32_bf16 v[60:63], v[32:35], v[132:135], v[60:63]
    v_mfma_f32_16x16x32_bf16 v[64:67], v[32:35], v[148:151], v[64:67]
    s_waitcnt lgkmcnt(4)
    v_mfma_f32_16x16x32_bf16 v[68:71], v[48:51], v[132:135], v[68:71]
    v_mfma_f32_16x16x32_bf16 v[72:75], v[48:51], v[148:151], v[72:75]
    s_waitcnt lgkmcnt(3)
    v_mfma_f32_16x16x32_bf16 v[60:63], v[36:39], v[136:139], v[60:63]
    v_mfma_f32_16x16x32_bf16 v[64:67], v[36:39], v[152:155], v[64:67]
    s_waitcnt lgkmcnt(2)
    v_mfma_f32_16x16x32_bf16 v[68:71], v[52:55], v[136:139], v[68:71]
    v_mfma_f32_16x16x32_bf16 v[72:75], v[52:55], v[152:155], v[72:75]
    s_waitcnt lgkmcnt(1)
    v_mfma_f32_16x16x32_bf16 v[60:63], v[40:43], v[140:143], v[60:63]
    v_mfma_f32_16x16x32_bf16 v[64:67], v[40:43], v[156:159], v[64:67]
    s_waitcnt lgkmcnt(0)
    v_mfma_f32_16x16x32_bf16 v[68:71], v[56:59], v[140:143], v[68:71]
    v_mfma_f32_16x16x32_bf16 v[72:75], v[56:59], v[156:159], v[72:75]
    s_nop 3
    v_pk_mul_f32 v[84:85], v[60:61], v[192:193]
    v_pk_mul_f32 v[88:89], v[64:65], v[192:193]
    v_pk_mul_f32 v[86:87], v[62:63], v[194:195]
    v_pk_mul_f32 v[90:91], v[66:67], v[194:195]
    v_pk_fma_f32 v[84:85], v[64:65], v[200:201], v[84:85]
    v_pk_fma_f32 v[88:89], v[60:61], v[200:201], v[88:89] neg_lo:[1,0,0] neg_hi:[1,0,0]
    v_pk_fma_f32 v[86:87], v[66:67], v[202:203], v[86:87]
    v_pk_fma_f32 v[90:91], v[62:63], v[202:203], v[90:91] neg_lo:[1,0,0] neg_hi:[1,0,0]
    v_cvt_pk_bf16_f32 v76, v84, v85
    v_cvt_pk_bf16_f32 v77, v86, v87
    v_cvt_pk_bf16_f32 v78, v88, v89
    v_cvt_pk_bf16_f32 v79, v90, v91
    v_pk_mul_f32 v[84:85], v[68:69], v[196:197]
    v_pk_mul_f32 v[88:89], v[72:73], v[196:197]
    v_pk_mul_f32 v[86:87], v[70:71], v[198:199]
    v_pk_mul_f32 v[90:91], v[74:75], v[198:199]
    v_pk_fma_f32 v[84:85], v[72:73], v[204:205], v[84:85]
    v_pk_fma_f32 v[88:89], v[68:69], v[204:205], v[88:89] neg_lo:[1,0,0] neg_hi:[1,0,0]
    v_pk_fma_f32 v[86:87], v[74:75], v[206:207], v[86:87]
    v_pk_fma_f32 v[90:91], v[70:71], v[206:207], v[90:91] neg_lo:[1,0,0] neg_hi:[1,0,0]
    v_cvt_pk_bf16_f32 v80, v84, v85
    v_cvt_pk_bf16_f32 v81, v86, v87
    v_cvt_pk_bf16_f32 v82, v88, v89
    v_cvt_pk_bf16_f32 v83, v90, v91
    v_mfma_f32_16x16x32_bf16 v[60:63], v[160:163], v[76:79], 0
    v_mfma_f32_16x16x32_bf16 v[64:67], v[176:179], v[76:79], 0
    v_mfma_f32_16x16x32_bf16 v[68:71], v[168:171], v[76:79], 0
    v_mfma_f32_16x16x32_bf16 v[72:75], v[184:187], v[76:79], 0
    v_mfma_f32_16x16x32_bf16 v[60:63], v[164:167], v[80:83], v[60:63]
    v_mfma_f32_16x16x32_bf16 v[64:67], v[180:183], v[80:83], v[64:67]
    v_mfma_f32_16x16x32_bf16 v[68:71], v[172:175], v[80:83], v[68:71]
    v_mfma_f32_16x16x32_bf16 v[72:75], v[188:191], v[80:83], v[72:75]
    s_waitcnt vmcnt(2)
    v_lshlrev_b32 v28, 16, v96
    v_and_b32 v36, s47, v96
    v_lshlrev_b32 v29, 16, v97
    v_and_b32 v37, s47, v97
    v_lshlrev_b32 v30, 16, v98
    v_and_b32 v38, s47, v98
    v_lshlrev_b32 v31, 16, v99
    v_and_b32 v39, s47, v99
    v_lshlrev_b32 v32, 16, v100
    v_and_b32 v40, s47, v100
    v_lshlrev_b32 v33, 16, v101
    v_and_b32 v41, s47, v101
    v_lshlrev_b32 v34, 16, v102
    v_and_b32 v42, s47, v102
    v_lshlrev_b32 v35, 16, v103
    v_and_b32 v43, s47, v103
    v_pk_mul_f32 v[84:85], v[60:61], v[28:29]
    v_pk_mul_f32 v[88:89], v[64:65], v[28:29] neg_lo:[1,0] neg_hi:[1,0]
    v_pk_mul_f32 v[86:87], v[62:63], v[30:31]
    v_pk_mul_f32 v[90:91], v[66:67], v[30:31] neg_lo:[1,0] neg_hi:[1,0]
    v_pk_fma_f32 v[84:85], v[64:65], v[36:37], v[84:85] neg_lo:[1,0,0] neg_hi:[1,0,0]
    v_pk_fma_f32 v[88:89], v[60:61], v[36:37], v[88:89] neg_lo:[1,0,0] neg_hi:[1,0,0]
    v_pk_fma_f32 v[86:87], v[66:67], v[38:39], v[86:87] neg_lo:[1,0,0] neg_hi:[1,0,0]
    v_pk_fma_f32 v[90:91], v[62:63], v[38:39], v[90:91] neg_lo:[1,0,0] neg_hi:[1,0,0]
    v_cvt_pk_bf16_f32 v76, v84, v85
    v_cvt_pk_bf16_f32 v77, v86, v87
    v_cvt_pk_bf16_f32 v78, v88, v89
    v_cvt_pk_bf16_f32 v79, v90, v91
    v_pk_mul_f32 v[84:85], v[68:69], v[32:33]
    v_pk_mul_f32 v[88:89], v[72:73], v[32:33] neg_lo:[1,0] neg_hi:[1,0]
    v_pk_mul_f32 v[86:87], v[70:71], v[34:35]
    v_pk_mul_f32 v[90:91], v[74:75], v[34:35] neg_lo:[1,0] neg_hi:[1,0]
    v_pk_fma_f32 v[84:85], v[72:73], v[40:41], v[84:85] neg_lo:[1,0,0] neg_hi:[1,0,0]
    v_pk_fma_f32 v[88:89], v[68:69], v[40:41], v[88:89] neg_lo:[1,0,0] neg_hi:[1,0,0]
    v_pk_fma_f32 v[86:87], v[74:75], v[42:43], v[86:87] neg_lo:[1,0,0] neg_hi:[1,0,0]
    v_pk_fma_f32 v[90:91], v[70:71], v[42:43], v[90:91] neg_lo:[1,0,0] neg_hi:[1,0,0]
    v_cvt_pk_bf16_f32 v80, v84, v85
    v_cvt_pk_bf16_f32 v81, v86, v87
    v_cvt_pk_bf16_f32 v82, v88, v89
    v_cvt_pk_bf16_f32 v83, v90, v91
    v_mfma_f32_16x16x32_bf16 v[60:63], v[160:163], v[76:79], 0
    v_mfma_f32_16x16x32_bf16 v[64:67], v[176:179], v[76:79], 0
    v_mfma_f32_16x16x32_bf16 v[68:71], v[168:171], v[76:79], 0
    v_mfma_f32_16x16x32_bf16 v[72:75], v[184:187], v[76:79], 0
    v_mfma_f32_16x16x32_bf16 v[60:63], v[164:167], v[80:83], v[60:63]
    v_mfma_f32_16x16x32_bf16 v[64:67], v[180:183], v[80:83], v[64:67]
    v_mfma_f32_16x16x32_bf16 v[68:71], v[172:175], v[80:83], v[68:71]
    v_mfma_f32_16x16x32_bf16 v[72:75], v[188:191], v[80:83], v[72:75]
    s_nop 4
    v_pk_mul_f32 v[84:85], v[60:61], v[192:193]
    v_pk_mul_f32 v[88:89], v[64:65], v[192:193]
    v_pk_mul_f32 v[86:87], v[62:63], v[194:195]
    v_pk_mul_f32 v[90:91], v[66:67], v[194:195]
    v_pk_fma_f32 v[84:85], v[64:65], v[200:201], v[84:85]
    v_pk_fma_f32 v[88:89], v[60:61], v[200:201], v[88:89] neg_lo:[1,0,0] neg_hi:[1,0,0]
    v_pk_fma_f32 v[86:87], v[66:67], v[202:203], v[86:87]
    v_pk_fma_f32 v[90:91], v[62:63], v[202:203], v[90:91] neg_lo:[1,0,0] neg_hi:[1,0,0]
    v_cvt_pk_bf16_f32 v92, v84, v88
    ds_write_b32 v110, v92 offset:0
    v_cvt_pk_bf16_f32 v93, v85, v89
    ds_write_b32 v110, v93 offset:272
    v_cvt_pk_bf16_f32 v94, v86, v90
    ds_write_b32 v110, v94 offset:544
    v_cvt_pk_bf16_f32 v95, v87, v91
    ds_write_b32 v110, v95 offset:816
    v_pk_mul_f32 v[84:85], v[68:69], v[196:197]
    v_pk_mul_f32 v[88:89], v[72:73], v[196:197]
    v_pk_mul_f32 v[86:87], v[70:71], v[198:199]
    v_pk_mul_f32 v[90:91], v[74:75], v[198:199]
    v_pk_fma_f32 v[84:85], v[72:73], v[204:205], v[84:85]
    v_pk_fma_f32 v[88:89], v[68:69], v[204:205], v[88:89] neg_lo:[1,0,0] neg_hi:[1,0,0]
    v_pk_fma_f32 v[86:87], v[74:75], v[206:207], v[86:87]
    v_pk_fma_f32 v[90:91], v[70:71], v[206:207], v[90:91] neg_lo:[1,0,0] neg_hi:[1,0,0]
    v_cvt_pk_bf16_f32 v92, v84, v88
    ds_write_b32 v110, v92 offset:4352
    v_cvt_pk_bf16_f32 v93, v85, v89
    ds_write_b32 v110, v93 offset:4624
    v_cvt_pk_bf16_f32 v94, v86, v90
    ds_write_b32 v110, v94 offset:4896
    v_cvt_pk_bf16_f32 v95, v87, v91
    ds_write_b32 v110, v95 offset:5168
    s_waitcnt lgkmcnt(0)
    s_barrier
    ds_read_b128 v[28:31], v111 offset:0
    ds_read_b128 v[44:47], v111 offset:4352
    ds_read_b128 v[32:35], v111 offset:64
    ds_read_b128 v[48:51], v111 offset:4416
    ds_read_b128 v[36:39], v111 offset:128
    ds_read_b128 v[52:55], v111 offset:4480
    ds_read_b128 v[40:43], v111 offset:192
    ds_read_b128 v[56:59], v111 offset:4544
    s_waitcnt lgkmcnt(7)
    v_mfma_f32_16x16x32_bf16 v[60:63], v[28:31], v[128:131], 0
    v_mfma_f32_16x16x32_bf16 v[64:67], v[28:31], v[144:147], 0
    s_waitcnt lgkmcnt(6)
    v_mfma_f32_16x16x32_bf16 v[68:71], v[44:47], v[128:131], 0
    v_mfma_f32_16x16x32_bf16 v[72:75], v[44:47], v[144:147], 0
    s_waitcnt lgkmcnt(5)
    v_mfma_f32_16x16x32_bf16 v[60:63], v[32:35], v[132:135], v[60:63]
    v_mfma_f32_16x16x32_bf16 v[64:67], v[32:35], v[148:151], v[64:67]
    s_waitcnt lgkmcnt(4)
    v_mfma_f32_16x16x32_bf16 v[68:71], v[48:51], v[132:135], v[68:71]
    v_mfma_f32_16x16x32_bf16 v[72:75], v[48:51], v[148:151], v[72:75]
    s_waitcnt lgkmcnt(3)
    v_mfma_f32_16x16x32_bf16 v[60:63], v[36:39], v[136:139], v[60:63]
    v_mfma_f32_16x16x32_bf16 v[64:67], v[36:39], v[152:155], v[64:67]
    s_waitcnt lgkmcnt(2)
    v_mfma_f32_16x16x32_bf16 v[68:71], v[52:55], v[136:139], v[68:71]
    v_mfma_f32_16x16x32_bf16 v[72:75], v[52:55], v[152:155], v[72:75]
    s_waitcnt lgkmcnt(1)
    v_mfma_f32_16x16x32_bf16 v[60:63], v[40:43], v[140:143], v[60:63]
    v_mfma_f32_16x16x32_bf16 v[64:67], v[40:43], v[156:159], v[64:67]
    s_waitcnt lgkmcnt(0)
    v_mfma_f32_16x16x32_bf16 v[68:71], v[56:59], v[140:143], v[68:71]
    v_mfma_f32_16x16x32_bf16 v[72:75], v[56:59], v[156:159], v[72:75]
    s_nop 3
    v_cvt_pk_bf16_f32 v84, v60, v61
    v_cvt_pk_bf16_f32 v85, v62, v63
    v_cvt_pk_bf16_f32 v86, v64, v65
    v_cvt_pk_bf16_f32 v87, v66, v67
    buffer_store_dwordx4 v[84:87], v112, s[28:31], s48 offen sc1
    v_cvt_pk_bf16_f32 v88, v68, v69
    v_cvt_pk_bf16_f32 v89, v70, v71
    v_cvt_pk_bf16_f32 v90, v72, v73
    v_cvt_pk_bf16_f32 v91, v74, v75
    s_add_u32 s48, s48, 4096
    buffer_store_dwordx4 v[88:91], v112, s[28:31], s48 offen sc1
    s_branch f_p2_done
f_p2_idle:
    s_barrier
    s_add_u32 m0, s55, 83200
    s_nop 0
    buffer_load_dwordx4 v109, s[4:7], s49 offen lds
    s_mov_b64 exec, 0xff
    buffer_load_dwordx4 v109, s[4:7], s49 offen offset:1024 lds
    s_mov_b64 exec, -1
    s_cmp_lt_u32 s2, 216
    s_cbranch_scc0 f_pla
    s_mov_b32 m0, s24
    s_nop 0
    buffer_load_dwordx4 v9, s[32:35], s60 offen offset:0 lds
    s_add_u32 s25, s60, 35840
    buffer_load_dwordx4 v9, s[32:35], s25 offen offset:1024 lds
    s_add_u32 s26, s60, 71680
    buffer_load_dwordx4 v10, s[32:35], s26 offen offset:2048 lds
    s_add_u32 s27, s60, 107520
    buffer_load_dwordx4 v10, s[32:35], s27 offen offset:3072 lds
    s_add_u32 s60, s60, 589824
    s_add_u32 s24, s24, 16384
    s_mov_b32 m0, s24
    s_nop 0
    buffer_load_dwordx4 v9, s[32:35], s60 offen offset:0 lds
    s_add_u32 s25, s60, 35840
    buffer_load_dwordx4 v9, s[32:35], s25 offen offset:1024 lds
    s_add_u32 s26, s60, 71680
    buffer_load_dwordx4 v10, s[32:35], s26 offen offset:2048 lds
    s_add_u32 s27, s60, 107520
    buffer_load_dwordx4 v10, s[32:35], s27 offen offset:3072 lds
    s_add_u32 s60, s60, 589824
    s_add_u32 s24, s24, 16384
f_pla:
    s_barrier
f_p2_done:
    s_mov_b32 s44, 0x26000
    s_mov_b32 s45, 0x28400
    s_mov_b32 s46, 0x2a800
    buffer_load_dwordx4 v[28:31], v126, s[28:31], s44 offen
    buffer_load_dwordx4 v[32:35], v126, s[28:31], s45 offen
    buffer_load_dwordx4 v[36:39], v126, s[28:31], s46 offen
    s_bfe_u32 s50, s38, 0x10001
    s_lshl_b32 s50, s50, 6
    s_lshr_b32 s51, s38, 2
    s_add_u32 s50, s50, s51
    s_lshl_b32 s50, s50, 1
    s_and_b32 s51, s38, 1
    s_add_u32 s50, s50, s51
    s_lshl_b32 s50, s50, 5
    s_add_u32 s48, s50, 7340032
    v_subrev_u32 v2, 288, v0
    v_cmp_gt_u32 vcc, 144, v2
    s_nop 1
    v_cndmask_b32 v3, 0, 1.0, vcc
    v_lshlrev_b32 v2, 4, v0
    s_mov_b32 s47, 0xffff0000
    s_waitcnt vmcnt(0)
    v_pk_add_f32 v[28:29], v[28:29], v[32:33]
    v_pk_add_f32 v[30:31], v[30:31], v[34:35]
    v_pk_add_f32 v[28:29], v[28:29], v[36:37]
    v_pk_add_f32 v[30:31], v[30:31], v[38:39]
    v_cvt_pk_bf16_f32 v48, v28, v29
    v_lshlrev_b32 v28, 16, v48
    v_and_b32 v29, s47, v48
    v_cvt_pk_bf16_f32 v49, v30, v31
    v_lshlrev_b32 v30, 16, v49
    v_and_b32 v31, s47, v49
    v_add_f32 v28, v28, v3
    v_add_f32 v29, v29, v3
    v_add_f32 v30, v30, v3
    v_add_f32 v31, v31, v3
    v_cvt_pk_bf16_f32 v48, v28, v29
    v_lshlrev_b32 v28, 16, v48
    v_and_b32 v29, s47, v48
    v_cvt_pk_bf16_f32 v49, v30, v31
    v_lshlrev_b32 v30, 16, v49
    v_and_b32 v31, s47, v49
    ds_write_b128 v2, v[28:31] offset:6656
    s_cmp_ge_u32 s2, 254
    s_cselect_b32 s50, s3, 0
    s_cmp_ge_u32 s50, 6
    s_cbranch_scc0 f_nogb
    v_subrev_u32 v2, 432, v0
    v_cmp_gt_u32 vcc, 72, v2
    v_mov_b32 v3, 0x7f000000
    s_nop 0
    v_cndmask_b32 v2, v3, v126, vcc
    s_movk_i32 s50, 4608
    buffer_store_dwordx4 v[28:31], v2, s[28:31], s50 offen sc1
    s_waitcnt vmcnt(0)
f_nogb:
    s_cmp_lt_u32 s2, 33
    s_cbranch_scc1 f_nozsl
    s_sleep 16
f_nozsl:
    s_cmp_lt_u32 s3, 2
    s_cbranch_scc1 f_z2
    s_mov_b32 s50, 0
f_za:
    buffer_load_dwordx4 v[40:43], v113, s[28:31], s48 offen sc1
    s_add_u32 s50, s50, 1
    s_waitcnt vmcnt(0)
    v_max3_u32 v48, v40, v41, v42
    v_max_u32 v48, v48, v43
    v_cmp_eq_u32 vcc, -1, v48
    s_nop 0
    s_and_b64 exec, vcc, vcc
    s_cbranch_scc0 f_za_ok
    s_cmp_lt_u32 s50, 30000
    s_cbranch_scc1 f_za
f_za_ok:
    s_mov_b64 exec, -1
    s_branch f_zj
f_z2:
    s_mov_b32 s50, 0
f_zb:
    buffer_load_dwordx4 v[40:43], v113, s[28:31], s48 offen sc1
    buffer_load_dwordx4 v[44:47], v114, s[28:31], s48 offen sc1
    s_add_u32 s50, s50, 1
    s_waitcnt vmcnt(0)
    v_max3_u32 v48, v40, v41, v42
    v_max3_u32 v48, v48, v43, v44
    v_max3_u32 v48, v48, v45, v46
    v_max_u32 v48, v48, v47
    v_cmp_eq_u32 vcc, -1, v48
    s_nop 0
    s_and_b64 exec, vcc, vcc
    s_cbranch_scc0 f_zb_ok
    s_cmp_lt_u32 s50, 30000
    s_cbranch_scc1 f_zb
f_zb_ok:
    s_mov_b64 exec, -1
    ds_write_b64 v115, v[44:45] offset:2304
    ds_write_b64 v115, v[46:47] offset:5184
f_zj:
    ds_write_b64 v115, v[40:41]
    ds_write_b64 v115, v[42:43] offset:2880
    s_cmp_lt_u32 s3, 4
    s_cbranch_scc1 f_plb_done0
    s_cmp_lt_u32 s2, 33
    s_cbranch_scc0 f_plb0
    s_cmp_lt_u32 s2, 216
    s_cbranch_scc0 f_plb00
    s_mov_b32 m0, s24
    s_nop 0
    buffer_load_dwordx4 v9, s[32:35], s60 offen offset:0 lds
    s_add_u32 s25, s60, 35840
    buffer_load_dwordx4 v9, s[32:35], s25 offen offset:1024 lds
    s_add_u32 s26, s60, 71680
    buffer_load_dwordx4 v10, s[32:35], s26 offen offset:2048 lds
    s_add_u32 s27, s60, 107520
    buffer_load_dwordx4 v10, s[32:35], s27 offen offset:3072 lds
    s_add_u32 s60, s60, 589824
    s_add_u32 s24, s24, 16384
    s_mov_b32 m0, s24
    s_nop 0
    buffer_load_dwordx4 v9, s[32:35], s60 offen offset:0 lds
    s_add_u32 s25, s60, 35840
    buffer_load_dwordx4 v9, s[32:35], s25 offen offset:1024 lds
    s_add_u32 s26, s60, 71680
    buffer_load_dwordx4 v10, s[32:35], s26 offen offset:2048 lds
    s_add_u32 s27, s60, 107520
    buffer_load_dwordx4 v10, s[32:35], s27 offen offset:3072 lds
    s_add_u32 s60, s60, 589824
    s_add_u32 s24, s24, 16384
f_plb00:
f_plb0:
    s_cmp_lt_u32 s2, 216
    s_cbranch_scc0 f_plb10
    s_mov_b32 m0, s24
    s_nop 0
    buffer_load_dwordx4 v9, s[32:35], s60 offen offset:0 lds
    s_add_u32 s25, s60, 35840
    buffer_load_dwordx4 v9, s[32:35], s25 offen offset:1024 lds
    s_add_u32 s26, s60, 71680
    buffer_load_dwordx4 v10, s[32:35], s26 offen offset:2048 lds
    s_add_u32 s27, s60, 107520
    buffer_load_dwordx4 v10, s[32:35], s27 offen offset:3072 lds
    s_add_u32 s60, s60, 589824
    s_add_u32 s24, s24, 16384
    s_mov_b32 m0, s24
    s_nop 0
    buffer_load_dwordx4 v9, s[32:35], s60 offen offset:0 lds
    s_add_u32 s25, s60, 35840
    buffer_load_dwordx4 v9, s[32:35], s25 offen offset:1024 lds
    s_add_u32 s26, s60, 71680
    buffer_load_dwordx4 v10, s[32:35], s26 offen offset:2048 lds
    s_add_u32 s27, s60, 107520
    buffer_load_dwordx4 v10, s[32:35], s27 offen offset:3072 lds
    s_add_u32 s60, s60, 589824
    s_add_u32 s24, s24, 16384
f_plb10:
f_plb_done0:
    s_cmp_lt_u32 s3, 4
    s_cbranch_scc1 f_not3
    s_sub_u32 s50, s37, 0
    s_cbranch_scc1 f_not3
    s_lshl_b32 s50, s50, 2
    s_add_u32 s50, s50, s39
    s_add_u32 s58, s50, 43
    s_mul_i32 s58, s58, 55296
    s_add_u32 s58, s58, s57
    buffer_load_dword v8, v17, s[32:35], s58 offen
    s_add_u32 s58, s58, 7077888
    s_cmp_lt_u32 s50, 90
    s_cbranch_scc0 ftch_5
    buffer_load_dword v8, v17, s[32:35], s58 offen
ftch_5:
f_not3:
    s_waitcnt lgkmcnt(0)
    s_barrier
    v_cmp_eq_u32 s[44:45], 1, v6
    v_cmp_eq_u32 s[50:51], 2, v6
    v_cmp_eq_u32 s[58:59], 3, v6
    ds_read_b64_tr_b16 v[28:29], v116 offset:0
    ds_read_b64_tr_b16 v[30:31], v116 offset:2880
    ds_read_b64_tr_b16 v[32:33], v116 offset:128
    ds_read_b64_tr_b16 v[34:35], v116 offset:3008
    ds_read_b64_tr_b16 v[36:37], v116 offset:256
    ds_read_b64_tr_b16 v[38:39], v116 offset:3136
    ds_read_b64_tr_b16 v[40:41], v116 offset:384
    ds_read_b64_tr_b16 v[42:43], v116 offset:3264
    ds_read_b64_tr_b16 v[44:45], v117 offset:0
    ds_read_b64_tr_b16 v[46:47], v117 offset:2880
    ds_read_b64_tr_b16 v[48:49], v117 offset:128
    ds_read_b64_tr_b16 v[50:51], v117 offset:3008
    ds_read_b64_tr_b16 v[52:53], v117 offset:256
    ds_read_b64_tr_b16 v[54:55], v117 offset:3136
    ds_read_b64_tr_b16 v[56:57], v117 offset:384
    ds_read_b64_tr_b16 v[58:59], v117 offset:3264
    s_waitcnt lgkmcnt(14)
    v_mfma_f32_16x16x32_bf16 v[60:63], v[28:31], v[216:219], 0
    v_mfma_f32_16x16x32_bf16 v[64:67], v[28:31], v[232:235], 0
    s_waitcnt lgkmcnt(12)
    v_mfma_f32_16x16x32_bf16 v[60:63], v[32:35], v[220:223], v[60:63]
    v_mfma_f32_16x16x32_bf16 v[64:67], v[32:35], v[236:239], v[64:67]
    s_waitcnt lgkmcnt(10)
    v_mfma_f32_16x16x32_bf16 v[60:63], v[36:39], v[224:227], v[60:63]
    v_mfma_f32_16x16x32_bf16 v[64:67], v[36:39], v[240:243], v[64:67]
    s_waitcnt lgkmcnt(8)
    v_mfma_f32_16x16x32_bf16 v[60:63], v[40:43], v[228:231], v[60:63]
    v_mfma_f32_16x16x32_bf16 v[64:67], v[40:43], v[244:247], v[64:67]
    s_waitcnt lgkmcnt(6)
    v_mfma_f32_16x16x32_bf16 v[68:71], v[44:47], v[216:219], 0
    s_waitcnt lgkmcnt(4)
    v_mfma_f32_16x16x32_bf16 v[68:71], v[48:51], v[220:223], v[68:71]
    s_waitcnt lgkmcnt(2)
    v_mfma_f32_16x16x32_bf16 v[68:71], v[52:55], v[224:227], v[68:71]
    s_waitcnt lgkmcnt(0)
    v_mfma_f32_16x16x32_bf16 v[68:71], v[56:59], v[228:231], v[68:71]
    ds_read_u16_d16_hi v18, v127 offset:0
    ds_read_u16_d16_hi v19, v127 offset:128
    ds_read_u16_d16_hi v20, v127 offset:256
    ds_read_u16_d16_hi v21, v127 offset:384
    ds_read_u16_d16_hi v22, v127 offset:512
    ds_read_u16_d16_hi v23, v127 offset:640
    ds_read_u16_d16_hi v24, v127 offset:768
    ds_read_u16_d16_hi v25, v127 offset:896
    ds_read_u16_d16_hi v26, v127 offset:1024
    ds_read2st64_b32 v[72:73], v124 offset0:26 offset1:27
    ds_read2st64_b32 v[74:75], v124 offset0:28 offset1:29
    ds_read2st64_b32 v[76:77], v124 offset0:30 offset1:31
    ds_read2st64_b32 v[78:79], v124 offset0:32 offset1:33
    ds_read2st64_b32 v[80:81], v124 offset0:34 offset1:35
    ds_read2st64_b32 v[82:83], v124 offset0:36 offset1:37
    ds_read2st64_b32 v[84:85], v124 offset0:38 offset1:39
    ds_read2st64_b32 v[86:87], v124 offset0:40 offset1:41
    ds_read2st64_b32 v[88:89], v124 offset0:42 offset1:43
    ds_read2st64_b32 v[90:91], v124 offset0:44 offset1:45
    ds_read2st64_b32 v[92:93], v124 offset0:46 offset1:47
    ds_read2st64_b32 v[94:95], v124 offset0:48 offset1:49
    ds_read2st64_b32 v[96:97], v124 offset0:50 offset1:51
    ds_read_b32 v98, v124 offset:13312
    v_permlane32_swap_b32 v60, v62
    v_permlane32_swap_b32 v61, v63
    v_permlane32_swap_b32 v64, v66
    v_permlane32_swap_b32 v65, v67
    v_permlane16_swap_b32 v60, v61
    v_permlane16_swap_b32 v62, v63
    v_permlane16_swap_b32 v64, v65
    v_permlane16_swap_b32 v66, v67
    v_pk_mul_f32 v[28:29], v[60:61], v[248:249]
    v_pk_mul_f32 v[32:33], v[64:65], v[248:249]
    v_pk_mul_f32 v[30:31], v[62:63], v[250:251]
    v_pk_mul_f32 v[34:35], v[66:67], v[250:251]
    v_pk_fma_f32 v[28:29], v[64:65], v[252:253], v[28:29] neg_lo:[1,0,0] neg_hi:[1,0,0]
    v_pk_fma_f32 v[32:33], v[60:61], v[252:253], v[32:33]
    v_pk_fma_f32 v[30:31], v[66:67], v[254:255], v[30:31] neg_lo:[1,0,0] neg_hi:[1,0,0]
    v_pk_fma_f32 v[34:35], v[62:63], v[254:255], v[34:35]
    v_cndmask_b32 v36, v68, v69, s[44:45]
    v_cndmask_b32 v36, v36, v70, s[50:51]
    v_cndmask_b32 v36, v36, v71, s[58:59]
    v_mul_f32 v36, 0x35638e39, v36
    v_add_f32 v37, v36, v28
    v_add_f32 v38, v29, v30
    v_add_f32 v37, v37, v31
    v_add_f32 v37, v37, v38
    v_fmamk_f32 v40, v28, 0x3f441b7d, v36
    v_fmamk_f32 v41, v28, 0x3e31d0d4, v36
    v_fmamk_f32 v42, v28, 0xbf000000, v36
    v_fmamk_f32 v43, v28, 0xbf708fb2, v36
    v_fmamk_f32 v40, v29, 0x3e31d0d4, v40
    v_fmamk_f32 v41, v29, 0xbf708fb2, v41
    v_fmamk_f32 v42, v29, 0xbf000000, v42
    v_fmamk_f32 v43, v29, 0x3f441b7d, v43
    v_fmamk_f32 v40, v30, 0xbf000000, v40
    v_fmamk_f32 v41, v30, 0xbf000000, v41
    v_fmamk_f32 v42, v30, 0x3f800000, v42
    v_fmamk_f32 v43, v30, 0xbf000000, v43
    v_fmamk_f32 v40, v31, 0xbf708fb2, v40
    v_fmamk_f32 v41, v31, 0x3f441b7d, v41
    v_fmamk_f32 v42, v31, 0xbf000000, v42
    v_fmamk_f32 v43, v31, 0x3e31d0d4, v43
    v_mul_f32 v44, 0x3f248dbb, v32
    v_mul_f32 v45, 0x3f7c1c5c, v32
    v_mul_f32 v46, 0x3f5db3d7, v32
    v_mul_f32 v47, 0x3eaf1d44, v32
    v_fmamk_f32 v44, v33, 0x3f7c1c5c, v44
    v_fmamk_f32 v45, v33, 0x3eaf1d44, v45
    v_fmamk_f32 v46, v33, 0xbf5db3d7, v46
    v_fmamk_f32 v47, v33, 0xbf248dbb, v47
    v_fmamk_f32 v44, v34, 0x3f5db3d7, v44
    v_fmamk_f32 v45, v34, 0xbf5db3d7, v45
    v_fmamk_f32 v47, v34, 0x3f5db3d7, v47
    v_fmamk_f32 v44, v35, 0x3eaf1d44, v44
    v_fmamk_f32 v45, v35, 0xbf248dbb, v45
    v_fmamk_f32 v46, v35, 0x3f5db3d7, v46
    v_fmamk_f32 v47, v35, 0xbf7c1c5c, v47
    s_waitcnt lgkmcnt(9)
    v_fmac_f32 v18, v37, v72
    v_sub_f32 v50, v40, v44
    v_add_f32 v51, v40, v44
    v_fmac_f32 v19, v50, v73
    v_fmac_f32 v26, v51, v80
    v_sub_f32 v48, v41, v45
    v_add_f32 v49, v41, v45
    v_fmac_f32 v20, v48, v74
    v_fmac_f32 v25, v49, v79
    v_sub_f32 v50, v42, v46
    v_add_f32 v51, v42, v46
    v_fmac_f32 v21, v50, v75
    v_fmac_f32 v24, v51, v78
    v_sub_f32 v48, v43, v47
    v_add_f32 v49, v43, v47
    v_fmac_f32 v22, v48, v76
    v_fmac_f32 v23, v49, v77
    v_cvt_pk_bf16_f32 v60, v18, v19
    v_cvt_pk_bf16_f32 v61, v20, v21
    v_cvt_pk_bf16_f32 v62, v22, v23
    v_cvt_pk_bf16_f32 v63, v24, v25
    v_cvt_pk_bf16_f32 v64, v26, v26
    v_lshlrev_b32 v18, 16, v60
    v_and_b32 v19, s47, v60
    v_lshlrev_b32 v20, 16, v61
    v_and_b32 v21, s47, v61
    v_lshlrev_b32 v22, 16, v62
    v_and_b32 v23, s47, v62
    v_lshlrev_b32 v24, 16, v63
    v_and_b32 v25, s47, v63
    v_lshlrev_b32 v26, 16, v64
    ds_write_b16 v127, v60 offset:0
    ds_write_b16_d16_hi v127, v60 offset:128
    ds_write_b16 v127, v61 offset:256
    ds_write_b16_d16_hi v127, v61 offset:384
    ds_write_b16 v127, v62 offset:512
    ds_write_b16_d16_hi v127, v62 offset:640
    ds_write_b16 v127, v63 offset:768
    ds_write_b16_d16_hi v127, v63 offset:896
    ds_write_b16 v127, v64 offset:1024
    s_add_u32 s52, s49, 10485760
    s_add_u32 s50, s55, 83200
    v_add_u32 v2, s50, v109
    v_cmp_eq_u32 s[44:45], 0, v5
    v_add_f32 v56, v18, v19
    v_mul_f32 v57, v18, v18
    v_fmac_f32 v57, v19, v19
    v_add_f32 v56, v56, v20
    v_fmac_f32 v57, v20, v20
    v_add_f32 v56, v56, v21
    v_fmac_f32 v57, v21, v21
    v_add_f32 v56, v56, v22
    v_fmac_f32 v57, v22, v22
    v_add_f32 v56, v56, v23
    v_fmac_f32 v57, v23, v23
    v_add_f32 v56, v56, v24
    v_fmac_f32 v57, v24, v24
    v_add_f32 v56, v56, v25
    v_fmac_f32 v57, v25, v25
    v_add_f32 v56, v56, v26
    v_fmac_f32 v57, v26, v26
    s_nop 0
    v_add_f32_dpp v56, v56, v56 quad_perm:[1,0,3,2] row_mask:0xf bank_mask:0xf
    v_add_f32_dpp v57, v57, v57 quad_perm:[1,0,3,2] row_mask:0xf bank_mask:0xf
    s_nop 0
    v_add_f32_dpp v56, v56, v56 quad_perm:[2,3,0,1] row_mask:0xf bank_mask:0xf
    v_add_f32_dpp v57, v57, v57 quad_perm:[2,3,0,1] row_mask:0xf bank_mask:0xf
    s_nop 0
    v_add_f32_dpp v56, v56, v56 row_half_mirror row_mask:0xf bank_mask:0xf
    v_add_f32_dpp v57, v57, v57 row_half_mirror row_mask:0xf bank_mask:0xf
    s_nop 0
    v_add_f32_dpp v56, v56, v56 row_mirror row_mask:0xf bank_mask:0xf
    v_add_f32_dpp v57, v57, v57 row_mirror row_mask:0xf bank_mask:0xf
    s_mov_b64 exec, s[44:45]
    ds_write_b64 v120, v[56:57] offset:0
    s_mov_b64 exec, -1
    s_waitcnt lgkmcnt(0)
    s_barrier
    ds_read_b128 v[48:51], v119 offset:0
    ds_read_b128 v[52:55], v119 offset:16
    v_mov_b32 v58, 0x3727c5ac
    s_waitcnt lgkmcnt(0)
    s_cmp_lt_u32 s3, 4
    s_cbranch_scc0 f_nox1r
    ds_read_b128 v[28:31], v2 offset:0
    ds_read_b128 v[32:35], v2 offset:1024
    ds_read_b128 v[36:39], v2 offset:4736
    ds_read_b128 v[40:43], v2 offset:5760
f_nox1r:
    v_pk_add_f32 v[48:49], v[48:49], v[50:51]
    v_pk_add_f32 v[52:53], v[52:53], v[54:55]
    v_pk_add_f32 v[48:49], v[48:49], v[52:53]
    v_mul_f32 v56, 0x3ae38e39, v48
    v_fmamk_f32 v57, v49, 0x3ae38e39, v58
    v_fma_f32 v57, -v56, v56, v57
    v_rsq_f32 v57, v57
    s_nop 0
    v_mul_f32 v56, -v56, v57
    v_fma_f32 v18, v18, v57, v56
    v_fma_f32 v19, v19, v57, v56
    v_fma_f32 v20, v20, v57, v56
    v_fma_f32 v21, v21, v57, v56
    v_fma_f32 v22, v22, v57, v56
    v_fma_f32 v23, v23, v57, v56
    v_fma_f32 v24, v24, v57, v56
    v_fma_f32 v25, v25, v57, v56
    v_fma_f32 v26, v26, v57, v56
    s_cmp_lt_u32 s3, 4
    s_cbranch_scc0 f_nox1s
    s_add_u32 s50, s52, 4608
    s_waitcnt lgkmcnt(0)
    buffer_store_dwordx4 v[28:31], v109, s[28:31], s52 offen sc1
    buffer_store_dwordx4 v[36:39], v109, s[28:31], s50 offen sc1
    s_mov_b64 exec, 0xff
    buffer_store_dwordx4 v[32:35], v109, s[28:31], s52 offen offset:1024 sc1
    buffer_store_dwordx4 v[40:43], v109, s[28:31], s50 offen offset:1024 sc1
    s_mov_b64 exec, -1
f_nox1s:
    v_fma_f32 v18, v18, v90, v81
    v_fma_f32 v19, v19, v91, v82
    v_fma_f32 v20, v20, v92, v83
    v_fma_f32 v21, v21, v93, v84
    v_fma_f32 v22, v22, v94, v85
    v_fma_f32 v23, v23, v95, v86
    v_fma_f32 v24, v24, v96, v87
    v_fma_f32 v25, v25, v97, v88
    v_fma_f32 v26, v26, v98, v89
    v_add_f32 v56, v18, v19
    v_mul_f32 v57, v18, v18
    v_fmac_f32 v57, v19, v19
    v_add_f32 v56, v56, v20
    v_fmac_f32 v57, v20, v20
    v_add_f32 v56, v56, v21
    v_fmac_f32 v57, v21, v21
    v_add_f32 v56, v56, v22
    v_fmac_f32 v57, v22, v22
    v_add_f32 v56, v56, v23
    v_fmac_f32 v57, v23, v23
    v_add_f32 v56, v56, v24
    v_fmac_f32 v57, v24, v24
    v_add_f32 v56, v56, v25
    v_fmac_f32 v57, v25, v25
    v_add_f32 v56, v56, v26
    v_fmac_f32 v57, v26, v26
    s_nop 0
    v_add_f32_dpp v56, v56, v56 quad_perm:[1,0,3,2] row_mask:0xf bank_mask:0xf
    v_add_f32_dpp v57, v57, v57 quad_perm:[1,0,3,2] row_mask:0xf bank_mask:0xf
    s_nop 0
    v_add_f32_dpp v56, v56, v56 quad_perm:[2,3,0,1] row_mask:0xf bank_mask:0xf
    v_add_f32_dpp v57, v57, v57 quad_perm:[2,3,0,1] row_mask:0xf bank_mask:0xf
    s_nop 0
    v_add_f32_dpp v56, v56, v56 row_half_mirror row_mask:0xf bank_mask:0xf
    v_add_f32_dpp v57, v57, v57 row_half_mirror row_mask:0xf bank_mask:0xf
    s_nop 0
    v_add_f32_dpp v56, v56, v56 row_mirror row_mask:0xf bank_mask:0xf
    v_add_f32_dpp v57, v57, v57 row_mirror row_mask:0xf bank_mask:0xf
    s_mov_b64 exec, s[44:45]
    ds_write_b64 v120, v[56:57] offset:256
    s_mov_b64 exec, -1
    s_waitcnt lgkmcnt(0)
    s_barrier
    ds_read_b128 v[48:51], v119 offset:256
    ds_read_b128 v[52:55], v119 offset:272
    v_mov_b32 v58, 0x3727c5ac
    s_waitcnt lgkmcnt(0)
    v_pk_add_f32 v[48:49], v[48:49], v[50:51]
    v_pk_add_f32 v[52:53], v[52:53], v[54:55]
    v_pk_add_f32 v[48:49], v[48:49], v[52:53]
    v_mul_f32 v56, 0x3ae38e39, v48
    v_fmamk_f32 v57, v49, 0x3ae38e39, v58
    v_fma_f32 v57, -v56, v56, v57
    v_rsq_f32 v57, v57
    s_nop 0
    v_mul_f32 v56, -v56, v57
    v_fma_f32 v18, v18, v57, v56
    v_fma_f32 v19, v19, v57, v56
    v_fma_f32 v20, v20, v57, v56
    v_fma_f32 v21, v21, v57, v56
    v_fma_f32 v22, v22, v57, v56
    v_fma_f32 v23, v23, v57, v56
    v_fma_f32 v24, v24, v57, v56
    v_fma_f32 v25, v25, v57, v56
    v_fma_f32 v26, v26, v57, v56
    v_mov_b32 v27, 0
    v_permlane16_swap_b32 v18, v19
    v_permlane16_swap_b32 v20, v21
    v_permlane16_swap_b32 v22, v23
    v_permlane16_swap_b32 v24, v25
    v_permlane16_swap_b32 v26, v27
    v_cvt_pk_bf16_f32 v28, v18, v19
    v_cvt_pk_bf16_f32 v29, v20, v21
    v_cvt_pk_bf16_f32 v30, v22, v23
    v_cvt_pk_bf16_f32 v31, v24, v25
    v_cvt_pk_bf16_f32 v32, v26, v27
    v_mov_b32 v33, 0
    v_permlane32_swap_b32 v28, v29
    v_permlane32_swap_b32 v30, v31
    v_permlane32_swap_b32 v32, v33
    s_mul_i32 s50, s38, 1536
    ds_write_b64 v121, v[28:29]
    ds_write_b64 v121, v[30:31] offset:4096
    s_mov_b64 exec, 0xffff
    ds_write_b64 v121, v[32:33] offset:8192
    s_mov_b64 exec, -1
    s_add_u32 s50, s50, 13631488
    v_lshlrev_b32 v2, 4, v0
    v_add_u32 v3, 8192, v2
    v_add_u32 v4, 8192, v109
    s_waitcnt lgkmcnt(0)
    s_barrier
    s_cmp_lt_u32 s3, 4
    s_cbranch_scc0 f_h2none
    ds_read_b128 v[28:31], v2 offset:61696
    ds_read_b128 v[32:35], v3 offset:57600
    s_cmp_eq_u32 s3, 1
    s_cbranch_scc0 f_h2one
    ds_read_b128 v[36:39], v4 offset:61696
    s_waitcnt lgkmcnt(0)
    buffer_store_dwordx4 v[36:39], v123, s[28:31], s50 offen sc1
f_h2one:
    s_waitcnt lgkmcnt(1)
    buffer_store_dwordx4 v[28:31], v122, s[28:31], s50 offen sc1
    s_waitcnt lgkmcnt(0)
    buffer_store_dwordx4 v[32:35], v118, s[28:31], s50 offen sc1
    s_waitcnt vmcnt(0)
f_h2none:
    v_mov_b32 v3, 1
    s_lshl_b32 s50, s38, 10
    s_add_u32 s50, s50, 262400
    s_barrier
    s_cmp_eq_u32 s3, 0
    s_cbranch_scc0 t_noflag
    s_mov_b64 exec, 1
    buffer_store_dword v3, off, s[28:31], s50 sc1
    s_mov_b64 exec, -1
t_noflag:
    s_cmp_ge_u32 s2, 216
    s_cbranch_scc1 t_spare
    s_cmp_lt_u32 s3, 4
    s_cbranch_scc1 t_cons
    s_mul_i32 s4, s39, 3072
    s_add_u32 m0, s4, 12288
    s_nop 0
    buffer_load_dwordx4 v14, s[28:31], s61 offen offset:0 lds
    buffer_load_dwordx4 v14, s[28:31], s61 offen offset:1024 lds
    buffer_load_dwordx4 v14, s[28:31], s61 offen offset:2048 lds
    s_add_u32 m0, s4, 24576
    s_add_u32 s25, s61, 12288
    buffer_load_dwordx4 v14, s[28:31], s25 offen offset:0 lds
    buffer_load_dwordx4 v14, s[28:31], s25 offen offset:1024 lds
    buffer_load_dwordx4 v14, s[28:31], s25 offen offset:2048 lds
    s_add_u32 m0, s4, 36864
    s_add_u32 s25, s61, 24576
    buffer_load_dwordx4 v14, s[28:31], s25 offen offset:0 lds
    buffer_load_dwordx4 v14, s[28:31], s25 offen offset:1024 lds
    buffer_load_dwordx4 v14, s[28:31], s25 offen offset:2048 lds
    s_add_u32 m0, s4, 49152
    s_add_u32 s25, s61, 36864
    buffer_load_dwordx4 v14, s[28:31], s25 offen offset:0 lds
    buffer_load_dwordx4 v14, s[28:31], s25 offen offset:1024 lds
    buffer_load_dwordx4 v14, s[28:31], s25 offen offset:2048 lds
    v_lshrrev_b32 v2, 1, v1
    v_lshlrev_b32 v2, 13, v2
    v_and_b32 v3, 1, v1
    v_lshl_add_u32 v2, v3, 10, v2
    s_lshl_b32 s50, s39, 11
    s_add_u32 s50, s50, 262400
    s_mul_i32 s4, s39, 3072
    s_sub_u32 s24, s24, 81920
    v_add_u32 v18, s24, v14
    v_add_u32 v19, 65536, v18
    s_mov_b64 s[54:55], 0
    s_mov_b32 s56, 16
    v_add_u32 v16, s4, v14
    s_waitcnt vmcnt(9) lgkmcnt(0)
    s_mov_b32 s51, 0
val_6:
    ds_read_b128 v[24:27], v16 offset:12288
    ds_read_b128 v[28:31], v16 offset:13312
    ds_read_b128 v[32:35], v16 offset:14336
    s_waitcnt lgkmcnt(2)
    v_max3_u32 v24, v24, v25, v26
    v_max_u32 v24, v24, v27
    s_waitcnt lgkmcnt(1)
    v_max3_u32 v28, v28, v29, v30
    v_max3_u32 v28, v28, v31, v24
    s_waitcnt lgkmcnt(0)
    v_max3_u32 v32, v32, v33, v34
    v_max3_u32 v32, v32, v35, v28
    v_cmp_eq_u32 vcc, -1, v32
    s_nop 0
    s_and_b64 exec, vcc, vcc
    s_cbranch_scc0 val_6_ok
    s_cmp_lt_u32 s51, 30000
    s_cbranch_scc0 val_6_ok
    s_cmp_eq_u32 s51, 0
    s_cbranch_scc1 val_6_ns
    s_sleep 2
val_6_ns:
    s_add_u32 s51, s51, 1
    s_add_u32 m0, s4, 12288
    s_nop 0
    buffer_load_dwordx4 v14, s[28:31], s61 offen offset:0 sc1 lds
    buffer_load_dwordx4 v14, s[28:31], s61 offen offset:1024 sc1 lds
    buffer_load_dwordx4 v14, s[28:31], s61 offen offset:2048 sc1 lds
    s_mov_b64 exec, -1
    s_waitcnt vmcnt(0)
    s_branch val_6
val_6_ok:
    s_mov_b64 exec, -1
    s_barrier
    s_add_u32 m0, s24, 0
    s_nop 0
    buffer_load_dwordx4 v9, s[32:35], s60 offen offset:0 lds
    s_add_u32 s45, s60, 35840
    buffer_load_dwordx4 v9, s[32:35], s45 offen offset:1024 lds
    s_add_u32 s46, s60, 71680
    buffer_load_dwordx4 v10, s[32:35], s46 offen offset:2048 lds
    s_add_u32 s44, s60, 107520
    buffer_load_dwordx4 v10, s[32:35], s44 offen offset:3072 lds
    s_add_u32 m0, s4, 0
    s_add_u32 s25, s61, 49152
    buffer_load_dwordx4 v14, s[28:31], s25 offen offset:0 lds
    buffer_load_dwordx4 v14, s[28:31], s25 offen offset:1024 lds
    buffer_load_dwordx4 v14, s[28:31], s25 offen offset:2048 lds
    s_waitcnt vmcnt(13) lgkmcnt(0)
    s_mov_b32 s51, 0
val_7:
    ds_read_b128 v[24:27], v16 offset:24576
    ds_read_b128 v[28:31], v16 offset:25600
    ds_read_b128 v[32:35], v16 offset:26624
    s_waitcnt lgkmcnt(2)
    v_max3_u32 v24, v24, v25, v26
    v_max_u32 v24, v24, v27
    s_waitcnt lgkmcnt(1)
    v_max3_u32 v28, v28, v29, v30
    v_max3_u32 v28, v28, v31, v24
    s_waitcnt lgkmcnt(0)
    v_max3_u32 v32, v32, v33, v34
    v_max3_u32 v32, v32, v35, v28
    v_cmp_eq_u32 vcc, -1, v32
    s_nop 0
    s_and_b64 exec, vcc, vcc
    s_cbranch_scc0 val_7_ok
    s_cmp_lt_u32 s51, 30000
    s_cbranch_scc0 val_7_ok
    s_cmp_eq_u32 s51, 0
    s_cbranch_scc1 val_7_ns
    s_sleep 2
val_7_ns:
    s_add_u32 s51, s51, 1
    s_add_u32 m0, s4, 24576
    s_add_u32 s25, s61, 12288
    buffer_load_dwordx4 v14, s[28:31], s25 offen offset:0 sc1 lds
    buffer_load_dwordx4 v14, s[28:31], s25 offen offset:1024 sc1 lds
    buffer_load_dwordx4 v14, s[28:31], s25 offen offset:2048 sc1 lds
    s_mov_b64 exec, -1
    s_waitcnt vmcnt(0)
    s_branch val_7
val_7_ok:
    s_mov_b64 exec, -1
    s_barrier
    s_add_u32 m0, s24, 16384
    s_add_u32 s44, s60, 589824
    buffer_load_dwordx4 v9, s[32:35], s44 offen offset:0 lds
    s_add_u32 s45, s60, 625664
    buffer_load_dwordx4 v9, s[32:35], s45 offen offset:1024 lds
    s_add_u32 s46, s60, 661504
    buffer_load_dwordx4 v10, s[32:35], s46 offen offset:2048 lds
    s_add_u32 s44, s60, 697344
    buffer_load_dwordx4 v10, s[32:35], s44 offen offset:3072 lds
    s_add_u32 m0, s4, 12288
    s_add_u32 s25, s61, 61440
    buffer_load_dwordx4 v14, s[28:31], s25 offen offset:0 lds
    buffer_load_dwordx4 v14, s[28:31], s25 offen offset:1024 lds
    buffer_load_dwordx4 v14, s[28:31], s25 offen offset:2048 lds
    s_waitcnt vmcnt(17) lgkmcnt(0)
    s_mov_b32 s51, 0
val_8:
    ds_read_b128 v[24:27], v16 offset:36864
    ds_read_b128 v[28:31], v16 offset:37888
    ds_read_b128 v[32:35], v16 offset:38912
    s_waitcnt lgkmcnt(2)
    v_max3_u32 v24, v24, v25, v26
    v_max_u32 v24, v24, v27
    s_waitcnt lgkmcnt(1)
    v_max3_u32 v28, v28, v29, v30
    v_max3_u32 v28, v28, v31, v24
    s_waitcnt lgkmcnt(0)
    v_max3_u32 v32, v32, v33, v34
    v_max3_u32 v32, v32, v35, v28
    v_cmp_eq_u32 vcc, -1, v32
    s_nop 0
    s_and_b64 exec, vcc, vcc
    s_cbranch_scc0 val_8_ok
    s_cmp_lt_u32 s51, 30000
    s_cbranch_scc0 val_8_ok
    s_cmp_eq_u32 s51, 0
    s_cbranch_scc1 val_8_ns
    s_sleep 2
val_8_ns:
    s_add_u32 s51, s51, 1
    s_add_u32 m0, s4, 36864
    s_add_u32 s25, s61, 24576
    buffer_load_dwordx4 v14, s[28:31], s25 offen offset:0 sc1 lds
    buffer_load_dwordx4 v14, s[28:31], s25 offen offset:1024 sc1 lds
    buffer_load_dwordx4 v14, s[28:31], s25 offen offset:2048 sc1 lds
    s_mov_b64 exec, -1
    s_waitcnt vmcnt(0)
    s_branch val_8
val_8_ok:
    s_mov_b64 exec, -1
    s_barrier
    s_add_u32 m0, s24, 32768
    s_add_u32 s44, s60, 1179648
    buffer_load_dwordx4 v9, s[32:35], s44 offen offset:0 lds
    s_add_u32 s45, s60, 1215488
    buffer_load_dwordx4 v9, s[32:35], s45 offen offset:1024 lds
    s_add_u32 s46, s60, 1251328
    buffer_load_dwordx4 v10, s[32:35], s46 offen offset:2048 lds
    s_add_u32 s44, s60, 1287168
    buffer_load_dwordx4 v10, s[32:35], s44 offen offset:3072 lds
    s_add_u32 m0, s4, 24576
    s_add_u32 s25, s61, 73728
    buffer_load_dwordx4 v14, s[28:31], s25 offen offset:0 lds
    buffer_load_dwordx4 v14, s[28:31], s25 offen offset:1024 lds
    buffer_load_dwordx4 v14, s[28:31], s25 offen offset:2048 lds
    s_waitcnt vmcnt(21) lgkmcnt(0)
    s_mov_b32 s51, 0
val_9:
    ds_read_b128 v[24:27], v16 offset:49152
    ds_read_b128 v[28:31], v16 offset:50176
    ds_read_b128 v[32:35], v16 offset:51200
    s_waitcnt lgkmcnt(2)
    v_max3_u32 v24, v24, v25, v26
    v_max_u32 v24, v24, v27
    s_waitcnt lgkmcnt(1)
    v_max3_u32 v28, v28, v29, v30
    v_max3_u32 v28, v28, v31, v24
    s_waitcnt lgkmcnt(0)
    v_max3_u32 v32, v32, v33, v34
    v_max3_u32 v32, v32, v35, v28
    v_cmp_eq_u32 vcc, -1, v32
    s_nop 0
    s_and_b64 exec, vcc, vcc
    s_cbranch_scc0 val_9_ok
    s_cmp_lt_u32 s51, 30000
    s_cbranch_scc0 val_9_ok
    s_cmp_eq_u32 s51, 0
    s_cbranch_scc1 val_9_ns
    s_sleep 2
val_9_ns:
    s_add_u32 s51, s51, 1
    s_add_u32 m0, s4, 49152
    s_add_u32 s25, s61, 36864
    buffer_load_dwordx4 v14, s[28:31], s25 offen offset:0 sc1 lds
    buffer_load_dwordx4 v14, s[28:31], s25 offen offset:1024 sc1 lds
    buffer_load_dwordx4 v14, s[28:31], s25 offen offset:2048 sc1 lds
    s_mov_b64 exec, -1
    s_waitcnt vmcnt(0)
    s_branch val_9
val_9_ok:
    s_mov_b64 exec, -1
    s_barrier
    buffer_load_dword v3, v2, s[28:31], s50 offen sc1
    s_add_u32 m0, s24, 49152
    s_add_u32 s44, s60, 1769472
    buffer_load_dwordx4 v9, s[32:35], s44 offen offset:0 lds
    s_add_u32 s45, s60, 1805312
    buffer_load_dwordx4 v9, s[32:35], s45 offen offset:1024 lds
    s_add_u32 s46, s60, 1841152
    buffer_load_dwordx4 v10, s[32:35], s46 offen offset:2048 lds
    s_add_u32 s44, s60, 1876992
    buffer_load_dwordx4 v10, s[32:35], s44 offen offset:3072 lds
    s_add_u32 m0, s4, 36864
    s_add_u32 s25, s61, 86016
    buffer_load_dwordx4 v14, s[28:31], s25 offen offset:0 lds
    buffer_load_dwordx4 v14, s[28:31], s25 offen offset:1024 lds
    buffer_load_dwordx4 v14, s[28:31], s25 offen offset:2048 lds
    s_waitcnt vmcnt(22) lgkmcnt(0)
    s_mov_b32 s51, 0
val_10:
    ds_read_b128 v[24:27], v16 offset:0
    ds_read_b128 v[28:31], v16 offset:1024
    ds_read_b128 v[32:35], v16 offset:2048
    s_waitcnt lgkmcnt(2)
    v_max3_u32 v24, v24, v25, v26
    v_max_u32 v24, v24, v27
    s_waitcnt lgkmcnt(1)
    v_max3_u32 v28, v28, v29, v30
    v_max3_u32 v28, v28, v31, v24
    s_waitcnt lgkmcnt(0)
    v_max3_u32 v32, v32, v33, v34
    v_max3_u32 v32, v32, v35, v28
    v_cmp_eq_u32 vcc, -1, v32
    s_nop 0
    s_and_b64 exec, vcc, vcc
    s_cbranch_scc0 val_10_ok
    s_cmp_lt_u32 s51, 30000
    s_cbranch_scc0 val_10_ok
    s_cmp_eq_u32 s51, 0
    s_cbranch_scc1 val_10_ns
    s_sleep 2
val_10_ns:
    s_add_u32 s51, s51, 1
    s_add_u32 m0, s4, 0
    s_add_u32 s25, s61, 49152
    buffer_load_dwordx4 v14, s[28:31], s25 offen offset:0 sc1 lds
    buffer_load_dwordx4 v14, s[28:31], s25 offen offset:1024 sc1 lds
    buffer_load_dwordx4 v14, s[28:31], s25 offen offset:2048 sc1 lds
    s_mov_b64 exec, -1
    s_waitcnt vmcnt(0)
    s_branch val_10
val_10_ok:
    s_mov_b64 exec, -1
    s_barrier
    s_add_u32 m0, s24, 65536
    s_add_u32 s44, s60, 2359296
    buffer_load_dwordx4 v9, s[32:35], s44 offen offset:0 lds
    s_add_u32 s45, s60, 2395136
    buffer_load_dwordx4 v9, s[32:35], s45 offen offset:1024 lds
    s_add_u32 s46, s60, 2430976
    buffer_load_dwordx4 v10, s[32:35], s46 offen offset:2048 lds
    s_add_u32 s44, s60, 2466816
    buffer_load_dwordx4 v10, s[32:35], s44 offen offset:3072 lds
    s_waitcnt vmcnt(11)
    v_cmp_ne_u32 vcc, 0, v3
    s_nop 0
    s_lshr_b64 s[54:55], vcc, s56
    s_andn2_b64 exec, 0xffff, vcc
    s_cbranch_scc0 g1_skipped_ok
    s_mov_b32 s51, 0
g1_skipped:
    buffer_load_dword v3, v2, s[28:31], s50 offen offset:0 sc1
    s_add_u32 s51, s51, 1
    s_waitcnt vmcnt(0)
    v_cmp_eq_u32 vcc, 0, v3
    s_nop 0
    s_and_b64 exec, vcc, vcc
    s_cbranch_scc0 g1_skipped_ok
    s_sleep 2
    s_cmp_lt_u32 s51, 30000
    s_cbranch_scc1 g1_skipped
g1_skipped_ok:
    s_mov_b64 exec, -1
    s_and_b32 s25, s54, 3
    s_cmp_eq_u32 s25, 3
    s_cbranch_scc1 chk_11_ok
    s_mov_b32 s51, 0
chk_11:
    buffer_load_dword v3, v2, s[28:31], s50 offen sc1
    s_add_u32 s51, s51, 1
    s_mov_b64 exec, -1
    s_waitcnt vmcnt(0)
    v_cmp_ne_u32 vcc, 0, v3
    s_nop 0
    s_lshr_b64 s[54:55], vcc, s56
    s_and_b32 s25, s54, 3
    s_cmp_eq_u32 s25, 3
    s_cbranch_scc1 chk_11_ok
    s_sleep 1
    s_lshl_b64 exec, 0xff, s56
    s_cmp_lt_u32 s51, 30000
    s_cbranch_scc1 chk_11
    s_mov_b64 exec, -1
chk_11_ok:
    s_lshr_b64 s[54:55], s[54:55], 2
    s_add_u32 s56, s56, 2
    s_add_u32 m0, s4, 49152
    s_add_u32 s25, s61, 98304
    buffer_load_dwordx4 v14, s[28:31], s25 offen offset:0 lds
    buffer_load_dwordx4 v14, s[28:31], s25 offen offset:1024 lds
    buffer_load_dwordx4 v14, s[28:31], s25 offen offset:2048 lds
    s_waitcnt vmcnt(22) lgkmcnt(0)
    s_mov_b32 s51, 0
val_12:
    ds_read_b128 v[24:27], v16 offset:12288
    ds_read_b128 v[28:31], v16 offset:13312
    ds_read_b128 v[32:35], v16 offset:14336
    s_waitcnt lgkmcnt(2)
    v_max3_u32 v24, v24, v25, v26
    v_max_u32 v24, v24, v27
    s_waitcnt lgkmcnt(1)
    v_max3_u32 v28, v28, v29, v30
    v_max3_u32 v28, v28, v31, v24
    s_waitcnt lgkmcnt(0)
    v_max3_u32 v32, v32, v33, v34
    v_max3_u32 v32, v32, v35, v28
    v_cmp_eq_u32 vcc, -1, v32
    s_nop 0
    s_and_b64 exec, vcc, vcc
    s_cbranch_scc0 val_12_ok
    s_cmp_lt_u32 s51, 30000
    s_cbranch_scc0 val_12_ok
    s_cmp_eq_u32 s51, 0
    s_cbranch_scc1 val_12_ns
    s_sleep 2
val_12_ns:
    s_add_u32 s51, s51, 1
    s_add_u32 m0, s4, 12288
    s_add_u32 s25, s61, 61440
    buffer_load_dwordx4 v14, s[28:31], s25 offen offset:0 sc1 lds
    buffer_load_dwordx4 v14, s[28:31], s25 offen offset:1024 sc1 lds
    buffer_load_dwordx4 v14, s[28:31], s25 offen offset:2048 sc1 lds
    s_mov_b64 exec, -1
    s_waitcnt vmcnt(0)
    s_branch val_12
val_12_ok:
    s_mov_b64 exec, -1
    s_barrier
    s_add_u32 m0, s24, 0
    s_add_u32 s44, s60, 2949120
    buffer_load_dwordx4 v9, s[32:35], s44 offen offset:0 lds
    s_add_u32 s45, s60, 2984960
    buffer_load_dwordx4 v9, s[32:35], s45 offen offset:1024 lds
    s_add_u32 s46, s60, 3020800
    buffer_load_dwordx4 v10, s[32:35], s46 offen offset:2048 lds
    s_add_u32 s44, s60, 3056640
    buffer_load_dwordx4 v10, s[32:35], s44 offen offset:3072 lds
    s_and_b32 s25, s54, 3
    s_cmp_eq_u32 s25, 3
    s_cbranch_scc1 chk_13_ok
    s_mov_b32 s51, 0
chk_13:
    buffer_load_dword v3, v2, s[28:31], s50 offen sc1
    s_add_u32 s51, s51, 1
    s_mov_b64 exec, -1
    s_waitcnt vmcnt(0)
    v_cmp_ne_u32 vcc, 0, v3
    s_nop 0
    s_lshr_b64 s[54:55], vcc, s56
    s_and_b32 s25, s54, 3
    s_cmp_eq_u32 s25, 3
    s_cbranch_scc1 chk_13_ok
    s_sleep 1
    s_lshl_b64 exec, 0xff, s56
    s_cmp_lt_u32 s51, 30000
    s_cbranch_scc1 chk_13
    s_mov_b64 exec, -1
chk_13_ok:
    s_lshr_b64 s[54:55], s[54:55], 2
    s_add_u32 s56, s56, 2
    s_add_u32 m0, s4, 0
    s_add_u32 s25, s61, 110592
    buffer_load_dwordx4 v14, s[28:31], s25 offen offset:0 lds
    buffer_load_dwordx4 v14, s[28:31], s25 offen offset:1024 lds
    buffer_load_dwordx4 v14, s[28:31], s25 offen offset:2048 lds
    s_waitcnt vmcnt(22) lgkmcnt(0)
    s_mov_b32 s51, 0
val_14:
    ds_read_b128 v[24:27], v16 offset:24576
    ds_read_b128 v[28:31], v16 offset:25600
    ds_read_b128 v[32:35], v16 offset:26624
    s_waitcnt lgkmcnt(2)
    v_max3_u32 v24, v24, v25, v26
    v_max_u32 v24, v24, v27
    s_waitcnt lgkmcnt(1)
    v_max3_u32 v28, v28, v29, v30
    v_max3_u32 v28, v28, v31, v24
    s_waitcnt lgkmcnt(0)
    v_max3_u32 v32, v32, v33, v34
    v_max3_u32 v32, v32, v35, v28
    v_cmp_eq_u32 vcc, -1, v32
    s_nop 0
    s_and_b64 exec, vcc, vcc
    s_cbranch_scc0 val_14_ok
    s_cmp_lt_u32 s51, 30000
    s_cbranch_scc0 val_14_ok
    s_cmp_eq_u32 s51, 0
    s_cbranch_scc1 val_14_ns
    s_sleep 2
val_14_ns:
    s_add_u32 s51, s51, 1
    s_add_u32 m0, s4, 24576
    s_add_u32 s25, s61, 73728
    buffer_load_dwordx4 v14, s[28:31], s25 offen offset:0 sc1 lds
    buffer_load_dwordx4 v14, s[28:31], s25 offen offset:1024 sc1 lds
    buffer_load_dwordx4 v14, s[28:31], s25 offen offset:2048 sc1 lds
    s_mov_b64 exec, -1
    s_waitcnt vmcnt(0)
    s_branch val_14
val_14_ok:
    s_mov_b64 exec, -1
    s_barrier
    s_add_u32 m0, s24, 16384
    s_add_u32 s44, s60, 3538944
    buffer_load_dwordx4 v9, s[32:35], s44 offen offset:0 lds
    s_add_u32 s45, s60, 3574784
    buffer_load_dwordx4 v9, s[32:35], s45 offen offset:1024 lds
    s_add_u32 s46, s60, 3610624
    buffer_load_dwordx4 v10, s[32:35], s46 offen offset:2048 lds
    s_add_u32 s44, s60, 3646464
    buffer_load_dwordx4 v10, s[32:35], s44 offen offset:3072 lds
    s_and_b32 s25, s54, 3
    s_cmp_eq_u32 s25, 3
    s_cbranch_scc1 chk_15_ok
    s_mov_b32 s51, 0
chk_15:
    buffer_load_dword v3, v2, s[28:31], s50 offen sc1
    s_add_u32 s51, s51, 1
    s_mov_b64 exec, -1
    s_waitcnt vmcnt(0)
    v_cmp_ne_u32 vcc, 0, v3
    s_nop 0
    s_lshr_b64 s[54:55], vcc, s56
    s_and_b32 s25, s54, 3
    s_cmp_eq_u32 s25, 3
    s_cbranch_scc1 chk_15_ok
    s_sleep 1
    s_lshl_b64 exec, 0xff, s56
    s_cmp_lt_u32 s51, 30000
    s_cbranch_scc1 chk_15
    s_mov_b64 exec, -1
chk_15_ok:
    s_lshr_b64 s[54:55], s[54:55], 2
    s_add_u32 s56, s56, 2
    s_add_u32 m0, s4, 12288
    s_add_u32 s25, s61, 122880
    buffer_load_dwordx4 v14, s[28:31], s25 offen offset:0 lds
    buffer_load_dwordx4 v14, s[28:31], s25 offen offset:1024 lds
    buffer_load_dwordx4 v14, s[28:31], s25 offen offset:2048 lds
    s_waitcnt vmcnt(21) lgkmcnt(0)
    s_mov_b32 s51, 0
val_16:
    ds_read_b128 v[24:27], v16 offset:36864
    ds_read_b128 v[28:31], v16 offset:37888
    ds_read_b128 v[32:35], v16 offset:38912
    s_waitcnt lgkmcnt(2)
    v_max3_u32 v24, v24, v25, v26
    v_max_u32 v24, v24, v27
    s_waitcnt lgkmcnt(1)
    v_max3_u32 v28, v28, v29, v30
    v_max3_u32 v28, v28, v31, v24
    s_waitcnt lgkmcnt(0)
    v_max3_u32 v32, v32, v33, v34
    v_max3_u32 v32, v32, v35, v28
    v_cmp_eq_u32 vcc, -1, v32
    s_nop 0
    s_and_b64 exec, vcc, vcc
    s_cbranch_scc0 val_16_ok
    s_cmp_lt_u32 s51, 30000
    s_cbranch_scc0 val_16_ok
    s_cmp_eq_u32 s51, 0
    s_cbranch_scc1 val_16_ns
    s_sleep 2
val_16_ns:
    s_add_u32 s51, s51, 1
    s_add_u32 m0, s4, 36864
    s_add_u32 s25, s61, 86016
    buffer_load_dwordx4 v14, s[28:31], s25 offen offset:0 sc1 lds
    buffer_load_dwordx4 v14, s[28:31], s25 offen offset:1024 sc1 lds
    buffer_load_dwordx4 v14, s[28:31], s25 offen offset:2048 sc1 lds
    s_mov_b64 exec, -1
    s_waitcnt vmcnt(0)
    s_branch val_16
val_16_ok:
    s_mov_b64 exec, -1
    s_barrier
    s_add_u32 m0, s24, 32768
    s_add_u32 s44, s60, 4128768
    buffer_load_dwordx4 v9, s[32:35], s44 offen offset:0 lds
    s_add_u32 s45, s60, 4164608
    buffer_load_dwordx4 v9, s[32:35], s45 offen offset:1024 lds
    s_add_u32 s46, s60, 4200448
    buffer_load_dwordx4 v10, s[32:35], s46 offen offset:2048 lds
    s_add_u32 s44, s60, 4236288
    buffer_load_dwordx4 v10, s[32:35], s44 offen offset:3072 lds
    s_and_b32 s25, s54, 3
    s_cmp_eq_u32 s25, 3
    s_cbranch_scc1 chk_17_ok
    s_mov_b32 s51, 0
chk_17:
    buffer_load_dword v3, v2, s[28:31], s50 offen sc1
    s_add_u32 s51, s51, 1
    s_mov_b64 exec, -1
    s_waitcnt vmcnt(0)
    v_cmp_ne_u32 vcc, 0, v3
    s_nop 0
    s_lshr_b64 s[54:55], vcc, s56
    s_and_b32 s25, s54, 3
    s_cmp_eq_u32 s25, 3
    s_cbranch_scc1 chk_17_ok
    s_sleep 1
    s_lshl_b64 exec, 0xff, s56
    s_cmp_lt_u32 s51, 30000
    s_cbranch_scc1 chk_17
    s_mov_b64 exec, -1
chk_17_ok:
    s_lshr_b64 s[54:55], s[54:55], 2
    s_add_u32 s56, s56, 2
    s_add_u32 m0, s4, 24576
    s_add_u32 s25, s61, 135168
    buffer_load_dwordx4 v14, s[28:31], s25 offen offset:0 lds
    buffer_load_dwordx4 v14, s[28:31], s25 offen offset:1024 lds
    buffer_load_dwordx4 v14, s[28:31], s25 offen offset:2048 lds
    s_waitcnt vmcnt(21) lgkmcnt(0)
    s_barrier
    s_add_u32 m0, s24, 49152
    s_add_u32 s44, s60, 4718592
    buffer_load_dwordx4 v9, s[32:35], s44 offen offset:0 lds
    s_add_u32 s45, s60, 4754432
    buffer_load_dwordx4 v9, s[32:35], s45 offen offset:1024 lds
    s_add_u32 s46, s60, 4790272
    buffer_load_dwordx4 v10, s[32:35], s46 offen offset:2048 lds
    s_add_u32 s44, s60, 4826112
    buffer_load_dwordx4 v10, s[32:35], s44 offen offset:3072 lds
    s_and_b32 s25, s54, 3
    s_cmp_eq_u32 s25, 3
    s_cbranch_scc1 chk_18_ok
    s_mov_b32 s51, 0
chk_18:
    buffer_load_dword v3, v2, s[28:31], s50 offen sc1
    s_add_u32 s51, s51, 1
    s_mov_b64 exec, -1
    s_waitcnt vmcnt(0)
    v_cmp_ne_u32 vcc, 0, v3
    s_nop 0
    s_lshr_b64 s[54:55], vcc, s56
    s_and_b32 s25, s54, 3
    s_cmp_eq_u32 s25, 3
    s_cbranch_scc1 chk_18_ok
    s_sleep 1
    s_lshl_b64 exec, 0xff, s56
    s_cmp_lt_u32 s51, 30000
    s_cbranch_scc1 chk_18
    s_mov_b64 exec, -1
chk_18_ok:
    s_lshr_b64 s[54:55], s[54:55], 2
    s_add_u32 s56, s56, 2
    s_add_u32 m0, s4, 36864
    s_add_u32 s25, s61, 147456
    buffer_load_dwordx4 v14, s[28:31], s25 offen offset:0 lds
    buffer_load_dwordx4 v14, s[28:31], s25 offen offset:1024 lds
    buffer_load_dwordx4 v14, s[28:31], s25 offen offset:2048 lds
    s_waitcnt vmcnt(21) lgkmcnt(0)
    s_barrier
    s_add_u32 m0, s24, 65536
    s_add_u32 s44, s60, 5308416
    buffer_load_dwordx4 v9, s[32:35], s44 offen offset:0 lds
    s_add_u32 s45, s60, 5344256
    buffer_load_dwordx4 v9, s[32:35], s45 offen offset:1024 lds
    s_add_u32 s46, s60, 5380096
    buffer_load_dwordx4 v10, s[32:35], s46 offen offset:2048 lds
    s_add_u32 s44, s60, 5415936
    buffer_load_dwordx4 v10, s[32:35], s44 offen offset:3072 lds
    s_and_b32 s25, s54, 3
    s_cmp_eq_u32 s25, 3
    s_cbranch_scc1 chk_19_ok
    s_mov_b32 s51, 0
chk_19:
    buffer_load_dword v3, v2, s[28:31], s50 offen sc1
    s_add_u32 s51, s51, 1
    s_mov_b64 exec, -1
    s_waitcnt vmcnt(0)
    v_cmp_ne_u32 vcc, 0, v3
    s_nop 0
    s_lshr_b64 s[54:55], vcc, s56
    s_and_b32 s25, s54, 3
    s_cmp_eq_u32 s25, 3
    s_cbranch_scc1 chk_19_ok
    s_sleep 1
    s_lshl_b64 exec, 0xff, s56
    s_cmp_lt_u32 s51, 30000
    s_cbranch_scc1 chk_19
    s_mov_b64 exec, -1
chk_19_ok:
    s_lshr_b64 s[54:55], s[54:55], 2
    s_add_u32 s56, s56, 2
    s_add_u32 m0, s4, 49152
    s_add_u32 s25, s61, 159744
    buffer_load_dwordx4 v14, s[28:31], s25 offen offset:0 lds
    buffer_load_dwordx4 v14, s[28:31], s25 offen offset:1024 lds
    buffer_load_dwordx4 v14, s[28:31], s25 offen offset:2048 lds
    s_waitcnt vmcnt(21) lgkmcnt(0)
    s_barrier
    s_add_u32 m0, s24, 0
    s_add_u32 s44, s60, 5898240
    buffer_load_dwordx4 v9, s[32:35], s44 offen offset:0 lds
    s_add_u32 s45, s60, 5934080
    buffer_load_dwordx4 v9, s[32:35], s45 offen offset:1024 lds
    s_add_u32 s46, s60, 5969920
    buffer_load_dwordx4 v10, s[32:35], s46 offen offset:2048 lds
    s_add_u32 s44, s60, 6005760
    buffer_load_dwordx4 v10, s[32:35], s44 offen offset:3072 lds
    s_and_b32 s25, s54, 3
    s_cmp_eq_u32 s25, 3
    s_cbranch_scc1 chk_20_ok
    s_mov_b32 s51, 0
chk_20:
    buffer_load_dword v3, v2, s[28:31], s50 offen sc1
    s_add_u32 s51, s51, 1
    s_mov_b64 exec, -1
    s_waitcnt vmcnt(0)
    v_cmp_ne_u32 vcc, 0, v3
    s_nop 0
    s_lshr_b64 s[54:55], vcc, s56
    s_and_b32 s25, s54, 3
    s_cmp_eq_u32 s25, 3
    s_cbranch_scc1 chk_20_ok
    s_sleep 1
    s_lshl_b64 exec, 0xff, s56
    s_cmp_lt_u32 s51, 30000
    s_cbranch_scc1 chk_20
    s_mov_b64 exec, -1
chk_20_ok:
    s_lshr_b64 s[54:55], s[54:55], 2
    s_add_u32 s56, s56, 2
    s_add_u32 m0, s4, 0
    s_add_u32 s25, s61, 172032
    buffer_load_dwordx4 v14, s[28:31], s25 offen offset:0 lds
    buffer_load_dwordx4 v14, s[28:31], s25 offen offset:1024 lds
    buffer_load_dwordx4 v14, s[28:31], s25 offen offset:2048 lds
    s_waitcnt vmcnt(21) lgkmcnt(0)
    s_barrier
    s_add_u32 m0, s24, 16384
    s_add_u32 s44, s60, 6488064
    buffer_load_dwordx4 v9, s[32:35], s44 offen offset:0 lds
    s_add_u32 s45, s60, 6523904
    buffer_load_dwordx4 v9, s[32:35], s45 offen offset:1024 lds
    s_add_u32 s46, s60, 6559744
    buffer_load_dwordx4 v10, s[32:35], s46 offen offset:2048 lds
    s_add_u32 s44, s60, 6595584
    buffer_load_dwordx4 v10, s[32:35], s44 offen offset:3072 lds
    s_and_b32 s25, s54, 3
    s_cmp_eq_u32 s25, 3
    s_cbranch_scc1 chk_21_ok
    s_mov_b32 s51, 0
chk_21:
    buffer_load_dword v3, v2, s[28:31], s50 offen sc1
    s_add_u32 s51, s51, 1
    s_mov_b64 exec, -1
    s_waitcnt vmcnt(0)
    v_cmp_ne_u32 vcc, 0, v3
    s_nop 0
    s_lshr_b64 s[54:55], vcc, s56
    s_and_b32 s25, s54, 3
    s_cmp_eq_u32 s25, 3
    s_cbranch_scc1 chk_21_ok
    s_sleep 1
    s_lshl_b64 exec, 0xff, s56
    s_cmp_lt_u32 s51, 30000
    s_cbranch_scc1 chk_21
    s_mov_b64 exec, -1
chk_21_ok:
    s_lshr_b64 s[54:55], s[54:55], 2
    s_add_u32 s56, s56, 2
    s_add_u32 m0, s4, 12288
    s_add_u32 s25, s61, 184320
    buffer_load_dwordx4 v14, s[28:31], s25 offen offset:0 lds
    buffer_load_dwordx4 v14, s[28:31], s25 offen offset:1024 lds
    buffer_load_dwordx4 v14, s[28:31], s25 offen offset:2048 lds
    s_waitcnt vmcnt(21) lgkmcnt(0)
    s_barrier
    s_add_u32 m0, s24, 32768
    s_add_u32 s44, s60, 7077888
    buffer_load_dwordx4 v9, s[32:35], s44 offen offset:0 lds
    s_add_u32 s45, s60, 7113728
    buffer_load_dwordx4 v9, s[32:35], s45 offen offset:1024 lds
    s_add_u32 s46, s60, 7149568
    buffer_load_dwordx4 v10, s[32:35], s46 offen offset:2048 lds
    s_add_u32 s44, s60, 7185408
    buffer_load_dwordx4 v10, s[32:35], s44 offen offset:3072 lds
    s_and_b32 s25, s54, 3
    s_cmp_eq_u32 s25, 3
    s_cbranch_scc1 chk_22_ok
    s_mov_b32 s51, 0
chk_22:
    buffer_load_dword v3, v2, s[28:31], s50 offen sc1
    s_add_u32 s51, s51, 1
    s_mov_b64 exec, -1
    s_waitcnt vmcnt(0)
    v_cmp_ne_u32 vcc, 0, v3
    s_nop 0
    s_lshr_b64 s[54:55], vcc, s56
    s_and_b32 s25, s54, 3
    s_cmp_eq_u32 s25, 3
    s_cbranch_scc1 chk_22_ok
    s_sleep 1
    s_lshl_b64 exec, 0xff, s56
    s_cmp_lt_u32 s51, 30000
    s_cbranch_scc1 chk_22
    s_mov_b64 exec, -1
chk_22_ok:
    s_lshr_b64 s[54:55], s[54:55], 2
    s_add_u32 s56, s56, 2
    s_add_u32 m0, s4, 24576
    s_add_u32 s25, s61, 196608
    buffer_load_dwordx4 v14, s[28:31], s25 offen offset:0 lds
    buffer_load_dwordx4 v14, s[28:31], s25 offen offset:1024 lds
    buffer_load_dwordx4 v14, s[28:31], s25 offen offset:2048 lds
    s_waitcnt vmcnt(21) lgkmcnt(0)
    s_barrier
    s_add_u32 m0, s24, 49152
    s_add_u32 s44, s60, 7667712
    buffer_load_dwordx4 v9, s[32:35], s44 offen offset:0 lds
    s_add_u32 s45, s60, 7703552
    buffer_load_dwordx4 v9, s[32:35], s45 offen offset:1024 lds
    s_add_u32 s46, s60, 7739392
    buffer_load_dwordx4 v10, s[32:35], s46 offen offset:2048 lds
    s_add_u32 s44, s60, 7775232
    buffer_load_dwordx4 v10, s[32:35], s44 offen offset:3072 lds
    s_and_b32 s25, s54, 3
    s_cmp_eq_u32 s25, 3
    s_cbranch_scc1 chk_23_ok
    s_mov_b32 s51, 0
chk_23:
    buffer_load_dword v3, v2, s[28:31], s50 offen sc1
    s_add_u32 s51, s51, 1
    s_mov_b64 exec, -1
    s_waitcnt vmcnt(0)
    v_cmp_ne_u32 vcc, 0, v3
    s_nop 0
    s_lshr_b64 s[54:55], vcc, s56
    s_and_b32 s25, s54, 3
    s_cmp_eq_u32 s25, 3
    s_cbranch_scc1 chk_23_ok
    s_sleep 1
    s_lshl_b64 exec, 0xff, s56
    s_cmp_lt_u32 s51, 30000
    s_cbranch_scc1 chk_23
    s_mov_b64 exec, -1
chk_23_ok:
    s_lshr_b64 s[54:55], s[54:55], 2
    s_add_u32 s56, s56, 2
    s_add_u32 m0, s4, 36864
    s_add_u32 s25, s61, 208896
    buffer_load_dwordx4 v14, s[28:31], s25 offen offset:0 lds
    buffer_load_dwordx4 v14, s[28:31], s25 offen offset:1024 lds
    buffer_load_dwordx4 v14, s[28:31], s25 offen offset:2048 lds
    s_waitcnt vmcnt(21) lgkmcnt(0)
    s_barrier
    s_add_u32 m0, s24, 65536
    s_add_u32 s44, s60, 8257536
    buffer_load_dwordx4 v9, s[32:35], s44 offen offset:0 lds
    s_add_u32 s45, s60, 8293376
    buffer_load_dwordx4 v9, s[32:35], s45 offen offset:1024 lds
    s_add_u32 s46, s60, 8329216
    buffer_load_dwordx4 v10, s[32:35], s46 offen offset:2048 lds
    s_add_u32 s44, s60, 8365056
    buffer_load_dwordx4 v10, s[32:35], s44 offen offset:3072 lds
    s_and_b32 s25, s54, 3
    s_cmp_eq_u32 s25, 3
    s_cbranch_scc1 chk_24_ok
    s_mov_b32 s51, 0
chk_24:
    buffer_load_dword v3, v2, s[28:31], s50 offen sc1
    s_add_u32 s51, s51, 1
    s_mov_b64 exec, -1
    s_waitcnt vmcnt(0)
    v_cmp_ne_u32 vcc, 0, v3
    s_nop 0
    s_lshr_b64 s[54:55], vcc, s56
    s_and_b32 s25, s54, 3
    s_cmp_eq_u32 s25, 3
    s_cbranch_scc1 chk_24_ok
    s_sleep 1
    s_lshl_b64 exec, 0xff, s56
    s_cmp_lt_u32 s51, 30000
    s_cbranch_scc1 chk_24
    s_mov_b64 exec, -1
chk_24_ok:
    s_lshr_b64 s[54:55], s[54:55], 2
    s_add_u32 s56, s56, 2
    s_add_u32 m0, s4, 49152
    s_add_u32 s25, s61, 221184
    buffer_load_dwordx4 v14, s[28:31], s25 offen offset:0 lds
    buffer_load_dwordx4 v14, s[28:31], s25 offen offset:1024 lds
    buffer_load_dwordx4 v14, s[28:31], s25 offen offset:2048 lds
    s_waitcnt vmcnt(21) lgkmcnt(0)
    s_barrier
    s_add_u32 m0, s24, 0
    s_add_u32 s44, s60, 8847360
    buffer_load_dwordx4 v9, s[32:35], s44 offen offset:0 lds
    s_add_u32 s45, s60, 8883200
    buffer_load_dwordx4 v9, s[32:35], s45 offen offset:1024 lds
    s_add_u32 s46, s60, 8919040
    buffer_load_dwordx4 v10, s[32:35], s46 offen offset:2048 lds
    s_add_u32 s44, s60, 8954880
    buffer_load_dwordx4 v10, s[32:35], s44 offen offset:3072 lds
    s_and_b32 s25, s54, 3
    s_cmp_eq_u32 s25, 3
    s_cbranch_scc1 chk_25_ok
    s_mov_b32 s51, 0
chk_25:
    buffer_load_dword v3, v2, s[28:31], s50 offen sc1
    s_add_u32 s51, s51, 1
    s_mov_b64 exec, -1
    s_waitcnt vmcnt(0)
    v_cmp_ne_u32 vcc, 0, v3
    s_nop 0
    s_lshr_b64 s[54:55], vcc, s56
    s_and_b32 s25, s54, 3
    s_cmp_eq_u32 s25, 3
    s_cbranch_scc1 chk_25_ok
    s_sleep 1
    s_lshl_b64 exec, 0xff, s56
    s_cmp_lt_u32 s51, 30000
    s_cbranch_scc1 chk_25
    s_mov_b64 exec, -1
chk_25_ok:
    s_lshr_b64 s[54:55], s[54:55], 2
    s_add_u32 s56, s56, 2
    s_add_u32 m0, s4, 0
    s_add_u32 s25, s61, 233472
    buffer_load_dwordx4 v14, s[28:31], s25 offen offset:0 lds
    buffer_load_dwordx4 v14, s[28:31], s25 offen offset:1024 lds
    buffer_load_dwordx4 v14, s[28:31], s25 offen offset:2048 lds
    s_waitcnt vmcnt(21) lgkmcnt(0)
    s_barrier
    s_add_u32 m0, s24, 16384
    s_add_u32 s44, s60, 9437184
    buffer_load_dwordx4 v9, s[32:35], s44 offen offset:0 lds
    s_add_u32 s45, s60, 9473024
    buffer_load_dwordx4 v9, s[32:35], s45 offen offset:1024 lds
    s_add_u32 s46, s60, 9508864
    buffer_load_dwordx4 v10, s[32:35], s46 offen offset:2048 lds
    s_add_u32 s44, s60, 9544704
    buffer_load_dwordx4 v10, s[32:35], s44 offen offset:3072 lds
    s_and_b32 s25, s54, 3
    s_cmp_eq_u32 s25, 3
    s_cbranch_scc1 chk_26_ok
    s_mov_b32 s51, 0
chk_26:
    buffer_load_dword v3, v2, s[28:31], s50 offen sc1
    s_add_u32 s51, s51, 1
    s_mov_b64 exec, -1
    s_waitcnt vmcnt(0)
    v_cmp_ne_u32 vcc, 0, v3
    s_nop 0
    s_lshr_b64 s[54:55], vcc, s56
    s_and_b32 s25, s54, 3
    s_cmp_eq_u32 s25, 3
    s_cbranch_scc1 chk_26_ok
    s_sleep 1
    s_lshl_b64 exec, 0xff, s56
    s_cmp_lt_u32 s51, 30000
    s_cbranch_scc1 chk_26
    s_mov_b64 exec, -1
chk_26_ok:
    s_lshr_b64 s[54:55], s[54:55], 2
    s_add_u32 s56, s56, 2
    s_add_u32 m0, s4, 12288
    s_add_u32 s25, s61, 245760
    buffer_load_dwordx4 v14, s[28:31], s25 offen offset:0 lds
    buffer_load_dwordx4 v14, s[28:31], s25 offen offset:1024 lds
    buffer_load_dwordx4 v14, s[28:31], s25 offen offset:2048 lds
    s_waitcnt vmcnt(21) lgkmcnt(0)
    s_barrier
    s_add_u32 m0, s24, 32768
    s_add_u32 s44, s60, 10027008
    buffer_load_dwordx4 v9, s[32:35], s44 offen offset:0 lds
    s_add_u32 s45, s60, 10062848
    buffer_load_dwordx4 v9, s[32:35], s45 offen offset:1024 lds
    s_add_u32 s46, s60, 10098688
    buffer_load_dwordx4 v10, s[32:35], s46 offen offset:2048 lds
    s_add_u32 s44, s60, 10134528
    buffer_load_dwordx4 v10, s[32:35], s44 offen offset:3072 lds
    s_and_b32 s25, s54, 3
    s_cmp_eq_u32 s25, 3
    s_cbranch_scc1 chk_27_ok
    s_mov_b32 s51, 0
chk_27:
    buffer_load_dword v3, v2, s[28:31], s50 offen sc1
    s_add_u32 s51, s51, 1
    s_mov_b64 exec, -1
    s_waitcnt vmcnt(0)
    v_cmp_ne_u32 vcc, 0, v3
    s_nop 0
    s_lshr_b64 s[54:55], vcc, s56
    s_and_b32 s25, s54, 3
    s_cmp_eq_u32 s25, 3
    s_cbranch_scc1 chk_27_ok
    s_sleep 1
    s_lshl_b64 exec, 0xff, s56
    s_cmp_lt_u32 s51, 30000
    s_cbranch_scc1 chk_27
    s_mov_b64 exec, -1
chk_27_ok:
    s_lshr_b64 s[54:55], s[54:55], 2
    s_add_u32 s56, s56, 2
    s_add_u32 m0, s4, 24576
    s_add_u32 s25, s61, 258048
    buffer_load_dwordx4 v14, s[28:31], s25 offen offset:0 lds
    buffer_load_dwordx4 v14, s[28:31], s25 offen offset:1024 lds
    buffer_load_dwordx4 v14, s[28:31], s25 offen offset:2048 lds
    s_waitcnt vmcnt(21) lgkmcnt(0)
    s_barrier
    s_add_u32 m0, s24, 49152
    s_add_u32 s44, s60, 10616832
    buffer_load_dwordx4 v9, s[32:35], s44 offen offset:0 lds
    s_add_u32 s45, s60, 10652672
    buffer_load_dwordx4 v9, s[32:35], s45 offen offset:1024 lds
    s_add_u32 s46, s60, 10688512
    buffer_load_dwordx4 v10, s[32:35], s46 offen offset:2048 lds
    s_add_u32 s44, s60, 10724352
    buffer_load_dwordx4 v10, s[32:35], s44 offen offset:3072 lds
    s_and_b32 s25, s54, 3
    s_cmp_eq_u32 s25, 3
    s_cbranch_scc1 chk_28_ok
    s_mov_b32 s51, 0
chk_28:
    buffer_load_dword v3, v2, s[28:31], s50 offen sc1
    s_add_u32 s51, s51, 1
    s_mov_b64 exec, -1
    s_waitcnt vmcnt(0)
    v_cmp_ne_u32 vcc, 0, v3
    s_nop 0
    s_lshr_b64 s[54:55], vcc, s56
    s_and_b32 s25, s54, 3
    s_cmp_eq_u32 s25, 3
    s_cbranch_scc1 chk_28_ok
    s_sleep 1
    s_lshl_b64 exec, 0xff, s56
    s_cmp_lt_u32 s51, 30000
    s_cbranch_scc1 chk_28
    s_mov_b64 exec, -1
chk_28_ok:
    s_lshr_b64 s[54:55], s[54:55], 2
    s_add_u32 s56, s56, 2
    s_add_u32 m0, s4, 36864
    s_add_u32 s25, s61, 270336
    buffer_load_dwordx4 v14, s[28:31], s25 offen offset:0 lds
    buffer_load_dwordx4 v14, s[28:31], s25 offen offset:1024 lds
    buffer_load_dwordx4 v14, s[28:31], s25 offen offset:2048 lds
    s_waitcnt vmcnt(21) lgkmcnt(0)
    s_barrier
    s_add_u32 m0, s24, 65536
    s_add_u32 s44, s60, 11206656
    buffer_load_dwordx4 v9, s[32:35], s44 offen offset:0 lds
    s_add_u32 s45, s60, 11242496
    buffer_load_dwordx4 v9, s[32:35], s45 offen offset:1024 lds
    s_add_u32 s46, s60, 11278336
    buffer_load_dwordx4 v10, s[32:35], s46 offen offset:2048 lds
    s_add_u32 s44, s60, 11314176
    buffer_load_dwordx4 v10, s[32:35], s44 offen offset:3072 lds
    s_and_b32 s25, s54, 3
    s_cmp_eq_u32 s25, 3
    s_cbranch_scc1 chk_29_ok
    s_mov_b32 s51, 0
chk_29:
    buffer_load_dword v3, v2, s[28:31], s50 offen sc1
    s_add_u32 s51, s51, 1
    s_mov_b64 exec, -1
    s_waitcnt vmcnt(0)
    v_cmp_ne_u32 vcc, 0, v3
    s_nop 0
    s_lshr_b64 s[54:55], vcc, s56
    s_and_b32 s25, s54, 3
    s_cmp_eq_u32 s25, 3
    s_cbranch_scc1 chk_29_ok
    s_sleep 1
    s_lshl_b64 exec, 0xff, s56
    s_cmp_lt_u32 s51, 30000
    s_cbranch_scc1 chk_29
    s_mov_b64 exec, -1
chk_29_ok:
    s_lshr_b64 s[54:55], s[54:55], 2
    s_add_u32 s56, s56, 2
    s_add_u32 m0, s4, 49152
    s_add_u32 s25, s61, 282624
    buffer_load_dwordx4 v14, s[28:31], s25 offen offset:0 lds
    buffer_load_dwordx4 v14, s[28:31], s25 offen offset:1024 lds
    buffer_load_dwordx4 v14, s[28:31], s25 offen offset:2048 lds
    s_waitcnt vmcnt(21) lgkmcnt(0)
    s_barrier
    s_add_u32 m0, s24, 0
    s_add_u32 s44, s60, 11796480
    buffer_load_dwordx4 v9, s[32:35], s44 offen offset:0 lds
    s_add_u32 s45, s60, 11832320
    buffer_load_dwordx4 v9, s[32:35], s45 offen offset:1024 lds
    s_add_u32 s46, s60, 11868160
    buffer_load_dwordx4 v10, s[32:35], s46 offen offset:2048 lds
    s_add_u32 s44, s60, 11904000
    buffer_load_dwordx4 v10, s[32:35], s44 offen offset:3072 lds
    s_and_b32 s25, s54, 3
    s_cmp_eq_u32 s25, 3
    s_cbranch_scc1 chk_30_ok
    s_mov_b32 s51, 0
chk_30:
    buffer_load_dword v3, v2, s[28:31], s50 offen sc1
    s_add_u32 s51, s51, 1
    s_mov_b64 exec, -1
    s_waitcnt vmcnt(0)
    v_cmp_ne_u32 vcc, 0, v3
    s_nop 0
    s_lshr_b64 s[54:55], vcc, s56
    s_and_b32 s25, s54, 3
    s_cmp_eq_u32 s25, 3
    s_cbranch_scc1 chk_30_ok
    s_sleep 1
    s_lshl_b64 exec, 0xff, s56
    s_cmp_lt_u32 s51, 30000
    s_cbranch_scc1 chk_30
    s_mov_b64 exec, -1
chk_30_ok:
    s_lshr_b64 s[54:55], s[54:55], 2
    s_add_u32 s56, s56, 2
    s_add_u32 m0, s4, 0
    s_add_u32 s25, s61, 294912
    buffer_load_dwordx4 v14, s[28:31], s25 offen offset:0 lds
    buffer_load_dwordx4 v14, s[28:31], s25 offen offset:1024 lds
    buffer_load_dwordx4 v14, s[28:31], s25 offen offset:2048 lds
    s_waitcnt vmcnt(21) lgkmcnt(0)
    s_barrier
    s_add_u32 m0, s24, 16384
    s_add_u32 s44, s60, 12386304
    buffer_load_dwordx4 v9, s[32:35], s44 offen offset:0 lds
    s_add_u32 s45, s60, 12422144
    buffer_load_dwordx4 v9, s[32:35], s45 offen offset:1024 lds
    s_add_u32 s46, s60, 12457984
    buffer_load_dwordx4 v10, s[32:35], s46 offen offset:2048 lds
    s_add_u32 s44, s60, 12493824
    buffer_load_dwordx4 v10, s[32:35], s44 offen offset:3072 lds
    s_and_b32 s25, s54, 3
    s_cmp_eq_u32 s25, 3
    s_cbranch_scc1 chk_31_ok
    s_mov_b32 s51, 0
chk_31:
    buffer_load_dword v3, v2, s[28:31], s50 offen sc1
    s_add_u32 s51, s51, 1
    s_mov_b64 exec, -1
    s_waitcnt vmcnt(0)
    v_cmp_ne_u32 vcc, 0, v3
    s_nop 0
    s_lshr_b64 s[54:55], vcc, s56
    s_and_b32 s25, s54, 3
    s_cmp_eq_u32 s25, 3
    s_cbranch_scc1 chk_31_ok
    s_sleep 1
    s_lshl_b64 exec, 0xff, s56
    s_cmp_lt_u32 s51, 30000
    s_cbranch_scc1 chk_31
    s_mov_b64 exec, -1
chk_31_ok:
    s_lshr_b64 s[54:55], s[54:55], 2
    s_add_u32 s56, s56, 2
    s_add_u32 m0, s4, 12288
    s_add_u32 s25, s61, 307200
    buffer_load_dwordx4 v14, s[28:31], s25 offen offset:0 lds
    buffer_load_dwordx4 v14, s[28:31], s25 offen offset:1024 lds
    buffer_load_dwordx4 v14, s[28:31], s25 offen offset:2048 lds
    s_waitcnt vmcnt(21) lgkmcnt(0)
    s_barrier
    s_add_u32 m0, s24, 32768
    s_add_u32 s44, s60, 12976128
    buffer_load_dwordx4 v9, s[32:35], s44 offen offset:0 lds
    s_add_u32 s45, s60, 13011968
    buffer_load_dwordx4 v9, s[32:35], s45 offen offset:1024 lds
    s_add_u32 s46, s60, 13047808
    buffer_load_dwordx4 v10, s[32:35], s46 offen offset:2048 lds
    s_add_u32 s44, s60, 13083648
    buffer_load_dwordx4 v10, s[32:35], s44 offen offset:3072 lds
    s_and_b32 s25, s54, 3
    s_cmp_eq_u32 s25, 3
    s_cbranch_scc1 chk_32_ok
    s_mov_b32 s51, 0
chk_32:
    buffer_load_dword v3, v2, s[28:31], s50 offen sc1
    s_add_u32 s51, s51, 1
    s_mov_b64 exec, -1
    s_waitcnt vmcnt(0)
    v_cmp_ne_u32 vcc, 0, v3
    s_nop 0
    s_lshr_b64 s[54:55], vcc, s56
    s_and_b32 s25, s54, 3
    s_cmp_eq_u32 s25, 3
    s_cbranch_scc1 chk_32_ok
    s_sleep 1
    s_lshl_b64 exec, 0xff, s56
    s_cmp_lt_u32 s51, 30000
    s_cbranch_scc1 chk_32
    s_mov_b64 exec, -1
chk_32_ok:
    s_lshr_b64 s[54:55], s[54:55], 2
    s_add_u32 s56, s56, 2
    s_add_u32 m0, s4, 24576
    s_add_u32 s25, s61, 319488
    buffer_load_dwordx4 v14, s[28:31], s25 offen offset:0 lds
    buffer_load_dwordx4 v14, s[28:31], s25 offen offset:1024 lds
    buffer_load_dwordx4 v14, s[28:31], s25 offen offset:2048 lds
    s_waitcnt vmcnt(21) lgkmcnt(0)
    s_barrier
    s_add_u32 m0, s24, 49152
    s_add_u32 s44, s60, 13565952
    buffer_load_dwordx4 v9, s[32:35], s44 offen offset:0 lds
    s_add_u32 s45, s60, 13601792
    buffer_load_dwordx4 v9, s[32:35], s45 offen offset:1024 lds
    s_add_u32 s46, s60, 13637632
    buffer_load_dwordx4 v10, s[32:35], s46 offen offset:2048 lds
    s_add_u32 s44, s60, 13673472
    buffer_load_dwordx4 v10, s[32:35], s44 offen offset:3072 lds
    s_and_b32 s25, s54, 3
    s_cmp_eq_u32 s25, 3
    s_cbranch_scc1 chk_33_ok
    s_mov_b32 s51, 0
chk_33:
    buffer_load_dword v3, v2, s[28:31], s50 offen sc1
    s_add_u32 s51, s51, 1
    s_mov_b64 exec, -1
    s_waitcnt vmcnt(0)
    v_cmp_ne_u32 vcc, 0, v3
    s_nop 0
    s_lshr_b64 s[54:55], vcc, s56
    s_and_b32 s25, s54, 3
    s_cmp_eq_u32 s25, 3
    s_cbranch_scc1 chk_33_ok
    s_sleep 1
    s_lshl_b64 exec, 0xff, s56
    s_cmp_lt_u32 s51, 30000
    s_cbranch_scc1 chk_33
    s_mov_b64 exec, -1
chk_33_ok:
    s_lshr_b64 s[54:55], s[54:55], 2
    s_add_u32 s56, s56, 2
    s_add_u32 m0, s4, 36864
    s_add_u32 s25, s61, 331776
    buffer_load_dwordx4 v14, s[28:31], s25 offen offset:0 lds
    buffer_load_dwordx4 v14, s[28:31], s25 offen offset:1024 lds
    buffer_load_dwordx4 v14, s[28:31], s25 offen offset:2048 lds
    s_waitcnt vmcnt(21) lgkmcnt(0)
    s_barrier
    s_add_u32 m0, s24, 65536
    s_add_u32 s44, s60, 14155776
    buffer_load_dwordx4 v9, s[32:35], s44 offen offset:0 lds
    s_add_u32 s45, s60, 14191616
    buffer_load_dwordx4 v9, s[32:35], s45 offen offset:1024 lds
    s_add_u32 s46, s60, 14227456
    buffer_load_dwordx4 v10, s[32:35], s46 offen offset:2048 lds
    s_add_u32 s44, s60, 14263296
    buffer_load_dwordx4 v10, s[32:35], s44 offen offset:3072 lds
    s_and_b32 s25, s54, 3
    s_cmp_eq_u32 s25, 3
    s_cbranch_scc1 chk_34_ok
    s_mov_b32 s51, 0
chk_34:
    buffer_load_dword v3, v2, s[28:31], s50 offen sc1
    s_add_u32 s51, s51, 1
    s_mov_b64 exec, -1
    s_waitcnt vmcnt(0)
    v_cmp_ne_u32 vcc, 0, v3
    s_nop 0
    s_lshr_b64 s[54:55], vcc, s56
    s_and_b32 s25, s54, 3
    s_cmp_eq_u32 s25, 3
    s_cbranch_scc1 chk_34_ok
    s_sleep 1
    s_lshl_b64 exec, 0xff, s56
    s_cmp_lt_u32 s51, 30000
    s_cbranch_scc1 chk_34
    s_mov_b64 exec, -1
chk_34_ok:
    s_lshr_b64 s[54:55], s[54:55], 2
    s_add_u32 s56, s56, 2
    s_add_u32 m0, s4, 49152
    s_add_u32 s25, s61, 344064
    buffer_load_dwordx4 v14, s[28:31], s25 offen offset:0 lds
    buffer_load_dwordx4 v14, s[28:31], s25 offen offset:1024 lds
    buffer_load_dwordx4 v14, s[28:31], s25 offen offset:2048 lds
    s_waitcnt vmcnt(21) lgkmcnt(0)
    s_barrier
    s_add_u32 m0, s24, 0
    s_add_u32 s44, s60, 14745600
    buffer_load_dwordx4 v9, s[32:35], s44 offen offset:0 lds
    s_add_u32 s45, s60, 14781440
    buffer_load_dwordx4 v9, s[32:35], s45 offen offset:1024 lds
    s_add_u32 s46, s60, 14817280
    buffer_load_dwordx4 v10, s[32:35], s46 offen offset:2048 lds
    s_add_u32 s44, s60, 14853120
    buffer_load_dwordx4 v10, s[32:35], s44 offen offset:3072 lds
    s_and_b32 s25, s54, 3
    s_cmp_eq_u32 s25, 3
    s_cbranch_scc1 chk_35_ok
    s_mov_b32 s51, 0
chk_35:
    buffer_load_dword v3, v2, s[28:31], s50 offen sc1
    s_add_u32 s51, s51, 1
    s_mov_b64 exec, -1
    s_waitcnt vmcnt(0)
    v_cmp_ne_u32 vcc, 0, v3
    s_nop 0
    s_lshr_b64 s[54:55], vcc, s56
    s_and_b32 s25, s54, 3
    s_cmp_eq_u32 s25, 3
    s_cbranch_scc1 chk_35_ok
    s_sleep 1
    s_lshl_b64 exec, 0xff, s56
    s_cmp_lt_u32 s51, 30000
    s_cbranch_scc1 chk_35
    s_mov_b64 exec, -1
chk_35_ok:
    s_lshr_b64 s[54:55], s[54:55], 2
    s_add_u32 s56, s56, 2
    s_add_u32 m0, s4, 0
    s_add_u32 s25, s61, 356352
    buffer_load_dwordx4 v14, s[28:31], s25 offen offset:0 lds
    buffer_load_dwordx4 v14, s[28:31], s25 offen offset:1024 lds
    buffer_load_dwordx4 v14, s[28:31], s25 offen offset:2048 lds
    s_waitcnt vmcnt(21) lgkmcnt(0)
    s_barrier
    s_add_u32 m0, s24, 16384
    s_add_u32 s44, s60, 15335424
    buffer_load_dwordx4 v9, s[32:35], s44 offen offset:0 lds
    s_add_u32 s45, s60, 15371264
    buffer_load_dwordx4 v9, s[32:35], s45 offen offset:1024 lds
    s_add_u32 s46, s60, 15407104
    buffer_load_dwordx4 v10, s[32:35], s46 offen offset:2048 lds
    s_add_u32 s44, s60, 15442944
    buffer_load_dwordx4 v10, s[32:35], s44 offen offset:3072 lds
    s_and_b32 s25, s54, 3
    s_cmp_eq_u32 s25, 3
    s_cbranch_scc1 chk_36_ok
    s_mov_b32 s51, 0
chk_36:
    buffer_load_dword v3, v2, s[28:31], s50 offen sc1
    s_add_u32 s51, s51, 1
    s_mov_b64 exec, -1
    s_waitcnt vmcnt(0)
    v_cmp_ne_u32 vcc, 0, v3
    s_nop 0
    s_lshr_b64 s[54:55], vcc, s56
    s_and_b32 s25, s54, 3
    s_cmp_eq_u32 s25, 3
    s_cbranch_scc1 chk_36_ok
    s_sleep 1
    s_lshl_b64 exec, 0xff, s56
    s_cmp_lt_u32 s51, 30000
    s_cbranch_scc1 chk_36
    s_mov_b64 exec, -1
chk_36_ok:
    s_lshr_b64 s[54:55], s[54:55], 2
    s_add_u32 s56, s56, 2
    s_add_u32 m0, s4, 12288
    s_add_u32 s25, s61, 368640
    buffer_load_dwordx4 v14, s[28:31], s25 offen offset:0 lds
    buffer_load_dwordx4 v14, s[28:31], s25 offen offset:1024 lds
    buffer_load_dwordx4 v14, s[28:31], s25 offen offset:2048 lds
    s_waitcnt vmcnt(21) lgkmcnt(0)
    s_barrier
    s_add_u32 m0, s24, 32768
    s_add_u32 s44, s60, 15925248
    buffer_load_dwordx4 v9, s[32:35], s44 offen offset:0 lds
    s_add_u32 s45, s60, 15961088
    buffer_load_dwordx4 v9, s[32:35], s45 offen offset:1024 lds
    s_add_u32 s46, s60, 15996928
    buffer_load_dwordx4 v10, s[32:35], s46 offen offset:2048 lds
    s_add_u32 s44, s60, 16032768
    buffer_load_dwordx4 v10, s[32:35], s44 offen offset:3072 lds
    s_and_b32 s25, s54, 3
    s_cmp_eq_u32 s25, 3
    s_cbranch_scc1 chk_37_ok
    s_mov_b32 s51, 0
chk_37:
    buffer_load_dword v3, v2, s[28:31], s50 offen sc1
    s_add_u32 s51, s51, 1
    s_mov_b64 exec, -1
    s_waitcnt vmcnt(0)
    v_cmp_ne_u32 vcc, 0, v3
    s_nop 0
    s_lshr_b64 s[54:55], vcc, s56
    s_and_b32 s25, s54, 3
    s_cmp_eq_u32 s25, 3
    s_cbranch_scc1 chk_37_ok
    s_sleep 1
    s_lshl_b64 exec, 0xff, s56
    s_cmp_lt_u32 s51, 30000
    s_cbranch_scc1 chk_37
    s_mov_b64 exec, -1
chk_37_ok:
    s_lshr_b64 s[54:55], s[54:55], 2
    s_add_u32 s56, s56, 2
    s_add_u32 m0, s4, 24576
    s_add_u32 s25, s61, 380928
    buffer_load_dwordx4 v14, s[28:31], s25 offen offset:0 lds
    buffer_load_dwordx4 v14, s[28:31], s25 offen offset:1024 lds
    buffer_load_dwordx4 v14, s[28:31], s25 offen offset:2048 lds
    s_waitcnt vmcnt(21) lgkmcnt(0)
    s_barrier
    s_waitcnt vmcnt(14) lgkmcnt(0)
    s_barrier
    s_waitcnt vmcnt(7) lgkmcnt(0)
    s_barrier
    s_waitcnt vmcnt(0) lgkmcnt(0)
    s_barrier
t_ld2:
    s_lshr_b32 s44, s36, 1
    s_and_b32 s45, s36, 1
    s_lshl_b32 s45, s45, 3
    s_lshr_b32 s46, s37, 2
    s_add_u32 s45, s45, s46
    s_and_b32 s46, s37, 3
    v_lshrrev_b32 v2, 4, v1
    v_and_b32 v3, 15, v1
    v_lshlrev_b32 v9, 1, v2
    v_xor_b32 v9, v9, v3
    v_xor_b32 v10, 8, v9
    v_mul_u32_u24 v2, 4096, v2
    v_lshl_add_u32 v9, v9, 4, v2
    v_lshl_add_u32 v10, v10, 4, v2
    s_mul_i32 s52, s44, 4718592
    s_lshl_b32 s50, s45, 8
    s_add_u32 s52, s52, s50
    s_mul_i32 s50, s39, 65536
    s_add_u32 s52, s52, s50
    s_mul_i32 s53, s46, 144
    s_mul_i32 s50, s44, 36
    s_add_u32 s53, s53, s50
    s_mul_i32 s53, s53, 9216
    s_mul_i32 s4, s39, 4608
    s_add_u32 s53, s53, s4
    s_add_u32 s53, s53, 16777216
    s_add_u32 s4, s4, 16384
    s_lshl_b32 s24, s39, 12
    s_mov_b32 s6, 0x18764320
    s_mov_b32 s7, 5
    s_cmp_eq_u32 s44, 1
    s_cselect_b32 s6, 0x40765321, s6
    s_cselect_b32 s7, 8, s7
    s_cmp_eq_u32 s44, 2
    s_cselect_b32 s6, 0x38654210, s6
    s_cselect_b32 s7, 7, s7
    s_cmp_eq_u32 s44, 3
    s_cselect_b32 s6, 0x28754310, s6
    s_cselect_b32 s7, 6, s7
    v_min_u32 v2, 35, v1
    v_and_b32 v3, 1, v2
    s_mul_i32 s50, s46, 3
    s_and_b32 s51, s39, 1
    s_add_u32 s50, s50, s51
    v_add_u32 v3, s50, v3
    v_and_b32 v4, 60, v2
    v_lshrrev_b64 v[12:13], v4, s[6:7]
    v_and_b32 v4, 15, v12
    v_mul_u32_u24 v4, 6, v4
    v_lshrrev_b32 v7, 1, v3
    v_add_u32 v4, v4, v7
    v_and_b32 v3, 1, v3
    v_lshlrev_b32 v3, 1, v3
    v_bfe_u32 v2, v2, 1, 1
    v_add_u32 v3, v3, v2
    v_lshlrev_b32 v3, 7, v3
    v_lshl_add_u32 v2, v4, 10, v3
    s_mul_i32 s50, s44, 55296
    s_add_u32 s50, s50, 262528
    s_cmp_lt_u32 s2, 216
    s_cbranch_scc0 g2_ld_nobar
    s_barrier
g2_ld_nobar:
    s_bfe_u32 s5, s6, 0x40000
    s_mul_i32 s57, s5, 524288
    s_add_u32 s57, s57, s52
    s_mul_i32 s58, s5, 36864
    s_add_u32 s58, s58, s53
    s_add_u32 m0, s24, 0
    s_nop 0
    buffer_load_dwordx4 v9, s[8:11], s57 offen offset:0 lds
    s_add_u32 s26, s57, 15360
    buffer_load_dwordx4 v10, s[8:11], s26 offen offset:1024 lds
    s_add_u32 s27, s57, 30720
    buffer_load_dwordx4 v9, s[8:11], s27 offen offset:2048 lds
    s_add_u32 s25, s57, 46080
    buffer_load_dwordx4 v10, s[8:11], s25 offen offset:3072 lds
    s_add_u32 m0, s24, 34816
    s_add_u32 s25, s57, 262144
    buffer_load_dwordx4 v9, s[8:11], s25 offen offset:0 lds
    s_add_u32 s26, s57, 277504
    buffer_load_dwordx4 v10, s[8:11], s26 offen offset:1024 lds
    s_add_u32 s27, s57, 292864
    buffer_load_dwordx4 v9, s[8:11], s27 offen offset:2048 lds
    s_add_u32 s25, s57, 308224
    buffer_load_dwordx4 v10, s[8:11], s25 offen offset:3072 lds
    s_bfe_u32 s5, s6, 0x40004
    s_mul_i32 s57, s5, 524288
    s_add_u32 s57, s57, s52
    s_mul_i32 s58, s5, 36864
    s_add_u32 s58, s58, s53
    s_add_u32 m0, s24, 69632
    s_nop 0
    buffer_load_dwordx4 v9, s[8:11], s57 offen offset:0 lds
    s_add_u32 s26, s57, 15360
    buffer_load_dwordx4 v10, s[8:11], s26 offen offset:1024 lds
    s_add_u32 s27, s57, 30720
    buffer_load_dwordx4 v9, s[8:11], s27 offen offset:2048 lds
    s_add_u32 s25, s57, 46080
    buffer_load_dwordx4 v10, s[8:11], s25 offen offset:3072 lds
    s_cmp_lt_u32 s2, 216
    s_cbranch_scc0 g2_ld_nobar2
    s_barrier
g2_ld_nobar2:
    s_sleep 8
    s_mov_b64 s[54:55], 0
    s_mov_b32 s56, 0
    s_bfe_u32 s5, s6, 0x40000
    s_mul_i32 s57, s5, 524288
    s_add_u32 s57, s57, s52
    s_mul_i32 s58, s5, 36864
    s_add_u32 s58, s58, s53
    s_and_b32 s25, s54, 3
    s_cmp_eq_u32 s25, 3
    s_cbranch_scc1 chk_38_ok
    s_mov_b32 s51, 0
chk_38:
    buffer_load_dword v3, v2, s[28:31], s50 offen sc1
    s_add_u32 s51, s51, 1
    s_mov_b64 exec, -1
    s_waitcnt vmcnt(0)
    v_cmp_ne_u32 vcc, 0, v3
    s_nop 0
    s_lshr_b64 s[54:55], vcc, s56
    s_and_b32 s25, s54, 3
    s_cmp_eq_u32 s25, 3
    s_cbranch_scc1 chk_38_ok
    s_sleep 2
    s_lshl_b64 exec, 0xff, s56
    s_cmp_lt_u32 s51, 30000
    s_cbranch_scc1 chk_38
    s_mov_b64 exec, -1
chk_38_ok:
    s_lshr_b64 s[54:55], s[54:55], 2
    s_add_u32 s56, s56, 2
    s_add_u32 m0, s4, 0
    s_mov_b64 exec, 0xffffffff
    buffer_load_dwordx4 v14, s[28:31], s58 offen lds
    s_mov_b64 exec, -1
    buffer_load_dwordx4 v14, s[28:31], s58 offen offset:512 lds
    buffer_load_dwordx4 v14, s[28:31], s58 offen offset:1536 lds
    buffer_load_dwordx4 v14, s[28:31], s58 offen offset:2560 lds
    buffer_load_dwordx4 v14, s[28:31], s58 offen offset:3584 lds
    s_and_b32 s25, s54, 3
    s_cmp_eq_u32 s25, 3
    s_cbranch_scc1 chk_39_ok
    s_mov_b32 s51, 0
chk_39:
    buffer_load_dword v3, v2, s[28:31], s50 offen sc1
    s_add_u32 s51, s51, 1
    s_mov_b64 exec, -1
    s_waitcnt vmcnt(0)
    v_cmp_ne_u32 vcc, 0, v3
    s_nop 0
    s_lshr_b64 s[54:55], vcc, s56
    s_and_b32 s25, s54, 3
    s_cmp_eq_u32 s25, 3
    s_cbranch_scc1 chk_39_ok
    s_sleep 2
    s_lshl_b64 exec, 0xff, s56
    s_cmp_lt_u32 s51, 30000
    s_cbranch_scc1 chk_39
    s_mov_b64 exec, -1
chk_39_ok:
    s_lshr_b64 s[54:55], s[54:55], 2
    s_add_u32 s56, s56, 2
    s_add_u32 m0, s4, 34816
    s_add_u32 s59, s58, 18432
    s_mov_b64 exec, 0xffffffff
    buffer_load_dwordx4 v14, s[28:31], s59 offen lds
    s_mov_b64 exec, -1
    buffer_load_dwordx4 v14, s[28:31], s59 offen offset:512 lds
    buffer_load_dwordx4 v14, s[28:31], s59 offen offset:1536 lds
    buffer_load_dwordx4 v14, s[28:31], s59 offen offset:2560 lds
    buffer_load_dwordx4 v14, s[28:31], s59 offen offset:3584 lds
    s_bfe_u32 s5, s6, 0x40004
    s_mul_i32 s57, s5, 524288
    s_add_u32 s57, s57, s52
    s_mul_i32 s58, s5, 36864
    s_add_u32 s58, s58, s53
    s_and_b32 s25, s54, 3
    s_cmp_eq_u32 s25, 3
    s_cbranch_scc1 chk_40_ok
    s_mov_b32 s51, 0
chk_40:
    buffer_load_dword v3, v2, s[28:31], s50 offen sc1
    s_add_u32 s51, s51, 1
    s_mov_b64 exec, -1
    s_waitcnt vmcnt(0)
    v_cmp_ne_u32 vcc, 0, v3
    s_nop 0
    s_lshr_b64 s[54:55], vcc, s56
    s_and_b32 s25, s54, 3
    s_cmp_eq_u32 s25, 3
    s_cbranch_scc1 chk_40_ok
    s_sleep 2
    s_lshl_b64 exec, 0xff, s56
    s_cmp_lt_u32 s51, 30000
    s_cbranch_scc1 chk_40
    s_mov_b64 exec, -1
chk_40_ok:
    s_lshr_b64 s[54:55], s[54:55], 2
    s_add_u32 s56, s56, 2
    s_add_u32 m0, s4, 69632
    s_mov_b64 exec, 0xffffffff
    buffer_load_dwordx4 v14, s[28:31], s58 offen lds
    s_mov_b64 exec, -1
    buffer_load_dwordx4 v14, s[28:31], s58 offen offset:512 lds
    buffer_load_dwordx4 v14, s[28:31], s58 offen offset:1536 lds
    buffer_load_dwordx4 v14, s[28:31], s58 offen offset:2560 lds
    buffer_load_dwordx4 v14, s[28:31], s58 offen offset:3584 lds
    s_waitcnt vmcnt(10)
    s_barrier
    s_add_u32 m0, s24, 104448
    s_add_u32 s25, s57, 262144
    buffer_load_dwordx4 v9, s[8:11], s25 offen offset:0 lds
    s_add_u32 s26, s57, 277504
    buffer_load_dwordx4 v10, s[8:11], s26 offen offset:1024 lds
    s_add_u32 s27, s57, 292864
    buffer_load_dwordx4 v9, s[8:11], s27 offen offset:2048 lds
    s_add_u32 s25, s57, 308224
    buffer_load_dwordx4 v10, s[8:11], s25 offen offset:3072 lds
    s_and_b32 s25, s54, 3
    s_cmp_eq_u32 s25, 3
    s_cbranch_scc1 chk_41_ok
    s_mov_b32 s51, 0
chk_41:
    buffer_load_dword v3, v2, s[28:31], s50 offen sc1
    s_add_u32 s51, s51, 1
    s_mov_b64 exec, -1
    s_waitcnt vmcnt(0)
    v_cmp_ne_u32 vcc, 0, v3
    s_nop 0
    s_lshr_b64 s[54:55], vcc, s56
    s_and_b32 s25, s54, 3
    s_cmp_eq_u32 s25, 3
    s_cbranch_scc1 chk_41_ok
    s_sleep 2
    s_lshl_b64 exec, 0xff, s56
    s_cmp_lt_u32 s51, 30000
    s_cbranch_scc1 chk_41
    s_mov_b64 exec, -1
chk_41_ok:
    s_lshr_b64 s[54:55], s[54:55], 2
    s_add_u32 s56, s56, 2
    s_add_u32 m0, s4, 104448
    s_add_u32 s59, s58, 18432
    s_mov_b64 exec, 0xffffffff
    buffer_load_dwordx4 v14, s[28:31], s59 offen lds
    s_mov_b64 exec, -1
    buffer_load_dwordx4 v14, s[28:31], s59 offen offset:512 lds
    buffer_load_dwordx4 v14, s[28:31], s59 offen offset:1536 lds
    buffer_load_dwordx4 v14, s[28:31], s59 offen offset:2560 lds
    buffer_load_dwordx4 v14, s[28:31], s59 offen offset:3584 lds
    s_waitcnt vmcnt(14)
    s_barrier
    s_bfe_u32 s5, s6, 0x40008
    s_mul_i32 s57, s5, 524288
    s_add_u32 s57, s57, s52
    s_mul_i32 s58, s5, 36864
    s_add_u32 s58, s58, s53
    s_add_u32 m0, s24, 0
    s_nop 0
    buffer_load_dwordx4 v9, s[8:11], s57 offen offset:0 lds
    s_add_u32 s26, s57, 15360
    buffer_load_dwordx4 v10, s[8:11], s26 offen offset:1024 lds
    s_add_u32 s27, s57, 30720
    buffer_load_dwordx4 v9, s[8:11], s27 offen offset:2048 lds
    s_add_u32 s25, s57, 46080
    buffer_load_dwordx4 v10, s[8:11], s25 offen offset:3072 lds
    s_and_b32 s25, s54, 3
    s_cmp_eq_u32 s25, 3
    s_cbranch_scc1 chk_42_ok
    s_mov_b32 s51, 0
chk_42:
    buffer_load_dword v3, v2, s[28:31], s50 offen sc1
    s_add_u32 s51, s51, 1
    s_mov_b64 exec, -1
    s_waitcnt vmcnt(0)
    v_cmp_ne_u32 vcc, 0, v3
    s_nop 0
    s_lshr_b64 s[54:55], vcc, s56
    s_and_b32 s25, s54, 3
    s_cmp_eq_u32 s25, 3
    s_cbranch_scc1 chk_42_ok
    s_sleep 2
    s_lshl_b64 exec, 0xff, s56
    s_cmp_lt_u32 s51, 30000
    s_cbranch_scc1 chk_42
    s_mov_b64 exec, -1
chk_42_ok:
    s_lshr_b64 s[54:55], s[54:55], 2
    s_add_u32 s56, s56, 2
    s_add_u32 m0, s4, 0
    s_mov_b64 exec, 0xffffffff
    buffer_load_dwordx4 v14, s[28:31], s58 offen lds
    s_mov_b64 exec, -1
    buffer_load_dwordx4 v14, s[28:31], s58 offen offset:512 lds
    buffer_load_dwordx4 v14, s[28:31], s58 offen offset:1536 lds
    buffer_load_dwordx4 v14, s[28:31], s58 offen offset:2560 lds
    buffer_load_dwordx4 v14, s[28:31], s58 offen offset:3584 lds
    s_waitcnt vmcnt(18)
    s_barrier
    s_add_u32 m0, s24, 34816
    s_add_u32 s25, s57, 262144
    buffer_load_dwordx4 v9, s[8:11], s25 offen offset:0 lds
    s_add_u32 s26, s57, 277504
    buffer_load_dwordx4 v10, s[8:11], s26 offen offset:1024 lds
    s_add_u32 s27, s57, 292864
    buffer_load_dwordx4 v9, s[8:11], s27 offen offset:2048 lds
    s_add_u32 s25, s57, 308224
    buffer_load_dwordx4 v10, s[8:11], s25 offen offset:3072 lds
    s_and_b32 s25, s54, 3
    s_cmp_eq_u32 s25, 3
    s_cbranch_scc1 chk_43_ok
    s_mov_b32 s51, 0
chk_43:
    buffer_load_dword v3, v2, s[28:31], s50 offen sc1
    s_add_u32 s51, s51, 1
    s_mov_b64 exec, -1
    s_waitcnt vmcnt(0)
    v_cmp_ne_u32 vcc, 0, v3
    s_nop 0
    s_lshr_b64 s[54:55], vcc, s56
    s_and_b32 s25, s54, 3
    s_cmp_eq_u32 s25, 3
    s_cbranch_scc1 chk_43_ok
    s_sleep 2
    s_lshl_b64 exec, 0xff, s56
    s_cmp_lt_u32 s51, 30000
    s_cbranch_scc1 chk_43
    s_mov_b64 exec, -1
chk_43_ok:
    s_lshr_b64 s[54:55], s[54:55], 2
    s_add_u32 s56, s56, 2
    s_add_u32 m0, s4, 34816
    s_add_u32 s59, s58, 18432
    s_mov_b64 exec, 0xffffffff
    buffer_load_dwordx4 v14, s[28:31], s59 offen lds
    s_mov_b64 exec, -1
    buffer_load_dwordx4 v14, s[28:31], s59 offen offset:512 lds
    buffer_load_dwordx4 v14, s[28:31], s59 offen offset:1536 lds
    buffer_load_dwordx4 v14, s[28:31], s59 offen offset:2560 lds
    buffer_load_dwordx4 v14, s[28:31], s59 offen offset:3584 lds
    s_waitcnt vmcnt(18)
    s_barrier
    s_bfe_u32 s5, s6, 0x4000c
    s_mul_i32 s57, s5, 524288
    s_add_u32 s57, s57, s52
    s_mul_i32 s58, s5, 36864
    s_add_u32 s58, s58, s53
    s_add_u32 m0, s24, 69632
    s_nop 0
    buffer_load_dwordx4 v9, s[8:11], s57 offen offset:0 lds
    s_add_u32 s26, s57, 15360
    buffer_load_dwordx4 v10, s[8:11], s26 offen offset:1024 lds
    s_add_u32 s27, s57, 30720
    buffer_load_dwordx4 v9, s[8:11], s27 offen offset:2048 lds
    s_add_u32 s25, s57, 46080
    buffer_load_dwordx4 v10, s[8:11], s25 offen offset:3072 lds
    s_and_b32 s25, s54, 3
    s_cmp_eq_u32 s25, 3
    s_cbranch_scc1 chk_44_ok
    s_mov_b32 s51, 0
chk_44:
    buffer_load_dword v3, v2, s[28:31], s50 offen sc1
    s_add_u32 s51, s51, 1
    s_mov_b64 exec, -1
    s_waitcnt vmcnt(0)
    v_cmp_ne_u32 vcc, 0, v3
    s_nop 0
    s_lshr_b64 s[54:55], vcc, s56
    s_and_b32 s25, s54, 3
    s_cmp_eq_u32 s25, 3
    s_cbranch_scc1 chk_44_ok
    s_sleep 2
    s_lshl_b64 exec, 0xff, s56
    s_cmp_lt_u32 s51, 30000
    s_cbranch_scc1 chk_44
    s_mov_b64 exec, -1
chk_44_ok:
    s_lshr_b64 s[54:55], s[54:55], 2
    s_add_u32 s56, s56, 2
    s_add_u32 m0, s4, 69632
    s_mov_b64 exec, 0xffffffff
    buffer_load_dwordx4 v14, s[28:31], s58 offen lds
    s_mov_b64 exec, -1
    buffer_load_dwordx4 v14, s[28:31], s58 offen offset:512 lds
    buffer_load_dwordx4 v14, s[28:31], s58 offen offset:1536 lds
    buffer_load_dwordx4 v14, s[28:31], s58 offen offset:2560 lds
    buffer_load_dwordx4 v14, s[28:31], s58 offen offset:3584 lds
    s_waitcnt vmcnt(18)
    s_barrier
    s_add_u32 m0, s24, 104448
    s_add_u32 s25, s57, 262144
    buffer_load_dwordx4 v9, s[8:11], s25 offen offset:0 lds
    s_add_u32 s26, s57, 277504
    buffer_load_dwordx4 v10, s[8:11], s26 offen offset:1024 lds
    s_add_u32 s27, s57, 292864
    buffer_load_dwordx4 v9, s[8:11], s27 offen offset:2048 lds
    s_add_u32 s25, s57, 308224
    buffer_load_dwordx4 v10, s[8:11], s25 offen offset:3072 lds
    s_and_b32 s25, s54, 3
    s_cmp_eq_u32 s25, 3
    s_cbranch_scc1 chk_45_ok
    s_mov_b32 s51, 0
chk_45:
    buffer_load_dword v3, v2, s[28:31], s50 offen sc1
    s_add_u32 s51, s51, 1
    s_mov_b64 exec, -1
    s_waitcnt vmcnt(0)
    v_cmp_ne_u32 vcc, 0, v3
    s_nop 0
    s_lshr_b64 s[54:55], vcc, s56
    s_and_b32 s25, s54, 3
    s_cmp_eq_u32 s25, 3
    s_cbranch_scc1 chk_45_ok
    s_sleep 2
    s_lshl_b64 exec, 0xff, s56
    s_cmp_lt_u32 s51, 30000
    s_cbranch_scc1 chk_45
    s_mov_b64 exec, -1
chk_45_ok:
    s_lshr_b64 s[54:55], s[54:55], 2
    s_add_u32 s56, s56, 2
    s_add_u32 m0, s4, 104448
    s_add_u32 s59, s58, 18432
    s_mov_b64 exec, 0xffffffff
    buffer_load_dwordx4 v14, s[28:31], s59 offen lds
    s_mov_b64 exec, -1
    buffer_load_dwordx4 v14, s[28:31], s59 offen offset:512 lds
    buffer_load_dwordx4 v14, s[28:31], s59 offen offset:1536 lds
    buffer_load_dwordx4 v14, s[28:31], s59 offen offset:2560 lds
    buffer_load_dwordx4 v14, s[28:31], s59 offen offset:3584 lds
    s_waitcnt vmcnt(18)
    s_barrier
    s_bfe_u32 s5, s6, 0x40010
    s_mul_i32 s57, s5, 524288
    s_add_u32 s57, s57, s52
    s_mul_i32 s58, s5, 36864
    s_add_u32 s58, s58, s53
    s_add_u32 m0, s24, 0
    s_nop 0
    buffer_load_dwordx4 v9, s[8:11], s57 offen offset:0 lds
    s_add_u32 s26, s57, 15360
    buffer_load_dwordx4 v10, s[8:11], s26 offen offset:1024 lds
    s_add_u32 s27, s57, 30720
    buffer_load_dwordx4 v9, s[8:11], s27 offen offset:2048 lds
    s_add_u32 s25, s57, 46080
    buffer_load_dwordx4 v10, s[8:11], s25 offen offset:3072 lds
    s_and_b32 s25, s54, 3
    s_cmp_eq_u32 s25, 3
    s_cbranch_scc1 chk_46_ok
    s_mov_b32 s51, 0
chk_46:
    buffer_load_dword v3, v2, s[28:31], s50 offen sc1
    s_add_u32 s51, s51, 1
    s_mov_b64 exec, -1
    s_waitcnt vmcnt(0)
    v_cmp_ne_u32 vcc, 0, v3
    s_nop 0
    s_lshr_b64 s[54:55], vcc, s56
    s_and_b32 s25, s54, 3
    s_cmp_eq_u32 s25, 3
    s_cbranch_scc1 chk_46_ok
    s_sleep 2
    s_lshl_b64 exec, 0xff, s56
    s_cmp_lt_u32 s51, 30000
    s_cbranch_scc1 chk_46
    s_mov_b64 exec, -1
chk_46_ok:
    s_lshr_b64 s[54:55], s[54:55], 2
    s_add_u32 s56, s56, 2
    s_add_u32 m0, s4, 0
    s_mov_b64 exec, 0xffffffff
    buffer_load_dwordx4 v14, s[28:31], s58 offen lds
    s_mov_b64 exec, -1
    buffer_load_dwordx4 v14, s[28:31], s58 offen offset:512 lds
    buffer_load_dwordx4 v14, s[28:31], s58 offen offset:1536 lds
    buffer_load_dwordx4 v14, s[28:31], s58 offen offset:2560 lds
    buffer_load_dwordx4 v14, s[28:31], s58 offen offset:3584 lds
    s_waitcnt vmcnt(18)
    s_barrier
    s_add_u32 m0, s24, 34816
    s_add_u32 s25, s57, 262144
    buffer_load_dwordx4 v9, s[8:11], s25 offen offset:0 lds
    s_add_u32 s26, s57, 277504
    buffer_load_dwordx4 v10, s[8:11], s26 offen offset:1024 lds
    s_add_u32 s27, s57, 292864
    buffer_load_dwordx4 v9, s[8:11], s27 offen offset:2048 lds
    s_add_u32 s25, s57, 308224
    buffer_load_dwordx4 v10, s[8:11], s25 offen offset:3072 lds
    s_and_b32 s25, s54, 3
    s_cmp_eq_u32 s25, 3
    s_cbranch_scc1 chk_47_ok
    s_mov_b32 s51, 0
chk_47:
    buffer_load_dword v3, v2, s[28:31], s50 offen sc1
    s_add_u32 s51, s51, 1
    s_mov_b64 exec, -1
    s_waitcnt vmcnt(0)
    v_cmp_ne_u32 vcc, 0, v3
    s_nop 0
    s_lshr_b64 s[54:55], vcc, s56
    s_and_b32 s25, s54, 3
    s_cmp_eq_u32 s25, 3
    s_cbranch_scc1 chk_47_ok
    s_sleep 2
    s_lshl_b64 exec, 0xff, s56
    s_cmp_lt_u32 s51, 30000
    s_cbranch_scc1 chk_47
    s_mov_b64 exec, -1
chk_47_ok:
    s_lshr_b64 s[54:55], s[54:55], 2
    s_add_u32 s56, s56, 2
    s_add_u32 m0, s4, 34816
    s_add_u32 s59, s58, 18432
    s_mov_b64 exec, 0xffffffff
    buffer_load_dwordx4 v14, s[28:31], s59 offen lds
    s_mov_b64 exec, -1
    buffer_load_dwordx4 v14, s[28:31], s59 offen offset:512 lds
    buffer_load_dwordx4 v14, s[28:31], s59 offen offset:1536 lds
    buffer_load_dwordx4 v14, s[28:31], s59 offen offset:2560 lds
    buffer_load_dwordx4 v14, s[28:31], s59 offen offset:3584 lds
    s_waitcnt vmcnt(18)
    s_barrier
    s_bfe_u32 s5, s6, 0x40014
    s_mul_i32 s57, s5, 524288
    s_add_u32 s57, s57, s52
    s_mul_i32 s58, s5, 36864
    s_add_u32 s58, s58, s53
    s_add_u32 m0, s24, 69632
    s_nop 0
    buffer_load_dwordx4 v9, s[8:11], s57 offen offset:0 lds
    s_add_u32 s26, s57, 15360
    buffer_load_dwordx4 v10, s[8:11], s26 offen offset:1024 lds
    s_add_u32 s27, s57, 30720
    buffer_load_dwordx4 v9, s[8:11], s27 offen offset:2048 lds
    s_add_u32 s25, s57, 46080
    buffer_load_dwordx4 v10, s[8:11], s25 offen offset:3072 lds
    s_and_b32 s25, s54, 3
    s_cmp_eq_u32 s25, 3
    s_cbranch_scc1 chk_48_ok
    s_mov_b32 s51, 0
chk_48:
    buffer_load_dword v3, v2, s[28:31], s50 offen sc1
    s_add_u32 s51, s51, 1
    s_mov_b64 exec, -1
    s_waitcnt vmcnt(0)
    v_cmp_ne_u32 vcc, 0, v3
    s_nop 0
    s_lshr_b64 s[54:55], vcc, s56
    s_and_b32 s25, s54, 3
    s_cmp_eq_u32 s25, 3
    s_cbranch_scc1 chk_48_ok
    s_sleep 2
    s_lshl_b64 exec, 0xff, s56
    s_cmp_lt_u32 s51, 30000
    s_cbranch_scc1 chk_48
    s_mov_b64 exec, -1
chk_48_ok:
    s_lshr_b64 s[54:55], s[54:55], 2
    s_add_u32 s56, s56, 2
    s_add_u32 m0, s4, 69632
    s_mov_b64 exec, 0xffffffff
    buffer_load_dwordx4 v14, s[28:31], s58 offen lds
    s_mov_b64 exec, -1
    buffer_load_dwordx4 v14, s[28:31], s58 offen offset:512 lds
    buffer_load_dwordx4 v14, s[28:31], s58 offen offset:1536 lds
    buffer_load_dwordx4 v14, s[28:31], s58 offen offset:2560 lds
    buffer_load_dwordx4 v14, s[28:31], s58 offen offset:3584 lds
    s_waitcnt vmcnt(18)
    s_barrier
    s_add_u32 m0, s24, 104448
    s_add_u32 s25, s57, 262144
    buffer_load_dwordx4 v9, s[8:11], s25 offen offset:0 lds
    s_add_u32 s26, s57, 277504
    buffer_load_dwordx4 v10, s[8:11], s26 offen offset:1024 lds
    s_add_u32 s27, s57, 292864
    buffer_load_dwordx4 v9, s[8:11], s27 offen offset:2048 lds
    s_add_u32 s25, s57, 308224
    buffer_load_dwordx4 v10, s[8:11], s25 offen offset:3072 lds
    s_and_b32 s25, s54, 3
    s_cmp_eq_u32 s25, 3
    s_cbranch_scc1 chk_49_ok
    s_mov_b32 s51, 0
chk_49:
    buffer_load_dword v3, v2, s[28:31], s50 offen sc1
    s_add_u32 s51, s51, 1
    s_mov_b64 exec, -1
    s_waitcnt vmcnt(0)
    v_cmp_ne_u32 vcc, 0, v3
    s_nop 0
    s_lshr_b64 s[54:55], vcc, s56
    s_and_b32 s25, s54, 3
    s_cmp_eq_u32 s25, 3
    s_cbranch_scc1 chk_49_ok
    s_sleep 2
    s_lshl_b64 exec, 0xff, s56
    s_cmp_lt_u32 s51, 30000
    s_cbranch_scc1 chk_49
    s_mov_b64 exec, -1
chk_49_ok:
    s_lshr_b64 s[54:55], s[54:55], 2
    s_add_u32 s56, s56, 2
    s_add_u32 m0, s4, 104448
    s_add_u32 s59, s58, 18432
    s_mov_b64 exec, 0xffffffff
    buffer_load_dwordx4 v14, s[28:31], s59 offen lds
    s_mov_b64 exec, -1
    buffer_load_dwordx4 v14, s[28:31], s59 offen offset:512 lds
    buffer_load_dwordx4 v14, s[28:31], s59 offen offset:1536 lds
    buffer_load_dwordx4 v14, s[28:31], s59 offen offset:2560 lds
    buffer_load_dwordx4 v14, s[28:31], s59 offen offset:3584 lds
    s_waitcnt vmcnt(18)
    s_barrier
    s_bfe_u32 s5, s6, 0x40018
    s_mul_i32 s57, s5, 524288
    s_add_u32 s57, s57, s52
    s_mul_i32 s58, s5, 36864
    s_add_u32 s58, s58, s53
    s_add_u32 m0, s24, 0
    s_nop 0
    buffer_load_dwordx4 v9, s[8:11], s57 offen offset:0 lds
    s_add_u32 s26, s57, 15360
    buffer_load_dwordx4 v10, s[8:11], s26 offen offset:1024 lds
    s_add_u32 s27, s57, 30720
    buffer_load_dwordx4 v9, s[8:11], s27 offen offset:2048 lds
    s_add_u32 s25, s57, 46080
    buffer_load_dwordx4 v10, s[8:11], s25 offen offset:3072 lds
    s_and_b32 s25, s54, 3
    s_cmp_eq_u32 s25, 3
    s_cbranch_scc1 chk_50_ok
    s_mov_b32 s51, 0
chk_50:
    buffer_load_dword v3, v2, s[28:31], s50 offen sc1
    s_add_u32 s51, s51, 1
    s_mov_b64 exec, -1
    s_waitcnt vmcnt(0)
    v_cmp_ne_u32 vcc, 0, v3
    s_nop 0
    s_lshr_b64 s[54:55], vcc, s56
    s_and_b32 s25, s54, 3
    s_cmp_eq_u32 s25, 3
    s_cbranch_scc1 chk_50_ok
    s_sleep 2
    s_lshl_b64 exec, 0xff, s56
    s_cmp_lt_u32 s51, 30000
    s_cbranch_scc1 chk_50
    s_mov_b64 exec, -1
chk_50_ok:
    s_lshr_b64 s[54:55], s[54:55], 2
    s_add_u32 s56, s56, 2
    s_add_u32 m0, s4, 0
    s_mov_b64 exec, 0xffffffff
    buffer_load_dwordx4 v14, s[28:31], s58 offen lds
    s_mov_b64 exec, -1
    buffer_load_dwordx4 v14, s[28:31], s58 offen offset:512 lds
    buffer_load_dwordx4 v14, s[28:31], s58 offen offset:1536 lds
    buffer_load_dwordx4 v14, s[28:31], s58 offen offset:2560 lds
    buffer_load_dwordx4 v14, s[28:31], s58 offen offset:3584 lds
    s_waitcnt vmcnt(18)
    s_barrier
    s_add_u32 m0, s24, 34816
    s_add_u32 s25, s57, 262144
    buffer_load_dwordx4 v9, s[8:11], s25 offen offset:0 lds
    s_add_u32 s26, s57, 277504
    buffer_load_dwordx4 v10, s[8:11], s26 offen offset:1024 lds
    s_add_u32 s27, s57, 292864
    buffer_load_dwordx4 v9, s[8:11], s27 offen offset:2048 lds
    s_add_u32 s25, s57, 308224
    buffer_load_dwordx4 v10, s[8:11], s25 offen offset:3072 lds
    s_and_b32 s25, s54, 3
    s_cmp_eq_u32 s25, 3
    s_cbranch_scc1 chk_51_ok
    s_mov_b32 s51, 0
chk_51:
    buffer_load_dword v3, v2, s[28:31], s50 offen sc1
    s_add_u32 s51, s51, 1
    s_mov_b64 exec, -1
    s_waitcnt vmcnt(0)
    v_cmp_ne_u32 vcc, 0, v3
    s_nop 0
    s_lshr_b64 s[54:55], vcc, s56
    s_and_b32 s25, s54, 3
    s_cmp_eq_u32 s25, 3
    s_cbranch_scc1 chk_51_ok
    s_sleep 2
    s_lshl_b64 exec, 0xff, s56
    s_cmp_lt_u32 s51, 30000
    s_cbranch_scc1 chk_51
    s_mov_b64 exec, -1
chk_51_ok:
    s_lshr_b64 s[54:55], s[54:55], 2
    s_add_u32 s56, s56, 2
    s_add_u32 m0, s4, 34816
    s_add_u32 s59, s58, 18432
    s_mov_b64 exec, 0xffffffff
    buffer_load_dwordx4 v14, s[28:31], s59 offen lds
    s_mov_b64 exec, -1
    buffer_load_dwordx4 v14, s[28:31], s59 offen offset:512 lds
    buffer_load_dwordx4 v14, s[28:31], s59 offen offset:1536 lds
    buffer_load_dwordx4 v14, s[28:31], s59 offen offset:2560 lds
    buffer_load_dwordx4 v14, s[28:31], s59 offen offset:3584 lds
    s_waitcnt vmcnt(18)
    s_barrier
    s_bfe_u32 s5, s6, 0x4001c
    s_mul_i32 s57, s5, 524288
    s_add_u32 s57, s57, s52
    s_mul_i32 s58, s5, 36864
    s_add_u32 s58, s58, s53
    s_add_u32 m0, s24, 69632
    s_nop 0
    buffer_load_dwordx4 v9, s[8:11], s57 offen offset:0 lds
    s_add_u32 s26, s57, 15360
    buffer_load_dwordx4 v10, s[8:11], s26 offen offset:1024 lds
    s_add_u32 s27, s57, 30720
    buffer_load_dwordx4 v9, s[8:11], s27 offen offset:2048 lds
    s_add_u32 s25, s57, 46080
    buffer_load_dwordx4 v10, s[8:11], s25 offen offset:3072 lds
    s_and_b32 s25, s54, 3
    s_cmp_eq_u32 s25, 3
    s_cbranch_scc1 chk_52_ok
    s_mov_b32 s51, 0
chk_52:
    buffer_load_dword v3, v2, s[28:31], s50 offen sc1
    s_add_u32 s51, s51, 1
    s_mov_b64 exec, -1
    s_waitcnt vmcnt(0)
    v_cmp_ne_u32 vcc, 0, v3
    s_nop 0
    s_lshr_b64 s[54:55], vcc, s56
    s_and_b32 s25, s54, 3
    s_cmp_eq_u32 s25, 3
    s_cbranch_scc1 chk_52_ok
    s_sleep 2
    s_lshl_b64 exec, 0xff, s56
    s_cmp_lt_u32 s51, 30000
    s_cbranch_scc1 chk_52
    s_mov_b64 exec, -1
chk_52_ok:
    s_lshr_b64 s[54:55], s[54:55], 2
    s_add_u32 s56, s56, 2
    s_add_u32 m0, s4, 69632
    s_mov_b64 exec, 0xffffffff
    buffer_load_dwordx4 v14, s[28:31], s58 offen lds
    s_mov_b64 exec, -1
    buffer_load_dwordx4 v14, s[28:31], s58 offen offset:512 lds
    buffer_load_dwordx4 v14, s[28:31], s58 offen offset:1536 lds
    buffer_load_dwordx4 v14, s[28:31], s58 offen offset:2560 lds
    buffer_load_dwordx4 v14, s[28:31], s58 offen offset:3584 lds
    s_waitcnt vmcnt(18)
    s_barrier
    s_add_u32 m0, s24, 104448
    s_add_u32 s25, s57, 262144
    buffer_load_dwordx4 v9, s[8:11], s25 offen offset:0 lds
    s_add_u32 s26, s57, 277504
    buffer_load_dwordx4 v10, s[8:11], s26 offen offset:1024 lds
    s_add_u32 s27, s57, 292864
    buffer_load_dwordx4 v9, s[8:11], s27 offen offset:2048 lds
    s_add_u32 s25, s57, 308224
    buffer_load_dwordx4 v10, s[8:11], s25 offen offset:3072 lds
    s_and_b32 s25, s54, 3
    s_cmp_eq_u32 s25, 3
    s_cbranch_scc1 chk_53_ok
    s_mov_b32 s51, 0
chk_53:
    buffer_load_dword v3, v2, s[28:31], s50 offen sc1
    s_add_u32 s51, s51, 1
    s_mov_b64 exec, -1
    s_waitcnt vmcnt(0)
    v_cmp_ne_u32 vcc, 0, v3
    s_nop 0
    s_lshr_b64 s[54:55], vcc, s56
    s_and_b32 s25, s54, 3
    s_cmp_eq_u32 s25, 3
    s_cbranch_scc1 chk_53_ok
    s_sleep 2
    s_lshl_b64 exec, 0xff, s56
    s_cmp_lt_u32 s51, 30000
    s_cbranch_scc1 chk_53
    s_mov_b64 exec, -1
chk_53_ok:
    s_lshr_b64 s[54:55], s[54:55], 2
    s_add_u32 s56, s56, 2
    s_add_u32 m0, s4, 104448
    s_add_u32 s59, s58, 18432
    s_mov_b64 exec, 0xffffffff
    buffer_load_dwordx4 v14, s[28:31], s59 offen lds
    s_mov_b64 exec, -1
    buffer_load_dwordx4 v14, s[28:31], s59 offen offset:512 lds
    buffer_load_dwordx4 v14, s[28:31], s59 offen offset:1536 lds
    buffer_load_dwordx4 v14, s[28:31], s59 offen offset:2560 lds
    buffer_load_dwordx4 v14, s[28:31], s59 offen offset:3584 lds
    s_waitcnt vmcnt(18)
    s_barrier
    s_bfe_u32 s5, s7, 0x40000
    s_mul_i32 s57, s5, 524288
    s_add_u32 s57, s57, s52
    s_mul_i32 s58, s5, 36864
    s_add_u32 s58, s58, s53
    s_add_u32 m0, s24, 0
    s_nop 0
    buffer_load_dwordx4 v9, s[8:11], s57 offen offset:0 lds
    s_add_u32 s26, s57, 15360
    buffer_load_dwordx4 v10, s[8:11], s26 offen offset:1024 lds
    s_add_u32 s27, s57, 30720
    buffer_load_dwordx4 v9, s[8:11], s27 offen offset:2048 lds
    s_add_u32 s25, s57, 46080
    buffer_load_dwordx4 v10, s[8:11], s25 offen offset:3072 lds
    s_and_b32 s25, s54, 3
    s_cmp_eq_u32 s25, 3
    s_cbranch_scc1 chk_54_ok
    s_mov_b32 s51, 0
chk_54:
    buffer_load_dword v3, v2, s[28:31], s50 offen sc1
    s_add_u32 s51, s51, 1
    s_mov_b64 exec, -1
    s_waitcnt vmcnt(0)
    v_cmp_ne_u32 vcc, 0, v3
    s_nop 0
    s_lshr_b64 s[54:55], vcc, s56
    s_and_b32 s25, s54, 3
    s_cmp_eq_u32 s25, 3
    s_cbranch_scc1 chk_54_ok
    s_sleep 2
    s_lshl_b64 exec, 0xff, s56
    s_cmp_lt_u32 s51, 30000
    s_cbranch_scc1 chk_54
    s_mov_b64 exec, -1
chk_54_ok:
    s_lshr_b64 s[54:55], s[54:55], 2
    s_add_u32 s56, s56, 2
    s_add_u32 m0, s4, 0
    s_mov_b64 exec, 0xffffffff
    buffer_load_dwordx4 v14, s[28:31], s58 offen lds
    s_mov_b64 exec, -1
    buffer_load_dwordx4 v14, s[28:31], s58 offen offset:512 lds
    buffer_load_dwordx4 v14, s[28:31], s58 offen offset:1536 lds
    buffer_load_dwordx4 v14, s[28:31], s58 offen offset:2560 lds
    buffer_load_dwordx4 v14, s[28:31], s58 offen offset:3584 lds
    s_waitcnt vmcnt(18)
    s_barrier
    s_add_u32 m0, s24, 34816
    s_add_u32 s25, s57, 262144
    buffer_load_dwordx4 v9, s[8:11], s25 offen offset:0 lds
    s_add_u32 s26, s57, 277504
    buffer_load_dwordx4 v10, s[8:11], s26 offen offset:1024 lds
    s_add_u32 s27, s57, 292864
    buffer_load_dwordx4 v9, s[8:11], s27 offen offset:2048 lds
    s_add_u32 s25, s57, 308224
    buffer_load_dwordx4 v10, s[8:11], s25 offen offset:3072 lds
    s_and_b32 s25, s54, 3
    s_cmp_eq_u32 s25, 3
    s_cbranch_scc1 chk_55_ok
    s_mov_b32 s51, 0
chk_55:
    buffer_load_dword v3, v2, s[28:31], s50 offen sc1
    s_add_u32 s51, s51, 1
    s_mov_b64 exec, -1
    s_waitcnt vmcnt(0)
    v_cmp_ne_u32 vcc, 0, v3
    s_nop 0
    s_lshr_b64 s[54:55], vcc, s56
    s_and_b32 s25, s54, 3
    s_cmp_eq_u32 s25, 3
    s_cbranch_scc1 chk_55_ok
    s_sleep 2
    s_lshl_b64 exec, 0xff, s56
    s_cmp_lt_u32 s51, 30000
    s_cbranch_scc1 chk_55
    s_mov_b64 exec, -1
chk_55_ok:
    s_lshr_b64 s[54:55], s[54:55], 2
    s_add_u32 s56, s56, 2
    s_add_u32 m0, s4, 34816
    s_add_u32 s59, s58, 18432
    s_mov_b64 exec, 0xffffffff
    buffer_load_dwordx4 v14, s[28:31], s59 offen lds
    s_mov_b64 exec, -1
    buffer_load_dwordx4 v14, s[28:31], s59 offen offset:512 lds
    buffer_load_dwordx4 v14, s[28:31], s59 offen offset:1536 lds
    buffer_load_dwordx4 v14, s[28:31], s59 offen offset:2560 lds
    buffer_load_dwordx4 v14, s[28:31], s59 offen offset:3584 lds
    s_waitcnt vmcnt(18)
    s_barrier
    s_waitcnt vmcnt(9)
    s_barrier
    s_waitcnt vmcnt(0)
    s_barrier
    s_branch t_end
t_spare:
    s_sub_u32 s50, s37, 27
    s_lshl_b32 s50, s50, 3
    s_add_u32 s50, s50, s3
    s_add_u32 s58, s50, 261
    s_mul_i32 s58, s58, 55296
    s_add_u32 s58, s58, s57
    s_cmp_lt_u32 s50, 80
    s_cbranch_scc0 t4_56
    buffer_load_dword v8, v17, s[32:35], s58 offen
t4_56:
    s_add_u32 s58, s58, 2211840
    s_cmp_lt_u32 s50, 40
    s_cbranch_scc0 t4_57
    buffer_load_dword v8, v17, s[32:35], s58 offen
t4_57:
    s_add_u32 s58, s58, 2211840
    s_waitcnt vmcnt(0)
    s_and_b32 s51, s36, 1
    s_lshl_b32 s51, s51, 11
    s_lshr_b32 s52, s36, 1
    s_mul_i32 s52, s52, 4718592
    s_add_u32 s51, s51, s52
    s_add_u32 s52, 0, s50
    s_lshl_b32 s52, s52, 14
    s_add_u32 s52, s52, s51
    v_lshrrev_b32 v2, 4, v1
    v_lshlrev_b32 v2, 12, v2
    v_and_b32 v3, 15, v1
    v_lshl_add_u32 v2, v3, 7, v2
    buffer_load_dword v4, v2, s[8:11], s52 offen
    s_add_u32 s52, s52, 655360
    s_waitcnt vmcnt(0)
    buffer_load_dword v4, v2, s[8:11], s52 offen
    s_add_u32 s52, s52, 655360
    s_waitcnt vmcnt(0)
    buffer_load_dword v4, v2, s[8:11], s52 offen
    s_add_u32 s52, s52, 655360
    s_waitcnt vmcnt(0)
    buffer_load_dword v4, v2, s[8:11], s52 offen
    s_add_u32 s52, s52, 655360
    s_waitcnt vmcnt(0)
    buffer_load_dword v4, v2, s[8:11], s52 offen
    s_add_u32 s52, s52, 655360
    s_waitcnt vmcnt(0)
    buffer_load_dword v4, v2, s[8:11], s52 offen
    s_add_u32 s52, s52, 655360
    s_waitcnt vmcnt(0)
    buffer_load_dword v4, v2, s[8:11], s52 offen
    s_add_u32 s52, s52, 655360
    s_cmp_lt_u32 s50, 8
    s_cbranch_scc0 pfskip_58
    s_waitcnt vmcnt(0)
    buffer_load_dword v4, v2, s[8:11], s52 offen
pfskip_58:
    s_waitcnt vmcnt(0)
    s_cmp_lt_u32 s3, 4
    s_cbranch_scc1 t_cons2
    s_branch t_ld2
t_cons:
    s_and_b32 s46, s3, 1
    s_lshr_b32 s47, s3, 1
    s_lshl_b32 s48, s46, 7
    s_lshl_b32 s49, s62, 8
    s_add_u32 s48, s48, s49
    v_lshlrev_b32 v7, 3, v6
    buffer_load_dwordx2 v[24:25], v7, s[20:23], s48 offen offset:0
    buffer_load_dwordx2 v[26:27], v7, s[20:23], s48 offen offset:32
    buffer_load_dwordx2 v[28:29], v7, s[20:23], s48 offen offset:64
    buffer_load_dwordx2 v[30:31], v7, s[20:23], s48 offen offset:96
    s_lshl_b32 s40, s46, 2
    s_add_u32 s40, s40, 0
    s_lshl_b32 s41, s46, 2
    s_add_u32 s41, s41, 1
    s_lshl_b32 s42, s46, 2
    s_add_u32 s42, s42, 2
    s_lshl_b32 s43, s46, 2
    s_add_u32 s43, s43, 3
    v_lshrrev_b32 v2, 2, v5
    v_and_b32 v3, 1, v6
    v_lshl_add_u32 v3, v3, 2, v2
    v_mad_u32_u24 v2, v6, 8, v2
    v_lshlrev_b32 v2, 8, v2
    v_and_b32 v4, 3, v1
    v_lshl_add_u32 v2, v4, 3, v2
    v_xor_b32 v4, s40, v3
    v_lshl_add_u32 v8, v4, 5, v2
    v_xor_b32 v4, s41, v3
    v_lshl_add_u32 v9, v4, 5, v2
    v_xor_b32 v4, s42, v3
    v_lshl_add_u32 v10, v4, 5, v2
    v_xor_b32 v4, s43, v3
    v_lshl_add_u32 v11, v4, 5, v2
    v_mul_u32_u24 v2, 1536, v6
    v_lshl_add_u32 v2, v5, 4, v2
    s_mul_i32 s48, s47, 768
    v_add_u32 v12, s48, v2
    s_mul_i32 s48, s63, 6
    s_mul_i32 s49, s47, 3
    s_add_u32 s48, s48, s49
    s_lshl_b32 s49, s62, 2
    s_lshl_b32 s50, s46, 1
    s_add_u32 s49, s49, s50
    s_mul_i32 s49, s49, 9
    s_add_u32 s50, s48, 0
    s_mul_i32 s51, s50, 57
    s_lshr_b32 s51, s51, 9
    s_mul_i32 s51, s51, 1287
    s_add_u32 s50, s50, s51
    s_add_u32 s50, s50, s49
    s_lshl_b32 s50, s50, 10
    s_add_u32 s52, s50, 16777216
    s_add_u32 s55, s50, 16786432
    s_add_u32 s50, s48, 1
    s_mul_i32 s51, s50, 57
    s_lshr_b32 s51, s51, 9
    s_mul_i32 s51, s51, 1287
    s_add_u32 s50, s50, s51
    s_add_u32 s50, s50, s49
    s_lshl_b32 s50, s50, 10
    s_add_u32 s53, s50, 16777216
    s_add_u32 s56, s50, 16786432
    s_add_u32 s50, s48, 2
    s_mul_i32 s51, s50, 57
    s_lshr_b32 s51, s51, 9
    s_mul_i32 s51, s51, 1287
    s_add_u32 s50, s50, s51
    s_add_u32 s50, s50, s49
    s_lshl_b32 s50, s50, 10
    s_add_u32 s54, s50, 16777216
    s_add_u32 s57, s50, 16786432
    s_mul_i32 s58, s62, 6
    s_add_u32 s58, s58, s63
    s_lshl_b32 s58, s58, 3
    s_add_u32 s58, s58, s3
    s_lshl_b32 s58, s58, 7
    s_add_u32 s58, s58, 262528
    v_mov_b32 v88, 0
    v_mov_b32 v89, 0
    v_mov_b32 v90, 0
    v_mov_b32 v91, 0
    v_mov_b32 v92, 0
    v_mov_b32 v93, 0
    v_mov_b32 v94, 0
    v_mov_b32 v95, 0
    v_mov_b32 v96, 0
    v_mov_b32 v97, 0
    v_mov_b32 v98, 0
    v_mov_b32 v99, 0
    v_mov_b32 v100, 0
    v_mov_b32 v101, 0
    v_mov_b32 v102, 0
    v_mov_b32 v103, 0
    v_mov_b32 v104, 0
    v_mov_b32 v105, 0
    v_mov_b32 v106, 0
    v_mov_b32 v107, 0
    v_mov_b32 v108, 0
    v_mov_b32 v109, 0
    v_mov_b32 v110, 0
    v_mov_b32 v111, 0
    v_mov_b32 v112, 0
    v_mov_b32 v113, 0
    v_mov_b32 v114, 0
    v_mov_b32 v115, 0
    v_mov_b32 v116, 0
    v_mov_b32 v117, 0
    v_mov_b32 v118, 0
    v_mov_b32 v119, 0
    v_mov_b32 v120, 0
    v_mov_b32 v121, 0
    v_mov_b32 v122, 0
    v_mov_b32 v123, 0
    v_mov_b32 v124, 0
    v_mov_b32 v125, 0
    v_mov_b32 v126, 0
    v_mov_b32 v127, 0
    v_mov_b32 v128, 0
    v_mov_b32 v129, 0
    v_mov_b32 v130, 0
    v_mov_b32 v131, 0
    v_mov_b32 v132, 0
    v_mov_b32 v133, 0
    v_mov_b32 v134, 0
    v_mov_b32 v135, 0
    s_mov_b32 s24, 98304
    s_mov_b32 s4, 12288
    v_add_u32 v16, s24, v8
    v_add_u32 v17, s24, v9
    v_add_u32 v18, s24, v10
    v_add_u32 v19, s24, v11
    v_add_u32 v20, s4, v12
    s_movk_i32 s59, 31
    s_barrier
    ds_read_b128 v[48:51], v20 offset:0
    ds_read_b64_tr_b16 v[32:33], v16 offset:0
    ds_read_b64_tr_b16 v[34:35], v16 offset:1024
    ds_read_b64_tr_b16 v[36:37], v17 offset:0
    ds_read_b64_tr_b16 v[38:39], v17 offset:1024
    ds_read_b64_tr_b16 v[40:41], v18 offset:0
    ds_read_b64_tr_b16 v[42:43], v18 offset:1024
    ds_read_b64_tr_b16 v[44:45], v19 offset:0
    ds_read_b64_tr_b16 v[46:47], v19 offset:1024
    ds_read_b128 v[52:55], v20 offset:256
    ds_read_b128 v[56:59], v20 offset:512
g1_mm_loop:
    s_waitcnt lgkmcnt(0)
    v_mfma_f32_16x16x32_bf16 v[88:91], v[32:35], v[48:51], v[88:91]
    ds_read_b128 v[76:79], v20 offset:6144
    ds_read_b64_tr_b16 v[60:61], v16 offset:8192
    v_mfma_f32_16x16x32_bf16 v[100:103], v[36:39], v[48:51], v[100:103]
    ds_read_b64_tr_b16 v[62:63], v16 offset:9216
    ds_read_b64_tr_b16 v[64:65], v17 offset:8192
    v_mfma_f32_16x16x32_bf16 v[112:115], v[40:43], v[48:51], v[112:115]
    ds_read_b64_tr_b16 v[66:67], v17 offset:9216
    ds_read_b64_tr_b16 v[68:69], v18 offset:8192
    v_mfma_f32_16x16x32_bf16 v[124:127], v[44:47], v[48:51], v[124:127]
    ds_read_b64_tr_b16 v[70:71], v18 offset:9216
    ds_read_b64_tr_b16 v[72:73], v19 offset:8192
    v_mfma_f32_16x16x32_bf16 v[128:131], v[44:47], v[52:55], v[128:131]
    ds_read_b64_tr_b16 v[74:75], v19 offset:9216
    ds_read_b128 v[80:83], v20 offset:6400
    v_mfma_f32_16x16x32_bf16 v[116:119], v[40:43], v[52:55], v[116:119]
    ds_read_b128 v[84:87], v20 offset:6656
    s_add_u32 s24, s24, 16384
    v_mfma_f32_16x16x32_bf16 v[104:107], v[36:39], v[52:55], v[104:107]
    s_add_u32 s4, s4, 12288
    s_cmp_eq_u32 s24, 163840
    v_mfma_f32_16x16x32_bf16 v[92:95], v[32:35], v[52:55], v[92:95]
    s_cselect_b32 s24, 81920, s24
    s_cselect_b32 s4, 0, s4
    v_mfma_f32_16x16x32_bf16 v[96:99], v[32:35], v[56:59], v[96:99]
    v_add_u32 v16, s24, v8
    v_add_u32 v17, s24, v9
    v_mfma_f32_16x16x32_bf16 v[108:111], v[36:39], v[56:59], v[108:111]
    v_add_u32 v18, s24, v10
    v_add_u32 v19, s24, v11
    v_mfma_f32_16x16x32_bf16 v[120:123], v[40:43], v[56:59], v[120:123]
    v_add_u32 v20, s4, v12
    s_waitcnt lgkmcnt(0)
    v_mfma_f32_16x16x32_bf16 v[132:135], v[44:47], v[56:59], v[132:135]
    s_barrier
    v_mfma_f32_16x16x32_bf16 v[88:91], v[60:63], v[76:79], v[88:91]
    ds_read_b128 v[48:51], v20 offset:0
    ds_read_b64_tr_b16 v[32:33], v16 offset:0
    v_mfma_f32_16x16x32_bf16 v[100:103], v[64:67], v[76:79], v[100:103]
    ds_read_b64_tr_b16 v[34:35], v16 offset:1024
    ds_read_b64_tr_b16 v[36:37], v17 offset:0
    v_mfma_f32_16x16x32_bf16 v[112:115], v[68:71], v[76:79], v[112:115]
    ds_read_b64_tr_b16 v[38:39], v17 offset:1024
    ds_read_b64_tr_b16 v[40:41], v18 offset:0
    v_mfma_f32_16x16x32_bf16 v[124:127], v[72:75], v[76:79], v[124:127]
    ds_read_b64_tr_b16 v[42:43], v18 offset:1024
    ds_read_b64_tr_b16 v[44:45], v19 offset:0
    v_mfma_f32_16x16x32_bf16 v[128:131], v[72:75], v[80:83], v[128:131]
    ds_read_b64_tr_b16 v[46:47], v19 offset:1024
    ds_read_b128 v[52:55], v20 offset:256
    v_mfma_f32_16x16x32_bf16 v[116:119], v[68:71], v[80:83], v[116:119]
    ds_read_b128 v[56:59], v20 offset:512
    s_sub_u32 s59, s59, 1
    v_mfma_f32_16x16x32_bf16 v[104:107], v[64:67], v[80:83], v[104:107]
    s_cmp_lg_u32 s59, 0
    v_mfma_f32_16x16x32_bf16 v[92:95], v[60:63], v[80:83], v[92:95]
    v_mfma_f32_16x16x32_bf16 v[96:99], v[60:63], v[84:87], v[96:99]
    v_mfma_f32_16x16x32_bf16 v[108:111], v[64:67], v[84:87], v[108:111]
    v_mfma_f32_16x16x32_bf16 v[120:123], v[68:71], v[84:87], v[120:123]
    v_mfma_f32_16x16x32_bf16 v[132:135], v[72:75], v[84:87], v[132:135]
    s_cbranch_scc1 g1_mm_loop
    s_waitcnt lgkmcnt(0)
    v_mfma_f32_16x16x32_bf16 v[88:91], v[32:35], v[48:51], v[88:91]
    ds_read_b128 v[76:79], v20 offset:6144
    ds_read_b64_tr_b16 v[60:61], v16 offset:8192
    v_mfma_f32_16x16x32_bf16 v[100:103], v[36:39], v[48:51], v[100:103]
    ds_read_b64_tr_b16 v[62:63], v16 offset:9216
    ds_read_b64_tr_b16 v[64:65], v17 offset:8192
    v_mfma_f32_16x16x32_bf16 v[112:115], v[40:43], v[48:51], v[112:115]
    ds_read_b64_tr_b16 v[66:67], v17 offset:9216
    ds_read_b64_tr_b16 v[68:69], v18 offset:8192
    v_mfma_f32_16x16x32_bf16 v[124:127], v[44:47], v[48:51], v[124:127]
    ds_read_b64_tr_b16 v[70:71], v18 offset:9216
    ds_read_b64_tr_b16 v[72:73], v19 offset:8192
    v_mfma_f32_16x16x32_bf16 v[128:131], v[44:47], v[52:55], v[128:131]
    ds_read_b64_tr_b16 v[74:75], v19 offset:9216
    ds_read_b128 v[80:83], v20 offset:6400
    v_mfma_f32_16x16x32_bf16 v[116:119], v[40:43], v[52:55], v[116:119]
    ds_read_b128 v[84:87], v20 offset:6656
    v_mfma_f32_16x16x32_bf16 v[104:107], v[36:39], v[52:55], v[104:107]
    v_mfma_f32_16x16x32_bf16 v[92:95], v[32:35], v[52:55], v[92:95]
    v_mfma_f32_16x16x32_bf16 v[96:99], v[32:35], v[56:59], v[96:99]
    v_mfma_f32_16x16x32_bf16 v[108:111], v[36:39], v[56:59], v[108:111]
    v_mfma_f32_16x16x32_bf16 v[120:123], v[40:43], v[56:59], v[120:123]
    v_mfma_f32_16x16x32_bf16 v[132:135], v[44:47], v[56:59], v[132:135]
    s_waitcnt lgkmcnt(0)
    s_barrier
    v_mfma_f32_16x16x32_bf16 v[88:91], v[60:63], v[76:79], v[88:91]
    v_mfma_f32_16x16x32_bf16 v[100:103], v[64:67], v[76:79], v[100:103]
    v_mfma_f32_16x16x32_bf16 v[112:115], v[68:71], v[76:79], v[112:115]
    v_mfma_f32_16x16x32_bf16 v[124:127], v[72:75], v[76:79], v[124:127]
    v_mfma_f32_16x16x32_bf16 v[128:131], v[72:75], v[80:83], v[128:131]
    v_mfma_f32_16x16x32_bf16 v[116:119], v[68:71], v[80:83], v[116:119]
    v_mfma_f32_16x16x32_bf16 v[104:107], v[64:67], v[80:83], v[104:107]
    v_mfma_f32_16x16x32_bf16 v[92:95], v[60:63], v[80:83], v[92:95]
    v_mfma_f32_16x16x32_bf16 v[96:99], v[60:63], v[84:87], v[96:99]
    v_mfma_f32_16x16x32_bf16 v[108:111], v[64:67], v[84:87], v[108:111]
    v_mfma_f32_16x16x32_bf16 v[120:123], v[68:71], v[84:87], v[120:123]
    v_mfma_f32_16x16x32_bf16 v[132:135], v[72:75], v[84:87], v[132:135]
    s_mov_b32 s42, 0xffff0000
    s_waitcnt vmcnt(0)
    v_lshlrev_b32 v32, 16, v24
    v_and_b32 v33, s42, v24
    v_lshlrev_b32 v34, 16, v25
    v_and_b32 v35, s42, v25
    v_lshlrev_b32 v36, 16, v26
    v_and_b32 v37, s42, v26
    v_lshlrev_b32 v38, 16, v27
    v_and_b32 v39, s42, v27
    v_lshlrev_b32 v40, 16, v28
    v_and_b32 v41, s42, v28
    v_lshlrev_b32 v42, 16, v29
    v_and_b32 v43, s42, v29
    v_lshlrev_b32 v44, 16, v30
    v_and_b32 v45, s42, v30
    v_lshlrev_b32 v46, 16, v31
    v_and_b32 v47, s42, v31
    v_mov_b32 v80, 0xc0135761
    v_mov_b32 v81, 0xc0135761
    v_mov_b32 v82, 0xbdd2d3e8
    v_mov_b32 v83, 0xbdd2d3e8
    v_mov_b32 v84, 0x3f800000
    v_mov_b32 v85, 0x3f800000
    v_pk_add_f32 v[88:89], v[88:89], v[32:33]
    v_pk_add_f32 v[90:91], v[90:91], v[34:35]
    v_pk_add_f32 v[100:101], v[100:101], v[36:37]
    v_pk_add_f32 v[102:103], v[102:103], v[38:39]
    v_pk_mul_f32 v[60:61], v[88:89], v[88:89]
    v_pk_mul_f32 v[62:63], v[90:91], v[90:91]
    v_pk_mul_f32 v[64:65], v[100:101], v[100:101]
    v_pk_mul_f32 v[66:67], v[102:103], v[102:103]
    v_pk_fma_f32 v[60:61], v[60:61], v[82:83], v[80:81]
    v_pk_fma_f32 v[62:63], v[62:63], v[82:83], v[80:81]
    v_pk_fma_f32 v[64:65], v[64:65], v[82:83], v[80:81]
    v_pk_fma_f32 v[66:67], v[66:67], v[82:83], v[80:81]
    v_pk_mul_f32 v[60:61], v[60:61], v[88:89]
    v_pk_mul_f32 v[62:63], v[62:63], v[90:91]
    v_pk_mul_f32 v[64:65], v[64:65], v[100:101]
    v_pk_mul_f32 v[66:67], v[66:67], v[102:103]
    v_exp_f32 v60, v60
    v_exp_f32 v61, v61
    v_exp_f32 v62, v62
    v_exp_f32 v63, v63
    v_exp_f32 v64, v64
    v_exp_f32 v65, v65
    v_exp_f32 v66, v66
    v_exp_f32 v67, v67
    v_pk_add_f32 v[60:61], v[60:61], v[84:85]
    v_pk_add_f32 v[62:63], v[62:63], v[84:85]
    v_pk_add_f32 v[64:65], v[64:65], v[84:85]
    v_pk_add_f32 v[66:67], v[66:67], v[84:85]
    v_rcp_f32 v60, v60
    v_rcp_f32 v61, v61
    v_rcp_f32 v62, v62
    v_rcp_f32 v63, v63
    v_rcp_f32 v64, v64
    v_rcp_f32 v65, v65
    v_rcp_f32 v66, v66
    v_rcp_f32 v67, v67
    v_pk_mul_f32 v[88:89], v[88:89], v[60:61]
    v_pk_mul_f32 v[90:91], v[90:91], v[62:63]
    v_pk_mul_f32 v[100:101], v[100:101], v[64:65]
    v_pk_mul_f32 v[102:103], v[102:103], v[66:67]
    v_cvt_pk_bf16_f32 v72, v88, v89
    v_cvt_pk_bf16_f32 v73, v90, v91
    v_cvt_pk_bf16_f32 v74, v100, v101
    v_cvt_pk_bf16_f32 v75, v102, v103
    buffer_store_dwordx4 v[72:75], v14, s[28:31], s52 offen sc1
    v_pk_add_f32 v[112:113], v[112:113], v[40:41]
    v_pk_add_f32 v[114:115], v[114:115], v[42:43]
    v_pk_add_f32 v[124:125], v[124:125], v[44:45]
    v_pk_add_f32 v[126:127], v[126:127], v[46:47]
    v_pk_mul_f32 v[60:61], v[112:113], v[112:113]
    v_pk_mul_f32 v[62:63], v[114:115], v[114:115]
    v_pk_mul_f32 v[64:65], v[124:125], v[124:125]
    v_pk_mul_f32 v[66:67], v[126:127], v[126:127]
    v_pk_fma_f32 v[60:61], v[60:61], v[82:83], v[80:81]
    v_pk_fma_f32 v[62:63], v[62:63], v[82:83], v[80:81]
    v_pk_fma_f32 v[64:65], v[64:65], v[82:83], v[80:81]
    v_pk_fma_f32 v[66:67], v[66:67], v[82:83], v[80:81]
    v_pk_mul_f32 v[60:61], v[60:61], v[112:113]
    v_pk_mul_f32 v[62:63], v[62:63], v[114:115]
    v_pk_mul_f32 v[64:65], v[64:65], v[124:125]
    v_pk_mul_f32 v[66:67], v[66:67], v[126:127]
    v_exp_f32 v60, v60
    v_exp_f32 v61, v61
    v_exp_f32 v62, v62
    v_exp_f32 v63, v63
    v_exp_f32 v64, v64
    v_exp_f32 v65, v65
    v_exp_f32 v66, v66
    v_exp_f32 v67, v67
    v_pk_add_f32 v[60:61], v[60:61], v[84:85]
    v_pk_add_f32 v[62:63], v[62:63], v[84:85]
    v_pk_add_f32 v[64:65], v[64:65], v[84:85]
    v_pk_add_f32 v[66:67], v[66:67], v[84:85]
    v_rcp_f32 v60, v60
    v_rcp_f32 v61, v61
    v_rcp_f32 v62, v62
    v_rcp_f32 v63, v63
    v_rcp_f32 v64, v64
    v_rcp_f32 v65, v65
    v_rcp_f32 v66, v66
    v_rcp_f32 v67, v67
    v_pk_mul_f32 v[112:113], v[112:113], v[60:61]
    v_pk_mul_f32 v[114:115], v[114:115], v[62:63]
    v_pk_mul_f32 v[124:125], v[124:125], v[64:65]
    v_pk_mul_f32 v[126:127], v[126:127], v[66:67]
    v_cvt_pk_bf16_f32 v76, v112, v113
    v_cvt_pk_bf16_f32 v77, v114, v115
    v_cvt_pk_bf16_f32 v78, v124, v125
    v_cvt_pk_bf16_f32 v79, v126, v127
    buffer_store_dwordx4 v[76:79], v14, s[28:31], s55 offen sc1
    v_pk_add_f32 v[92:93], v[92:93], v[32:33]
    v_pk_add_f32 v[94:95], v[94:95], v[34:35]
    v_pk_add_f32 v[104:105], v[104:105], v[36:37]
    v_pk_add_f32 v[106:107], v[106:107], v[38:39]
    v_pk_mul_f32 v[60:61], v[92:93], v[92:93]
    v_pk_mul_f32 v[62:63], v[94:95], v[94:95]
    v_pk_mul_f32 v[64:65], v[104:105], v[104:105]
    v_pk_mul_f32 v[66:67], v[106:107], v[106:107]
    v_pk_fma_f32 v[60:61], v[60:61], v[82:83], v[80:81]
    v_pk_fma_f32 v[62:63], v[62:63], v[82:83], v[80:81]
    v_pk_fma_f32 v[64:65], v[64:65], v[82:83], v[80:81]
    v_pk_fma_f32 v[66:67], v[66:67], v[82:83], v[80:81]
    v_pk_mul_f32 v[60:61], v[60:61], v[92:93]
    v_pk_mul_f32 v[62:63], v[62:63], v[94:95]
    v_pk_mul_f32 v[64:65], v[64:65], v[104:105]
    v_pk_mul_f32 v[66:67], v[66:67], v[106:107]
    v_exp_f32 v60, v60
    v_exp_f32 v61, v61
    v_exp_f32 v62, v62
    v_exp_f32 v63, v63
    v_exp_f32 v64, v64
    v_exp_f32 v65, v65
    v_exp_f32 v66, v66
    v_exp_f32 v67, v67
    v_pk_add_f32 v[60:61], v[60:61], v[84:85]
    v_pk_add_f32 v[62:63], v[62:63], v[84:85]
    v_pk_add_f32 v[64:65], v[64:65], v[84:85]
    v_pk_add_f32 v[66:67], v[66:67], v[84:85]
    v_rcp_f32 v60, v60
    v_rcp_f32 v61, v61
    v_rcp_f32 v62, v62
    v_rcp_f32 v63, v63
    v_rcp_f32 v64, v64
    v_rcp_f32 v65, v65
    v_rcp_f32 v66, v66
    v_rcp_f32 v67, v67
    v_pk_mul_f32 v[92:93], v[92:93], v[60:61]
    v_pk_mul_f32 v[94:95], v[94:95], v[62:63]
    v_pk_mul_f32 v[104:105], v[104:105], v[64:65]
    v_pk_mul_f32 v[106:107], v[106:107], v[66:67]
    v_cvt_pk_bf16_f32 v72, v92, v93
    v_cvt_pk_bf16_f32 v73, v94, v95
    v_cvt_pk_bf16_f32 v74, v104, v105
    v_cvt_pk_bf16_f32 v75, v106, v107
    buffer_store_dwordx4 v[72:75], v14, s[28:31], s53 offen sc1
    v_pk_add_f32 v[116:117], v[116:117], v[40:41]
    v_pk_add_f32 v[118:119], v[118:119], v[42:43]
    v_pk_add_f32 v[128:129], v[128:129], v[44:45]
    v_pk_add_f32 v[130:131], v[130:131], v[46:47]
    v_pk_mul_f32 v[60:61], v[116:117], v[116:117]
    v_pk_mul_f32 v[62:63], v[118:119], v[118:119]
    v_pk_mul_f32 v[64:65], v[128:129], v[128:129]
    v_pk_mul_f32 v[66:67], v[130:131], v[130:131]
    v_pk_fma_f32 v[60:61], v[60:61], v[82:83], v[80:81]
    v_pk_fma_f32 v[62:63], v[62:63], v[82:83], v[80:81]
    v_pk_fma_f32 v[64:65], v[64:65], v[82:83], v[80:81]
    v_pk_fma_f32 v[66:67], v[66:67], v[82:83], v[80:81]
    v_pk_mul_f32 v[60:61], v[60:61], v[116:117]
    v_pk_mul_f32 v[62:63], v[62:63], v[118:119]
    v_pk_mul_f32 v[64:65], v[64:65], v[128:129]
    v_pk_mul_f32 v[66:67], v[66:67], v[130:131]
    v_exp_f32 v60, v60
    v_exp_f32 v61, v61
    v_exp_f32 v62, v62
    v_exp_f32 v63, v63
    v_exp_f32 v64, v64
    v_exp_f32 v65, v65
    v_exp_f32 v66, v66
    v_exp_f32 v67, v67
    v_pk_add_f32 v[60:61], v[60:61], v[84:85]
    v_pk_add_f32 v[62:63], v[62:63], v[84:85]
    v_pk_add_f32 v[64:65], v[64:65], v[84:85]
    v_pk_add_f32 v[66:67], v[66:67], v[84:85]
    v_rcp_f32 v60, v60
    v_rcp_f32 v61, v61
    v_rcp_f32 v62, v62
    v_rcp_f32 v63, v63
    v_rcp_f32 v64, v64
    v_rcp_f32 v65, v65
    v_rcp_f32 v66, v66
    v_rcp_f32 v67, v67
    v_pk_mul_f32 v[116:117], v[116:117], v[60:61]
    v_pk_mul_f32 v[118:119], v[118:119], v[62:63]
    v_pk_mul_f32 v[128:129], v[128:129], v[64:65]
    v_pk_mul_f32 v[130:131], v[130:131], v[66:67]
    v_cvt_pk_bf16_f32 v76, v116, v117
    v_cvt_pk_bf16_f32 v77, v118, v119
    v_cvt_pk_bf16_f32 v78, v128, v129
    v_cvt_pk_bf16_f32 v79, v130, v131
    buffer_store_dwordx4 v[76:79], v14, s[28:31], s56 offen sc1
    v_pk_add_f32 v[96:97], v[96:97], v[32:33]
    v_pk_add_f32 v[98:99], v[98:99], v[34:35]
    v_pk_add_f32 v[108:109], v[108:109], v[36:37]
    v_pk_add_f32 v[110:111], v[110:111], v[38:39]
    v_pk_mul_f32 v[60:61], v[96:97], v[96:97]
    v_pk_mul_f32 v[62:63], v[98:99], v[98:99]
    v_pk_mul_f32 v[64:65], v[108:109], v[108:109]
    v_pk_mul_f32 v[66:67], v[110:111], v[110:111]
    v_pk_fma_f32 v[60:61], v[60:61], v[82:83], v[80:81]
    v_pk_fma_f32 v[62:63], v[62:63], v[82:83], v[80:81]
    v_pk_fma_f32 v[64:65], v[64:65], v[82:83], v[80:81]
    v_pk_fma_f32 v[66:67], v[66:67], v[82:83], v[80:81]
    v_pk_mul_f32 v[60:61], v[60:61], v[96:97]
    v_pk_mul_f32 v[62:63], v[62:63], v[98:99]
    v_pk_mul_f32 v[64:65], v[64:65], v[108:109]
    v_pk_mul_f32 v[66:67], v[66:67], v[110:111]
    v_exp_f32 v60, v60
    v_exp_f32 v61, v61
    v_exp_f32 v62, v62
    v_exp_f32 v63, v63
    v_exp_f32 v64, v64
    v_exp_f32 v65, v65
    v_exp_f32 v66, v66
    v_exp_f32 v67, v67
    v_pk_add_f32 v[60:61], v[60:61], v[84:85]
    v_pk_add_f32 v[62:63], v[62:63], v[84:85]
    v_pk_add_f32 v[64:65], v[64:65], v[84:85]
    v_pk_add_f32 v[66:67], v[66:67], v[84:85]
    v_rcp_f32 v60, v60
    v_rcp_f32 v61, v61
    v_rcp_f32 v62, v62
    v_rcp_f32 v63, v63
    v_rcp_f32 v64, v64
    v_rcp_f32 v65, v65
    v_rcp_f32 v66, v66
    v_rcp_f32 v67, v67
    v_pk_mul_f32 v[96:97], v[96:97], v[60:61]
    v_pk_mul_f32 v[98:99], v[98:99], v[62:63]
    v_pk_mul_f32 v[108:109], v[108:109], v[64:65]
    v_pk_mul_f32 v[110:111], v[110:111], v[66:67]
    v_cvt_pk_bf16_f32 v72, v96, v97
    v_cvt_pk_bf16_f32 v73, v98, v99
    v_cvt_pk_bf16_f32 v74, v108, v109
    v_cvt_pk_bf16_f32 v75, v110, v111
    buffer_store_dwordx4 v[72:75], v14, s[28:31], s54 offen sc1
    v_pk_add_f32 v[120:121], v[120:121], v[40:41]
    v_pk_add_f32 v[122:123], v[122:123], v[42:43]
    v_pk_add_f32 v[132:133], v[132:133], v[44:45]
    v_pk_add_f32 v[134:135], v[134:135], v[46:47]
    v_pk_mul_f32 v[60:61], v[120:121], v[120:121]
    v_pk_mul_f32 v[62:63], v[122:123], v[122:123]
    v_pk_mul_f32 v[64:65], v[132:133], v[132:133]
    v_pk_mul_f32 v[66:67], v[134:135], v[134:135]
    v_pk_fma_f32 v[60:61], v[60:61], v[82:83], v[80:81]
    v_pk_fma_f32 v[62:63], v[62:63], v[82:83], v[80:81]
    v_pk_fma_f32 v[64:65], v[64:65], v[82:83], v[80:81]
    v_pk_fma_f32 v[66:67], v[66:67], v[82:83], v[80:81]
    v_pk_mul_f32 v[60:61], v[60:61], v[120:121]
    v_pk_mul_f32 v[62:63], v[62:63], v[122:123]
    v_pk_mul_f32 v[64:65], v[64:65], v[132:133]
    v_pk_mul_f32 v[66:67], v[66:67], v[134:135]
    v_exp_f32 v60, v60
    v_exp_f32 v61, v61
    v_exp_f32 v62, v62
    v_exp_f32 v63, v63
    v_exp_f32 v64, v64
    v_exp_f32 v65, v65
    v_exp_f32 v66, v66
    v_exp_f32 v67, v67
    v_pk_add_f32 v[60:61], v[60:61], v[84:85]
    v_pk_add_f32 v[62:63], v[62:63], v[84:85]
    v_pk_add_f32 v[64:65], v[64:65], v[84:85]
    v_pk_add_f32 v[66:67], v[66:67], v[84:85]
    v_rcp_f32 v60, v60
    v_rcp_f32 v61, v61
    v_rcp_f32 v62, v62
    v_rcp_f32 v63, v63
    v_rcp_f32 v64, v64
    v_rcp_f32 v65, v65
    v_rcp_f32 v66, v66
    v_rcp_f32 v67, v67
    v_pk_mul_f32 v[120:121], v[120:121], v[60:61]
    v_pk_mul_f32 v[122:123], v[122:123], v[62:63]
    v_pk_mul_f32 v[132:133], v[132:133], v[64:65]
    v_pk_mul_f32 v[134:135], v[134:135], v[66:67]
    v_cvt_pk_bf16_f32 v76, v120, v121
    v_cvt_pk_bf16_f32 v77, v122, v123
    v_cvt_pk_bf16_f32 v78, v132, v133
    v_cvt_pk_bf16_f32 v79, v134, v135
    buffer_store_dwordx4 v[76:79], v14, s[28:31], s57 offen sc1
    v_mov_b32 v3, 1
    s_waitcnt vmcnt(0)
    s_mov_b64 exec, 1
    buffer_store_dword v3, off, s[28:31], s58 sc1
    s_mov_b64 exec, -1
    s_barrier
t_cons2:
    s_lshr_b32 s44, s36, 1
    s_and_b32 s45, s36, 1
    s_lshl_b32 s45, s45, 3
    s_lshr_b32 s46, s37, 2
    s_add_u32 s45, s45, s46
    s_and_b32 s46, s37, 3
    s_lshr_b32 s47, s44, 1
    s_and_b32 s48, s44, 1
    s_lshl_b32 s40, s3, 1
    s_add_u32 s40, s40, s47
    s_xor_b32 s41, s40, 1
    v_lshrrev_b32 v2, 2, v5
    v_and_b32 v3, 1, v6
    v_lshl_add_u32 v3, v3, 2, v2
    v_mad_u32_u24 v2, v6, 4, v2
    v_lshlrev_b32 v2, 8, v2
    v_and_b32 v4, 3, v1
    v_lshl_add_u32 v2, v4, 3, v2
    v_xor_b32 v4, s40, v3
    v_lshl_add_u32 v8, v4, 5, v2
    v_xor_b32 v4, s41, v3
    v_lshl_add_u32 v9, v4, 5, v2
    s_lshl_b32 s42, s48, 12
    s_add_u32 s43, s42, 16384
    v_add_u32 v10, s43, v14
    s_xor_b32 s43, s43, 4096
    v_add_u32 v11, s43, v14
    v_add_u32 v12, 24576, v14
    s_lshl_b32 s49, s45, 3
    s_add_u32 s49, s49, s40
    s_lshl_b32 s49, s49, 4
    v_add_u32 v2, s49, v5
    v_mov_b32 v230, 0
    v_lshlrev_b32 v3, 1, v2
    buffer_load_short_d16_hi v230, v3, s[12:15], 0 offen
    v_mul_u32_u24 v2, 1152, v2
    v_lshl_add_u32 v22, v6, 3, v2
    s_mul_i32 s49, s46, 288
    s_lshl_b32 s52, s48, 7
    s_add_u32 s52, s52, s49
    s_lshl_b32 s53, s48, 2
    s_add_u32 s53, s53, s49
    s_add_u32 s53, s53, 256
    s_add_u32 s54, s52, 10485760
    s_add_u32 s55, s53, 10485760
    v_lshlrev_b32 v3, 4, v6
    s_lshl_b32 s56, s52, 1
    s_add_u32 s56, s56, 11520
    s_lshl_b32 s57, s53, 1
    s_add_u32 s57, s57, 11520
    v_mov_b32 v115, s26
    v_mov_b32 v119, s26
    v_mov_b32 v123, s26
    v_mov_b32 v235, s26
    v_mov_b32 v239, s26
    v_mov_b32 v243, s26
    v_mov_b32 v247, s26
    v_mov_b32 v251, s26
    v_mov_b32 v255, s26
    s_lshl_b32 s50, s46, 4
    s_add_u32 s50, s50, s45
    s_lshl_b32 s50, s50, 2
    s_add_u32 s50, s50, s3
    s_lshl_b32 s50, s50, 4
    s_xor_b32 s51, s44, 1
    s_lshl_b32 s61, s51, 2
    s_add_u32 s61, s61, s44
    s_add_u32 s61, s61, s50
    s_mul_i32 s61, s61, 3072
    s_add_u32 s61, s61, 25165824
    s_lshl_b32 s5, s44, 2
    s_add_u32 s5, s5, s51
    s_add_u32 s5, s5, s50
    s_mul_i32 s5, s5, 3072
    s_add_u32 s5, s5, 25165824
    s_xor_b32 s51, s44, 2
    s_lshl_b32 s62, s51, 2
    s_add_u32 s62, s62, s44
    s_add_u32 s62, s62, s50
    s_mul_i32 s62, s62, 3072
    s_add_u32 s62, s62, 25165824
    s_lshl_b32 s6, s44, 2
    s_add_u32 s6, s6, s51
    s_add_u32 s6, s6, s50
    s_mul_i32 s6, s6, 3072
    s_add_u32 s6, s6, 25165824
    s_xor_b32 s51, s44, 3
    s_lshl_b32 s63, s51, 2
    s_add_u32 s63, s63, s44
    s_add_u32 s63, s63, s50
    s_mul_i32 s63, s63, 3072
    s_add_u32 s63, s63, 25165824
    s_lshl_b32 s7, s44, 2
    s_add_u32 s7, s7, s51
    s_add_u32 s7, s7, s50
    s_mul_i32 s7, s7, 3072
    s_add_u32 s7, s7, 25165824
    v_mov_b32 v23, s5
    v_writelane_b32 v23, s6, 1
    v_writelane_b32 v23, s7, 2
    s_cmp_lt_u32 s2, 216
    s_cbranch_scc0 g2_late_ops
    buffer_load_dwordx2 v[200:201], v22, s[28:31], s54 offen offset:0
    buffer_load_dwordx2 v[202:203], v22, s[28:31], s54 offen offset:32
    buffer_load_dwordx2 v[204:205], v22, s[28:31], s54 offen offset:64
    buffer_load_dwordx2 v[206:207], v22, s[28:31], s54 offen offset:96
    buffer_load_dword v208, v22, s[28:31], s55 offen
    buffer_load_dwordx4 v[210:213], v3, s[28:31], s56 offen offset:0
    buffer_load_dwordx4 v[214:217], v3, s[28:31], s56 offen offset:64
    buffer_load_dwordx4 v[218:221], v3, s[28:31], s56 offen offset:128
    buffer_load_dwordx4 v[222:225], v3, s[28:31], s56 offen offset:192
    buffer_load_dwordx2 v[226:227], v3, s[28:31], s57 offen
g2_late_ops:
    v_mov_b32 v128, 0
    v_mov_b32 v129, 0
    v_mov_b32 v130, 0
    v_mov_b32 v131, 0
    v_mov_b32 v132, 0
    v_mov_b32 v133, 0
    v_mov_b32 v134, 0
    v_mov_b32 v135, 0
    v_mov_b32 v136, 0
    v_mov_b32 v137, 0
    v_mov_b32 v138, 0
    v_mov_b32 v139, 0
    v_mov_b32 v140, 0
    v_mov_b32 v141, 0
    v_mov_b32 v142, 0
    v_mov_b32 v143, 0
    v_mov_b32 v144, 0
    v_mov_b32 v145, 0
    v_mov_b32 v146, 0
    v_mov_b32 v147, 0
    v_mov_b32 v148, 0
    v_mov_b32 v149, 0
    v_mov_b32 v150, 0
    v_mov_b32 v151, 0
    v_mov_b32 v152, 0
    v_mov_b32 v153, 0
    v_mov_b32 v154, 0
    v_mov_b32 v155, 0
    v_mov_b32 v156, 0
    v_mov_b32 v157, 0
    v_mov_b32 v158, 0
    v_mov_b32 v159, 0
    v_mov_b32 v160, 0
    v_mov_b32 v161, 0
    v_mov_b32 v162, 0
    v_mov_b32 v163, 0
    v_mov_b32 v164, 0
    v_mov_b32 v165, 0
    v_mov_b32 v166, 0
    v_mov_b32 v167, 0
    v_mov_b32 v168, 0
    v_mov_b32 v169, 0
    v_mov_b32 v170, 0
    v_mov_b32 v171, 0
    v_mov_b32 v172, 0
    v_mov_b32 v173, 0
    v_mov_b32 v174, 0
    v_mov_b32 v175, 0
    v_mov_b32 v176, 0
    v_mov_b32 v177, 0
    v_mov_b32 v178, 0
    v_mov_b32 v179, 0
    v_mov_b32 v180, 0
    v_mov_b32 v181, 0
    v_mov_b32 v182, 0
    v_mov_b32 v183, 0
    v_mov_b32 v184, 0
    v_mov_b32 v185, 0
    v_mov_b32 v186, 0
    v_mov_b32 v187, 0
    v_mov_b32 v188, 0
    v_mov_b32 v189, 0
    v_mov_b32 v190, 0
    v_mov_b32 v191, 0
    v_mov_b32 v192, 0
    v_mov_b32 v193, 0
    v_mov_b32 v194, 0
    v_mov_b32 v195, 0
    v_mov_b32 v196, 0
    v_mov_b32 v197, 0
    v_mov_b32 v198, 0
    v_mov_b32 v199, 0
    s_mov_b32 s24, 0
    v_add_u32 v16, s24, v8
    v_add_u32 v17, s24, v9
    v_add_u32 v18, s24, v10
    v_add_u32 v19, s24, v11
    v_add_u32 v20, s24, v12
    s_movk_i32 s59, 17
    s_barrier
    ds_read_b128 v[32:35], v18 offset:0
    ds_read_b64_tr_b16 v[24:25], v16 offset:0
    ds_read_b64_tr_b16 v[26:27], v16 offset:4096
    ds_read_b64_tr_b16 v[28:29], v17 offset:0
    ds_read_b64_tr_b16 v[30:31], v17 offset:4096
    ds_read_b128 v[36:39], v18 offset:1024
    ds_read_b128 v[40:43], v18 offset:2048
    ds_read_b128 v[44:47], v18 offset:3072
    ds_read_b128 v[48:51], v19 offset:0
    ds_read_b128 v[52:55], v19 offset:1024
    ds_read_b128 v[56:59], v19 offset:2048
    ds_read_b128 v[60:63], v19 offset:3072
    ds_read_b128 v[64:67], v20 offset:0
    s_cmp_lt_u32 s2, 216
    s_cbranch_scc1 g2_late_done
    buffer_load_dwordx2 v[200:201], v22, s[28:31], s54 offen offset:0
    buffer_load_dwordx2 v[202:203], v22, s[28:31], s54 offen offset:32
    buffer_load_dwordx2 v[204:205], v22, s[28:31], s54 offen offset:64
    buffer_load_dwordx2 v[206:207], v22, s[28:31], s54 offen offset:96
    buffer_load_dword v208, v22, s[28:31], s55 offen
    buffer_load_dwordx4 v[210:213], v3, s[28:31], s56 offen offset:0
    buffer_load_dwordx4 v[214:217], v3, s[28:31], s56 offen offset:64
    buffer_load_dwordx4 v[218:221], v3, s[28:31], s56 offen offset:128
    buffer_load_dwordx4 v[222:225], v3, s[28:31], s56 offen offset:192
    buffer_load_dwordx2 v[226:227], v3, s[28:31], s57 offen
g2_late_done:
g2_mm_loop:
    s_waitcnt lgkmcnt(0)
    v_mfma_f32_16x16x32_bf16 v[128:131], v[32:35], v[24:27], v[128:131]
    ds_read_b128 v[76:79], v18 offset:9216
    ds_read_b64_tr_b16 v[68:69], v16 offset:8192
    v_mfma_f32_16x16x32_bf16 v[164:167], v[32:35], v[28:31], v[164:167]
    ds_read_b64_tr_b16 v[70:71], v16 offset:12288
    ds_read_b64_tr_b16 v[72:73], v17 offset:8192
    v_mfma_f32_16x16x32_bf16 v[168:171], v[36:39], v[28:31], v[168:171]
    ds_read_b64_tr_b16 v[74:75], v17 offset:12288
    ds_read_b128 v[80:83], v18 offset:10240
    v_mfma_f32_16x16x32_bf16 v[132:135], v[36:39], v[24:27], v[132:135]
    ds_read_b128 v[84:87], v18 offset:11264
    ds_read_b128 v[88:91], v18 offset:12288
    v_mfma_f32_16x16x32_bf16 v[136:139], v[40:43], v[24:27], v[136:139]
    ds_read_b128 v[92:95], v19 offset:9216
    ds_read_b128 v[96:99], v19 offset:10240
    v_mfma_f32_16x16x32_bf16 v[172:175], v[40:43], v[28:31], v[172:175]
    ds_read_b128 v[100:103], v19 offset:11264
    ds_read_b128 v[104:107], v19 offset:12288
    v_mfma_f32_16x16x32_bf16 v[176:179], v[44:47], v[28:31], v[176:179]
    ds_read_b128 v[108:111], v20 offset:9216
    s_add_u32 s24, s24, 34816
    v_mfma_f32_16x16x32_bf16 v[140:143], v[44:47], v[24:27], v[140:143]
    s_cmp_eq_u32 s24, 139264
    s_cselect_b32 s24, 0, s24
    v_mfma_f32_16x16x32_bf16 v[144:147], v[48:51], v[24:27], v[144:147]
    v_add_u32 v16, s24, v8
    v_add_u32 v17, s24, v9
    v_mfma_f32_16x16x32_bf16 v[180:183], v[48:51], v[28:31], v[180:183]
    v_add_u32 v18, s24, v10
    v_add_u32 v19, s24, v11
    v_mfma_f32_16x16x32_bf16 v[184:187], v[52:55], v[28:31], v[184:187]
    v_add_u32 v20, s24, v12
    v_mfma_f32_16x16x32_bf16 v[148:151], v[52:55], v[24:27], v[148:151]
    v_mfma_f32_16x16x32_bf16 v[152:155], v[56:59], v[24:27], v[152:155]
    v_mfma_f32_16x16x32_bf16 v[188:191], v[56:59], v[28:31], v[188:191]
    v_mfma_f32_16x16x32_bf16 v[192:195], v[60:63], v[28:31], v[192:195]
    v_mfma_f32_16x16x32_bf16 v[156:159], v[60:63], v[24:27], v[156:159]
    s_waitcnt lgkmcnt(0)
    s_barrier
    v_mfma_f32_16x16x32_bf16 v[160:163], v[64:67], v[24:27], v[160:163]
    v_mfma_f32_16x16x32_bf16 v[196:199], v[64:67], v[28:31], v[196:199]
    v_mfma_f32_16x16x32_bf16 v[128:131], v[76:79], v[68:71], v[128:131]
    ds_read_b128 v[32:35], v18 offset:0
    ds_read_b64_tr_b16 v[24:25], v16 offset:0
    v_mfma_f32_16x16x32_bf16 v[164:167], v[76:79], v[72:75], v[164:167]
    ds_read_b64_tr_b16 v[26:27], v16 offset:4096
    ds_read_b64_tr_b16 v[28:29], v17 offset:0
    v_mfma_f32_16x16x32_bf16 v[168:171], v[80:83], v[72:75], v[168:171]
    ds_read_b64_tr_b16 v[30:31], v17 offset:4096
    ds_read_b128 v[36:39], v18 offset:1024
    v_mfma_f32_16x16x32_bf16 v[132:135], v[80:83], v[68:71], v[132:135]
    ds_read_b128 v[40:43], v18 offset:2048
    ds_read_b128 v[44:47], v18 offset:3072
    v_mfma_f32_16x16x32_bf16 v[136:139], v[84:87], v[68:71], v[136:139]
    ds_read_b128 v[48:51], v19 offset:0
    ds_read_b128 v[52:55], v19 offset:1024
    v_mfma_f32_16x16x32_bf16 v[172:175], v[84:87], v[72:75], v[172:175]
    ds_read_b128 v[56:59], v19 offset:2048
    ds_read_b128 v[60:63], v19 offset:3072
    v_mfma_f32_16x16x32_bf16 v[176:179], v[88:91], v[72:75], v[176:179]
    ds_read_b128 v[64:67], v20 offset:0
    s_sub_u32 s59, s59, 1
    v_mfma_f32_16x16x32_bf16 v[140:143], v[88:91], v[68:71], v[140:143]
    s_cmp_lg_u32 s59, 0
    v_mfma_f32_16x16x32_bf16 v[144:147], v[92:95], v[68:71], v[144:147]
    v_mfma_f32_16x16x32_bf16 v[180:183], v[92:95], v[72:75], v[180:183]
    v_mfma_f32_16x16x32_bf16 v[184:187], v[96:99], v[72:75], v[184:187]
    v_mfma_f32_16x16x32_bf16 v[148:151], v[96:99], v[68:71], v[148:151]
    v_mfma_f32_16x16x32_bf16 v[152:155], v[100:103], v[68:71], v[152:155]
    v_mfma_f32_16x16x32_bf16 v[188:191], v[100:103], v[72:75], v[188:191]
    v_mfma_f32_16x16x32_bf16 v[192:195], v[104:107], v[72:75], v[192:195]
    v_mfma_f32_16x16x32_bf16 v[156:159], v[104:107], v[68:71], v[156:159]
    v_mfma_f32_16x16x32_bf16 v[160:163], v[108:111], v[68:71], v[160:163]
    v_mfma_f32_16x16x32_bf16 v[196:199], v[108:111], v[72:75], v[196:199]
    s_cbranch_scc1 g2_mm_loop
    s_waitcnt lgkmcnt(0)
    v_mfma_f32_16x16x32_bf16 v[128:131], v[32:35], v[24:27], v[128:131]
    ds_read_b128 v[76:79], v18 offset:9216
    ds_read_b64_tr_b16 v[68:69], v16 offset:8192
    v_mfma_f32_16x16x32_bf16 v[164:167], v[32:35], v[28:31], v[164:167]
    ds_read_b64_tr_b16 v[70:71], v16 offset:12288
    ds_read_b64_tr_b16 v[72:73], v17 offset:8192
    v_mfma_f32_16x16x32_bf16 v[168:171], v[36:39], v[28:31], v[168:171]
    ds_read_b64_tr_b16 v[74:75], v17 offset:12288
    ds_read_b128 v[80:83], v18 offset:10240
    v_mfma_f32_16x16x32_bf16 v[132:135], v[36:39], v[24:27], v[132:135]
    ds_read_b128 v[84:87], v18 offset:11264
    ds_read_b128 v[88:91], v18 offset:12288
    v_mfma_f32_16x16x32_bf16 v[136:139], v[40:43], v[24:27], v[136:139]
    ds_read_b128 v[92:95], v19 offset:9216
    ds_read_b128 v[96:99], v19 offset:10240
    v_mfma_f32_16x16x32_bf16 v[172:175], v[40:43], v[28:31], v[172:175]
    ds_read_b128 v[100:103], v19 offset:11264
    ds_read_b128 v[104:107], v19 offset:12288
    v_mfma_f32_16x16x32_bf16 v[176:179], v[44:47], v[28:31], v[176:179]
    ds_read_b128 v[108:111], v20 offset:9216
    v_mfma_f32_16x16x32_bf16 v[140:143], v[44:47], v[24:27], v[140:143]
    v_mfma_f32_16x16x32_bf16 v[144:147], v[48:51], v[24:27], v[144:147]
    v_mfma_f32_16x16x32_bf16 v[180:183], v[48:51], v[28:31], v[180:183]
    v_mfma_f32_16x16x32_bf16 v[184:187], v[52:55], v[28:31], v[184:187]
    v_mfma_f32_16x16x32_bf16 v[148:151], v[52:55], v[24:27], v[148:151]
    v_mfma_f32_16x16x32_bf16 v[152:155], v[56:59], v[24:27], v[152:155]
    v_mfma_f32_16x16x32_bf16 v[188:191], v[56:59], v[28:31], v[188:191]
    v_mfma_f32_16x16x32_bf16 v[192:195], v[60:63], v[28:31], v[192:195]
    v_mfma_f32_16x16x32_bf16 v[156:159], v[60:63], v[24:27], v[156:159]
    v_mfma_f32_16x16x32_bf16 v[160:163], v[64:67], v[24:27], v[160:163]
    v_mfma_f32_16x16x32_bf16 v[196:199], v[64:67], v[28:31], v[196:199]
    s_waitcnt lgkmcnt(0)
    v_mfma_f32_16x16x32_bf16 v[128:131], v[76:79], v[68:71], v[128:131]
    v_mfma_f32_16x16x32_bf16 v[164:167], v[76:79], v[72:75], v[164:167]
    v_mfma_f32_16x16x32_bf16 v[168:171], v[80:83], v[72:75], v[168:171]
    v_mfma_f32_16x16x32_bf16 v[132:135], v[80:83], v[68:71], v[132:135]
    v_mfma_f32_16x16x32_bf16 v[136:139], v[84:87], v[68:71], v[136:139]
    v_mfma_f32_16x16x32_bf16 v[172:175], v[84:87], v[72:75], v[172:175]
    v_mfma_f32_16x16x32_bf16 v[176:179], v[88:91], v[72:75], v[176:179]
    v_mfma_f32_16x16x32_bf16 v[140:143], v[88:91], v[68:71], v[140:143]
    v_mfma_f32_16x16x32_bf16 v[144:147], v[92:95], v[68:71], v[144:147]
    v_mfma_f32_16x16x32_bf16 v[180:183], v[92:95], v[72:75], v[180:183]
    v_mfma_f32_16x16x32_bf16 v[184:187], v[96:99], v[72:75], v[184:187]
    v_mfma_f32_16x16x32_bf16 v[148:151], v[96:99], v[68:71], v[148:151]
    v_mfma_f32_16x16x32_bf16 v[152:155], v[100:103], v[68:71], v[152:155]
    v_mfma_f32_16x16x32_bf16 v[188:191], v[100:103], v[72:75], v[188:191]
    v_mfma_f32_16x16x32_bf16 v[192:195], v[104:107], v[72:75], v[192:195]
    v_mfma_f32_16x16x32_bf16 v[156:159], v[104:107], v[68:71], v[156:159]
    v_mfma_f32_16x16x32_bf16 v[160:163], v[108:111], v[68:71], v[160:163]
    v_mfma_f32_16x16x32_bf16 v[196:199], v[108:111], v[72:75], v[196:199]
    s_cmp_eq_u32 s48, 1
    s_cbranch_scc0 g2_noswap
    s_nop 4
    v_swap_b32 v160, v162
    v_swap_b32 v161, v163
    v_swap_b32 v196, v198
    v_swap_b32 v197, v199
g2_noswap:
    v_cvt_pk_bf16_f32 v112, v144, v145
    v_cvt_pk_bf16_f32 v113, v146, v147
    v_cvt_pk_bf16_f32 v114, v148, v149
    buffer_store_dwordx4 v[112:115], v14, s[28:31], s61 offen offset:0 sc1
    v_cvt_pk_bf16_f32 v116, v150, v151
    v_cvt_pk_bf16_f32 v117, v152, v153
    v_cvt_pk_bf16_f32 v118, v154, v155
    buffer_store_dwordx4 v[116:119], v14, s[28:31], s61 offen offset:1024 sc1
    v_cvt_pk_bf16_f32 v120, v156, v157
    v_cvt_pk_bf16_f32 v121, v158, v159
    v_cvt_pk_bf16_f32 v122, v162, v163
    buffer_store_dwordx4 v[120:123], v14, s[28:31], s61 offen offset:2048 sc1
    v_cvt_pk_bf16_f32 v232, v164, v165
    v_cvt_pk_bf16_f32 v233, v166, v167
    v_cvt_pk_bf16_f32 v234, v168, v169
    buffer_store_dwordx4 v[232:235], v14, s[28:31], s62 offen offset:0 sc1
    v_cvt_pk_bf16_f32 v236, v170, v171
    v_cvt_pk_bf16_f32 v237, v172, v173
    v_cvt_pk_bf16_f32 v238, v174, v175
    buffer_store_dwordx4 v[236:239], v14, s[28:31], s62 offen offset:1024 sc1
    v_cvt_pk_bf16_f32 v240, v176, v177
    v_cvt_pk_bf16_f32 v241, v178, v179
    v_cvt_pk_bf16_f32 v242, v196, v197
    buffer_store_dwordx4 v[240:243], v14, s[28:31], s62 offen offset:2048 sc1
    v_cvt_pk_bf16_f32 v244, v180, v181
    v_cvt_pk_bf16_f32 v245, v182, v183
    v_cvt_pk_bf16_f32 v246, v184, v185
    buffer_store_dwordx4 v[244:247], v14, s[28:31], s63 offen offset:0 sc1
    v_cvt_pk_bf16_f32 v248, v186, v187
    v_cvt_pk_bf16_f32 v249, v188, v189
    v_cvt_pk_bf16_f32 v250, v190, v191
    buffer_store_dwordx4 v[248:251], v14, s[28:31], s63 offen offset:1024 sc1
    v_cvt_pk_bf16_f32 v252, v192, v193
    v_cvt_pk_bf16_f32 v253, v194, v195
    v_cvt_pk_bf16_f32 v254, v198, v199
    buffer_store_dwordx4 v[252:255], v14, s[28:31], s63 offen offset:2048 sc1
    s_mov_b32 s42, 0xffff0000
    s_waitcnt vmcnt(9)
    v_add_f32 v128, v128, v230
    v_add_f32 v129, v129, v230
    v_add_f32 v130, v130, v230
    v_add_f32 v131, v131, v230
    v_add_f32 v132, v132, v230
    v_add_f32 v133, v133, v230
    v_add_f32 v134, v134, v230
    v_add_f32 v135, v135, v230
    v_add_f32 v136, v136, v230
    v_add_f32 v137, v137, v230
    v_add_f32 v138, v138, v230
    v_add_f32 v139, v139, v230
    v_add_f32 v140, v140, v230
    v_add_f32 v141, v141, v230
    v_add_f32 v142, v142, v230
    v_add_f32 v143, v143, v230
    v_add_f32 v160, v160, v230
    v_add_f32 v161, v161, v230
    v_lshlrev_b32 v32, 16, v200
    v_and_b32 v33, s42, v200
    v_lshlrev_b32 v34, 16, v201
    v_and_b32 v35, s42, v201
    v_lshlrev_b32 v36, 16, v202
    v_and_b32 v37, s42, v202
    v_lshlrev_b32 v38, 16, v203
    v_and_b32 v39, s42, v203
    v_lshlrev_b32 v40, 16, v204
    v_and_b32 v41, s42, v204
    v_lshlrev_b32 v42, 16, v205
    v_and_b32 v43, s42, v205
    v_lshlrev_b32 v44, 16, v206
    v_and_b32 v45, s42, v206
    v_lshlrev_b32 v46, 16, v207
    v_and_b32 v47, s42, v207
    v_lshlrev_b32 v48, 16, v208
    v_and_b32 v49, s42, v208
    s_mov_b32 s49, 0
    s_mov_b64 s[40:41], 7
g2_scout:
    s_mov_b64 exec, s[40:41]
    buffer_load_dword v2, v23, s[28:31], 0 offen offset:3068 sc1
    s_add_u32 s49, s49, 1
    s_waitcnt vmcnt(0)
    v_cmp_eq_u32 vcc, s26, v2
    s_mov_b64 exec, -1
    s_bitcmp1_b32 vcc_lo, 0
    s_cbranch_scc0 g2_sc1
    buffer_load_dwordx4 v[68:71], v14, s[28:31], s5 offen offset:0 sc1
    buffer_load_dwordx4 v[72:75], v14, s[28:31], s5 offen offset:1024 sc1
    buffer_load_dwordx4 v[76:79], v14, s[28:31], s5 offen offset:2048 sc1
g2_sc1:
    s_bitcmp1_b32 vcc_lo, 1
    s_cbranch_scc0 g2_sc2
    buffer_load_dwordx4 v[80:83], v14, s[28:31], s6 offen offset:0 sc1
    buffer_load_dwordx4 v[84:87], v14, s[28:31], s6 offen offset:1024 sc1
    buffer_load_dwordx4 v[88:91], v14, s[28:31], s6 offen offset:2048 sc1
g2_sc2:
    s_bitcmp1_b32 vcc_lo, 2
    s_cbranch_scc0 g2_sc3
    buffer_load_dwordx4 v[92:95], v14, s[28:31], s7 offen offset:0 sc1
    buffer_load_dwordx4 v[96:99], v14, s[28:31], s7 offen offset:1024 sc1
    buffer_load_dwordx4 v[100:103], v14, s[28:31], s7 offen offset:2048 sc1
g2_sc3:
    s_andn2_b32 s40, s40, vcc_lo
    s_cbranch_scc0 g2_check
    s_cmp_lt_u32 s49, 30000
    s_cbranch_scc1 g2_scout
g2_poll:
    buffer_load_dwordx4 v[68:71], v14, s[28:31], s5 offen offset:0 sc1
    buffer_load_dwordx4 v[72:75], v14, s[28:31], s5 offen offset:1024 sc1
    buffer_load_dwordx4 v[76:79], v14, s[28:31], s5 offen offset:2048 sc1
    buffer_load_dwordx4 v[80:83], v14, s[28:31], s6 offen offset:0 sc1
    buffer_load_dwordx4 v[84:87], v14, s[28:31], s6 offen offset:1024 sc1
    buffer_load_dwordx4 v[88:91], v14, s[28:31], s6 offen offset:2048 sc1
    buffer_load_dwordx4 v[92:95], v14, s[28:31], s7 offen offset:0 sc1
    buffer_load_dwordx4 v[96:99], v14, s[28:31], s7 offen offset:1024 sc1
    buffer_load_dwordx4 v[100:103], v14, s[28:31], s7 offen offset:2048 sc1
    s_add_u32 s49, s49, 1
g2_check:
    s_waitcnt vmcnt(0)
    v_xor_b32 v24, s26, v71
    v_xor_b32 v25, s26, v75
    v_xor_b32 v26, s26, v79
    v_xor_b32 v27, s26, v83
    v_xor_b32 v28, s26, v87
    v_xor_b32 v29, s26, v91
    v_xor_b32 v30, s26, v95
    v_xor_b32 v31, s26, v99
    v_xor_b32 v2, s26, v103
    v_or3_b32 v24, v24, v25, v26
    v_or3_b32 v27, v27, v28, v29
    v_or3_b32 v30, v30, v31, v2
    v_or3_b32 v24, v24, v27, v30
    v_cmp_ne_u32 vcc, 0, v24
    s_nop 0
    s_and_b64 exec, vcc, vcc
    s_cbranch_scc0 g2_ready
    s_cmp_lt_u32 s49, 30000
    s_cbranch_scc1 g2_poll
g2_ready:
    s_mov_b64 exec, -1
    v_lshlrev_b32 v24, 16, v68
    v_and_b32 v25, s42, v68
    v_pk_add_f32 v[128:129], v[128:129], v[24:25]
    v_lshlrev_b32 v26, 16, v69
    v_and_b32 v27, s42, v69
    v_pk_add_f32 v[130:131], v[130:131], v[26:27]
    v_lshlrev_b32 v24, 16, v70
    v_and_b32 v25, s42, v70
    v_pk_add_f32 v[132:133], v[132:133], v[24:25]
    v_lshlrev_b32 v26, 16, v72
    v_and_b32 v27, s42, v72
    v_pk_add_f32 v[134:135], v[134:135], v[26:27]
    v_lshlrev_b32 v24, 16, v73
    v_and_b32 v25, s42, v73
    v_pk_add_f32 v[136:137], v[136:137], v[24:25]
    v_lshlrev_b32 v26, 16, v74
    v_and_b32 v27, s42, v74
    v_pk_add_f32 v[138:139], v[138:139], v[26:27]
    v_lshlrev_b32 v24, 16, v76
    v_and_b32 v25, s42, v76
    v_pk_add_f32 v[140:141], v[140:141], v[24:25]
    v_lshlrev_b32 v26, 16, v77
    v_and_b32 v27, s42, v77
    v_pk_add_f32 v[142:143], v[142:143], v[26:27]
    v_lshlrev_b32 v24, 16, v78
    v_and_b32 v25, s42, v78
    v_pk_add_f32 v[160:161], v[160:161], v[24:25]
    v_lshlrev_b32 v24, 16, v80
    v_and_b32 v25, s42, v80
    v_pk_add_f32 v[128:129], v[128:129], v[24:25]
    v_lshlrev_b32 v26, 16, v81
    v_and_b32 v27, s42, v81
    v_pk_add_f32 v[130:131], v[130:131], v[26:27]
    v_lshlrev_b32 v24, 16, v82
    v_and_b32 v25, s42, v82
    v_pk_add_f32 v[132:133], v[132:133], v[24:25]
    v_lshlrev_b32 v26, 16, v84
    v_and_b32 v27, s42, v84
    v_pk_add_f32 v[134:135], v[134:135], v[26:27]
    v_lshlrev_b32 v24, 16, v85
    v_and_b32 v25, s42, v85
    v_pk_add_f32 v[136:137], v[136:137], v[24:25]
    v_lshlrev_b32 v26, 16, v86
    v_and_b32 v27, s42, v86
    v_pk_add_f32 v[138:139], v[138:139], v[26:27]
    v_lshlrev_b32 v24, 16, v88
    v_and_b32 v25, s42, v88
    v_pk_add_f32 v[140:141], v[140:141], v[24:25]
    v_lshlrev_b32 v26, 16, v89
    v_and_b32 v27, s42, v89
    v_pk_add_f32 v[142:143], v[142:143], v[26:27]
    v_lshlrev_b32 v24, 16, v90
    v_and_b32 v25, s42, v90
    v_pk_add_f32 v[160:161], v[160:161], v[24:25]
    v_lshlrev_b32 v24, 16, v92
    v_and_b32 v25, s42, v92
    v_pk_add_f32 v[128:129], v[128:129], v[24:25]
    v_lshlrev_b32 v26, 16, v93
    v_and_b32 v27, s42, v93
    v_pk_add_f32 v[130:131], v[130:131], v[26:27]
    v_lshlrev_b32 v24, 16, v94
    v_and_b32 v25, s42, v94
    v_pk_add_f32 v[132:133], v[132:133], v[24:25]
    v_lshlrev_b32 v26, 16, v96
    v_and_b32 v27, s42, v96
    v_pk_add_f32 v[134:135], v[134:135], v[26:27]
    v_lshlrev_b32 v24, 16, v97
    v_and_b32 v25, s42, v97
    v_pk_add_f32 v[136:137], v[136:137], v[24:25]
    v_lshlrev_b32 v26, 16, v98
    v_and_b32 v27, s42, v98
    v_pk_add_f32 v[138:139], v[138:139], v[26:27]
    v_lshlrev_b32 v24, 16, v100
    v_and_b32 v25, s42, v100
    v_pk_add_f32 v[140:141], v[140:141], v[24:25]
    v_lshlrev_b32 v26, 16, v101
    v_and_b32 v27, s42, v101
    v_pk_add_f32 v[142:143], v[142:143], v[26:27]
    v_lshlrev_b32 v24, 16, v102
    v_and_b32 v25, s42, v102
    v_pk_add_f32 v[160:161], v[160:161], v[24:25]
    v_pk_fma_f32 v[128:129], v[128:129], v[210:211], v[32:33]
    v_cvt_pk_bf16_f32 v68, v128, v129
    v_pk_fma_f32 v[130:131], v[130:131], v[212:213], v[34:35]
    v_cvt_pk_bf16_f32 v69, v130, v131
    buffer_store_dwordx2 v[68:69], v22, s[16:19], s52 offen offset:0
    v_pk_fma_f32 v[132:133], v[132:133], v[214:215], v[36:37]
    v_cvt_pk_bf16_f32 v70, v132, v133
    v_pk_fma_f32 v[134:135], v[134:135], v[216:217], v[38:39]
    v_cvt_pk_bf16_f32 v71, v134, v135
    buffer_store_dwordx2 v[70:71], v22, s[16:19], s52 offen offset:32
    v_pk_fma_f32 v[136:137], v[136:137], v[218:219], v[40:41]
    v_cvt_pk_bf16_f32 v72, v136, v137
    v_pk_fma_f32 v[138:139], v[138:139], v[220:221], v[42:43]
    v_cvt_pk_bf16_f32 v73, v138, v139
    buffer_store_dwordx2 v[72:73], v22, s[16:19], s52 offen offset:64
    v_pk_fma_f32 v[140:141], v[140:141], v[222:223], v[44:45]
    v_cvt_pk_bf16_f32 v74, v140, v141
    v_pk_fma_f32 v[142:143], v[142:143], v[224:225], v[46:47]
    v_cvt_pk_bf16_f32 v75, v142, v143
    buffer_store_dwordx2 v[74:75], v22, s[16:19], s52 offen offset:96
    v_pk_fma_f32 v[160:161], v[160:161], v[226:227], v[48:49]
    v_cvt_pk_bf16_f32 v76, v160, v161
    buffer_store_dword v76, v22, s[16:19], s53 offen
t_end:
f_done:
    s_endpgm
.section .rodata,"a"
.p2align 6
.amdhsa_kernel f_kernel
  .amdhsa_next_free_vgpr 256
  .amdhsa_next_free_sgpr 102
  .amdhsa_accum_offset 256
  .amdhsa_group_segment_fixed_size 0
  .amdhsa_kernarg_size 104
  .amdhsa_user_sgpr_count 2
  .amdhsa_user_sgpr_kernarg_segment_ptr 1
  .amdhsa_system_sgpr_workgroup_id_x 1
.end_amdhsa_kernel
```

```asm
; @launch kernel=f_kernel grid=(256,1,1) block=(512,1,1) lds=163840
.amdgcn_target "amdgcn-amd-amdhsa--gfx950"
.text
.globl f_kernel
.p2align 8
.type f_kernel,@function
f_kernel:
    s_cmp_ge_u32 s2, 256
    s_cbranch_scc1 f_done
    s_load_dwordx2 s[16:17], s[0:1], 64
    s_load_dwordx2 s[20:21], s[0:1], 72
    s_load_dwordx2 s[28:29], s[0:1], 96
    s_load_dwordx2 s[4:5], s[0:1], 0
    s_load_dwordx2 s[8:9], s[0:1], 8
    s_load_dwordx2 s[12:13], s[0:1], 16
    s_load_dwordx2 s[24:25], s[0:1], 88
    s_load_dwordx2 s[32:33], s[0:1], 32
    s_mov_b32 s18, 0x480
    s_mov_b32 s19, 0x20000
    s_mov_b32 s22, 0x3cc000
    s_mov_b32 s23, 0x20000
    s_mov_b32 s30, 0x3000000
    s_mov_b32 s31, 0x20000
    s_mov_b32 s6, 0x240000
    s_mov_b32 s7, 0x20000
    s_mov_b32 s10, 0x121000
    s_mov_b32 s11, 0x20000
    s_mov_b32 s14, 0x121000
    s_mov_b32 s15, 0x20000
    s_mov_b32 s26, 0x100
    s_mov_b32 s27, 0x20000
    s_mov_b32 s34, 0x1200000
    s_mov_b32 s35, 0x20000
    v_and_b32 v1, 63, v0
    v_lshrrev_b32 v2, 6, v0
    s_nop 0
    v_readfirstlane_b32 s3, v2
    v_and_b32 v5, 15, v1
    v_lshrrev_b32 v6, 4, v1
    s_and_b32 s36, s2, 7
    s_lshr_b32 s37, s2, 3
    s_lshr_b32 s38, s37, 3
    s_sub_u32 s38, 3, s38
    s_lshl_b32 s38, s38, 3
    s_add_u32 s38, s38, s36
    s_lshl_b32 s38, s38, 3
    s_and_b32 s39, s37, 7
    s_add_u32 s38, s38, s39
    s_and_b32 s39, s3, 3
    s_lshr_b32 s40, s3, 2
    s_sub_u32 s41, s2, 64
    s_mul_i32 s43, s41, 171
    s_lshr_b32 s43, s43, 9
    s_mul_i32 s44, s43, 3
    s_sub_u32 s44, s41, s44
    v_lshrrev_b32 v2, 3, v0
    v_and_b32 v3, 7, v0
    v_mul_u32_u24 v4, 6912, v2
    v_lshl_add_u32 v3, v3, 4, v4
    v_lshlrev_b32 v2, 1, v2
    s_mul_i32 s45, s44, 384
    s_mul_i32 s46, s44, 1327104
    s_lshl_b32 s47, s43, 7
    s_add_u32 s46, s46, s47
    s_cmp_lt_u32 s41, 54
    s_cselect_b32 s48, 1, 2
    s_mul_i32 s48, s48, 4608
    s_mul_i32 s48, s48, s44
    s_lshl_b32 s47, s43, 8
    s_add_u32 s48, s48, s47
    s_cmp_lt_u32 s41, 54
    s_movk_i32 s47, 19968
    s_cselect_b32 s47, 0, s47
    s_add_u32 s48, s48, s47
    s_add_u32 s48, s48, 131072
    v_lshlrev_b32 v125, 2, v1
    v_lshlrev_b32 v109, 4, v1
    v_mov_b32 v68, -1
    v_mov_b32 v69, -1
    v_mov_b32 v70, -1
    v_mov_b32 v71, -1
    v_mov_b32 v44, 0
    v_mov_b32 v45, 0
    v_mov_b32 v46, 0
    s_bfe_u32 s49, s2, 0x10001
    s_lshl_b32 s49, s49, 3
    s_bfe_u32 s50, s2, 0x30003
    s_add_u32 s49, s49, s50
    s_bfe_u32 s50, s2, 0x10002
    s_lshl_b32 s50, s50, 2
    s_lshr_b32 s51, s2, 6
    s_add_u32 s50, s50, s51
    s_lshl_b32 s50, s50, 1
    s_and_b32 s51, s2, 1
    s_add_u32 s50, s50, s51
    s_lshl_b32 s56, s49, 4
    s_add_u32 s56, s56, s50
    s_lshl_b32 s49, s49, 2
    s_add_u32 s49, s49, s39
    s_lshl_b32 s49, s49, 4
    s_add_u32 s49, s49, s50
    s_lshl_b32 s49, s49, 1
    s_add_u32 s49, s49, s40
    s_mul_i32 s49, s49, 1152
    s_lshl_b32 s50, s39, 4
    v_add_u32 v7, s50, v5
    s_mul_i32 s55, s3, 1184
    s_sub_u32 s51, s2, 254
    s_cmp_lt_u32 s51, 2
    s_cselect_b32 s50, s3, 0
    s_cmp_eq_u32 s50, 6
    s_waitcnt lgkmcnt(0)
    s_cbranch_scc0 f_nolead
    s_mul_i32 s50, s51, 12288
    s_add_u32 s50, s50, 131072
    buffer_store_dwordx4 v[68:71], v109, s[28:31], s50 offen offset:0 sc1
    buffer_store_dwordx4 v[68:71], v109, s[28:31], s50 offen offset:1024 sc1
    buffer_store_dwordx4 v[68:71], v109, s[28:31], s50 offen offset:2048 sc1
    buffer_store_dwordx4 v[68:71], v109, s[28:31], s50 offen offset:3072 sc1
    s_add_u32 s50, s50, 4096
    buffer_store_dwordx4 v[68:71], v109, s[28:31], s50 offen offset:0 sc1
    buffer_store_dwordx4 v[68:71], v109, s[28:31], s50 offen offset:1024 sc1
    buffer_store_dwordx4 v[68:71], v109, s[28:31], s50 offen offset:2048 sc1
    buffer_store_dwordx4 v[68:71], v109, s[28:31], s50 offen offset:3072 sc1
    s_add_u32 s50, s50, 4096
    buffer_store_dwordx4 v[68:71], v109, s[28:31], s50 offen offset:0 sc1
    buffer_store_dwordx4 v[68:71], v109, s[28:31], s50 offen offset:1024 sc1
    buffer_store_dwordx4 v[68:71], v109, s[28:31], s50 offen offset:2048 sc1
    buffer_store_dwordx4 v[68:71], v109, s[28:31], s50 offen offset:3072 sc1
    s_lshl_b32 s50, s51, 7
    s_memrealtime s[46:47]
    s_waitcnt vmcnt(0) lgkmcnt(0)
    s_or_b32 s46, s46, 1
    v_mov_b32 v4, s46
    s_mov_b64 exec, 1
    buffer_store_dword v4, off, s[24:27], s50 sc1
    s_mov_b64 exec, -1
f_nolead:
    s_cmp_eq_u32 s3, 7
    s_cbranch_scc0 f_noslot
    s_sub_u32 s50, s2, 118
    s_cmp_lt_u32 s50, 136
    s_cbranch_scc0 f_noslot
    s_mul_i32 s50, s2, 20480
    s_add_u32 s50, s50, 1777664
    buffer_store_dwordx4 v[68:71], v109, s[28:31], s50 offen offset:0 sc1
    buffer_store_dwordx4 v[68:71], v109, s[28:31], s50 offen offset:1024 sc1
    buffer_store_dwordx4 v[68:71], v109, s[28:31], s50 offen offset:2048 sc1
    buffer_store_dwordx4 v[68:71], v109, s[28:31], s50 offen offset:3072 sc1
    s_add_u32 s50, s50, 4096
    buffer_store_dwordx4 v[68:71], v109, s[28:31], s50 offen offset:0 sc1
    buffer_store_dwordx4 v[68:71], v109, s[28:31], s50 offen offset:1024 sc1
    buffer_store_dwordx4 v[68:71], v109, s[28:31], s50 offen offset:2048 sc1
    buffer_store_dwordx4 v[68:71], v109, s[28:31], s50 offen offset:3072 sc1
    s_add_u32 s50, s50, 4096
    buffer_store_dwordx4 v[68:71], v109, s[28:31], s50 offen offset:0 sc1
    buffer_store_dwordx4 v[68:71], v109, s[28:31], s50 offen offset:1024 sc1
    buffer_store_dwordx4 v[68:71], v109, s[28:31], s50 offen offset:2048 sc1
    buffer_store_dwordx4 v[68:71], v109, s[28:31], s50 offen offset:3072 sc1
    s_add_u32 s50, s50, 4096
    buffer_store_dwordx4 v[68:71], v109, s[28:31], s50 offen offset:0 sc1
    buffer_store_dwordx4 v[68:71], v109, s[28:31], s50 offen offset:1024 sc1
    buffer_store_dwordx4 v[68:71], v109, s[28:31], s50 offen offset:2048 sc1
    buffer_store_dwordx4 v[68:71], v109, s[28:31], s50 offen offset:3072 sc1
    s_add_u32 s50, s50, 4096
    buffer_store_dwordx4 v[68:71], v109, s[28:31], s50 offen offset:0 sc1
    buffer_store_dwordx4 v[68:71], v109, s[28:31], s50 offen offset:1024 sc1
    buffer_store_dwordx4 v[68:71], v109, s[28:31], s50 offen offset:2048 sc1
    buffer_store_dwordx4 v[68:71], v109, s[28:31], s50 offen offset:3072 sc1
f_noslot:
    s_cmp_lt_u32 s41, 162
    s_cbranch_scc0 f_nogemv1
    buffer_load_short_d16_hi v44, v2, s[16:19], s45 offen offset:0
    buffer_load_short_d16_hi v45, v2, s[16:19], s45 offen offset:128
    buffer_load_short_d16_hi v46, v2, s[16:19], s45 offen offset:256
    buffer_load_dwordx4 v[48:51], v3, s[20:23], s46 offen
    s_add_u32 s46, s46, 442368
    buffer_load_dwordx4 v[52:55], v3, s[20:23], s46 offen
    s_add_u32 s46, s46, 442368
    buffer_load_dwordx4 v[56:59], v3, s[20:23], s46 offen
    s_branch f_issue2
f_nogemv1:
    s_cmp_lt_u32 s2, 64
    s_cbranch_scc0 f_issue2
    s_lshl_b32 s50, s37, 2
    s_add_u32 s50, s50, s39
    s_lshl_b32 s50, s50, 3
    s_add_u32 s50, s50, s36
    s_mul_i32 s50, s50, 4624
    v_add_u32 v2, s50, v109
    v_add_u32 v3, 4096, v2
    s_mul_i32 s50, s3, 5120
    s_add_u32 m0, s50, 19200
    s_cmp_eq_u32 s40, 0
    s_cbranch_scc1 f_wt_re
    s_mov_b32 s8, s12
    s_mov_b32 s9, s13
f_wt_re:
    buffer_load_dwordx4 v2, s[8:11], 0 offen offset:0 lds
    buffer_load_dwordx4 v2, s[8:11], 0 offen offset:1024 lds
    buffer_load_dwordx4 v2, s[8:11], 0 offen offset:2048 lds
    buffer_load_dwordx4 v2, s[8:11], 0 offen offset:3072 lds
    s_add_u32 m0, m0, 4096
    s_mov_b32 exec_hi, 1
    buffer_load_dwordx4 v3, s[8:11], 0 offen lds
    s_mov_b64 exec, -1
f_issue2:
    s_add_u32 m0, s55, 9728
    s_nop 0
    buffer_load_dwordx4 v109, s[4:7], s49 offen lds
    s_mov_b64 exec, 0xff
    buffer_load_dwordx4 v109, s[4:7], s49 offen offset:1024 lds
    s_mov_b64 exec, -1
    v_cvt_f32_u32 v84, v7
    v_cvt_f32_u32 v85, v6
    v_mul_f32 v86, v85, v84
    v_mul_f32 v86, 0x3d800000, v86
    v_fmamk_f32 v72, v84, 0x00000000, v86
    v_cos_f32 v73, v72
    v_sin_f32 v74, v72
    v_fmamk_f32 v75, v84, 0x3c800000, v86
    v_cos_f32 v76, v75
    v_sin_f32 v77, v75
    v_cvt_pk_bf16_f32 v128, v73, v74
    v_cvt_pk_bf16_f32 v144, -v74, v73
    v_fmamk_f32 v72, v84, 0x3d000000, v86
    v_cos_f32 v73, v72
    v_sin_f32 v74, v72
    v_cvt_pk_bf16_f32 v129, v76, v77
    v_cvt_pk_bf16_f32 v145, -v77, v76
    v_fmamk_f32 v75, v84, 0x3d400000, v86
    v_cos_f32 v76, v75
    v_sin_f32 v77, v75
    v_cvt_pk_bf16_f32 v130, v73, v74
    v_cvt_pk_bf16_f32 v146, -v74, v73
    v_fmamk_f32 v72, v84, 0x3e800000, v86
    v_cos_f32 v73, v72
    v_sin_f32 v74, v72
    v_cvt_pk_bf16_f32 v131, v76, v77
    v_cvt_pk_bf16_f32 v147, -v77, v76
    v_fmamk_f32 v75, v84, 0x3e880000, v86
    v_cos_f32 v76, v75
    v_sin_f32 v77, v75
    v_cvt_pk_bf16_f32 v132, v73, v74
    v_cvt_pk_bf16_f32 v148, -v74, v73
    v_fmamk_f32 v72, v84, 0x3e900000, v86
    v_cos_f32 v73, v72
    v_sin_f32 v74, v72
    v_cvt_pk_bf16_f32 v133, v76, v77
    v_cvt_pk_bf16_f32 v149, -v77, v76
    v_fmamk_f32 v75, v84, 0x3e980000, v86
    v_cos_f32 v76, v75
    v_sin_f32 v77, v75
    v_cvt_pk_bf16_f32 v134, v73, v74
    v_cvt_pk_bf16_f32 v150, -v74, v73
    v_fmamk_f32 v72, v84, 0x3f000000, v86
    v_cos_f32 v73, v72
    v_sin_f32 v74, v72
    v_cvt_pk_bf16_f32 v135, v76, v77
    v_cvt_pk_bf16_f32 v151, -v77, v76
    v_fmamk_f32 v75, v84, 0x3f040000, v86
    v_cos_f32 v76, v75
    v_sin_f32 v77, v75
    v_cvt_pk_bf16_f32 v136, v73, v74
    v_cvt_pk_bf16_f32 v152, -v74, v73
    v_fmamk_f32 v72, v84, 0x3f080000, v86
    v_cos_f32 v73, v72
    v_sin_f32 v74, v72
    v_cvt_pk_bf16_f32 v137, v76, v77
    v_cvt_pk_bf16_f32 v153, -v77, v76
    v_fmamk_f32 v75, v84, 0x3f0c0000, v86
    v_cos_f32 v76, v75
    v_sin_f32 v77, v75
    v_cvt_pk_bf16_f32 v138, v73, v74
    v_cvt_pk_bf16_f32 v154, -v74, v73
    v_fmamk_f32 v72, v84, 0x3f400000, v86
    v_cos_f32 v73, v72
    v_sin_f32 v74, v72
    v_cvt_pk_bf16_f32 v139, v76, v77
    v_cvt_pk_bf16_f32 v155, -v77, v76
    v_fmamk_f32 v75, v84, 0x3f440000, v86
    v_cos_f32 v76, v75
    v_sin_f32 v77, v75
    v_cvt_pk_bf16_f32 v140, v73, v74
    v_cvt_pk_bf16_f32 v156, -v74, v73
    v_fmamk_f32 v72, v84, 0x3f480000, v86
    v_cos_f32 v73, v72
    v_sin_f32 v74, v72
    v_cvt_pk_bf16_f32 v141, v76, v77
    v_cvt_pk_bf16_f32 v157, -v77, v76
    v_fmamk_f32 v75, v84, 0x3f4c0000, v86
    v_cos_f32 v76, v75
    v_sin_f32 v77, v75
    v_cvt_pk_bf16_f32 v142, v73, v74
    v_cvt_pk_bf16_f32 v158, -v74, v73
    v_cvt_pk_bf16_f32 v143, v76, v77
    v_cvt_pk_bf16_f32 v159, -v77, v76
    v_mul_u32_u24 v118, 1152, v6
    v_lshl_add_u32 v118, v7, 1, v118
    s_lshl_b32 s52, s38, 1
    s_add_u32 s52, s52, s40
    s_mul_i32 s52, s52, 4608
    s_lshl_b32 s49, s38, 3
    s_add_u32 s49, s49, s3
    s_mul_i32 s49, s49, 1152
    v_mov_b32 v8, 0
    v_mov_b32 v9, 0
    v_mov_b32 v10, 0
    v_mov_b32 v11, 0
    v_mov_b32 v12, 0
    v_mov_b32 v13, 0
    v_mov_b32 v14, 0
    v_mov_b32 v15, 0
    v_mov_b32 v16, 0
    v_mov_b32 v18, 0
    v_mov_b32 v19, 0
    v_mov_b32 v20, 0
    v_mov_b32 v21, 0
    v_mov_b32 v22, 0
    v_mov_b32 v23, 0
    v_mov_b32 v24, 0
    v_mov_b32 v25, 0
    v_mov_b32 v26, 0
    v_lshlrev_b32 v2, 4, v0
    s_add_u32 s53, s38, 64
    s_lshl_b32 s50, s53, 13
    s_add_u32 s50, s50, 7340032
    buffer_store_dwordx4 v[68:71], v2, s[28:31], s50 offen sc1
    s_lshl_b32 s54, s36, 2
    s_add_u32 s54, s54, s37
    s_cmp_lt_u32 s2, 32
    s_cselect_b32 s54, s54, -1
    s_cmp_eq_u32 s2, 32
    s_cselect_b32 s54, 32, s54
    s_cmp_eq_u32 s40, 0
    s_cselect_b32 s42, s53, s54
    s_cmp_lt_u32 s2, 33
    s_cbranch_scc0 f_nozp2
    s_lshl_b32 s50, s54, 13
    s_add_u32 s50, s50, 7340032
    buffer_store_dwordx4 v[68:71], v2, s[28:31], s50 offen sc1
f_nozp2:
    s_cmp_eq_u32 s3, 6
    s_cbranch_scc0 f_nofl
    s_lshl_b32 s50, s2, 10
    s_add_u32 s50, s50, 262144
    buffer_store_dwordx4 v[18:21], v109, s[28:31], s50 offen sc1
f_nofl:
    v_cvt_f32_u32 v82, v1
    v_mul_f32 v73, 0x3ae38e39, v82
    v_mul_f32 v74, 0x3b638e39, v82
    v_mul_f32 v75, 0x3baaaaab, v82
    v_mul_f32 v76, 0x3be38e39, v82
    v_cos_f32 v208, v73
    v_sin_f32 v212, v73
    v_cos_f32 v209, v74
    v_sin_f32 v213, v74
    v_cos_f32 v210, v75
    v_sin_f32 v214, v75
    v_cos_f32 v211, v76
    v_sin_f32 v215, v76
    s_lshl_b32 s50, s40, 2
    s_add_u32 s50, s50, s39
    s_mul_i32 s50, s50, 272
    s_add_u32 s50, s50, 9728
    v_add_u32 v104, s50, v125
    v_mul_u32_u24 v2, 272, v5
    v_lshl_add_u32 v2, v6, 4, v2
    s_mul_i32 s50, s40, 8704
    s_add_u32 s51, s50, 9728
    v_add_u32 v105, s51, v2
    s_add_u32 s51, s50, 46336
    v_add_u32 v111, s51, v2
    v_mul_u32_u24 v2, 1088, v6
    v_lshl_add_u32 v2, v7, 2, v2
    v_add_u32 v110, s51, v2
    v_lshrrev_b32 v2, 1, v6
    v_lshl_add_u32 v2, v2, 6, v7
    v_and_b32 v3, 1, v6
    v_lshlrev_b32 v3, 4, v3
    v_lshl_add_u32 v2, v2, 5, v3
    s_lshl_b32 s50, s40, 13
    v_add_u32 v106, s50, v2
    v_add_u32 v107, 4096, v2
    v_cmp_lt_u32 vcc, 1, v6
    s_cmp_eq_u32 s40, 1
    s_cselect_b64 s[50:51], vcc, 0
    v_mov_b32 v3, 0x7f000000
    v_cndmask_b32 v106, v106, v3, s[50:51]
    s_mul_i32 s56, s56, 10240
    s_add_u32 s56, s56, 4194304
    v_lshrrev_b32 v2, 1, v5
    v_lshl_add_u32 v2, v6, 4, v2
    v_mul_u32_u24 v2, 10240, v2
    v_and_b32 v3, 1, v5
    v_lshl_add_u32 v108, v3, 4, v2
    v_lshlrev_b32 v2, 6, v7
    v_lshl_add_u32 v112, v6, 4, v2
    v_lshrrev_b32 v2, 1, v1
    s_and_b32 s50, s3, 1
    s_lshl_b32 s50, s50, 5
    v_add_u32 v2, s50, v2
    v_and_b32 v3, 1, v1
    s_lshr_b32 s51, s3, 1
    v_mul_u32_u24 v4, 5760, v3
    v_lshl_add_u32 v4, v2, 3, v4
    s_mul_i32 s50, s51, 576
    s_add_u32 s50, s50, 17920
    v_add_u32 v115, s50, v4
    v_lshlrev_b32 v3, 4, v3
    v_lshl_add_u32 v114, v2, 13, v3
    v_add_u32 v114, 2097152, v114
    v_sub_u32 v4, 64, v2
    v_min_u32 v4, v4, v2
    s_cmp_eq_u32 s51, 0
    s_cselect_b64 vcc, -1, 0
    v_cndmask_b32 v2, v2, v4, vcc
    s_lshl_b32 s51, s51, 19
    v_lshl_add_u32 v113, v2, 13, v3
    v_add_u32 v113, s51, v113
    v_lshrrev_b32 v2, 2, v5
    v_lshl_add_u32 v2, v6, 2, v2
    v_lshlrev_b32 v2, 3, v2
    s_mul_i32 s50, s40, 5760
    s_add_u32 s50, s50, 17920
    v_add_u32 v117, s50, v2
    v_and_b32 v2, 3, v1
    v_add_u32 v2, 1, v2
    v_mul_u32_u24 v2, 576, v2
    v_add_u32 v116, v2, v117
    s_lshl_b32 s50, s40, 7
    s_add_u32 s50, s50, 29440
    v_lshl_add_u32 v119, v6, 5, s50
    s_lshl_b32 s50, s39, 3
    v_add_u32 v120, s50, v119
    s_mov_b32 s50, 391680
    v_lshl_add_u32 v2, v6, 6, v7
    s_lshl_b32 s51, s40, 3
    s_add_u32 s51, s51, 17920
    v_lshl_add_u32 v121, v2, 4, s51
    v_mul_u32_u24 v3, 683, v0
    v_lshrrev_b32 v3, 16, v3
    v_mul_lo_u32 v3, v3, s50
    v_lshl_add_u32 v122, v0, 4, v3
    v_add_u32 v2, 256, v0
    v_mul_u32_u24 v3, 683, v2
    v_lshrrev_b32 v3, 16, v3
    v_mul_lo_u32 v3, v3, s50
    v_lshl_add_u32 v118, v2, 4, v3
    v_add_u32 v123, 1966592, v109
    v_lshlrev_b32 v124, 2, v7
    v_mul_u32_u24 v2, 1184, v6
    v_lshl_add_u32 v2, v7, 1, v2
    s_mul_i32 s50, s40, 4736
    s_add_u32 s50, s50, 0
    v_add_u32 v127, s50, v2
    s_and_b32 s50, s2, 1
    s_mul_i32 s50, s50, 1152
    v_cmp_lt_u32 vcc, 431, v0
    v_mov_b32 v3, s50
    s_nop 0
    v_cndmask_b32 v3, 0, v3, vcc
    v_lshl_add_u32 v126, v0, 4, v3
    s_mul_i32 s57, s36, 4617
    s_lshr_b32 s57, s57, 10
    s_lshl_b32 s57, s57, 8
    v_mul_u32_u24 v2, 26, v1
    v_lshrrev_b32 v2, 8, v2
    v_mul_u32_u24 v2, 7936, v2
    v_lshl_add_u32 v17, v1, 7, v2
    s_cmp_lt_u32 s38, 64
    s_cbranch_scc0 f_noh2p
    s_mul_i32 s50, s38, 1536
    s_add_u32 s50, s50, 13631488
    buffer_store_dwordx4 v[68:71], v122, s[28:31], s50 offen sc1
    s_cmp_eq_u32 s3, 1
    s_cbranch_scc0 f_noh2p
    buffer_store_dwordx4 v[68:71], v123, s[28:31], s50 offen sc1
f_noh2p:
    s_cmp_lt_u32 s41, 162
    s_cbranch_scc0 f_other
    s_mov_b32 s47, 0xffff0000
    s_waitcnt vmcnt(6)
    v_mul_f32 v72, 0xbfb8aa3b, v44
    v_mul_f32 v73, 0xbfb8aa3b, v45
    v_mul_f32 v74, 0xbfb8aa3b, v46
    v_exp_f32 v72, v72
    v_exp_f32 v73, v73
    v_exp_f32 v74, v74
    v_add_f32 v72, 1.0, v72
    v_add_f32 v73, 1.0, v73
    v_add_f32 v74, 1.0, v74
    v_rcp_f32 v72, v72
    v_rcp_f32 v73, v73
    v_rcp_f32 v74, v74
    v_mul_f32 v44, v44, v72
    v_mul_f32 v45, v45, v73
    v_mul_f32 v46, v46, v74
    v_cvt_pk_bf16_f32 v72, v44, v45
    v_lshlrev_b32 v44, 16, v72
    v_and_b32 v45, s47, v72
    v_cvt_pk_bf16_f32 v46, v46, v46
    v_lshlrev_b32 v46, 16, v46
    s_waitcnt vmcnt(5)
    v_lshlrev_b32 v72, 16, v48
    v_and_b32 v73, s47, v48
    v_mul_f32 v60, v44, v72
    v_mul_f32 v61, v44, v73
    v_lshlrev_b32 v74, 16, v49
    v_and_b32 v75, s47, v49
    v_mul_f32 v62, v44, v74
    v_mul_f32 v63, v44, v75
    v_lshlrev_b32 v72, 16, v50
    v_and_b32 v73, s47, v50
    v_mul_f32 v64, v44, v72
    v_mul_f32 v65, v44, v73
    v_lshlrev_b32 v74, 16, v51
    v_and_b32 v75, s47, v51
    v_mul_f32 v66, v44, v74
    v_mul_f32 v67, v44, v75
    s_waitcnt vmcnt(4)
    v_lshlrev_b32 v72, 16, v52
    v_and_b32 v73, s47, v52
    v_fmac_f32 v60, v45, v72
    v_fmac_f32 v61, v45, v73
    v_lshlrev_b32 v74, 16, v53
    v_and_b32 v75, s47, v53
    v_fmac_f32 v62, v45, v74
    v_fmac_f32 v63, v45, v75
    v_lshlrev_b32 v72, 16, v54
    v_and_b32 v73, s47, v54
    v_fmac_f32 v64, v45, v72
    v_fmac_f32 v65, v45, v73
    v_lshlrev_b32 v74, 16, v55
    v_and_b32 v75, s47, v55
    v_fmac_f32 v66, v45, v74
    v_fmac_f32 v67, v45, v75
    s_waitcnt vmcnt(3)
    v_lshlrev_b32 v72, 16, v56
    v_and_b32 v73, s47, v56
    v_fmac_f32 v60, v46, v72
    v_fmac_f32 v61, v46, v73
    v_lshlrev_b32 v74, 16, v57
    v_and_b32 v75, s47, v57
    v_fmac_f32 v62, v46, v74
    v_fmac_f32 v63, v46, v75
    v_lshlrev_b32 v72, 16, v58
    v_and_b32 v73, s47, v58
    v_fmac_f32 v64, v46, v72
    v_fmac_f32 v65, v46, v73
    v_lshlrev_b32 v74, 16, v59
    v_and_b32 v75, s47, v59
    v_fmac_f32 v66, v46, v74
    v_fmac_f32 v67, v46, v75
    v_permlane16_swap_b32 v60, v61
    v_permlane16_swap_b32 v62, v63
    v_permlane16_swap_b32 v64, v65
    v_permlane16_swap_b32 v66, v67
    v_add_f32 v60, v60, v61
    v_add_f32 v62, v62, v63
    v_add_f32 v64, v64, v65
    v_add_f32 v66, v66, v67
    v_permlane32_swap_b32 v60, v62
    s_nop 0
    v_permlane32_swap_b32 v64, v66
    v_add_f32 v60, v60, v62
    v_add_f32 v64, v64, v66
    s_nop 0
    v_add_f32_dpp v60, v60, v60 row_ror:8 row_mask:0xf bank_mask:0xf
    v_add_f32_dpp v64, v64, v64 row_ror:8 row_mask:0xf bank_mask:0xf
    v_cmp_lt_u32 vcc, 7, v5
    s_nop 1
    v_cndmask_b32 v60, v60, v64, vcc
    v_and_b32 v2, 7, v5
    v_lshrrev_b32 v3, 3, v5
    v_lshl_add_u32 v2, v2, 1, v3
    v_lshl_add_u32 v2, v2, 2, v6
    s_lshl_b32 s50, s3, 8
    s_add_u32 s50, s50, 4608
    v_lshl_add_u32 v2, v2, 2, s50
    ds_write_b32 v2, v60
    s_cmp_eq_u32 s3, 7
    s_cbranch_scc0 f_nochka
    s_mov_b64 exec, 3
    v_lshlrev_b32 v2, 7, v1
    s_mov_b32 s50, 0
f_an2a:
    buffer_load_dword v3, v2, s[24:27], 0 offen sc1
    s_add_u32 s50, s50, 1
    s_waitcnt vmcnt(0)
    v_cmp_eq_u32 vcc, 0, v3
    s_nop 1
    s_cbranch_vccz f_an2a_ok
    s_sleep 2
    s_cmp_lt_u32 s50, 30000
    s_cbranch_scc1 f_an2a
f_an2a_ok:
    s_mov_b64 exec, -1
    s_sub_u32 s50, s2, 118
    s_cmp_lt_u32 s50, 136
    s_cbranch_scc0 f_nochka
    s_lshl_b32 s50, s50, 6
    s_add_u32 s50, s50, 144896
    s_mov_b64 exec, 1
    buffer_store_dword v1, off, s[28:31], s50 sc1
    s_mov_b64 exec, -1
f_nochka:
    s_waitcnt lgkmcnt(0)
    s_barrier
    s_cmp_eq_u32 s3, 7
    s_cbranch_scc0 f_nogemv2
    ds_read2st64_b32 v[60:61], v125 offset0:18 offset1:19
    ds_read2st64_b32 v[62:63], v125 offset0:20 offset1:21
    ds_read2st64_b32 v[64:65], v125 offset0:22 offset1:23
    ds_read2st64_b32 v[66:67], v125 offset0:24 offset1:25
    s_waitcnt lgkmcnt(0)
    v_pk_add_f32 v[60:61], v[60:61], v[62:63]
    v_pk_add_f32 v[64:65], v[64:65], v[66:67]
    v_pk_add_f32 v[60:61], v[60:61], v[64:65]
    v_add_f32 v60, v60, v61
    buffer_store_dword v60, v125, s[28:31], s48 offen sc1
    s_branch f_nogemv2
f_other:
    s_cmp_lt_u32 s2, 64
    s_cbranch_scc1 f_wt1
    s_waitcnt vmcnt(0)
    s_cmp_eq_u32 s3, 7
    s_cbranch_scc0 f_nochkb
    s_mov_b64 exec, 3
    v_lshlrev_b32 v2, 7, v1
    s_mov_b32 s50, 0
f_an2b:
    buffer_load_dword v3, v2, s[24:27], 0 offen sc1
    s_add_u32 s50, s50, 1
    s_waitcnt vmcnt(0)
    v_cmp_eq_u32 vcc, 0, v3
    s_nop 1
    s_cbranch_vccz f_an2b_ok
    s_sleep 2
    s_cmp_lt_u32 s50, 30000
    s_cbranch_scc1 f_an2b
f_an2b_ok:
    s_mov_b64 exec, -1
    s_sub_u32 s50, s2, 118
    s_cmp_lt_u32 s50, 136
    s_cbranch_scc0 f_nochkb
    s_lshl_b32 s50, s50, 6
    s_add_u32 s50, s50, 144896
    s_mov_b64 exec, 1
    buffer_store_dword v1, off, s[28:31], s50 sc1
    s_mov_b64 exec, -1
f_nochkb:
    s_branch f_ln
f_wt1:
    s_waitcnt vmcnt(3)
    s_barrier
f_wt2:
    v_and_b32 v3, 7, v0
    v_lshrrev_b32 v4, 3, v0
    v_mul_u32_u24 v2, 578, v3
    v_lshl_add_u32 v2, v4, 1, v2
    v_add_u32 v2, 19200, v2
    v_lshlrev_b32 v3, 4, v3
    v_lshl_add_u32 v3, v4, 13, v3
    s_lshr_b32 s50, s36, 1
    s_lshl_b32 s50, s50, 1
    s_lshr_b32 s51, s37, 2
    s_add_u32 s50, s50, s51
    s_lshl_b32 s50, s50, 2
    s_and_b32 s51, s37, 3
    s_add_u32 s50, s50, s51
    s_lshl_b32 s50, s50, 1
    s_and_b32 s51, s36, 1
    s_add_u32 s50, s50, s51
    s_lshl_b32 s50, s50, 7
    s_add_u32 s50, s50, 1048576
    ds_read_u16 v28, v2 offset:0
    ds_read_u16 v32, v2 offset:20480
    ds_read_u16 v29, v2 offset:5120
    ds_read_u16 v33, v2 offset:25600
    ds_read_u16 v30, v2 offset:10240
    ds_read_u16 v34, v2 offset:30720
    ds_read_u16 v31, v2 offset:15360
    ds_read_u16 v35, v2 offset:35840
    s_waitcnt vmcnt(1)
    ds_read_u16 v36, v2 offset:128
    ds_read_u16 v40, v2 offset:20608
    ds_read_u16 v37, v2 offset:5248
    ds_read_u16 v41, v2 offset:25728
    ds_read_u16 v38, v2 offset:10368
    ds_read_u16 v42, v2 offset:30848
    ds_read_u16 v39, v2 offset:15488
    ds_read_u16 v43, v2 offset:35968
    s_waitcnt lgkmcnt(8)
    v_lshl_or_b32 v52, v32, 16, v28
    v_lshl_or_b32 v53, v33, 16, v29
    v_lshl_or_b32 v54, v34, 16, v30
    v_lshl_or_b32 v55, v35, 16, v31
    buffer_store_dwordx4 v[52:55], v3, s[28:31], s50 offen sc1
    s_add_u32 s50, s50, 524288
    ds_read_u16 v44, v2 offset:256
    ds_read_u16 v48, v2 offset:20736
    ds_read_u16 v45, v2 offset:5376
    ds_read_u16 v49, v2 offset:25856
    ds_read_u16 v46, v2 offset:10496
    ds_read_u16 v50, v2 offset:30976
    ds_read_u16 v47, v2 offset:15616
    ds_read_u16 v51, v2 offset:36096
    s_waitcnt lgkmcnt(8)
    v_lshl_or_b32 v56, v40, 16, v36
    v_lshl_or_b32 v57, v41, 16, v37
    v_lshl_or_b32 v58, v42, 16, v38
    v_lshl_or_b32 v59, v43, 16, v39
    buffer_store_dwordx4 v[56:59], v3, s[28:31], s50 offen sc1
    s_add_u32 s50, s50, 524288
    ds_read_u16 v28, v2 offset:384
    ds_read_u16 v32, v2 offset:20864
    ds_read_u16 v29, v2 offset:5504
    ds_read_u16 v33, v2 offset:25984
    ds_read_u16 v30, v2 offset:10624
    ds_read_u16 v34, v2 offset:31104
    ds_read_u16 v31, v2 offset:15744
    ds_read_u16 v35, v2 offset:36224
    s_waitcnt lgkmcnt(8)
    v_lshl_or_b32 v52, v48, 16, v44
    v_lshl_or_b32 v53, v49, 16, v45
    v_lshl_or_b32 v54, v50, 16, v46
    v_lshl_or_b32 v55, v51, 16, v47
    buffer_store_dwordx4 v[52:55], v3, s[28:31], s50 offen sc1
    s_add_u32 s50, s50, 524288
    ds_read_u16 v36, v2 offset:512
    ds_read_u16 v40, v2 offset:20992
    ds_read_u16 v37, v2 offset:5632
    ds_read_u16 v41, v2 offset:26112
    ds_read_u16 v38, v2 offset:10752
    ds_read_u16 v42, v2 offset:31232
    ds_read_u16 v39, v2 offset:15872
    ds_read_u16 v43, v2 offset:36352
    s_waitcnt lgkmcnt(8)
    v_lshl_or_b32 v56, v32, 16, v28
    v_lshl_or_b32 v57, v33, 16, v29
    v_lshl_or_b32 v58, v34, 16, v30
    v_lshl_or_b32 v59, v35, 16, v31
    buffer_store_dwordx4 v[56:59], v3, s[28:31], s50 offen sc1
    s_add_u32 s50, s50, 524288
    s_waitcnt lgkmcnt(0)
    v_lshl_or_b32 v52, v40, 16, v36
    v_lshl_or_b32 v53, v41, 16, v37
    v_lshl_or_b32 v54, v42, 16, v38
    v_lshl_or_b32 v55, v43, 16, v39
    v_cmp_gt_u32 vcc, 33, v4
    v_mov_b32 v4, 0x7f000000
    s_nop 0
    v_cndmask_b32 v3, v4, v3, vcc
    buffer_store_dwordx4 v[52:55], v3, s[28:31], s50 offen sc1
    s_branch f_ln
f_nogemv2:
    s_waitcnt vmcnt(1)
f_ln:
    v_lshlrev_b32 v2, 1, v1
    s_add_u32 s50, s55, 9728
    v_add_u32 v2, s50, v2
    ds_read_u16_d16_hi v8, v2 offset:0
    ds_read_u16_d16_hi v9, v2 offset:128
    ds_read_u16_d16_hi v10, v2 offset:256
    ds_read_u16_d16_hi v11, v2 offset:384
    ds_read_u16_d16_hi v12, v2 offset:512
    ds_read_u16_d16_hi v13, v2 offset:640
    ds_read_u16_d16_hi v14, v2 offset:768
    ds_read_u16_d16_hi v15, v2 offset:896
    ds_read_u16_d16_hi v16, v2 offset:1024
    s_waitcnt lgkmcnt(0)
    v_add_f32 v80, v8, v9
    v_add_f32 v80, v80, v10
    v_add_f32 v80, v80, v11
    v_add_f32 v80, v80, v12
    v_add_f32 v80, v80, v13
    v_add_f32 v80, v80, v14
    v_add_f32 v80, v80, v15
    v_add_f32 v80, v80, v16
    s_nop 1
    v_add_f32_dpp v80, v80, v80 quad_perm:[1,0,3,2] row_mask:0xf bank_mask:0xf
    s_nop 1
    v_add_f32_dpp v80, v80, v80 quad_perm:[2,3,0,1] row_mask:0xf bank_mask:0xf
    s_nop 1
    v_add_f32_dpp v80, v80, v80 row_half_mirror row_mask:0xf bank_mask:0xf
    s_nop 1
    v_add_f32_dpp v80, v80, v80 row_mirror row_mask:0xf bank_mask:0xf
    v_mov_b32 v72, v80
    s_nop 1
    v_permlane16_swap_b32 v80, v72
    v_add_f32 v80, v80, v72
    v_mov_b32 v72, v80
    s_nop 1
    v_permlane32_swap_b32 v80, v72
    v_add_f32 v80, v80, v72
    v_mul_f32 v80, 0x3ae38e39, v80
    v_sub_f32 v8, v8, v80
    v_sub_f32 v9, v9, v80
    v_sub_f32 v10, v10, v80
    v_sub_f32 v11, v11, v80
    v_sub_f32 v12, v12, v80
    v_sub_f32 v13, v13, v80
    v_sub_f32 v14, v14, v80
    v_sub_f32 v15, v15, v80
    v_sub_f32 v16, v16, v80
    v_mul_f32 v81, v8, v8
    v_fmac_f32 v81, v9, v9
    v_fmac_f32 v81, v10, v10
    v_fmac_f32 v81, v11, v11
    v_fmac_f32 v81, v12, v12
    v_fmac_f32 v81, v13, v13
    v_fmac_f32 v81, v14, v14
    v_fmac_f32 v81, v15, v15
    v_fmac_f32 v81, v16, v16
    s_nop 1
    v_add_f32_dpp v81, v81, v81 quad_perm:[1,0,3,2] row_mask:0xf bank_mask:0xf
    s_nop 1
    v_add_f32_dpp v81, v81, v81 quad_perm:[2,3,0,1] row_mask:0xf bank_mask:0xf
    s_nop 1
    v_add_f32_dpp v81, v81, v81 row_half_mirror row_mask:0xf bank_mask:0xf
    s_nop 1
    v_add_f32_dpp v81, v81, v81 row_mirror row_mask:0xf bank_mask:0xf
    v_mov_b32 v72, v81
    s_nop 1
    v_permlane16_swap_b32 v81, v72
    v_add_f32 v81, v81, v72
    v_mov_b32 v72, v81
    s_nop 1
    v_permlane32_swap_b32 v81, v72
    v_add_f32 v81, v81, v72
    v_mov_b32 v72, 0x3727c5ac
    v_fmamk_f32 v81, v81, 0x3ae38e39, v72
    v_rsq_f32 v81, v81
    s_nop 0
    v_mul_f32 v8, v8, v81
    v_mul_f32 v9, v9, v81
    v_mul_f32 v10, v10, v81
    v_mul_f32 v11, v11, v81
    v_mul_f32 v12, v12, v81
    v_mul_f32 v13, v13, v81
    v_mul_f32 v14, v14, v81
    v_mul_f32 v15, v15, v81
    v_mul_f32 v16, v16, v81
    v_cvt_f32_u32 v84, v7
    v_cvt_f32_u32 v85, v6
    v_mul_f32 v86, v85, v84
    v_mul_f32 v86, 0x3d800000, v86
    v_mul_f32 v86, 0x3d000000, v86
    v_fmamk_f32 v72, v84, 0x00000000, v86
    v_fmamk_f32 v73, v84, 0x3a000000, v86
    v_fmamk_f32 v74, v84, 0x3a800000, v86
    v_fmamk_f32 v75, v84, 0x3ac00000, v86
    v_cos_f32 v192, v72
    v_sin_f32 v200, v72
    v_cos_f32 v193, v73
    v_sin_f32 v201, v73
    v_cos_f32 v194, v74
    v_sin_f32 v202, v74
    v_cos_f32 v195, v75
    v_sin_f32 v203, v75
    v_fmamk_f32 v72, v84, 0x3c000000, v86
    v_fmamk_f32 v73, v84, 0x3c080000, v86
    v_fmamk_f32 v74, v84, 0x3c100000, v86
    v_fmamk_f32 v75, v84, 0x3c180000, v86
    v_cos_f32 v196, v72
    v_sin_f32 v204, v72
    v_cos_f32 v197, v73
    v_sin_f32 v205, v73
    v_cos_f32 v198, v74
    v_sin_f32 v206, v74
    v_cos_f32 v199, v75
    v_sin_f32 v207, v75
    v_add_u32 v84, 0, v5
    v_cvt_f32_u32 v84, v84
    v_mul_f32 v86, v85, v84
    v_mul_f32 v86, 0x3e000000, v86
    v_fmamk_f32 v72, v84, 0x00000000, v86
    v_fmamk_f32 v73, v84, 0x3d000000, v86
    v_fmamk_f32 v74, v84, 0x3d800000, v86
    v_fmamk_f32 v75, v84, 0x3dc00000, v86
    v_cos_f32 v76, v72
    v_sin_f32 v80, v72
    v_cos_f32 v77, v73
    v_sin_f32 v81, v73
    v_cos_f32 v78, v74
    v_sin_f32 v82, v74
    v_cos_f32 v79, v75
    v_sin_f32 v83, v75
    v_cvt_pk_bf16_f32 v160, v76, v77
    v_cvt_pk_bf16_f32 v161, v78, v79
    v_cvt_pk_bf16_f32 v178, v76, v77
    v_cvt_pk_bf16_f32 v179, v78, v79
    v_cvt_pk_bf16_f32 v162, v80, v81
    v_cvt_pk_bf16_f32 v163, v82, v83
    v_cvt_pk_bf16_f32 v176, -v80, -v81
    v_cvt_pk_bf16_f32 v177, -v82, -v83
    v_fmamk_f32 v72, v84, 0x3f000000, v86
    v_fmamk_f32 v73, v84, 0x3f080000, v86
    v_fmamk_f32 v74, v84, 0x3f100000, v86
    v_fmamk_f32 v75, v84, 0x3f180000, v86
    v_cos_f32 v76, v72
    v_sin_f32 v80, v72
    v_cos_f32 v77, v73
    v_sin_f32 v81, v73
    v_cos_f32 v78, v74
    v_sin_f32 v82, v74
    v_cos_f32 v79, v75
    v_sin_f32 v83, v75
    v_cvt_pk_bf16_f32 v164, v76, v77
    v_cvt_pk_bf16_f32 v165, v78, v79
    v_cvt_pk_bf16_f32 v182, v76, v77
    v_cvt_pk_bf16_f32 v183, v78, v79
    v_cvt_pk_bf16_f32 v166, v80, v81
    v_cvt_pk_bf16_f32 v167, v82, v83
    v_cvt_pk_bf16_f32 v180, -v80, -v81
    v_cvt_pk_bf16_f32 v181, -v82, -v83
    v_add_u32 v84, 16, v5
    v_cvt_f32_u32 v84, v84
    v_mul_f32 v86, v85, v84
    v_mul_f32 v86, 0x3e000000, v86
    v_fmamk_f32 v72, v84, 0x00000000, v86
    v_fmamk_f32 v73, v84, 0x3d000000, v86
    v_fmamk_f32 v74, v84, 0x3d800000, v86
    v_fmamk_f32 v75, v84, 0x3dc00000, v86
    v_cos_f32 v76, v72
    v_sin_f32 v80, v72
    v_cos_f32 v77, v73
    v_sin_f32 v81, v73
    v_cos_f32 v78, v74
    v_sin_f32 v82, v74
    v_cos_f32 v79, v75
    v_sin_f32 v83, v75
    v_cvt_pk_bf16_f32 v168, v76, v77
    v_cvt_pk_bf16_f32 v169, v78, v79
    v_cvt_pk_bf16_f32 v186, v76, v77
    v_cvt_pk_bf16_f32 v187, v78, v79
    v_cvt_pk_bf16_f32 v170, v80, v81
    v_cvt_pk_bf16_f32 v171, v82, v83
    v_cvt_pk_bf16_f32 v184, -v80, -v81
    v_cvt_pk_bf16_f32 v185, -v82, -v83
    v_fmamk_f32 v72, v84, 0x3f000000, v86
    v_fmamk_f32 v73, v84, 0x3f080000, v86
    v_fmamk_f32 v74, v84, 0x3f100000, v86
    v_fmamk_f32 v75, v84, 0x3f180000, v86
    v_cos_f32 v76, v72
    v_sin_f32 v80, v72
    v_cos_f32 v77, v73
    v_sin_f32 v81, v73
    v_cos_f32 v78, v74
    v_sin_f32 v82, v74
    v_cos_f32 v79, v75
    v_sin_f32 v83, v75
    v_cvt_pk_bf16_f32 v172, v76, v77
    v_cvt_pk_bf16_f32 v173, v78, v79
    v_cvt_pk_bf16_f32 v190, v76, v77
    v_cvt_pk_bf16_f32 v191, v78, v79
    v_cvt_pk_bf16_f32 v174, v80, v81
    v_cvt_pk_bf16_f32 v175, v82, v83
    v_cvt_pk_bf16_f32 v188, -v80, -v81
    v_cvt_pk_bf16_f32 v189, -v82, -v83
    s_cmp_lt_u32 s3, 3
    s_cbranch_scc1 f_stage
    v_cvt_f32_u32 v84, v7
    v_cvt_f32_u32 v85, v6
    v_mul_f32 v85, v85, v84
    v_mul_f32 v85, 0x3d800000, v85
    v_fmamk_f32 v72, v84, 0x00000000, v85
    v_fmamk_f32 v73, v84, 0x3c800000, v85
    v_fmamk_f32 v74, v84, 0x3d000000, v85
    v_fmamk_f32 v75, v84, 0x3d400000, v85
    v_cos_f32 v76, v72
    v_sin_f32 v80, v72
    v_cos_f32 v77, v73
    v_sin_f32 v81, v73
    v_cos_f32 v78, v74
    v_sin_f32 v82, v74
    v_cos_f32 v79, v75
    v_sin_f32 v83, v75
    v_cvt_pk_bf16_f32 v216, v76, v77
    v_cvt_pk_bf16_f32 v217, v78, v79
    v_cvt_pk_bf16_f32 v234, -v76, -v77
    v_cvt_pk_bf16_f32 v235, -v78, -v79
    v_cvt_pk_bf16_f32 v218, v80, v81
    v_cvt_pk_bf16_f32 v219, v82, v83
    v_cvt_pk_bf16_f32 v232, v80, v81
    v_cvt_pk_bf16_f32 v233, v82, v83
    v_fmamk_f32 v72, v84, 0x3e800000, v85
    v_fmamk_f32 v73, v84, 0x3e880000, v85
    v_fmamk_f32 v74, v84, 0x3e900000, v85
    v_fmamk_f32 v75, v84, 0x3e980000, v85
    v_cos_f32 v76, v72
    v_sin_f32 v80, v72
    v_cos_f32 v77, v73
    v_sin_f32 v81, v73
    v_cos_f32 v78, v74
    v_sin_f32 v82, v74
    v_cos_f32 v79, v75
    v_sin_f32 v83, v75
    v_cvt_pk_bf16_f32 v220, v76, v77
    v_cvt_pk_bf16_f32 v221, v78, v79
    v_cvt_pk_bf16_f32 v238, -v76, -v77
    v_cvt_pk_bf16_f32 v239, -v78, -v79
    v_cvt_pk_bf16_f32 v222, v80, v81
    v_cvt_pk_bf16_f32 v223, v82, v83
    v_cvt_pk_bf16_f32 v236, v80, v81
    v_cvt_pk_bf16_f32 v237, v82, v83
    v_fmamk_f32 v72, v84, 0x3f000000, v85
    v_fmamk_f32 v73, v84, 0x3f040000, v85
    v_fmamk_f32 v74, v84, 0x3f080000, v85
    v_fmamk_f32 v75, v84, 0x3f0c0000, v85
    v_cos_f32 v76, v72
    v_sin_f32 v80, v72
    v_cos_f32 v77, v73
    v_sin_f32 v81, v73
    v_cos_f32 v78, v74
    v_sin_f32 v82, v74
    v_cos_f32 v79, v75
    v_sin_f32 v83, v75
    v_cvt_pk_bf16_f32 v224, v76, v77
    v_cvt_pk_bf16_f32 v225, v78, v79
    v_cvt_pk_bf16_f32 v242, v76, v77
    v_cvt_pk_bf16_f32 v243, v78, v79
    v_cvt_pk_bf16_f32 v226, -v80, -v81
    v_cvt_pk_bf16_f32 v227, -v82, -v83
    v_cvt_pk_bf16_f32 v240, v80, v81
    v_cvt_pk_bf16_f32 v241, v82, v83
    v_fmamk_f32 v72, v84, 0x3f400000, v85
    v_fmamk_f32 v73, v84, 0x3f440000, v85
    v_fmamk_f32 v74, v84, 0x3f480000, v85
    v_fmamk_f32 v75, v84, 0x3f4c0000, v85
    v_cos_f32 v76, v72
    v_sin_f32 v80, v72
    v_cos_f32 v77, v73
    v_sin_f32 v81, v73
    v_cos_f32 v78, v74
    v_sin_f32 v82, v74
    v_cos_f32 v79, v75
    v_sin_f32 v83, v75
    v_cvt_pk_bf16_f32 v228, v76, v77
    v_cvt_pk_bf16_f32 v229, v78, v79
    v_cvt_pk_bf16_f32 v246, v76, v77
    v_cvt_pk_bf16_f32 v247, v78, v79
    v_cvt_pk_bf16_f32 v230, -v80, -v81
    v_cvt_pk_bf16_f32 v231, -v82, -v83
    v_cvt_pk_bf16_f32 v244, v80, v81
    v_cvt_pk_bf16_f32 v245, v82, v83
    v_mul_f32 v73, 0x3ae38e39, v84
    v_mul_f32 v74, 0x3b638e39, v84
    v_mul_f32 v75, 0x3baaaaab, v84
    v_mul_f32 v76, 0x3be38e39, v84
    v_cos_f32 v248, v73
    v_sin_f32 v252, v73
    v_cos_f32 v249, v74
    v_sin_f32 v253, v74
    v_cos_f32 v250, v75
    v_sin_f32 v254, v75
    v_cos_f32 v251, v76
    v_sin_f32 v255, v76
    v_mul_f32 v248, 0x35e38e39, v248
    v_mul_f32 v249, 0x35e38e39, v249
    v_mul_f32 v250, 0x35e38e39, v250
    v_mul_f32 v251, 0x35e38e39, v251
    v_mul_f32 v252, 0x35e38e39, v252
    v_mul_f32 v253, 0x35e38e39, v253
    v_mul_f32 v254, 0x35e38e39, v254
    v_mul_f32 v255, 0x35e38e39, v255
    s_cmp_eq_u32 s3, 3
    s_cbranch_scc0 f_nofp
    s_cmp_ge_u32 s2, 226
    s_cbranch_scc0 f_nosl3
    s_sleep 20
f_nosl3:
    s_mov_b64 exec, 3
    v_lshlrev_b32 v2, 7, v1
    s_mov_b32 s50, 0
f_an4:
    buffer_load_dword v3, v2, s[24:27], 0 offen sc1
    s_add_u32 s50, s50, 1
    s_waitcnt vmcnt(0)
    v_cmp_eq_u32 vcc, 0, v3
    s_nop 1
    s_cbranch_vccz f_an4_ok
    s_sleep 2
    s_cmp_lt_u32 s50, 30000
    s_cbranch_scc1 f_an4
f_an4_ok:
    v_readfirstlane_b32 s26, v3
    s_mov_b64 exec, -1
    v_lshlrev_b32 v2, 6, v1
    v_min_u32 v3, 448, v2
    s_mov_b32 s51, 144896
    s_mov_b32 s47, 148992
    s_mov_b32 s46, 153088
    s_mov_b32 s50, 0
f_pf:
    buffer_load_dword v48, v2, s[28:31], s51 offen sc1
    buffer_load_dword v49, v2, s[28:31], s47 offen sc1
    buffer_load_dword v50, v3, s[28:31], s46 offen sc1
    s_add_u32 s50, s50, 1
    s_waitcnt vmcnt(0)
    v_max3_u32 v51, v48, v49, v50
    v_cmp_eq_u32 vcc, -1, v51
    s_nop 0
    s_and_b64 exec, vcc, vcc
    s_cbranch_scc0 f_pf_ok
    s_cmp_lt_u32 s50, 30000
    s_cbranch_scc1 f_pf
f_pf_ok:
    s_mov_b64 exec, -1
f_nofp:
    s_branch f_staged
f_stage:
    s_waitcnt vmcnt(0)
    s_cmp_ge_u32 s2, 226
    s_cbranch_scc0 f_nosl0
    s_sleep 20
f_nosl0:
    s_mov_b64 exec, 3
    v_lshlrev_b32 v2, 7, v1
    s_mov_b32 s50, 0
f_an3:
    buffer_load_dword v3, v2, s[24:27], 0 offen sc1
    s_add_u32 s50, s50, 1
    s_waitcnt vmcnt(0)
    v_cmp_eq_u32 vcc, 0, v3
    s_nop 1
    s_cbranch_vccz f_an3_ok
    s_sleep 2
    s_cmp_lt_u32 s50, 30000
    s_cbranch_scc1 f_an3
f_an3_ok:
    v_readfirstlane_b32 s26, v3
    s_mov_b64 exec, -1
    v_mul_u32_u24 v2, 24, v0
    s_mov_b32 s44, 0x20000
    s_mov_b32 s45, 0x21200
    s_mov_b32 s46, 0x22400
    v_cmp_lt_u32 vcc, 95, v0
    s_nop 1
    v_cndmask_b32 v3, 0, 1.0, vcc
    s_mov_b32 s47, 0xffff0000
    s_mov_b32 s50, 0
f_mp:
    buffer_load_dwordx4 v[84:87], v2, s[28:31], s44 offen sc1
    buffer_load_dwordx2 v[88:89], v2, s[28:31], s44 offen offset:16 sc1
    buffer_load_dwordx4 v[90:93], v2, s[28:31], s45 offen sc1
    buffer_load_dwordx2 v[94:95], v2, s[28:31], s45 offen offset:16 sc1
    buffer_load_dwordx4 v[96:99], v2, s[28:31], s46 offen sc1
    buffer_load_dwordx2 v[100:101], v2, s[28:31], s46 offen offset:16 sc1
    s_add_u32 s50, s50, 1
    s_waitcnt vmcnt(0)
    v_max3_u32 v72, v84, v85, v86
    v_max3_u32 v72, v72, v87, v88
    v_max3_u32 v72, v72, v89, v90
    v_max3_u32 v72, v72, v91, v92
    v_max3_u32 v72, v72, v93, v94
    v_max3_u32 v72, v72, v95, v96
    v_max3_u32 v72, v72, v97, v98
    v_max3_u32 v72, v72, v99, v100
    v_max_u32 v72, v72, v101
    v_cmp_eq_u32 vcc, -1, v72
    s_nop 0
    s_and_b64 exec, vcc, vcc
    s_cbranch_scc0 f_mp_ok
    s_cmp_lt_u32 s50, 30000
    s_cbranch_scc1 f_mp
f_mp_ok:
    s_mov_b64 exec, -1
    v_pk_add_f32 v[84:85], v[84:85], v[90:91]
    v_pk_add_f32 v[86:87], v[86:87], v[92:93]
    v_pk_add_f32 v[88:89], v[88:89], v[94:95]
    v_pk_add_f32 v[84:85], v[84:85], v[96:97]
    v_pk_add_f32 v[86:87], v[86:87], v[98:99]
    v_pk_add_f32 v[88:89], v[88:89], v[100:101]
    v_cvt_pk_bf16_f32 v72, v84, v85
    v_lshlrev_b32 v84, 16, v72
    v_and_b32 v85, s47, v72
    v_cvt_pk_bf16_f32 v73, v86, v87
    v_lshlrev_b32 v86, 16, v73
    v_and_b32 v87, s47, v73
    v_cvt_pk_bf16_f32 v72, v88, v89
    v_lshlrev_b32 v88, 16, v72
    v_and_b32 v89, s47, v72
    v_add_f32 v84, v84, v3
    v_add_f32 v85, v85, v3
    v_add_f32 v86, v86, v3
    v_add_f32 v87, v87, v3
    v_add_f32 v88, v88, v3
    v_add_f32 v89, v89, v3
    v_cvt_pk_bf16_f32 v72, v84, v85
    v_lshlrev_b32 v84, 16, v72
    v_and_b32 v85, s47, v72
    v_cvt_pk_bf16_f32 v73, v86, v87
    v_lshlrev_b32 v86, 16, v73
    v_and_b32 v87, s47, v73
    v_cvt_pk_bf16_f32 v72, v88, v89
    v_lshlrev_b32 v88, 16, v72
    v_and_b32 v89, s47, v72
    ds_write_b64 v2, v[84:85] offset:0
    ds_write_b64 v2, v[86:87] offset:8
    ds_write_b64 v2, v[88:89] offset:16
f_staged:
    s_load_dwordx2 s[8:9], s[0:1], 48
    s_mov_b32 s10, 0x1200000
    s_load_dwordx2 s[12:13], s[0:1], 56
    s_mov_b32 s14, 0x1000
    s_load_dwordx2 s[16:17], s[0:1], 80
    s_mov_b32 s18, 0x240000
    s_load_dwordx2 s[20:21], s[0:1], 40
    s_mov_b32 s22, 0x2400
    s_waitcnt lgkmcnt(0)
    s_barrier
    ds_read2st64_b32 v[36:37], v125 offset0:8 offset1:9
    ds_read2st64_b32 v[38:39], v125 offset0:10 offset1:11
    ds_read2st64_b32 v[40:41], v125 offset0:12 offset1:13
    ds_read2st64_b32 v[42:43], v125 offset0:14 offset1:15
    ds_read2st64_b32 v[44:45], v125 offset0:16 offset1:17
    ds_read2st64_b32 v[28:29], v125 offset0:0 offset1:1
    ds_read2st64_b32 v[30:31], v125 offset0:2 offset1:3
    ds_read2st64_b32 v[32:33], v125 offset0:4 offset1:5
    ds_read2st64_b32 v[34:35], v125 offset0:6 offset1:7
    s_waitcnt lgkmcnt(3)
    v_fma_f32 v8, v8, v37, v28
    v_fma_f32 v9, v9, v38, v29
    s_waitcnt lgkmcnt(2)
    v_fma_f32 v10, v10, v39, v30
    v_fma_f32 v11, v11, v40, v31
    s_waitcnt lgkmcnt(1)
    v_fma_f32 v12, v12, v41, v32
    v_fma_f32 v13, v13, v42, v33
    s_waitcnt lgkmcnt(0)
    v_fma_f32 v14, v14, v43, v34
    v_fma_f32 v15, v15, v44, v35
    v_fma_f32 v16, v16, v45, v36
    v_add_f32 v48, v9, v16
    v_sub_f32 v52, v9, v16
    v_add_f32 v49, v10, v15
    v_sub_f32 v53, v10, v15
    v_add_f32 v50, v11, v14
    v_sub_f32 v54, v11, v14
    v_add_f32 v51, v12, v13
    v_sub_f32 v55, v12, v13
    v_add_f32 v64, v8, v48
    v_add_f32 v65, v49, v50
    v_add_f32 v64, v64, v51
    v_add_f32 v64, v64, v65
    v_fmamk_f32 v56, v48, 0x3f441b7d, v8
    v_fmamk_f32 v57, v48, 0x3e31d0d4, v8
    v_fmamk_f32 v58, v48, 0xbf000000, v8
    v_fmamk_f32 v59, v48, 0xbf708fb2, v8
    v_fmamk_f32 v56, v49, 0x3e31d0d4, v56
    v_fmamk_f32 v57, v49, 0xbf708fb2, v57
    v_fmamk_f32 v58, v49, 0xbf000000, v58
    v_fmamk_f32 v59, v49, 0x3f441b7d, v59
    v_fmamk_f32 v56, v50, 0xbf000000, v56
    v_fmamk_f32 v57, v50, 0xbf000000, v57
    v_fmamk_f32 v58, v50, 0x3f800000, v58
    v_fmamk_f32 v59, v50, 0xbf000000, v59
    v_fmamk_f32 v56, v51, 0xbf708fb2, v56
    v_fmamk_f32 v57, v51, 0x3f441b7d, v57
    v_fmamk_f32 v58, v51, 0xbf000000, v58
    v_fmamk_f32 v59, v51, 0x3e31d0d4, v59
    v_mul_f32 v60, 0xbf248dbb, v52
    v_mul_f32 v61, 0xbf7c1c5c, v52
    v_mul_f32 v62, 0xbf5db3d7, v52
    v_mul_f32 v63, 0xbeaf1d44, v52
    v_fmamk_f32 v60, v53, 0xbf7c1c5c, v60
    v_fmamk_f32 v61, v53, 0xbeaf1d44, v61
    v_fmamk_f32 v62, v53, 0x3f5db3d7, v62
    v_fmamk_f32 v63, v53, 0x3f248dbb, v63
    v_fmamk_f32 v60, v54, 0xbf5db3d7, v60
    v_fmamk_f32 v61, v54, 0x3f5db3d7, v61
    v_fmamk_f32 v63, v54, 0xbf5db3d7, v63
    v_fmamk_f32 v60, v55, 0xbeaf1d44, v60
    v_fmamk_f32 v61, v55, 0x3f248dbb, v61
    v_fmamk_f32 v62, v55, 0xbf5db3d7, v62
    v_fmamk_f32 v63, v55, 0x3f7c1c5c, v63
    v_cvt_pk_bf16_f32 v64, v64, 0
    ds_write_b32 v104, v64
    v_pk_mul_f32 v[68:69], v[56:57], v[208:209]
    v_pk_mul_f32 v[72:73], v[60:61], v[208:209]
    v_pk_mul_f32 v[70:71], v[58:59], v[210:211]
    v_pk_mul_f32 v[74:75], v[62:63], v[210:211]
    v_pk_fma_f32 v[68:69], v[60:61], v[212:213], v[68:69]
    v_pk_fma_f32 v[72:73], v[56:57], v[212:213], v[72:73] neg_lo:[1,0,0] neg_hi:[1,0,0]
    v_pk_fma_f32 v[70:71], v[62:63], v[214:215], v[70:71]
    v_pk_fma_f32 v[74:75], v[58:59], v[214:215], v[74:75] neg_lo:[1,0,0] neg_hi:[1,0,0]
    v_cvt_pk_bf16_f32 v9, v68, v72
    ds_write_b32 v104, v9 offset:2176
    v_cvt_pk_bf16_f32 v10, v69, v73
    ds_write_b32 v104, v10 offset:4352
    v_cvt_pk_bf16_f32 v11, v70, v74
    ds_write_b32 v104, v11 offset:6528
    v_cvt_pk_bf16_f32 v12, v71, v75
    ds_write_b32 v104, v12 offset:8704
    s_cmp_lt_u32 s39, 2
    s_cselect_b32 s47, 0, 0x80000000
    s_waitcnt vmcnt(0) lgkmcnt(0)
    s_barrier
    ds_read_b128 v[28:31], v105 offset:0
    ds_read_b128 v[32:35], v105 offset:64
    ds_read_b128 v[36:39], v105 offset:128
    ds_read_b128 v[40:43], v105 offset:192
    s_cmp_eq_u32 s40, 1
    s_cbranch_scc1 f_p1_one
    ds_read_b128 v[44:47], v105 offset:4352
    ds_read_b128 v[48:51], v105 offset:4416
    ds_read_b128 v[52:55], v105 offset:4480
    ds_read_b128 v[56:59], v105 offset:4544
    s_waitcnt lgkmcnt(7)
    v_mfma_f32_16x16x32_bf16 v[60:63], v[28:31], v[128:131], 0
    v_mfma_f32_16x16x32_bf16 v[64:67], v[28:31], v[144:147], 0
    s_waitcnt lgkmcnt(6)
    v_mfma_f32_16x16x32_bf16 v[60:63], v[32:35], v[132:135], v[60:63]
    v_mfma_f32_16x16x32_bf16 v[64:67], v[32:35], v[148:151], v[64:67]
    s_waitcnt lgkmcnt(5)
    v_mfma_f32_16x16x32_bf16 v[60:63], v[36:39], v[136:139], v[60:63]
    v_mfma_f32_16x16x32_bf16 v[64:67], v[36:39], v[152:155], v[64:67]
    s_waitcnt lgkmcnt(4)
    v_mfma_f32_16x16x32_bf16 v[60:63], v[40:43], v[140:143], v[60:63]
    v_mfma_f32_16x16x32_bf16 v[64:67], v[40:43], v[156:159], v[64:67]
    s_waitcnt lgkmcnt(3)
    v_mfma_f32_16x16x32_bf16 v[68:71], v[44:47], v[128:131], 0
    v_mfma_f32_16x16x32_bf16 v[72:75], v[44:47], v[144:147], 0
    s_waitcnt lgkmcnt(2)
    v_mfma_f32_16x16x32_bf16 v[68:71], v[48:51], v[132:135], v[68:71]
    v_mfma_f32_16x16x32_bf16 v[72:75], v[48:51], v[148:151], v[72:75]
    s_waitcnt lgkmcnt(1)
    v_mfma_f32_16x16x32_bf16 v[68:71], v[52:55], v[136:139], v[68:71]
    v_mfma_f32_16x16x32_bf16 v[72:75], v[52:55], v[152:155], v[72:75]
    s_waitcnt lgkmcnt(0)
    v_mfma_f32_16x16x32_bf16 v[68:71], v[56:59], v[140:143], v[68:71]
    v_mfma_f32_16x16x32_bf16 v[72:75], v[56:59], v[156:159], v[72:75]
    v_cvt_pk_bf16_f32 v76, v60, v64
    v_cvt_pk_bf16_f32 v77, v61, v65
    v_cvt_pk_bf16_f32 v78, v62, v66
    v_cvt_pk_bf16_f32 v79, v63, v67
    v_xor_b32 v76, s47, v76
    v_xor_b32 v77, s47, v77
    v_xor_b32 v78, s47, v78
    v_xor_b32 v79, s47, v79
    buffer_store_dwordx4 v[76:79], v106, s[28:31], s56 offen sc1
    v_cvt_pk_bf16_f32 v80, v68, v72
    v_cvt_pk_bf16_f32 v81, v69, v73
    v_cvt_pk_bf16_f32 v82, v70, v74
    v_cvt_pk_bf16_f32 v83, v71, v75
    v_xor_b32 v80, s47, v80
    v_xor_b32 v81, s47, v81
    v_xor_b32 v82, s47, v82
    v_xor_b32 v83, s47, v83
    buffer_store_dwordx4 v[80:83], v107, s[28:31], s56 offen sc1
    s_branch f_p1_join
f_p1_one:
    s_waitcnt lgkmcnt(3)
    v_mfma_f32_16x16x32_bf16 v[60:63], v[28:31], v[128:131], 0
    v_mfma_f32_16x16x32_bf16 v[64:67], v[28:31], v[144:147], 0
    s_waitcnt lgkmcnt(2)
    v_mfma_f32_16x16x32_bf16 v[60:63], v[32:35], v[132:135], v[60:63]
    v_mfma_f32_16x16x32_bf16 v[64:67], v[32:35], v[148:151], v[64:67]
    s_waitcnt lgkmcnt(1)
    v_mfma_f32_16x16x32_bf16 v[60:63], v[36:39], v[136:139], v[60:63]
    v_mfma_f32_16x16x32_bf16 v[64:67], v[36:39], v[152:155], v[64:67]
    s_waitcnt lgkmcnt(0)
    v_mfma_f32_16x16x32_bf16 v[60:63], v[40:43], v[140:143], v[60:63]
    v_mfma_f32_16x16x32_bf16 v[64:67], v[40:43], v[156:159], v[64:67]
    s_nop 7
    v_cvt_pk_bf16_f32 v76, v60, v64
    v_cvt_pk_bf16_f32 v77, v61, v65
    v_cvt_pk_bf16_f32 v78, v62, v66
    v_cvt_pk_bf16_f32 v79, v63, v67
    v_xor_b32 v76, s47, v76
    v_xor_b32 v77, s47, v77
    v_xor_b32 v78, s47, v78
    v_xor_b32 v79, s47, v79
    buffer_store_dwordx4 v[76:79], v106, s[28:31], s56 offen sc1
f_p1_join:
    s_cmp_lt_u32 s3, 3
    s_cbranch_scc0 f_c3done
    v_cvt_f32_u32 v96, v7
    v_cvt_f32_u32 v97, v6
    v_mul_f32 v97, v97, v96
    v_mul_f32 v97, 0x3d800000, v97
    v_fmamk_f32 v84, v96, 0x00000000, v97
    v_fmamk_f32 v85, v96, 0x3c800000, v97
    v_fmamk_f32 v86, v96, 0x3d000000, v97
    v_fmamk_f32 v87, v96, 0x3d400000, v97
    v_cos_f32 v88, v84
    v_sin_f32 v92, v84
    v_cos_f32 v89, v85
    v_sin_f32 v93, v85
    v_cos_f32 v90, v86
    v_sin_f32 v94, v86
    v_cos_f32 v91, v87
    v_sin_f32 v95, v87
    v_cvt_pk_bf16_f32 v216, v88, v89
    v_cvt_pk_bf16_f32 v217, v90, v91
    v_cvt_pk_bf16_f32 v234, -v88, -v89
    v_cvt_pk_bf16_f32 v235, -v90, -v91
    v_cvt_pk_bf16_f32 v218, v92, v93
    v_cvt_pk_bf16_f32 v219, v94, v95
    v_cvt_pk_bf16_f32 v232, v92, v93
    v_cvt_pk_bf16_f32 v233, v94, v95
    v_fmamk_f32 v84, v96, 0x3e800000, v97
    v_fmamk_f32 v85, v96, 0x3e880000, v97
    v_fmamk_f32 v86, v96, 0x3e900000, v97
    v_fmamk_f32 v87, v96, 0x3e980000, v97
    v_cos_f32 v88, v84
    v_sin_f32 v92, v84
    v_cos_f32 v89, v85
    v_sin_f32 v93, v85
    v_cos_f32 v90, v86
    v_sin_f32 v94, v86
    v_cos_f32 v91, v87
    v_sin_f32 v95, v87
    v_cvt_pk_bf16_f32 v220, v88, v89
    v_cvt_pk_bf16_f32 v221, v90, v91
    v_cvt_pk_bf16_f32 v238, -v88, -v89
    v_cvt_pk_bf16_f32 v239, -v90, -v91
    v_cvt_pk_bf16_f32 v222, v92, v93
    v_cvt_pk_bf16_f32 v223, v94, v95
    v_cvt_pk_bf16_f32 v236, v92, v93
    v_cvt_pk_bf16_f32 v237, v94, v95
    v_fmamk_f32 v84, v96, 0x3f000000, v97
    v_fmamk_f32 v85, v96, 0x3f040000, v97
    v_fmamk_f32 v86, v96, 0x3f080000, v97
    v_fmamk_f32 v87, v96, 0x3f0c0000, v97
    v_cos_f32 v88, v84
    v_sin_f32 v92, v84
    v_cos_f32 v89, v85
    v_sin_f32 v93, v85
    v_cos_f32 v90, v86
    v_sin_f32 v94, v86
    v_cos_f32 v91, v87
    v_sin_f32 v95, v87
    v_cvt_pk_bf16_f32 v224, v88, v89
    v_cvt_pk_bf16_f32 v225, v90, v91
    v_cvt_pk_bf16_f32 v242, v88, v89
    v_cvt_pk_bf16_f32 v243, v90, v91
    v_cvt_pk_bf16_f32 v226, -v92, -v93
    v_cvt_pk_bf16_f32 v227, -v94, -v95
    v_cvt_pk_bf16_f32 v240, v92, v93
    v_cvt_pk_bf16_f32 v241, v94, v95
    v_fmamk_f32 v84, v96, 0x3f400000, v97
    v_fmamk_f32 v85, v96, 0x3f440000, v97
    v_fmamk_f32 v86, v96, 0x3f480000, v97
    v_fmamk_f32 v87, v96, 0x3f4c0000, v97
    v_cos_f32 v88, v84
    v_sin_f32 v92, v84
    v_cos_f32 v89, v85
    v_sin_f32 v93, v85
    v_cos_f32 v90, v86
    v_sin_f32 v94, v86
    v_cos_f32 v91, v87
    v_sin_f32 v95, v87
    v_cvt_pk_bf16_f32 v228, v88, v89
    v_cvt_pk_bf16_f32 v229, v90, v91
    v_cvt_pk_bf16_f32 v246, v88, v89
    v_cvt_pk_bf16_f32 v247, v90, v91
    v_cvt_pk_bf16_f32 v230, -v92, -v93
    v_cvt_pk_bf16_f32 v231, -v94, -v95
    v_cvt_pk_bf16_f32 v244, v92, v93
    v_cvt_pk_bf16_f32 v245, v94, v95
    v_mul_f32 v85, 0x3ae38e39, v96
    v_mul_f32 v86, 0x3b638e39, v96
    v_mul_f32 v87, 0x3baaaaab, v96
    v_mul_f32 v88, 0x3be38e39, v96
    v_cos_f32 v248, v85
    v_sin_f32 v252, v85
    v_cos_f32 v249, v86
    v_sin_f32 v253, v86
    v_cos_f32 v250, v87
    v_sin_f32 v254, v87
    v_cos_f32 v251, v88
    v_sin_f32 v255, v88
    v_mul_f32 v248, 0x35e38e39, v248
    v_mul_f32 v249, 0x35e38e39, v249
    v_mul_f32 v250, 0x35e38e39, v250
    v_mul_f32 v251, 0x35e38e39, v251
    v_mul_f32 v252, 0x35e38e39, v252
    v_mul_f32 v253, 0x35e38e39, v253
    v_mul_f32 v254, 0x35e38e39, v254
    v_mul_f32 v255, 0x35e38e39, v255
f_c3done:
    s_mul_i32 s63, s36, 27
    s_add_u32 s63, s63, s37
    s_mul_i32 s62, s63, 171
    s_lshr_b32 s62, s62, 10
    s_mul_i32 s60, s62, 6
    s_sub_u32 s63, s63, s60
    s_lshl_b32 s60, s62, 8
    s_mul_i32 s61, s39, 147456
    s_add_u32 s60, s60, s61
    s_mul_i32 s61, s63, 393216
    s_mul_i32 s24, s39, 3072
    s_add_u32 s61, s61, s24
    s_add_u32 s61, s61, 13631488
    s_lshl_b32 s24, s39, 12
    s_add_u32 s24, s24, 65536
    v_lshrrev_b32 v2, 4, v1
    v_and_b32 v3, 15, v1
    v_lshlrev_b32 v9, 1, v2
    v_xor_b32 v9, v9, v3
    v_xor_b32 v10, 8, v9
    v_mul_u32_u24 v2, 9216, v2
    v_lshl_add_u32 v9, v9, 4, v2
    v_lshl_add_u32 v10, v10, 4, v2
    v_lshlrev_b32 v14, 4, v1
    v_lshlrev_b32 v15, 2, v1
    s_cmp_eq_u32 s42, -1
    s_cbranch_scc1 f_p2_idle
    s_and_b32 s50, s39, 1
    s_lshl_b32 s50, s50, 4
    s_lshr_b32 s51, s39, 1
    s_add_u32 s50, s50, s51
    s_mul_i32 s50, s50, 81920
    s_lshl_b32 s51, s42, 5
    s_add_u32 s50, s50, s51
    s_add_u32 s44, s50, 4194304
    s_add_u32 s45, s44, 655360
    s_lshl_b32 s50, s3, 11
    s_add_u32 s50, s50, 29952
    v_add_u32 v2, s50, v109
    s_lshl_b32 s50, s40, 13
    s_add_u32 s50, s50, 29952
    v_add_u32 v3, s50, v109
    s_lshr_b32 s50, s42, 6
    s_and_b32 s51, s42, 63
    s_mul_i32 s46, s51, 9
    s_add_u32 s46, s46, s50
    s_sub_u32 s50, 576, s46
    s_cmp_lt_u32 s51, 32
    s_cselect_b32 s46, s46, s50
    s_lshl_b32 s46, s46, 13
    s_lshl_b32 s50, s39, 11
    s_add_u32 s46, s46, s50
    s_add_u32 s46, s46, 1048576
    s_lshl_b32 s48, s42, 13
    s_add_u32 s48, s48, 7340032
    s_mov_b32 s47, 0xffff0000
    s_waitcnt vmcnt(0)
    s_mov_b32 s50, 0
f_hb:
    buffer_load_dwordx4 v[28:31], v108, s[28:31], s44 offen sc1
    buffer_load_dwordx4 v[32:35], v108, s[28:31], s45 offen sc1
    s_add_u32 s50, s50, 1
    s_waitcnt vmcnt(0)
    v_max3_u32 v84, v28, v29, v30
    v_max3_u32 v84, v84, v31, v32
    v_max3_u32 v84, v84, v33, v34
    v_max_u32 v84, v84, v35
    v_cmp_eq_u32 vcc, -1, v84
    s_nop 0
    s_and_b64 exec, vcc, vcc
    s_cbranch_scc0 f_hb_ok
    s_cmp_lt_u32 s50, 30000
    s_cbranch_scc1 f_hb
f_hb_ok:
    s_mov_b64 exec, -1
    buffer_load_dwordx4 v[96:99], v109, s[28:31], s46 offen offset:0 sc1
    buffer_load_dwordx4 v[100:103], v109, s[28:31], s46 offen offset:1024 sc1
    ds_write_b128 v2, v[28:31] offset:0
    ds_write_b128 v2, v[32:35] offset:1024
    s_waitcnt lgkmcnt(0)
    s_barrier
    s_add_u32 m0, s55, 0
    s_nop 0
    buffer_load_dwordx4 v109, s[4:7], s49 offen lds
    s_mov_b64 exec, 0xff
    buffer_load_dwordx4 v109, s[4:7], s49 offen offset:1024 lds
    s_mov_b64 exec, -1
    ds_read_b128 v[28:31], v3 offset:0
    ds_read_b128 v[44:47], v3 offset:4096
    ds_read_b128 v[32:35], v3 offset:1024
    ds_read_b128 v[48:51], v3 offset:5120
    ds_read_b128 v[36:39], v3 offset:2048
    ds_read_b128 v[52:55], v3 offset:6144
    ds_read_b128 v[40:43], v3 offset:3072
    ds_read_b128 v[56:59], v3 offset:7168
    s_waitcnt lgkmcnt(7)
    v_mfma_f32_16x16x32_bf16 v[60:63], v[28:31], v[128:131], 0
    v_mfma_f32_16x16x32_bf16 v[64:67], v[28:31], v[144:147], 0
    s_waitcnt lgkmcnt(6)
    v_mfma_f32_16x16x32_bf16 v[68:71], v[44:47], v[128:131], 0
    v_mfma_f32_16x16x32_bf16 v[72:75], v[44:47], v[144:147], 0
    s_waitcnt lgkmcnt(5)
    v_mfma_f32_16x16x32_bf16 v[60:63], v[32:35], v[132:135], v[60:63]
    v_mfma_f32_16x16x32_bf16 v[64:67], v[32:35], v[148:151], v[64:67]
    s_waitcnt lgkmcnt(4)
    v_mfma_f32_16x16x32_bf16 v[68:71], v[48:51], v[132:135], v[68:71]
    v_mfma_f32_16x16x32_bf16 v[72:75], v[48:51], v[148:151], v[72:75]
    s_waitcnt lgkmcnt(3)
    v_mfma_f32_16x16x32_bf16 v[60:63], v[36:39], v[136:139], v[60:63]
    v_mfma_f32_16x16x32_bf16 v[64:67], v[36:39], v[152:155], v[64:67]
    s_waitcnt lgkmcnt(2)
    v_mfma_f32_16x16x32_bf16 v[68:71], v[52:55], v[136:139], v[68:71]
    v_mfma_f32_16x16x32_bf16 v[72:75], v[52:55], v[152:155], v[72:75]
    s_waitcnt lgkmcnt(1)
    v_mfma_f32_16x16x32_bf16 v[60:63], v[40:43], v[140:143], v[60:63]
    v_mfma_f32_16x16x32_bf16 v[64:67], v[40:43], v[156:159], v[64:67]
    s_waitcnt lgkmcnt(0)
    v_mfma_f32_16x16x32_bf16 v[68:71], v[56:59], v[140:143], v[68:71]
    v_mfma_f32_16x16x32_bf16 v[72:75], v[56:59], v[156:159], v[72:75]
    s_nop 3
    v_pk_mul_f32 v[84:85], v[60:61], v[192:193]
    v_pk_mul_f32 v[88:89], v[64:65], v[192:193]
    v_pk_mul_f32 v[86:87], v[62:63], v[194:195]
    v_pk_mul_f32 v[90:91], v[66:67], v[194:195]
    v_pk_fma_f32 v[84:85], v[64:65], v[200:201], v[84:85]
    v_pk_fma_f32 v[88:89], v[60:61], v[200:201], v[88:89] neg_lo:[1,0,0] neg_hi:[1,0,0]
    v_pk_fma_f32 v[86:87], v[66:67], v[202:203], v[86:87]
    v_pk_fma_f32 v[90:91], v[62:63], v[202:203], v[90:91] neg_lo:[1,0,0] neg_hi:[1,0,0]
    v_cvt_pk_bf16_f32 v76, v84, v85
    v_cvt_pk_bf16_f32 v77, v86, v87
    v_cvt_pk_bf16_f32 v78, v88, v89
    v_cvt_pk_bf16_f32 v79, v90, v91
    v_pk_mul_f32 v[84:85], v[68:69], v[196:197]
    v_pk_mul_f32 v[88:89], v[72:73], v[196:197]
    v_pk_mul_f32 v[86:87], v[70:71], v[198:199]
    v_pk_mul_f32 v[90:91], v[74:75], v[198:199]
    v_pk_fma_f32 v[84:85], v[72:73], v[204:205], v[84:85]
    v_pk_fma_f32 v[88:89], v[68:69], v[204:205], v[88:89] neg_lo:[1,0,0] neg_hi:[1,0,0]
    v_pk_fma_f32 v[86:87], v[74:75], v[206:207], v[86:87]
    v_pk_fma_f32 v[90:91], v[70:71], v[206:207], v[90:91] neg_lo:[1,0,0] neg_hi:[1,0,0]
    v_cvt_pk_bf16_f32 v80, v84, v85
    v_cvt_pk_bf16_f32 v81, v86, v87
    v_cvt_pk_bf16_f32 v82, v88, v89
    v_cvt_pk_bf16_f32 v83, v90, v91
    v_mfma_f32_16x16x32_bf16 v[60:63], v[160:163], v[76:79], 0
    v_mfma_f32_16x16x32_bf16 v[64:67], v[176:179], v[76:79], 0
    v_mfma_f32_16x16x32_bf16 v[68:71], v[168:171], v[76:79], 0
    v_mfma_f32_16x16x32_bf16 v[72:75], v[184:187], v[76:79], 0
    v_mfma_f32_16x16x32_bf16 v[60:63], v[164:167], v[80:83], v[60:63]
    v_mfma_f32_16x16x32_bf16 v[64:67], v[180:183], v[80:83], v[64:67]
    v_mfma_f32_16x16x32_bf16 v[68:71], v[172:175], v[80:83], v[68:71]
    v_mfma_f32_16x16x32_bf16 v[72:75], v[188:191], v[80:83], v[72:75]
    s_waitcnt vmcnt(2)
    v_lshlrev_b32 v28, 16, v96
    v_and_b32 v36, s47, v96
    v_lshlrev_b32 v29, 16, v97
    v_and_b32 v37, s47, v97
    v_lshlrev_b32 v30, 16, v98
    v_and_b32 v38, s47, v98
    v_lshlrev_b32 v31, 16, v99
    v_and_b32 v39, s47, v99
    v_lshlrev_b32 v32, 16, v100
    v_and_b32 v40, s47, v100
    v_lshlrev_b32 v33, 16, v101
    v_and_b32 v41, s47, v101
    v_lshlrev_b32 v34, 16, v102
    v_and_b32 v42, s47, v102
    v_lshlrev_b32 v35, 16, v103
    v_and_b32 v43, s47, v103
    v_pk_mul_f32 v[84:85], v[60:61], v[28:29]
    v_pk_mul_f32 v[88:89], v[64:65], v[28:29] neg_lo:[1,0] neg_hi:[1,0]
    v_pk_mul_f32 v[86:87], v[62:63], v[30:31]
    v_pk_mul_f32 v[90:91], v[66:67], v[30:31] neg_lo:[1,0] neg_hi:[1,0]
    v_pk_fma_f32 v[84:85], v[64:65], v[36:37], v[84:85] neg_lo:[1,0,0] neg_hi:[1,0,0]
    v_pk_fma_f32 v[88:89], v[60:61], v[36:37], v[88:89] neg_lo:[1,0,0] neg_hi:[1,0,0]
    v_pk_fma_f32 v[86:87], v[66:67], v[38:39], v[86:87] neg_lo:[1,0,0] neg_hi:[1,0,0]
    v_pk_fma_f32 v[90:91], v[62:63], v[38:39], v[90:91] neg_lo:[1,0,0] neg_hi:[1,0,0]
    v_cvt_pk_bf16_f32 v76, v84, v85
    v_cvt_pk_bf16_f32 v77, v86, v87
    v_cvt_pk_bf16_f32 v78, v88, v89
    v_cvt_pk_bf16_f32 v79, v90, v91
    v_pk_mul_f32 v[84:85], v[68:69], v[32:33]
    v_pk_mul_f32 v[88:89], v[72:73], v[32:33] neg_lo:[1,0] neg_hi:[1,0]
    v_pk_mul_f32 v[86:87], v[70:71], v[34:35]
    v_pk_mul_f32 v[90:91], v[74:75], v[34:35] neg_lo:[1,0] neg_hi:[1,0]
    v_pk_fma_f32 v[84:85], v[72:73], v[40:41], v[84:85] neg_lo:[1,0,0] neg_hi:[1,0,0]
    v_pk_fma_f32 v[88:89], v[68:69], v[40:41], v[88:89] neg_lo:[1,0,0] neg_hi:[1,0,0]
    v_pk_fma_f32 v[86:87], v[74:75], v[42:43], v[86:87] neg_lo:[1,0,0] neg_hi:[1,0,0]
    v_pk_fma_f32 v[90:91], v[70:71], v[42:43], v[90:91] neg_lo:[1,0,0] neg_hi:[1,0,0]
    v_cvt_pk_bf16_f32 v80, v84, v85
    v_cvt_pk_bf16_f32 v81, v86, v87
    v_cvt_pk_bf16_f32 v82, v88, v89
    v_cvt_pk_bf16_f32 v83, v90, v91
    v_mfma_f32_16x16x32_bf16 v[60:63], v[160:163], v[76:79], 0
    v_mfma_f32_16x16x32_bf16 v[64:67], v[176:179], v[76:79], 0
    v_mfma_f32_16x16x32_bf16 v[68:71], v[168:171], v[76:79], 0
    v_mfma_f32_16x16x32_bf16 v[72:75], v[184:187], v[76:79], 0
    v_mfma_f32_16x16x32_bf16 v[60:63], v[164:167], v[80:83], v[60:63]
    v_mfma_f32_16x16x32_bf16 v[64:67], v[180:183], v[80:83], v[64:67]
    v_mfma_f32_16x16x32_bf16 v[68:71], v[172:175], v[80:83], v[68:71]
    v_mfma_f32_16x16x32_bf16 v[72:75], v[188:191], v[80:83], v[72:75]
    s_nop 4
    v_pk_mul_f32 v[84:85], v[60:61], v[192:193]
    v_pk_mul_f32 v[88:89], v[64:65], v[192:193]
    v_pk_mul_f32 v[86:87], v[62:63], v[194:195]
    v_pk_mul_f32 v[90:91], v[66:67], v[194:195]
    v_pk_fma_f32 v[84:85], v[64:65], v[200:201], v[84:85]
    v_pk_fma_f32 v[88:89], v[60:61], v[200:201], v[88:89] neg_lo:[1,0,0] neg_hi:[1,0,0]
    v_pk_fma_f32 v[86:87], v[66:67], v[202:203], v[86:87]
    v_pk_fma_f32 v[90:91], v[62:63], v[202:203], v[90:91] neg_lo:[1,0,0] neg_hi:[1,0,0]
    v_cvt_pk_bf16_f32 v92, v84, v88
    ds_write_b32 v110, v92 offset:0
    v_cvt_pk_bf16_f32 v93, v85, v89
    ds_write_b32 v110, v93 offset:272
    v_cvt_pk_bf16_f32 v94, v86, v90
    ds_write_b32 v110, v94 offset:544
    v_cvt_pk_bf16_f32 v95, v87, v91
    ds_write_b32 v110, v95 offset:816
    v_pk_mul_f32 v[84:85], v[68:69], v[196:197]
    v_pk_mul_f32 v[88:89], v[72:73], v[196:197]
    v_pk_mul_f32 v[86:87], v[70:71], v[198:199]
    v_pk_mul_f32 v[90:91], v[74:75], v[198:199]
    v_pk_fma_f32 v[84:85], v[72:73], v[204:205], v[84:85]
    v_pk_fma_f32 v[88:89], v[68:69], v[204:205], v[88:89] neg_lo:[1,0,0] neg_hi:[1,0,0]
    v_pk_fma_f32 v[86:87], v[74:75], v[206:207], v[86:87]
    v_pk_fma_f32 v[90:91], v[70:71], v[206:207], v[90:91] neg_lo:[1,0,0] neg_hi:[1,0,0]
    v_cvt_pk_bf16_f32 v92, v84, v88
    ds_write_b32 v110, v92 offset:4352
    v_cvt_pk_bf16_f32 v93, v85, v89
    ds_write_b32 v110, v93 offset:4624
    v_cvt_pk_bf16_f32 v94, v86, v90
    ds_write_b32 v110, v94 offset:4896
    v_cvt_pk_bf16_f32 v95, v87, v91
    ds_write_b32 v110, v95 offset:5168
    s_waitcnt lgkmcnt(0)
    s_barrier
    ds_read_b128 v[28:31], v111 offset:0
    ds_read_b128 v[44:47], v111 offset:4352
    ds_read_b128 v[32:35], v111 offset:64
    ds_read_b128 v[48:51], v111 offset:4416
    ds_read_b128 v[36:39], v111 offset:128
    ds_read_b128 v[52:55], v111 offset:4480
    ds_read_b128 v[40:43], v111 offset:192
    ds_read_b128 v[56:59], v111 offset:4544
    s_waitcnt lgkmcnt(7)
    v_mfma_f32_16x16x32_bf16 v[60:63], v[28:31], v[128:131], 0
    v_mfma_f32_16x16x32_bf16 v[64:67], v[28:31], v[144:147], 0
    s_waitcnt lgkmcnt(6)
    v_mfma_f32_16x16x32_bf16 v[68:71], v[44:47], v[128:131], 0
    v_mfma_f32_16x16x32_bf16 v[72:75], v[44:47], v[144:147], 0
    s_waitcnt lgkmcnt(5)
    v_mfma_f32_16x16x32_bf16 v[60:63], v[32:35], v[132:135], v[60:63]
    v_mfma_f32_16x16x32_bf16 v[64:67], v[32:35], v[148:151], v[64:67]
    s_waitcnt lgkmcnt(4)
    v_mfma_f32_16x16x32_bf16 v[68:71], v[48:51], v[132:135], v[68:71]
    v_mfma_f32_16x16x32_bf16 v[72:75], v[48:51], v[148:151], v[72:75]
    s_waitcnt lgkmcnt(3)
    v_mfma_f32_16x16x32_bf16 v[60:63], v[36:39], v[136:139], v[60:63]
    v_mfma_f32_16x16x32_bf16 v[64:67], v[36:39], v[152:155], v[64:67]
    s_waitcnt lgkmcnt(2)
    v_mfma_f32_16x16x32_bf16 v[68:71], v[52:55], v[136:139], v[68:71]
    v_mfma_f32_16x16x32_bf16 v[72:75], v[52:55], v[152:155], v[72:75]
    s_waitcnt lgkmcnt(1)
    v_mfma_f32_16x16x32_bf16 v[60:63], v[40:43], v[140:143], v[60:63]
    v_mfma_f32_16x16x32_bf16 v[64:67], v[40:43], v[156:159], v[64:67]
    s_waitcnt lgkmcnt(0)
    v_mfma_f32_16x16x32_bf16 v[68:71], v[56:59], v[140:143], v[68:71]
    v_mfma_f32_16x16x32_bf16 v[72:75], v[56:59], v[156:159], v[72:75]
    s_nop 3
    v_cvt_pk_bf16_f32 v84, v60, v61
    v_cvt_pk_bf16_f32 v85, v62, v63
    v_cvt_pk_bf16_f32 v86, v64, v65
    v_cvt_pk_bf16_f32 v87, v66, v67
    buffer_store_dwordx4 v[84:87], v112, s[28:31], s48 offen sc1
    v_cvt_pk_bf16_f32 v88, v68, v69
    v_cvt_pk_bf16_f32 v89, v70, v71
    v_cvt_pk_bf16_f32 v90, v72, v73
    v_cvt_pk_bf16_f32 v91, v74, v75
    s_add_u32 s48, s48, 4096
    buffer_store_dwordx4 v[88:91], v112, s[28:31], s48 offen sc1
    s_branch f_p2_done
f_p2_idle:
    s_barrier
    s_add_u32 m0, s55, 0
    s_nop 0
    buffer_load_dwordx4 v109, s[4:7], s49 offen lds
    s_mov_b64 exec, 0xff
    buffer_load_dwordx4 v109, s[4:7], s49 offen offset:1024 lds
    s_mov_b64 exec, -1
    s_cmp_lt_u32 s2, 216
    s_cbranch_scc0 f_pla
    s_mov_b32 m0, s24
    s_nop 0
    buffer_load_dwordx4 v9, s[32:35], s60 offen offset:0 lds
    s_add_u32 s25, s60, 35840
    buffer_load_dwordx4 v9, s[32:35], s25 offen offset:1024 lds
    s_add_u32 s26, s60, 71680
    buffer_load_dwordx4 v10, s[32:35], s26 offen offset:2048 lds
    s_add_u32 s27, s60, 107520
    buffer_load_dwordx4 v10, s[32:35], s27 offen offset:3072 lds
    s_add_u32 s60, s60, 589824
    s_add_u32 s24, s24, 16384
    s_mov_b32 m0, s24
    s_nop 0
    buffer_load_dwordx4 v9, s[32:35], s60 offen offset:0 lds
    s_add_u32 s25, s60, 35840
    buffer_load_dwordx4 v9, s[32:35], s25 offen offset:1024 lds
    s_add_u32 s26, s60, 71680
    buffer_load_dwordx4 v10, s[32:35], s26 offen offset:2048 lds
    s_add_u32 s27, s60, 107520
    buffer_load_dwordx4 v10, s[32:35], s27 offen offset:3072 lds
    s_add_u32 s60, s60, 589824
    s_add_u32 s24, s24, 16384
f_pla:
    s_barrier
f_p2_done:
    s_mov_b32 s44, 0x26000
    s_mov_b32 s45, 0x28400
    s_mov_b32 s46, 0x2a800
    buffer_load_dwordx4 v[28:31], v126, s[28:31], s44 offen
    buffer_load_dwordx4 v[32:35], v126, s[28:31], s45 offen
    buffer_load_dwordx4 v[36:39], v126, s[28:31], s46 offen
    s_bfe_u32 s50, s38, 0x10001
    s_lshl_b32 s50, s50, 6
    s_lshr_b32 s51, s38, 2
    s_add_u32 s50, s50, s51
    s_lshl_b32 s50, s50, 1
    s_and_b32 s51, s38, 1
    s_add_u32 s50, s50, s51
    s_lshl_b32 s50, s50, 5
    s_add_u32 s48, s50, 7340032
    v_subrev_u32 v2, 288, v0
    v_cmp_gt_u32 vcc, 144, v2
    s_nop 1
    v_cndmask_b32 v3, 0, 1.0, vcc
    v_lshlrev_b32 v2, 4, v0
    s_mov_b32 s47, 0xffff0000
    s_waitcnt vmcnt(0)
    v_pk_add_f32 v[28:29], v[28:29], v[32:33]
    v_pk_add_f32 v[30:31], v[30:31], v[34:35]
    v_pk_add_f32 v[28:29], v[28:29], v[36:37]
    v_pk_add_f32 v[30:31], v[30:31], v[38:39]
    v_cvt_pk_bf16_f32 v48, v28, v29
    v_lshlrev_b32 v28, 16, v48
    v_and_b32 v29, s47, v48
    v_cvt_pk_bf16_f32 v49, v30, v31
    v_lshlrev_b32 v30, 16, v49
    v_and_b32 v31, s47, v49
    v_add_f32 v28, v28, v3
    v_add_f32 v29, v29, v3
    v_add_f32 v30, v30, v3
    v_add_f32 v31, v31, v3
    v_cvt_pk_bf16_f32 v48, v28, v29
    v_lshlrev_b32 v28, 16, v48
    v_and_b32 v29, s47, v48
    v_cvt_pk_bf16_f32 v49, v30, v31
    v_lshlrev_b32 v30, 16, v49
    v_and_b32 v31, s47, v49
    ds_write_b128 v2, v[28:31] offset:9728
    s_cmp_ge_u32 s2, 254
    s_cselect_b32 s50, s3, 0
    s_cmp_ge_u32 s50, 6
    s_cbranch_scc0 f_nogb
    v_subrev_u32 v2, 432, v0
    v_cmp_gt_u32 vcc, 72, v2
    v_mov_b32 v3, 0x7f000000
    s_nop 0
    v_cndmask_b32 v2, v3, v126, vcc
    s_movk_i32 s50, 4608
    buffer_store_dwordx4 v[28:31], v2, s[28:31], s50 offen sc1
    s_waitcnt vmcnt(0)
f_nogb:
    s_cmp_lt_u32 s2, 33
    s_cbranch_scc1 f_nozsl
    s_sleep 16
f_nozsl:
    s_cmp_lt_u32 s3, 2
    s_cbranch_scc1 f_z2
    s_mov_b32 s50, 0
f_za:
    buffer_load_dwordx4 v[40:43], v113, s[28:31], s48 offen sc1
    s_add_u32 s50, s50, 1
    s_waitcnt vmcnt(0)
    v_max3_u32 v48, v40, v41, v42
    v_max_u32 v48, v48, v43
    v_cmp_eq_u32 vcc, -1, v48
    s_nop 0
    s_and_b64 exec, vcc, vcc
    s_cbranch_scc0 f_za_ok
    s_cmp_lt_u32 s50, 30000
    s_cbranch_scc1 f_za
f_za_ok:
    s_mov_b64 exec, -1
    s_branch f_zj
f_z2:
    s_mov_b32 s50, 0
f_zb:
    buffer_load_dwordx4 v[40:43], v113, s[28:31], s48 offen sc1
    buffer_load_dwordx4 v[44:47], v114, s[28:31], s48 offen sc1
    s_add_u32 s50, s50, 1
    s_waitcnt vmcnt(0)
    v_max3_u32 v48, v40, v41, v42
    v_max3_u32 v48, v48, v43, v44
    v_max3_u32 v48, v48, v45, v46
    v_max_u32 v48, v48, v47
    v_cmp_eq_u32 vcc, -1, v48
    s_nop 0
    s_and_b64 exec, vcc, vcc
    s_cbranch_scc0 f_zb_ok
    s_cmp_lt_u32 s50, 30000
    s_cbranch_scc1 f_zb
f_zb_ok:
    s_mov_b64 exec, -1
    ds_write_b64 v115, v[44:45] offset:2304
    ds_write_b64 v115, v[46:47] offset:5184
f_zj:
    ds_write_b64 v115, v[40:41]
    ds_write_b64 v115, v[42:43] offset:2880
    s_cmp_lt_u32 s3, 4
    s_cbranch_scc1 f_plb_done0
    s_cmp_lt_u32 s2, 33
    s_cbranch_scc0 f_plb0
    s_cmp_lt_u32 s2, 216
    s_cbranch_scc0 f_plb00
    s_mov_b32 m0, s24
    s_nop 0
    buffer_load_dwordx4 v9, s[32:35], s60 offen offset:0 lds
    s_add_u32 s25, s60, 35840
    buffer_load_dwordx4 v9, s[32:35], s25 offen offset:1024 lds
    s_add_u32 s26, s60, 71680
    buffer_load_dwordx4 v10, s[32:35], s26 offen offset:2048 lds
    s_add_u32 s27, s60, 107520
    buffer_load_dwordx4 v10, s[32:35], s27 offen offset:3072 lds
    s_add_u32 s60, s60, 589824
    s_add_u32 s24, s24, 16384
    s_mov_b32 m0, s24
    s_nop 0
    buffer_load_dwordx4 v9, s[32:35], s60 offen offset:0 lds
    s_add_u32 s25, s60, 35840
    buffer_load_dwordx4 v9, s[32:35], s25 offen offset:1024 lds
    s_add_u32 s26, s60, 71680
    buffer_load_dwordx4 v10, s[32:35], s26 offen offset:2048 lds
    s_add_u32 s27, s60, 107520
    buffer_load_dwordx4 v10, s[32:35], s27 offen offset:3072 lds
    s_add_u32 s60, s60, 589824
    s_add_u32 s24, s24, 16384
f_plb00:
f_plb0:
    s_cmp_lt_u32 s2, 216
    s_cbranch_scc0 f_plb10
    s_mov_b32 m0, s24
    s_nop 0
    buffer_load_dwordx4 v9, s[32:35], s60 offen offset:0 lds
    s_add_u32 s25, s60, 35840
    buffer_load_dwordx4 v9, s[32:35], s25 offen offset:1024 lds
    s_add_u32 s26, s60, 71680
    buffer_load_dwordx4 v10, s[32:35], s26 offen offset:2048 lds
    s_add_u32 s27, s60, 107520
    buffer_load_dwordx4 v10, s[32:35], s27 offen offset:3072 lds
    s_add_u32 s60, s60, 589824
    s_add_u32 s24, s24, 16384
    s_mov_b32 m0, s24
    s_nop 0
    buffer_load_dwordx4 v9, s[32:35], s60 offen offset:0 lds
    s_add_u32 s25, s60, 35840
    buffer_load_dwordx4 v9, s[32:35], s25 offen offset:1024 lds
    s_add_u32 s26, s60, 71680
    buffer_load_dwordx4 v10, s[32:35], s26 offen offset:2048 lds
    s_add_u32 s27, s60, 107520
    buffer_load_dwordx4 v10, s[32:35], s27 offen offset:3072 lds
    s_add_u32 s60, s60, 589824
    s_add_u32 s24, s24, 16384
f_plb10:
f_plb_done0:
    s_waitcnt lgkmcnt(0)
    s_barrier
    s_cmp_lt_u32 s3, 4
    s_cbranch_scc1 f_plb_done1
    s_cmp_lt_u32 s3, 4
    s_cbranch_scc1 f_not3
    s_sub_u32 s50, s37, 0
    s_cbranch_scc1 f_not3
    s_lshl_b32 s50, s50, 2
    s_add_u32 s50, s50, s39
    s_add_u32 s58, s50, 64
    s_mul_i32 s58, s58, 55296
    s_add_u32 s58, s58, s57
    buffer_load_dword v8, v17, s[32:35], s58 offen
    s_add_u32 s58, s58, 7077888
    s_cmp_lt_u32 s50, 69
    s_cbranch_scc0 ftch_5
    buffer_load_dword v8, v17, s[32:35], s58 offen
ftch_5:
f_not3:
f_plb_done1:
    v_cmp_eq_u32 s[44:45], 1, v6
    v_cmp_eq_u32 s[50:51], 2, v6
    v_cmp_eq_u32 s[58:59], 3, v6
    ds_read_b64_tr_b16 v[28:29], v116 offset:0
    ds_read_b64_tr_b16 v[30:31], v116 offset:2880
    ds_read_b64_tr_b16 v[32:33], v116 offset:128
    ds_read_b64_tr_b16 v[34:35], v116 offset:3008
    ds_read_b64_tr_b16 v[36:37], v116 offset:256
    ds_read_b64_tr_b16 v[38:39], v116 offset:3136
    ds_read_b64_tr_b16 v[40:41], v116 offset:384
    ds_read_b64_tr_b16 v[42:43], v116 offset:3264
    ds_read_b64_tr_b16 v[44:45], v117 offset:0
    ds_read_b64_tr_b16 v[46:47], v117 offset:2880
    ds_read_b64_tr_b16 v[48:49], v117 offset:128
    ds_read_b64_tr_b16 v[50:51], v117 offset:3008
    ds_read_b64_tr_b16 v[52:53], v117 offset:256
    ds_read_b64_tr_b16 v[54:55], v117 offset:3136
    ds_read_b64_tr_b16 v[56:57], v117 offset:384
    ds_read_b64_tr_b16 v[58:59], v117 offset:3264
    s_waitcnt lgkmcnt(14)
    v_mfma_f32_16x16x32_bf16 v[60:63], v[28:31], v[216:219], 0
    v_mfma_f32_16x16x32_bf16 v[64:67], v[28:31], v[232:235], 0
    s_waitcnt lgkmcnt(12)
    v_mfma_f32_16x16x32_bf16 v[60:63], v[32:35], v[220:223], v[60:63]
    v_mfma_f32_16x16x32_bf16 v[64:67], v[32:35], v[236:239], v[64:67]
    s_waitcnt lgkmcnt(10)
    v_mfma_f32_16x16x32_bf16 v[60:63], v[36:39], v[224:227], v[60:63]
    v_mfma_f32_16x16x32_bf16 v[64:67], v[36:39], v[240:243], v[64:67]
    s_waitcnt lgkmcnt(8)
    v_mfma_f32_16x16x32_bf16 v[60:63], v[40:43], v[228:231], v[60:63]
    v_mfma_f32_16x16x32_bf16 v[64:67], v[40:43], v[244:247], v[64:67]
    s_waitcnt lgkmcnt(6)
    v_mfma_f32_16x16x32_bf16 v[68:71], v[44:47], v[216:219], 0
    s_waitcnt lgkmcnt(4)
    v_mfma_f32_16x16x32_bf16 v[68:71], v[48:51], v[220:223], v[68:71]
    s_waitcnt lgkmcnt(2)
    v_mfma_f32_16x16x32_bf16 v[68:71], v[52:55], v[224:227], v[68:71]
    s_waitcnt lgkmcnt(0)
    v_mfma_f32_16x16x32_bf16 v[68:71], v[56:59], v[228:231], v[68:71]
    ds_read_u16_d16_hi v18, v127 offset:0
    ds_read_u16_d16_hi v19, v127 offset:128
    ds_read_u16_d16_hi v20, v127 offset:256
    ds_read_u16_d16_hi v21, v127 offset:384
    ds_read_u16_d16_hi v22, v127 offset:512
    ds_read_u16_d16_hi v23, v127 offset:640
    ds_read_u16_d16_hi v24, v127 offset:768
    ds_read_u16_d16_hi v25, v127 offset:896
    ds_read_u16_d16_hi v26, v127 offset:1024
    ds_read2st64_b32 v[72:73], v124 offset0:38 offset1:39
    ds_read2st64_b32 v[74:75], v124 offset0:40 offset1:41
    ds_read2st64_b32 v[76:77], v124 offset0:42 offset1:43
    ds_read2st64_b32 v[78:79], v124 offset0:44 offset1:45
    ds_read2st64_b32 v[80:81], v124 offset0:46 offset1:47
    ds_read2st64_b32 v[82:83], v124 offset0:48 offset1:49
    ds_read2st64_b32 v[84:85], v124 offset0:50 offset1:51
    ds_read2st64_b32 v[86:87], v124 offset0:52 offset1:53
    ds_read2st64_b32 v[88:89], v124 offset0:54 offset1:55
    ds_read2st64_b32 v[90:91], v124 offset0:56 offset1:57
    ds_read2st64_b32 v[92:93], v124 offset0:58 offset1:59
    ds_read2st64_b32 v[94:95], v124 offset0:60 offset1:61
    ds_read2st64_b32 v[96:97], v124 offset0:62 offset1:63
    ds_read_b32 v98, v124 offset:16384
    v_permlane32_swap_b32 v60, v62
    v_permlane32_swap_b32 v61, v63
    v_permlane32_swap_b32 v64, v66
    v_permlane32_swap_b32 v65, v67
    v_permlane16_swap_b32 v60, v61
    v_permlane16_swap_b32 v62, v63
    v_permlane16_swap_b32 v64, v65
    v_permlane16_swap_b32 v66, v67
    v_pk_mul_f32 v[28:29], v[60:61], v[248:249]
    v_pk_mul_f32 v[32:33], v[64:65], v[248:249]
    v_pk_mul_f32 v[30:31], v[62:63], v[250:251]
    v_pk_mul_f32 v[34:35], v[66:67], v[250:251]
    v_pk_fma_f32 v[28:29], v[64:65], v[252:253], v[28:29] neg_lo:[1,0,0] neg_hi:[1,0,0]
    v_pk_fma_f32 v[32:33], v[60:61], v[252:253], v[32:33]
    v_pk_fma_f32 v[30:31], v[66:67], v[254:255], v[30:31] neg_lo:[1,0,0] neg_hi:[1,0,0]
    v_pk_fma_f32 v[34:35], v[62:63], v[254:255], v[34:35]
    v_cndmask_b32 v36, v68, v69, s[44:45]
    v_cndmask_b32 v36, v36, v70, s[50:51]
    v_cndmask_b32 v36, v36, v71, s[58:59]
    v_mul_f32 v36, 0x35638e39, v36
    v_add_f32 v37, v36, v28
    v_add_f32 v38, v29, v30
    v_add_f32 v37, v37, v31
    v_add_f32 v37, v37, v38
    v_fmamk_f32 v40, v28, 0x3f441b7d, v36
    v_fmamk_f32 v41, v28, 0x3e31d0d4, v36
    v_fmamk_f32 v42, v28, 0xbf000000, v36
    v_fmamk_f32 v43, v28, 0xbf708fb2, v36
    v_fmamk_f32 v40, v29, 0x3e31d0d4, v40
    v_fmamk_f32 v41, v29, 0xbf708fb2, v41
    v_fmamk_f32 v42, v29, 0xbf000000, v42
    v_fmamk_f32 v43, v29, 0x3f441b7d, v43
    v_fmamk_f32 v40, v30, 0xbf000000, v40
    v_fmamk_f32 v41, v30, 0xbf000000, v41
    v_fmamk_f32 v42, v30, 0x3f800000, v42
    v_fmamk_f32 v43, v30, 0xbf000000, v43
    v_fmamk_f32 v40, v31, 0xbf708fb2, v40
    v_fmamk_f32 v41, v31, 0x3f441b7d, v41
    v_fmamk_f32 v42, v31, 0xbf000000, v42
    v_fmamk_f32 v43, v31, 0x3e31d0d4, v43
    v_mul_f32 v44, 0x3f248dbb, v32
    v_mul_f32 v45, 0x3f7c1c5c, v32
    v_mul_f32 v46, 0x3f5db3d7, v32
    v_mul_f32 v47, 0x3eaf1d44, v32
    v_fmamk_f32 v44, v33, 0x3f7c1c5c, v44
    v_fmamk_f32 v45, v33, 0x3eaf1d44, v45
    v_fmamk_f32 v46, v33, 0xbf5db3d7, v46
    v_fmamk_f32 v47, v33, 0xbf248dbb, v47
    v_fmamk_f32 v44, v34, 0x3f5db3d7, v44
    v_fmamk_f32 v45, v34, 0xbf5db3d7, v45
    v_fmamk_f32 v47, v34, 0x3f5db3d7, v47
    v_fmamk_f32 v44, v35, 0x3eaf1d44, v44
    v_fmamk_f32 v45, v35, 0xbf248dbb, v45
    v_fmamk_f32 v46, v35, 0x3f5db3d7, v46
    v_fmamk_f32 v47, v35, 0xbf7c1c5c, v47
    s_waitcnt lgkmcnt(9)
    v_fmac_f32 v18, v37, v72
    v_sub_f32 v50, v40, v44
    v_add_f32 v51, v40, v44
    v_fmac_f32 v19, v50, v73
    v_fmac_f32 v26, v51, v80
    v_sub_f32 v48, v41, v45
    v_add_f32 v49, v41, v45
    v_fmac_f32 v20, v48, v74
    v_fmac_f32 v25, v49, v79
    v_sub_f32 v50, v42, v46
    v_add_f32 v51, v42, v46
    v_fmac_f32 v21, v50, v75
    v_fmac_f32 v24, v51, v78
    v_sub_f32 v48, v43, v47
    v_add_f32 v49, v43, v47
    v_fmac_f32 v22, v48, v76
    v_fmac_f32 v23, v49, v77
    v_cvt_pk_bf16_f32 v60, v18, v19
    v_cvt_pk_bf16_f32 v61, v20, v21
    v_cvt_pk_bf16_f32 v62, v22, v23
    v_cvt_pk_bf16_f32 v63, v24, v25
    v_cvt_pk_bf16_f32 v64, v26, v26
    v_lshlrev_b32 v18, 16, v60
    v_and_b32 v19, s47, v60
    v_lshlrev_b32 v20, 16, v61
    v_and_b32 v21, s47, v61
    v_lshlrev_b32 v22, 16, v62
    v_and_b32 v23, s47, v62
    v_lshlrev_b32 v24, 16, v63
    v_and_b32 v25, s47, v63
    v_lshlrev_b32 v26, 16, v64
    ds_write_b16 v127, v60 offset:0
    ds_write_b16_d16_hi v127, v60 offset:128
    ds_write_b16 v127, v61 offset:256
    ds_write_b16_d16_hi v127, v61 offset:384
    ds_write_b16 v127, v62 offset:512
    ds_write_b16_d16_hi v127, v62 offset:640
    ds_write_b16 v127, v63 offset:768
    ds_write_b16_d16_hi v127, v63 offset:896
    ds_write_b16 v127, v64 offset:1024
    s_add_u32 s52, s49, 10485760
    s_add_u32 s50, s55, 0
    v_add_u32 v2, s50, v109
    v_cmp_eq_u32 s[44:45], 0, v5
    v_add_f32 v56, v18, v19
    v_mul_f32 v57, v18, v18
    v_fmac_f32 v57, v19, v19
    v_add_f32 v56, v56, v20
    v_fmac_f32 v57, v20, v20
    v_add_f32 v56, v56, v21
    v_fmac_f32 v57, v21, v21
    v_add_f32 v56, v56, v22
    v_fmac_f32 v57, v22, v22
    v_add_f32 v56, v56, v23
    v_fmac_f32 v57, v23, v23
    v_add_f32 v56, v56, v24
    v_fmac_f32 v57, v24, v24
    v_add_f32 v56, v56, v25
    v_fmac_f32 v57, v25, v25
    v_add_f32 v56, v56, v26
    v_fmac_f32 v57, v26, v26
    s_nop 0
    v_add_f32_dpp v56, v56, v56 quad_perm:[1,0,3,2] row_mask:0xf bank_mask:0xf
    v_add_f32_dpp v57, v57, v57 quad_perm:[1,0,3,2] row_mask:0xf bank_mask:0xf
    s_nop 0
    v_add_f32_dpp v56, v56, v56 quad_perm:[2,3,0,1] row_mask:0xf bank_mask:0xf
    v_add_f32_dpp v57, v57, v57 quad_perm:[2,3,0,1] row_mask:0xf bank_mask:0xf
    s_nop 0
    v_add_f32_dpp v56, v56, v56 row_half_mirror row_mask:0xf bank_mask:0xf
    v_add_f32_dpp v57, v57, v57 row_half_mirror row_mask:0xf bank_mask:0xf
    s_nop 0
    v_add_f32_dpp v56, v56, v56 row_mirror row_mask:0xf bank_mask:0xf
    v_add_f32_dpp v57, v57, v57 row_mirror row_mask:0xf bank_mask:0xf
    s_mov_b64 exec, s[44:45]
    ds_write_b64 v120, v[56:57] offset:0
    s_mov_b64 exec, -1
    s_waitcnt lgkmcnt(0)
    s_barrier
    ds_read_b128 v[48:51], v119 offset:0
    ds_read_b128 v[52:55], v119 offset:16
    v_mov_b32 v58, 0x3727c5ac
    s_waitcnt lgkmcnt(0)
    s_cmp_lt_u32 s3, 4
    s_cbranch_scc0 f_nox1r
    ds_read_b128 v[28:31], v2 offset:0
    ds_read_b128 v[32:35], v2 offset:1024
    ds_read_b128 v[36:39], v2 offset:4736
    ds_read_b128 v[40:43], v2 offset:5760
f_nox1r:
    v_pk_add_f32 v[48:49], v[48:49], v[50:51]
    v_pk_add_f32 v[52:53], v[52:53], v[54:55]
    v_pk_add_f32 v[48:49], v[48:49], v[52:53]
    v_mul_f32 v56, 0x3ae38e39, v48
    v_fmamk_f32 v57, v49, 0x3ae38e39, v58
    v_fma_f32 v57, -v56, v56, v57
    v_rsq_f32 v57, v57
    s_nop 0
    v_mul_f32 v56, -v56, v57
    v_fma_f32 v18, v18, v57, v56
    v_fma_f32 v19, v19, v57, v56
    v_fma_f32 v20, v20, v57, v56
    v_fma_f32 v21, v21, v57, v56
    v_fma_f32 v22, v22, v57, v56
    v_fma_f32 v23, v23, v57, v56
    v_fma_f32 v24, v24, v57, v56
    v_fma_f32 v25, v25, v57, v56
    v_fma_f32 v26, v26, v57, v56
    s_cmp_lt_u32 s3, 4
    s_cbranch_scc0 f_nox1s
    s_add_u32 s50, s52, 4608
    s_waitcnt lgkmcnt(0)
    buffer_store_dwordx4 v[28:31], v109, s[28:31], s52 offen sc1
    buffer_store_dwordx4 v[36:39], v109, s[28:31], s50 offen sc1
    s_mov_b64 exec, 0xff
    buffer_store_dwordx4 v[32:35], v109, s[28:31], s52 offen offset:1024 sc1
    buffer_store_dwordx4 v[40:43], v109, s[28:31], s50 offen offset:1024 sc1
    s_mov_b64 exec, -1
f_nox1s:
    v_fma_f32 v18, v18, v90, v81
    v_fma_f32 v19, v19, v91, v82
    v_fma_f32 v20, v20, v92, v83
    v_fma_f32 v21, v21, v93, v84
    v_fma_f32 v22, v22, v94, v85
    v_fma_f32 v23, v23, v95, v86
    v_fma_f32 v24, v24, v96, v87
    v_fma_f32 v25, v25, v97, v88
    v_fma_f32 v26, v26, v98, v89
    v_add_f32 v56, v18, v19
    v_mul_f32 v57, v18, v18
    v_fmac_f32 v57, v19, v19
    v_add_f32 v56, v56, v20
    v_fmac_f32 v57, v20, v20
    v_add_f32 v56, v56, v21
    v_fmac_f32 v57, v21, v21
    v_add_f32 v56, v56, v22
    v_fmac_f32 v57, v22, v22
    v_add_f32 v56, v56, v23
    v_fmac_f32 v57, v23, v23
    v_add_f32 v56, v56, v24
    v_fmac_f32 v57, v24, v24
    v_add_f32 v56, v56, v25
    v_fmac_f32 v57, v25, v25
    v_add_f32 v56, v56, v26
    v_fmac_f32 v57, v26, v26
    s_nop 0
    v_add_f32_dpp v56, v56, v56 quad_perm:[1,0,3,2] row_mask:0xf bank_mask:0xf
    v_add_f32_dpp v57, v57, v57 quad_perm:[1,0,3,2] row_mask:0xf bank_mask:0xf
    s_nop 0
    v_add_f32_dpp v56, v56, v56 quad_perm:[2,3,0,1] row_mask:0xf bank_mask:0xf
    v_add_f32_dpp v57, v57, v57 quad_perm:[2,3,0,1] row_mask:0xf bank_mask:0xf
    s_nop 0
    v_add_f32_dpp v56, v56, v56 row_half_mirror row_mask:0xf bank_mask:0xf
    v_add_f32_dpp v57, v57, v57 row_half_mirror row_mask:0xf bank_mask:0xf
    s_nop 0
    v_add_f32_dpp v56, v56, v56 row_mirror row_mask:0xf bank_mask:0xf
    v_add_f32_dpp v57, v57, v57 row_mirror row_mask:0xf bank_mask:0xf
    s_mov_b64 exec, s[44:45]
    ds_write_b64 v120, v[56:57] offset:256
    s_mov_b64 exec, -1
    s_waitcnt lgkmcnt(0)
    s_barrier
    ds_read_b128 v[48:51], v119 offset:256
    ds_read_b128 v[52:55], v119 offset:272
    v_mov_b32 v58, 0x3727c5ac
    s_waitcnt lgkmcnt(0)
    v_pk_add_f32 v[48:49], v[48:49], v[50:51]
    v_pk_add_f32 v[52:53], v[52:53], v[54:55]
    v_pk_add_f32 v[48:49], v[48:49], v[52:53]
    v_mul_f32 v56, 0x3ae38e39, v48
    v_fmamk_f32 v57, v49, 0x3ae38e39, v58
    v_fma_f32 v57, -v56, v56, v57
    v_rsq_f32 v57, v57
    s_nop 0
    v_mul_f32 v56, -v56, v57
    v_fma_f32 v18, v18, v57, v56
    v_fma_f32 v19, v19, v57, v56
    v_fma_f32 v20, v20, v57, v56
    v_fma_f32 v21, v21, v57, v56
    v_fma_f32 v22, v22, v57, v56
    v_fma_f32 v23, v23, v57, v56
    v_fma_f32 v24, v24, v57, v56
    v_fma_f32 v25, v25, v57, v56
    v_fma_f32 v26, v26, v57, v56
    v_mov_b32 v27, 0
    v_permlane16_swap_b32 v18, v19
    v_permlane16_swap_b32 v20, v21
    v_permlane16_swap_b32 v22, v23
    v_permlane16_swap_b32 v24, v25
    v_permlane16_swap_b32 v26, v27
    v_cvt_pk_bf16_f32 v28, v18, v19
    v_cvt_pk_bf16_f32 v29, v20, v21
    v_cvt_pk_bf16_f32 v30, v22, v23
    v_cvt_pk_bf16_f32 v31, v24, v25
    v_cvt_pk_bf16_f32 v32, v26, v27
    v_mov_b32 v33, 0
    v_permlane32_swap_b32 v28, v29
    v_permlane32_swap_b32 v30, v31
    v_permlane32_swap_b32 v32, v33
    s_mul_i32 s50, s38, 1536
    ds_write_b64 v121, v[28:29]
    ds_write_b64 v121, v[30:31] offset:4096
    s_mov_b64 exec, 0xffff
    ds_write_b64 v121, v[32:33] offset:8192
    s_mov_b64 exec, -1
    s_add_u32 s50, s50, 13631488
    v_lshlrev_b32 v2, 4, v0
    v_add_u32 v3, 8192, v2
    v_add_u32 v4, 8192, v109
    s_waitcnt lgkmcnt(0)
    s_barrier
    s_cmp_lt_u32 s3, 4
    s_cbranch_scc1 f_plb_done3
    s_cmp_lt_u32 s2, 216
    s_cbranch_scc0 f_plb13
    s_mov_b32 m0, s24
    s_nop 0
    buffer_load_dwordx4 v9, s[32:35], s60 offen offset:0 lds
    s_add_u32 s25, s60, 35840
    buffer_load_dwordx4 v9, s[32:35], s25 offen offset:1024 lds
    s_add_u32 s26, s60, 71680
    buffer_load_dwordx4 v10, s[32:35], s26 offen offset:2048 lds
    s_add_u32 s27, s60, 107520
    buffer_load_dwordx4 v10, s[32:35], s27 offen offset:3072 lds
    s_add_u32 s60, s60, 589824
    s_add_u32 s24, s24, 16384
    s_mov_b32 m0, s24
    s_nop 0
    buffer_load_dwordx4 v9, s[32:35], s60 offen offset:0 lds
    s_add_u32 s25, s60, 35840
    buffer_load_dwordx4 v9, s[32:35], s25 offen offset:1024 lds
    s_add_u32 s26, s60, 71680
    buffer_load_dwordx4 v10, s[32:35], s26 offen offset:2048 lds
    s_add_u32 s27, s60, 107520
    buffer_load_dwordx4 v10, s[32:35], s27 offen offset:3072 lds
    s_add_u32 s60, s60, 589824
    s_add_u32 s24, s24, 16384
f_plb13:
f_plb_done3:
    s_cmp_lt_u32 s3, 4
    s_cbranch_scc0 f_h2none
    ds_read_b128 v[28:31], v2 offset:17920
    ds_read_b128 v[32:35], v3 offset:13824
    s_cmp_eq_u32 s3, 1
    s_cbranch_scc0 f_h2one
    ds_read_b128 v[36:39], v4 offset:17920
    s_waitcnt lgkmcnt(0)
    buffer_store_dwordx4 v[36:39], v123, s[28:31], s50 offen sc1
f_h2one:
    s_waitcnt lgkmcnt(1)
    buffer_store_dwordx4 v[28:31], v122, s[28:31], s50 offen sc1
    s_waitcnt lgkmcnt(0)
    buffer_store_dwordx4 v[32:35], v118, s[28:31], s50 offen sc1
    s_waitcnt vmcnt(0)
f_h2none:
    v_mov_b32 v3, 1
    s_lshl_b32 s50, s38, 10
    s_add_u32 s50, s50, 262400
    s_barrier
    s_cmp_eq_u32 s3, 0
    s_cbranch_scc0 t_noflag
    s_mov_b64 exec, 1
    buffer_store_dword v3, off, s[28:31], s50 sc1
    s_mov_b64 exec, -1
t_noflag:
    s_cmp_ge_u32 s2, 216
    s_cbranch_scc1 t_spare
    s_cmp_lt_u32 s3, 4
    s_cbranch_scc1 t_cons
    s_mul_i32 s4, s39, 3072
    s_add_u32 m0, s4, 12288
    s_nop 0
    buffer_load_dwordx4 v14, s[28:31], s61 offen offset:0 lds
    buffer_load_dwordx4 v14, s[28:31], s61 offen offset:1024 lds
    buffer_load_dwordx4 v14, s[28:31], s61 offen offset:2048 lds
    s_add_u32 m0, s4, 24576
    s_add_u32 s25, s61, 12288
    buffer_load_dwordx4 v14, s[28:31], s25 offen offset:0 lds
    buffer_load_dwordx4 v14, s[28:31], s25 offen offset:1024 lds
    buffer_load_dwordx4 v14, s[28:31], s25 offen offset:2048 lds
    s_add_u32 m0, s4, 36864
    s_add_u32 s25, s61, 24576
    buffer_load_dwordx4 v14, s[28:31], s25 offen offset:0 lds
    buffer_load_dwordx4 v14, s[28:31], s25 offen offset:1024 lds
    buffer_load_dwordx4 v14, s[28:31], s25 offen offset:2048 lds
    s_add_u32 m0, s4, 49152
    s_add_u32 s25, s61, 36864
    buffer_load_dwordx4 v14, s[28:31], s25 offen offset:0 lds
    buffer_load_dwordx4 v14, s[28:31], s25 offen offset:1024 lds
    buffer_load_dwordx4 v14, s[28:31], s25 offen offset:2048 lds
    v_lshrrev_b32 v2, 1, v1
    v_lshlrev_b32 v2, 13, v2
    v_and_b32 v3, 1, v1
    v_lshl_add_u32 v2, v3, 10, v2
    s_lshl_b32 s50, s39, 11
    s_add_u32 s50, s50, 262400
    s_mul_i32 s4, s39, 3072
    s_sub_u32 s24, s24, 98304
    v_add_u32 v18, s24, v14
    v_add_u32 v19, 65536, v18
    s_mov_b64 s[54:55], 0
    s_mov_b32 s56, 16
    v_add_u32 v16, s4, v14
    s_waitcnt vmcnt(9) lgkmcnt(0)
    s_mov_b32 s51, 0
val_6:
    ds_read_b128 v[24:27], v16 offset:12288
    ds_read_b128 v[28:31], v16 offset:13312
    ds_read_b128 v[32:35], v16 offset:14336
    s_waitcnt lgkmcnt(2)
    v_max3_u32 v24, v24, v25, v26
    v_max_u32 v24, v24, v27
    s_waitcnt lgkmcnt(1)
    v_max3_u32 v28, v28, v29, v30
    v_max3_u32 v28, v28, v31, v24
    s_waitcnt lgkmcnt(0)
    v_max3_u32 v32, v32, v33, v34
    v_max3_u32 v32, v32, v35, v28
    v_cmp_eq_u32 vcc, -1, v32
    s_nop 0
    s_and_b64 exec, vcc, vcc
    s_cbranch_scc0 val_6_ok
    s_cmp_lt_u32 s51, 30000
    s_cbranch_scc0 val_6_ok
    s_cmp_eq_u32 s51, 0
    s_cbranch_scc1 val_6_ns
    s_sleep 2
val_6_ns:
    s_add_u32 s51, s51, 1
    s_add_u32 m0, s4, 12288
    s_nop 0
    buffer_load_dwordx4 v14, s[28:31], s61 offen offset:0 sc1 lds
    buffer_load_dwordx4 v14, s[28:31], s61 offen offset:1024 sc1 lds
    buffer_load_dwordx4 v14, s[28:31], s61 offen offset:2048 sc1 lds
    s_mov_b64 exec, -1
    s_waitcnt vmcnt(0)
    s_branch val_6
val_6_ok:
    s_mov_b64 exec, -1
    s_barrier
    s_add_u32 m0, s4, 0
    s_add_u32 s25, s61, 49152
    buffer_load_dwordx4 v14, s[28:31], s25 offen offset:0 lds
    buffer_load_dwordx4 v14, s[28:31], s25 offen offset:1024 lds
    buffer_load_dwordx4 v14, s[28:31], s25 offen offset:2048 lds
    s_waitcnt vmcnt(9) lgkmcnt(0)
    s_mov_b32 s51, 0
val_7:
    ds_read_b128 v[24:27], v16 offset:24576
    ds_read_b128 v[28:31], v16 offset:25600
    ds_read_b128 v[32:35], v16 offset:26624
    s_waitcnt lgkmcnt(2)
    v_max3_u32 v24, v24, v25, v26
    v_max_u32 v24, v24, v27
    s_waitcnt lgkmcnt(1)
    v_max3_u32 v28, v28, v29, v30
    v_max3_u32 v28, v28, v31, v24
    s_waitcnt lgkmcnt(0)
    v_max3_u32 v32, v32, v33, v34
    v_max3_u32 v32, v32, v35, v28
    v_cmp_eq_u32 vcc, -1, v32
    s_nop 0
    s_and_b64 exec, vcc, vcc
    s_cbranch_scc0 val_7_ok
    s_cmp_lt_u32 s51, 30000
    s_cbranch_scc0 val_7_ok
    s_cmp_eq_u32 s51, 0
    s_cbranch_scc1 val_7_ns
    s_sleep 2
val_7_ns:
    s_add_u32 s51, s51, 1
    s_add_u32 m0, s4, 24576
    s_add_u32 s25, s61, 12288
    buffer_load_dwordx4 v14, s[28:31], s25 offen offset:0 sc1 lds
    buffer_load_dwordx4 v14, s[28:31], s25 offen offset:1024 sc1 lds
    buffer_load_dwordx4 v14, s[28:31], s25 offen offset:2048 sc1 lds
    s_mov_b64 exec, -1
    s_waitcnt vmcnt(0)
    s_branch val_7
val_7_ok:
    s_mov_b64 exec, -1
    s_barrier
    s_add_u32 m0, s24, 0
    s_nop 0
    buffer_load_dwordx4 v9, s[32:35], s60 offen offset:0 lds
    s_add_u32 s45, s60, 35840
    buffer_load_dwordx4 v9, s[32:35], s45 offen offset:1024 lds
    s_add_u32 s46, s60, 71680
    buffer_load_dwordx4 v10, s[32:35], s46 offen offset:2048 lds
    s_add_u32 s44, s60, 107520
    buffer_load_dwordx4 v10, s[32:35], s44 offen offset:3072 lds
    s_add_u32 m0, s4, 12288
    s_add_u32 s25, s61, 61440
    buffer_load_dwordx4 v14, s[28:31], s25 offen offset:0 lds
    buffer_load_dwordx4 v14, s[28:31], s25 offen offset:1024 lds
    buffer_load_dwordx4 v14, s[28:31], s25 offen offset:2048 lds
    s_waitcnt vmcnt(13) lgkmcnt(0)
    s_mov_b32 s51, 0
val_8:
    ds_read_b128 v[24:27], v16 offset:36864
    ds_read_b128 v[28:31], v16 offset:37888
    ds_read_b128 v[32:35], v16 offset:38912
    s_waitcnt lgkmcnt(2)
    v_max3_u32 v24, v24, v25, v26
    v_max_u32 v24, v24, v27
    s_waitcnt lgkmcnt(1)
    v_max3_u32 v28, v28, v29, v30
    v_max3_u32 v28, v28, v31, v24
    s_waitcnt lgkmcnt(0)
    v_max3_u32 v32, v32, v33, v34
    v_max3_u32 v32, v32, v35, v28
    v_cmp_eq_u32 vcc, -1, v32
    s_nop 0
    s_and_b64 exec, vcc, vcc
    s_cbranch_scc0 val_8_ok
    s_cmp_lt_u32 s51, 30000
    s_cbranch_scc0 val_8_ok
    s_cmp_eq_u32 s51, 0
    s_cbranch_scc1 val_8_ns
    s_sleep 2
val_8_ns:
    s_add_u32 s51, s51, 1
    s_add_u32 m0, s4, 36864
    s_add_u32 s25, s61, 24576
    buffer_load_dwordx4 v14, s[28:31], s25 offen offset:0 sc1 lds
    buffer_load_dwordx4 v14, s[28:31], s25 offen offset:1024 sc1 lds
    buffer_load_dwordx4 v14, s[28:31], s25 offen offset:2048 sc1 lds
    s_mov_b64 exec, -1
    s_waitcnt vmcnt(0)
    s_branch val_8
val_8_ok:
    s_mov_b64 exec, -1
    s_barrier
    s_add_u32 m0, s24, 16384
    s_add_u32 s44, s60, 589824
    buffer_load_dwordx4 v9, s[32:35], s44 offen offset:0 lds
    s_add_u32 s45, s60, 625664
    buffer_load_dwordx4 v9, s[32:35], s45 offen offset:1024 lds
    s_add_u32 s46, s60, 661504
    buffer_load_dwordx4 v10, s[32:35], s46 offen offset:2048 lds
    s_add_u32 s44, s60, 697344
    buffer_load_dwordx4 v10, s[32:35], s44 offen offset:3072 lds
    s_add_u32 m0, s4, 24576
    s_add_u32 s25, s61, 73728
    buffer_load_dwordx4 v14, s[28:31], s25 offen offset:0 lds
    buffer_load_dwordx4 v14, s[28:31], s25 offen offset:1024 lds
    buffer_load_dwordx4 v14, s[28:31], s25 offen offset:2048 lds
    s_waitcnt vmcnt(17) lgkmcnt(0)
    s_mov_b32 s51, 0
val_9:
    ds_read_b128 v[24:27], v16 offset:49152
    ds_read_b128 v[28:31], v16 offset:50176
    ds_read_b128 v[32:35], v16 offset:51200
    s_waitcnt lgkmcnt(2)
    v_max3_u32 v24, v24, v25, v26
    v_max_u32 v24, v24, v27
    s_waitcnt lgkmcnt(1)
    v_max3_u32 v28, v28, v29, v30
    v_max3_u32 v28, v28, v31, v24
    s_waitcnt lgkmcnt(0)
    v_max3_u32 v32, v32, v33, v34
    v_max3_u32 v32, v32, v35, v28
    v_cmp_eq_u32 vcc, -1, v32
    s_nop 0
    s_and_b64 exec, vcc, vcc
    s_cbranch_scc0 val_9_ok
    s_cmp_lt_u32 s51, 30000
    s_cbranch_scc0 val_9_ok
    s_cmp_eq_u32 s51, 0
    s_cbranch_scc1 val_9_ns
    s_sleep 2
val_9_ns:
    s_add_u32 s51, s51, 1
    s_add_u32 m0, s4, 49152
    s_add_u32 s25, s61, 36864
    buffer_load_dwordx4 v14, s[28:31], s25 offen offset:0 sc1 lds
    buffer_load_dwordx4 v14, s[28:31], s25 offen offset:1024 sc1 lds
    buffer_load_dwordx4 v14, s[28:31], s25 offen offset:2048 sc1 lds
    s_mov_b64 exec, -1
    s_waitcnt vmcnt(0)
    s_branch val_9
val_9_ok:
    s_mov_b64 exec, -1
    s_barrier
    buffer_load_dword v3, v2, s[28:31], s50 offen sc1
    s_add_u32 m0, s24, 32768
    s_add_u32 s44, s60, 1179648
    buffer_load_dwordx4 v9, s[32:35], s44 offen offset:0 lds
    s_add_u32 s45, s60, 1215488
    buffer_load_dwordx4 v9, s[32:35], s45 offen offset:1024 lds
    s_add_u32 s46, s60, 1251328
    buffer_load_dwordx4 v10, s[32:35], s46 offen offset:2048 lds
    s_add_u32 s44, s60, 1287168
    buffer_load_dwordx4 v10, s[32:35], s44 offen offset:3072 lds
    s_add_u32 m0, s4, 36864
    s_add_u32 s25, s61, 86016
    buffer_load_dwordx4 v14, s[28:31], s25 offen offset:0 lds
    buffer_load_dwordx4 v14, s[28:31], s25 offen offset:1024 lds
    buffer_load_dwordx4 v14, s[28:31], s25 offen offset:2048 lds
    s_waitcnt vmcnt(22) lgkmcnt(0)
    s_mov_b32 s51, 0
val_10:
    ds_read_b128 v[24:27], v16 offset:0
    ds_read_b128 v[28:31], v16 offset:1024
    ds_read_b128 v[32:35], v16 offset:2048
    s_waitcnt lgkmcnt(2)
    v_max3_u32 v24, v24, v25, v26
    v_max_u32 v24, v24, v27
    s_waitcnt lgkmcnt(1)
    v_max3_u32 v28, v28, v29, v30
    v_max3_u32 v28, v28, v31, v24
    s_waitcnt lgkmcnt(0)
    v_max3_u32 v32, v32, v33, v34
    v_max3_u32 v32, v32, v35, v28
    v_cmp_eq_u32 vcc, -1, v32
    s_nop 0
    s_and_b64 exec, vcc, vcc
    s_cbranch_scc0 val_10_ok
    s_cmp_lt_u32 s51, 30000
    s_cbranch_scc0 val_10_ok
    s_cmp_eq_u32 s51, 0
    s_cbranch_scc1 val_10_ns
    s_sleep 2
val_10_ns:
    s_add_u32 s51, s51, 1
    s_add_u32 m0, s4, 0
    s_add_u32 s25, s61, 49152
    buffer_load_dwordx4 v14, s[28:31], s25 offen offset:0 sc1 lds
    buffer_load_dwordx4 v14, s[28:31], s25 offen offset:1024 sc1 lds
    buffer_load_dwordx4 v14, s[28:31], s25 offen offset:2048 sc1 lds
    s_mov_b64 exec, -1
    s_waitcnt vmcnt(0)
    s_branch val_10
val_10_ok:
    s_mov_b64 exec, -1
    s_barrier
    s_add_u32 m0, s24, 49152
    s_add_u32 s44, s60, 1769472
    buffer_load_dwordx4 v9, s[32:35], s44 offen offset:0 lds
    s_add_u32 s45, s60, 1805312
    buffer_load_dwordx4 v9, s[32:35], s45 offen offset:1024 lds
    s_add_u32 s46, s60, 1841152
    buffer_load_dwordx4 v10, s[32:35], s46 offen offset:2048 lds
    s_add_u32 s44, s60, 1876992
    buffer_load_dwordx4 v10, s[32:35], s44 offen offset:3072 lds
    s_waitcnt vmcnt(11)
    v_cmp_ne_u32 vcc, 0, v3
    s_nop 0
    s_lshr_b64 s[54:55], vcc, s56
    s_andn2_b64 exec, 0xffff, vcc
    s_cbranch_scc0 g1_skipped_ok
    s_mov_b32 s51, 0
g1_skipped:
    buffer_load_dword v3, v2, s[28:31], s50 offen offset:0 sc1
    s_add_u32 s51, s51, 1
    s_waitcnt vmcnt(0)
    v_cmp_eq_u32 vcc, 0, v3
    s_nop 0
    s_and_b64 exec, vcc, vcc
    s_cbranch_scc0 g1_skipped_ok
    s_sleep 2
    s_cmp_lt_u32 s51, 30000
    s_cbranch_scc1 g1_skipped
g1_skipped_ok:
    s_mov_b64 exec, -1
    s_and_b32 s25, s54, 3
    s_cmp_eq_u32 s25, 3
    s_cbranch_scc1 chk_11_ok
    s_mov_b32 s51, 0
chk_11:
    buffer_load_dword v3, v2, s[28:31], s50 offen sc1
    s_add_u32 s51, s51, 1
    s_mov_b64 exec, -1
    s_waitcnt vmcnt(0)
    v_cmp_ne_u32 vcc, 0, v3
    s_nop 0
    s_lshr_b64 s[54:55], vcc, s56
    s_and_b32 s25, s54, 3
    s_cmp_eq_u32 s25, 3
    s_cbranch_scc1 chk_11_ok
    s_sleep 1
    s_lshl_b64 exec, 0xff, s56
    s_cmp_lt_u32 s51, 30000
    s_cbranch_scc1 chk_11
    s_mov_b64 exec, -1
chk_11_ok:
    s_lshr_b64 s[54:55], s[54:55], 2
    s_add_u32 s56, s56, 2
    s_add_u32 m0, s4, 49152
    s_add_u32 s25, s61, 98304
    buffer_load_dwordx4 v14, s[28:31], s25 offen offset:0 lds
    buffer_load_dwordx4 v14, s[28:31], s25 offen offset:1024 lds
    buffer_load_dwordx4 v14, s[28:31], s25 offen offset:2048 lds
    s_waitcnt vmcnt(22) lgkmcnt(0)
    s_mov_b32 s51, 0
val_12:
    ds_read_b128 v[24:27], v16 offset:12288
    ds_read_b128 v[28:31], v16 offset:13312
    ds_read_b128 v[32:35], v16 offset:14336
    s_waitcnt lgkmcnt(2)
    v_max3_u32 v24, v24, v25, v26
    v_max_u32 v24, v24, v27
    s_waitcnt lgkmcnt(1)
    v_max3_u32 v28, v28, v29, v30
    v_max3_u32 v28, v28, v31, v24
    s_waitcnt lgkmcnt(0)
    v_max3_u32 v32, v32, v33, v34
    v_max3_u32 v32, v32, v35, v28
    v_cmp_eq_u32 vcc, -1, v32
    s_nop 0
    s_and_b64 exec, vcc, vcc
    s_cbranch_scc0 val_12_ok
    s_cmp_lt_u32 s51, 30000
    s_cbranch_scc0 val_12_ok
    s_cmp_eq_u32 s51, 0
    s_cbranch_scc1 val_12_ns
    s_sleep 2
val_12_ns:
    s_add_u32 s51, s51, 1
    s_add_u32 m0, s4, 12288
    s_add_u32 s25, s61, 61440
    buffer_load_dwordx4 v14, s[28:31], s25 offen offset:0 sc1 lds
    buffer_load_dwordx4 v14, s[28:31], s25 offen offset:1024 sc1 lds
    buffer_load_dwordx4 v14, s[28:31], s25 offen offset:2048 sc1 lds
    s_mov_b64 exec, -1
    s_waitcnt vmcnt(0)
    s_branch val_12
val_12_ok:
    s_mov_b64 exec, -1
    s_barrier
    s_add_u32 m0, s24, 65536
    s_add_u32 s44, s60, 2359296
    buffer_load_dwordx4 v9, s[32:35], s44 offen offset:0 lds
    s_add_u32 s45, s60, 2395136
    buffer_load_dwordx4 v9, s[32:35], s45 offen offset:1024 lds
    s_add_u32 s46, s60, 2430976
    buffer_load_dwordx4 v10, s[32:35], s46 offen offset:2048 lds
    s_add_u32 s44, s60, 2466816
    buffer_load_dwordx4 v10, s[32:35], s44 offen offset:3072 lds
    s_and_b32 s25, s54, 3
    s_cmp_eq_u32 s25, 3
    s_cbranch_scc1 chk_13_ok
    s_mov_b32 s51, 0
chk_13:
    buffer_load_dword v3, v2, s[28:31], s50 offen sc1
    s_add_u32 s51, s51, 1
    s_mov_b64 exec, -1
    s_waitcnt vmcnt(0)
    v_cmp_ne_u32 vcc, 0, v3
    s_nop 0
    s_lshr_b64 s[54:55], vcc, s56
    s_and_b32 s25, s54, 3
    s_cmp_eq_u32 s25, 3
    s_cbranch_scc1 chk_13_ok
    s_sleep 1
    s_lshl_b64 exec, 0xff, s56
    s_cmp_lt_u32 s51, 30000
    s_cbranch_scc1 chk_13
    s_mov_b64 exec, -1
chk_13_ok:
    s_lshr_b64 s[54:55], s[54:55], 2
    s_add_u32 s56, s56, 2
    s_add_u32 m0, s4, 0
    s_add_u32 s25, s61, 110592
    buffer_load_dwordx4 v14, s[28:31], s25 offen offset:0 lds
    buffer_load_dwordx4 v14, s[28:31], s25 offen offset:1024 lds
    buffer_load_dwordx4 v14, s[28:31], s25 offen offset:2048 lds
    s_waitcnt vmcnt(22) lgkmcnt(0)
    s_mov_b32 s51, 0
val_14:
    ds_read_b128 v[24:27], v16 offset:24576
    ds_read_b128 v[28:31], v16 offset:25600
    ds_read_b128 v[32:35], v16 offset:26624
    s_waitcnt lgkmcnt(2)
    v_max3_u32 v24, v24, v25, v26
    v_max_u32 v24, v24, v27
    s_waitcnt lgkmcnt(1)
    v_max3_u32 v28, v28, v29, v30
    v_max3_u32 v28, v28, v31, v24
    s_waitcnt lgkmcnt(0)
    v_max3_u32 v32, v32, v33, v34
    v_max3_u32 v32, v32, v35, v28
    v_cmp_eq_u32 vcc, -1, v32
    s_nop 0
    s_and_b64 exec, vcc, vcc
    s_cbranch_scc0 val_14_ok
    s_cmp_lt_u32 s51, 30000
    s_cbranch_scc0 val_14_ok
    s_cmp_eq_u32 s51, 0
    s_cbranch_scc1 val_14_ns
    s_sleep 2
val_14_ns:
    s_add_u32 s51, s51, 1
    s_add_u32 m0, s4, 24576
    s_add_u32 s25, s61, 73728
    buffer_load_dwordx4 v14, s[28:31], s25 offen offset:0 sc1 lds
    buffer_load_dwordx4 v14, s[28:31], s25 offen offset:1024 sc1 lds
    buffer_load_dwordx4 v14, s[28:31], s25 offen offset:2048 sc1 lds
    s_mov_b64 exec, -1
    s_waitcnt vmcnt(0)
    s_branch val_14
val_14_ok:
    s_mov_b64 exec, -1
    s_barrier
    s_add_u32 m0, s24, 81920
    s_add_u32 s44, s60, 2949120
    buffer_load_dwordx4 v9, s[32:35], s44 offen offset:0 lds
    s_add_u32 s45, s60, 2984960
    buffer_load_dwordx4 v9, s[32:35], s45 offen offset:1024 lds
    s_add_u32 s46, s60, 3020800
    buffer_load_dwordx4 v10, s[32:35], s46 offen offset:2048 lds
    s_add_u32 s44, s60, 3056640
    buffer_load_dwordx4 v10, s[32:35], s44 offen offset:3072 lds
    s_and_b32 s25, s54, 3
    s_cmp_eq_u32 s25, 3
    s_cbranch_scc1 chk_15_ok
    s_mov_b32 s51, 0
chk_15:
    buffer_load_dword v3, v2, s[28:31], s50 offen sc1
    s_add_u32 s51, s51, 1
    s_mov_b64 exec, -1
    s_waitcnt vmcnt(0)
    v_cmp_ne_u32 vcc, 0, v3
    s_nop 0
    s_lshr_b64 s[54:55], vcc, s56
    s_and_b32 s25, s54, 3
    s_cmp_eq_u32 s25, 3
    s_cbranch_scc1 chk_15_ok
    s_sleep 1
    s_lshl_b64 exec, 0xff, s56
    s_cmp_lt_u32 s51, 30000
    s_cbranch_scc1 chk_15
    s_mov_b64 exec, -1
chk_15_ok:
    s_lshr_b64 s[54:55], s[54:55], 2
    s_add_u32 s56, s56, 2
    s_add_u32 m0, s4, 12288
    s_add_u32 s25, s61, 122880
    buffer_load_dwordx4 v14, s[28:31], s25 offen offset:0 lds
    buffer_load_dwordx4 v14, s[28:31], s25 offen offset:1024 lds
    buffer_load_dwordx4 v14, s[28:31], s25 offen offset:2048 lds
    s_waitcnt vmcnt(21) lgkmcnt(0)
    s_mov_b32 s51, 0
val_16:
    ds_read_b128 v[24:27], v16 offset:36864
    ds_read_b128 v[28:31], v16 offset:37888
    ds_read_b128 v[32:35], v16 offset:38912
    s_waitcnt lgkmcnt(2)
    v_max3_u32 v24, v24, v25, v26
    v_max_u32 v24, v24, v27
    s_waitcnt lgkmcnt(1)
    v_max3_u32 v28, v28, v29, v30
    v_max3_u32 v28, v28, v31, v24
    s_waitcnt lgkmcnt(0)
    v_max3_u32 v32, v32, v33, v34
    v_max3_u32 v32, v32, v35, v28
    v_cmp_eq_u32 vcc, -1, v32
    s_nop 0
    s_and_b64 exec, vcc, vcc
    s_cbranch_scc0 val_16_ok
    s_cmp_lt_u32 s51, 30000
    s_cbranch_scc0 val_16_ok
    s_cmp_eq_u32 s51, 0
    s_cbranch_scc1 val_16_ns
    s_sleep 2
val_16_ns:
    s_add_u32 s51, s51, 1
    s_add_u32 m0, s4, 36864
    s_add_u32 s25, s61, 86016
    buffer_load_dwordx4 v14, s[28:31], s25 offen offset:0 sc1 lds
    buffer_load_dwordx4 v14, s[28:31], s25 offen offset:1024 sc1 lds
    buffer_load_dwordx4 v14, s[28:31], s25 offen offset:2048 sc1 lds
    s_mov_b64 exec, -1
    s_waitcnt vmcnt(0)
    s_branch val_16
val_16_ok:
    s_mov_b64 exec, -1
    s_barrier
    s_add_u32 m0, s24, 0
    s_add_u32 s44, s60, 3538944
    buffer_load_dwordx4 v9, s[32:35], s44 offen offset:0 lds
    s_add_u32 s45, s60, 3574784
    buffer_load_dwordx4 v9, s[32:35], s45 offen offset:1024 lds
    s_add_u32 s46, s60, 3610624
    buffer_load_dwordx4 v10, s[32:35], s46 offen offset:2048 lds
    s_add_u32 s44, s60, 3646464
    buffer_load_dwordx4 v10, s[32:35], s44 offen offset:3072 lds
    s_and_b32 s25, s54, 3
    s_cmp_eq_u32 s25, 3
    s_cbranch_scc1 chk_17_ok
    s_mov_b32 s51, 0
chk_17:
    buffer_load_dword v3, v2, s[28:31], s50 offen sc1
    s_add_u32 s51, s51, 1
    s_mov_b64 exec, -1
    s_waitcnt vmcnt(0)
    v_cmp_ne_u32 vcc, 0, v3
    s_nop 0
    s_lshr_b64 s[54:55], vcc, s56
    s_and_b32 s25, s54, 3
    s_cmp_eq_u32 s25, 3
    s_cbranch_scc1 chk_17_ok
    s_sleep 1
    s_lshl_b64 exec, 0xff, s56
    s_cmp_lt_u32 s51, 30000
    s_cbranch_scc1 chk_17
    s_mov_b64 exec, -1
chk_17_ok:
    s_lshr_b64 s[54:55], s[54:55], 2
    s_add_u32 s56, s56, 2
    s_add_u32 m0, s4, 24576
    s_add_u32 s25, s61, 135168
    buffer_load_dwordx4 v14, s[28:31], s25 offen offset:0 lds
    buffer_load_dwordx4 v14, s[28:31], s25 offen offset:1024 lds
    buffer_load_dwordx4 v14, s[28:31], s25 offen offset:2048 lds
    s_waitcnt vmcnt(21) lgkmcnt(0)
    s_barrier
    s_add_u32 m0, s24, 16384
    s_add_u32 s44, s60, 4128768
    buffer_load_dwordx4 v9, s[32:35], s44 offen offset:0 lds
    s_add_u32 s45, s60, 4164608
    buffer_load_dwordx4 v9, s[32:35], s45 offen offset:1024 lds
    s_add_u32 s46, s60, 4200448
    buffer_load_dwordx4 v10, s[32:35], s46 offen offset:2048 lds
    s_add_u32 s44, s60, 4236288
    buffer_load_dwordx4 v10, s[32:35], s44 offen offset:3072 lds
    s_and_b32 s25, s54, 3
    s_cmp_eq_u32 s25, 3
    s_cbranch_scc1 chk_18_ok
    s_mov_b32 s51, 0
chk_18:
    buffer_load_dword v3, v2, s[28:31], s50 offen sc1
    s_add_u32 s51, s51, 1
    s_mov_b64 exec, -1
    s_waitcnt vmcnt(0)
    v_cmp_ne_u32 vcc, 0, v3
    s_nop 0
    s_lshr_b64 s[54:55], vcc, s56
    s_and_b32 s25, s54, 3
    s_cmp_eq_u32 s25, 3
    s_cbranch_scc1 chk_18_ok
    s_sleep 1
    s_lshl_b64 exec, 0xff, s56
    s_cmp_lt_u32 s51, 30000
    s_cbranch_scc1 chk_18
    s_mov_b64 exec, -1
chk_18_ok:
    s_lshr_b64 s[54:55], s[54:55], 2
    s_add_u32 s56, s56, 2
    s_add_u32 m0, s4, 36864
    s_add_u32 s25, s61, 147456
    buffer_load_dwordx4 v14, s[28:31], s25 offen offset:0 lds
    buffer_load_dwordx4 v14, s[28:31], s25 offen offset:1024 lds
    buffer_load_dwordx4 v14, s[28:31], s25 offen offset:2048 lds
    s_waitcnt vmcnt(21) lgkmcnt(0)
    s_barrier
    s_add_u32 m0, s24, 32768
    s_add_u32 s44, s60, 4718592
    buffer_load_dwordx4 v9, s[32:35], s44 offen offset:0 lds
    s_add_u32 s45, s60, 4754432
    buffer_load_dwordx4 v9, s[32:35], s45 offen offset:1024 lds
    s_add_u32 s46, s60, 4790272
    buffer_load_dwordx4 v10, s[32:35], s46 offen offset:2048 lds
    s_add_u32 s44, s60, 4826112
    buffer_load_dwordx4 v10, s[32:35], s44 offen offset:3072 lds
    s_and_b32 s25, s54, 3
    s_cmp_eq_u32 s25, 3
    s_cbranch_scc1 chk_19_ok
    s_mov_b32 s51, 0
chk_19:
    buffer_load_dword v3, v2, s[28:31], s50 offen sc1
    s_add_u32 s51, s51, 1
    s_mov_b64 exec, -1
    s_waitcnt vmcnt(0)
    v_cmp_ne_u32 vcc, 0, v3
    s_nop 0
    s_lshr_b64 s[54:55], vcc, s56
    s_and_b32 s25, s54, 3
    s_cmp_eq_u32 s25, 3
    s_cbranch_scc1 chk_19_ok
    s_sleep 1
    s_lshl_b64 exec, 0xff, s56
    s_cmp_lt_u32 s51, 30000
    s_cbranch_scc1 chk_19
    s_mov_b64 exec, -1
chk_19_ok:
    s_lshr_b64 s[54:55], s[54:55], 2
    s_add_u32 s56, s56, 2
    s_add_u32 m0, s4, 49152
    s_add_u32 s25, s61, 159744
    buffer_load_dwordx4 v14, s[28:31], s25 offen offset:0 lds
    buffer_load_dwordx4 v14, s[28:31], s25 offen offset:1024 lds
    buffer_load_dwordx4 v14, s[28:31], s25 offen offset:2048 lds
    s_waitcnt vmcnt(21) lgkmcnt(0)
    s_barrier
    s_add_u32 m0, s24, 49152
    s_add_u32 s44, s60, 5308416
    buffer_load_dwordx4 v9, s[32:35], s44 offen offset:0 lds
    s_add_u32 s45, s60, 5344256
    buffer_load_dwordx4 v9, s[32:35], s45 offen offset:1024 lds
    s_add_u32 s46, s60, 5380096
    buffer_load_dwordx4 v10, s[32:35], s46 offen offset:2048 lds
    s_add_u32 s44, s60, 5415936
    buffer_load_dwordx4 v10, s[32:35], s44 offen offset:3072 lds
    s_and_b32 s25, s54, 3
    s_cmp_eq_u32 s25, 3
    s_cbranch_scc1 chk_20_ok
    s_mov_b32 s51, 0
chk_20:
    buffer_load_dword v3, v2, s[28:31], s50 offen sc1
    s_add_u32 s51, s51, 1
    s_mov_b64 exec, -1
    s_waitcnt vmcnt(0)
    v_cmp_ne_u32 vcc, 0, v3
    s_nop 0
    s_lshr_b64 s[54:55], vcc, s56
    s_and_b32 s25, s54, 3
    s_cmp_eq_u32 s25, 3
    s_cbranch_scc1 chk_20_ok
    s_sleep 1
    s_lshl_b64 exec, 0xff, s56
    s_cmp_lt_u32 s51, 30000
    s_cbranch_scc1 chk_20
    s_mov_b64 exec, -1
chk_20_ok:
    s_lshr_b64 s[54:55], s[54:55], 2
    s_add_u32 s56, s56, 2
    s_add_u32 m0, s4, 0
    s_add_u32 s25, s61, 172032
    buffer_load_dwordx4 v14, s[28:31], s25 offen offset:0 lds
    buffer_load_dwordx4 v14, s[28:31], s25 offen offset:1024 lds
    buffer_load_dwordx4 v14, s[28:31], s25 offen offset:2048 lds
    s_waitcnt vmcnt(21) lgkmcnt(0)
    s_barrier
    s_add_u32 m0, s24, 65536
    s_add_u32 s44, s60, 5898240
    buffer_load_dwordx4 v9, s[32:35], s44 offen offset:0 lds
    s_add_u32 s45, s60, 5934080
    buffer_load_dwordx4 v9, s[32:35], s45 offen offset:1024 lds
    s_add_u32 s46, s60, 5969920
    buffer_load_dwordx4 v10, s[32:35], s46 offen offset:2048 lds
    s_add_u32 s44, s60, 6005760
    buffer_load_dwordx4 v10, s[32:35], s44 offen offset:3072 lds
    s_and_b32 s25, s54, 3
    s_cmp_eq_u32 s25, 3
    s_cbranch_scc1 chk_21_ok
    s_mov_b32 s51, 0
chk_21:
    buffer_load_dword v3, v2, s[28:31], s50 offen sc1
    s_add_u32 s51, s51, 1
    s_mov_b64 exec, -1
    s_waitcnt vmcnt(0)
    v_cmp_ne_u32 vcc, 0, v3
    s_nop 0
    s_lshr_b64 s[54:55], vcc, s56
    s_and_b32 s25, s54, 3
    s_cmp_eq_u32 s25, 3
    s_cbranch_scc1 chk_21_ok
    s_sleep 1
    s_lshl_b64 exec, 0xff, s56
    s_cmp_lt_u32 s51, 30000
    s_cbranch_scc1 chk_21
    s_mov_b64 exec, -1
chk_21_ok:
    s_lshr_b64 s[54:55], s[54:55], 2
    s_add_u32 s56, s56, 2
    s_add_u32 m0, s4, 12288
    s_add_u32 s25, s61, 184320
    buffer_load_dwordx4 v14, s[28:31], s25 offen offset:0 lds
    buffer_load_dwordx4 v14, s[28:31], s25 offen offset:1024 lds
    buffer_load_dwordx4 v14, s[28:31], s25 offen offset:2048 lds
    s_waitcnt vmcnt(21) lgkmcnt(0)
    s_barrier
    s_add_u32 m0, s24, 81920
    s_add_u32 s44, s60, 6488064
    buffer_load_dwordx4 v9, s[32:35], s44 offen offset:0 lds
    s_add_u32 s45, s60, 6523904
    buffer_load_dwordx4 v9, s[32:35], s45 offen offset:1024 lds
    s_add_u32 s46, s60, 6559744
    buffer_load_dwordx4 v10, s[32:35], s46 offen offset:2048 lds
    s_add_u32 s44, s60, 6595584
    buffer_load_dwordx4 v10, s[32:35], s44 offen offset:3072 lds
    s_and_b32 s25, s54, 3
    s_cmp_eq_u32 s25, 3
    s_cbranch_scc1 chk_22_ok
    s_mov_b32 s51, 0
chk_22:
    buffer_load_dword v3, v2, s[28:31], s50 offen sc1
    s_add_u32 s51, s51, 1
    s_mov_b64 exec, -1
    s_waitcnt vmcnt(0)
    v_cmp_ne_u32 vcc, 0, v3
    s_nop 0
    s_lshr_b64 s[54:55], vcc, s56
    s_and_b32 s25, s54, 3
    s_cmp_eq_u32 s25, 3
    s_cbranch_scc1 chk_22_ok
    s_sleep 1
    s_lshl_b64 exec, 0xff, s56
    s_cmp_lt_u32 s51, 30000
    s_cbranch_scc1 chk_22
    s_mov_b64 exec, -1
chk_22_ok:
    s_lshr_b64 s[54:55], s[54:55], 2
    s_add_u32 s56, s56, 2
    s_add_u32 m0, s4, 24576
    s_add_u32 s25, s61, 196608
    buffer_load_dwordx4 v14, s[28:31], s25 offen offset:0 lds
    buffer_load_dwordx4 v14, s[28:31], s25 offen offset:1024 lds
    buffer_load_dwordx4 v14, s[28:31], s25 offen offset:2048 lds
    s_waitcnt vmcnt(21) lgkmcnt(0)
    s_barrier
    s_add_u32 m0, s24, 0
    s_add_u32 s44, s60, 7077888
    buffer_load_dwordx4 v9, s[32:35], s44 offen offset:0 lds
    s_add_u32 s45, s60, 7113728
    buffer_load_dwordx4 v9, s[32:35], s45 offen offset:1024 lds
    s_add_u32 s46, s60, 7149568
    buffer_load_dwordx4 v10, s[32:35], s46 offen offset:2048 lds
    s_add_u32 s44, s60, 7185408
    buffer_load_dwordx4 v10, s[32:35], s44 offen offset:3072 lds
    s_and_b32 s25, s54, 3
    s_cmp_eq_u32 s25, 3
    s_cbranch_scc1 chk_23_ok
    s_mov_b32 s51, 0
chk_23:
    buffer_load_dword v3, v2, s[28:31], s50 offen sc1
    s_add_u32 s51, s51, 1
    s_mov_b64 exec, -1
    s_waitcnt vmcnt(0)
    v_cmp_ne_u32 vcc, 0, v3
    s_nop 0
    s_lshr_b64 s[54:55], vcc, s56
    s_and_b32 s25, s54, 3
    s_cmp_eq_u32 s25, 3
    s_cbranch_scc1 chk_23_ok
    s_sleep 1
    s_lshl_b64 exec, 0xff, s56
    s_cmp_lt_u32 s51, 30000
    s_cbranch_scc1 chk_23
    s_mov_b64 exec, -1
chk_23_ok:
    s_lshr_b64 s[54:55], s[54:55], 2
    s_add_u32 s56, s56, 2
    s_add_u32 m0, s4, 36864
    s_add_u32 s25, s61, 208896
    buffer_load_dwordx4 v14, s[28:31], s25 offen offset:0 lds
    buffer_load_dwordx4 v14, s[28:31], s25 offen offset:1024 lds
    buffer_load_dwordx4 v14, s[28:31], s25 offen offset:2048 lds
    s_waitcnt vmcnt(21) lgkmcnt(0)
    s_barrier
    s_add_u32 m0, s24, 16384
    s_add_u32 s44, s60, 7667712
    buffer_load_dwordx4 v9, s[32:35], s44 offen offset:0 lds
    s_add_u32 s45, s60, 7703552
    buffer_load_dwordx4 v9, s[32:35], s45 offen offset:1024 lds
    s_add_u32 s46, s60, 7739392
    buffer_load_dwordx4 v10, s[32:35], s46 offen offset:2048 lds
    s_add_u32 s44, s60, 7775232
    buffer_load_dwordx4 v10, s[32:35], s44 offen offset:3072 lds
    s_and_b32 s25, s54, 3
    s_cmp_eq_u32 s25, 3
    s_cbranch_scc1 chk_24_ok
    s_mov_b32 s51, 0
chk_24:
    buffer_load_dword v3, v2, s[28:31], s50 offen sc1
    s_add_u32 s51, s51, 1
    s_mov_b64 exec, -1
    s_waitcnt vmcnt(0)
    v_cmp_ne_u32 vcc, 0, v3
    s_nop 0
    s_lshr_b64 s[54:55], vcc, s56
    s_and_b32 s25, s54, 3
    s_cmp_eq_u32 s25, 3
    s_cbranch_scc1 chk_24_ok
    s_sleep 1
    s_lshl_b64 exec, 0xff, s56
    s_cmp_lt_u32 s51, 30000
    s_cbranch_scc1 chk_24
    s_mov_b64 exec, -1
chk_24_ok:
    s_lshr_b64 s[54:55], s[54:55], 2
    s_add_u32 s56, s56, 2
    s_add_u32 m0, s4, 49152
    s_add_u32 s25, s61, 221184
    buffer_load_dwordx4 v14, s[28:31], s25 offen offset:0 lds
    buffer_load_dwordx4 v14, s[28:31], s25 offen offset:1024 lds
    buffer_load_dwordx4 v14, s[28:31], s25 offen offset:2048 lds
    s_waitcnt vmcnt(21) lgkmcnt(0)
    s_barrier
    s_add_u32 m0, s24, 32768
    s_add_u32 s44, s60, 8257536
    buffer_load_dwordx4 v9, s[32:35], s44 offen offset:0 lds
    s_add_u32 s45, s60, 8293376
    buffer_load_dwordx4 v9, s[32:35], s45 offen offset:1024 lds
    s_add_u32 s46, s60, 8329216
    buffer_load_dwordx4 v10, s[32:35], s46 offen offset:2048 lds
    s_add_u32 s44, s60, 8365056
    buffer_load_dwordx4 v10, s[32:35], s44 offen offset:3072 lds
    s_and_b32 s25, s54, 3
    s_cmp_eq_u32 s25, 3
    s_cbranch_scc1 chk_25_ok
    s_mov_b32 s51, 0
chk_25:
    buffer_load_dword v3, v2, s[28:31], s50 offen sc1
    s_add_u32 s51, s51, 1
    s_mov_b64 exec, -1
    s_waitcnt vmcnt(0)
    v_cmp_ne_u32 vcc, 0, v3
    s_nop 0
    s_lshr_b64 s[54:55], vcc, s56
    s_and_b32 s25, s54, 3
    s_cmp_eq_u32 s25, 3
    s_cbranch_scc1 chk_25_ok
    s_sleep 1
    s_lshl_b64 exec, 0xff, s56
    s_cmp_lt_u32 s51, 30000
    s_cbranch_scc1 chk_25
    s_mov_b64 exec, -1
chk_25_ok:
    s_lshr_b64 s[54:55], s[54:55], 2
    s_add_u32 s56, s56, 2
    s_add_u32 m0, s4, 0
    s_add_u32 s25, s61, 233472
    buffer_load_dwordx4 v14, s[28:31], s25 offen offset:0 lds
    buffer_load_dwordx4 v14, s[28:31], s25 offen offset:1024 lds
    buffer_load_dwordx4 v14, s[28:31], s25 offen offset:2048 lds
    s_waitcnt vmcnt(21) lgkmcnt(0)
    s_barrier
    s_add_u32 m0, s24, 49152
    s_add_u32 s44, s60, 8847360
    buffer_load_dwordx4 v9, s[32:35], s44 offen offset:0 lds
    s_add_u32 s45, s60, 8883200
    buffer_load_dwordx4 v9, s[32:35], s45 offen offset:1024 lds
    s_add_u32 s46, s60, 8919040
    buffer_load_dwordx4 v10, s[32:35], s46 offen offset:2048 lds
    s_add_u32 s44, s60, 8954880
    buffer_load_dwordx4 v10, s[32:35], s44 offen offset:3072 lds
    s_and_b32 s25, s54, 3
    s_cmp_eq_u32 s25, 3
    s_cbranch_scc1 chk_26_ok
    s_mov_b32 s51, 0
chk_26:
    buffer_load_dword v3, v2, s[28:31], s50 offen sc1
    s_add_u32 s51, s51, 1
    s_mov_b64 exec, -1
    s_waitcnt vmcnt(0)
    v_cmp_ne_u32 vcc, 0, v3
    s_nop 0
    s_lshr_b64 s[54:55], vcc, s56
    s_and_b32 s25, s54, 3
    s_cmp_eq_u32 s25, 3
    s_cbranch_scc1 chk_26_ok
    s_sleep 1
    s_lshl_b64 exec, 0xff, s56
    s_cmp_lt_u32 s51, 30000
    s_cbranch_scc1 chk_26
    s_mov_b64 exec, -1
chk_26_ok:
    s_lshr_b64 s[54:55], s[54:55], 2
    s_add_u32 s56, s56, 2
    s_add_u32 m0, s4, 12288
    s_add_u32 s25, s61, 245760
    buffer_load_dwordx4 v14, s[28:31], s25 offen offset:0 lds
    buffer_load_dwordx4 v14, s[28:31], s25 offen offset:1024 lds
    buffer_load_dwordx4 v14, s[28:31], s25 offen offset:2048 lds
    s_waitcnt vmcnt(21) lgkmcnt(0)
    s_barrier
    s_add_u32 m0, s24, 65536
    s_add_u32 s44, s60, 9437184
    buffer_load_dwordx4 v9, s[32:35], s44 offen offset:0 lds
    s_add_u32 s45, s60, 9473024
    buffer_load_dwordx4 v9, s[32:35], s45 offen offset:1024 lds
    s_add_u32 s46, s60, 9508864
    buffer_load_dwordx4 v10, s[32:35], s46 offen offset:2048 lds
    s_add_u32 s44, s60, 9544704
    buffer_load_dwordx4 v10, s[32:35], s44 offen offset:3072 lds
    s_and_b32 s25, s54, 3
    s_cmp_eq_u32 s25, 3
    s_cbranch_scc1 chk_27_ok
    s_mov_b32 s51, 0
chk_27:
    buffer_load_dword v3, v2, s[28:31], s50 offen sc1
    s_add_u32 s51, s51, 1
    s_mov_b64 exec, -1
    s_waitcnt vmcnt(0)
    v_cmp_ne_u32 vcc, 0, v3
    s_nop 0
    s_lshr_b64 s[54:55], vcc, s56
    s_and_b32 s25, s54, 3
    s_cmp_eq_u32 s25, 3
    s_cbranch_scc1 chk_27_ok
    s_sleep 1
    s_lshl_b64 exec, 0xff, s56
    s_cmp_lt_u32 s51, 30000
    s_cbranch_scc1 chk_27
    s_mov_b64 exec, -1
chk_27_ok:
    s_lshr_b64 s[54:55], s[54:55], 2
    s_add_u32 s56, s56, 2
    s_add_u32 m0, s4, 24576
    s_add_u32 s25, s61, 258048
    buffer_load_dwordx4 v14, s[28:31], s25 offen offset:0 lds
    buffer_load_dwordx4 v14, s[28:31], s25 offen offset:1024 lds
    buffer_load_dwordx4 v14, s[28:31], s25 offen offset:2048 lds
    s_waitcnt vmcnt(21) lgkmcnt(0)
    s_barrier
    s_add_u32 m0, s24, 81920
    s_add_u32 s44, s60, 10027008
    buffer_load_dwordx4 v9, s[32:35], s44 offen offset:0 lds
    s_add_u32 s45, s60, 10062848
    buffer_load_dwordx4 v9, s[32:35], s45 offen offset:1024 lds
    s_add_u32 s46, s60, 10098688
    buffer_load_dwordx4 v10, s[32:35], s46 offen offset:2048 lds
    s_add_u32 s44, s60, 10134528
    buffer_load_dwordx4 v10, s[32:35], s44 offen offset:3072 lds
    s_and_b32 s25, s54, 3
    s_cmp_eq_u32 s25, 3
    s_cbranch_scc1 chk_28_ok
    s_mov_b32 s51, 0
chk_28:
    buffer_load_dword v3, v2, s[28:31], s50 offen sc1
    s_add_u32 s51, s51, 1
    s_mov_b64 exec, -1
    s_waitcnt vmcnt(0)
    v_cmp_ne_u32 vcc, 0, v3
    s_nop 0
    s_lshr_b64 s[54:55], vcc, s56
    s_and_b32 s25, s54, 3
    s_cmp_eq_u32 s25, 3
    s_cbranch_scc1 chk_28_ok
    s_sleep 1
    s_lshl_b64 exec, 0xff, s56
    s_cmp_lt_u32 s51, 30000
    s_cbranch_scc1 chk_28
    s_mov_b64 exec, -1
chk_28_ok:
    s_lshr_b64 s[54:55], s[54:55], 2
    s_add_u32 s56, s56, 2
    s_add_u32 m0, s4, 36864
    s_add_u32 s25, s61, 270336
    buffer_load_dwordx4 v14, s[28:31], s25 offen offset:0 lds
    buffer_load_dwordx4 v14, s[28:31], s25 offen offset:1024 lds
    buffer_load_dwordx4 v14, s[28:31], s25 offen offset:2048 lds
    s_waitcnt vmcnt(21) lgkmcnt(0)
    s_barrier
    s_add_u32 m0, s24, 0
    s_add_u32 s44, s60, 10616832
    buffer_load_dwordx4 v9, s[32:35], s44 offen offset:0 lds
    s_add_u32 s45, s60, 10652672
    buffer_load_dwordx4 v9, s[32:35], s45 offen offset:1024 lds
    s_add_u32 s46, s60, 10688512
    buffer_load_dwordx4 v10, s[32:35], s46 offen offset:2048 lds
    s_add_u32 s44, s60, 10724352
    buffer_load_dwordx4 v10, s[32:35], s44 offen offset:3072 lds
    s_and_b32 s25, s54, 3
    s_cmp_eq_u32 s25, 3
    s_cbranch_scc1 chk_29_ok
    s_mov_b32 s51, 0
chk_29:
    buffer_load_dword v3, v2, s[28:31], s50 offen sc1
    s_add_u32 s51, s51, 1
    s_mov_b64 exec, -1
    s_waitcnt vmcnt(0)
    v_cmp_ne_u32 vcc, 0, v3
    s_nop 0
    s_lshr_b64 s[54:55], vcc, s56
    s_and_b32 s25, s54, 3
    s_cmp_eq_u32 s25, 3
    s_cbranch_scc1 chk_29_ok
    s_sleep 1
    s_lshl_b64 exec, 0xff, s56
    s_cmp_lt_u32 s51, 30000
    s_cbranch_scc1 chk_29
    s_mov_b64 exec, -1
chk_29_ok:
    s_lshr_b64 s[54:55], s[54:55], 2
    s_add_u32 s56, s56, 2
    s_add_u32 m0, s4, 49152
    s_add_u32 s25, s61, 282624
    buffer_load_dwordx4 v14, s[28:31], s25 offen offset:0 lds
    buffer_load_dwordx4 v14, s[28:31], s25 offen offset:1024 lds
    buffer_load_dwordx4 v14, s[28:31], s25 offen offset:2048 lds
    s_waitcnt vmcnt(21) lgkmcnt(0)
    s_barrier
    s_add_u32 m0, s24, 16384
    s_add_u32 s44, s60, 11206656
    buffer_load_dwordx4 v9, s[32:35], s44 offen offset:0 lds
    s_add_u32 s45, s60, 11242496
    buffer_load_dwordx4 v9, s[32:35], s45 offen offset:1024 lds
    s_add_u32 s46, s60, 11278336
    buffer_load_dwordx4 v10, s[32:35], s46 offen offset:2048 lds
    s_add_u32 s44, s60, 11314176
    buffer_load_dwordx4 v10, s[32:35], s44 offen offset:3072 lds
    s_and_b32 s25, s54, 3
    s_cmp_eq_u32 s25, 3
    s_cbranch_scc1 chk_30_ok
    s_mov_b32 s51, 0
chk_30:
    buffer_load_dword v3, v2, s[28:31], s50 offen sc1
    s_add_u32 s51, s51, 1
    s_mov_b64 exec, -1
    s_waitcnt vmcnt(0)
    v_cmp_ne_u32 vcc, 0, v3
    s_nop 0
    s_lshr_b64 s[54:55], vcc, s56
    s_and_b32 s25, s54, 3
    s_cmp_eq_u32 s25, 3
    s_cbranch_scc1 chk_30_ok
    s_sleep 1
    s_lshl_b64 exec, 0xff, s56
    s_cmp_lt_u32 s51, 30000
    s_cbranch_scc1 chk_30
    s_mov_b64 exec, -1
chk_30_ok:
    s_lshr_b64 s[54:55], s[54:55], 2
    s_add_u32 s56, s56, 2
    s_add_u32 m0, s4, 0
    s_add_u32 s25, s61, 294912
    buffer_load_dwordx4 v14, s[28:31], s25 offen offset:0 lds
    buffer_load_dwordx4 v14, s[28:31], s25 offen offset:1024 lds
    buffer_load_dwordx4 v14, s[28:31], s25 offen offset:2048 lds
    s_waitcnt vmcnt(21) lgkmcnt(0)
    s_barrier
    s_add_u32 m0, s24, 32768
    s_add_u32 s44, s60, 11796480
    buffer_load_dwordx4 v9, s[32:35], s44 offen offset:0 lds
    s_add_u32 s45, s60, 11832320
    buffer_load_dwordx4 v9, s[32:35], s45 offen offset:1024 lds
    s_add_u32 s46, s60, 11868160
    buffer_load_dwordx4 v10, s[32:35], s46 offen offset:2048 lds
    s_add_u32 s44, s60, 11904000
    buffer_load_dwordx4 v10, s[32:35], s44 offen offset:3072 lds
    s_and_b32 s25, s54, 3
    s_cmp_eq_u32 s25, 3
    s_cbranch_scc1 chk_31_ok
    s_mov_b32 s51, 0
chk_31:
    buffer_load_dword v3, v2, s[28:31], s50 offen sc1
    s_add_u32 s51, s51, 1
    s_mov_b64 exec, -1
    s_waitcnt vmcnt(0)
    v_cmp_ne_u32 vcc, 0, v3
    s_nop 0
    s_lshr_b64 s[54:55], vcc, s56
    s_and_b32 s25, s54, 3
    s_cmp_eq_u32 s25, 3
    s_cbranch_scc1 chk_31_ok
    s_sleep 1
    s_lshl_b64 exec, 0xff, s56
    s_cmp_lt_u32 s51, 30000
    s_cbranch_scc1 chk_31
    s_mov_b64 exec, -1
chk_31_ok:
    s_lshr_b64 s[54:55], s[54:55], 2
    s_add_u32 s56, s56, 2
    s_add_u32 m0, s4, 12288
    s_add_u32 s25, s61, 307200
    buffer_load_dwordx4 v14, s[28:31], s25 offen offset:0 lds
    buffer_load_dwordx4 v14, s[28:31], s25 offen offset:1024 lds
    buffer_load_dwordx4 v14, s[28:31], s25 offen offset:2048 lds
    s_waitcnt vmcnt(21) lgkmcnt(0)
    s_barrier
    s_add_u32 m0, s24, 49152
    s_add_u32 s44, s60, 12386304
    buffer_load_dwordx4 v9, s[32:35], s44 offen offset:0 lds
    s_add_u32 s45, s60, 12422144
    buffer_load_dwordx4 v9, s[32:35], s45 offen offset:1024 lds
    s_add_u32 s46, s60, 12457984
    buffer_load_dwordx4 v10, s[32:35], s46 offen offset:2048 lds
    s_add_u32 s44, s60, 12493824
    buffer_load_dwordx4 v10, s[32:35], s44 offen offset:3072 lds
    s_and_b32 s25, s54, 3
    s_cmp_eq_u32 s25, 3
    s_cbranch_scc1 chk_32_ok
    s_mov_b32 s51, 0
chk_32:
    buffer_load_dword v3, v2, s[28:31], s50 offen sc1
    s_add_u32 s51, s51, 1
    s_mov_b64 exec, -1
    s_waitcnt vmcnt(0)
    v_cmp_ne_u32 vcc, 0, v3
    s_nop 0
    s_lshr_b64 s[54:55], vcc, s56
    s_and_b32 s25, s54, 3
    s_cmp_eq_u32 s25, 3
    s_cbranch_scc1 chk_32_ok
    s_sleep 1
    s_lshl_b64 exec, 0xff, s56
    s_cmp_lt_u32 s51, 30000
    s_cbranch_scc1 chk_32
    s_mov_b64 exec, -1
chk_32_ok:
    s_lshr_b64 s[54:55], s[54:55], 2
    s_add_u32 s56, s56, 2
    s_add_u32 m0, s4, 24576
    s_add_u32 s25, s61, 319488
    buffer_load_dwordx4 v14, s[28:31], s25 offen offset:0 lds
    buffer_load_dwordx4 v14, s[28:31], s25 offen offset:1024 lds
    buffer_load_dwordx4 v14, s[28:31], s25 offen offset:2048 lds
    s_waitcnt vmcnt(21) lgkmcnt(0)
    s_barrier
    s_add_u32 m0, s24, 65536
    s_add_u32 s44, s60, 12976128
    buffer_load_dwordx4 v9, s[32:35], s44 offen offset:0 lds
    s_add_u32 s45, s60, 13011968
    buffer_load_dwordx4 v9, s[32:35], s45 offen offset:1024 lds
    s_add_u32 s46, s60, 13047808
    buffer_load_dwordx4 v10, s[32:35], s46 offen offset:2048 lds
    s_add_u32 s44, s60, 13083648
    buffer_load_dwordx4 v10, s[32:35], s44 offen offset:3072 lds
    s_and_b32 s25, s54, 3
    s_cmp_eq_u32 s25, 3
    s_cbranch_scc1 chk_33_ok
    s_mov_b32 s51, 0
chk_33:
    buffer_load_dword v3, v2, s[28:31], s50 offen sc1
    s_add_u32 s51, s51, 1
    s_mov_b64 exec, -1
    s_waitcnt vmcnt(0)
    v_cmp_ne_u32 vcc, 0, v3
    s_nop 0
    s_lshr_b64 s[54:55], vcc, s56
    s_and_b32 s25, s54, 3
    s_cmp_eq_u32 s25, 3
    s_cbranch_scc1 chk_33_ok
    s_sleep 1
    s_lshl_b64 exec, 0xff, s56
    s_cmp_lt_u32 s51, 30000
    s_cbranch_scc1 chk_33
    s_mov_b64 exec, -1
chk_33_ok:
    s_lshr_b64 s[54:55], s[54:55], 2
    s_add_u32 s56, s56, 2
    s_add_u32 m0, s4, 36864
    s_add_u32 s25, s61, 331776
    buffer_load_dwordx4 v14, s[28:31], s25 offen offset:0 lds
    buffer_load_dwordx4 v14, s[28:31], s25 offen offset:1024 lds
    buffer_load_dwordx4 v14, s[28:31], s25 offen offset:2048 lds
    s_waitcnt vmcnt(21) lgkmcnt(0)
    s_barrier
    s_add_u32 m0, s24, 81920
    s_add_u32 s44, s60, 13565952
    buffer_load_dwordx4 v9, s[32:35], s44 offen offset:0 lds
    s_add_u32 s45, s60, 13601792
    buffer_load_dwordx4 v9, s[32:35], s45 offen offset:1024 lds
    s_add_u32 s46, s60, 13637632
    buffer_load_dwordx4 v10, s[32:35], s46 offen offset:2048 lds
    s_add_u32 s44, s60, 13673472
    buffer_load_dwordx4 v10, s[32:35], s44 offen offset:3072 lds
    s_and_b32 s25, s54, 3
    s_cmp_eq_u32 s25, 3
    s_cbranch_scc1 chk_34_ok
    s_mov_b32 s51, 0
chk_34:
    buffer_load_dword v3, v2, s[28:31], s50 offen sc1
    s_add_u32 s51, s51, 1
    s_mov_b64 exec, -1
    s_waitcnt vmcnt(0)
    v_cmp_ne_u32 vcc, 0, v3
    s_nop 0
    s_lshr_b64 s[54:55], vcc, s56
    s_and_b32 s25, s54, 3
    s_cmp_eq_u32 s25, 3
    s_cbranch_scc1 chk_34_ok
    s_sleep 1
    s_lshl_b64 exec, 0xff, s56
    s_cmp_lt_u32 s51, 30000
    s_cbranch_scc1 chk_34
    s_mov_b64 exec, -1
chk_34_ok:
    s_lshr_b64 s[54:55], s[54:55], 2
    s_add_u32 s56, s56, 2
    s_add_u32 m0, s4, 49152
    s_add_u32 s25, s61, 344064
    buffer_load_dwordx4 v14, s[28:31], s25 offen offset:0 lds
    buffer_load_dwordx4 v14, s[28:31], s25 offen offset:1024 lds
    buffer_load_dwordx4 v14, s[28:31], s25 offen offset:2048 lds
    s_waitcnt vmcnt(21) lgkmcnt(0)
    s_barrier
    s_add_u32 m0, s24, 0
    s_add_u32 s44, s60, 14155776
    buffer_load_dwordx4 v9, s[32:35], s44 offen offset:0 lds
    s_add_u32 s45, s60, 14191616
    buffer_load_dwordx4 v9, s[32:35], s45 offen offset:1024 lds
    s_add_u32 s46, s60, 14227456
    buffer_load_dwordx4 v10, s[32:35], s46 offen offset:2048 lds
    s_add_u32 s44, s60, 14263296
    buffer_load_dwordx4 v10, s[32:35], s44 offen offset:3072 lds
    s_and_b32 s25, s54, 3
    s_cmp_eq_u32 s25, 3
    s_cbranch_scc1 chk_35_ok
    s_mov_b32 s51, 0
chk_35:
    buffer_load_dword v3, v2, s[28:31], s50 offen sc1
    s_add_u32 s51, s51, 1
    s_mov_b64 exec, -1
    s_waitcnt vmcnt(0)
    v_cmp_ne_u32 vcc, 0, v3
    s_nop 0
    s_lshr_b64 s[54:55], vcc, s56
    s_and_b32 s25, s54, 3
    s_cmp_eq_u32 s25, 3
    s_cbranch_scc1 chk_35_ok
    s_sleep 1
    s_lshl_b64 exec, 0xff, s56
    s_cmp_lt_u32 s51, 30000
    s_cbranch_scc1 chk_35
    s_mov_b64 exec, -1
chk_35_ok:
    s_lshr_b64 s[54:55], s[54:55], 2
    s_add_u32 s56, s56, 2
    s_add_u32 m0, s4, 0
    s_add_u32 s25, s61, 356352
    buffer_load_dwordx4 v14, s[28:31], s25 offen offset:0 lds
    buffer_load_dwordx4 v14, s[28:31], s25 offen offset:1024 lds
    buffer_load_dwordx4 v14, s[28:31], s25 offen offset:2048 lds
    s_waitcnt vmcnt(21) lgkmcnt(0)
    s_barrier
    s_add_u32 m0, s24, 16384
    s_add_u32 s44, s60, 14745600
    buffer_load_dwordx4 v9, s[32:35], s44 offen offset:0 lds
    s_add_u32 s45, s60, 14781440
    buffer_load_dwordx4 v9, s[32:35], s45 offen offset:1024 lds
    s_add_u32 s46, s60, 14817280
    buffer_load_dwordx4 v10, s[32:35], s46 offen offset:2048 lds
    s_add_u32 s44, s60, 14853120
    buffer_load_dwordx4 v10, s[32:35], s44 offen offset:3072 lds
    s_and_b32 s25, s54, 3
    s_cmp_eq_u32 s25, 3
    s_cbranch_scc1 chk_36_ok
    s_mov_b32 s51, 0
chk_36:
    buffer_load_dword v3, v2, s[28:31], s50 offen sc1
    s_add_u32 s51, s51, 1
    s_mov_b64 exec, -1
    s_waitcnt vmcnt(0)
    v_cmp_ne_u32 vcc, 0, v3
    s_nop 0
    s_lshr_b64 s[54:55], vcc, s56
    s_and_b32 s25, s54, 3
    s_cmp_eq_u32 s25, 3
    s_cbranch_scc1 chk_36_ok
    s_sleep 1
    s_lshl_b64 exec, 0xff, s56
    s_cmp_lt_u32 s51, 30000
    s_cbranch_scc1 chk_36
    s_mov_b64 exec, -1
chk_36_ok:
    s_lshr_b64 s[54:55], s[54:55], 2
    s_add_u32 s56, s56, 2
    s_add_u32 m0, s4, 12288
    s_add_u32 s25, s61, 368640
    buffer_load_dwordx4 v14, s[28:31], s25 offen offset:0 lds
    buffer_load_dwordx4 v14, s[28:31], s25 offen offset:1024 lds
    buffer_load_dwordx4 v14, s[28:31], s25 offen offset:2048 lds
    s_waitcnt vmcnt(21) lgkmcnt(0)
    s_barrier
    s_and_b32 s25, s54, 3
    s_cmp_eq_u32 s25, 3
    s_cbranch_scc1 chk_37_ok
    s_mov_b32 s51, 0
chk_37:
    buffer_load_dword v3, v2, s[28:31], s50 offen sc1
    s_add_u32 s51, s51, 1
    s_mov_b64 exec, -1
    s_waitcnt vmcnt(0)
    v_cmp_ne_u32 vcc, 0, v3
    s_nop 0
    s_lshr_b64 s[54:55], vcc, s56
    s_and_b32 s25, s54, 3
    s_cmp_eq_u32 s25, 3
    s_cbranch_scc1 chk_37_ok
    s_sleep 1
    s_lshl_b64 exec, 0xff, s56
    s_cmp_lt_u32 s51, 30000
    s_cbranch_scc1 chk_37
    s_mov_b64 exec, -1
chk_37_ok:
    s_lshr_b64 s[54:55], s[54:55], 2
    s_add_u32 s56, s56, 2
    s_add_u32 m0, s4, 24576
    s_add_u32 s25, s61, 380928
    buffer_load_dwordx4 v14, s[28:31], s25 offen offset:0 lds
    buffer_load_dwordx4 v14, s[28:31], s25 offen offset:1024 lds
    buffer_load_dwordx4 v14, s[28:31], s25 offen offset:2048 lds
    s_waitcnt vmcnt(17) lgkmcnt(0)
    s_barrier
    s_waitcnt vmcnt(10) lgkmcnt(0)
    s_barrier
    s_waitcnt vmcnt(3) lgkmcnt(0)
    s_barrier
    s_waitcnt vmcnt(0) lgkmcnt(0)
    s_barrier
t_ld2:
    s_lshr_b32 s44, s36, 1
    s_and_b32 s45, s36, 1
    s_lshl_b32 s45, s45, 3
    s_lshr_b32 s46, s37, 2
    s_add_u32 s45, s45, s46
    s_and_b32 s46, s37, 3
    v_lshrrev_b32 v2, 4, v1
    v_and_b32 v3, 15, v1
    v_lshlrev_b32 v9, 1, v2
    v_xor_b32 v9, v9, v3
    v_xor_b32 v10, 8, v9
    v_mul_u32_u24 v2, 4096, v2
    v_lshl_add_u32 v9, v9, 4, v2
    v_lshl_add_u32 v10, v10, 4, v2
    s_mul_i32 s52, s44, 4718592
    s_lshl_b32 s50, s45, 8
    s_add_u32 s52, s52, s50
    s_mul_i32 s50, s39, 65536
    s_add_u32 s52, s52, s50
    s_mul_i32 s53, s46, 144
    s_mul_i32 s50, s44, 36
    s_add_u32 s53, s53, s50
    s_mul_i32 s53, s53, 9216
    s_mul_i32 s4, s39, 4608
    s_add_u32 s53, s53, s4
    s_add_u32 s53, s53, 16777216
    s_add_u32 s4, s4, 81920
    s_lshl_b32 s24, s39, 12
    s_mov_b32 s6, 0x18764320
    s_mov_b32 s7, 5
    s_cmp_eq_u32 s44, 1
    s_cselect_b32 s6, 0x40765321, s6
    s_cselect_b32 s7, 8, s7
    s_cmp_eq_u32 s44, 2
    s_cselect_b32 s6, 0x38654210, s6
    s_cselect_b32 s7, 7, s7
    s_cmp_eq_u32 s44, 3
    s_cselect_b32 s6, 0x28754310, s6
    s_cselect_b32 s7, 6, s7
    v_min_u32 v2, 35, v1
    v_and_b32 v3, 1, v2
    s_mul_i32 s50, s46, 3
    s_and_b32 s51, s39, 1
    s_add_u32 s50, s50, s51
    v_add_u32 v3, s50, v3
    v_and_b32 v4, 60, v2
    v_lshrrev_b64 v[12:13], v4, s[6:7]
    v_and_b32 v4, 15, v12
    v_mul_u32_u24 v4, 6, v4
    v_lshrrev_b32 v7, 1, v3
    v_add_u32 v4, v4, v7
    v_and_b32 v3, 1, v3
    v_lshlrev_b32 v3, 1, v3
    v_bfe_u32 v2, v2, 1, 1
    v_add_u32 v3, v3, v2
    v_lshlrev_b32 v3, 7, v3
    v_lshl_add_u32 v2, v4, 10, v3
    s_mul_i32 s50, s44, 55296
    s_add_u32 s50, s50, 262528
    s_cmp_lt_u32 s2, 216
    s_cbranch_scc0 g2_ld_nobar
    s_barrier
g2_ld_nobar:
    s_bfe_u32 s5, s6, 0x40000
    s_mul_i32 s57, s5, 524288
    s_add_u32 s57, s57, s52
    s_add_u32 m0, s24, 0
    s_nop 0
    buffer_load_dwordx4 v9, s[8:11], s57 offen offset:0 lds
    s_add_u32 s26, s57, 15360
    buffer_load_dwordx4 v10, s[8:11], s26 offen offset:1024 lds
    s_add_u32 s27, s57, 30720
    buffer_load_dwordx4 v9, s[8:11], s27 offen offset:2048 lds
    s_add_u32 s25, s57, 46080
    buffer_load_dwordx4 v10, s[8:11], s25 offen offset:3072 lds
    s_add_u32 m0, s24, 16384
    s_add_u32 s25, s57, 262144
    buffer_load_dwordx4 v9, s[8:11], s25 offen offset:0 lds
    s_add_u32 s26, s57, 277504
    buffer_load_dwordx4 v10, s[8:11], s26 offen offset:1024 lds
    s_add_u32 s27, s57, 292864
    buffer_load_dwordx4 v9, s[8:11], s27 offen offset:2048 lds
    s_add_u32 s25, s57, 308224
    buffer_load_dwordx4 v10, s[8:11], s25 offen offset:3072 lds
    s_bfe_u32 s5, s6, 0x40004
    s_mul_i32 s57, s5, 524288
    s_add_u32 s57, s57, s52
    s_add_u32 m0, s24, 32768
    s_nop 0
    buffer_load_dwordx4 v9, s[8:11], s57 offen offset:0 lds
    s_add_u32 s26, s57, 15360
    buffer_load_dwordx4 v10, s[8:11], s26 offen offset:1024 lds
    s_add_u32 s27, s57, 30720
    buffer_load_dwordx4 v9, s[8:11], s27 offen offset:2048 lds
    s_add_u32 s25, s57, 46080
    buffer_load_dwordx4 v10, s[8:11], s25 offen offset:3072 lds
    s_add_u32 m0, s24, 49152
    s_add_u32 s25, s57, 262144
    buffer_load_dwordx4 v9, s[8:11], s25 offen offset:0 lds
    s_add_u32 s26, s57, 277504
    buffer_load_dwordx4 v10, s[8:11], s26 offen offset:1024 lds
    s_add_u32 s27, s57, 292864
    buffer_load_dwordx4 v9, s[8:11], s27 offen offset:2048 lds
    s_add_u32 s25, s57, 308224
    buffer_load_dwordx4 v10, s[8:11], s25 offen offset:3072 lds
    s_bfe_u32 s5, s6, 0x40008
    s_mul_i32 s57, s5, 524288
    s_add_u32 s57, s57, s52
    s_add_u32 m0, s24, 65536
    s_nop 0
    buffer_load_dwordx4 v9, s[8:11], s57 offen offset:0 lds
    s_add_u32 s26, s57, 15360
    buffer_load_dwordx4 v10, s[8:11], s26 offen offset:1024 lds
    s_add_u32 s27, s57, 30720
    buffer_load_dwordx4 v9, s[8:11], s27 offen offset:2048 lds
    s_add_u32 s25, s57, 46080
    buffer_load_dwordx4 v10, s[8:11], s25 offen offset:3072 lds
    s_cmp_lt_u32 s2, 216
    s_cbranch_scc0 g2_ld_nobar2
    s_barrier
g2_ld_nobar2:
    s_sleep 8
    s_mov_b64 s[54:55], 0
    s_mov_b32 s56, 0
    s_bfe_u32 s5, s6, 0x40000
    s_mul_i32 s58, s5, 36864
    s_add_u32 s58, s58, s53
    s_and_b32 s25, s54, 3
    s_cmp_eq_u32 s25, 3
    s_cbranch_scc1 chk_38_ok
    s_mov_b32 s51, 0
chk_38:
    buffer_load_dword v3, v2, s[28:31], s50 offen sc1
    s_add_u32 s51, s51, 1
    s_mov_b64 exec, -1
    s_waitcnt vmcnt(0)
    v_cmp_ne_u32 vcc, 0, v3
    s_nop 0
    s_lshr_b64 s[54:55], vcc, s56
    s_and_b32 s25, s54, 3
    s_cmp_eq_u32 s25, 3
    s_cbranch_scc1 chk_38_ok
    s_sleep 2
    s_lshl_b64 exec, 0xff, s56
    s_cmp_lt_u32 s51, 30000
    s_cbranch_scc1 chk_38
    s_mov_b64 exec, -1
chk_38_ok:
    s_lshr_b64 s[54:55], s[54:55], 2
    s_add_u32 s56, s56, 2
    s_add_u32 m0, s4, 0
    s_mov_b64 exec, 0xffffffff
    buffer_load_dwordx4 v14, s[28:31], s58 offen lds
    s_mov_b64 exec, -1
    buffer_load_dwordx4 v14, s[28:31], s58 offen offset:512 lds
    buffer_load_dwordx4 v14, s[28:31], s58 offen offset:1536 lds
    buffer_load_dwordx4 v14, s[28:31], s58 offen offset:2560 lds
    buffer_load_dwordx4 v14, s[28:31], s58 offen offset:3584 lds
    s_and_b32 s25, s54, 3
    s_cmp_eq_u32 s25, 3
    s_cbranch_scc1 chk_39_ok
    s_mov_b32 s51, 0
chk_39:
    buffer_load_dword v3, v2, s[28:31], s50 offen sc1
    s_add_u32 s51, s51, 1
    s_mov_b64 exec, -1
    s_waitcnt vmcnt(0)
    v_cmp_ne_u32 vcc, 0, v3
    s_nop 0
    s_lshr_b64 s[54:55], vcc, s56
    s_and_b32 s25, s54, 3
    s_cmp_eq_u32 s25, 3
    s_cbranch_scc1 chk_39_ok
    s_sleep 2
    s_lshl_b64 exec, 0xff, s56
    s_cmp_lt_u32 s51, 30000
    s_cbranch_scc1 chk_39
    s_mov_b64 exec, -1
chk_39_ok:
    s_lshr_b64 s[54:55], s[54:55], 2
    s_add_u32 s56, s56, 2
    s_add_u32 m0, s4, 18432
    s_add_u32 s59, s58, 18432
    s_mov_b64 exec, 0xffffffff
    buffer_load_dwordx4 v14, s[28:31], s59 offen lds
    s_mov_b64 exec, -1
    buffer_load_dwordx4 v14, s[28:31], s59 offen offset:512 lds
    buffer_load_dwordx4 v14, s[28:31], s59 offen offset:1536 lds
    buffer_load_dwordx4 v14, s[28:31], s59 offen offset:2560 lds
    buffer_load_dwordx4 v14, s[28:31], s59 offen offset:3584 lds
    s_bfe_u32 s5, s6, 0x40004
    s_mul_i32 s58, s5, 36864
    s_add_u32 s58, s58, s53
    s_and_b32 s25, s54, 3
    s_cmp_eq_u32 s25, 3
    s_cbranch_scc1 chk_40_ok
    s_mov_b32 s51, 0
chk_40:
    buffer_load_dword v3, v2, s[28:31], s50 offen sc1
    s_add_u32 s51, s51, 1
    s_mov_b64 exec, -1
    s_waitcnt vmcnt(0)
    v_cmp_ne_u32 vcc, 0, v3
    s_nop 0
    s_lshr_b64 s[54:55], vcc, s56
    s_and_b32 s25, s54, 3
    s_cmp_eq_u32 s25, 3
    s_cbranch_scc1 chk_40_ok
    s_sleep 2
    s_lshl_b64 exec, 0xff, s56
    s_cmp_lt_u32 s51, 30000
    s_cbranch_scc1 chk_40
    s_mov_b64 exec, -1
chk_40_ok:
    s_lshr_b64 s[54:55], s[54:55], 2
    s_add_u32 s56, s56, 2
    s_add_u32 m0, s4, 36864
    s_mov_b64 exec, 0xffffffff
    buffer_load_dwordx4 v14, s[28:31], s58 offen lds
    s_mov_b64 exec, -1
    buffer_load_dwordx4 v14, s[28:31], s58 offen offset:512 lds
    buffer_load_dwordx4 v14, s[28:31], s58 offen offset:1536 lds
    buffer_load_dwordx4 v14, s[28:31], s58 offen offset:2560 lds
    buffer_load_dwordx4 v14, s[28:31], s58 offen offset:3584 lds
    s_waitcnt vmcnt(10)
    s_barrier
    s_and_b32 s25, s54, 3
    s_cmp_eq_u32 s25, 3
    s_cbranch_scc1 chk_41_ok
    s_mov_b32 s51, 0
chk_41:
    buffer_load_dword v3, v2, s[28:31], s50 offen sc1
    s_add_u32 s51, s51, 1
    s_mov_b64 exec, -1
    s_waitcnt vmcnt(0)
    v_cmp_ne_u32 vcc, 0, v3
    s_nop 0
    s_lshr_b64 s[54:55], vcc, s56
    s_and_b32 s25, s54, 3
    s_cmp_eq_u32 s25, 3
    s_cbranch_scc1 chk_41_ok
    s_sleep 2
    s_lshl_b64 exec, 0xff, s56
    s_cmp_lt_u32 s51, 30000
    s_cbranch_scc1 chk_41
    s_mov_b64 exec, -1
chk_41_ok:
    s_lshr_b64 s[54:55], s[54:55], 2
    s_add_u32 s56, s56, 2
    s_add_u32 m0, s4, 55296
    s_add_u32 s59, s58, 18432
    s_mov_b64 exec, 0xffffffff
    buffer_load_dwordx4 v14, s[28:31], s59 offen lds
    s_mov_b64 exec, -1
    buffer_load_dwordx4 v14, s[28:31], s59 offen offset:512 lds
    buffer_load_dwordx4 v14, s[28:31], s59 offen offset:1536 lds
    buffer_load_dwordx4 v14, s[28:31], s59 offen offset:2560 lds
    buffer_load_dwordx4 v14, s[28:31], s59 offen offset:3584 lds
    s_waitcnt vmcnt(10)
    s_barrier
    s_add_u32 m0, s24, 0
    s_add_u32 s25, s57, 262144
    buffer_load_dwordx4 v9, s[8:11], s25 offen offset:0 lds
    s_add_u32 s26, s57, 277504
    buffer_load_dwordx4 v10, s[8:11], s26 offen offset:1024 lds
    s_add_u32 s27, s57, 292864
    buffer_load_dwordx4 v9, s[8:11], s27 offen offset:2048 lds
    s_add_u32 s25, s57, 308224
    buffer_load_dwordx4 v10, s[8:11], s25 offen offset:3072 lds
    s_bfe_u32 s5, s6, 0x40008
    s_mul_i32 s58, s5, 36864
    s_add_u32 s58, s58, s53
    s_and_b32 s25, s54, 3
    s_cmp_eq_u32 s25, 3
    s_cbranch_scc1 chk_42_ok
    s_mov_b32 s51, 0
chk_42:
    buffer_load_dword v3, v2, s[28:31], s50 offen sc1
    s_add_u32 s51, s51, 1
    s_mov_b64 exec, -1
    s_waitcnt vmcnt(0)
    v_cmp_ne_u32 vcc, 0, v3
    s_nop 0
    s_lshr_b64 s[54:55], vcc, s56
    s_and_b32 s25, s54, 3
    s_cmp_eq_u32 s25, 3
    s_cbranch_scc1 chk_42_ok
    s_sleep 2
    s_lshl_b64 exec, 0xff, s56
    s_cmp_lt_u32 s51, 30000
    s_cbranch_scc1 chk_42
    s_mov_b64 exec, -1
chk_42_ok:
    s_lshr_b64 s[54:55], s[54:55], 2
    s_add_u32 s56, s56, 2
    s_add_u32 m0, s4, 0
    s_mov_b64 exec, 0xffffffff
    buffer_load_dwordx4 v14, s[28:31], s58 offen lds
    s_mov_b64 exec, -1
    buffer_load_dwordx4 v14, s[28:31], s58 offen offset:512 lds
    buffer_load_dwordx4 v14, s[28:31], s58 offen offset:1536 lds
    buffer_load_dwordx4 v14, s[28:31], s58 offen offset:2560 lds
    buffer_load_dwordx4 v14, s[28:31], s58 offen offset:3584 lds
    s_waitcnt vmcnt(14)
    s_barrier
    s_bfe_u32 s5, s6, 0x4000c
    s_mul_i32 s57, s5, 524288
    s_add_u32 s57, s57, s52
    s_add_u32 m0, s24, 16384
    s_nop 0
    buffer_load_dwordx4 v9, s[8:11], s57 offen offset:0 lds
    s_add_u32 s26, s57, 15360
    buffer_load_dwordx4 v10, s[8:11], s26 offen offset:1024 lds
    s_add_u32 s27, s57, 30720
    buffer_load_dwordx4 v9, s[8:11], s27 offen offset:2048 lds
    s_add_u32 s25, s57, 46080
    buffer_load_dwordx4 v10, s[8:11], s25 offen offset:3072 lds
    s_and_b32 s25, s54, 3
    s_cmp_eq_u32 s25, 3
    s_cbranch_scc1 chk_43_ok
    s_mov_b32 s51, 0
chk_43:
    buffer_load_dword v3, v2, s[28:31], s50 offen sc1
    s_add_u32 s51, s51, 1
    s_mov_b64 exec, -1
    s_waitcnt vmcnt(0)
    v_cmp_ne_u32 vcc, 0, v3
    s_nop 0
    s_lshr_b64 s[54:55], vcc, s56
    s_and_b32 s25, s54, 3
    s_cmp_eq_u32 s25, 3
    s_cbranch_scc1 chk_43_ok
    s_sleep 2
    s_lshl_b64 exec, 0xff, s56
    s_cmp_lt_u32 s51, 30000
    s_cbranch_scc1 chk_43
    s_mov_b64 exec, -1
chk_43_ok:
    s_lshr_b64 s[54:55], s[54:55], 2
    s_add_u32 s56, s56, 2
    s_add_u32 m0, s4, 18432
    s_add_u32 s59, s58, 18432
    s_mov_b64 exec, 0xffffffff
    buffer_load_dwordx4 v14, s[28:31], s59 offen lds
    s_mov_b64 exec, -1
    buffer_load_dwordx4 v14, s[28:31], s59 offen offset:512 lds
    buffer_load_dwordx4 v14, s[28:31], s59 offen offset:1536 lds
    buffer_load_dwordx4 v14, s[28:31], s59 offen offset:2560 lds
    buffer_load_dwordx4 v14, s[28:31], s59 offen offset:3584 lds
    s_waitcnt vmcnt(18)
    s_barrier
    s_add_u32 m0, s24, 32768
    s_add_u32 s25, s57, 262144
    buffer_load_dwordx4 v9, s[8:11], s25 offen offset:0 lds
    s_add_u32 s26, s57, 277504
    buffer_load_dwordx4 v10, s[8:11], s26 offen offset:1024 lds
    s_add_u32 s27, s57, 292864
    buffer_load_dwordx4 v9, s[8:11], s27 offen offset:2048 lds
    s_add_u32 s25, s57, 308224
    buffer_load_dwordx4 v10, s[8:11], s25 offen offset:3072 lds
    s_bfe_u32 s5, s6, 0x4000c
    s_mul_i32 s58, s5, 36864
    s_add_u32 s58, s58, s53
    s_and_b32 s25, s54, 3
    s_cmp_eq_u32 s25, 3
    s_cbranch_scc1 chk_44_ok
    s_mov_b32 s51, 0
chk_44:
    buffer_load_dword v3, v2, s[28:31], s50 offen sc1
    s_add_u32 s51, s51, 1
    s_mov_b64 exec, -1
    s_waitcnt vmcnt(0)
    v_cmp_ne_u32 vcc, 0, v3
    s_nop 0
    s_lshr_b64 s[54:55], vcc, s56
    s_and_b32 s25, s54, 3
    s_cmp_eq_u32 s25, 3
    s_cbranch_scc1 chk_44_ok
    s_sleep 2
    s_lshl_b64 exec, 0xff, s56
    s_cmp_lt_u32 s51, 30000
    s_cbranch_scc1 chk_44
    s_mov_b64 exec, -1
chk_44_ok:
    s_lshr_b64 s[54:55], s[54:55], 2
    s_add_u32 s56, s56, 2
    s_add_u32 m0, s4, 36864
    s_mov_b64 exec, 0xffffffff
    buffer_load_dwordx4 v14, s[28:31], s58 offen lds
    s_mov_b64 exec, -1
    buffer_load_dwordx4 v14, s[28:31], s58 offen offset:512 lds
    buffer_load_dwordx4 v14, s[28:31], s58 offen offset:1536 lds
    buffer_load_dwordx4 v14, s[28:31], s58 offen offset:2560 lds
    buffer_load_dwordx4 v14, s[28:31], s58 offen offset:3584 lds
    s_waitcnt vmcnt(18)
    s_barrier
    s_bfe_u32 s5, s6, 0x40010
    s_mul_i32 s57, s5, 524288
    s_add_u32 s57, s57, s52
    s_add_u32 m0, s24, 49152
    s_nop 0
    buffer_load_dwordx4 v9, s[8:11], s57 offen offset:0 lds
    s_add_u32 s26, s57, 15360
    buffer_load_dwordx4 v10, s[8:11], s26 offen offset:1024 lds
    s_add_u32 s27, s57, 30720
    buffer_load_dwordx4 v9, s[8:11], s27 offen offset:2048 lds
    s_add_u32 s25, s57, 46080
    buffer_load_dwordx4 v10, s[8:11], s25 offen offset:3072 lds
    s_and_b32 s25, s54, 3
    s_cmp_eq_u32 s25, 3
    s_cbranch_scc1 chk_45_ok
    s_mov_b32 s51, 0
chk_45:
    buffer_load_dword v3, v2, s[28:31], s50 offen sc1
    s_add_u32 s51, s51, 1
    s_mov_b64 exec, -1
    s_waitcnt vmcnt(0)
    v_cmp_ne_u32 vcc, 0, v3
    s_nop 0
    s_lshr_b64 s[54:55], vcc, s56
    s_and_b32 s25, s54, 3
    s_cmp_eq_u32 s25, 3
    s_cbranch_scc1 chk_45_ok
    s_sleep 2
    s_lshl_b64 exec, 0xff, s56
    s_cmp_lt_u32 s51, 30000
    s_cbranch_scc1 chk_45
    s_mov_b64 exec, -1
chk_45_ok:
    s_lshr_b64 s[54:55], s[54:55], 2
    s_add_u32 s56, s56, 2
    s_add_u32 m0, s4, 55296
    s_add_u32 s59, s58, 18432
    s_mov_b64 exec, 0xffffffff
    buffer_load_dwordx4 v14, s[28:31], s59 offen lds
    s_mov_b64 exec, -1
    buffer_load_dwordx4 v14, s[28:31], s59 offen offset:512 lds
    buffer_load_dwordx4 v14, s[28:31], s59 offen offset:1536 lds
    buffer_load_dwordx4 v14, s[28:31], s59 offen offset:2560 lds
    buffer_load_dwordx4 v14, s[28:31], s59 offen offset:3584 lds
    s_waitcnt vmcnt(18)
    s_barrier
    s_add_u32 m0, s24, 65536
    s_add_u32 s25, s57, 262144
    buffer_load_dwordx4 v9, s[8:11], s25 offen offset:0 lds
    s_add_u32 s26, s57, 277504
    buffer_load_dwordx4 v10, s[8:11], s26 offen offset:1024 lds
    s_add_u32 s27, s57, 292864
    buffer_load_dwordx4 v9, s[8:11], s27 offen offset:2048 lds
    s_add_u32 s25, s57, 308224
    buffer_load_dwordx4 v10, s[8:11], s25 offen offset:3072 lds
    s_bfe_u32 s5, s6, 0x40010
    s_mul_i32 s58, s5, 36864
    s_add_u32 s58, s58, s53
    s_and_b32 s25, s54, 3
    s_cmp_eq_u32 s25, 3
    s_cbranch_scc1 chk_46_ok
    s_mov_b32 s51, 0
chk_46:
    buffer_load_dword v3, v2, s[28:31], s50 offen sc1
    s_add_u32 s51, s51, 1
    s_mov_b64 exec, -1
    s_waitcnt vmcnt(0)
    v_cmp_ne_u32 vcc, 0, v3
    s_nop 0
    s_lshr_b64 s[54:55], vcc, s56
    s_and_b32 s25, s54, 3
    s_cmp_eq_u32 s25, 3
    s_cbranch_scc1 chk_46_ok
    s_sleep 2
    s_lshl_b64 exec, 0xff, s56
    s_cmp_lt_u32 s51, 30000
    s_cbranch_scc1 chk_46
    s_mov_b64 exec, -1
chk_46_ok:
    s_lshr_b64 s[54:55], s[54:55], 2
    s_add_u32 s56, s56, 2
    s_add_u32 m0, s4, 0
    s_mov_b64 exec, 0xffffffff
    buffer_load_dwordx4 v14, s[28:31], s58 offen lds
    s_mov_b64 exec, -1
    buffer_load_dwordx4 v14, s[28:31], s58 offen offset:512 lds
    buffer_load_dwordx4 v14, s[28:31], s58 offen offset:1536 lds
    buffer_load_dwordx4 v14, s[28:31], s58 offen offset:2560 lds
    buffer_load_dwordx4 v14, s[28:31], s58 offen offset:3584 lds
    s_waitcnt vmcnt(18)
    s_barrier
    s_bfe_u32 s5, s6, 0x40014
    s_mul_i32 s57, s5, 524288
    s_add_u32 s57, s57, s52
    s_add_u32 m0, s24, 0
    s_nop 0
    buffer_load_dwordx4 v9, s[8:11], s57 offen offset:0 lds
    s_add_u32 s26, s57, 15360
    buffer_load_dwordx4 v10, s[8:11], s26 offen offset:1024 lds
    s_add_u32 s27, s57, 30720
    buffer_load_dwordx4 v9, s[8:11], s27 offen offset:2048 lds
    s_add_u32 s25, s57, 46080
    buffer_load_dwordx4 v10, s[8:11], s25 offen offset:3072 lds
    s_and_b32 s25, s54, 3
    s_cmp_eq_u32 s25, 3
    s_cbranch_scc1 chk_47_ok
    s_mov_b32 s51, 0
chk_47:
    buffer_load_dword v3, v2, s[28:31], s50 offen sc1
    s_add_u32 s51, s51, 1
    s_mov_b64 exec, -1
    s_waitcnt vmcnt(0)
    v_cmp_ne_u32 vcc, 0, v3
    s_nop 0
    s_lshr_b64 s[54:55], vcc, s56
    s_and_b32 s25, s54, 3
    s_cmp_eq_u32 s25, 3
    s_cbranch_scc1 chk_47_ok
    s_sleep 2
    s_lshl_b64 exec, 0xff, s56
    s_cmp_lt_u32 s51, 30000
    s_cbranch_scc1 chk_47
    s_mov_b64 exec, -1
chk_47_ok:
    s_lshr_b64 s[54:55], s[54:55], 2
    s_add_u32 s56, s56, 2
    s_add_u32 m0, s4, 18432
    s_add_u32 s59, s58, 18432
    s_mov_b64 exec, 0xffffffff
    buffer_load_dwordx4 v14, s[28:31], s59 offen lds
    s_mov_b64 exec, -1
    buffer_load_dwordx4 v14, s[28:31], s59 offen offset:512 lds
    buffer_load_dwordx4 v14, s[28:31], s59 offen offset:1536 lds
    buffer_load_dwordx4 v14, s[28:31], s59 offen offset:2560 lds
    buffer_load_dwordx4 v14, s[28:31], s59 offen offset:3584 lds
    s_waitcnt vmcnt(18)
    s_barrier
    s_add_u32 m0, s24, 16384
    s_add_u32 s25, s57, 262144
    buffer_load_dwordx4 v9, s[8:11], s25 offen offset:0 lds
    s_add_u32 s26, s57, 277504
    buffer_load_dwordx4 v10, s[8:11], s26 offen offset:1024 lds
    s_add_u32 s27, s57, 292864
    buffer_load_dwordx4 v9, s[8:11], s27 offen offset:2048 lds
    s_add_u32 s25, s57, 308224
    buffer_load_dwordx4 v10, s[8:11], s25 offen offset:3072 lds
    s_bfe_u32 s5, s6, 0x40014
    s_mul_i32 s58, s5, 36864
    s_add_u32 s58, s58, s53
    s_and_b32 s25, s54, 3
    s_cmp_eq_u32 s25, 3
    s_cbranch_scc1 chk_48_ok
    s_mov_b32 s51, 0
chk_48:
    buffer_load_dword v3, v2, s[28:31], s50 offen sc1
    s_add_u32 s51, s51, 1
    s_mov_b64 exec, -1
    s_waitcnt vmcnt(0)
    v_cmp_ne_u32 vcc, 0, v3
    s_nop 0
    s_lshr_b64 s[54:55], vcc, s56
    s_and_b32 s25, s54, 3
    s_cmp_eq_u32 s25, 3
    s_cbranch_scc1 chk_48_ok
    s_sleep 2
    s_lshl_b64 exec, 0xff, s56
    s_cmp_lt_u32 s51, 30000
    s_cbranch_scc1 chk_48
    s_mov_b64 exec, -1
chk_48_ok:
    s_lshr_b64 s[54:55], s[54:55], 2
    s_add_u32 s56, s56, 2
    s_add_u32 m0, s4, 36864
    s_mov_b64 exec, 0xffffffff
    buffer_load_dwordx4 v14, s[28:31], s58 offen lds
    s_mov_b64 exec, -1
    buffer_load_dwordx4 v14, s[28:31], s58 offen offset:512 lds
    buffer_load_dwordx4 v14, s[28:31], s58 offen offset:1536 lds
    buffer_load_dwordx4 v14, s[28:31], s58 offen offset:2560 lds
    buffer_load_dwordx4 v14, s[28:31], s58 offen offset:3584 lds
    s_waitcnt vmcnt(18)
    s_barrier
    s_bfe_u32 s5, s6, 0x40018
    s_mul_i32 s57, s5, 524288
    s_add_u32 s57, s57, s52
    s_add_u32 m0, s24, 32768
    s_nop 0
    buffer_load_dwordx4 v9, s[8:11], s57 offen offset:0 lds
    s_add_u32 s26, s57, 15360
    buffer_load_dwordx4 v10, s[8:11], s26 offen offset:1024 lds
    s_add_u32 s27, s57, 30720
    buffer_load_dwordx4 v9, s[8:11], s27 offen offset:2048 lds
    s_add_u32 s25, s57, 46080
    buffer_load_dwordx4 v10, s[8:11], s25 offen offset:3072 lds
    s_and_b32 s25, s54, 3
    s_cmp_eq_u32 s25, 3
    s_cbranch_scc1 chk_49_ok
    s_mov_b32 s51, 0
chk_49:
    buffer_load_dword v3, v2, s[28:31], s50 offen sc1
    s_add_u32 s51, s51, 1
    s_mov_b64 exec, -1
    s_waitcnt vmcnt(0)
    v_cmp_ne_u32 vcc, 0, v3
    s_nop 0
    s_lshr_b64 s[54:55], vcc, s56
    s_and_b32 s25, s54, 3
    s_cmp_eq_u32 s25, 3
    s_cbranch_scc1 chk_49_ok
    s_sleep 2
    s_lshl_b64 exec, 0xff, s56
    s_cmp_lt_u32 s51, 30000
    s_cbranch_scc1 chk_49
    s_mov_b64 exec, -1
chk_49_ok:
    s_lshr_b64 s[54:55], s[54:55], 2
    s_add_u32 s56, s56, 2
    s_add_u32 m0, s4, 55296
    s_add_u32 s59, s58, 18432
    s_mov_b64 exec, 0xffffffff
    buffer_load_dwordx4 v14, s[28:31], s59 offen lds
    s_mov_b64 exec, -1
    buffer_load_dwordx4 v14, s[28:31], s59 offen offset:512 lds
    buffer_load_dwordx4 v14, s[28:31], s59 offen offset:1536 lds
    buffer_load_dwordx4 v14, s[28:31], s59 offen offset:2560 lds
    buffer_load_dwordx4 v14, s[28:31], s59 offen offset:3584 lds
    s_waitcnt vmcnt(18)
    s_barrier
    s_add_u32 m0, s24, 49152
    s_add_u32 s25, s57, 262144
    buffer_load_dwordx4 v9, s[8:11], s25 offen offset:0 lds
    s_add_u32 s26, s57, 277504
    buffer_load_dwordx4 v10, s[8:11], s26 offen offset:1024 lds
    s_add_u32 s27, s57, 292864
    buffer_load_dwordx4 v9, s[8:11], s27 offen offset:2048 lds
    s_add_u32 s25, s57, 308224
    buffer_load_dwordx4 v10, s[8:11], s25 offen offset:3072 lds
    s_bfe_u32 s5, s6, 0x40018
    s_mul_i32 s58, s5, 36864
    s_add_u32 s58, s58, s53
    s_and_b32 s25, s54, 3
    s_cmp_eq_u32 s25, 3
    s_cbranch_scc1 chk_50_ok
    s_mov_b32 s51, 0
chk_50:
    buffer_load_dword v3, v2, s[28:31], s50 offen sc1
    s_add_u32 s51, s51, 1
    s_mov_b64 exec, -1
    s_waitcnt vmcnt(0)
    v_cmp_ne_u32 vcc, 0, v3
    s_nop 0
    s_lshr_b64 s[54:55], vcc, s56
    s_and_b32 s25, s54, 3
    s_cmp_eq_u32 s25, 3
    s_cbranch_scc1 chk_50_ok
    s_sleep 2
    s_lshl_b64 exec, 0xff, s56
    s_cmp_lt_u32 s51, 30000
    s_cbranch_scc1 chk_50
    s_mov_b64 exec, -1
chk_50_ok:
    s_lshr_b64 s[54:55], s[54:55], 2
    s_add_u32 s56, s56, 2
    s_add_u32 m0, s4, 0
    s_mov_b64 exec, 0xffffffff
    buffer_load_dwordx4 v14, s[28:31], s58 offen lds
    s_mov_b64 exec, -1
    buffer_load_dwordx4 v14, s[28:31], s58 offen offset:512 lds
    buffer_load_dwordx4 v14, s[28:31], s58 offen offset:1536 lds
    buffer_load_dwordx4 v14, s[28:31], s58 offen offset:2560 lds
    buffer_load_dwordx4 v14, s[28:31], s58 offen offset:3584 lds
    s_waitcnt vmcnt(18)
    s_barrier
    s_bfe_u32 s5, s6, 0x4001c
    s_mul_i32 s57, s5, 524288
    s_add_u32 s57, s57, s52
    s_add_u32 m0, s24, 65536
    s_nop 0
    buffer_load_dwordx4 v9, s[8:11], s57 offen offset:0 lds
    s_add_u32 s26, s57, 15360
    buffer_load_dwordx4 v10, s[8:11], s26 offen offset:1024 lds
    s_add_u32 s27, s57, 30720
    buffer_load_dwordx4 v9, s[8:11], s27 offen offset:2048 lds
    s_add_u32 s25, s57, 46080
    buffer_load_dwordx4 v10, s[8:11], s25 offen offset:3072 lds
    s_and_b32 s25, s54, 3
    s_cmp_eq_u32 s25, 3
    s_cbranch_scc1 chk_51_ok
    s_mov_b32 s51, 0
chk_51:
    buffer_load_dword v3, v2, s[28:31], s50 offen sc1
    s_add_u32 s51, s51, 1
    s_mov_b64 exec, -1
    s_waitcnt vmcnt(0)
    v_cmp_ne_u32 vcc, 0, v3
    s_nop 0
    s_lshr_b64 s[54:55], vcc, s56
    s_and_b32 s25, s54, 3
    s_cmp_eq_u32 s25, 3
    s_cbranch_scc1 chk_51_ok
    s_sleep 2
    s_lshl_b64 exec, 0xff, s56
    s_cmp_lt_u32 s51, 30000
    s_cbranch_scc1 chk_51
    s_mov_b64 exec, -1
chk_51_ok:
    s_lshr_b64 s[54:55], s[54:55], 2
    s_add_u32 s56, s56, 2
    s_add_u32 m0, s4, 18432
    s_add_u32 s59, s58, 18432
    s_mov_b64 exec, 0xffffffff
    buffer_load_dwordx4 v14, s[28:31], s59 offen lds
    s_mov_b64 exec, -1
    buffer_load_dwordx4 v14, s[28:31], s59 offen offset:512 lds
    buffer_load_dwordx4 v14, s[28:31], s59 offen offset:1536 lds
    buffer_load_dwordx4 v14, s[28:31], s59 offen offset:2560 lds
    buffer_load_dwordx4 v14, s[28:31], s59 offen offset:3584 lds
    s_waitcnt vmcnt(18)
    s_barrier
    s_add_u32 m0, s24, 0
    s_add_u32 s25, s57, 262144
    buffer_load_dwordx4 v9, s[8:11], s25 offen offset:0 lds
    s_add_u32 s26, s57, 277504
    buffer_load_dwordx4 v10, s[8:11], s26 offen offset:1024 lds
    s_add_u32 s27, s57, 292864
    buffer_load_dwordx4 v9, s[8:11], s27 offen offset:2048 lds
    s_add_u32 s25, s57, 308224
    buffer_load_dwordx4 v10, s[8:11], s25 offen offset:3072 lds
    s_bfe_u32 s5, s6, 0x4001c
    s_mul_i32 s58, s5, 36864
    s_add_u32 s58, s58, s53
    s_and_b32 s25, s54, 3
    s_cmp_eq_u32 s25, 3
    s_cbranch_scc1 chk_52_ok
    s_mov_b32 s51, 0
chk_52:
    buffer_load_dword v3, v2, s[28:31], s50 offen sc1
    s_add_u32 s51, s51, 1
    s_mov_b64 exec, -1
    s_waitcnt vmcnt(0)
    v_cmp_ne_u32 vcc, 0, v3
    s_nop 0
    s_lshr_b64 s[54:55], vcc, s56
    s_and_b32 s25, s54, 3
    s_cmp_eq_u32 s25, 3
    s_cbranch_scc1 chk_52_ok
    s_sleep 2
    s_lshl_b64 exec, 0xff, s56
    s_cmp_lt_u32 s51, 30000
    s_cbranch_scc1 chk_52
    s_mov_b64 exec, -1
chk_52_ok:
    s_lshr_b64 s[54:55], s[54:55], 2
    s_add_u32 s56, s56, 2
    s_add_u32 m0, s4, 36864
    s_mov_b64 exec, 0xffffffff
    buffer_load_dwordx4 v14, s[28:31], s58 offen lds
    s_mov_b64 exec, -1
    buffer_load_dwordx4 v14, s[28:31], s58 offen offset:512 lds
    buffer_load_dwordx4 v14, s[28:31], s58 offen offset:1536 lds
    buffer_load_dwordx4 v14, s[28:31], s58 offen offset:2560 lds
    buffer_load_dwordx4 v14, s[28:31], s58 offen offset:3584 lds
    s_waitcnt vmcnt(18)
    s_barrier
    s_bfe_u32 s5, s7, 0x40000
    s_mul_i32 s57, s5, 524288
    s_add_u32 s57, s57, s52
    s_add_u32 m0, s24, 16384
    s_nop 0
    buffer_load_dwordx4 v9, s[8:11], s57 offen offset:0 lds
    s_add_u32 s26, s57, 15360
    buffer_load_dwordx4 v10, s[8:11], s26 offen offset:1024 lds
    s_add_u32 s27, s57, 30720
    buffer_load_dwordx4 v9, s[8:11], s27 offen offset:2048 lds
    s_add_u32 s25, s57, 46080
    buffer_load_dwordx4 v10, s[8:11], s25 offen offset:3072 lds
    s_and_b32 s25, s54, 3
    s_cmp_eq_u32 s25, 3
    s_cbranch_scc1 chk_53_ok
    s_mov_b32 s51, 0
chk_53:
    buffer_load_dword v3, v2, s[28:31], s50 offen sc1
    s_add_u32 s51, s51, 1
    s_mov_b64 exec, -1
    s_waitcnt vmcnt(0)
    v_cmp_ne_u32 vcc, 0, v3
    s_nop 0
    s_lshr_b64 s[54:55], vcc, s56
    s_and_b32 s25, s54, 3
    s_cmp_eq_u32 s25, 3
    s_cbranch_scc1 chk_53_ok
    s_sleep 2
    s_lshl_b64 exec, 0xff, s56
    s_cmp_lt_u32 s51, 30000
    s_cbranch_scc1 chk_53
    s_mov_b64 exec, -1
chk_53_ok:
    s_lshr_b64 s[54:55], s[54:55], 2
    s_add_u32 s56, s56, 2
    s_add_u32 m0, s4, 55296
    s_add_u32 s59, s58, 18432
    s_mov_b64 exec, 0xffffffff
    buffer_load_dwordx4 v14, s[28:31], s59 offen lds
    s_mov_b64 exec, -1
    buffer_load_dwordx4 v14, s[28:31], s59 offen offset:512 lds
    buffer_load_dwordx4 v14, s[28:31], s59 offen offset:1536 lds
    buffer_load_dwordx4 v14, s[28:31], s59 offen offset:2560 lds
    buffer_load_dwordx4 v14, s[28:31], s59 offen offset:3584 lds
    s_waitcnt vmcnt(18)
    s_barrier
    s_add_u32 m0, s24, 32768
    s_add_u32 s25, s57, 262144
    buffer_load_dwordx4 v9, s[8:11], s25 offen offset:0 lds
    s_add_u32 s26, s57, 277504
    buffer_load_dwordx4 v10, s[8:11], s26 offen offset:1024 lds
    s_add_u32 s27, s57, 292864
    buffer_load_dwordx4 v9, s[8:11], s27 offen offset:2048 lds
    s_add_u32 s25, s57, 308224
    buffer_load_dwordx4 v10, s[8:11], s25 offen offset:3072 lds
    s_bfe_u32 s5, s7, 0x40000
    s_mul_i32 s58, s5, 36864
    s_add_u32 s58, s58, s53
    s_and_b32 s25, s54, 3
    s_cmp_eq_u32 s25, 3
    s_cbranch_scc1 chk_54_ok
    s_mov_b32 s51, 0
chk_54:
    buffer_load_dword v3, v2, s[28:31], s50 offen sc1
    s_add_u32 s51, s51, 1
    s_mov_b64 exec, -1
    s_waitcnt vmcnt(0)
    v_cmp_ne_u32 vcc, 0, v3
    s_nop 0
    s_lshr_b64 s[54:55], vcc, s56
    s_and_b32 s25, s54, 3
    s_cmp_eq_u32 s25, 3
    s_cbranch_scc1 chk_54_ok
    s_sleep 2
    s_lshl_b64 exec, 0xff, s56
    s_cmp_lt_u32 s51, 30000
    s_cbranch_scc1 chk_54
    s_mov_b64 exec, -1
chk_54_ok:
    s_lshr_b64 s[54:55], s[54:55], 2
    s_add_u32 s56, s56, 2
    s_add_u32 m0, s4, 0
    s_mov_b64 exec, 0xffffffff
    buffer_load_dwordx4 v14, s[28:31], s58 offen lds
    s_mov_b64 exec, -1
    buffer_load_dwordx4 v14, s[28:31], s58 offen offset:512 lds
    buffer_load_dwordx4 v14, s[28:31], s58 offen offset:1536 lds
    buffer_load_dwordx4 v14, s[28:31], s58 offen offset:2560 lds
    buffer_load_dwordx4 v14, s[28:31], s58 offen offset:3584 lds
    s_waitcnt vmcnt(18)
    s_barrier
    s_and_b32 s25, s54, 3
    s_cmp_eq_u32 s25, 3
    s_cbranch_scc1 chk_55_ok
    s_mov_b32 s51, 0
chk_55:
    buffer_load_dword v3, v2, s[28:31], s50 offen sc1
    s_add_u32 s51, s51, 1
    s_mov_b64 exec, -1
    s_waitcnt vmcnt(0)
    v_cmp_ne_u32 vcc, 0, v3
    s_nop 0
    s_lshr_b64 s[54:55], vcc, s56
    s_and_b32 s25, s54, 3
    s_cmp_eq_u32 s25, 3
    s_cbranch_scc1 chk_55_ok
    s_sleep 2
    s_lshl_b64 exec, 0xff, s56
    s_cmp_lt_u32 s51, 30000
    s_cbranch_scc1 chk_55
    s_mov_b64 exec, -1
chk_55_ok:
    s_lshr_b64 s[54:55], s[54:55], 2
    s_add_u32 s56, s56, 2
    s_add_u32 m0, s4, 18432
    s_add_u32 s59, s58, 18432
    s_mov_b64 exec, 0xffffffff
    buffer_load_dwordx4 v14, s[28:31], s59 offen lds
    s_mov_b64 exec, -1
    buffer_load_dwordx4 v14, s[28:31], s59 offen offset:512 lds
    buffer_load_dwordx4 v14, s[28:31], s59 offen offset:1536 lds
    buffer_load_dwordx4 v14, s[28:31], s59 offen offset:2560 lds
    buffer_load_dwordx4 v14, s[28:31], s59 offen offset:3584 lds
    s_waitcnt vmcnt(14)
    s_barrier
    s_waitcnt vmcnt(5)
    s_barrier
    s_waitcnt vmcnt(0)
    s_barrier
    s_branch t_end
t_spare:
    s_sub_u32 s50, s37, 27
    s_lshl_b32 s50, s50, 3
    s_add_u32 s50, s50, s3
    s_add_u32 s58, s50, 261
    s_mul_i32 s58, s58, 55296
    s_add_u32 s58, s58, s57
    s_cmp_lt_u32 s50, 80
    s_cbranch_scc0 t4_56
    buffer_load_dword v8, v17, s[32:35], s58 offen
t4_56:
    s_add_u32 s58, s58, 2211840
    s_cmp_lt_u32 s50, 40
    s_cbranch_scc0 t4_57
    buffer_load_dword v8, v17, s[32:35], s58 offen
t4_57:
    s_add_u32 s58, s58, 2211840
    s_sleep 16
    s_sleep 16
    s_sleep 16
    s_sleep 16
    s_waitcnt vmcnt(0)
    s_lshr_b32 s44, s36, 1
    s_mov_b32 s6, 0x18764320
    s_mov_b32 s7, 5
    s_cmp_eq_u32 s44, 1
    s_cselect_b32 s6, 0x40765321, s6
    s_cselect_b32 s7, 8, s7
    s_cmp_eq_u32 s44, 2
    s_cselect_b32 s6, 0x38654210, s6
    s_cselect_b32 s7, 7, s7
    s_cmp_eq_u32 s44, 3
    s_cselect_b32 s6, 0x28754310, s6
    s_cselect_b32 s7, 6, s7
    s_and_b32 s51, s36, 1
    s_lshl_b32 s51, s51, 11
    s_mul_i32 s52, s44, 4718592
    s_add_u32 s51, s51, s52
    s_add_u32 s52, 0, s50
    v_lshrrev_b32 v2, 4, v1
    v_lshlrev_b32 v2, 12, v2
    v_and_b32 v3, 15, v1
    v_lshl_add_u32 v2, v3, 7, v2
    s_lshr_b32 s53, s52, 5
    s_lshl_b32 s53, s53, 2
    s_lshr_b64 s[54:55], s[6:7], s53
    s_and_b32 s54, s54, 15
    s_lshl_b32 s54, s54, 5
    s_and_b32 s53, s52, 31
    s_add_u32 s54, s54, s53
    s_lshl_b32 s54, s54, 14
    s_add_u32 s54, s54, s51
    buffer_load_dword v4, v2, s[8:11], s54 offen
    s_add_u32 s52, s52, 40
    s_lshr_b32 s53, s52, 5
    s_lshl_b32 s53, s53, 2
    s_lshr_b64 s[54:55], s[6:7], s53
    s_and_b32 s54, s54, 15
    s_lshl_b32 s54, s54, 5
    s_and_b32 s53, s52, 31
    s_add_u32 s54, s54, s53
    s_lshl_b32 s54, s54, 14
    s_add_u32 s54, s54, s51
    s_waitcnt vmcnt(0)
    buffer_load_dword v4, v2, s[8:11], s54 offen
    s_add_u32 s52, s52, 40
    s_lshr_b32 s53, s52, 5
    s_lshl_b32 s53, s53, 2
    s_lshr_b64 s[54:55], s[6:7], s53
    s_and_b32 s54, s54, 15
    s_lshl_b32 s54, s54, 5
    s_and_b32 s53, s52, 31
    s_add_u32 s54, s54, s53
    s_lshl_b32 s54, s54, 14
    s_add_u32 s54, s54, s51
    s_waitcnt vmcnt(0)
    buffer_load_dword v4, v2, s[8:11], s54 offen
    s_add_u32 s52, s52, 40
    s_lshr_b32 s53, s52, 5
    s_lshl_b32 s53, s53, 2
    s_lshr_b64 s[54:55], s[6:7], s53
    s_and_b32 s54, s54, 15
    s_lshl_b32 s54, s54, 5
    s_and_b32 s53, s52, 31
    s_add_u32 s54, s54, s53
    s_lshl_b32 s54, s54, 14
    s_add_u32 s54, s54, s51
    s_waitcnt vmcnt(0)
    buffer_load_dword v4, v2, s[8:11], s54 offen
    s_add_u32 s52, s52, 40
    s_lshr_b32 s53, s52, 5
    s_lshl_b32 s53, s53, 2
    s_lshr_b64 s[54:55], s[6:7], s53
    s_and_b32 s54, s54, 15
    s_lshl_b32 s54, s54, 5
    s_and_b32 s53, s52, 31
    s_add_u32 s54, s54, s53
    s_lshl_b32 s54, s54, 14
    s_add_u32 s54, s54, s51
    s_waitcnt vmcnt(0)
    buffer_load_dword v4, v2, s[8:11], s54 offen
    s_add_u32 s52, s52, 40
    s_lshr_b32 s53, s52, 5
    s_lshl_b32 s53, s53, 2
    s_lshr_b64 s[54:55], s[6:7], s53
    s_and_b32 s54, s54, 15
    s_lshl_b32 s54, s54, 5
    s_and_b32 s53, s52, 31
    s_add_u32 s54, s54, s53
    s_lshl_b32 s54, s54, 14
    s_add_u32 s54, s54, s51
    s_waitcnt vmcnt(0)
    buffer_load_dword v4, v2, s[8:11], s54 offen
    s_add_u32 s52, s52, 40
    s_lshr_b32 s53, s52, 5
    s_lshl_b32 s53, s53, 2
    s_lshr_b64 s[54:55], s[6:7], s53
    s_and_b32 s54, s54, 15
    s_lshl_b32 s54, s54, 5
    s_and_b32 s53, s52, 31
    s_add_u32 s54, s54, s53
    s_lshl_b32 s54, s54, 14
    s_add_u32 s54, s54, s51
    s_waitcnt vmcnt(0)
    buffer_load_dword v4, v2, s[8:11], s54 offen
    s_add_u32 s52, s52, 40
    s_cmp_lt_u32 s50, 8
    s_cbranch_scc0 pfskip_58
    s_lshr_b32 s53, s52, 5
    s_lshl_b32 s53, s53, 2
    s_lshr_b64 s[54:55], s[6:7], s53
    s_and_b32 s54, s54, 15
    s_lshl_b32 s54, s54, 5
    s_and_b32 s53, s52, 31
    s_add_u32 s54, s54, s53
    s_lshl_b32 s54, s54, 14
    s_add_u32 s54, s54, s51
    s_waitcnt vmcnt(0)
    buffer_load_dword v4, v2, s[8:11], s54 offen
pfskip_58:
    s_waitcnt vmcnt(0)
    s_cmp_lt_u32 s3, 4
    s_cbranch_scc1 t_cons2
    s_branch t_ld2
t_cons:
    s_and_b32 s46, s3, 1
    s_lshr_b32 s47, s3, 1
    s_lshl_b32 s48, s46, 7
    s_lshl_b32 s49, s62, 8
    s_add_u32 s48, s48, s49
    v_lshlrev_b32 v7, 3, v6
    buffer_load_dwordx2 v[24:25], v7, s[20:23], s48 offen offset:0
    buffer_load_dwordx2 v[26:27], v7, s[20:23], s48 offen offset:32
    buffer_load_dwordx2 v[28:29], v7, s[20:23], s48 offen offset:64
    buffer_load_dwordx2 v[30:31], v7, s[20:23], s48 offen offset:96
    s_lshl_b32 s40, s46, 2
    s_add_u32 s40, s40, 0
    s_lshl_b32 s41, s46, 2
    s_add_u32 s41, s41, 1
    s_lshl_b32 s42, s46, 2
    s_add_u32 s42, s42, 2
    s_lshl_b32 s43, s46, 2
    s_add_u32 s43, s43, 3
    v_lshrrev_b32 v2, 2, v5
    v_and_b32 v3, 1, v6
    v_lshl_add_u32 v3, v3, 2, v2
    v_mad_u32_u24 v2, v6, 8, v2
    v_lshlrev_b32 v2, 8, v2
    v_and_b32 v4, 3, v1
    v_lshl_add_u32 v2, v4, 3, v2
    v_xor_b32 v4, s40, v3
    v_lshl_add_u32 v8, v4, 5, v2
    v_xor_b32 v4, s41, v3
    v_lshl_add_u32 v9, v4, 5, v2
    v_xor_b32 v4, s42, v3
    v_lshl_add_u32 v10, v4, 5, v2
    v_xor_b32 v4, s43, v3
    v_lshl_add_u32 v11, v4, 5, v2
    v_mul_u32_u24 v2, 1536, v6
    v_lshl_add_u32 v2, v5, 4, v2
    s_mul_i32 s48, s47, 768
    v_add_u32 v12, s48, v2
    s_mul_i32 s48, s63, 6
    s_mul_i32 s49, s47, 3
    s_add_u32 s48, s48, s49
    s_lshl_b32 s49, s62, 2
    s_lshl_b32 s50, s46, 1
    s_add_u32 s49, s49, s50
    s_mul_i32 s49, s49, 9
    s_add_u32 s50, s48, 0
    s_mul_i32 s51, s50, 57
    s_lshr_b32 s51, s51, 9
    s_mul_i32 s51, s51, 1287
    s_add_u32 s50, s50, s51
    s_add_u32 s50, s50, s49
    s_lshl_b32 s50, s50, 10
    s_add_u32 s52, s50, 16777216
    s_add_u32 s55, s50, 16786432
    s_add_u32 s50, s48, 1
    s_mul_i32 s51, s50, 57
    s_lshr_b32 s51, s51, 9
    s_mul_i32 s51, s51, 1287
    s_add_u32 s50, s50, s51
    s_add_u32 s50, s50, s49
    s_lshl_b32 s50, s50, 10
    s_add_u32 s53, s50, 16777216
    s_add_u32 s56, s50, 16786432
    s_add_u32 s50, s48, 2
    s_mul_i32 s51, s50, 57
    s_lshr_b32 s51, s51, 9
    s_mul_i32 s51, s51, 1287
    s_add_u32 s50, s50, s51
    s_add_u32 s50, s50, s49
    s_lshl_b32 s50, s50, 10
    s_add_u32 s54, s50, 16777216
    s_add_u32 s57, s50, 16786432
    s_mul_i32 s58, s62, 6
    s_add_u32 s58, s58, s63
    s_lshl_b32 s58, s58, 3
    s_add_u32 s58, s58, s3
    s_lshl_b32 s58, s58, 7
    s_add_u32 s58, s58, 262528
    v_mov_b32 v88, 0
    v_mov_b32 v89, 0
    v_mov_b32 v90, 0
    v_mov_b32 v91, 0
    v_mov_b32 v92, 0
    v_mov_b32 v93, 0
    v_mov_b32 v94, 0
    v_mov_b32 v95, 0
    v_mov_b32 v96, 0
    v_mov_b32 v97, 0
    v_mov_b32 v98, 0
    v_mov_b32 v99, 0
    v_mov_b32 v100, 0
    v_mov_b32 v101, 0
    v_mov_b32 v102, 0
    v_mov_b32 v103, 0
    v_mov_b32 v104, 0
    v_mov_b32 v105, 0
    v_mov_b32 v106, 0
    v_mov_b32 v107, 0
    v_mov_b32 v108, 0
    v_mov_b32 v109, 0
    v_mov_b32 v110, 0
    v_mov_b32 v111, 0
    v_mov_b32 v112, 0
    v_mov_b32 v113, 0
    v_mov_b32 v114, 0
    v_mov_b32 v115, 0
    v_mov_b32 v116, 0
    v_mov_b32 v117, 0
    v_mov_b32 v118, 0
    v_mov_b32 v119, 0
    v_mov_b32 v120, 0
    v_mov_b32 v121, 0
    v_mov_b32 v122, 0
    v_mov_b32 v123, 0
    v_mov_b32 v124, 0
    v_mov_b32 v125, 0
    v_mov_b32 v126, 0
    v_mov_b32 v127, 0
    v_mov_b32 v128, 0
    v_mov_b32 v129, 0
    v_mov_b32 v130, 0
    v_mov_b32 v131, 0
    v_mov_b32 v132, 0
    v_mov_b32 v133, 0
    v_mov_b32 v134, 0
    v_mov_b32 v135, 0
    s_mov_b32 s24, 65536
    s_mov_b32 s4, 12288
    v_add_u32 v16, s24, v8
    v_add_u32 v17, s24, v9
    v_add_u32 v18, s24, v10
    v_add_u32 v19, s24, v11
    v_add_u32 v20, s4, v12
    s_movk_i32 s59, 31
    s_barrier
    ds_read_b128 v[48:51], v20 offset:0
    ds_read_b64_tr_b16 v[32:33], v16 offset:0
    ds_read_b64_tr_b16 v[34:35], v16 offset:1024
    ds_read_b64_tr_b16 v[36:37], v17 offset:0
    ds_read_b64_tr_b16 v[38:39], v17 offset:1024
    ds_read_b64_tr_b16 v[40:41], v18 offset:0
    ds_read_b64_tr_b16 v[42:43], v18 offset:1024
    ds_read_b64_tr_b16 v[44:45], v19 offset:0
    ds_read_b64_tr_b16 v[46:47], v19 offset:1024
    ds_read_b128 v[52:55], v20 offset:256
    ds_read_b128 v[56:59], v20 offset:512
    s_add_u32 s24, s24, 16384
    s_add_u32 s4, s4, 12288
    s_cmp_eq_u32 s24, 163840
    s_cselect_b32 s24, 65536, s24
    s_cmp_eq_u32 s4, 61440
    s_cselect_b32 s4, 0, s4
g1_mm_loop:
    s_waitcnt lgkmcnt(0)
    v_mfma_f32_16x16x32_bf16 v[88:91], v[32:35], v[48:51], v[88:91]
    ds_read_b128 v[76:79], v20 offset:6144
    ds_read_b64_tr_b16 v[60:61], v16 offset:8192
    v_mfma_f32_16x16x32_bf16 v[100:103], v[36:39], v[48:51], v[100:103]
    ds_read_b64_tr_b16 v[62:63], v16 offset:9216
    ds_read_b64_tr_b16 v[64:65], v17 offset:8192
    v_mfma_f32_16x16x32_bf16 v[112:115], v[40:43], v[48:51], v[112:115]
    ds_read_b64_tr_b16 v[66:67], v17 offset:9216
    ds_read_b64_tr_b16 v[68:69], v18 offset:8192
    v_mfma_f32_16x16x32_bf16 v[124:127], v[44:47], v[48:51], v[124:127]
    ds_read_b64_tr_b16 v[70:71], v18 offset:9216
    ds_read_b64_tr_b16 v[72:73], v19 offset:8192
    v_mfma_f32_16x16x32_bf16 v[128:131], v[44:47], v[52:55], v[128:131]
    ds_read_b64_tr_b16 v[74:75], v19 offset:9216
    ds_read_b128 v[80:83], v20 offset:6400
    v_mfma_f32_16x16x32_bf16 v[116:119], v[40:43], v[52:55], v[116:119]
    ds_read_b128 v[84:87], v20 offset:6656
    v_add_u32 v16, s24, v8
    v_mfma_f32_16x16x32_bf16 v[104:107], v[36:39], v[52:55], v[104:107]
    v_add_u32 v17, s24, v9
    v_add_u32 v18, s24, v10
    v_mfma_f32_16x16x32_bf16 v[92:95], v[32:35], v[52:55], v[92:95]
    v_add_u32 v19, s24, v11
    v_add_u32 v20, s4, v12
    v_mfma_f32_16x16x32_bf16 v[96:99], v[32:35], v[56:59], v[96:99]
    v_mfma_f32_16x16x32_bf16 v[108:111], v[36:39], v[56:59], v[108:111]
    s_waitcnt lgkmcnt(0)
    s_barrier
    v_mfma_f32_16x16x32_bf16 v[120:123], v[40:43], v[56:59], v[120:123]
    v_mfma_f32_16x16x32_bf16 v[132:135], v[44:47], v[56:59], v[132:135]
    v_mfma_f32_16x16x32_bf16 v[88:91], v[60:63], v[76:79], v[88:91]
    ds_read_b128 v[48:51], v20 offset:0
    ds_read_b64_tr_b16 v[32:33], v16 offset:0
    v_mfma_f32_16x16x32_bf16 v[100:103], v[64:67], v[76:79], v[100:103]
    ds_read_b64_tr_b16 v[34:35], v16 offset:1024
    ds_read_b64_tr_b16 v[36:37], v17 offset:0
    v_mfma_f32_16x16x32_bf16 v[112:115], v[68:71], v[76:79], v[112:115]
    ds_read_b64_tr_b16 v[38:39], v17 offset:1024
    ds_read_b64_tr_b16 v[40:41], v18 offset:0
    v_mfma_f32_16x16x32_bf16 v[124:127], v[72:75], v[76:79], v[124:127]
    ds_read_b64_tr_b16 v[42:43], v18 offset:1024
    ds_read_b64_tr_b16 v[44:45], v19 offset:0
    v_mfma_f32_16x16x32_bf16 v[128:131], v[72:75], v[80:83], v[128:131]
    ds_read_b64_tr_b16 v[46:47], v19 offset:1024
    ds_read_b128 v[52:55], v20 offset:256
    v_mfma_f32_16x16x32_bf16 v[116:119], v[68:71], v[80:83], v[116:119]
    ds_read_b128 v[56:59], v20 offset:512
    s_add_u32 s24, s24, 16384
    v_mfma_f32_16x16x32_bf16 v[104:107], v[64:67], v[80:83], v[104:107]
    s_add_u32 s4, s4, 12288
    s_cmp_eq_u32 s24, 163840
    v_mfma_f32_16x16x32_bf16 v[92:95], v[60:63], v[80:83], v[92:95]
    s_cselect_b32 s24, 65536, s24
    s_cmp_eq_u32 s4, 61440
    v_mfma_f32_16x16x32_bf16 v[96:99], v[60:63], v[84:87], v[96:99]
    s_cselect_b32 s4, 0, s4
    s_sub_u32 s59, s59, 1
    v_mfma_f32_16x16x32_bf16 v[108:111], v[64:67], v[84:87], v[108:111]
    s_cmp_lg_u32 s59, 0
    v_mfma_f32_16x16x32_bf16 v[120:123], v[68:71], v[84:87], v[120:123]
    v_mfma_f32_16x16x32_bf16 v[132:135], v[72:75], v[84:87], v[132:135]
    s_cbranch_scc1 g1_mm_loop
    s_waitcnt lgkmcnt(0)
    v_mfma_f32_16x16x32_bf16 v[88:91], v[32:35], v[48:51], v[88:91]
    ds_read_b128 v[76:79], v20 offset:6144
    ds_read_b64_tr_b16 v[60:61], v16 offset:8192
    v_mfma_f32_16x16x32_bf16 v[100:103], v[36:39], v[48:51], v[100:103]
    ds_read_b64_tr_b16 v[62:63], v16 offset:9216
    ds_read_b64_tr_b16 v[64:65], v17 offset:8192
    v_mfma_f32_16x16x32_bf16 v[112:115], v[40:43], v[48:51], v[112:115]
    ds_read_b64_tr_b16 v[66:67], v17 offset:9216
    ds_read_b64_tr_b16 v[68:69], v18 offset:8192
    v_mfma_f32_16x16x32_bf16 v[124:127], v[44:47], v[48:51], v[124:127]
    ds_read_b64_tr_b16 v[70:71], v18 offset:9216
    ds_read_b64_tr_b16 v[72:73], v19 offset:8192
    v_mfma_f32_16x16x32_bf16 v[128:131], v[44:47], v[52:55], v[128:131]
    ds_read_b64_tr_b16 v[74:75], v19 offset:9216
    ds_read_b128 v[80:83], v20 offset:6400
    v_mfma_f32_16x16x32_bf16 v[116:119], v[40:43], v[52:55], v[116:119]
    ds_read_b128 v[84:87], v20 offset:6656
    v_mfma_f32_16x16x32_bf16 v[104:107], v[36:39], v[52:55], v[104:107]
    v_mfma_f32_16x16x32_bf16 v[92:95], v[32:35], v[52:55], v[92:95]
    v_mfma_f32_16x16x32_bf16 v[96:99], v[32:35], v[56:59], v[96:99]
    v_mfma_f32_16x16x32_bf16 v[108:111], v[36:39], v[56:59], v[108:111]
    v_mfma_f32_16x16x32_bf16 v[120:123], v[40:43], v[56:59], v[120:123]
    v_mfma_f32_16x16x32_bf16 v[132:135], v[44:47], v[56:59], v[132:135]
    s_waitcnt lgkmcnt(0)
    s_barrier
    v_mfma_f32_16x16x32_bf16 v[88:91], v[60:63], v[76:79], v[88:91]
    v_mfma_f32_16x16x32_bf16 v[100:103], v[64:67], v[76:79], v[100:103]
    v_mfma_f32_16x16x32_bf16 v[112:115], v[68:71], v[76:79], v[112:115]
    v_mfma_f32_16x16x32_bf16 v[124:127], v[72:75], v[76:79], v[124:127]
    v_mfma_f32_16x16x32_bf16 v[128:131], v[72:75], v[80:83], v[128:131]
    v_mfma_f32_16x16x32_bf16 v[116:119], v[68:71], v[80:83], v[116:119]
    v_mfma_f32_16x16x32_bf16 v[104:107], v[64:67], v[80:83], v[104:107]
    v_mfma_f32_16x16x32_bf16 v[92:95], v[60:63], v[80:83], v[92:95]
    v_mfma_f32_16x16x32_bf16 v[96:99], v[60:63], v[84:87], v[96:99]
    v_mfma_f32_16x16x32_bf16 v[108:111], v[64:67], v[84:87], v[108:111]
    v_mfma_f32_16x16x32_bf16 v[120:123], v[68:71], v[84:87], v[120:123]
    v_mfma_f32_16x16x32_bf16 v[132:135], v[72:75], v[84:87], v[132:135]
    s_mov_b32 s42, 0xffff0000
    s_waitcnt vmcnt(0)
    v_lshlrev_b32 v32, 16, v24
    v_and_b32 v33, s42, v24
    v_lshlrev_b32 v34, 16, v25
    v_and_b32 v35, s42, v25
    v_lshlrev_b32 v36, 16, v26
    v_and_b32 v37, s42, v26
    v_lshlrev_b32 v38, 16, v27
    v_and_b32 v39, s42, v27
    v_lshlrev_b32 v40, 16, v28
    v_and_b32 v41, s42, v28
    v_lshlrev_b32 v42, 16, v29
    v_and_b32 v43, s42, v29
    v_lshlrev_b32 v44, 16, v30
    v_and_b32 v45, s42, v30
    v_lshlrev_b32 v46, 16, v31
    v_and_b32 v47, s42, v31
    v_mov_b32 v80, 0xc0135761
    v_mov_b32 v81, 0xc0135761
    v_mov_b32 v82, 0xbdd2d3e8
    v_mov_b32 v83, 0xbdd2d3e8
    v_mov_b32 v84, 0x3f800000
    v_mov_b32 v85, 0x3f800000
    v_pk_add_f32 v[88:89], v[88:89], v[32:33]
    v_pk_add_f32 v[90:91], v[90:91], v[34:35]
    v_pk_add_f32 v[100:101], v[100:101], v[36:37]
    v_pk_add_f32 v[102:103], v[102:103], v[38:39]
    v_pk_mul_f32 v[60:61], v[88:89], v[88:89]
    v_pk_mul_f32 v[62:63], v[90:91], v[90:91]
    v_pk_mul_f32 v[64:65], v[100:101], v[100:101]
    v_pk_mul_f32 v[66:67], v[102:103], v[102:103]
    v_pk_fma_f32 v[60:61], v[60:61], v[82:83], v[80:81]
    v_pk_fma_f32 v[62:63], v[62:63], v[82:83], v[80:81]
    v_pk_fma_f32 v[64:65], v[64:65], v[82:83], v[80:81]
    v_pk_fma_f32 v[66:67], v[66:67], v[82:83], v[80:81]
    v_pk_mul_f32 v[60:61], v[60:61], v[88:89]
    v_pk_mul_f32 v[62:63], v[62:63], v[90:91]
    v_pk_mul_f32 v[64:65], v[64:65], v[100:101]
    v_pk_mul_f32 v[66:67], v[66:67], v[102:103]
    v_exp_f32 v60, v60
    v_exp_f32 v61, v61
    v_exp_f32 v62, v62
    v_exp_f32 v63, v63
    v_exp_f32 v64, v64
    v_exp_f32 v65, v65
    v_exp_f32 v66, v66
    v_exp_f32 v67, v67
    v_pk_add_f32 v[60:61], v[60:61], v[84:85]
    v_pk_add_f32 v[62:63], v[62:63], v[84:85]
    v_pk_add_f32 v[64:65], v[64:65], v[84:85]
    v_pk_add_f32 v[66:67], v[66:67], v[84:85]
    v_rcp_f32 v60, v60
    v_rcp_f32 v61, v61
    v_rcp_f32 v62, v62
    v_rcp_f32 v63, v63
    v_rcp_f32 v64, v64
    v_rcp_f32 v65, v65
    v_rcp_f32 v66, v66
    v_rcp_f32 v67, v67
    v_pk_mul_f32 v[88:89], v[88:89], v[60:61]
    v_pk_mul_f32 v[90:91], v[90:91], v[62:63]
    v_pk_mul_f32 v[100:101], v[100:101], v[64:65]
    v_pk_mul_f32 v[102:103], v[102:103], v[66:67]
    v_cvt_pk_bf16_f32 v72, v88, v89
    v_cvt_pk_bf16_f32 v73, v90, v91
    v_cvt_pk_bf16_f32 v74, v100, v101
    v_cvt_pk_bf16_f32 v75, v102, v103
    buffer_store_dwordx4 v[72:75], v14, s[28:31], s52 offen sc1
    v_pk_add_f32 v[112:113], v[112:113], v[40:41]
    v_pk_add_f32 v[114:115], v[114:115], v[42:43]
    v_pk_add_f32 v[124:125], v[124:125], v[44:45]
    v_pk_add_f32 v[126:127], v[126:127], v[46:47]
    v_pk_mul_f32 v[60:61], v[112:113], v[112:113]
    v_pk_mul_f32 v[62:63], v[114:115], v[114:115]
    v_pk_mul_f32 v[64:65], v[124:125], v[124:125]
    v_pk_mul_f32 v[66:67], v[126:127], v[126:127]
    v_pk_fma_f32 v[60:61], v[60:61], v[82:83], v[80:81]
    v_pk_fma_f32 v[62:63], v[62:63], v[82:83], v[80:81]
    v_pk_fma_f32 v[64:65], v[64:65], v[82:83], v[80:81]
    v_pk_fma_f32 v[66:67], v[66:67], v[82:83], v[80:81]
    v_pk_mul_f32 v[60:61], v[60:61], v[112:113]
    v_pk_mul_f32 v[62:63], v[62:63], v[114:115]
    v_pk_mul_f32 v[64:65], v[64:65], v[124:125]
    v_pk_mul_f32 v[66:67], v[66:67], v[126:127]
    v_exp_f32 v60, v60
    v_exp_f32 v61, v61
    v_exp_f32 v62, v62
    v_exp_f32 v63, v63
    v_exp_f32 v64, v64
    v_exp_f32 v65, v65
    v_exp_f32 v66, v66
    v_exp_f32 v67, v67
    v_pk_add_f32 v[60:61], v[60:61], v[84:85]
    v_pk_add_f32 v[62:63], v[62:63], v[84:85]
    v_pk_add_f32 v[64:65], v[64:65], v[84:85]
    v_pk_add_f32 v[66:67], v[66:67], v[84:85]
    v_rcp_f32 v60, v60
    v_rcp_f32 v61, v61
    v_rcp_f32 v62, v62
    v_rcp_f32 v63, v63
    v_rcp_f32 v64, v64
    v_rcp_f32 v65, v65
    v_rcp_f32 v66, v66
    v_rcp_f32 v67, v67
    v_pk_mul_f32 v[112:113], v[112:113], v[60:61]
    v_pk_mul_f32 v[114:115], v[114:115], v[62:63]
    v_pk_mul_f32 v[124:125], v[124:125], v[64:65]
    v_pk_mul_f32 v[126:127], v[126:127], v[66:67]
    v_cvt_pk_bf16_f32 v76, v112, v113
    v_cvt_pk_bf16_f32 v77, v114, v115
    v_cvt_pk_bf16_f32 v78, v124, v125
    v_cvt_pk_bf16_f32 v79, v126, v127
    buffer_store_dwordx4 v[76:79], v14, s[28:31], s55 offen sc1
    v_pk_add_f32 v[92:93], v[92:93], v[32:33]
    v_pk_add_f32 v[94:95], v[94:95], v[34:35]
    v_pk_add_f32 v[104:105], v[104:105], v[36:37]
    v_pk_add_f32 v[106:107], v[106:107], v[38:39]
    v_pk_mul_f32 v[60:61], v[92:93], v[92:93]
    v_pk_mul_f32 v[62:63], v[94:95], v[94:95]
    v_pk_mul_f32 v[64:65], v[104:105], v[104:105]
    v_pk_mul_f32 v[66:67], v[106:107], v[106:107]
    v_pk_fma_f32 v[60:61], v[60:61], v[82:83], v[80:81]
    v_pk_fma_f32 v[62:63], v[62:63], v[82:83], v[80:81]
    v_pk_fma_f32 v[64:65], v[64:65], v[82:83], v[80:81]
    v_pk_fma_f32 v[66:67], v[66:67], v[82:83], v[80:81]
    v_pk_mul_f32 v[60:61], v[60:61], v[92:93]
    v_pk_mul_f32 v[62:63], v[62:63], v[94:95]
    v_pk_mul_f32 v[64:65], v[64:65], v[104:105]
    v_pk_mul_f32 v[66:67], v[66:67], v[106:107]
    v_exp_f32 v60, v60
    v_exp_f32 v61, v61
    v_exp_f32 v62, v62
    v_exp_f32 v63, v63
    v_exp_f32 v64, v64
    v_exp_f32 v65, v65
    v_exp_f32 v66, v66
    v_exp_f32 v67, v67
    v_pk_add_f32 v[60:61], v[60:61], v[84:85]
    v_pk_add_f32 v[62:63], v[62:63], v[84:85]
    v_pk_add_f32 v[64:65], v[64:65], v[84:85]
    v_pk_add_f32 v[66:67], v[66:67], v[84:85]
    v_rcp_f32 v60, v60
    v_rcp_f32 v61, v61
    v_rcp_f32 v62, v62
    v_rcp_f32 v63, v63
    v_rcp_f32 v64, v64
    v_rcp_f32 v65, v65
    v_rcp_f32 v66, v66
    v_rcp_f32 v67, v67
    v_pk_mul_f32 v[92:93], v[92:93], v[60:61]
    v_pk_mul_f32 v[94:95], v[94:95], v[62:63]
    v_pk_mul_f32 v[104:105], v[104:105], v[64:65]
    v_pk_mul_f32 v[106:107], v[106:107], v[66:67]
    v_cvt_pk_bf16_f32 v72, v92, v93
    v_cvt_pk_bf16_f32 v73, v94, v95
    v_cvt_pk_bf16_f32 v74, v104, v105
    v_cvt_pk_bf16_f32 v75, v106, v107
    buffer_store_dwordx4 v[72:75], v14, s[28:31], s53 offen sc1
    v_pk_add_f32 v[116:117], v[116:117], v[40:41]
    v_pk_add_f32 v[118:119], v[118:119], v[42:43]
    v_pk_add_f32 v[128:129], v[128:129], v[44:45]
    v_pk_add_f32 v[130:131], v[130:131], v[46:47]
    v_pk_mul_f32 v[60:61], v[116:117], v[116:117]
    v_pk_mul_f32 v[62:63], v[118:119], v[118:119]
    v_pk_mul_f32 v[64:65], v[128:129], v[128:129]
    v_pk_mul_f32 v[66:67], v[130:131], v[130:131]
    v_pk_fma_f32 v[60:61], v[60:61], v[82:83], v[80:81]
    v_pk_fma_f32 v[62:63], v[62:63], v[82:83], v[80:81]
    v_pk_fma_f32 v[64:65], v[64:65], v[82:83], v[80:81]
    v_pk_fma_f32 v[66:67], v[66:67], v[82:83], v[80:81]
    v_pk_mul_f32 v[60:61], v[60:61], v[116:117]
    v_pk_mul_f32 v[62:63], v[62:63], v[118:119]
    v_pk_mul_f32 v[64:65], v[64:65], v[128:129]
    v_pk_mul_f32 v[66:67], v[66:67], v[130:131]
    v_exp_f32 v60, v60
    v_exp_f32 v61, v61
    v_exp_f32 v62, v62
    v_exp_f32 v63, v63
    v_exp_f32 v64, v64
    v_exp_f32 v65, v65
    v_exp_f32 v66, v66
    v_exp_f32 v67, v67
    v_pk_add_f32 v[60:61], v[60:61], v[84:85]
    v_pk_add_f32 v[62:63], v[62:63], v[84:85]
    v_pk_add_f32 v[64:65], v[64:65], v[84:85]
    v_pk_add_f32 v[66:67], v[66:67], v[84:85]
    v_rcp_f32 v60, v60
    v_rcp_f32 v61, v61
    v_rcp_f32 v62, v62
    v_rcp_f32 v63, v63
    v_rcp_f32 v64, v64
    v_rcp_f32 v65, v65
    v_rcp_f32 v66, v66
    v_rcp_f32 v67, v67
    v_pk_mul_f32 v[116:117], v[116:117], v[60:61]
    v_pk_mul_f32 v[118:119], v[118:119], v[62:63]
    v_pk_mul_f32 v[128:129], v[128:129], v[64:65]
    v_pk_mul_f32 v[130:131], v[130:131], v[66:67]
    v_cvt_pk_bf16_f32 v76, v116, v117
    v_cvt_pk_bf16_f32 v77, v118, v119
    v_cvt_pk_bf16_f32 v78, v128, v129
    v_cvt_pk_bf16_f32 v79, v130, v131
    buffer_store_dwordx4 v[76:79], v14, s[28:31], s56 offen sc1
    v_pk_add_f32 v[96:97], v[96:97], v[32:33]
    v_pk_add_f32 v[98:99], v[98:99], v[34:35]
    v_pk_add_f32 v[108:109], v[108:109], v[36:37]
    v_pk_add_f32 v[110:111], v[110:111], v[38:39]
    v_pk_mul_f32 v[60:61], v[96:97], v[96:97]
    v_pk_mul_f32 v[62:63], v[98:99], v[98:99]
    v_pk_mul_f32 v[64:65], v[108:109], v[108:109]
    v_pk_mul_f32 v[66:67], v[110:111], v[110:111]
    v_pk_fma_f32 v[60:61], v[60:61], v[82:83], v[80:81]
    v_pk_fma_f32 v[62:63], v[62:63], v[82:83], v[80:81]
    v_pk_fma_f32 v[64:65], v[64:65], v[82:83], v[80:81]
    v_pk_fma_f32 v[66:67], v[66:67], v[82:83], v[80:81]
    v_pk_mul_f32 v[60:61], v[60:61], v[96:97]
    v_pk_mul_f32 v[62:63], v[62:63], v[98:99]
    v_pk_mul_f32 v[64:65], v[64:65], v[108:109]
    v_pk_mul_f32 v[66:67], v[66:67], v[110:111]
    v_exp_f32 v60, v60
    v_exp_f32 v61, v61
    v_exp_f32 v62, v62
    v_exp_f32 v63, v63
    v_exp_f32 v64, v64
    v_exp_f32 v65, v65
    v_exp_f32 v66, v66
    v_exp_f32 v67, v67
    v_pk_add_f32 v[60:61], v[60:61], v[84:85]
    v_pk_add_f32 v[62:63], v[62:63], v[84:85]
    v_pk_add_f32 v[64:65], v[64:65], v[84:85]
    v_pk_add_f32 v[66:67], v[66:67], v[84:85]
    v_rcp_f32 v60, v60
    v_rcp_f32 v61, v61
    v_rcp_f32 v62, v62
    v_rcp_f32 v63, v63
    v_rcp_f32 v64, v64
    v_rcp_f32 v65, v65
    v_rcp_f32 v66, v66
    v_rcp_f32 v67, v67
    v_pk_mul_f32 v[96:97], v[96:97], v[60:61]
    v_pk_mul_f32 v[98:99], v[98:99], v[62:63]
    v_pk_mul_f32 v[108:109], v[108:109], v[64:65]
    v_pk_mul_f32 v[110:111], v[110:111], v[66:67]
    v_cvt_pk_bf16_f32 v72, v96, v97
    v_cvt_pk_bf16_f32 v73, v98, v99
    v_cvt_pk_bf16_f32 v74, v108, v109
    v_cvt_pk_bf16_f32 v75, v110, v111
    buffer_store_dwordx4 v[72:75], v14, s[28:31], s54 offen sc1
    v_pk_add_f32 v[120:121], v[120:121], v[40:41]
    v_pk_add_f32 v[122:123], v[122:123], v[42:43]
    v_pk_add_f32 v[132:133], v[132:133], v[44:45]
    v_pk_add_f32 v[134:135], v[134:135], v[46:47]
    v_pk_mul_f32 v[60:61], v[120:121], v[120:121]
    v_pk_mul_f32 v[62:63], v[122:123], v[122:123]
    v_pk_mul_f32 v[64:65], v[132:133], v[132:133]
    v_pk_mul_f32 v[66:67], v[134:135], v[134:135]
    v_pk_fma_f32 v[60:61], v[60:61], v[82:83], v[80:81]
    v_pk_fma_f32 v[62:63], v[62:63], v[82:83], v[80:81]
    v_pk_fma_f32 v[64:65], v[64:65], v[82:83], v[80:81]
    v_pk_fma_f32 v[66:67], v[66:67], v[82:83], v[80:81]
    v_pk_mul_f32 v[60:61], v[60:61], v[120:121]
    v_pk_mul_f32 v[62:63], v[62:63], v[122:123]
    v_pk_mul_f32 v[64:65], v[64:65], v[132:133]
    v_pk_mul_f32 v[66:67], v[66:67], v[134:135]
    v_exp_f32 v60, v60
    v_exp_f32 v61, v61
    v_exp_f32 v62, v62
    v_exp_f32 v63, v63
    v_exp_f32 v64, v64
    v_exp_f32 v65, v65
    v_exp_f32 v66, v66
    v_exp_f32 v67, v67
    v_pk_add_f32 v[60:61], v[60:61], v[84:85]
    v_pk_add_f32 v[62:63], v[62:63], v[84:85]
    v_pk_add_f32 v[64:65], v[64:65], v[84:85]
    v_pk_add_f32 v[66:67], v[66:67], v[84:85]
    v_rcp_f32 v60, v60
    v_rcp_f32 v61, v61
    v_rcp_f32 v62, v62
    v_rcp_f32 v63, v63
    v_rcp_f32 v64, v64
    v_rcp_f32 v65, v65
    v_rcp_f32 v66, v66
    v_rcp_f32 v67, v67
    v_pk_mul_f32 v[120:121], v[120:121], v[60:61]
    v_pk_mul_f32 v[122:123], v[122:123], v[62:63]
    v_pk_mul_f32 v[132:133], v[132:133], v[64:65]
    v_pk_mul_f32 v[134:135], v[134:135], v[66:67]
    v_cvt_pk_bf16_f32 v76, v120, v121
    v_cvt_pk_bf16_f32 v77, v122, v123
    v_cvt_pk_bf16_f32 v78, v132, v133
    v_cvt_pk_bf16_f32 v79, v134, v135
    buffer_store_dwordx4 v[76:79], v14, s[28:31], s57 offen sc1
    v_mov_b32 v3, 1
    s_waitcnt vmcnt(0)
    s_mov_b64 exec, 1
    buffer_store_dword v3, off, s[28:31], s58 sc1
    s_mov_b64 exec, -1
    s_barrier
t_cons2:
    s_lshr_b32 s44, s36, 1
    s_and_b32 s45, s36, 1
    s_lshl_b32 s45, s45, 3
    s_lshr_b32 s46, s37, 2
    s_add_u32 s45, s45, s46
    s_and_b32 s46, s37, 3
    s_lshr_b32 s47, s44, 1
    s_and_b32 s48, s44, 1
    s_lshl_b32 s40, s3, 1
    s_add_u32 s40, s40, s47
    s_xor_b32 s41, s40, 1
    v_lshrrev_b32 v2, 2, v5
    v_and_b32 v3, 1, v6
    v_lshl_add_u32 v3, v3, 2, v2
    v_mad_u32_u24 v2, v6, 4, v2
    v_lshlrev_b32 v2, 8, v2
    v_and_b32 v4, 3, v1
    v_lshl_add_u32 v2, v4, 3, v2
    v_xor_b32 v4, s40, v3
    v_lshl_add_u32 v8, v4, 5, v2
    v_xor_b32 v4, s41, v3
    v_lshl_add_u32 v9, v4, 5, v2
    s_lshl_b32 s42, s48, 12
    s_add_u32 s43, s42, 81920
    v_add_u32 v10, s43, v14
    s_xor_b32 s43, s43, 4096
    v_add_u32 v11, s43, v14
    v_add_u32 v12, 90112, v14
    s_lshl_b32 s49, s45, 3
    s_add_u32 s49, s49, s40
    s_lshl_b32 s49, s49, 4
    v_add_u32 v2, s49, v5
    v_mov_b32 v230, 0
    v_lshlrev_b32 v3, 1, v2
    buffer_load_short_d16_hi v230, v3, s[12:15], 0 offen
    v_mul_u32_u24 v2, 1152, v2
    v_lshl_add_u32 v22, v6, 3, v2
    s_mul_i32 s49, s46, 288
    s_lshl_b32 s52, s48, 7
    s_add_u32 s52, s52, s49
    s_lshl_b32 s53, s48, 2
    s_add_u32 s53, s53, s49
    s_add_u32 s53, s53, 256
    s_add_u32 s54, s52, 10485760
    s_add_u32 s55, s53, 10485760
    v_lshlrev_b32 v3, 4, v6
    s_lshl_b32 s56, s52, 1
    s_add_u32 s56, s56, 11520
    s_lshl_b32 s57, s53, 1
    s_add_u32 s57, s57, 11520
    v_mov_b32 v115, s26
    v_mov_b32 v119, s26
    v_mov_b32 v123, s26
    v_mov_b32 v235, s26
    v_mov_b32 v239, s26
    v_mov_b32 v243, s26
    v_mov_b32 v247, s26
    v_mov_b32 v251, s26
    v_mov_b32 v255, s26
    s_lshl_b32 s50, s46, 4
    s_add_u32 s50, s50, s45
    s_lshl_b32 s50, s50, 2
    s_add_u32 s50, s50, s3
    s_lshl_b32 s50, s50, 4
    s_xor_b32 s51, s44, 1
    s_lshl_b32 s61, s51, 2
    s_add_u32 s61, s61, s44
    s_add_u32 s61, s61, s50
    s_mul_i32 s61, s61, 3072
    s_add_u32 s61, s61, 25165824
    s_lshl_b32 s5, s44, 2
    s_add_u32 s5, s5, s51
    s_add_u32 s5, s5, s50
    s_mul_i32 s5, s5, 3072
    s_add_u32 s5, s5, 25165824
    s_xor_b32 s51, s44, 2
    s_lshl_b32 s62, s51, 2
    s_add_u32 s62, s62, s44
    s_add_u32 s62, s62, s50
    s_mul_i32 s62, s62, 3072
    s_add_u32 s62, s62, 25165824
    s_lshl_b32 s6, s44, 2
    s_add_u32 s6, s6, s51
    s_add_u32 s6, s6, s50
    s_mul_i32 s6, s6, 3072
    s_add_u32 s6, s6, 25165824
    s_xor_b32 s51, s44, 3
    s_lshl_b32 s63, s51, 2
    s_add_u32 s63, s63, s44
    s_add_u32 s63, s63, s50
    s_mul_i32 s63, s63, 3072
    s_add_u32 s63, s63, 25165824
    s_lshl_b32 s7, s44, 2
    s_add_u32 s7, s7, s51
    s_add_u32 s7, s7, s50
    s_mul_i32 s7, s7, 3072
    s_add_u32 s7, s7, 25165824
    v_mov_b32 v23, s5
    v_writelane_b32 v23, s6, 1
    v_writelane_b32 v23, s7, 2
    s_cmp_lt_u32 s2, 216
    s_cbranch_scc0 g2_late_ops
    buffer_load_dwordx2 v[200:201], v22, s[28:31], s54 offen offset:0
    buffer_load_dwordx2 v[202:203], v22, s[28:31], s54 offen offset:32
    buffer_load_dwordx2 v[204:205], v22, s[28:31], s54 offen offset:64
    buffer_load_dwordx2 v[206:207], v22, s[28:31], s54 offen offset:96
    buffer_load_dword v208, v22, s[28:31], s55 offen
    buffer_load_dwordx4 v[210:213], v3, s[28:31], s56 offen offset:0
    buffer_load_dwordx4 v[214:217], v3, s[28:31], s56 offen offset:64
    buffer_load_dwordx4 v[218:221], v3, s[28:31], s56 offen offset:128
    buffer_load_dwordx4 v[222:225], v3, s[28:31], s56 offen offset:192
    buffer_load_dwordx2 v[226:227], v3, s[28:31], s57 offen
g2_late_ops:
    v_mov_b32 v128, 0
    v_mov_b32 v129, 0
    v_mov_b32 v130, 0
    v_mov_b32 v131, 0
    v_mov_b32 v132, 0
    v_mov_b32 v133, 0
    v_mov_b32 v134, 0
    v_mov_b32 v135, 0
    v_mov_b32 v136, 0
    v_mov_b32 v137, 0
    v_mov_b32 v138, 0
    v_mov_b32 v139, 0
    v_mov_b32 v140, 0
    v_mov_b32 v141, 0
    v_mov_b32 v142, 0
    v_mov_b32 v143, 0
    v_mov_b32 v144, 0
    v_mov_b32 v145, 0
    v_mov_b32 v146, 0
    v_mov_b32 v147, 0
    v_mov_b32 v148, 0
    v_mov_b32 v149, 0
    v_mov_b32 v150, 0
    v_mov_b32 v151, 0
    v_mov_b32 v152, 0
    v_mov_b32 v153, 0
    v_mov_b32 v154, 0
    v_mov_b32 v155, 0
    v_mov_b32 v156, 0
    v_mov_b32 v157, 0
    v_mov_b32 v158, 0
    v_mov_b32 v159, 0
    v_mov_b32 v160, 0
    v_mov_b32 v161, 0
    v_mov_b32 v162, 0
    v_mov_b32 v163, 0
    v_mov_b32 v164, 0
    v_mov_b32 v165, 0
    v_mov_b32 v166, 0
    v_mov_b32 v167, 0
    v_mov_b32 v168, 0
    v_mov_b32 v169, 0
    v_mov_b32 v170, 0
    v_mov_b32 v171, 0
    v_mov_b32 v172, 0
    v_mov_b32 v173, 0
    v_mov_b32 v174, 0
    v_mov_b32 v175, 0
    v_mov_b32 v176, 0
    v_mov_b32 v177, 0
    v_mov_b32 v178, 0
    v_mov_b32 v179, 0
    v_mov_b32 v180, 0
    v_mov_b32 v181, 0
    v_mov_b32 v182, 0
    v_mov_b32 v183, 0
    v_mov_b32 v184, 0
    v_mov_b32 v185, 0
    v_mov_b32 v186, 0
    v_mov_b32 v187, 0
    v_mov_b32 v188, 0
    v_mov_b32 v189, 0
    v_mov_b32 v190, 0
    v_mov_b32 v191, 0
    v_mov_b32 v192, 0
    v_mov_b32 v193, 0
    v_mov_b32 v194, 0
    v_mov_b32 v195, 0
    v_mov_b32 v196, 0
    v_mov_b32 v197, 0
    v_mov_b32 v198, 0
    v_mov_b32 v199, 0
    s_mov_b32 s24, 0
    s_mov_b32 s4, 0
    v_add_u32 v16, s24, v8
    v_add_u32 v17, s24, v9
    v_add_u32 v18, s4, v10
    v_add_u32 v19, s4, v11
    v_add_u32 v20, s4, v12
    s_movk_i32 s59, 17
    s_barrier
    ds_read_b128 v[32:35], v18 offset:0
    ds_read_b64_tr_b16 v[24:25], v16 offset:0
    ds_read_b64_tr_b16 v[26:27], v16 offset:4096
    ds_read_b64_tr_b16 v[28:29], v17 offset:0
    ds_read_b64_tr_b16 v[30:31], v17 offset:4096
    ds_read_b128 v[36:39], v18 offset:1024
    ds_read_b128 v[40:43], v18 offset:2048
    ds_read_b128 v[44:47], v18 offset:3072
    ds_read_b128 v[48:51], v19 offset:0
    ds_read_b128 v[52:55], v19 offset:1024
    ds_read_b128 v[56:59], v19 offset:2048
    ds_read_b128 v[60:63], v19 offset:3072
    ds_read_b128 v[64:67], v20 offset:0
    s_cmp_lt_u32 s2, 216
    s_cbranch_scc1 g2_late_done
    buffer_load_dwordx2 v[200:201], v22, s[28:31], s54 offen offset:0
    buffer_load_dwordx2 v[202:203], v22, s[28:31], s54 offen offset:32
    buffer_load_dwordx2 v[204:205], v22, s[28:31], s54 offen offset:64
    buffer_load_dwordx2 v[206:207], v22, s[28:31], s54 offen offset:96
    buffer_load_dword v208, v22, s[28:31], s55 offen
    buffer_load_dwordx4 v[210:213], v3, s[28:31], s56 offen offset:0
    buffer_load_dwordx4 v[214:217], v3, s[28:31], s56 offen offset:64
    buffer_load_dwordx4 v[218:221], v3, s[28:31], s56 offen offset:128
    buffer_load_dwordx4 v[222:225], v3, s[28:31], s56 offen offset:192
    buffer_load_dwordx2 v[226:227], v3, s[28:31], s57 offen
g2_late_done:
    s_add_u32 s24, s24, 16384
    s_cmp_eq_u32 s24, 81920
    s_cselect_b32 s24, 0, s24
    s_add_u32 s4, s4, 18432
    s_cmp_eq_u32 s4, 73728
    s_cselect_b32 s4, 0, s4
g2_mm_loop:
    s_waitcnt lgkmcnt(0)
    v_mfma_f32_16x16x32_bf16 v[128:131], v[32:35], v[24:27], v[128:131]
    ds_read_b128 v[76:79], v18 offset:9216
    ds_read_b64_tr_b16 v[68:69], v16 offset:8192
    v_mfma_f32_16x16x32_bf16 v[164:167], v[32:35], v[28:31], v[164:167]
    ds_read_b64_tr_b16 v[70:71], v16 offset:12288
    ds_read_b64_tr_b16 v[72:73], v17 offset:8192
    v_mfma_f32_16x16x32_bf16 v[168:171], v[36:39], v[28:31], v[168:171]
    ds_read_b64_tr_b16 v[74:75], v17 offset:12288
    ds_read_b128 v[80:83], v18 offset:10240
    v_mfma_f32_16x16x32_bf16 v[132:135], v[36:39], v[24:27], v[132:135]
    ds_read_b128 v[84:87], v18 offset:11264
    ds_read_b128 v[88:91], v18 offset:12288
    v_mfma_f32_16x16x32_bf16 v[136:139], v[40:43], v[24:27], v[136:139]
    ds_read_b128 v[92:95], v19 offset:9216
    ds_read_b128 v[96:99], v19 offset:10240
    v_mfma_f32_16x16x32_bf16 v[172:175], v[40:43], v[28:31], v[172:175]
    ds_read_b128 v[100:103], v19 offset:11264
    ds_read_b128 v[104:107], v19 offset:12288
    v_mfma_f32_16x16x32_bf16 v[176:179], v[44:47], v[28:31], v[176:179]
    ds_read_b128 v[108:111], v20 offset:9216
    v_add_u32 v16, s24, v8
    v_mfma_f32_16x16x32_bf16 v[140:143], v[44:47], v[24:27], v[140:143]
    v_add_u32 v17, s24, v9
    v_add_u32 v18, s4, v10
    v_mfma_f32_16x16x32_bf16 v[144:147], v[48:51], v[24:27], v[144:147]
    v_add_u32 v19, s4, v11
    v_add_u32 v20, s4, v12
    v_mfma_f32_16x16x32_bf16 v[180:183], v[48:51], v[28:31], v[180:183]
    v_mfma_f32_16x16x32_bf16 v[184:187], v[52:55], v[28:31], v[184:187]
    v_mfma_f32_16x16x32_bf16 v[148:151], v[52:55], v[24:27], v[148:151]
    v_mfma_f32_16x16x32_bf16 v[152:155], v[56:59], v[24:27], v[152:155]
    v_mfma_f32_16x16x32_bf16 v[188:191], v[56:59], v[28:31], v[188:191]
    v_mfma_f32_16x16x32_bf16 v[192:195], v[60:63], v[28:31], v[192:195]
    v_mfma_f32_16x16x32_bf16 v[156:159], v[60:63], v[24:27], v[156:159]
    s_waitcnt lgkmcnt(0)
    s_barrier
    v_mfma_f32_16x16x32_bf16 v[160:163], v[64:67], v[24:27], v[160:163]
    v_mfma_f32_16x16x32_bf16 v[196:199], v[64:67], v[28:31], v[196:199]
    v_mfma_f32_16x16x32_bf16 v[128:131], v[76:79], v[68:71], v[128:131]
    ds_read_b128 v[32:35], v18 offset:0
    ds_read_b64_tr_b16 v[24:25], v16 offset:0
    v_mfma_f32_16x16x32_bf16 v[164:167], v[76:79], v[72:75], v[164:167]
    ds_read_b64_tr_b16 v[26:27], v16 offset:4096
    ds_read_b64_tr_b16 v[28:29], v17 offset:0
    v_mfma_f32_16x16x32_bf16 v[168:171], v[80:83], v[72:75], v[168:171]
    ds_read_b64_tr_b16 v[30:31], v17 offset:4096
    ds_read_b128 v[36:39], v18 offset:1024
    v_mfma_f32_16x16x32_bf16 v[132:135], v[80:83], v[68:71], v[132:135]
    ds_read_b128 v[40:43], v18 offset:2048
    ds_read_b128 v[44:47], v18 offset:3072
    v_mfma_f32_16x16x32_bf16 v[136:139], v[84:87], v[68:71], v[136:139]
    ds_read_b128 v[48:51], v19 offset:0
    ds_read_b128 v[52:55], v19 offset:1024
    v_mfma_f32_16x16x32_bf16 v[172:175], v[84:87], v[72:75], v[172:175]
    ds_read_b128 v[56:59], v19 offset:2048
    ds_read_b128 v[60:63], v19 offset:3072
    v_mfma_f32_16x16x32_bf16 v[176:179], v[88:91], v[72:75], v[176:179]
    ds_read_b128 v[64:67], v20 offset:0
    s_add_u32 s24, s24, 16384
    v_mfma_f32_16x16x32_bf16 v[140:143], v[88:91], v[68:71], v[140:143]
    s_cmp_eq_u32 s24, 81920
    s_cselect_b32 s24, 0, s24
    v_mfma_f32_16x16x32_bf16 v[144:147], v[92:95], v[68:71], v[144:147]
    s_add_u32 s4, s4, 18432
    s_cmp_eq_u32 s4, 73728
    v_mfma_f32_16x16x32_bf16 v[180:183], v[92:95], v[72:75], v[180:183]
    s_cselect_b32 s4, 0, s4
    s_sub_u32 s59, s59, 1
    v_mfma_f32_16x16x32_bf16 v[184:187], v[96:99], v[72:75], v[184:187]
    s_cmp_lg_u32 s59, 0
    v_mfma_f32_16x16x32_bf16 v[148:151], v[96:99], v[68:71], v[148:151]
    v_mfma_f32_16x16x32_bf16 v[152:155], v[100:103], v[68:71], v[152:155]
    v_mfma_f32_16x16x32_bf16 v[188:191], v[100:103], v[72:75], v[188:191]
    v_mfma_f32_16x16x32_bf16 v[192:195], v[104:107], v[72:75], v[192:195]
    v_mfma_f32_16x16x32_bf16 v[156:159], v[104:107], v[68:71], v[156:159]
    v_mfma_f32_16x16x32_bf16 v[160:163], v[108:111], v[68:71], v[160:163]
    v_mfma_f32_16x16x32_bf16 v[196:199], v[108:111], v[72:75], v[196:199]
    s_cbranch_scc1 g2_mm_loop
    s_waitcnt lgkmcnt(0)
    v_mfma_f32_16x16x32_bf16 v[128:131], v[32:35], v[24:27], v[128:131]
    ds_read_b128 v[76:79], v18 offset:9216
    ds_read_b64_tr_b16 v[68:69], v16 offset:8192
    v_mfma_f32_16x16x32_bf16 v[164:167], v[32:35], v[28:31], v[164:167]
    ds_read_b64_tr_b16 v[70:71], v16 offset:12288
    ds_read_b64_tr_b16 v[72:73], v17 offset:8192
    v_mfma_f32_16x16x32_bf16 v[168:171], v[36:39], v[28:31], v[168:171]
    ds_read_b64_tr_b16 v[74:75], v17 offset:12288
    ds_read_b128 v[80:83], v18 offset:10240
    v_mfma_f32_16x16x32_bf16 v[132:135], v[36:39], v[24:27], v[132:135]
    ds_read_b128 v[84:87], v18 offset:11264
    ds_read_b128 v[88:91], v18 offset:12288
    v_mfma_f32_16x16x32_bf16 v[136:139], v[40:43], v[24:27], v[136:139]
    ds_read_b128 v[92:95], v19 offset:9216
    ds_read_b128 v[96:99], v19 offset:10240
    v_mfma_f32_16x16x32_bf16 v[172:175], v[40:43], v[28:31], v[172:175]
    ds_read_b128 v[100:103], v19 offset:11264
    ds_read_b128 v[104:107], v19 offset:12288
    v_mfma_f32_16x16x32_bf16 v[176:179], v[44:47], v[28:31], v[176:179]
    ds_read_b128 v[108:111], v20 offset:9216
    v_mfma_f32_16x16x32_bf16 v[140:143], v[44:47], v[24:27], v[140:143]
    v_mfma_f32_16x16x32_bf16 v[144:147], v[48:51], v[24:27], v[144:147]
    v_mfma_f32_16x16x32_bf16 v[180:183], v[48:51], v[28:31], v[180:183]
    v_mfma_f32_16x16x32_bf16 v[184:187], v[52:55], v[28:31], v[184:187]
    v_mfma_f32_16x16x32_bf16 v[148:151], v[52:55], v[24:27], v[148:151]
    v_mfma_f32_16x16x32_bf16 v[152:155], v[56:59], v[24:27], v[152:155]
    v_mfma_f32_16x16x32_bf16 v[188:191], v[56:59], v[28:31], v[188:191]
    v_mfma_f32_16x16x32_bf16 v[192:195], v[60:63], v[28:31], v[192:195]
    v_mfma_f32_16x16x32_bf16 v[156:159], v[60:63], v[24:27], v[156:159]
    v_mfma_f32_16x16x32_bf16 v[160:163], v[64:67], v[24:27], v[160:163]
    v_mfma_f32_16x16x32_bf16 v[196:199], v[64:67], v[28:31], v[196:199]
    s_waitcnt lgkmcnt(0)
    v_mfma_f32_16x16x32_bf16 v[128:131], v[76:79], v[68:71], v[128:131]
    v_mfma_f32_16x16x32_bf16 v[164:167], v[76:79], v[72:75], v[164:167]
    v_mfma_f32_16x16x32_bf16 v[168:171], v[80:83], v[72:75], v[168:171]
    v_mfma_f32_16x16x32_bf16 v[132:135], v[80:83], v[68:71], v[132:135]
    v_mfma_f32_16x16x32_bf16 v[136:139], v[84:87], v[68:71], v[136:139]
    v_mfma_f32_16x16x32_bf16 v[172:175], v[84:87], v[72:75], v[172:175]
    v_mfma_f32_16x16x32_bf16 v[176:179], v[88:91], v[72:75], v[176:179]
    v_mfma_f32_16x16x32_bf16 v[140:143], v[88:91], v[68:71], v[140:143]
    v_mfma_f32_16x16x32_bf16 v[144:147], v[92:95], v[68:71], v[144:147]
    v_mfma_f32_16x16x32_bf16 v[180:183], v[92:95], v[72:75], v[180:183]
    v_mfma_f32_16x16x32_bf16 v[184:187], v[96:99], v[72:75], v[184:187]
    v_mfma_f32_16x16x32_bf16 v[148:151], v[96:99], v[68:71], v[148:151]
    v_mfma_f32_16x16x32_bf16 v[152:155], v[100:103], v[68:71], v[152:155]
    v_mfma_f32_16x16x32_bf16 v[188:191], v[100:103], v[72:75], v[188:191]
    v_mfma_f32_16x16x32_bf16 v[192:195], v[104:107], v[72:75], v[192:195]
    v_mfma_f32_16x16x32_bf16 v[156:159], v[104:107], v[68:71], v[156:159]
    v_mfma_f32_16x16x32_bf16 v[160:163], v[108:111], v[68:71], v[160:163]
    v_mfma_f32_16x16x32_bf16 v[196:199], v[108:111], v[72:75], v[196:199]
    s_cmp_eq_u32 s48, 1
    s_cbranch_scc0 g2_noswap
    s_nop 4
    v_swap_b32 v160, v162
    v_swap_b32 v161, v163
    v_swap_b32 v196, v198
    v_swap_b32 v197, v199
g2_noswap:
    v_cvt_pk_bf16_f32 v112, v144, v145
    v_cvt_pk_bf16_f32 v113, v146, v147
    v_cvt_pk_bf16_f32 v114, v148, v149
    buffer_store_dwordx4 v[112:115], v14, s[28:31], s61 offen offset:0 sc1
    v_cvt_pk_bf16_f32 v116, v150, v151
    v_cvt_pk_bf16_f32 v117, v152, v153
    v_cvt_pk_bf16_f32 v118, v154, v155
    buffer_store_dwordx4 v[116:119], v14, s[28:31], s61 offen offset:1024 sc1
    v_cvt_pk_bf16_f32 v120, v156, v157
    v_cvt_pk_bf16_f32 v121, v158, v159
    v_cvt_pk_bf16_f32 v122, v162, v163
    buffer_store_dwordx4 v[120:123], v14, s[28:31], s61 offen offset:2048 sc1
    v_cvt_pk_bf16_f32 v232, v164, v165
    v_cvt_pk_bf16_f32 v233, v166, v167
    v_cvt_pk_bf16_f32 v234, v168, v169
    buffer_store_dwordx4 v[232:235], v14, s[28:31], s62 offen offset:0 sc1
    v_cvt_pk_bf16_f32 v236, v170, v171
    v_cvt_pk_bf16_f32 v237, v172, v173
    v_cvt_pk_bf16_f32 v238, v174, v175
    buffer_store_dwordx4 v[236:239], v14, s[28:31], s62 offen offset:1024 sc1
    v_cvt_pk_bf16_f32 v240, v176, v177
    v_cvt_pk_bf16_f32 v241, v178, v179
    v_cvt_pk_bf16_f32 v242, v196, v197
    buffer_store_dwordx4 v[240:243], v14, s[28:31], s62 offen offset:2048 sc1
    v_cvt_pk_bf16_f32 v244, v180, v181
    v_cvt_pk_bf16_f32 v245, v182, v183
    v_cvt_pk_bf16_f32 v246, v184, v185
    buffer_store_dwordx4 v[244:247], v14, s[28:31], s63 offen offset:0 sc1
    v_cvt_pk_bf16_f32 v248, v186, v187
    v_cvt_pk_bf16_f32 v249, v188, v189
    v_cvt_pk_bf16_f32 v250, v190, v191
    buffer_store_dwordx4 v[248:251], v14, s[28:31], s63 offen offset:1024 sc1
    v_cvt_pk_bf16_f32 v252, v192, v193
    v_cvt_pk_bf16_f32 v253, v194, v195
    v_cvt_pk_bf16_f32 v254, v198, v199
    buffer_store_dwordx4 v[252:255], v14, s[28:31], s63 offen offset:2048 sc1
    s_mov_b32 s42, 0xffff0000
    s_waitcnt vmcnt(9)
    v_add_f32 v128, v128, v230
    v_add_f32 v129, v129, v230
    v_add_f32 v130, v130, v230
    v_add_f32 v131, v131, v230
    v_add_f32 v132, v132, v230
    v_add_f32 v133, v133, v230
    v_add_f32 v134, v134, v230
    v_add_f32 v135, v135, v230
    v_add_f32 v136, v136, v230
    v_add_f32 v137, v137, v230
    v_add_f32 v138, v138, v230
    v_add_f32 v139, v139, v230
    v_add_f32 v140, v140, v230
    v_add_f32 v141, v141, v230
    v_add_f32 v142, v142, v230
    v_add_f32 v143, v143, v230
    v_add_f32 v160, v160, v230
    v_add_f32 v161, v161, v230
    v_lshlrev_b32 v32, 16, v200
    v_and_b32 v33, s42, v200
    v_lshlrev_b32 v34, 16, v201
    v_and_b32 v35, s42, v201
    v_lshlrev_b32 v36, 16, v202
    v_and_b32 v37, s42, v202
    v_lshlrev_b32 v38, 16, v203
    v_and_b32 v39, s42, v203
    v_lshlrev_b32 v40, 16, v204
    v_and_b32 v41, s42, v204
    v_lshlrev_b32 v42, 16, v205
    v_and_b32 v43, s42, v205
    v_lshlrev_b32 v44, 16, v206
    v_and_b32 v45, s42, v206
    v_lshlrev_b32 v46, 16, v207
    v_and_b32 v47, s42, v207
    v_lshlrev_b32 v48, 16, v208
    v_and_b32 v49, s42, v208
    s_mov_b32 s49, 0
    s_mov_b64 s[40:41], 7
g2_scout:
    s_mov_b64 exec, s[40:41]
    buffer_load_dword v2, v23, s[28:31], 0 offen offset:3068 sc1
    s_add_u32 s49, s49, 1
    s_waitcnt vmcnt(0)
    v_cmp_eq_u32 vcc, s26, v2
    s_mov_b64 exec, -1
    s_bitcmp1_b32 vcc_lo, 0
    s_cbranch_scc0 g2_sc1
    buffer_load_dwordx4 v[68:71], v14, s[28:31], s5 offen offset:0 sc1
    buffer_load_dwordx4 v[72:75], v14, s[28:31], s5 offen offset:1024 sc1
    buffer_load_dwordx4 v[76:79], v14, s[28:31], s5 offen offset:2048 sc1
g2_sc1:
    s_bitcmp1_b32 vcc_lo, 1
    s_cbranch_scc0 g2_sc2
    buffer_load_dwordx4 v[80:83], v14, s[28:31], s6 offen offset:0 sc1
    buffer_load_dwordx4 v[84:87], v14, s[28:31], s6 offen offset:1024 sc1
    buffer_load_dwordx4 v[88:91], v14, s[28:31], s6 offen offset:2048 sc1
g2_sc2:
    s_bitcmp1_b32 vcc_lo, 2
    s_cbranch_scc0 g2_sc3
    buffer_load_dwordx4 v[92:95], v14, s[28:31], s7 offen offset:0 sc1
    buffer_load_dwordx4 v[96:99], v14, s[28:31], s7 offen offset:1024 sc1
    buffer_load_dwordx4 v[100:103], v14, s[28:31], s7 offen offset:2048 sc1
g2_sc3:
    s_andn2_b32 s40, s40, vcc_lo
    s_cbranch_scc0 g2_check
    s_cmp_lt_u32 s49, 30000
    s_cbranch_scc1 g2_scout
g2_poll:
    buffer_load_dwordx4 v[68:71], v14, s[28:31], s5 offen offset:0 sc1
    buffer_load_dwordx4 v[72:75], v14, s[28:31], s5 offen offset:1024 sc1
    buffer_load_dwordx4 v[76:79], v14, s[28:31], s5 offen offset:2048 sc1
    buffer_load_dwordx4 v[80:83], v14, s[28:31], s6 offen offset:0 sc1
    buffer_load_dwordx4 v[84:87], v14, s[28:31], s6 offen offset:1024 sc1
    buffer_load_dwordx4 v[88:91], v14, s[28:31], s6 offen offset:2048 sc1
    buffer_load_dwordx4 v[92:95], v14, s[28:31], s7 offen offset:0 sc1
    buffer_load_dwordx4 v[96:99], v14, s[28:31], s7 offen offset:1024 sc1
    buffer_load_dwordx4 v[100:103], v14, s[28:31], s7 offen offset:2048 sc1
    s_add_u32 s49, s49, 1
g2_check:
    s_waitcnt vmcnt(0)
    v_xor_b32 v24, s26, v71
    v_xor_b32 v25, s26, v75
    v_xor_b32 v26, s26, v79
    v_xor_b32 v27, s26, v83
    v_xor_b32 v28, s26, v87
    v_xor_b32 v29, s26, v91
    v_xor_b32 v30, s26, v95
    v_xor_b32 v31, s26, v99
    v_xor_b32 v2, s26, v103
    v_or3_b32 v24, v24, v25, v26
    v_or3_b32 v27, v27, v28, v29
    v_or3_b32 v30, v30, v31, v2
    v_or3_b32 v24, v24, v27, v30
    v_cmp_ne_u32 vcc, 0, v24
    s_nop 0
    s_and_b64 exec, vcc, vcc
    s_cbranch_scc0 g2_ready
    s_cmp_lt_u32 s49, 30000
    s_cbranch_scc1 g2_poll
g2_ready:
    s_mov_b64 exec, -1
    v_lshlrev_b32 v24, 16, v68
    v_and_b32 v25, s42, v68
    v_pk_add_f32 v[128:129], v[128:129], v[24:25]
    v_lshlrev_b32 v26, 16, v69
    v_and_b32 v27, s42, v69
    v_pk_add_f32 v[130:131], v[130:131], v[26:27]
    v_lshlrev_b32 v24, 16, v70
    v_and_b32 v25, s42, v70
    v_pk_add_f32 v[132:133], v[132:133], v[24:25]
    v_lshlrev_b32 v26, 16, v72
    v_and_b32 v27, s42, v72
    v_pk_add_f32 v[134:135], v[134:135], v[26:27]
    v_lshlrev_b32 v24, 16, v73
    v_and_b32 v25, s42, v73
    v_pk_add_f32 v[136:137], v[136:137], v[24:25]
    v_lshlrev_b32 v26, 16, v74
    v_and_b32 v27, s42, v74
    v_pk_add_f32 v[138:139], v[138:139], v[26:27]
    v_lshlrev_b32 v24, 16, v76
    v_and_b32 v25, s42, v76
    v_pk_add_f32 v[140:141], v[140:141], v[24:25]
    v_lshlrev_b32 v26, 16, v77
    v_and_b32 v27, s42, v77
    v_pk_add_f32 v[142:143], v[142:143], v[26:27]
    v_lshlrev_b32 v24, 16, v78
    v_and_b32 v25, s42, v78
    v_pk_add_f32 v[160:161], v[160:161], v[24:25]
    v_lshlrev_b32 v24, 16, v80
    v_and_b32 v25, s42, v80
    v_pk_add_f32 v[128:129], v[128:129], v[24:25]
    v_lshlrev_b32 v26, 16, v81
    v_and_b32 v27, s42, v81
    v_pk_add_f32 v[130:131], v[130:131], v[26:27]
    v_lshlrev_b32 v24, 16, v82
    v_and_b32 v25, s42, v82
    v_pk_add_f32 v[132:133], v[132:133], v[24:25]
    v_lshlrev_b32 v26, 16, v84
    v_and_b32 v27, s42, v84
    v_pk_add_f32 v[134:135], v[134:135], v[26:27]
    v_lshlrev_b32 v24, 16, v85
    v_and_b32 v25, s42, v85
    v_pk_add_f32 v[136:137], v[136:137], v[24:25]
    v_lshlrev_b32 v26, 16, v86
    v_and_b32 v27, s42, v86
    v_pk_add_f32 v[138:139], v[138:139], v[26:27]
    v_lshlrev_b32 v24, 16, v88
    v_and_b32 v25, s42, v88
    v_pk_add_f32 v[140:141], v[140:141], v[24:25]
    v_lshlrev_b32 v26, 16, v89
    v_and_b32 v27, s42, v89
    v_pk_add_f32 v[142:143], v[142:143], v[26:27]
    v_lshlrev_b32 v24, 16, v90
    v_and_b32 v25, s42, v90
    v_pk_add_f32 v[160:161], v[160:161], v[24:25]
    v_lshlrev_b32 v24, 16, v92
    v_and_b32 v25, s42, v92
    v_pk_add_f32 v[128:129], v[128:129], v[24:25]
    v_lshlrev_b32 v26, 16, v93
    v_and_b32 v27, s42, v93
    v_pk_add_f32 v[130:131], v[130:131], v[26:27]
    v_lshlrev_b32 v24, 16, v94
    v_and_b32 v25, s42, v94
    v_pk_add_f32 v[132:133], v[132:133], v[24:25]
    v_lshlrev_b32 v26, 16, v96
    v_and_b32 v27, s42, v96
    v_pk_add_f32 v[134:135], v[134:135], v[26:27]
    v_lshlrev_b32 v24, 16, v97
    v_and_b32 v25, s42, v97
    v_pk_add_f32 v[136:137], v[136:137], v[24:25]
    v_lshlrev_b32 v26, 16, v98
    v_and_b32 v27, s42, v98
    v_pk_add_f32 v[138:139], v[138:139], v[26:27]
    v_lshlrev_b32 v24, 16, v100
    v_and_b32 v25, s42, v100
    v_pk_add_f32 v[140:141], v[140:141], v[24:25]
    v_lshlrev_b32 v26, 16, v101
    v_and_b32 v27, s42, v101
    v_pk_add_f32 v[142:143], v[142:143], v[26:27]
    v_lshlrev_b32 v24, 16, v102
    v_and_b32 v25, s42, v102
    v_pk_add_f32 v[160:161], v[160:161], v[24:25]
    v_pk_fma_f32 v[128:129], v[128:129], v[210:211], v[32:33]
    v_cvt_pk_bf16_f32 v68, v128, v129
    v_pk_fma_f32 v[130:131], v[130:131], v[212:213], v[34:35]
    v_cvt_pk_bf16_f32 v69, v130, v131
    buffer_store_dwordx2 v[68:69], v22, s[16:19], s52 offen offset:0
    v_pk_fma_f32 v[132:133], v[132:133], v[214:215], v[36:37]
    v_cvt_pk_bf16_f32 v70, v132, v133
    v_pk_fma_f32 v[134:135], v[134:135], v[216:217], v[38:39]
    v_cvt_pk_bf16_f32 v71, v134, v135
    buffer_store_dwordx2 v[70:71], v22, s[16:19], s52 offen offset:32
    v_pk_fma_f32 v[136:137], v[136:137], v[218:219], v[40:41]
    v_cvt_pk_bf16_f32 v72, v136, v137
    v_pk_fma_f32 v[138:139], v[138:139], v[220:221], v[42:43]
    v_cvt_pk_bf16_f32 v73, v138, v139
    buffer_store_dwordx2 v[72:73], v22, s[16:19], s52 offen offset:64
    v_pk_fma_f32 v[140:141], v[140:141], v[222:223], v[44:45]
    v_cvt_pk_bf16_f32 v74, v140, v141
    v_pk_fma_f32 v[142:143], v[142:143], v[224:225], v[46:47]
    v_cvt_pk_bf16_f32 v75, v142, v143
    buffer_store_dwordx2 v[74:75], v22, s[16:19], s52 offen offset:96
    v_pk_fma_f32 v[160:161], v[160:161], v[226:227], v[48:49]
    v_cvt_pk_bf16_f32 v76, v160, v161
    buffer_store_dword v76, v22, s[16:19], s53 offen
t_end:
f_done:
    s_endpgm
.section .rodata,"a"
.p2align 6
.amdhsa_kernel f_kernel
  .amdhsa_next_free_vgpr 256
  .amdhsa_next_free_sgpr 102
  .amdhsa_accum_offset 256
  .amdhsa_group_segment_fixed_size 0
  .amdhsa_kernarg_size 104
  .amdhsa_user_sgpr_count 2
  .amdhsa_user_sgpr_kernarg_segment_ptr 1
  .amdhsa_system_sgpr_workgroup_id_x 1
.end_amdhsa_kernel
```

```asm
; @launch kernel=f_kernel grid=(256,1,1) block=(512,1,1) lds=163840
.amdgcn_target "amdgcn-amd-amdhsa--gfx950"
.text
.globl f_kernel
.p2align 8
.type f_kernel,@function
f_kernel:
    s_cmp_ge_u32 s2, 256
    s_cbranch_scc1 f_done
    s_load_dwordx2 s[16:17], s[0:1], 64
    s_load_dwordx2 s[20:21], s[0:1], 72
    s_load_dwordx2 s[28:29], s[0:1], 96
    s_load_dwordx2 s[4:5], s[0:1], 0
    s_load_dwordx2 s[8:9], s[0:1], 8
    s_load_dwordx2 s[12:13], s[0:1], 16
    s_load_dwordx2 s[24:25], s[0:1], 88
    s_load_dwordx2 s[32:33], s[0:1], 32
    s_mov_b32 s18, 0x480
    s_mov_b32 s19, 0x20000
    s_mov_b32 s22, 0x3cc000
    s_mov_b32 s23, 0x20000
    s_mov_b32 s30, 0x3000000
    s_mov_b32 s31, 0x20000
    s_mov_b32 s6, 0x240000
    s_mov_b32 s7, 0x20000
    s_mov_b32 s10, 0x121000
    s_mov_b32 s11, 0x20000
    s_mov_b32 s14, 0x121000
    s_mov_b32 s15, 0x20000
    s_mov_b32 s26, 0x100
    s_mov_b32 s27, 0x20000
    s_mov_b32 s34, 0x1200000
    s_mov_b32 s35, 0x20000
    v_and_b32 v1, 63, v0
    v_lshrrev_b32 v2, 6, v0
    s_nop 0
    v_readfirstlane_b32 s3, v2
    v_and_b32 v5, 15, v1
    v_lshrrev_b32 v6, 4, v1
    s_and_b32 s36, s2, 7
    s_lshr_b32 s37, s2, 3
    s_sub_u32 s50, s37, 27
    s_cbranch_scc1 cpf_no
    s_cmp_eq_u32 s3, 5
    s_cbranch_scc0 cpf_no
    s_lshl_b32 s50, s50, 13
    s_add_u32 s50, s50, f_kernel-f_kernel
    v_lshl_add_u32 v102, v1, 7, s50
    v_min_u32 v102, f_end-f_kernel-4, v102
    s_getpc_b64 s[50:51]
cpf_pc:
    s_sub_u32 s50, s50, cpf_pc-f_kernel
    s_subb_u32 s51, s51, 0
    global_load_dword v103, v102, s[50:51]
cpf_no:
    s_lshr_b32 s38, s37, 3
    s_sub_u32 s38, 3, s38
    s_lshl_b32 s38, s38, 3
    s_add_u32 s38, s38, s36
    s_lshl_b32 s38, s38, 3
    s_and_b32 s39, s37, 7
    s_add_u32 s38, s38, s39
    s_and_b32 s39, s3, 3
    s_lshr_b32 s40, s3, 2
    s_sub_u32 s41, s2, 0
    s_mul_i32 s43, s41, 171
    s_lshr_b32 s43, s43, 9
    s_mul_i32 s44, s43, 3
    s_sub_u32 s44, s41, s44
    v_lshrrev_b32 v2, 3, v0
    v_and_b32 v3, 7, v0
    v_mul_u32_u24 v4, 6912, v2
    v_lshl_add_u32 v3, v3, 4, v4
    v_lshrrev_b32 v2, 3, v1
    v_min_u32 v2, 2, v2
    v_lshlrev_b32 v2, 6, v2
    v_and_or_b32 v2, v1, 7, v2
    v_lshl_add_u32 v2, s3, 3, v2
    v_lshlrev_b32 v2, 1, v2
    s_mul_i32 s45, s44, 384
    s_mul_i32 s46, s44, 1327104
    s_lshl_b32 s47, s43, 7
    s_add_u32 s46, s46, s47
    s_mul_i32 s48, s44, 9216
    s_lshl_b32 s47, s43, 8
    s_add_u32 s48, s48, s47
    s_add_u32 s47, s47, 131072
    s_cmp_lt_u32 s41, 54
    s_cselect_b32 s47, s47, 167424
    s_add_u32 s48, s48, s47
    s_memrealtime s[52:53]
    v_lshlrev_b32 v125, 2, v1
    v_lshlrev_b32 v109, 4, v1
    v_mov_b32 v68, -1
    v_mov_b32 v69, -1
    v_mov_b32 v70, -1
    v_mov_b32 v71, -1
    v_mov_b32 v44, 0
    v_mov_b32 v45, 0
    v_mov_b32 v46, 0
    s_bfe_u32 s49, s2, 0x10001
    s_lshl_b32 s49, s49, 3
    s_bfe_u32 s50, s2, 0x30003
    s_add_u32 s49, s49, s50
    s_bfe_u32 s50, s2, 0x10002
    s_lshl_b32 s50, s50, 2
    s_lshr_b32 s51, s2, 6
    s_add_u32 s50, s50, s51
    s_lshl_b32 s50, s50, 1
    s_and_b32 s51, s2, 1
    s_add_u32 s50, s50, s51
    s_lshl_b32 s56, s49, 4
    s_add_u32 s56, s56, s50
    s_lshl_b32 s49, s49, 2
    s_add_u32 s49, s49, s39
    s_lshl_b32 s49, s49, 4
    s_add_u32 s49, s49, s50
    s_lshl_b32 s49, s49, 1
    s_add_u32 s49, s49, s40
    s_mul_i32 s49, s49, 1152
    s_lshl_b32 s50, s39, 4
    v_add_u32 v7, s50, v5
    s_mul_i32 s55, s3, 1184
    s_xor_b32 s50, s2, 54
    s_or_b32 s50, s50, s3
    s_waitcnt lgkmcnt(0)
    s_cbranch_scc1 f_nolead
    s_or_b32 s59, s52, 1
    v_mov_b32 v4, s59
    s_mov_b64 exec, 1
    buffer_store_dword v4, off, s[24:27], 0 offset:252 sc1
    s_mov_b64 exec, -1
f_nolead:
    s_or_b32 s59, s52, 1
    s_cmp_lt_u32 s41, 162
    s_cbranch_scc0 f_nogemv1
    buffer_load_short_d16_hi v44, v2, s[16:19], s45 offen offset:0
    buffer_load_dwordx4 v[48:51], v3, s[20:23], s46 offen
    s_add_u32 s46, s46, 442368
    buffer_load_dwordx4 v[52:55], v3, s[20:23], s46 offen
    s_add_u32 s46, s46, 442368
    buffer_load_dwordx4 v[56:59], v3, s[20:23], s46 offen
    s_cmp_lt_u32 s41, 54
    s_cbranch_scc1 f_issue2
f_nogemv1:
    s_add_u32 m0, s55, 9728
    s_nop 0
    buffer_load_dwordx4 v109, s[4:7], s49 offen lds
    s_mov_b64 exec, 0xff
    buffer_load_dwordx4 v109, s[4:7], s49 offen offset:1024 lds
    s_mov_b64 exec, -1
    s_and_b32 s50, s37, 7
    s_lshl_b32 s50, s50, 2
    s_add_u32 s50, s50, s39
    s_lshl_b32 s50, s50, 3
    s_add_u32 s50, s50, s36
    s_mul_i32 s50, s50, 4624
    s_lshr_b32 s51, s2, 6
    s_mul_i32 s51, s51, 1152
    s_add_u32 s50, s50, s51
    s_mul_i32 s51, s3, 5120
    s_add_u32 m0, s51, 65536
    s_cmp_eq_u32 s40, 0
    s_cselect_b32 s8, s8, s12
    s_cselect_b32 s9, s9, s13
    buffer_load_dwordx4 v109, s[8:11], s50 offen lds
    s_mov_b64 exec, 0x1ff
    buffer_load_dwordx4 v109, s[8:11], s50 offen offset:1024 lds
    s_mov_b64 exec, -1
    s_sub_u32 s50, s2, 176
    s_cmp_lt_u32 s50, 80
    s_cbranch_scc0 f_noslot
    s_lshl_b32 s50, s50, 3
    s_add_u32 s50, s50, s3
    s_mul_i32 s50, s50, 4096
    s_add_u32 s50, s50, 4194304
    buffer_store_dwordx4 v[68:71], v109, s[28:31], s50 offen offset:0 sc1
    buffer_store_dwordx4 v[68:71], v109, s[28:31], s50 offen offset:1024 sc1
    buffer_store_dwordx4 v[68:71], v109, s[28:31], s50 offen offset:2048 sc1
    buffer_store_dwordx4 v[68:71], v109, s[28:31], s50 offen offset:3072 sc1
f_noslot:
f_issue2:
    v_mul_u32_u24 v118, 1152, v6
    v_lshl_add_u32 v118, v7, 1, v118
    s_lshl_b32 s52, s38, 1
    s_add_u32 s52, s52, s40
    s_mul_i32 s52, s52, 4608
    v_mov_b32 v8, 0
    v_mov_b32 v9, 0
    v_mov_b32 v10, 0
    v_mov_b32 v11, 0
    v_mov_b32 v12, 0
    v_mov_b32 v13, 0
    v_mov_b32 v14, 0
    v_mov_b32 v15, 0
    v_mov_b32 v16, 0
    v_mov_b32 v18, 0
    v_mov_b32 v19, 0
    v_mov_b32 v20, 0
    v_mov_b32 v21, 0
    v_mov_b32 v22, 0
    v_mov_b32 v23, 0
    v_mov_b32 v24, 0
    v_mov_b32 v25, 0
    v_mov_b32 v26, 0
    s_add_u32 s53, s38, 64
    s_lshl_b32 s54, s36, 2
    s_add_u32 s54, s54, s37
    s_cmp_lt_u32 s2, 32
    s_cselect_b32 s54, s54, -1
    s_cmp_eq_u32 s2, 32
    s_cselect_b32 s54, 32, s54
    s_cmp_eq_u32 s40, 0
    s_cselect_b32 s42, s53, s54
    s_lshl_b32 s50, s40, 2
    s_add_u32 s50, s50, s39
    s_mul_i32 s50, s50, 272
    s_add_u32 s50, s50, 9728
    v_add_u32 v104, s50, v125
    v_mul_u32_u24 v2, 272, v5
    v_lshl_add_u32 v2, v6, 4, v2
    s_mul_i32 s50, s40, 8704
    s_add_u32 s51, s50, 9728
    v_add_u32 v105, s51, v2
    s_add_u32 s51, s50, 46336
    v_add_u32 v111, s51, v2
    v_mul_u32_u24 v2, 1088, v6
    v_lshl_add_u32 v2, v7, 2, v2
    v_add_u32 v110, s51, v2
    v_lshrrev_b32 v2, 1, v6
    v_lshl_add_u32 v2, v2, 6, v7
    v_and_b32 v3, 1, v6
    v_lshlrev_b32 v3, 4, v3
    v_lshl_add_u32 v2, v2, 5, v3
    s_lshl_b32 s50, s40, 13
    v_add_u32 v106, s50, v2
    v_add_u32 v107, 4096, v2
    v_cmp_lt_u32 vcc, 1, v6
    s_cmp_eq_u32 s40, 1
    s_cselect_b64 s[50:51], vcc, 0
    v_mov_b32 v3, 0x7f000000
    v_cndmask_b32 v106, v106, v3, s[50:51]
    s_mul_i32 s56, s56, 10240
    s_add_u32 s56, s56, 4194304
    v_lshrrev_b32 v2, 1, v5
    v_lshl_add_u32 v2, v6, 4, v2
    v_mul_u32_u24 v2, 10240, v2
    v_and_b32 v3, 1, v5
    v_lshl_add_u32 v108, v3, 4, v2
    v_lshlrev_b32 v2, 6, v7
    v_lshl_add_u32 v112, v6, 4, v2
    v_lshrrev_b32 v2, 1, v1
    s_and_b32 s50, s3, 1
    s_lshl_b32 s50, s50, 5
    v_add_u32 v2, s50, v2
    v_and_b32 v3, 1, v1
    s_lshr_b32 s51, s3, 1
    v_mul_u32_u24 v4, 5760, v3
    v_lshl_add_u32 v4, v2, 3, v4
    s_mul_i32 s50, s51, 576
    s_add_u32 s50, s50, 17920
    v_add_u32 v115, s50, v4
    v_lshlrev_b32 v3, 4, v3
    v_lshl_add_u32 v114, v2, 13, v3
    v_add_u32 v114, 2097152, v114
    v_sub_u32 v4, 64, v2
    v_min_u32 v4, v4, v2
    s_cmp_eq_u32 s51, 0
    s_cselect_b64 vcc, -1, 0
    v_cndmask_b32 v2, v2, v4, vcc
    s_lshl_b32 s51, s51, 19
    v_lshl_add_u32 v113, v2, 13, v3
    v_add_u32 v113, s51, v113
    v_lshrrev_b32 v2, 2, v5
    v_lshl_add_u32 v2, v6, 2, v2
    v_lshlrev_b32 v2, 3, v2
    s_mul_i32 s50, s40, 5760
    s_add_u32 s50, s50, 17920
    v_add_u32 v117, s50, v2
    v_and_b32 v2, 3, v1
    v_add_u32 v2, 1, v2
    v_mul_u32_u24 v2, 576, v2
    v_add_u32 v116, v2, v117
    s_lshl_b32 s50, s40, 7
    s_add_u32 s50, s50, 29440
    v_lshl_add_u32 v119, v6, 5, s50
    s_lshl_b32 s50, s39, 3
    v_add_u32 v120, s50, v119
    s_mov_b32 s50, 391680
    v_lshl_add_u32 v2, v6, 6, v7
    s_lshl_b32 s51, s40, 3
    s_add_u32 s51, s51, 17920
    v_lshl_add_u32 v121, v2, 4, s51
    v_mul_u32_u24 v3, 683, v0
    v_lshrrev_b32 v3, 16, v3
    v_mul_lo_u32 v3, v3, s50
    v_lshl_add_u32 v122, v0, 4, v3
    v_add_u32 v2, 256, v0
    v_mul_u32_u24 v3, 683, v2
    v_lshrrev_b32 v3, 16, v3
    v_mul_lo_u32 v3, v3, s50
    v_lshl_add_u32 v118, v2, 4, v3
    v_add_u32 v123, 1966592, v109
    v_lshlrev_b32 v124, 2, v7
    v_mul_u32_u24 v2, 1184, v6
    v_lshl_add_u32 v2, v7, 1, v2
    s_mul_i32 s50, s40, 4736
    s_add_u32 s50, s50, 0
    v_add_u32 v127, s50, v2
    s_and_b32 s50, s2, 1
    s_mul_i32 s50, s50, 1152
    v_cmp_lt_u32 vcc, 431, v0
    v_mov_b32 v3, s50
    s_nop 0
    v_cndmask_b32 v3, 0, v3, vcc
    v_lshl_add_u32 v126, v0, 4, v3
    s_mul_i32 s57, s36, 4617
    s_lshr_b32 s57, s57, 10
    s_lshl_b32 s57, s57, 8
    v_mul_u32_u24 v2, 26, v1
    v_lshrrev_b32 v2, 8, v2
    v_mul_u32_u24 v2, 7936, v2
    v_lshl_add_u32 v17, v1, 7, v2
    s_cmp_lt_u32 s41, 54
    s_cbranch_scc0 f_notag
    s_add_u32 m0, s55, 9728
    s_nop 0
    buffer_load_dwordx4 v109, s[4:7], s49 offen lds
    s_mov_b64 exec, 0xff
    buffer_load_dwordx4 v109, s[4:7], s49 offen offset:1024 lds
    s_mov_b64 exec, -1
    s_and_b32 s50, s37, 7
    s_lshl_b32 s50, s50, 2
    s_add_u32 s50, s50, s39
    s_lshl_b32 s50, s50, 3
    s_add_u32 s50, s50, s36
    s_mul_i32 s50, s50, 4624
    s_lshr_b32 s51, s2, 6
    s_mul_i32 s51, s51, 1152
    s_add_u32 s50, s50, s51
    s_mul_i32 s51, s3, 5120
    s_add_u32 m0, s51, 65536
    s_cmp_eq_u32 s40, 0
    s_cselect_b32 s8, s8, s12
    s_cselect_b32 s9, s9, s13
    buffer_load_dwordx4 v109, s[8:11], s50 offen lds
    s_mov_b64 exec, 0x1ff
    buffer_load_dwordx4 v109, s[8:11], s50 offen offset:1024 lds
    s_mov_b64 exec, -1
    s_lshl_b32 s50, s41, 2
    v_mov_b32 v4, s59
    s_mov_b64 exec, 1
    s_cmp_eq_u32 s3, 7
    s_cbranch_scc0 f_filler
    buffer_store_dword v4, off, s[24:27], s50 sc1
    s_branch f_filled
f_filler:
    buffer_load_dword v99, off, s[16:19], 0
f_filled:
    s_mov_b64 exec, -1
    s_branch f_c1done
f_notag:
    v_cvt_f32_u32 v84, v7
    v_cvt_f32_u32 v85, v6
    v_mul_f32 v86, v85, v84
    v_mul_f32 v86, 0x3d800000, v86
    v_fmamk_f32 v72, v84, 0x00000000, v86
    v_cos_f32 v73, v72
    v_sin_f32 v74, v72
    v_fmamk_f32 v75, v84, 0x3c800000, v86
    v_cos_f32 v76, v75
    v_sin_f32 v77, v75
    v_cvt_pk_bf16_f32 v128, v73, v74
    v_cvt_pk_bf16_f32 v144, -v74, v73
    v_fmamk_f32 v72, v84, 0x3d000000, v86
    v_cos_f32 v73, v72
    v_sin_f32 v74, v72
    v_cvt_pk_bf16_f32 v129, v76, v77
    v_cvt_pk_bf16_f32 v145, -v77, v76
    v_fmamk_f32 v75, v84, 0x3d400000, v86
    v_cos_f32 v76, v75
    v_sin_f32 v77, v75
    v_cvt_pk_bf16_f32 v130, v73, v74
    v_cvt_pk_bf16_f32 v146, -v74, v73
    v_fmamk_f32 v72, v84, 0x3e800000, v86
    v_cos_f32 v73, v72
    v_sin_f32 v74, v72
    v_cvt_pk_bf16_f32 v131, v76, v77
    v_cvt_pk_bf16_f32 v147, -v77, v76
    v_fmamk_f32 v75, v84, 0x3e880000, v86
    v_cos_f32 v76, v75
    v_sin_f32 v77, v75
    v_cvt_pk_bf16_f32 v132, v73, v74
    v_cvt_pk_bf16_f32 v148, -v74, v73
    v_fmamk_f32 v72, v84, 0x3e900000, v86
    v_cos_f32 v73, v72
    v_sin_f32 v74, v72
    v_cvt_pk_bf16_f32 v133, v76, v77
    v_cvt_pk_bf16_f32 v149, -v77, v76
    v_fmamk_f32 v75, v84, 0x3e980000, v86
    v_cos_f32 v76, v75
    v_sin_f32 v77, v75
    v_cvt_pk_bf16_f32 v134, v73, v74
    v_cvt_pk_bf16_f32 v150, -v74, v73
    v_fmamk_f32 v72, v84, 0x3f000000, v86
    v_cos_f32 v73, v72
    v_sin_f32 v74, v72
    v_cvt_pk_bf16_f32 v135, v76, v77
    v_cvt_pk_bf16_f32 v151, -v77, v76
    v_fmamk_f32 v75, v84, 0x3f040000, v86
    v_cos_f32 v76, v75
    v_sin_f32 v77, v75
    v_cvt_pk_bf16_f32 v136, v73, v74
    v_cvt_pk_bf16_f32 v152, -v74, v73
    v_fmamk_f32 v72, v84, 0x3f080000, v86
    v_cos_f32 v73, v72
    v_sin_f32 v74, v72
    v_cvt_pk_bf16_f32 v137, v76, v77
    v_cvt_pk_bf16_f32 v153, -v77, v76
    v_fmamk_f32 v75, v84, 0x3f0c0000, v86
    v_cos_f32 v76, v75
    v_sin_f32 v77, v75
    v_cvt_pk_bf16_f32 v138, v73, v74
    v_cvt_pk_bf16_f32 v154, -v74, v73
    v_fmamk_f32 v72, v84, 0x3f400000, v86
    v_cos_f32 v73, v72
    v_sin_f32 v74, v72
    v_cvt_pk_bf16_f32 v139, v76, v77
    v_cvt_pk_bf16_f32 v155, -v77, v76
    v_fmamk_f32 v75, v84, 0x3f440000, v86
    v_cos_f32 v76, v75
    v_sin_f32 v77, v75
    v_cvt_pk_bf16_f32 v140, v73, v74
    v_cvt_pk_bf16_f32 v156, -v74, v73
    v_fmamk_f32 v72, v84, 0x3f480000, v86
    v_cos_f32 v73, v72
    v_sin_f32 v74, v72
    v_cvt_pk_bf16_f32 v141, v76, v77
    v_cvt_pk_bf16_f32 v157, -v77, v76
    v_fmamk_f32 v75, v84, 0x3f4c0000, v86
    v_cos_f32 v76, v75
    v_sin_f32 v77, v75
    v_cvt_pk_bf16_f32 v142, v73, v74
    v_cvt_pk_bf16_f32 v158, -v74, v73
    v_cvt_pk_bf16_f32 v143, v76, v77
    v_cvt_pk_bf16_f32 v159, -v77, v76
    v_cvt_f32_u32 v82, v1
    v_mul_f32 v73, 0x3ae38e39, v82
    v_mul_f32 v74, 0x3b638e39, v82
    v_mul_f32 v75, 0x3baaaaab, v82
    v_mul_f32 v76, 0x3be38e39, v82
    v_cos_f32 v208, v73
    v_sin_f32 v212, v73
    v_cos_f32 v209, v74
    v_sin_f32 v213, v74
    v_cos_f32 v210, v75
    v_sin_f32 v214, v75
    v_cos_f32 v211, v76
    v_sin_f32 v215, v76
f_c1done:
    s_lshl_b32 s49, s38, 3
    s_add_u32 s49, s49, s3
    s_mul_i32 s49, s49, 1152
    s_cmp_lt_u32 s41, 162
    s_cbranch_scc0 f_other
    s_mov_b32 s47, 0xffff0000
    s_cmp_lt_u32 s41, 54
    v_lshrrev_b32 v2, 3, v1
    v_lshlrev_b32 v2, 2, v2
    s_waitcnt vmcnt(8)
    s_cbranch_scc1 gw_5
    s_waitcnt vmcnt(7)
gw_5:
    v_mul_f32 v72, 0xbfb8aa3b, v44
    v_exp_f32 v72, v72
    s_nop 0
    v_add_f32 v72, 1.0, v72
    v_rcp_f32 v72, v72
    s_nop 0
    v_mul_f32 v44, v44, v72
    v_cvt_pk_bf16_f32 v44, v44, v44
    v_lshlrev_b32 v44, 16, v44
    ds_bpermute_b32 v45, v2, v44 offset:32
    ds_bpermute_b32 v46, v2, v44 offset:64
    ds_bpermute_b32 v44, v2, v44 offset:0
    s_waitcnt vmcnt(7)
    s_cbranch_scc1 gw_6
    s_waitcnt vmcnt(6)
gw_6:
    v_lshlrev_b32 v72, 16, v48
    v_and_b32 v73, s47, v48
    v_lshlrev_b32 v74, 16, v49
    v_and_b32 v75, s47, v49
    v_lshlrev_b32 v76, 16, v50
    v_and_b32 v77, s47, v50
    v_lshlrev_b32 v78, 16, v51
    v_and_b32 v79, s47, v51
    s_waitcnt lgkmcnt(0)
    v_pk_mul_f32 v[60:61], v[72:73], v[44:45] op_sel_hi:[1,0]
    v_pk_mul_f32 v[62:63], v[74:75], v[44:45] op_sel_hi:[1,0]
    v_pk_mul_f32 v[64:65], v[76:77], v[44:45] op_sel_hi:[1,0]
    v_pk_mul_f32 v[66:67], v[78:79], v[44:45] op_sel_hi:[1,0]
    s_waitcnt vmcnt(6)
    s_cbranch_scc1 gw_7
    s_waitcnt vmcnt(5)
gw_7:
    v_lshlrev_b32 v72, 16, v52
    v_and_b32 v73, s47, v52
    v_lshlrev_b32 v74, 16, v53
    v_and_b32 v75, s47, v53
    v_lshlrev_b32 v76, 16, v54
    v_and_b32 v77, s47, v54
    v_lshlrev_b32 v78, 16, v55
    v_and_b32 v79, s47, v55
    v_pk_fma_f32 v[60:61], v[72:73], v[44:45], v[60:61] op_sel:[0,1,0]
    v_pk_fma_f32 v[62:63], v[74:75], v[44:45], v[62:63] op_sel:[0,1,0]
    v_pk_fma_f32 v[64:65], v[76:77], v[44:45], v[64:65] op_sel:[0,1,0]
    v_pk_fma_f32 v[66:67], v[78:79], v[44:45], v[66:67] op_sel:[0,1,0]
    s_waitcnt vmcnt(5)
    s_cbranch_scc1 gw_8
    s_waitcnt vmcnt(4)
gw_8:
    v_lshlrev_b32 v72, 16, v56
    v_and_b32 v73, s47, v56
    v_lshlrev_b32 v74, 16, v57
    v_and_b32 v75, s47, v57
    v_lshlrev_b32 v76, 16, v58
    v_and_b32 v77, s47, v58
    v_lshlrev_b32 v78, 16, v59
    v_and_b32 v79, s47, v59
    v_pk_fma_f32 v[60:61], v[72:73], v[46:47], v[60:61] op_sel_hi:[1,0,1]
    v_pk_fma_f32 v[62:63], v[74:75], v[46:47], v[62:63] op_sel_hi:[1,0,1]
    v_pk_fma_f32 v[64:65], v[76:77], v[46:47], v[64:65] op_sel_hi:[1,0,1]
    v_pk_fma_f32 v[66:67], v[78:79], v[46:47], v[66:67] op_sel_hi:[1,0,1]
    v_permlane16_swap_b32 v60, v61
    v_permlane16_swap_b32 v62, v63
    v_permlane16_swap_b32 v64, v65
    v_permlane16_swap_b32 v66, v67
    v_add_f32 v60, v60, v61
    v_add_f32 v62, v62, v63
    v_add_f32 v64, v64, v65
    v_add_f32 v66, v66, v67
    v_permlane32_swap_b32 v60, v62
    s_nop 0
    v_permlane32_swap_b32 v64, v66
    v_add_f32 v60, v60, v62
    v_add_f32 v64, v64, v66
    s_nop 0
    v_add_f32_dpp v60, v60, v60 row_ror:8 row_mask:0xf bank_mask:0xf
    v_add_f32_dpp v64, v64, v64 row_ror:8 row_mask:0xf bank_mask:0xf
    v_cmp_lt_u32 vcc, 7, v5
    s_nop 1
    v_cndmask_b32 v60, v60, v64, vcc
    v_and_b32 v2, 7, v5
    v_lshrrev_b32 v3, 3, v5
    v_lshl_add_u32 v2, v2, 1, v3
    v_lshl_add_u32 v2, v2, 2, v6
    s_lshl_b32 s50, s3, 8
    s_add_u32 s50, s50, 4608
    v_lshl_add_u32 v2, v2, 2, s50
    ds_write_b32 v2, v60
    s_cmp_lt_u32 s41, 54
    s_cbranch_scc0 f_other
    s_waitcnt lgkmcnt(0)
    s_barrier
    s_cmp_eq_u32 s3, 7
    s_cbranch_scc0 f_noposta
    ds_read2st64_b32 v[60:61], v125 offset0:18 offset1:19
    ds_read2st64_b32 v[62:63], v125 offset0:20 offset1:21
    ds_read2st64_b32 v[64:65], v125 offset0:22 offset1:23
    ds_read2st64_b32 v[66:67], v125 offset0:24 offset1:25
    v_lshlrev_b32 v2, 3, v1
    s_waitcnt lgkmcnt(0)
    v_pk_add_f32 v[60:61], v[60:61], v[62:63]
    v_pk_add_f32 v[64:65], v[64:65], v[66:67]
    v_pk_add_f32 v[60:61], v[60:61], v[64:65]
    v_add_f32 v60, v60, v61
    v_mov_b32 v61, s59
    buffer_store_dwordx2 v[60:61], v2, s[28:31], s48 offen sc1
    s_waitcnt vmcnt(4)
    s_branch f_ln
f_noposta:
    s_waitcnt vmcnt(3)
    s_branch f_ln
f_other:
    s_waitcnt vmcnt(6)
    s_cmp_lt_u32 s2, 176
    s_cbranch_scc0 f_poi1
    s_waitcnt vmcnt(2)
    s_branch f_ln
f_poi1:
    s_cmp_eq_u32 s3, 7
    s_cbranch_scc0 f_ln
    buffer_load_dword v99, off, s[24:27], 0 offset:252 sc1
f_ln:
    v_lshlrev_b32 v2, 1, v1
    s_add_u32 s50, s55, 9728
    v_add_u32 v2, s50, v2
    ds_read_u16_d16_hi v8, v2 offset:0
    ds_read_u16_d16_hi v9, v2 offset:128
    ds_read_u16_d16_hi v10, v2 offset:256
    ds_read_u16_d16_hi v11, v2 offset:384
    ds_read_u16_d16_hi v12, v2 offset:512
    ds_read_u16_d16_hi v13, v2 offset:640
    ds_read_u16_d16_hi v14, v2 offset:768
    ds_read_u16_d16_hi v15, v2 offset:896
    ds_read_u16_d16_hi v16, v2 offset:1024
    s_waitcnt lgkmcnt(0)
    v_add_f32 v80, v8, v9
    v_add_f32 v80, v80, v10
    v_add_f32 v80, v80, v11
    v_add_f32 v80, v80, v12
    v_add_f32 v80, v80, v13
    v_add_f32 v80, v80, v14
    v_add_f32 v80, v80, v15
    v_add_f32 v80, v80, v16
    s_nop 1
    v_add_f32_dpp v80, v80, v80 quad_perm:[1,0,3,2] row_mask:0xf bank_mask:0xf
    s_nop 1
    v_add_f32_dpp v80, v80, v80 quad_perm:[2,3,0,1] row_mask:0xf bank_mask:0xf
    s_nop 1
    v_add_f32_dpp v80, v80, v80 row_half_mirror row_mask:0xf bank_mask:0xf
    s_nop 1
    v_add_f32_dpp v80, v80, v80 row_mirror row_mask:0xf bank_mask:0xf
    v_mov_b32 v72, v80
    s_nop 1
    v_permlane16_swap_b32 v80, v72
    v_add_f32 v80, v80, v72
    v_mov_b32 v72, v80
    s_nop 1
    v_permlane32_swap_b32 v80, v72
    v_add_f32 v80, v80, v72
    v_mul_f32 v80, 0x3ae38e39, v80
    v_sub_f32 v8, v8, v80
    v_sub_f32 v9, v9, v80
    v_sub_f32 v10, v10, v80
    v_sub_f32 v11, v11, v80
    v_sub_f32 v12, v12, v80
    v_sub_f32 v13, v13, v80
    v_sub_f32 v14, v14, v80
    v_sub_f32 v15, v15, v80
    v_sub_f32 v16, v16, v80
    v_mul_f32 v81, v8, v8
    v_fmac_f32 v81, v9, v9
    v_fmac_f32 v81, v10, v10
    v_fmac_f32 v81, v11, v11
    v_fmac_f32 v81, v12, v12
    v_fmac_f32 v81, v13, v13
    v_fmac_f32 v81, v14, v14
    v_fmac_f32 v81, v15, v15
    v_fmac_f32 v81, v16, v16
    s_nop 1
    v_add_f32_dpp v81, v81, v81 quad_perm:[1,0,3,2] row_mask:0xf bank_mask:0xf
    s_nop 1
    v_add_f32_dpp v81, v81, v81 quad_perm:[2,3,0,1] row_mask:0xf bank_mask:0xf
    s_nop 1
    v_add_f32_dpp v81, v81, v81 row_half_mirror row_mask:0xf bank_mask:0xf
    s_nop 1
    v_add_f32_dpp v81, v81, v81 row_mirror row_mask:0xf bank_mask:0xf
    v_mov_b32 v72, v81
    s_nop 1
    v_permlane16_swap_b32 v81, v72
    v_add_f32 v81, v81, v72
    v_mov_b32 v72, v81
    s_nop 1
    v_permlane32_swap_b32 v81, v72
    v_add_f32 v81, v81, v72
    v_mov_b32 v72, 0x3727c5ac
    v_fmamk_f32 v81, v81, 0x3ae38e39, v72
    v_rsq_f32 v81, v81
    s_nop 0
    v_mul_f32 v8, v8, v81
    v_mul_f32 v9, v9, v81
    v_mul_f32 v10, v10, v81
    v_mul_f32 v11, v11, v81
    v_mul_f32 v12, v12, v81
    v_mul_f32 v13, v13, v81
    v_mul_f32 v14, v14, v81
    v_mul_f32 v15, v15, v81
    v_mul_f32 v16, v16, v81
    s_waitcnt vmcnt(2)
    s_cmp_lt_u32 s41, 54
    s_cselect_b32 s50, s3, 8
    s_cmp_eq_u32 s50, 7
    s_cbranch_scc1 f_b0
    s_waitcnt vmcnt(1)
    s_cmp_lt_u32 s50, 8
    s_cbranch_scc1 f_b0
    s_waitcnt vmcnt(0)
f_b0:
    s_waitcnt lgkmcnt(0)
    s_barrier
    s_cmp_lt_u32 s3, 3
    s_cbranch_scc1 f_nozp2
    s_cmp_eq_u32 s3, 7
    s_cbranch_scc0 f_nopostb
    s_cmp_lt_u32 s2, 176
    s_cbranch_scc1 f_nopoi2
    v_readfirstlane_b32 s50, v99
    s_nop 0
    s_cmp_eq_u32 s50, 0
    s_cbranch_scc0 f_tagok
    s_mov_b64 exec, 1
    s_mov_b32 s50, 0
f_an2b:
    buffer_load_dword v99, off, s[24:27], 0 offset:252 sc1
    s_add_u32 s50, s50, 1
    s_waitcnt vmcnt(0)
    v_cmp_eq_u32 vcc, 0, v99
    s_nop 1
    s_cbranch_vccz f_an2b_ok
    s_sleep 2
    s_cmp_lt_u32 s50, 30000
    s_cbranch_scc1 f_an2b
f_an2b_ok:
    s_mov_b64 exec, -1
f_tagok:
    s_lshl_b32 s50, s2, 6
    s_add_u32 s50, s50, 147456
    s_mov_b64 exec, 1
    buffer_store_dword v99, off, s[28:31], s50 sc1
    s_mov_b64 exec, -1
f_nopoi2:
    s_sub_u32 s50, s41, 54
    s_cmp_lt_u32 s50, 108
    s_cbranch_scc0 f_nopostb
    ds_read2st64_b32 v[60:61], v125 offset0:18 offset1:19
    ds_read2st64_b32 v[62:63], v125 offset0:20 offset1:21
    ds_read2st64_b32 v[64:65], v125 offset0:22 offset1:23
    ds_read2st64_b32 v[66:67], v125 offset0:24 offset1:25
    v_lshlrev_b32 v2, 3, v1
    s_waitcnt lgkmcnt(0)
    v_pk_add_f32 v[60:61], v[60:61], v[62:63]
    v_pk_add_f32 v[64:65], v[64:65], v[66:67]
    v_pk_add_f32 v[60:61], v[60:61], v[64:65]
    v_add_f32 v60, v60, v61
    buffer_store_dword v60, v125, s[28:31], s48 offen sc1
f_nopostb:
    v_subrev_u32 v4, 192, v0
    v_lshlrev_b32 v3, 4, v4
    s_mul_i32 s50, s2, 9344
    s_add_u32 s50, s50, 1048576
    s_add_u32 s51, s50, 5120
    v_and_b32 v2, 1, v0
    v_mul_u32_u24 v2, 577, v2
    v_add_u32 v2, v2, v4
    s_lshr_b32 s46, s2, 6
    s_lshl_b32 s46, s46, 2
    s_add_u32 s46, s46, 65536
    v_add_u32 v2, s46, v2
    ds_read_u16 v28, v2 offset:0
    ds_read_u16 v32, v2 offset:20480
    ds_read_u16 v29, v2 offset:5120
    ds_read_u16 v33, v2 offset:25600
    ds_read_u16 v30, v2 offset:10240
    ds_read_u16 v34, v2 offset:30720
    ds_read_u16 v31, v2 offset:15360
    ds_read_u16 v35, v2 offset:35840
    ds_read_u16 v36, v2 offset:320
    ds_read_u16 v40, v2 offset:20800
    ds_read_u16 v37, v2 offset:5440
    ds_read_u16 v41, v2 offset:25920
    ds_read_u16 v38, v2 offset:10560
    ds_read_u16 v42, v2 offset:31040
    ds_read_u16 v39, v2 offset:15680
    ds_read_u16 v43, v2 offset:36160
    v_cmp_gt_u32 vcc, 264, v4
    v_mov_b32 v4, 0x7f000000
    s_nop 0
    v_cndmask_b32 v4, v4, v3, vcc
    s_waitcnt lgkmcnt(8)
    v_lshl_or_b32 v28, v32, 16, v28
    v_lshl_or_b32 v29, v33, 16, v29
    v_lshl_or_b32 v30, v34, 16, v30
    v_lshl_or_b32 v31, v35, 16, v31
    buffer_store_dwordx4 v[28:31], v3, s[28:31], s50 offen sc1
    s_waitcnt lgkmcnt(0)
    v_lshl_or_b32 v36, v40, 16, v36
    v_lshl_or_b32 v37, v41, 16, v37
    v_lshl_or_b32 v38, v42, 16, v38
    v_lshl_or_b32 v39, v43, 16, v39
    buffer_store_dwordx4 v[36:39], v4, s[28:31], s51 offen sc1
    s_cmp_lt_u32 s3, 4
    s_cbranch_scc1 f_nozp2
    s_lshl_b32 s51, s39, 11
    s_add_u32 s51, s51, 7340032
    s_lshl_b32 s50, s53, 13
    s_add_u32 s50, s50, s51
    buffer_store_dwordx4 v[68:71], v109, s[28:31], s50 offen offset:0 sc1
    buffer_store_dwordx4 v[68:71], v109, s[28:31], s50 offen offset:1024 sc1
    s_cmp_lt_u32 s2, 33
    s_cbranch_scc0 f_nozp2
    s_lshl_b32 s50, s54, 13
    s_add_u32 s50, s50, s51
    buffer_store_dwordx4 v[68:71], v109, s[28:31], s50 offen offset:0 sc1
    buffer_store_dwordx4 v[68:71], v109, s[28:31], s50 offen offset:1024 sc1
f_nozp2:
    s_cmp_lt_u32 s41, 54
    s_cbranch_scc0 f_c1done2
    v_cvt_f32_u32 v84, v7
    v_cvt_f32_u32 v85, v6
    v_mul_f32 v86, v85, v84
    v_mul_f32 v86, 0x3d800000, v86
    v_fmamk_f32 v72, v84, 0x00000000, v86
    v_cos_f32 v73, v72
    v_sin_f32 v74, v72
    v_fmamk_f32 v75, v84, 0x3c800000, v86
    v_cos_f32 v76, v75
    v_sin_f32 v77, v75
    v_cvt_pk_bf16_f32 v128, v73, v74
    v_cvt_pk_bf16_f32 v144, -v74, v73
    v_fmamk_f32 v72, v84, 0x3d000000, v86
    v_cos_f32 v73, v72
    v_sin_f32 v74, v72
    v_cvt_pk_bf16_f32 v129, v76, v77
    v_cvt_pk_bf16_f32 v145, -v77, v76
    v_fmamk_f32 v75, v84, 0x3d400000, v86
    v_cos_f32 v76, v75
    v_sin_f32 v77, v75
    v_cvt_pk_bf16_f32 v130, v73, v74
    v_cvt_pk_bf16_f32 v146, -v74, v73
    v_fmamk_f32 v72, v84, 0x3e800000, v86
    v_cos_f32 v73, v72
    v_sin_f32 v74, v72
    v_cvt_pk_bf16_f32 v131, v76, v77
    v_cvt_pk_bf16_f32 v147, -v77, v76
    v_fmamk_f32 v75, v84, 0x3e880000, v86
    v_cos_f32 v76, v75
    v_sin_f32 v77, v75
    v_cvt_pk_bf16_f32 v132, v73, v74
    v_cvt_pk_bf16_f32 v148, -v74, v73
    v_fmamk_f32 v72, v84, 0x3e900000, v86
    v_cos_f32 v73, v72
    v_sin_f32 v74, v72
    v_cvt_pk_bf16_f32 v133, v76, v77
    v_cvt_pk_bf16_f32 v149, -v77, v76
    v_fmamk_f32 v75, v84, 0x3e980000, v86
    v_cos_f32 v76, v75
    v_sin_f32 v77, v75
    v_cvt_pk_bf16_f32 v134, v73, v74
    v_cvt_pk_bf16_f32 v150, -v74, v73
    v_fmamk_f32 v72, v84, 0x3f000000, v86
    v_cos_f32 v73, v72
    v_sin_f32 v74, v72
    v_cvt_pk_bf16_f32 v135, v76, v77
    v_cvt_pk_bf16_f32 v151, -v77, v76
    v_fmamk_f32 v75, v84, 0x3f040000, v86
    v_cos_f32 v76, v75
    v_sin_f32 v77, v75
    v_cvt_pk_bf16_f32 v136, v73, v74
    v_cvt_pk_bf16_f32 v152, -v74, v73
    v_fmamk_f32 v72, v84, 0x3f080000, v86
    v_cos_f32 v73, v72
    v_sin_f32 v74, v72
    v_cvt_pk_bf16_f32 v137, v76, v77
    v_cvt_pk_bf16_f32 v153, -v77, v76
    v_fmamk_f32 v75, v84, 0x3f0c0000, v86
    v_cos_f32 v76, v75
    v_sin_f32 v77, v75
    v_cvt_pk_bf16_f32 v138, v73, v74
    v_cvt_pk_bf16_f32 v154, -v74, v73
    v_fmamk_f32 v72, v84, 0x3f400000, v86
    v_cos_f32 v73, v72
    v_sin_f32 v74, v72
    v_cvt_pk_bf16_f32 v139, v76, v77
    v_cvt_pk_bf16_f32 v155, -v77, v76
    v_fmamk_f32 v75, v84, 0x3f440000, v86
    v_cos_f32 v76, v75
    v_sin_f32 v77, v75
    v_cvt_pk_bf16_f32 v140, v73, v74
    v_cvt_pk_bf16_f32 v156, -v74, v73
    v_fmamk_f32 v72, v84, 0x3f480000, v86
    v_cos_f32 v73, v72
    v_sin_f32 v74, v72
    v_cvt_pk_bf16_f32 v141, v76, v77
    v_cvt_pk_bf16_f32 v157, -v77, v76
    v_fmamk_f32 v75, v84, 0x3f4c0000, v86
    v_cos_f32 v76, v75
    v_sin_f32 v77, v75
    v_cvt_pk_bf16_f32 v142, v73, v74
    v_cvt_pk_bf16_f32 v158, -v74, v73
    v_cvt_pk_bf16_f32 v143, v76, v77
    v_cvt_pk_bf16_f32 v159, -v77, v76
    v_cvt_f32_u32 v82, v1
    v_mul_f32 v73, 0x3ae38e39, v82
    v_mul_f32 v74, 0x3b638e39, v82
    v_mul_f32 v75, 0x3baaaaab, v82
    v_mul_f32 v76, 0x3be38e39, v82
    v_cos_f32 v208, v73
    v_sin_f32 v212, v73
    v_cos_f32 v209, v74
    v_sin_f32 v213, v74
    v_cos_f32 v210, v75
    v_sin_f32 v214, v75
    v_cos_f32 v211, v76
    v_sin_f32 v215, v76
f_c1done2:
    s_cmp_lt_u32 s41, 54
    s_cbranch_scc1 f_nosl0
    s_sleep 8
f_nosl0:
    s_cmp_lt_u32 s3, 3
    s_cbranch_scc0 f_staged
    v_mul_u32_u24 v2, 48, v0
    s_mov_b32 s44, 0x20000
    s_mov_b32 s45, 0x22400
    s_mov_b32 s46, 0x24800
    v_cmp_lt_u32 vcc, 95, v0
    s_nop 1
    v_cndmask_b32 v3, 0, 1.0, vcc
    s_mov_b32 s47, 0xffff0000
    v_lshrrev_b32 v78, 9, v2
    v_add_u32 v79, 32, v2
    v_lshrrev_b32 v79, 9, v79
    v_add_u32 v80, 16, v2
    v_lshrrev_b32 v80, 9, v80
    v_cmp_ne_u32 s[50:51], v80, v78
    v_mul_u32_u24 v78, 12, v78
    v_mul_u32_u24 v79, 12, v79
    s_mov_b32 s43, 0
f_mp:
    buffer_load_dword v67, off, s[24:27], 0 offset:252 sc1
    buffer_load_dwordx3 v[64:66], v78, s[24:27], 0 offen sc1
    buffer_load_dwordx3 v[68:70], v79, s[24:27], 0 offen sc1
    buffer_load_dwordx4 v[28:31], v2, s[28:31], s44 offen offset:0 sc1
    buffer_load_dwordx4 v[32:35], v2, s[28:31], s44 offen offset:16 sc1
    buffer_load_dwordx4 v[36:39], v2, s[28:31], s44 offen offset:32 sc1
    buffer_load_dwordx4 v[40:43], v2, s[28:31], s45 offen offset:0 sc1
    buffer_load_dwordx4 v[44:47], v2, s[28:31], s45 offen offset:16 sc1
    buffer_load_dwordx4 v[48:51], v2, s[28:31], s45 offen offset:32 sc1
    buffer_load_dwordx4 v[52:55], v2, s[28:31], s46 offen offset:0 sc1
    buffer_load_dwordx4 v[56:59], v2, s[28:31], s46 offen offset:16 sc1
    buffer_load_dwordx4 v[60:63], v2, s[28:31], s46 offen offset:32 sc1
    s_add_u32 s43, s43, 1
    s_waitcnt vmcnt(9)
    v_cndmask_b32 v74, v64, v68, s[50:51]
    v_cndmask_b32 v75, v65, v69, s[50:51]
    v_cndmask_b32 v76, v66, v70, s[50:51]
    v_min3_u32 v72, v64, v65, v66
    v_min3_u32 v73, v68, v69, v70
    v_min3_u32 v72, v72, v73, v67
    v_cmp_eq_u32 s[58:59], 0, v72
    s_waitcnt vmcnt(6)
    v_xor_b32 v72, v29, v64
    v_xor_b32 v73, v31, v64
    v_bitop3_b32 v72, v33, v74, v72 bitop3:0xbe
    v_bitop3_b32 v73, v35, v74, v73 bitop3:0xbe
    v_bitop3_b32 v72, v37, v68, v72 bitop3:0xbe
    v_bitop3_b32 v73, v39, v68, v73 bitop3:0xbe
    s_waitcnt vmcnt(3)
    v_bitop3_b32 v72, v41, v65, v72 bitop3:0xbe
    v_bitop3_b32 v73, v43, v65, v73 bitop3:0xbe
    v_bitop3_b32 v72, v45, v75, v72 bitop3:0xbe
    v_bitop3_b32 v73, v47, v75, v73 bitop3:0xbe
    v_bitop3_b32 v72, v49, v69, v72 bitop3:0xbe
    v_bitop3_b32 v73, v51, v69, v73 bitop3:0xbe
    s_waitcnt vmcnt(0)
    v_bitop3_b32 v72, v53, v66, v72 bitop3:0xbe
    v_bitop3_b32 v73, v55, v66, v73 bitop3:0xbe
    v_bitop3_b32 v72, v57, v76, v72 bitop3:0xbe
    v_bitop3_b32 v73, v59, v76, v73 bitop3:0xbe
    v_bitop3_b32 v72, v61, v70, v72 bitop3:0xbe
    v_bitop3_b32 v73, v63, v70, v73 bitop3:0xbe
    v_or_b32 v72, v72, v73
    v_cmp_ne_u32 vcc, 0, v72
    s_nop 0
    s_or_b64 exec, vcc, s[58:59]
    s_cbranch_scc0 f_mp_ok
    s_cmp_lt_u32 s43, 30000
    s_cbranch_scc1 f_mp
f_mp_ok:
    s_mov_b64 exec, -1
    s_mov_b32 s50, s43
    v_readfirstlane_b32 s26, v67
    v_lshrrev_b32 v2, 1, v2
    v_add_f32 v74, v28, v40
    v_add_f32 v75, v30, v42
    v_add_f32 v76, v32, v44
    v_add_f32 v77, v34, v46
    v_add_f32 v78, v36, v48
    v_add_f32 v79, v38, v50
    v_add_f32 v74, v74, v52
    v_add_f32 v75, v75, v54
    v_add_f32 v76, v76, v56
    v_add_f32 v77, v77, v58
    v_add_f32 v78, v78, v60
    v_add_f32 v79, v79, v62
    v_cvt_pk_bf16_f32 v72, v74, v75
    v_lshlrev_b32 v74, 16, v72
    v_and_b32 v75, s47, v72
    v_cvt_pk_bf16_f32 v73, v76, v77
    v_lshlrev_b32 v76, 16, v73
    v_and_b32 v77, s47, v73
    v_cvt_pk_bf16_f32 v72, v78, v79
    v_lshlrev_b32 v78, 16, v72
    v_and_b32 v79, s47, v72
    v_add_f32 v74, v74, v3
    v_add_f32 v75, v75, v3
    v_add_f32 v76, v76, v3
    v_add_f32 v77, v77, v3
    v_add_f32 v78, v78, v3
    v_add_f32 v79, v79, v3
    v_cvt_pk_bf16_f32 v72, v74, v75
    v_lshlrev_b32 v74, 16, v72
    v_and_b32 v75, s47, v72
    v_cvt_pk_bf16_f32 v73, v76, v77
    v_lshlrev_b32 v76, 16, v73
    v_and_b32 v77, s47, v73
    v_cvt_pk_bf16_f32 v72, v78, v79
    v_lshlrev_b32 v78, 16, v72
    v_and_b32 v79, s47, v72
    ds_write_b64 v2, v[74:75] offset:0
    ds_write_b64 v2, v[76:77] offset:8
    ds_write_b64 v2, v[78:79] offset:16
f_staged:
    s_load_dwordx2 s[8:9], s[0:1], 48
    s_mov_b32 s10, 0x1200000
    s_load_dwordx2 s[12:13], s[0:1], 56
    s_mov_b32 s14, 0x1000
    s_load_dwordx2 s[16:17], s[0:1], 80
    s_mov_b32 s18, 0x240000
    s_load_dwordx2 s[20:21], s[0:1], 40
    s_mov_b32 s22, 0x2400
    s_waitcnt lgkmcnt(0)
    s_barrier
    s_cmp_eq_u32 s3, 3
    s_cbranch_scc0 f_nofp
    v_lshlrev_b32 v2, 6, v1
    v_min_u32 v3, 960, v2
    s_mov_b32 s51, 158720
    s_mov_b32 s46, 162816
    buffer_load_dword v98, off, s[24:27], 0 offset:252 sc1
    buffer_load_dword v99, v2, s[28:31], s51 offen sc1
    buffer_load_dword v100, v3, s[28:31], s46 offen sc1
f_nofp:
    ds_read2st64_b32 v[36:37], v125 offset0:8 offset1:9
    ds_read2st64_b32 v[38:39], v125 offset0:10 offset1:11
    ds_read2st64_b32 v[40:41], v125 offset0:12 offset1:13
    ds_read2st64_b32 v[42:43], v125 offset0:14 offset1:15
    ds_read2st64_b32 v[44:45], v125 offset0:16 offset1:17
    ds_read2st64_b32 v[28:29], v125 offset0:0 offset1:1
    ds_read2st64_b32 v[30:31], v125 offset0:2 offset1:3
    ds_read2st64_b32 v[32:33], v125 offset0:4 offset1:5
    ds_read2st64_b32 v[34:35], v125 offset0:6 offset1:7
    s_waitcnt lgkmcnt(3)
    v_fma_f32 v8, v8, v37, v28
    v_fma_f32 v9, v9, v38, v29
    s_waitcnt lgkmcnt(2)
    v_fma_f32 v10, v10, v39, v30
    v_fma_f32 v11, v11, v40, v31
    s_waitcnt lgkmcnt(1)
    v_fma_f32 v12, v12, v41, v32
    v_fma_f32 v13, v13, v42, v33
    s_waitcnt lgkmcnt(0)
    v_fma_f32 v14, v14, v43, v34
    v_fma_f32 v15, v15, v44, v35
    v_fma_f32 v16, v16, v45, v36
    v_add_f32 v48, v9, v16
    v_sub_f32 v52, v9, v16
    v_add_f32 v49, v10, v15
    v_sub_f32 v53, v10, v15
    v_add_f32 v50, v11, v14
    v_sub_f32 v54, v11, v14
    v_add_f32 v51, v12, v13
    v_sub_f32 v55, v12, v13
    v_add_f32 v64, v8, v48
    v_add_f32 v65, v49, v50
    v_add_f32 v64, v64, v51
    v_add_f32 v64, v64, v65
    v_fmamk_f32 v56, v48, 0x3f441b7d, v8
    v_fmamk_f32 v57, v48, 0x3e31d0d4, v8
    v_fmamk_f32 v58, v48, 0xbf000000, v8
    v_fmamk_f32 v59, v48, 0xbf708fb2, v8
    v_fmamk_f32 v56, v49, 0x3e31d0d4, v56
    v_fmamk_f32 v57, v49, 0xbf708fb2, v57
    v_fmamk_f32 v58, v49, 0xbf000000, v58
    v_fmamk_f32 v59, v49, 0x3f441b7d, v59
    v_fmamk_f32 v56, v50, 0xbf000000, v56
    v_fmamk_f32 v57, v50, 0xbf000000, v57
    v_fmamk_f32 v58, v50, 0x3f800000, v58
    v_fmamk_f32 v59, v50, 0xbf000000, v59
    v_fmamk_f32 v56, v51, 0xbf708fb2, v56
    v_fmamk_f32 v57, v51, 0x3f441b7d, v57
    v_fmamk_f32 v58, v51, 0xbf000000, v58
    v_fmamk_f32 v59, v51, 0x3e31d0d4, v59
    v_mul_f32 v60, 0xbf248dbb, v52
    v_mul_f32 v61, 0xbf7c1c5c, v52
    v_mul_f32 v62, 0xbf5db3d7, v52
    v_mul_f32 v63, 0xbeaf1d44, v52
    v_fmamk_f32 v60, v53, 0xbf7c1c5c, v60
    v_fmamk_f32 v61, v53, 0xbeaf1d44, v61
    v_fmamk_f32 v62, v53, 0x3f5db3d7, v62
    v_fmamk_f32 v63, v53, 0x3f248dbb, v63
    v_fmamk_f32 v60, v54, 0xbf5db3d7, v60
    v_fmamk_f32 v61, v54, 0x3f5db3d7, v61
    v_fmamk_f32 v63, v54, 0xbf5db3d7, v63
    v_fmamk_f32 v60, v55, 0xbeaf1d44, v60
    v_fmamk_f32 v61, v55, 0x3f248dbb, v61
    v_fmamk_f32 v62, v55, 0xbf5db3d7, v62
    v_fmamk_f32 v63, v55, 0x3f7c1c5c, v63
    v_cvt_pk_bf16_f32 v64, v64, 0
    ds_write_b32 v104, v64
    v_pk_mul_f32 v[68:69], v[56:57], v[208:209]
    v_pk_mul_f32 v[72:73], v[60:61], v[208:209]
    v_pk_mul_f32 v[70:71], v[58:59], v[210:211]
    v_pk_mul_f32 v[74:75], v[62:63], v[210:211]
    v_pk_fma_f32 v[68:69], v[60:61], v[212:213], v[68:69]
    v_pk_fma_f32 v[72:73], v[56:57], v[212:213], v[72:73] neg_lo:[1,0,0] neg_hi:[1,0,0]
    v_pk_fma_f32 v[70:71], v[62:63], v[214:215], v[70:71]
    v_pk_fma_f32 v[74:75], v[58:59], v[214:215], v[74:75] neg_lo:[1,0,0] neg_hi:[1,0,0]
    v_cvt_pk_bf16_f32 v9, v68, v72
    ds_write_b32 v104, v9 offset:2176
    v_cvt_pk_bf16_f32 v10, v69, v73
    ds_write_b32 v104, v10 offset:4352
    v_cvt_pk_bf16_f32 v11, v70, v74
    ds_write_b32 v104, v11 offset:6528
    v_cvt_pk_bf16_f32 v12, v71, v75
    ds_write_b32 v104, v12 offset:8704
    s_cmp_lt_u32 s39, 2
    s_cselect_b32 s47, 0, 0x80000000
    s_waitcnt vmcnt(0) lgkmcnt(0)
    s_cmp_eq_u32 s3, 3
    s_cbranch_scc0 f_pf_ok
    s_mov_b32 s50, 0
f_pf:
    v_xor_b32 v99, v99, v98
    v_bitop3_b32 v99, v100, v98, v99 bitop3:0xbe
    v_cmp_eq_u32 s[58:59], 0, v98
    v_cmp_ne_u32 vcc, 0, v99
    s_nop 0
    s_or_b64 vcc, vcc, s[58:59]
    s_cbranch_scc0 f_pf_got
    s_cmp_lt_u32 s50, 30000
    s_cbranch_scc0 f_pf_got
    v_lshlrev_b32 v2, 6, v1
    v_min_u32 v3, 960, v2
    s_mov_b32 s51, 158720
    s_mov_b32 s46, 162816
    buffer_load_dword v98, off, s[24:27], 0 offset:252 sc1
    buffer_load_dword v99, v2, s[28:31], s51 offen sc1
    buffer_load_dword v100, v3, s[28:31], s46 offen sc1
    s_add_u32 s50, s50, 1
    s_waitcnt vmcnt(0)
    s_branch f_pf
f_pf_got:
    v_readfirstlane_b32 s26, v98
f_pf_ok:
    s_barrier
    ds_read_b128 v[28:31], v105 offset:0
    ds_read_b128 v[32:35], v105 offset:64
    ds_read_b128 v[36:39], v105 offset:128
    ds_read_b128 v[40:43], v105 offset:192
    s_cmp_eq_u32 s40, 1
    s_cbranch_scc1 f_p1_one
    ds_read_b128 v[44:47], v105 offset:4352
    ds_read_b128 v[48:51], v105 offset:4416
    ds_read_b128 v[52:55], v105 offset:4480
    ds_read_b128 v[56:59], v105 offset:4544
    s_waitcnt lgkmcnt(7)
    v_mfma_f32_16x16x32_bf16 v[60:63], v[28:31], v[128:131], 0
    v_mfma_f32_16x16x32_bf16 v[64:67], v[28:31], v[144:147], 0
    s_waitcnt lgkmcnt(6)
    v_mfma_f32_16x16x32_bf16 v[60:63], v[32:35], v[132:135], v[60:63]
    v_mfma_f32_16x16x32_bf16 v[64:67], v[32:35], v[148:151], v[64:67]
    s_waitcnt lgkmcnt(5)
    v_mfma_f32_16x16x32_bf16 v[60:63], v[36:39], v[136:139], v[60:63]
    v_mfma_f32_16x16x32_bf16 v[64:67], v[36:39], v[152:155], v[64:67]
    s_waitcnt lgkmcnt(4)
    v_mfma_f32_16x16x32_bf16 v[60:63], v[40:43], v[140:143], v[60:63]
    v_mfma_f32_16x16x32_bf16 v[64:67], v[40:43], v[156:159], v[64:67]
    s_waitcnt lgkmcnt(3)
    v_mfma_f32_16x16x32_bf16 v[68:71], v[44:47], v[128:131], 0
    v_mfma_f32_16x16x32_bf16 v[72:75], v[44:47], v[144:147], 0
    s_waitcnt lgkmcnt(2)
    v_mfma_f32_16x16x32_bf16 v[68:71], v[48:51], v[132:135], v[68:71]
    v_mfma_f32_16x16x32_bf16 v[72:75], v[48:51], v[148:151], v[72:75]
    s_waitcnt lgkmcnt(1)
    v_mfma_f32_16x16x32_bf16 v[68:71], v[52:55], v[136:139], v[68:71]
    v_mfma_f32_16x16x32_bf16 v[72:75], v[52:55], v[152:155], v[72:75]
    s_waitcnt lgkmcnt(0)
    v_mfma_f32_16x16x32_bf16 v[68:71], v[56:59], v[140:143], v[68:71]
    v_mfma_f32_16x16x32_bf16 v[72:75], v[56:59], v[156:159], v[72:75]
    v_cvt_pk_bf16_f32 v76, v60, v64
    v_cvt_pk_bf16_f32 v77, v61, v65
    v_cvt_pk_bf16_f32 v78, v62, v66
    v_cvt_pk_bf16_f32 v79, v63, v67
    v_xor_b32 v76, s47, v76
    v_xor_b32 v77, s47, v77
    v_xor_b32 v78, s47, v78
    v_xor_b32 v79, s47, v79
    buffer_store_dwordx4 v[76:79], v106, s[28:31], s56 offen sc1
    v_cvt_pk_bf16_f32 v80, v68, v72
    v_cvt_pk_bf16_f32 v81, v69, v73
    v_cvt_pk_bf16_f32 v82, v70, v74
    v_cvt_pk_bf16_f32 v83, v71, v75
    v_xor_b32 v80, s47, v80
    v_xor_b32 v81, s47, v81
    v_xor_b32 v82, s47, v82
    v_xor_b32 v83, s47, v83
    buffer_store_dwordx4 v[80:83], v107, s[28:31], s56 offen sc1
    s_branch f_p1_join
f_p1_one:
    s_waitcnt lgkmcnt(3)
    v_mfma_f32_16x16x32_bf16 v[60:63], v[28:31], v[128:131], 0
    v_mfma_f32_16x16x32_bf16 v[64:67], v[28:31], v[144:147], 0
    s_waitcnt lgkmcnt(2)
    v_mfma_f32_16x16x32_bf16 v[60:63], v[32:35], v[132:135], v[60:63]
    v_mfma_f32_16x16x32_bf16 v[64:67], v[32:35], v[148:151], v[64:67]
    s_waitcnt lgkmcnt(1)
    v_mfma_f32_16x16x32_bf16 v[60:63], v[36:39], v[136:139], v[60:63]
    v_mfma_f32_16x16x32_bf16 v[64:67], v[36:39], v[152:155], v[64:67]
    s_waitcnt lgkmcnt(0)
    v_mfma_f32_16x16x32_bf16 v[60:63], v[40:43], v[140:143], v[60:63]
    v_mfma_f32_16x16x32_bf16 v[64:67], v[40:43], v[156:159], v[64:67]
    s_nop 7
    v_cvt_pk_bf16_f32 v76, v60, v64
    v_cvt_pk_bf16_f32 v77, v61, v65
    v_cvt_pk_bf16_f32 v78, v62, v66
    v_cvt_pk_bf16_f32 v79, v63, v67
    v_xor_b32 v76, s47, v76
    v_xor_b32 v77, s47, v77
    v_xor_b32 v78, s47, v78
    v_xor_b32 v79, s47, v79
    buffer_store_dwordx4 v[76:79], v106, s[28:31], s56 offen sc1
f_p1_join:
    s_cmp_eq_u32 s3, 6
    s_cbranch_scc0 f_nofl
    s_lshl_b32 s50, s2, 10
    s_add_u32 s50, s50, 262144
    buffer_store_dwordx4 v[18:21], v109, s[28:31], s50 offen sc1
f_nofl:
    s_cmp_lt_u32 s38, 64
    s_cbranch_scc0 f_noh2p
    v_mov_b32 v28, -1
    v_mov_b32 v29, -1
    v_mov_b32 v30, -1
    v_mov_b32 v31, -1
    s_mul_i32 s50, s38, 1536
    s_add_u32 s50, s50, 13631488
    buffer_store_dwordx4 v[28:31], v122, s[28:31], s50 offen sc1
    s_cmp_eq_u32 s3, 1
    s_cbranch_scc0 f_noh2p
    buffer_store_dwordx4 v[28:31], v123, s[28:31], s50 offen sc1
f_noh2p:
    s_cmp_eq_u32 s42, -1
    s_cbranch_scc1 f_c3now
    v_cvt_f32_u32 v96, v7
    v_cvt_f32_u32 v97, v6
    v_mul_f32 v98, v97, v96
    v_mul_f32 v98, 0x3d800000, v98
    v_mul_f32 v98, 0x3d000000, v98
    v_fmamk_f32 v84, v96, 0x00000000, v98
    v_fmamk_f32 v85, v96, 0x3a000000, v98
    v_fmamk_f32 v86, v96, 0x3a800000, v98
    v_fmamk_f32 v87, v96, 0x3ac00000, v98
    v_cos_f32 v192, v84
    v_sin_f32 v200, v84
    v_cos_f32 v193, v85
    v_sin_f32 v201, v85
    v_cos_f32 v194, v86
    v_sin_f32 v202, v86
    v_cos_f32 v195, v87
    v_sin_f32 v203, v87
    v_fmamk_f32 v84, v96, 0x3c000000, v98
    v_fmamk_f32 v85, v96, 0x3c080000, v98
    v_fmamk_f32 v86, v96, 0x3c100000, v98
    v_fmamk_f32 v87, v96, 0x3c180000, v98
    v_cos_f32 v196, v84
    v_sin_f32 v204, v84
    v_cos_f32 v197, v85
    v_sin_f32 v205, v85
    v_cos_f32 v198, v86
    v_sin_f32 v206, v86
    v_cos_f32 v199, v87
    v_sin_f32 v207, v87
    v_add_u32 v96, 0, v5
    v_cvt_f32_u32 v96, v96
    v_mul_f32 v98, v97, v96
    v_mul_f32 v98, 0x3e000000, v98
    v_fmamk_f32 v84, v96, 0x00000000, v98
    v_fmamk_f32 v85, v96, 0x3d000000, v98
    v_fmamk_f32 v86, v96, 0x3d800000, v98
    v_fmamk_f32 v87, v96, 0x3dc00000, v98
    v_cos_f32 v88, v84
    v_sin_f32 v92, v84
    v_cos_f32 v89, v85
    v_sin_f32 v93, v85
    v_cos_f32 v90, v86
    v_sin_f32 v94, v86
    v_cos_f32 v91, v87
    v_sin_f32 v95, v87
    v_cvt_pk_bf16_f32 v160, v88, v89
    v_cvt_pk_bf16_f32 v161, v90, v91
    v_cvt_pk_bf16_f32 v178, v88, v89
    v_cvt_pk_bf16_f32 v179, v90, v91
    v_cvt_pk_bf16_f32 v162, v92, v93
    v_cvt_pk_bf16_f32 v163, v94, v95
    v_cvt_pk_bf16_f32 v176, -v92, -v93
    v_cvt_pk_bf16_f32 v177, -v94, -v95
    v_fmamk_f32 v84, v96, 0x3f000000, v98
    v_fmamk_f32 v85, v96, 0x3f080000, v98
    v_fmamk_f32 v86, v96, 0x3f100000, v98
    v_fmamk_f32 v87, v96, 0x3f180000, v98
    v_cos_f32 v88, v84
    v_sin_f32 v92, v84
    v_cos_f32 v89, v85
    v_sin_f32 v93, v85
    v_cos_f32 v90, v86
    v_sin_f32 v94, v86
    v_cos_f32 v91, v87
    v_sin_f32 v95, v87
    v_cvt_pk_bf16_f32 v164, v88, v89
    v_cvt_pk_bf16_f32 v165, v90, v91
    v_cvt_pk_bf16_f32 v182, v88, v89
    v_cvt_pk_bf16_f32 v183, v90, v91
    v_cvt_pk_bf16_f32 v166, v92, v93
    v_cvt_pk_bf16_f32 v167, v94, v95
    v_cvt_pk_bf16_f32 v180, -v92, -v93
    v_cvt_pk_bf16_f32 v181, -v94, -v95
    v_add_u32 v96, 16, v5
    v_cvt_f32_u32 v96, v96
    v_mul_f32 v98, v97, v96
    v_mul_f32 v98, 0x3e000000, v98
    v_fmamk_f32 v84, v96, 0x00000000, v98
    v_fmamk_f32 v85, v96, 0x3d000000, v98
    v_fmamk_f32 v86, v96, 0x3d800000, v98
    v_fmamk_f32 v87, v96, 0x3dc00000, v98
    v_cos_f32 v88, v84
    v_sin_f32 v92, v84
    v_cos_f32 v89, v85
    v_sin_f32 v93, v85
    v_cos_f32 v90, v86
    v_sin_f32 v94, v86
    v_cos_f32 v91, v87
    v_sin_f32 v95, v87
    v_cvt_pk_bf16_f32 v168, v88, v89
    v_cvt_pk_bf16_f32 v169, v90, v91
    v_cvt_pk_bf16_f32 v186, v88, v89
    v_cvt_pk_bf16_f32 v187, v90, v91
    v_cvt_pk_bf16_f32 v170, v92, v93
    v_cvt_pk_bf16_f32 v171, v94, v95
    v_cvt_pk_bf16_f32 v184, -v92, -v93
    v_cvt_pk_bf16_f32 v185, -v94, -v95
    v_fmamk_f32 v84, v96, 0x3f000000, v98
    v_fmamk_f32 v85, v96, 0x3f080000, v98
    v_fmamk_f32 v86, v96, 0x3f100000, v98
    v_fmamk_f32 v87, v96, 0x3f180000, v98
    v_cos_f32 v88, v84
    v_sin_f32 v92, v84
    v_cos_f32 v89, v85
    v_sin_f32 v93, v85
    v_cos_f32 v90, v86
    v_sin_f32 v94, v86
    v_cos_f32 v91, v87
    v_sin_f32 v95, v87
    v_cvt_pk_bf16_f32 v172, v88, v89
    v_cvt_pk_bf16_f32 v173, v90, v91
    v_cvt_pk_bf16_f32 v190, v88, v89
    v_cvt_pk_bf16_f32 v191, v90, v91
    v_cvt_pk_bf16_f32 v174, v92, v93
    v_cvt_pk_bf16_f32 v175, v94, v95
    v_cvt_pk_bf16_f32 v188, -v92, -v93
    v_cvt_pk_bf16_f32 v189, -v94, -v95
    s_branch f_c3done
f_c3now:
    v_cvt_f32_u32 v96, v7
    v_cvt_f32_u32 v97, v6
    v_mul_f32 v97, v97, v96
    v_mul_f32 v97, 0x3d800000, v97
    v_fmamk_f32 v84, v96, 0x00000000, v97
    v_fmamk_f32 v85, v96, 0x3c800000, v97
    v_fmamk_f32 v86, v96, 0x3d000000, v97
    v_fmamk_f32 v87, v96, 0x3d400000, v97
    v_cos_f32 v88, v84
    v_sin_f32 v92, v84
    v_cos_f32 v89, v85
    v_sin_f32 v93, v85
    v_cos_f32 v90, v86
    v_sin_f32 v94, v86
    v_cos_f32 v91, v87
    v_sin_f32 v95, v87
    v_cvt_pk_bf16_f32 v216, v88, v89
    v_cvt_pk_bf16_f32 v217, v90, v91
    v_cvt_pk_bf16_f32 v234, -v88, -v89
    v_cvt_pk_bf16_f32 v235, -v90, -v91
    v_cvt_pk_bf16_f32 v218, v92, v93
    v_cvt_pk_bf16_f32 v219, v94, v95
    v_cvt_pk_bf16_f32 v232, v92, v93
    v_cvt_pk_bf16_f32 v233, v94, v95
    v_fmamk_f32 v84, v96, 0x3e800000, v97
    v_fmamk_f32 v85, v96, 0x3e880000, v97
    v_fmamk_f32 v86, v96, 0x3e900000, v97
    v_fmamk_f32 v87, v96, 0x3e980000, v97
    v_cos_f32 v88, v84
    v_sin_f32 v92, v84
    v_cos_f32 v89, v85
    v_sin_f32 v93, v85
    v_cos_f32 v90, v86
    v_sin_f32 v94, v86
    v_cos_f32 v91, v87
    v_sin_f32 v95, v87
    v_cvt_pk_bf16_f32 v220, v88, v89
    v_cvt_pk_bf16_f32 v221, v90, v91
    v_cvt_pk_bf16_f32 v238, -v88, -v89
    v_cvt_pk_bf16_f32 v239, -v90, -v91
    v_cvt_pk_bf16_f32 v222, v92, v93
    v_cvt_pk_bf16_f32 v223, v94, v95
    v_cvt_pk_bf16_f32 v236, v92, v93
    v_cvt_pk_bf16_f32 v237, v94, v95
    v_fmamk_f32 v84, v96, 0x3f000000, v97
    v_fmamk_f32 v85, v96, 0x3f040000, v97
    v_fmamk_f32 v86, v96, 0x3f080000, v97
    v_fmamk_f32 v87, v96, 0x3f0c0000, v97
    v_cos_f32 v88, v84
    v_sin_f32 v92, v84
    v_cos_f32 v89, v85
    v_sin_f32 v93, v85
    v_cos_f32 v90, v86
    v_sin_f32 v94, v86
    v_cos_f32 v91, v87
    v_sin_f32 v95, v87
    v_cvt_pk_bf16_f32 v224, v88, v89
    v_cvt_pk_bf16_f32 v225, v90, v91
    v_cvt_pk_bf16_f32 v242, v88, v89
    v_cvt_pk_bf16_f32 v243, v90, v91
    v_cvt_pk_bf16_f32 v226, -v92, -v93
    v_cvt_pk_bf16_f32 v227, -v94, -v95
    v_cvt_pk_bf16_f32 v240, v92, v93
    v_cvt_pk_bf16_f32 v241, v94, v95
    v_fmamk_f32 v84, v96, 0x3f400000, v97
    v_fmamk_f32 v85, v96, 0x3f440000, v97
    v_fmamk_f32 v86, v96, 0x3f480000, v97
    v_fmamk_f32 v87, v96, 0x3f4c0000, v97
    v_cos_f32 v88, v84
    v_sin_f32 v92, v84
    v_cos_f32 v89, v85
    v_sin_f32 v93, v85
    v_cos_f32 v90, v86
    v_sin_f32 v94, v86
    v_cos_f32 v91, v87
    v_sin_f32 v95, v87
    v_cvt_pk_bf16_f32 v228, v88, v89
    v_cvt_pk_bf16_f32 v229, v90, v91
    v_cvt_pk_bf16_f32 v246, v88, v89
    v_cvt_pk_bf16_f32 v247, v90, v91
    v_cvt_pk_bf16_f32 v230, -v92, -v93
    v_cvt_pk_bf16_f32 v231, -v94, -v95
    v_cvt_pk_bf16_f32 v244, v92, v93
    v_cvt_pk_bf16_f32 v245, v94, v95
    v_mul_f32 v85, 0x3ae38e39, v96
    v_mul_f32 v86, 0x3b638e39, v96
    v_mul_f32 v87, 0x3baaaaab, v96
    v_mul_f32 v88, 0x3be38e39, v96
    v_cos_f32 v248, v85
    v_sin_f32 v252, v85
    v_cos_f32 v249, v86
    v_sin_f32 v253, v86
    v_cos_f32 v250, v87
    v_sin_f32 v254, v87
    v_cos_f32 v251, v88
    v_sin_f32 v255, v88
    v_mul_f32 v248, 0x35e38e39, v248
    v_mul_f32 v249, 0x35e38e39, v249
    v_mul_f32 v250, 0x35e38e39, v250
    v_mul_f32 v251, 0x35e38e39, v251
    v_mul_f32 v252, 0x35e38e39, v252
    v_mul_f32 v253, 0x35e38e39, v253
    v_mul_f32 v254, 0x35e38e39, v254
    v_mul_f32 v255, 0x35e38e39, v255
f_c3done:
    s_mul_i32 s63, s36, 27
    s_add_u32 s63, s63, s37
    s_mul_i32 s62, s63, 171
    s_lshr_b32 s62, s62, 10
    s_mul_i32 s60, s62, 6
    s_sub_u32 s63, s63, s60
    s_lshl_b32 s60, s62, 8
    s_mul_i32 s61, s39, 147456
    s_add_u32 s60, s60, s61
    s_mul_i32 s61, s63, 393216
    s_mul_i32 s24, s39, 3072
    s_add_u32 s61, s61, s24
    s_add_u32 s61, s61, 13631488
    s_lshl_b32 s24, s39, 12
    s_add_u32 s24, s24, 65536
    v_lshrrev_b32 v2, 4, v1
    v_and_b32 v3, 15, v1
    v_lshlrev_b32 v9, 1, v2
    v_xor_b32 v9, v9, v3
    v_xor_b32 v10, 8, v9
    v_mul_u32_u24 v2, 9216, v2
    v_lshl_add_u32 v9, v9, 4, v2
    v_lshl_add_u32 v10, v10, 4, v2
    v_lshlrev_b32 v14, 4, v1
    v_lshlrev_b32 v15, 2, v1
    s_cmp_eq_u32 s42, -1
    s_cbranch_scc1 f_p2_idle
    s_and_b32 s50, s39, 1
    s_lshl_b32 s50, s50, 4
    s_lshr_b32 s51, s39, 1
    s_add_u32 s50, s50, s51
    s_mul_i32 s50, s50, 81920
    s_lshl_b32 s51, s42, 5
    s_add_u32 s50, s50, s51
    s_add_u32 s44, s50, 4194304
    s_add_u32 s45, s44, 655360
    s_lshl_b32 s50, s3, 11
    s_add_u32 s50, s50, 29952
    v_add_u32 v2, s50, v109
    s_lshl_b32 s50, s40, 13
    s_add_u32 s50, s50, 29952
    v_add_u32 v3, s50, v109
    s_lshr_b32 s50, s42, 6
    s_and_b32 s51, s42, 63
    s_mul_i32 s46, s51, 9
    s_add_u32 s46, s46, s50
    s_sub_u32 s50, 576, s46
    s_cmp_lt_u32 s51, 32
    s_cselect_b32 s46, s46, s50
    s_lshl_b32 s46, s46, 5
    s_mul_i32 s50, s39, 18688
    s_add_u32 s46, s46, s50
    s_add_u32 s46, s46, 1048576
    s_add_u32 s51, s46, 299008
    v_bfe_u32 v4, v1, 3, 1
    v_lshl_add_u32 v4, v6, 3, v4
    v_bfe_u32 v84, v1, 1, 2
    v_lshl_add_u32 v4, v84, 6, v4
    v_mul_u32_u24 v4, 9344, v4
    v_and_b32 v84, 1, v1
    v_lshl_add_u32 v4, v84, 4, v4
    s_lshl_b32 s48, s42, 13
    s_add_u32 s48, s48, 7340032
    s_mov_b32 s47, 0xffff0000
    s_waitcnt vmcnt(0)
    s_mov_b32 s50, 0
f_hb:
    buffer_load_dwordx4 v[28:31], v108, s[28:31], s44 offen sc1
    buffer_load_dwordx4 v[32:35], v108, s[28:31], s45 offen sc1
    s_add_u32 s50, s50, 1
    s_waitcnt vmcnt(0)
    v_max3_u32 v84, v28, v29, v30
    v_max3_u32 v84, v84, v31, v32
    v_max3_u32 v84, v84, v33, v34
    v_max_u32 v84, v84, v35
    v_cmp_eq_u32 vcc, -1, v84
    s_nop 0
    s_and_b64 exec, vcc, vcc
    s_cbranch_scc0 f_hb_ok
    s_cmp_lt_u32 s50, 30000
    s_cbranch_scc1 f_hb
f_hb_ok:
    s_mov_b64 exec, -1
    buffer_load_dwordx4 v[96:99], v4, s[28:31], s46 offen sc1
    buffer_load_dwordx4 v[100:103], v4, s[28:31], s51 offen sc1
    ds_write_b128 v2, v[28:31] offset:0
    ds_write_b128 v2, v[32:35] offset:1024
    s_waitcnt lgkmcnt(0)
    s_barrier
    s_add_u32 m0, s55, 0
    s_nop 0
    buffer_load_dwordx4 v109, s[4:7], s49 offen lds
    s_mov_b64 exec, 0xff
    buffer_load_dwordx4 v109, s[4:7], s49 offen offset:1024 lds
    s_mov_b64 exec, -1
    ds_read_b128 v[28:31], v3 offset:0
    ds_read_b128 v[44:47], v3 offset:4096
    ds_read_b128 v[32:35], v3 offset:1024
    ds_read_b128 v[48:51], v3 offset:5120
    ds_read_b128 v[36:39], v3 offset:2048
    ds_read_b128 v[52:55], v3 offset:6144
    ds_read_b128 v[40:43], v3 offset:3072
    ds_read_b128 v[56:59], v3 offset:7168
    s_waitcnt lgkmcnt(7)
    v_mfma_f32_16x16x32_bf16 v[60:63], v[28:31], v[128:131], 0
    v_mfma_f32_16x16x32_bf16 v[64:67], v[28:31], v[144:147], 0
    s_waitcnt lgkmcnt(6)
    v_mfma_f32_16x16x32_bf16 v[68:71], v[44:47], v[128:131], 0
    v_mfma_f32_16x16x32_bf16 v[72:75], v[44:47], v[144:147], 0
    s_waitcnt lgkmcnt(5)
    v_mfma_f32_16x16x32_bf16 v[60:63], v[32:35], v[132:135], v[60:63]
    v_mfma_f32_16x16x32_bf16 v[64:67], v[32:35], v[148:151], v[64:67]
    s_waitcnt lgkmcnt(4)
    v_mfma_f32_16x16x32_bf16 v[68:71], v[48:51], v[132:135], v[68:71]
    v_mfma_f32_16x16x32_bf16 v[72:75], v[48:51], v[148:151], v[72:75]
    s_waitcnt lgkmcnt(3)
    v_mfma_f32_16x16x32_bf16 v[60:63], v[36:39], v[136:139], v[60:63]
    v_mfma_f32_16x16x32_bf16 v[64:67], v[36:39], v[152:155], v[64:67]
    s_waitcnt lgkmcnt(2)
    v_mfma_f32_16x16x32_bf16 v[68:71], v[52:55], v[136:139], v[68:71]
    v_mfma_f32_16x16x32_bf16 v[72:75], v[52:55], v[152:155], v[72:75]
    s_waitcnt lgkmcnt(1)
    v_mfma_f32_16x16x32_bf16 v[60:63], v[40:43], v[140:143], v[60:63]
    v_mfma_f32_16x16x32_bf16 v[64:67], v[40:43], v[156:159], v[64:67]
    s_waitcnt lgkmcnt(0)
    v_mfma_f32_16x16x32_bf16 v[68:71], v[56:59], v[140:143], v[68:71]
    v_mfma_f32_16x16x32_bf16 v[72:75], v[56:59], v[156:159], v[72:75]
    s_nop 3
    v_pk_mul_f32 v[84:85], v[60:61], v[192:193]
    v_pk_mul_f32 v[88:89], v[64:65], v[192:193]
    v_pk_mul_f32 v[86:87], v[62:63], v[194:195]
    v_pk_mul_f32 v[90:91], v[66:67], v[194:195]
    v_pk_fma_f32 v[84:85], v[64:65], v[200:201], v[84:85]
    v_pk_fma_f32 v[88:89], v[60:61], v[200:201], v[88:89] neg_lo:[1,0,0] neg_hi:[1,0,0]
    v_pk_fma_f32 v[86:87], v[66:67], v[202:203], v[86:87]
    v_pk_fma_f32 v[90:91], v[62:63], v[202:203], v[90:91] neg_lo:[1,0,0] neg_hi:[1,0,0]
    v_cvt_pk_bf16_f32 v76, v84, v85
    v_cvt_pk_bf16_f32 v77, v86, v87
    v_cvt_pk_bf16_f32 v78, v88, v89
    v_cvt_pk_bf16_f32 v79, v90, v91
    v_pk_mul_f32 v[84:85], v[68:69], v[196:197]
    v_pk_mul_f32 v[88:89], v[72:73], v[196:197]
    v_pk_mul_f32 v[86:87], v[70:71], v[198:199]
    v_pk_mul_f32 v[90:91], v[74:75], v[198:199]
    v_pk_fma_f32 v[84:85], v[72:73], v[204:205], v[84:85]
    v_pk_fma_f32 v[88:89], v[68:69], v[204:205], v[88:89] neg_lo:[1,0,0] neg_hi:[1,0,0]
    v_pk_fma_f32 v[86:87], v[74:75], v[206:207], v[86:87]
    v_pk_fma_f32 v[90:91], v[70:71], v[206:207], v[90:91] neg_lo:[1,0,0] neg_hi:[1,0,0]
    v_cvt_pk_bf16_f32 v80, v84, v85
    v_cvt_pk_bf16_f32 v81, v86, v87
    v_cvt_pk_bf16_f32 v82, v88, v89
    v_cvt_pk_bf16_f32 v83, v90, v91
    v_mfma_f32_16x16x32_bf16 v[60:63], v[160:163], v[76:79], 0
    v_mfma_f32_16x16x32_bf16 v[64:67], v[176:179], v[76:79], 0
    v_mfma_f32_16x16x32_bf16 v[68:71], v[168:171], v[76:79], 0
    v_mfma_f32_16x16x32_bf16 v[72:75], v[184:187], v[76:79], 0
    v_mfma_f32_16x16x32_bf16 v[60:63], v[164:167], v[80:83], v[60:63]
    v_mfma_f32_16x16x32_bf16 v[64:67], v[180:183], v[80:83], v[64:67]
    v_mfma_f32_16x16x32_bf16 v[68:71], v[172:175], v[80:83], v[68:71]
    v_mfma_f32_16x16x32_bf16 v[72:75], v[188:191], v[80:83], v[72:75]
    s_waitcnt vmcnt(2)
    v_lshlrev_b32 v28, 16, v96
    v_and_b32 v36, s47, v96
    v_lshlrev_b32 v29, 16, v97
    v_and_b32 v37, s47, v97
    v_lshlrev_b32 v30, 16, v98
    v_and_b32 v38, s47, v98
    v_lshlrev_b32 v31, 16, v99
    v_and_b32 v39, s47, v99
    v_lshlrev_b32 v32, 16, v100
    v_and_b32 v40, s47, v100
    v_lshlrev_b32 v33, 16, v101
    v_and_b32 v41, s47, v101
    v_lshlrev_b32 v34, 16, v102
    v_and_b32 v42, s47, v102
    v_lshlrev_b32 v35, 16, v103
    v_and_b32 v43, s47, v103
    v_pk_mul_f32 v[84:85], v[60:61], v[28:29]
    v_pk_mul_f32 v[88:89], v[64:65], v[28:29] neg_lo:[1,0] neg_hi:[1,0]
    v_pk_mul_f32 v[86:87], v[62:63], v[30:31]
    v_pk_mul_f32 v[90:91], v[66:67], v[30:31] neg_lo:[1,0] neg_hi:[1,0]
    v_pk_fma_f32 v[84:85], v[64:65], v[36:37], v[84:85] neg_lo:[1,0,0] neg_hi:[1,0,0]
    v_pk_fma_f32 v[88:89], v[60:61], v[36:37], v[88:89] neg_lo:[1,0,0] neg_hi:[1,0,0]
    v_pk_fma_f32 v[86:87], v[66:67], v[38:39], v[86:87] neg_lo:[1,0,0] neg_hi:[1,0,0]
    v_pk_fma_f32 v[90:91], v[62:63], v[38:39], v[90:91] neg_lo:[1,0,0] neg_hi:[1,0,0]
    v_cvt_pk_bf16_f32 v76, v84, v85
    v_cvt_pk_bf16_f32 v77, v86, v87
    v_cvt_pk_bf16_f32 v78, v88, v89
    v_cvt_pk_bf16_f32 v79, v90, v91
    v_pk_mul_f32 v[84:85], v[68:69], v[32:33]
    v_pk_mul_f32 v[88:89], v[72:73], v[32:33] neg_lo:[1,0] neg_hi:[1,0]
    v_pk_mul_f32 v[86:87], v[70:71], v[34:35]
    v_pk_mul_f32 v[90:91], v[74:75], v[34:35] neg_lo:[1,0] neg_hi:[1,0]
    v_pk_fma_f32 v[84:85], v[72:73], v[40:41], v[84:85] neg_lo:[1,0,0] neg_hi:[1,0,0]
    v_pk_fma_f32 v[88:89], v[68:69], v[40:41], v[88:89] neg_lo:[1,0,0] neg_hi:[1,0,0]
    v_pk_fma_f32 v[86:87], v[74:75], v[42:43], v[86:87] neg_lo:[1,0,0] neg_hi:[1,0,0]
    v_pk_fma_f32 v[90:91], v[70:71], v[42:43], v[90:91] neg_lo:[1,0,0] neg_hi:[1,0,0]
    v_cvt_pk_bf16_f32 v80, v84, v85
    v_cvt_pk_bf16_f32 v81, v86, v87
    v_cvt_pk_bf16_f32 v82, v88, v89
    v_cvt_pk_bf16_f32 v83, v90, v91
    v_mfma_f32_16x16x32_bf16 v[60:63], v[160:163], v[76:79], 0
    v_mfma_f32_16x16x32_bf16 v[64:67], v[176:179], v[76:79], 0
    v_mfma_f32_16x16x32_bf16 v[68:71], v[168:171], v[76:79], 0
    v_mfma_f32_16x16x32_bf16 v[72:75], v[184:187], v[76:79], 0
    v_mfma_f32_16x16x32_bf16 v[60:63], v[164:167], v[80:83], v[60:63]
    v_mfma_f32_16x16x32_bf16 v[64:67], v[180:183], v[80:83], v[64:67]
    v_mfma_f32_16x16x32_bf16 v[68:71], v[172:175], v[80:83], v[68:71]
    v_mfma_f32_16x16x32_bf16 v[72:75], v[188:191], v[80:83], v[72:75]
    s_nop 4
    v_pk_mul_f32 v[84:85], v[60:61], v[192:193]
    v_pk_mul_f32 v[88:89], v[64:65], v[192:193]
    v_pk_mul_f32 v[86:87], v[62:63], v[194:195]
    v_pk_mul_f32 v[90:91], v[66:67], v[194:195]
    v_pk_fma_f32 v[84:85], v[64:65], v[200:201], v[84:85]
    v_pk_fma_f32 v[88:89], v[60:61], v[200:201], v[88:89] neg_lo:[1,0,0] neg_hi:[1,0,0]
    v_pk_fma_f32 v[86:87], v[66:67], v[202:203], v[86:87]
    v_pk_fma_f32 v[90:91], v[62:63], v[202:203], v[90:91] neg_lo:[1,0,0] neg_hi:[1,0,0]
    v_cvt_pk_bf16_f32 v92, v84, v88
    ds_write_b32 v110, v92 offset:0
    v_cvt_pk_bf16_f32 v93, v85, v89
    ds_write_b32 v110, v93 offset:272
    v_cvt_pk_bf16_f32 v94, v86, v90
    ds_write_b32 v110, v94 offset:544
    v_cvt_pk_bf16_f32 v95, v87, v91
    ds_write_b32 v110, v95 offset:816
    v_pk_mul_f32 v[84:85], v[68:69], v[196:197]
    v_pk_mul_f32 v[88:89], v[72:73], v[196:197]
    v_pk_mul_f32 v[86:87], v[70:71], v[198:199]
    v_pk_mul_f32 v[90:91], v[74:75], v[198:199]
    v_pk_fma_f32 v[84:85], v[72:73], v[204:205], v[84:85]
    v_pk_fma_f32 v[88:89], v[68:69], v[204:205], v[88:89] neg_lo:[1,0,0] neg_hi:[1,0,0]
    v_pk_fma_f32 v[86:87], v[74:75], v[206:207], v[86:87]
    v_pk_fma_f32 v[90:91], v[70:71], v[206:207], v[90:91] neg_lo:[1,0,0] neg_hi:[1,0,0]
    v_cvt_pk_bf16_f32 v92, v84, v88
    ds_write_b32 v110, v92 offset:4352
    v_cvt_pk_bf16_f32 v93, v85, v89
    ds_write_b32 v110, v93 offset:4624
    v_cvt_pk_bf16_f32 v94, v86, v90
    ds_write_b32 v110, v94 offset:4896
    v_cvt_pk_bf16_f32 v95, v87, v91
    ds_write_b32 v110, v95 offset:5168
    s_waitcnt lgkmcnt(0)
    s_barrier
    ds_read_b128 v[28:31], v111 offset:0
    ds_read_b128 v[44:47], v111 offset:4352
    ds_read_b128 v[32:35], v111 offset:64
    ds_read_b128 v[48:51], v111 offset:4416
    ds_read_b128 v[36:39], v111 offset:128
    ds_read_b128 v[52:55], v111 offset:4480
    ds_read_b128 v[40:43], v111 offset:192
    ds_read_b128 v[56:59], v111 offset:4544
    s_waitcnt lgkmcnt(7)
    v_mfma_f32_16x16x32_bf16 v[60:63], v[28:31], v[128:131], 0
    v_mfma_f32_16x16x32_bf16 v[64:67], v[28:31], v[144:147], 0
    s_waitcnt lgkmcnt(6)
    v_mfma_f32_16x16x32_bf16 v[68:71], v[44:47], v[128:131], 0
    v_mfma_f32_16x16x32_bf16 v[72:75], v[44:47], v[144:147], 0
    s_waitcnt lgkmcnt(5)
    v_mfma_f32_16x16x32_bf16 v[60:63], v[32:35], v[132:135], v[60:63]
    v_mfma_f32_16x16x32_bf16 v[64:67], v[32:35], v[148:151], v[64:67]
    s_waitcnt lgkmcnt(4)
    v_mfma_f32_16x16x32_bf16 v[68:71], v[48:51], v[132:135], v[68:71]
    v_mfma_f32_16x16x32_bf16 v[72:75], v[48:51], v[148:151], v[72:75]
    s_waitcnt lgkmcnt(3)
    v_mfma_f32_16x16x32_bf16 v[60:63], v[36:39], v[136:139], v[60:63]
    v_mfma_f32_16x16x32_bf16 v[64:67], v[36:39], v[152:155], v[64:67]
    s_waitcnt lgkmcnt(2)
    v_mfma_f32_16x16x32_bf16 v[68:71], v[52:55], v[136:139], v[68:71]
    v_mfma_f32_16x16x32_bf16 v[72:75], v[52:55], v[152:155], v[72:75]
    s_waitcnt lgkmcnt(1)
    v_mfma_f32_16x16x32_bf16 v[60:63], v[40:43], v[140:143], v[60:63]
    v_mfma_f32_16x16x32_bf16 v[64:67], v[40:43], v[156:159], v[64:67]
    s_waitcnt lgkmcnt(0)
    v_mfma_f32_16x16x32_bf16 v[68:71], v[56:59], v[140:143], v[68:71]
    v_mfma_f32_16x16x32_bf16 v[72:75], v[56:59], v[156:159], v[72:75]
    s_nop 3
    v_cvt_pk_bf16_f32 v84, v60, v61
    v_cvt_pk_bf16_f32 v85, v62, v63
    v_cvt_pk_bf16_f32 v86, v64, v65
    v_cvt_pk_bf16_f32 v87, v66, v67
    buffer_store_dwordx4 v[84:87], v112, s[28:31], s48 offen sc1
    v_cvt_pk_bf16_f32 v88, v68, v69
    v_cvt_pk_bf16_f32 v89, v70, v71
    v_cvt_pk_bf16_f32 v90, v72, v73
    v_cvt_pk_bf16_f32 v91, v74, v75
    s_add_u32 s48, s48, 4096
    buffer_store_dwordx4 v[88:91], v112, s[28:31], s48 offen sc1
    s_branch f_p2_done
f_p2_idle:
    s_waitcnt vmcnt(0)
    s_barrier
    s_add_u32 m0, s55, 0
    s_nop 0
    buffer_load_dwordx4 v109, s[4:7], s49 offen lds
    s_mov_b64 exec, 0xff
    buffer_load_dwordx4 v109, s[4:7], s49 offen offset:1024 lds
    s_mov_b64 exec, -1
    s_cmp_lt_u32 s2, 216
    s_cbranch_scc0 f_pla
    s_mov_b32 m0, s24
    s_nop 0
    buffer_load_dwordx4 v9, s[32:35], s60 offen offset:0 lds
    s_add_u32 s25, s60, 35840
    buffer_load_dwordx4 v9, s[32:35], s25 offen offset:1024 lds
    s_add_u32 s26, s60, 71680
    buffer_load_dwordx4 v10, s[32:35], s26 offen offset:2048 lds
    s_add_u32 s27, s60, 107520
    buffer_load_dwordx4 v10, s[32:35], s27 offen offset:3072 lds
    s_add_u32 s60, s60, 589824
    s_add_u32 s24, s24, 16384
    s_mov_b32 m0, s24
    s_nop 0
    buffer_load_dwordx4 v9, s[32:35], s60 offen offset:0 lds
    s_add_u32 s25, s60, 35840
    buffer_load_dwordx4 v9, s[32:35], s25 offen offset:1024 lds
    s_add_u32 s26, s60, 71680
    buffer_load_dwordx4 v10, s[32:35], s26 offen offset:2048 lds
    s_add_u32 s27, s60, 107520
    buffer_load_dwordx4 v10, s[32:35], s27 offen offset:3072 lds
    s_add_u32 s60, s60, 589824
    s_add_u32 s24, s24, 16384
f_pla:
    s_barrier
f_p2_done:
    s_mov_b32 s44, 0x2a000
    s_mov_b32 s45, 0x2c400
    s_mov_b32 s46, 0x2e800
    buffer_load_dwordx4 v[28:31], v126, s[28:31], s44 offen
    buffer_load_dwordx4 v[32:35], v126, s[28:31], s45 offen
    buffer_load_dwordx4 v[36:39], v126, s[28:31], s46 offen
    s_bfe_u32 s50, s38, 0x10001
    s_lshl_b32 s50, s50, 6
    s_lshr_b32 s51, s38, 2
    s_add_u32 s50, s50, s51
    s_lshl_b32 s50, s50, 1
    s_and_b32 s51, s38, 1
    s_add_u32 s50, s50, s51
    s_lshl_b32 s50, s50, 5
    s_add_u32 s48, s50, 7340032
    v_subrev_u32 v2, 288, v0
    v_cmp_gt_u32 vcc, 144, v2
    s_nop 1
    v_cndmask_b32 v3, 0, 1.0, vcc
    v_lshlrev_b32 v2, 4, v0
    s_mov_b32 s47, 0xffff0000
    s_cmp_eq_u32 s42, -1
    s_cbranch_scc1 f_c3late
    v_cvt_f32_u32 v72, v7
    v_cvt_f32_u32 v73, v6
    v_mul_f32 v73, v73, v72
    v_mul_f32 v73, 0x3d800000, v73
    v_fmamk_f32 v60, v72, 0x00000000, v73
    v_fmamk_f32 v61, v72, 0x3c800000, v73
    v_fmamk_f32 v62, v72, 0x3d000000, v73
    v_fmamk_f32 v63, v72, 0x3d400000, v73
    v_cos_f32 v64, v60
    v_sin_f32 v68, v60
    v_cos_f32 v65, v61
    v_sin_f32 v69, v61
    v_cos_f32 v66, v62
    v_sin_f32 v70, v62
    v_cos_f32 v67, v63
    v_sin_f32 v71, v63
    v_cvt_pk_bf16_f32 v216, v64, v65
    v_cvt_pk_bf16_f32 v217, v66, v67
    v_cvt_pk_bf16_f32 v234, -v64, -v65
    v_cvt_pk_bf16_f32 v235, -v66, -v67
    v_cvt_pk_bf16_f32 v218, v68, v69
    v_cvt_pk_bf16_f32 v219, v70, v71
    v_cvt_pk_bf16_f32 v232, v68, v69
    v_cvt_pk_bf16_f32 v233, v70, v71
    v_fmamk_f32 v60, v72, 0x3e800000, v73
    v_fmamk_f32 v61, v72, 0x3e880000, v73
    v_fmamk_f32 v62, v72, 0x3e900000, v73
    v_fmamk_f32 v63, v72, 0x3e980000, v73
    v_cos_f32 v64, v60
    v_sin_f32 v68, v60
    v_cos_f32 v65, v61
    v_sin_f32 v69, v61
    v_cos_f32 v66, v62
    v_sin_f32 v70, v62
    v_cos_f32 v67, v63
    v_sin_f32 v71, v63
    v_cvt_pk_bf16_f32 v220, v64, v65
    v_cvt_pk_bf16_f32 v221, v66, v67
    v_cvt_pk_bf16_f32 v238, -v64, -v65
    v_cvt_pk_bf16_f32 v239, -v66, -v67
    v_cvt_pk_bf16_f32 v222, v68, v69
    v_cvt_pk_bf16_f32 v223, v70, v71
    v_cvt_pk_bf16_f32 v236, v68, v69
    v_cvt_pk_bf16_f32 v237, v70, v71
    v_fmamk_f32 v60, v72, 0x3f000000, v73
    v_fmamk_f32 v61, v72, 0x3f040000, v73
    v_fmamk_f32 v62, v72, 0x3f080000, v73
    v_fmamk_f32 v63, v72, 0x3f0c0000, v73
    v_cos_f32 v64, v60
    v_sin_f32 v68, v60
    v_cos_f32 v65, v61
    v_sin_f32 v69, v61
    v_cos_f32 v66, v62
    v_sin_f32 v70, v62
    v_cos_f32 v67, v63
    v_sin_f32 v71, v63
    v_cvt_pk_bf16_f32 v224, v64, v65
    v_cvt_pk_bf16_f32 v225, v66, v67
    v_cvt_pk_bf16_f32 v242, v64, v65
    v_cvt_pk_bf16_f32 v243, v66, v67
    v_cvt_pk_bf16_f32 v226, -v68, -v69
    v_cvt_pk_bf16_f32 v227, -v70, -v71
    v_cvt_pk_bf16_f32 v240, v68, v69
    v_cvt_pk_bf16_f32 v241, v70, v71
    v_fmamk_f32 v60, v72, 0x3f400000, v73
    v_fmamk_f32 v61, v72, 0x3f440000, v73
    v_fmamk_f32 v62, v72, 0x3f480000, v73
    v_fmamk_f32 v63, v72, 0x3f4c0000, v73
    v_cos_f32 v64, v60
    v_sin_f32 v68, v60
    v_cos_f32 v65, v61
    v_sin_f32 v69, v61
    v_cos_f32 v66, v62
    v_sin_f32 v70, v62
    v_cos_f32 v67, v63
    v_sin_f32 v71, v63
    v_cvt_pk_bf16_f32 v228, v64, v65
    v_cvt_pk_bf16_f32 v229, v66, v67
    v_cvt_pk_bf16_f32 v246, v64, v65
    v_cvt_pk_bf16_f32 v247, v66, v67
    v_cvt_pk_bf16_f32 v230, -v68, -v69
    v_cvt_pk_bf16_f32 v231, -v70, -v71
    v_cvt_pk_bf16_f32 v244, v68, v69
    v_cvt_pk_bf16_f32 v245, v70, v71
    v_mul_f32 v61, 0x3ae38e39, v72
    v_mul_f32 v62, 0x3b638e39, v72
    v_mul_f32 v63, 0x3baaaaab, v72
    v_mul_f32 v64, 0x3be38e39, v72
    v_cos_f32 v248, v61
    v_sin_f32 v252, v61
    v_cos_f32 v249, v62
    v_sin_f32 v253, v62
    v_cos_f32 v250, v63
    v_sin_f32 v254, v63
    v_cos_f32 v251, v64
    v_sin_f32 v255, v64
    v_mul_f32 v248, 0x35e38e39, v248
    v_mul_f32 v249, 0x35e38e39, v249
    v_mul_f32 v250, 0x35e38e39, v250
    v_mul_f32 v251, 0x35e38e39, v251
    v_mul_f32 v252, 0x35e38e39, v252
    v_mul_f32 v253, 0x35e38e39, v253
    v_mul_f32 v254, 0x35e38e39, v254
    v_mul_f32 v255, 0x35e38e39, v255
f_c3late:
    s_waitcnt vmcnt(0)
    v_pk_add_f32 v[28:29], v[28:29], v[32:33]
    v_pk_add_f32 v[30:31], v[30:31], v[34:35]
    v_pk_add_f32 v[28:29], v[28:29], v[36:37]
    v_pk_add_f32 v[30:31], v[30:31], v[38:39]
    v_cvt_pk_bf16_f32 v48, v28, v29
    v_lshlrev_b32 v28, 16, v48
    v_and_b32 v29, s47, v48
    v_cvt_pk_bf16_f32 v49, v30, v31
    v_lshlrev_b32 v30, 16, v49
    v_and_b32 v31, s47, v49
    v_add_f32 v28, v28, v3
    v_add_f32 v29, v29, v3
    v_add_f32 v30, v30, v3
    v_add_f32 v31, v31, v3
    v_cvt_pk_bf16_f32 v48, v28, v29
    v_lshlrev_b32 v28, 16, v48
    v_and_b32 v29, s47, v48
    v_cvt_pk_bf16_f32 v49, v30, v31
    v_lshlrev_b32 v30, 16, v49
    v_and_b32 v31, s47, v49
    ds_write_b128 v2, v[28:31] offset:9728
    s_cmp_ge_u32 s2, 254
    s_cselect_b32 s50, s3, 0
    s_cmp_ge_u32 s50, 6
    s_cbranch_scc0 f_nogb
    v_subrev_u32 v2, 432, v0
    v_cmp_gt_u32 vcc, 72, v2
    v_mov_b32 v3, 0x7f000000
    s_nop 0
    v_cndmask_b32 v2, v3, v126, vcc
    s_movk_i32 s50, 4608
    buffer_store_dwordx4 v[28:31], v2, s[28:31], s50 offen sc1
    s_waitcnt vmcnt(0)
f_nogb:
    s_cmp_lt_u32 s2, 33
    s_cbranch_scc1 f_nozsl
    s_sleep 32
f_nozsl:
    s_cmp_lt_u32 s3, 2
    s_cbranch_scc1 f_z2
    s_mov_b32 s50, 0
f_za:
    buffer_load_dwordx4 v[40:43], v113, s[28:31], s48 offen sc1
    s_add_u32 s50, s50, 1
    s_waitcnt vmcnt(0)
    v_max3_u32 v48, v40, v41, v42
    v_max_u32 v48, v48, v43
    v_cmp_eq_u32 vcc, -1, v48
    s_nop 0
    s_and_b64 exec, vcc, vcc
    s_cbranch_scc0 f_za_ok
    s_sleep 4
    s_cmp_lt_u32 s50, 30000
    s_cbranch_scc1 f_za
f_za_ok:
    s_mov_b64 exec, -1
    s_branch f_zj
f_z2:
    s_mov_b32 s50, 0
f_zb:
    buffer_load_dwordx4 v[40:43], v113, s[28:31], s48 offen sc1
    buffer_load_dwordx4 v[44:47], v114, s[28:31], s48 offen sc1
    s_add_u32 s50, s50, 1
    s_waitcnt vmcnt(0)
    v_max3_u32 v48, v40, v41, v42
    v_max3_u32 v48, v48, v43, v44
    v_max3_u32 v48, v48, v45, v46
    v_max_u32 v48, v48, v47
    v_cmp_eq_u32 vcc, -1, v48
    s_nop 0
    s_and_b64 exec, vcc, vcc
    s_cbranch_scc0 f_zb_ok
    s_sleep 4
    s_cmp_lt_u32 s50, 30000
    s_cbranch_scc1 f_zb
f_zb_ok:
    s_mov_b64 exec, -1
    ds_write_b64 v115, v[44:45] offset:2304
    ds_write_b64 v115, v[46:47] offset:5184
f_zj:
    ds_write_b64 v115, v[40:41]
    ds_write_b64 v115, v[42:43] offset:2880
    s_cmp_lt_u32 s3, 4
    s_cbranch_scc1 f_plb_done0
    s_cmp_lt_u32 s2, 33
    s_cbranch_scc0 f_plb0
    s_cmp_lt_u32 s2, 216
    s_cbranch_scc0 f_plb00
    s_mov_b32 m0, s24
    s_nop 0
    buffer_load_dwordx4 v9, s[32:35], s60 offen offset:0 lds
    s_add_u32 s25, s60, 35840
    buffer_load_dwordx4 v9, s[32:35], s25 offen offset:1024 lds
    s_add_u32 s26, s60, 71680
    buffer_load_dwordx4 v10, s[32:35], s26 offen offset:2048 lds
    s_add_u32 s27, s60, 107520
    buffer_load_dwordx4 v10, s[32:35], s27 offen offset:3072 lds
    s_add_u32 s60, s60, 589824
    s_add_u32 s24, s24, 16384
    s_mov_b32 m0, s24
    s_nop 0
    buffer_load_dwordx4 v9, s[32:35], s60 offen offset:0 lds
    s_add_u32 s25, s60, 35840
    buffer_load_dwordx4 v9, s[32:35], s25 offen offset:1024 lds
    s_add_u32 s26, s60, 71680
    buffer_load_dwordx4 v10, s[32:35], s26 offen offset:2048 lds
    s_add_u32 s27, s60, 107520
    buffer_load_dwordx4 v10, s[32:35], s27 offen offset:3072 lds
    s_add_u32 s60, s60, 589824
    s_add_u32 s24, s24, 16384
f_plb00:
f_plb0:
    s_cmp_lt_u32 s2, 216
    s_cbranch_scc0 f_plb10
    s_mov_b32 m0, s24
    s_nop 0
    buffer_load_dwordx4 v9, s[32:35], s60 offen offset:0 lds
    s_add_u32 s25, s60, 35840
    buffer_load_dwordx4 v9, s[32:35], s25 offen offset:1024 lds
    s_add_u32 s26, s60, 71680
    buffer_load_dwordx4 v10, s[32:35], s26 offen offset:2048 lds
    s_add_u32 s27, s60, 107520
    buffer_load_dwordx4 v10, s[32:35], s27 offen offset:3072 lds
    s_add_u32 s60, s60, 589824
    s_add_u32 s24, s24, 16384
    s_mov_b32 m0, s24
    s_nop 0
    buffer_load_dwordx4 v9, s[32:35], s60 offen offset:0 lds
    s_add_u32 s25, s60, 35840
    buffer_load_dwordx4 v9, s[32:35], s25 offen offset:1024 lds
    s_add_u32 s26, s60, 71680
    buffer_load_dwordx4 v10, s[32:35], s26 offen offset:2048 lds
    s_add_u32 s27, s60, 107520
    buffer_load_dwordx4 v10, s[32:35], s27 offen offset:3072 lds
    s_add_u32 s60, s60, 589824
    s_add_u32 s24, s24, 16384
f_plb10:
f_plb_done0:
    s_waitcnt lgkmcnt(0)
    s_barrier
    s_cmp_lt_u32 s3, 4
    s_cbranch_scc1 f_plb_done1
    s_cmp_lt_u32 s3, 4
    s_cbranch_scc1 f_not3
    s_sub_u32 s50, s37, 0
    s_cbranch_scc1 f_not3
    s_lshl_b32 s50, s50, 2
    s_add_u32 s50, s50, s39
    s_add_u32 s58, s50, 64
    s_mul_i32 s58, s58, 55296
    s_add_u32 s58, s58, s57
    buffer_load_dword v8, v17, s[32:35], s58 offen
    s_add_u32 s58, s58, 7077888
    s_cmp_lt_u32 s50, 69
    s_cbranch_scc0 ftch_9
    buffer_load_dword v8, v17, s[32:35], s58 offen
ftch_9:
f_not3:
f_plb_done1:
    v_cmp_eq_u32 s[44:45], 1, v6
    v_cmp_eq_u32 s[50:51], 2, v6
    v_cmp_eq_u32 s[58:59], 3, v6
    ds_read_b64_tr_b16 v[28:29], v116 offset:0
    ds_read_b64_tr_b16 v[30:31], v116 offset:2880
    ds_read_b64_tr_b16 v[32:33], v116 offset:128
    ds_read_b64_tr_b16 v[34:35], v116 offset:3008
    ds_read_b64_tr_b16 v[36:37], v116 offset:256
    ds_read_b64_tr_b16 v[38:39], v116 offset:3136
    ds_read_b64_tr_b16 v[40:41], v116 offset:384
    ds_read_b64_tr_b16 v[42:43], v116 offset:3264
    ds_read_b64_tr_b16 v[44:45], v117 offset:0
    ds_read_b64_tr_b16 v[46:47], v117 offset:2880
    ds_read_b64_tr_b16 v[48:49], v117 offset:128
    ds_read_b64_tr_b16 v[50:51], v117 offset:3008
    ds_read_b64_tr_b16 v[52:53], v117 offset:256
    ds_read_b64_tr_b16 v[54:55], v117 offset:3136
    ds_read_b64_tr_b16 v[56:57], v117 offset:384
    ds_read_b64_tr_b16 v[58:59], v117 offset:3264
    s_waitcnt lgkmcnt(14)
    v_mfma_f32_16x16x32_bf16 v[60:63], v[28:31], v[216:219], 0
    v_mfma_f32_16x16x32_bf16 v[64:67], v[28:31], v[232:235], 0
    s_waitcnt lgkmcnt(12)
    v_mfma_f32_16x16x32_bf16 v[60:63], v[32:35], v[220:223], v[60:63]
    v_mfma_f32_16x16x32_bf16 v[64:67], v[32:35], v[236:239], v[64:67]
    s_waitcnt lgkmcnt(10)
    v_mfma_f32_16x16x32_bf16 v[60:63], v[36:39], v[224:227], v[60:63]
    v_mfma_f32_16x16x32_bf16 v[64:67], v[36:39], v[240:243], v[64:67]
    s_waitcnt lgkmcnt(8)
    v_mfma_f32_16x16x32_bf16 v[60:63], v[40:43], v[228:231], v[60:63]
    v_mfma_f32_16x16x32_bf16 v[64:67], v[40:43], v[244:247], v[64:67]
    s_waitcnt lgkmcnt(6)
    v_mfma_f32_16x16x32_bf16 v[68:71], v[44:47], v[216:219], 0
    s_waitcnt lgkmcnt(4)
    v_mfma_f32_16x16x32_bf16 v[68:71], v[48:51], v[220:223], v[68:71]
    s_waitcnt lgkmcnt(2)
    v_mfma_f32_16x16x32_bf16 v[68:71], v[52:55], v[224:227], v[68:71]
    s_waitcnt lgkmcnt(0)
    v_mfma_f32_16x16x32_bf16 v[68:71], v[56:59], v[228:231], v[68:71]
    ds_read_u16_d16_hi v18, v127 offset:0
    ds_read_u16_d16_hi v19, v127 offset:128
    ds_read_u16_d16_hi v20, v127 offset:256
    ds_read_u16_d16_hi v21, v127 offset:384
    ds_read_u16_d16_hi v22, v127 offset:512
    ds_read_u16_d16_hi v23, v127 offset:640
    ds_read_u16_d16_hi v24, v127 offset:768
    ds_read_u16_d16_hi v25, v127 offset:896
    ds_read_u16_d16_hi v26, v127 offset:1024
    ds_read2st64_b32 v[72:73], v124 offset0:38 offset1:39
    ds_read2st64_b32 v[74:75], v124 offset0:40 offset1:41
    ds_read2st64_b32 v[76:77], v124 offset0:42 offset1:43
    ds_read2st64_b32 v[78:79], v124 offset0:44 offset1:45
    ds_read2st64_b32 v[80:81], v124 offset0:46 offset1:47
    ds_read2st64_b32 v[82:83], v124 offset0:48 offset1:49
    ds_read2st64_b32 v[84:85], v124 offset0:50 offset1:51
    ds_read2st64_b32 v[86:87], v124 offset0:52 offset1:53
    ds_read2st64_b32 v[88:89], v124 offset0:54 offset1:55
    ds_read2st64_b32 v[90:91], v124 offset0:56 offset1:57
    ds_read2st64_b32 v[92:93], v124 offset0:58 offset1:59
    ds_read2st64_b32 v[94:95], v124 offset0:60 offset1:61
    ds_read2st64_b32 v[96:97], v124 offset0:62 offset1:63
    ds_read_b32 v98, v124 offset:16384
    v_permlane32_swap_b32 v60, v62
    v_permlane32_swap_b32 v61, v63
    v_permlane32_swap_b32 v64, v66
    v_permlane32_swap_b32 v65, v67
    v_permlane16_swap_b32 v60, v61
    v_permlane16_swap_b32 v62, v63
    v_permlane16_swap_b32 v64, v65
    v_permlane16_swap_b32 v66, v67
    v_pk_mul_f32 v[28:29], v[60:61], v[248:249]
    v_pk_mul_f32 v[32:33], v[64:65], v[248:249]
    v_pk_mul_f32 v[30:31], v[62:63], v[250:251]
    v_pk_mul_f32 v[34:35], v[66:67], v[250:251]
    v_pk_fma_f32 v[28:29], v[64:65], v[252:253], v[28:29] neg_lo:[1,0,0] neg_hi:[1,0,0]
    v_pk_fma_f32 v[32:33], v[60:61], v[252:253], v[32:33]
    v_pk_fma_f32 v[30:31], v[66:67], v[254:255], v[30:31] neg_lo:[1,0,0] neg_hi:[1,0,0]
    v_pk_fma_f32 v[34:35], v[62:63], v[254:255], v[34:35]
    v_cndmask_b32 v36, v68, v69, s[44:45]
    v_cndmask_b32 v36, v36, v70, s[50:51]
    v_cndmask_b32 v36, v36, v71, s[58:59]
    v_mul_f32 v36, 0x35638e39, v36
    v_add_f32 v37, v36, v28
    v_add_f32 v38, v29, v30
    v_add_f32 v37, v37, v31
    v_add_f32 v37, v37, v38
    v_fmamk_f32 v40, v28, 0x3f441b7d, v36
    v_fmamk_f32 v41, v28, 0x3e31d0d4, v36
    v_fmamk_f32 v42, v28, 0xbf000000, v36
    v_fmamk_f32 v43, v28, 0xbf708fb2, v36
    v_fmamk_f32 v40, v29, 0x3e31d0d4, v40
    v_fmamk_f32 v41, v29, 0xbf708fb2, v41
    v_fmamk_f32 v42, v29, 0xbf000000, v42
    v_fmamk_f32 v43, v29, 0x3f441b7d, v43
    v_fmamk_f32 v40, v30, 0xbf000000, v40
    v_fmamk_f32 v41, v30, 0xbf000000, v41
    v_fmamk_f32 v42, v30, 0x3f800000, v42
    v_fmamk_f32 v43, v30, 0xbf000000, v43
    v_fmamk_f32 v40, v31, 0xbf708fb2, v40
    v_fmamk_f32 v41, v31, 0x3f441b7d, v41
    v_fmamk_f32 v42, v31, 0xbf000000, v42
    v_fmamk_f32 v43, v31, 0x3e31d0d4, v43
    v_mul_f32 v44, 0x3f248dbb, v32
    v_mul_f32 v45, 0x3f7c1c5c, v32
    v_mul_f32 v46, 0x3f5db3d7, v32
    v_mul_f32 v47, 0x3eaf1d44, v32
    v_fmamk_f32 v44, v33, 0x3f7c1c5c, v44
    v_fmamk_f32 v45, v33, 0x3eaf1d44, v45
    v_fmamk_f32 v46, v33, 0xbf5db3d7, v46
    v_fmamk_f32 v47, v33, 0xbf248dbb, v47
    v_fmamk_f32 v44, v34, 0x3f5db3d7, v44
    v_fmamk_f32 v45, v34, 0xbf5db3d7, v45
    v_fmamk_f32 v47, v34, 0x3f5db3d7, v47
    v_fmamk_f32 v44, v35, 0x3eaf1d44, v44
    v_fmamk_f32 v45, v35, 0xbf248dbb, v45
    v_fmamk_f32 v46, v35, 0x3f5db3d7, v46
    v_fmamk_f32 v47, v35, 0xbf7c1c5c, v47
    s_waitcnt lgkmcnt(9)
    v_fmac_f32 v18, v37, v72
    v_sub_f32 v50, v40, v44
    v_add_f32 v51, v40, v44
    v_fmac_f32 v19, v50, v73
    v_fmac_f32 v26, v51, v80
    v_sub_f32 v48, v41, v45
    v_add_f32 v49, v41, v45
    v_fmac_f32 v20, v48, v74
    v_fmac_f32 v25, v49, v79
    v_sub_f32 v50, v42, v46
    v_add_f32 v51, v42, v46
    v_fmac_f32 v21, v50, v75
    v_fmac_f32 v24, v51, v78
    v_sub_f32 v48, v43, v47
    v_add_f32 v49, v43, v47
    v_fmac_f32 v22, v48, v76
    v_fmac_f32 v23, v49, v77
    v_cvt_pk_bf16_f32 v60, v18, v19
    v_cvt_pk_bf16_f32 v61, v20, v21
    v_cvt_pk_bf16_f32 v62, v22, v23
    v_cvt_pk_bf16_f32 v63, v24, v25
    v_cvt_pk_bf16_f32 v64, v26, v26
    v_lshlrev_b32 v18, 16, v60
    v_and_b32 v19, s47, v60
    v_lshlrev_b32 v20, 16, v61
    v_and_b32 v21, s47, v61
    v_lshlrev_b32 v22, 16, v62
    v_and_b32 v23, s47, v62
    v_lshlrev_b32 v24, 16, v63
    v_and_b32 v25, s47, v63
    v_lshlrev_b32 v26, 16, v64
    ds_write_b16 v127, v60 offset:0
    ds_write_b16_d16_hi v127, v60 offset:128
    ds_write_b16 v127, v61 offset:256
    ds_write_b16_d16_hi v127, v61 offset:384
    ds_write_b16 v127, v62 offset:512
    ds_write_b16_d16_hi v127, v62 offset:640
    ds_write_b16 v127, v63 offset:768
    ds_write_b16_d16_hi v127, v63 offset:896
    ds_write_b16 v127, v64 offset:1024
    s_add_u32 s52, s49, 10485760
    s_add_u32 s50, s55, 0
    v_add_u32 v2, s50, v109
    v_cmp_eq_u32 s[44:45], 0, v5
    v_add_f32 v56, v18, v19
    v_mul_f32 v57, v18, v18
    v_fmac_f32 v57, v19, v19
    v_add_f32 v56, v56, v20
    v_fmac_f32 v57, v20, v20
    v_add_f32 v56, v56, v21
    v_fmac_f32 v57, v21, v21
    v_add_f32 v56, v56, v22
    v_fmac_f32 v57, v22, v22
    v_add_f32 v56, v56, v23
    v_fmac_f32 v57, v23, v23
    v_add_f32 v56, v56, v24
    v_fmac_f32 v57, v24, v24
    v_add_f32 v56, v56, v25
    v_fmac_f32 v57, v25, v25
    v_add_f32 v56, v56, v26
    v_fmac_f32 v57, v26, v26
    s_nop 0
    v_add_f32_dpp v56, v56, v56 quad_perm:[1,0,3,2] row_mask:0xf bank_mask:0xf
    v_add_f32_dpp v57, v57, v57 quad_perm:[1,0,3,2] row_mask:0xf bank_mask:0xf
    s_nop 0
    v_add_f32_dpp v56, v56, v56 quad_perm:[2,3,0,1] row_mask:0xf bank_mask:0xf
    v_add_f32_dpp v57, v57, v57 quad_perm:[2,3,0,1] row_mask:0xf bank_mask:0xf
    s_nop 0
    v_add_f32_dpp v56, v56, v56 row_half_mirror row_mask:0xf bank_mask:0xf
    v_add_f32_dpp v57, v57, v57 row_half_mirror row_mask:0xf bank_mask:0xf
    s_nop 0
    v_add_f32_dpp v56, v56, v56 row_mirror row_mask:0xf bank_mask:0xf
    v_add_f32_dpp v57, v57, v57 row_mirror row_mask:0xf bank_mask:0xf
    s_mov_b64 exec, s[44:45]
    ds_write_b64 v120, v[56:57] offset:0
    s_mov_b64 exec, -1
    s_waitcnt lgkmcnt(0)
    s_barrier
    ds_read_b128 v[48:51], v119 offset:0
    ds_read_b128 v[52:55], v119 offset:16
    v_mov_b32 v58, 0x3727c5ac
    s_waitcnt lgkmcnt(0)
    s_cmp_lt_u32 s3, 4
    s_cbranch_scc0 f_nox1r
    ds_read_b128 v[28:31], v2 offset:0
    ds_read_b128 v[32:35], v2 offset:1024
    ds_read_b128 v[36:39], v2 offset:4736
    ds_read_b128 v[40:43], v2 offset:5760
f_nox1r:
    v_pk_add_f32 v[48:49], v[48:49], v[50:51]
    v_pk_add_f32 v[52:53], v[52:53], v[54:55]
    v_pk_add_f32 v[48:49], v[48:49], v[52:53]
    v_mul_f32 v56, 0x3ae38e39, v48
    v_fmamk_f32 v57, v49, 0x3ae38e39, v58
    v_fma_f32 v57, -v56, v56, v57
    v_rsq_f32 v57, v57
    s_nop 0
    v_mul_f32 v56, -v56, v57
    v_fma_f32 v18, v18, v57, v56
    v_fma_f32 v19, v19, v57, v56
    v_fma_f32 v20, v20, v57, v56
    v_fma_f32 v21, v21, v57, v56
    v_fma_f32 v22, v22, v57, v56
    v_fma_f32 v23, v23, v57, v56
    v_fma_f32 v24, v24, v57, v56
    v_fma_f32 v25, v25, v57, v56
    v_fma_f32 v26, v26, v57, v56
    s_cmp_lt_u32 s3, 4
    s_cbranch_scc0 f_nox1s
    s_add_u32 s50, s52, 4608
    s_waitcnt lgkmcnt(0)
    buffer_store_dwordx4 v[28:31], v109, s[28:31], s52 offen sc1
    buffer_store_dwordx4 v[36:39], v109, s[28:31], s50 offen sc1
    s_mov_b64 exec, 0xff
    buffer_store_dwordx4 v[32:35], v109, s[28:31], s52 offen offset:1024 sc1
    buffer_store_dwordx4 v[40:43], v109, s[28:31], s50 offen offset:1024 sc1
    s_mov_b64 exec, -1
f_nox1s:
    v_fma_f32 v18, v18, v90, v81
    v_fma_f32 v19, v19, v91, v82
    v_fma_f32 v20, v20, v92, v83
    v_fma_f32 v21, v21, v93, v84
    v_fma_f32 v22, v22, v94, v85
    v_fma_f32 v23, v23, v95, v86
    v_fma_f32 v24, v24, v96, v87
    v_fma_f32 v25, v25, v97, v88
    v_fma_f32 v26, v26, v98, v89
    v_add_f32 v56, v18, v19
    v_mul_f32 v57, v18, v18
    v_fmac_f32 v57, v19, v19
    v_add_f32 v56, v56, v20
    v_fmac_f32 v57, v20, v20
    v_add_f32 v56, v56, v21
    v_fmac_f32 v57, v21, v21
    v_add_f32 v56, v56, v22
    v_fmac_f32 v57, v22, v22
    v_add_f32 v56, v56, v23
    v_fmac_f32 v57, v23, v23
    v_add_f32 v56, v56, v24
    v_fmac_f32 v57, v24, v24
    v_add_f32 v56, v56, v25
    v_fmac_f32 v57, v25, v25
    v_add_f32 v56, v56, v26
    v_fmac_f32 v57, v26, v26
    s_nop 0
    v_add_f32_dpp v56, v56, v56 quad_perm:[1,0,3,2] row_mask:0xf bank_mask:0xf
    v_add_f32_dpp v57, v57, v57 quad_perm:[1,0,3,2] row_mask:0xf bank_mask:0xf
    s_nop 0
    v_add_f32_dpp v56, v56, v56 quad_perm:[2,3,0,1] row_mask:0xf bank_mask:0xf
    v_add_f32_dpp v57, v57, v57 quad_perm:[2,3,0,1] row_mask:0xf bank_mask:0xf
    s_nop 0
    v_add_f32_dpp v56, v56, v56 row_half_mirror row_mask:0xf bank_mask:0xf
    v_add_f32_dpp v57, v57, v57 row_half_mirror row_mask:0xf bank_mask:0xf
    s_nop 0
    v_add_f32_dpp v56, v56, v56 row_mirror row_mask:0xf bank_mask:0xf
    v_add_f32_dpp v57, v57, v57 row_mirror row_mask:0xf bank_mask:0xf
    s_mov_b64 exec, s[44:45]
    ds_write_b64 v120, v[56:57] offset:256
    s_mov_b64 exec, -1
    s_waitcnt lgkmcnt(0)
    s_barrier
    ds_read_b128 v[48:51], v119 offset:256
    ds_read_b128 v[52:55], v119 offset:272
    v_mov_b32 v58, 0x3727c5ac
    s_waitcnt lgkmcnt(0)
    v_pk_add_f32 v[48:49], v[48:49], v[50:51]
    v_pk_add_f32 v[52:53], v[52:53], v[54:55]
    v_pk_add_f32 v[48:49], v[48:49], v[52:53]
    v_mul_f32 v56, 0x3ae38e39, v48
    v_fmamk_f32 v57, v49, 0x3ae38e39, v58
    v_fma_f32 v57, -v56, v56, v57
    v_rsq_f32 v57, v57
    s_nop 0
    v_mul_f32 v56, -v56, v57
    v_fma_f32 v18, v18, v57, v56
    v_fma_f32 v19, v19, v57, v56
    v_fma_f32 v20, v20, v57, v56
    v_fma_f32 v21, v21, v57, v56
    v_fma_f32 v22, v22, v57, v56
    v_fma_f32 v23, v23, v57, v56
    v_fma_f32 v24, v24, v57, v56
    v_fma_f32 v25, v25, v57, v56
    v_fma_f32 v26, v26, v57, v56
    v_mov_b32 v27, 0
    v_permlane16_swap_b32 v18, v19
    v_permlane16_swap_b32 v20, v21
    v_permlane16_swap_b32 v22, v23
    v_permlane16_swap_b32 v24, v25
    v_permlane16_swap_b32 v26, v27
    v_cvt_pk_bf16_f32 v28, v18, v19
    v_cvt_pk_bf16_f32 v29, v20, v21
    v_cvt_pk_bf16_f32 v30, v22, v23
    v_cvt_pk_bf16_f32 v31, v24, v25
    v_cvt_pk_bf16_f32 v32, v26, v27
    v_mov_b32 v33, 0
    v_permlane32_swap_b32 v28, v29
    v_permlane32_swap_b32 v30, v31
    v_permlane32_swap_b32 v32, v33
    s_mul_i32 s50, s38, 1536
    ds_write_b64 v121, v[28:29]
    ds_write_b64 v121, v[30:31] offset:4096
    s_mov_b64 exec, 0xffff
    ds_write_b64 v121, v[32:33] offset:8192
    s_mov_b64 exec, -1
    s_add_u32 s50, s50, 13631488
    v_lshlrev_b32 v2, 4, v0
    v_add_u32 v3, 8192, v2
    v_add_u32 v4, 8192, v109
    s_waitcnt lgkmcnt(0)
    s_barrier
    s_cmp_lt_u32 s3, 4
    s_cbranch_scc1 f_plb_done3
    s_cmp_lt_u32 s2, 216
    s_cbranch_scc0 f_plb13
    s_mov_b32 m0, s24
    s_nop 0
    buffer_load_dwordx4 v9, s[32:35], s60 offen offset:0 lds
    s_add_u32 s25, s60, 35840
    buffer_load_dwordx4 v9, s[32:35], s25 offen offset:1024 lds
    s_add_u32 s26, s60, 71680
    buffer_load_dwordx4 v10, s[32:35], s26 offen offset:2048 lds
    s_add_u32 s27, s60, 107520
    buffer_load_dwordx4 v10, s[32:35], s27 offen offset:3072 lds
    s_add_u32 s60, s60, 589824
    s_add_u32 s24, s24, 16384
    s_mov_b32 m0, s24
    s_nop 0
    buffer_load_dwordx4 v9, s[32:35], s60 offen offset:0 lds
    s_add_u32 s25, s60, 35840
    buffer_load_dwordx4 v9, s[32:35], s25 offen offset:1024 lds
    s_add_u32 s26, s60, 71680
    buffer_load_dwordx4 v10, s[32:35], s26 offen offset:2048 lds
    s_add_u32 s27, s60, 107520
    buffer_load_dwordx4 v10, s[32:35], s27 offen offset:3072 lds
    s_add_u32 s60, s60, 589824
    s_add_u32 s24, s24, 16384
f_plb13:
f_plb_done3:
    s_cmp_lt_u32 s3, 4
    s_cbranch_scc0 f_h2none
    ds_read_b128 v[28:31], v2 offset:17920
    ds_read_b128 v[32:35], v3 offset:13824
    s_cmp_eq_u32 s3, 1
    s_cbranch_scc0 f_h2one
    ds_read_b128 v[36:39], v4 offset:17920
    s_waitcnt lgkmcnt(0)
    buffer_store_dwordx4 v[36:39], v123, s[28:31], s50 offen sc1
f_h2one:
    s_waitcnt lgkmcnt(1)
    buffer_store_dwordx4 v[28:31], v122, s[28:31], s50 offen sc1
    s_waitcnt lgkmcnt(0)
    buffer_store_dwordx4 v[32:35], v118, s[28:31], s50 offen sc1
    s_waitcnt vmcnt(0)
f_h2none:
    v_mov_b32 v3, 1
    s_lshl_b32 s50, s38, 10
    s_add_u32 s50, s50, 262400
    s_barrier
    s_cmp_eq_u32 s3, 0
    s_cbranch_scc0 t_noflag
    s_mov_b64 exec, 1
    buffer_store_dword v3, off, s[28:31], s50 sc1
    s_mov_b64 exec, -1
t_noflag:
    s_cmp_ge_u32 s2, 216
    s_cbranch_scc1 t_spare
    s_cmp_lt_u32 s3, 4
    s_cbranch_scc1 t_cons
    s_mul_i32 s4, s39, 3072
    s_add_u32 m0, s4, 12288
    s_nop 0
    buffer_load_dwordx4 v14, s[28:31], s61 offen offset:0 lds
    buffer_load_dwordx4 v14, s[28:31], s61 offen offset:1024 lds
    buffer_load_dwordx4 v14, s[28:31], s61 offen offset:2048 lds
    s_add_u32 m0, s4, 24576
    s_add_u32 s25, s61, 12288
    buffer_load_dwordx4 v14, s[28:31], s25 offen offset:0 lds
    buffer_load_dwordx4 v14, s[28:31], s25 offen offset:1024 lds
    buffer_load_dwordx4 v14, s[28:31], s25 offen offset:2048 lds
    s_add_u32 m0, s4, 36864
    s_add_u32 s25, s61, 24576
    buffer_load_dwordx4 v14, s[28:31], s25 offen offset:0 lds
    buffer_load_dwordx4 v14, s[28:31], s25 offen offset:1024 lds
    buffer_load_dwordx4 v14, s[28:31], s25 offen offset:2048 lds
    s_add_u32 m0, s4, 49152
    s_add_u32 s25, s61, 36864
    buffer_load_dwordx4 v14, s[28:31], s25 offen offset:0 lds
    buffer_load_dwordx4 v14, s[28:31], s25 offen offset:1024 lds
    buffer_load_dwordx4 v14, s[28:31], s25 offen offset:2048 lds
    v_lshrrev_b32 v2, 1, v1
    v_lshlrev_b32 v2, 13, v2
    v_and_b32 v3, 1, v1
    v_lshl_add_u32 v2, v3, 10, v2
    s_lshl_b32 s50, s39, 11
    s_add_u32 s50, s50, 262400
    s_mul_i32 s4, s39, 3072
    s_sub_u32 s24, s24, 98304
    v_add_u32 v18, s24, v14
    v_add_u32 v19, 65536, v18
    s_mov_b64 s[54:55], 0
    s_mov_b32 s56, 16
    v_add_u32 v16, s4, v14
    s_waitcnt vmcnt(9) lgkmcnt(0)
    s_mov_b32 s51, 0
val_10:
    ds_read_b128 v[24:27], v16 offset:12288
    ds_read_b128 v[28:31], v16 offset:13312
    ds_read_b128 v[32:35], v16 offset:14336
    s_waitcnt lgkmcnt(2)
    v_max3_u32 v24, v24, v25, v26
    v_max_u32 v24, v24, v27
    s_waitcnt lgkmcnt(1)
    v_max3_u32 v28, v28, v29, v30
    v_max3_u32 v28, v28, v31, v24
    s_waitcnt lgkmcnt(0)
    v_max3_u32 v32, v32, v33, v34
    v_max3_u32 v32, v32, v35, v28
    v_cmp_eq_u32 vcc, -1, v32
    s_nop 0
    s_and_b64 exec, vcc, vcc
    s_cbranch_scc0 val_10_ok
    s_cmp_lt_u32 s51, 30000
    s_cbranch_scc0 val_10_ok
    s_cmp_eq_u32 s51, 0
    s_cbranch_scc1 val_10_ns
    s_sleep 2
val_10_ns:
    s_add_u32 s51, s51, 1
    s_add_u32 m0, s4, 12288
    s_nop 0
    buffer_load_dwordx4 v14, s[28:31], s61 offen offset:0 sc1 lds
    buffer_load_dwordx4 v14, s[28:31], s61 offen offset:1024 sc1 lds
    buffer_load_dwordx4 v14, s[28:31], s61 offen offset:2048 sc1 lds
    s_mov_b64 exec, -1
    s_waitcnt vmcnt(0)
    s_branch val_10
val_10_ok:
    s_mov_b64 exec, -1
    s_barrier
    s_add_u32 m0, s4, 0
    s_add_u32 s25, s61, 49152
    buffer_load_dwordx4 v14, s[28:31], s25 offen offset:0 lds
    buffer_load_dwordx4 v14, s[28:31], s25 offen offset:1024 lds
    buffer_load_dwordx4 v14, s[28:31], s25 offen offset:2048 lds
    s_waitcnt vmcnt(9) lgkmcnt(0)
    s_mov_b32 s51, 0
val_11:
    ds_read_b128 v[24:27], v16 offset:24576
    ds_read_b128 v[28:31], v16 offset:25600
    ds_read_b128 v[32:35], v16 offset:26624
    s_waitcnt lgkmcnt(2)
    v_max3_u32 v24, v24, v25, v26
    v_max_u32 v24, v24, v27
    s_waitcnt lgkmcnt(1)
    v_max3_u32 v28, v28, v29, v30
    v_max3_u32 v28, v28, v31, v24
    s_waitcnt lgkmcnt(0)
    v_max3_u32 v32, v32, v33, v34
    v_max3_u32 v32, v32, v35, v28
    v_cmp_eq_u32 vcc, -1, v32
    s_nop 0
    s_and_b64 exec, vcc, vcc
    s_cbranch_scc0 val_11_ok
    s_cmp_lt_u32 s51, 30000
    s_cbranch_scc0 val_11_ok
    s_cmp_eq_u32 s51, 0
    s_cbranch_scc1 val_11_ns
    s_sleep 2
val_11_ns:
    s_add_u32 s51, s51, 1
    s_add_u32 m0, s4, 24576
    s_add_u32 s25, s61, 12288
    buffer_load_dwordx4 v14, s[28:31], s25 offen offset:0 sc1 lds
    buffer_load_dwordx4 v14, s[28:31], s25 offen offset:1024 sc1 lds
    buffer_load_dwordx4 v14, s[28:31], s25 offen offset:2048 sc1 lds
    s_mov_b64 exec, -1
    s_waitcnt vmcnt(0)
    s_branch val_11
val_11_ok:
    s_mov_b64 exec, -1
    s_barrier
    s_add_u32 m0, s24, 0
    s_nop 0
    buffer_load_dwordx4 v9, s[32:35], s60 offen offset:0 lds
    s_add_u32 s45, s60, 35840
    buffer_load_dwordx4 v9, s[32:35], s45 offen offset:1024 lds
    s_add_u32 s46, s60, 71680
    buffer_load_dwordx4 v10, s[32:35], s46 offen offset:2048 lds
    s_add_u32 s44, s60, 107520
    buffer_load_dwordx4 v10, s[32:35], s44 offen offset:3072 lds
    s_add_u32 m0, s4, 12288
    s_add_u32 s25, s61, 61440
    buffer_load_dwordx4 v14, s[28:31], s25 offen offset:0 lds
    buffer_load_dwordx4 v14, s[28:31], s25 offen offset:1024 lds
    buffer_load_dwordx4 v14, s[28:31], s25 offen offset:2048 lds
    s_waitcnt vmcnt(13) lgkmcnt(0)
    s_mov_b32 s51, 0
val_12:
    ds_read_b128 v[24:27], v16 offset:36864
    ds_read_b128 v[28:31], v16 offset:37888
    ds_read_b128 v[32:35], v16 offset:38912
    s_waitcnt lgkmcnt(2)
    v_max3_u32 v24, v24, v25, v26
    v_max_u32 v24, v24, v27
    s_waitcnt lgkmcnt(1)
    v_max3_u32 v28, v28, v29, v30
    v_max3_u32 v28, v28, v31, v24
    s_waitcnt lgkmcnt(0)
    v_max3_u32 v32, v32, v33, v34
    v_max3_u32 v32, v32, v35, v28
    v_cmp_eq_u32 vcc, -1, v32
    s_nop 0
    s_and_b64 exec, vcc, vcc
    s_cbranch_scc0 val_12_ok
    s_cmp_lt_u32 s51, 30000
    s_cbranch_scc0 val_12_ok
    s_cmp_eq_u32 s51, 0
    s_cbranch_scc1 val_12_ns
    s_sleep 2
val_12_ns:
    s_add_u32 s51, s51, 1
    s_add_u32 m0, s4, 36864
    s_add_u32 s25, s61, 24576
    buffer_load_dwordx4 v14, s[28:31], s25 offen offset:0 sc1 lds
    buffer_load_dwordx4 v14, s[28:31], s25 offen offset:1024 sc1 lds
    buffer_load_dwordx4 v14, s[28:31], s25 offen offset:2048 sc1 lds
    s_mov_b64 exec, -1
    s_waitcnt vmcnt(0)
    s_branch val_12
val_12_ok:
    s_mov_b64 exec, -1
    s_barrier
    s_add_u32 m0, s24, 16384
    s_add_u32 s44, s60, 589824
    buffer_load_dwordx4 v9, s[32:35], s44 offen offset:0 lds
    s_add_u32 s45, s60, 625664
    buffer_load_dwordx4 v9, s[32:35], s45 offen offset:1024 lds
    s_add_u32 s46, s60, 661504
    buffer_load_dwordx4 v10, s[32:35], s46 offen offset:2048 lds
    s_add_u32 s44, s60, 697344
    buffer_load_dwordx4 v10, s[32:35], s44 offen offset:3072 lds
    s_add_u32 m0, s4, 24576
    s_add_u32 s25, s61, 73728
    buffer_load_dwordx4 v14, s[28:31], s25 offen offset:0 lds
    buffer_load_dwordx4 v14, s[28:31], s25 offen offset:1024 lds
    buffer_load_dwordx4 v14, s[28:31], s25 offen offset:2048 lds
    s_waitcnt vmcnt(17) lgkmcnt(0)
    s_mov_b32 s51, 0
val_13:
    ds_read_b128 v[24:27], v16 offset:49152
    ds_read_b128 v[28:31], v16 offset:50176
    ds_read_b128 v[32:35], v16 offset:51200
    s_waitcnt lgkmcnt(2)
    v_max3_u32 v24, v24, v25, v26
    v_max_u32 v24, v24, v27
    s_waitcnt lgkmcnt(1)
    v_max3_u32 v28, v28, v29, v30
    v_max3_u32 v28, v28, v31, v24
    s_waitcnt lgkmcnt(0)
    v_max3_u32 v32, v32, v33, v34
    v_max3_u32 v32, v32, v35, v28
    v_cmp_eq_u32 vcc, -1, v32
    s_nop 0
    s_and_b64 exec, vcc, vcc
    s_cbranch_scc0 val_13_ok
    s_cmp_lt_u32 s51, 30000
    s_cbranch_scc0 val_13_ok
    s_cmp_eq_u32 s51, 0
    s_cbranch_scc1 val_13_ns
    s_sleep 2
val_13_ns:
    s_add_u32 s51, s51, 1
    s_add_u32 m0, s4, 49152
    s_add_u32 s25, s61, 36864
    buffer_load_dwordx4 v14, s[28:31], s25 offen offset:0 sc1 lds
    buffer_load_dwordx4 v14, s[28:31], s25 offen offset:1024 sc1 lds
    buffer_load_dwordx4 v14, s[28:31], s25 offen offset:2048 sc1 lds
    s_mov_b64 exec, -1
    s_waitcnt vmcnt(0)
    s_branch val_13
val_13_ok:
    s_mov_b64 exec, -1
    s_barrier
    buffer_load_dword v3, v2, s[28:31], s50 offen sc1
    s_add_u32 m0, s24, 32768
    s_add_u32 s44, s60, 1179648
    buffer_load_dwordx4 v9, s[32:35], s44 offen offset:0 lds
    s_add_u32 s45, s60, 1215488
    buffer_load_dwordx4 v9, s[32:35], s45 offen offset:1024 lds
    s_add_u32 s46, s60, 1251328
    buffer_load_dwordx4 v10, s[32:35], s46 offen offset:2048 lds
    s_add_u32 s44, s60, 1287168
    buffer_load_dwordx4 v10, s[32:35], s44 offen offset:3072 lds
    s_add_u32 m0, s4, 36864
    s_add_u32 s25, s61, 86016
    buffer_load_dwordx4 v14, s[28:31], s25 offen offset:0 lds
    buffer_load_dwordx4 v14, s[28:31], s25 offen offset:1024 lds
    buffer_load_dwordx4 v14, s[28:31], s25 offen offset:2048 lds
    s_waitcnt vmcnt(22) lgkmcnt(0)
    s_mov_b32 s51, 0
val_14:
    ds_read_b128 v[24:27], v16 offset:0
    ds_read_b128 v[28:31], v16 offset:1024
    ds_read_b128 v[32:35], v16 offset:2048
    s_waitcnt lgkmcnt(2)
    v_max3_u32 v24, v24, v25, v26
    v_max_u32 v24, v24, v27
    s_waitcnt lgkmcnt(1)
    v_max3_u32 v28, v28, v29, v30
    v_max3_u32 v28, v28, v31, v24
    s_waitcnt lgkmcnt(0)
    v_max3_u32 v32, v32, v33, v34
    v_max3_u32 v32, v32, v35, v28
    v_cmp_eq_u32 vcc, -1, v32
    s_nop 0
    s_and_b64 exec, vcc, vcc
    s_cbranch_scc0 val_14_ok
    s_cmp_lt_u32 s51, 30000
    s_cbranch_scc0 val_14_ok
    s_cmp_eq_u32 s51, 0
    s_cbranch_scc1 val_14_ns
    s_sleep 2
val_14_ns:
    s_add_u32 s51, s51, 1
    s_add_u32 m0, s4, 0
    s_add_u32 s25, s61, 49152
    buffer_load_dwordx4 v14, s[28:31], s25 offen offset:0 sc1 lds
    buffer_load_dwordx4 v14, s[28:31], s25 offen offset:1024 sc1 lds
    buffer_load_dwordx4 v14, s[28:31], s25 offen offset:2048 sc1 lds
    s_mov_b64 exec, -1
    s_waitcnt vmcnt(0)
    s_branch val_14
val_14_ok:
    s_mov_b64 exec, -1
    s_barrier
    s_add_u32 m0, s24, 49152
    s_add_u32 s44, s60, 1769472
    buffer_load_dwordx4 v9, s[32:35], s44 offen offset:0 lds
    s_add_u32 s45, s60, 1805312
    buffer_load_dwordx4 v9, s[32:35], s45 offen offset:1024 lds
    s_add_u32 s46, s60, 1841152
    buffer_load_dwordx4 v10, s[32:35], s46 offen offset:2048 lds
    s_add_u32 s44, s60, 1876992
    buffer_load_dwordx4 v10, s[32:35], s44 offen offset:3072 lds
    s_waitcnt vmcnt(11)
    v_cmp_ne_u32 vcc, 0, v3
    s_nop 0
    s_lshr_b64 s[54:55], vcc, s56
    s_andn2_b64 exec, 0xffff, vcc
    s_cbranch_scc0 g1_skipped_ok
    s_mov_b32 s51, 0
g1_skipped:
    buffer_load_dword v3, v2, s[28:31], s50 offen offset:0 sc1
    s_add_u32 s51, s51, 1
    s_waitcnt vmcnt(0)
    v_cmp_eq_u32 vcc, 0, v3
    s_nop 0
    s_and_b64 exec, vcc, vcc
    s_cbranch_scc0 g1_skipped_ok
    s_sleep 2
    s_cmp_lt_u32 s51, 30000
    s_cbranch_scc1 g1_skipped
g1_skipped_ok:
    s_mov_b64 exec, -1
    s_and_b32 s25, s54, 3
    s_cmp_eq_u32 s25, 3
    s_cbranch_scc1 chk_15_ok
    s_mov_b32 s51, 0
chk_15:
    buffer_load_dword v3, v2, s[28:31], s50 offen sc1
    s_add_u32 s51, s51, 1
    s_mov_b64 exec, -1
    s_waitcnt vmcnt(0)
    v_cmp_ne_u32 vcc, 0, v3
    s_nop 0
    s_lshr_b64 s[54:55], vcc, s56
    s_and_b32 s25, s54, 3
    s_cmp_eq_u32 s25, 3
    s_cbranch_scc1 chk_15_ok
    s_sleep 1
    s_lshl_b64 exec, 0xff, s56
    s_cmp_lt_u32 s51, 30000
    s_cbranch_scc1 chk_15
    s_mov_b64 exec, -1
chk_15_ok:
    s_lshr_b64 s[54:55], s[54:55], 2
    s_add_u32 s56, s56, 2
    s_add_u32 m0, s4, 49152
    s_add_u32 s25, s61, 98304
    buffer_load_dwordx4 v14, s[28:31], s25 offen offset:0 lds
    buffer_load_dwordx4 v14, s[28:31], s25 offen offset:1024 lds
    buffer_load_dwordx4 v14, s[28:31], s25 offen offset:2048 lds
    s_waitcnt vmcnt(22) lgkmcnt(0)
    s_mov_b32 s51, 0
val_16:
    ds_read_b128 v[24:27], v16 offset:12288
    ds_read_b128 v[28:31], v16 offset:13312
    ds_read_b128 v[32:35], v16 offset:14336
    s_waitcnt lgkmcnt(2)
    v_max3_u32 v24, v24, v25, v26
    v_max_u32 v24, v24, v27
    s_waitcnt lgkmcnt(1)
    v_max3_u32 v28, v28, v29, v30
    v_max3_u32 v28, v28, v31, v24
    s_waitcnt lgkmcnt(0)
    v_max3_u32 v32, v32, v33, v34
    v_max3_u32 v32, v32, v35, v28
    v_cmp_eq_u32 vcc, -1, v32
    s_nop 0
    s_and_b64 exec, vcc, vcc
    s_cbranch_scc0 val_16_ok
    s_cmp_lt_u32 s51, 30000
    s_cbranch_scc0 val_16_ok
    s_cmp_eq_u32 s51, 0
    s_cbranch_scc1 val_16_ns
    s_sleep 2
val_16_ns:
    s_add_u32 s51, s51, 1
    s_add_u32 m0, s4, 12288
    s_add_u32 s25, s61, 61440
    buffer_load_dwordx4 v14, s[28:31], s25 offen offset:0 sc1 lds
    buffer_load_dwordx4 v14, s[28:31], s25 offen offset:1024 sc1 lds
    buffer_load_dwordx4 v14, s[28:31], s25 offen offset:2048 sc1 lds
    s_mov_b64 exec, -1
    s_waitcnt vmcnt(0)
    s_branch val_16
val_16_ok:
    s_mov_b64 exec, -1
    s_barrier
    s_add_u32 m0, s24, 65536
    s_add_u32 s44, s60, 2359296
    buffer_load_dwordx4 v9, s[32:35], s44 offen offset:0 lds
    s_add_u32 s45, s60, 2395136
    buffer_load_dwordx4 v9, s[32:35], s45 offen offset:1024 lds
    s_add_u32 s46, s60, 2430976
    buffer_load_dwordx4 v10, s[32:35], s46 offen offset:2048 lds
    s_add_u32 s44, s60, 2466816
    buffer_load_dwordx4 v10, s[32:35], s44 offen offset:3072 lds
    s_and_b32 s25, s54, 3
    s_cmp_eq_u32 s25, 3
    s_cbranch_scc1 chk_17_ok
    s_mov_b32 s51, 0
chk_17:
    buffer_load_dword v3, v2, s[28:31], s50 offen sc1
    s_add_u32 s51, s51, 1
    s_mov_b64 exec, -1
    s_waitcnt vmcnt(0)
    v_cmp_ne_u32 vcc, 0, v3
    s_nop 0
    s_lshr_b64 s[54:55], vcc, s56
    s_and_b32 s25, s54, 3
    s_cmp_eq_u32 s25, 3
    s_cbranch_scc1 chk_17_ok
    s_sleep 1
    s_lshl_b64 exec, 0xff, s56
    s_cmp_lt_u32 s51, 30000
    s_cbranch_scc1 chk_17
    s_mov_b64 exec, -1
chk_17_ok:
    s_lshr_b64 s[54:55], s[54:55], 2
    s_add_u32 s56, s56, 2
    s_add_u32 m0, s4, 0
    s_add_u32 s25, s61, 110592
    buffer_load_dwordx4 v14, s[28:31], s25 offen offset:0 lds
    buffer_load_dwordx4 v14, s[28:31], s25 offen offset:1024 lds
    buffer_load_dwordx4 v14, s[28:31], s25 offen offset:2048 lds
    s_waitcnt vmcnt(22) lgkmcnt(0)
    s_mov_b32 s51, 0
val_18:
    ds_read_b128 v[24:27], v16 offset:24576
    ds_read_b128 v[28:31], v16 offset:25600
    ds_read_b128 v[32:35], v16 offset:26624
    s_waitcnt lgkmcnt(2)
    v_max3_u32 v24, v24, v25, v26
    v_max_u32 v24, v24, v27
    s_waitcnt lgkmcnt(1)
    v_max3_u32 v28, v28, v29, v30
    v_max3_u32 v28, v28, v31, v24
    s_waitcnt lgkmcnt(0)
    v_max3_u32 v32, v32, v33, v34
    v_max3_u32 v32, v32, v35, v28
    v_cmp_eq_u32 vcc, -1, v32
    s_nop 0
    s_and_b64 exec, vcc, vcc
    s_cbranch_scc0 val_18_ok
    s_cmp_lt_u32 s51, 30000
    s_cbranch_scc0 val_18_ok
    s_cmp_eq_u32 s51, 0
    s_cbranch_scc1 val_18_ns
    s_sleep 2
val_18_ns:
    s_add_u32 s51, s51, 1
    s_add_u32 m0, s4, 24576
    s_add_u32 s25, s61, 73728
    buffer_load_dwordx4 v14, s[28:31], s25 offen offset:0 sc1 lds
    buffer_load_dwordx4 v14, s[28:31], s25 offen offset:1024 sc1 lds
    buffer_load_dwordx4 v14, s[28:31], s25 offen offset:2048 sc1 lds
    s_mov_b64 exec, -1
    s_waitcnt vmcnt(0)
    s_branch val_18
val_18_ok:
    s_mov_b64 exec, -1
    s_barrier
    s_add_u32 m0, s24, 81920
    s_add_u32 s44, s60, 2949120
    buffer_load_dwordx4 v9, s[32:35], s44 offen offset:0 lds
    s_add_u32 s45, s60, 2984960
    buffer_load_dwordx4 v9, s[32:35], s45 offen offset:1024 lds
    s_add_u32 s46, s60, 3020800
    buffer_load_dwordx4 v10, s[32:35], s46 offen offset:2048 lds
    s_add_u32 s44, s60, 3056640
    buffer_load_dwordx4 v10, s[32:35], s44 offen offset:3072 lds
    s_and_b32 s25, s54, 3
    s_cmp_eq_u32 s25, 3
    s_cbranch_scc1 chk_19_ok
    s_mov_b32 s51, 0
chk_19:
    buffer_load_dword v3, v2, s[28:31], s50 offen sc1
    s_add_u32 s51, s51, 1
    s_mov_b64 exec, -1
    s_waitcnt vmcnt(0)
    v_cmp_ne_u32 vcc, 0, v3
    s_nop 0
    s_lshr_b64 s[54:55], vcc, s56
    s_and_b32 s25, s54, 3
    s_cmp_eq_u32 s25, 3
    s_cbranch_scc1 chk_19_ok
    s_sleep 1
    s_lshl_b64 exec, 0xff, s56
    s_cmp_lt_u32 s51, 30000
    s_cbranch_scc1 chk_19
    s_mov_b64 exec, -1
chk_19_ok:
    s_lshr_b64 s[54:55], s[54:55], 2
    s_add_u32 s56, s56, 2
    s_add_u32 m0, s4, 12288
    s_add_u32 s25, s61, 122880
    buffer_load_dwordx4 v14, s[28:31], s25 offen offset:0 lds
    buffer_load_dwordx4 v14, s[28:31], s25 offen offset:1024 lds
    buffer_load_dwordx4 v14, s[28:31], s25 offen offset:2048 lds
    s_waitcnt vmcnt(21) lgkmcnt(0)
    s_mov_b32 s51, 0
val_20:
    ds_read_b128 v[24:27], v16 offset:36864
    ds_read_b128 v[28:31], v16 offset:37888
    ds_read_b128 v[32:35], v16 offset:38912
    s_waitcnt lgkmcnt(2)
    v_max3_u32 v24, v24, v25, v26
    v_max_u32 v24, v24, v27
    s_waitcnt lgkmcnt(1)
    v_max3_u32 v28, v28, v29, v30
    v_max3_u32 v28, v28, v31, v24
    s_waitcnt lgkmcnt(0)
    v_max3_u32 v32, v32, v33, v34
    v_max3_u32 v32, v32, v35, v28
    v_cmp_eq_u32 vcc, -1, v32
    s_nop 0
    s_and_b64 exec, vcc, vcc
    s_cbranch_scc0 val_20_ok
    s_cmp_lt_u32 s51, 30000
    s_cbranch_scc0 val_20_ok
    s_cmp_eq_u32 s51, 0
    s_cbranch_scc1 val_20_ns
    s_sleep 2
val_20_ns:
    s_add_u32 s51, s51, 1
    s_add_u32 m0, s4, 36864
    s_add_u32 s25, s61, 86016
    buffer_load_dwordx4 v14, s[28:31], s25 offen offset:0 sc1 lds
    buffer_load_dwordx4 v14, s[28:31], s25 offen offset:1024 sc1 lds
    buffer_load_dwordx4 v14, s[28:31], s25 offen offset:2048 sc1 lds
    s_mov_b64 exec, -1
    s_waitcnt vmcnt(0)
    s_branch val_20
val_20_ok:
    s_mov_b64 exec, -1
    s_barrier
    s_add_u32 m0, s24, 0
    s_add_u32 s44, s60, 3538944
    buffer_load_dwordx4 v9, s[32:35], s44 offen offset:0 lds
    s_add_u32 s45, s60, 3574784
    buffer_load_dwordx4 v9, s[32:35], s45 offen offset:1024 lds
    s_add_u32 s46, s60, 3610624
    buffer_load_dwordx4 v10, s[32:35], s46 offen offset:2048 lds
    s_add_u32 s44, s60, 3646464
    buffer_load_dwordx4 v10, s[32:35], s44 offen offset:3072 lds
    s_and_b32 s25, s54, 3
    s_cmp_eq_u32 s25, 3
    s_cbranch_scc1 chk_21_ok
    s_mov_b32 s51, 0
chk_21:
    buffer_load_dword v3, v2, s[28:31], s50 offen sc1
    s_add_u32 s51, s51, 1
    s_mov_b64 exec, -1
    s_waitcnt vmcnt(0)
    v_cmp_ne_u32 vcc, 0, v3
    s_nop 0
    s_lshr_b64 s[54:55], vcc, s56
    s_and_b32 s25, s54, 3
    s_cmp_eq_u32 s25, 3
    s_cbranch_scc1 chk_21_ok
    s_sleep 1
    s_lshl_b64 exec, 0xff, s56
    s_cmp_lt_u32 s51, 30000
    s_cbranch_scc1 chk_21
    s_mov_b64 exec, -1
chk_21_ok:
    s_lshr_b64 s[54:55], s[54:55], 2
    s_add_u32 s56, s56, 2
    s_add_u32 m0, s4, 24576
    s_add_u32 s25, s61, 135168
    buffer_load_dwordx4 v14, s[28:31], s25 offen offset:0 lds
    buffer_load_dwordx4 v14, s[28:31], s25 offen offset:1024 lds
    buffer_load_dwordx4 v14, s[28:31], s25 offen offset:2048 lds
    s_waitcnt vmcnt(21) lgkmcnt(0)
    s_barrier
    s_add_u32 m0, s24, 16384
    s_add_u32 s44, s60, 4128768
    buffer_load_dwordx4 v9, s[32:35], s44 offen offset:0 lds
    s_add_u32 s45, s60, 4164608
    buffer_load_dwordx4 v9, s[32:35], s45 offen offset:1024 lds
    s_add_u32 s46, s60, 4200448
    buffer_load_dwordx4 v10, s[32:35], s46 offen offset:2048 lds
    s_add_u32 s44, s60, 4236288
    buffer_load_dwordx4 v10, s[32:35], s44 offen offset:3072 lds
    s_and_b32 s25, s54, 3
    s_cmp_eq_u32 s25, 3
    s_cbranch_scc1 chk_22_ok
    s_mov_b32 s51, 0
chk_22:
    buffer_load_dword v3, v2, s[28:31], s50 offen sc1
    s_add_u32 s51, s51, 1
    s_mov_b64 exec, -1
    s_waitcnt vmcnt(0)
    v_cmp_ne_u32 vcc, 0, v3
    s_nop 0
    s_lshr_b64 s[54:55], vcc, s56
    s_and_b32 s25, s54, 3
    s_cmp_eq_u32 s25, 3
    s_cbranch_scc1 chk_22_ok
    s_sleep 1
    s_lshl_b64 exec, 0xff, s56
    s_cmp_lt_u32 s51, 30000
    s_cbranch_scc1 chk_22
    s_mov_b64 exec, -1
chk_22_ok:
    s_lshr_b64 s[54:55], s[54:55], 2
    s_add_u32 s56, s56, 2
    s_add_u32 m0, s4, 36864
    s_add_u32 s25, s61, 147456
    buffer_load_dwordx4 v14, s[28:31], s25 offen offset:0 lds
    buffer_load_dwordx4 v14, s[28:31], s25 offen offset:1024 lds
    buffer_load_dwordx4 v14, s[28:31], s25 offen offset:2048 lds
    s_waitcnt vmcnt(21) lgkmcnt(0)
    s_barrier
    s_add_u32 m0, s24, 32768
    s_add_u32 s44, s60, 4718592
    buffer_load_dwordx4 v9, s[32:35], s44 offen offset:0 lds
    s_add_u32 s45, s60, 4754432
    buffer_load_dwordx4 v9, s[32:35], s45 offen offset:1024 lds
    s_add_u32 s46, s60, 4790272
    buffer_load_dwordx4 v10, s[32:35], s46 offen offset:2048 lds
    s_add_u32 s44, s60, 4826112
    buffer_load_dwordx4 v10, s[32:35], s44 offen offset:3072 lds
    s_and_b32 s25, s54, 3
    s_cmp_eq_u32 s25, 3
    s_cbranch_scc1 chk_23_ok
    s_mov_b32 s51, 0
chk_23:
    buffer_load_dword v3, v2, s[28:31], s50 offen sc1
    s_add_u32 s51, s51, 1
    s_mov_b64 exec, -1
    s_waitcnt vmcnt(0)
    v_cmp_ne_u32 vcc, 0, v3
    s_nop 0
    s_lshr_b64 s[54:55], vcc, s56
    s_and_b32 s25, s54, 3
    s_cmp_eq_u32 s25, 3
    s_cbranch_scc1 chk_23_ok
    s_sleep 1
    s_lshl_b64 exec, 0xff, s56
    s_cmp_lt_u32 s51, 30000
    s_cbranch_scc1 chk_23
    s_mov_b64 exec, -1
chk_23_ok:
    s_lshr_b64 s[54:55], s[54:55], 2
    s_add_u32 s56, s56, 2
    s_add_u32 m0, s4, 49152
    s_add_u32 s25, s61, 159744
    buffer_load_dwordx4 v14, s[28:31], s25 offen offset:0 lds
    buffer_load_dwordx4 v14, s[28:31], s25 offen offset:1024 lds
    buffer_load_dwordx4 v14, s[28:31], s25 offen offset:2048 lds
    s_waitcnt vmcnt(21) lgkmcnt(0)
    s_barrier
    s_add_u32 m0, s24, 49152
    s_add_u32 s44, s60, 5308416
    buffer_load_dwordx4 v9, s[32:35], s44 offen offset:0 lds
    s_add_u32 s45, s60, 5344256
    buffer_load_dwordx4 v9, s[32:35], s45 offen offset:1024 lds
    s_add_u32 s46, s60, 5380096
    buffer_load_dwordx4 v10, s[32:35], s46 offen offset:2048 lds
    s_add_u32 s44, s60, 5415936
    buffer_load_dwordx4 v10, s[32:35], s44 offen offset:3072 lds
    s_and_b32 s25, s54, 3
    s_cmp_eq_u32 s25, 3
    s_cbranch_scc1 chk_24_ok
    s_mov_b32 s51, 0
chk_24:
    buffer_load_dword v3, v2, s[28:31], s50 offen sc1
    s_add_u32 s51, s51, 1
    s_mov_b64 exec, -1
    s_waitcnt vmcnt(0)
    v_cmp_ne_u32 vcc, 0, v3
    s_nop 0
    s_lshr_b64 s[54:55], vcc, s56
    s_and_b32 s25, s54, 3
    s_cmp_eq_u32 s25, 3
    s_cbranch_scc1 chk_24_ok
    s_sleep 1
    s_lshl_b64 exec, 0xff, s56
    s_cmp_lt_u32 s51, 30000
    s_cbranch_scc1 chk_24
    s_mov_b64 exec, -1
chk_24_ok:
    s_lshr_b64 s[54:55], s[54:55], 2
    s_add_u32 s56, s56, 2
    s_add_u32 m0, s4, 0
    s_add_u32 s25, s61, 172032
    buffer_load_dwordx4 v14, s[28:31], s25 offen offset:0 lds
    buffer_load_dwordx4 v14, s[28:31], s25 offen offset:1024 lds
    buffer_load_dwordx4 v14, s[28:31], s25 offen offset:2048 lds
    s_waitcnt vmcnt(21) lgkmcnt(0)
    s_barrier
    s_add_u32 m0, s24, 65536
    s_add_u32 s44, s60, 5898240
    buffer_load_dwordx4 v9, s[32:35], s44 offen offset:0 lds
    s_add_u32 s45, s60, 5934080
    buffer_load_dwordx4 v9, s[32:35], s45 offen offset:1024 lds
    s_add_u32 s46, s60, 5969920
    buffer_load_dwordx4 v10, s[32:35], s46 offen offset:2048 lds
    s_add_u32 s44, s60, 6005760
    buffer_load_dwordx4 v10, s[32:35], s44 offen offset:3072 lds
    s_and_b32 s25, s54, 3
    s_cmp_eq_u32 s25, 3
    s_cbranch_scc1 chk_25_ok
    s_mov_b32 s51, 0
chk_25:
    buffer_load_dword v3, v2, s[28:31], s50 offen sc1
    s_add_u32 s51, s51, 1
    s_mov_b64 exec, -1
    s_waitcnt vmcnt(0)
    v_cmp_ne_u32 vcc, 0, v3
    s_nop 0
    s_lshr_b64 s[54:55], vcc, s56
    s_and_b32 s25, s54, 3
    s_cmp_eq_u32 s25, 3
    s_cbranch_scc1 chk_25_ok
    s_sleep 1
    s_lshl_b64 exec, 0xff, s56
    s_cmp_lt_u32 s51, 30000
    s_cbranch_scc1 chk_25
    s_mov_b64 exec, -1
chk_25_ok:
    s_lshr_b64 s[54:55], s[54:55], 2
    s_add_u32 s56, s56, 2
    s_add_u32 m0, s4, 12288
    s_add_u32 s25, s61, 184320
    buffer_load_dwordx4 v14, s[28:31], s25 offen offset:0 lds
    buffer_load_dwordx4 v14, s[28:31], s25 offen offset:1024 lds
    buffer_load_dwordx4 v14, s[28:31], s25 offen offset:2048 lds
    s_waitcnt vmcnt(21) lgkmcnt(0)
    s_barrier
    s_add_u32 m0, s24, 81920
    s_add_u32 s44, s60, 6488064
    buffer_load_dwordx4 v9, s[32:35], s44 offen offset:0 lds
    s_add_u32 s45, s60, 6523904
    buffer_load_dwordx4 v9, s[32:35], s45 offen offset:1024 lds
    s_add_u32 s46, s60, 6559744
    buffer_load_dwordx4 v10, s[32:35], s46 offen offset:2048 lds
    s_add_u32 s44, s60, 6595584
    buffer_load_dwordx4 v10, s[32:35], s44 offen offset:3072 lds
    s_and_b32 s25, s54, 3
    s_cmp_eq_u32 s25, 3
    s_cbranch_scc1 chk_26_ok
    s_mov_b32 s51, 0
chk_26:
    buffer_load_dword v3, v2, s[28:31], s50 offen sc1
    s_add_u32 s51, s51, 1
    s_mov_b64 exec, -1
    s_waitcnt vmcnt(0)
    v_cmp_ne_u32 vcc, 0, v3
    s_nop 0
    s_lshr_b64 s[54:55], vcc, s56
    s_and_b32 s25, s54, 3
    s_cmp_eq_u32 s25, 3
    s_cbranch_scc1 chk_26_ok
    s_sleep 1
    s_lshl_b64 exec, 0xff, s56
    s_cmp_lt_u32 s51, 30000
    s_cbranch_scc1 chk_26
    s_mov_b64 exec, -1
chk_26_ok:
    s_lshr_b64 s[54:55], s[54:55], 2
    s_add_u32 s56, s56, 2
    s_add_u32 m0, s4, 24576
    s_add_u32 s25, s61, 196608
    buffer_load_dwordx4 v14, s[28:31], s25 offen offset:0 lds
    buffer_load_dwordx4 v14, s[28:31], s25 offen offset:1024 lds
    buffer_load_dwordx4 v14, s[28:31], s25 offen offset:2048 lds
    s_waitcnt vmcnt(21) lgkmcnt(0)
    s_barrier
    s_add_u32 m0, s24, 0
    s_add_u32 s44, s60, 7077888
    buffer_load_dwordx4 v9, s[32:35], s44 offen offset:0 lds
    s_add_u32 s45, s60, 7113728
    buffer_load_dwordx4 v9, s[32:35], s45 offen offset:1024 lds
    s_add_u32 s46, s60, 7149568
    buffer_load_dwordx4 v10, s[32:35], s46 offen offset:2048 lds
    s_add_u32 s44, s60, 7185408
    buffer_load_dwordx4 v10, s[32:35], s44 offen offset:3072 lds
    s_and_b32 s25, s54, 3
    s_cmp_eq_u32 s25, 3
    s_cbranch_scc1 chk_27_ok
    s_mov_b32 s51, 0
chk_27:
    buffer_load_dword v3, v2, s[28:31], s50 offen sc1
    s_add_u32 s51, s51, 1
    s_mov_b64 exec, -1
    s_waitcnt vmcnt(0)
    v_cmp_ne_u32 vcc, 0, v3
    s_nop 0
    s_lshr_b64 s[54:55], vcc, s56
    s_and_b32 s25, s54, 3
    s_cmp_eq_u32 s25, 3
    s_cbranch_scc1 chk_27_ok
    s_sleep 1
    s_lshl_b64 exec, 0xff, s56
    s_cmp_lt_u32 s51, 30000
    s_cbranch_scc1 chk_27
    s_mov_b64 exec, -1
chk_27_ok:
    s_lshr_b64 s[54:55], s[54:55], 2
    s_add_u32 s56, s56, 2
    s_add_u32 m0, s4, 36864
    s_add_u32 s25, s61, 208896
    buffer_load_dwordx4 v14, s[28:31], s25 offen offset:0 lds
    buffer_load_dwordx4 v14, s[28:31], s25 offen offset:1024 lds
    buffer_load_dwordx4 v14, s[28:31], s25 offen offset:2048 lds
    s_waitcnt vmcnt(21) lgkmcnt(0)
    s_barrier
    s_add_u32 m0, s24, 16384
    s_add_u32 s44, s60, 7667712
    buffer_load_dwordx4 v9, s[32:35], s44 offen offset:0 lds
    s_add_u32 s45, s60, 7703552
    buffer_load_dwordx4 v9, s[32:35], s45 offen offset:1024 lds
    s_add_u32 s46, s60, 7739392
    buffer_load_dwordx4 v10, s[32:35], s46 offen offset:2048 lds
    s_add_u32 s44, s60, 7775232
    buffer_load_dwordx4 v10, s[32:35], s44 offen offset:3072 lds
    s_and_b32 s25, s54, 3
    s_cmp_eq_u32 s25, 3
    s_cbranch_scc1 chk_28_ok
    s_mov_b32 s51, 0
chk_28:
    buffer_load_dword v3, v2, s[28:31], s50 offen sc1
    s_add_u32 s51, s51, 1
    s_mov_b64 exec, -1
    s_waitcnt vmcnt(0)
    v_cmp_ne_u32 vcc, 0, v3
    s_nop 0
    s_lshr_b64 s[54:55], vcc, s56
    s_and_b32 s25, s54, 3
    s_cmp_eq_u32 s25, 3
    s_cbranch_scc1 chk_28_ok
    s_sleep 1
    s_lshl_b64 exec, 0xff, s56
    s_cmp_lt_u32 s51, 30000
    s_cbranch_scc1 chk_28
    s_mov_b64 exec, -1
chk_28_ok:
    s_lshr_b64 s[54:55], s[54:55], 2
    s_add_u32 s56, s56, 2
    s_add_u32 m0, s4, 49152
    s_add_u32 s25, s61, 221184
    buffer_load_dwordx4 v14, s[28:31], s25 offen offset:0 lds
    buffer_load_dwordx4 v14, s[28:31], s25 offen offset:1024 lds
    buffer_load_dwordx4 v14, s[28:31], s25 offen offset:2048 lds
    s_waitcnt vmcnt(21) lgkmcnt(0)
    s_barrier
    s_add_u32 m0, s24, 32768
    s_add_u32 s44, s60, 8257536
    buffer_load_dwordx4 v9, s[32:35], s44 offen offset:0 lds
    s_add_u32 s45, s60, 8293376
    buffer_load_dwordx4 v9, s[32:35], s45 offen offset:1024 lds
    s_add_u32 s46, s60, 8329216
    buffer_load_dwordx4 v10, s[32:35], s46 offen offset:2048 lds
    s_add_u32 s44, s60, 8365056
    buffer_load_dwordx4 v10, s[32:35], s44 offen offset:3072 lds
    s_and_b32 s25, s54, 3
    s_cmp_eq_u32 s25, 3
    s_cbranch_scc1 chk_29_ok
    s_mov_b32 s51, 0
chk_29:
    buffer_load_dword v3, v2, s[28:31], s50 offen sc1
    s_add_u32 s51, s51, 1
    s_mov_b64 exec, -1
    s_waitcnt vmcnt(0)
    v_cmp_ne_u32 vcc, 0, v3
    s_nop 0
    s_lshr_b64 s[54:55], vcc, s56
    s_and_b32 s25, s54, 3
    s_cmp_eq_u32 s25, 3
    s_cbranch_scc1 chk_29_ok
    s_sleep 1
    s_lshl_b64 exec, 0xff, s56
    s_cmp_lt_u32 s51, 30000
    s_cbranch_scc1 chk_29
    s_mov_b64 exec, -1
chk_29_ok:
    s_lshr_b64 s[54:55], s[54:55], 2
    s_add_u32 s56, s56, 2
    s_add_u32 m0, s4, 0
    s_add_u32 s25, s61, 233472
    buffer_load_dwordx4 v14, s[28:31], s25 offen offset:0 lds
    buffer_load_dwordx4 v14, s[28:31], s25 offen offset:1024 lds
    buffer_load_dwordx4 v14, s[28:31], s25 offen offset:2048 lds
    s_waitcnt vmcnt(21) lgkmcnt(0)
    s_barrier
    s_add_u32 m0, s24, 49152
    s_add_u32 s44, s60, 8847360
    buffer_load_dwordx4 v9, s[32:35], s44 offen offset:0 lds
    s_add_u32 s45, s60, 8883200
    buffer_load_dwordx4 v9, s[32:35], s45 offen offset:1024 lds
    s_add_u32 s46, s60, 8919040
    buffer_load_dwordx4 v10, s[32:35], s46 offen offset:2048 lds
    s_add_u32 s44, s60, 8954880
    buffer_load_dwordx4 v10, s[32:35], s44 offen offset:3072 lds
    s_and_b32 s25, s54, 3
    s_cmp_eq_u32 s25, 3
    s_cbranch_scc1 chk_30_ok
    s_mov_b32 s51, 0
chk_30:
    buffer_load_dword v3, v2, s[28:31], s50 offen sc1
    s_add_u32 s51, s51, 1
    s_mov_b64 exec, -1
    s_waitcnt vmcnt(0)
    v_cmp_ne_u32 vcc, 0, v3
    s_nop 0
    s_lshr_b64 s[54:55], vcc, s56
    s_and_b32 s25, s54, 3
    s_cmp_eq_u32 s25, 3
    s_cbranch_scc1 chk_30_ok
    s_sleep 1
    s_lshl_b64 exec, 0xff, s56
    s_cmp_lt_u32 s51, 30000
    s_cbranch_scc1 chk_30
    s_mov_b64 exec, -1
chk_30_ok:
    s_lshr_b64 s[54:55], s[54:55], 2
    s_add_u32 s56, s56, 2
    s_add_u32 m0, s4, 12288
    s_add_u32 s25, s61, 245760
    buffer_load_dwordx4 v14, s[28:31], s25 offen offset:0 lds
    buffer_load_dwordx4 v14, s[28:31], s25 offen offset:1024 lds
    buffer_load_dwordx4 v14, s[28:31], s25 offen offset:2048 lds
    s_waitcnt vmcnt(21) lgkmcnt(0)
    s_barrier
    s_add_u32 m0, s24, 65536
    s_add_u32 s44, s60, 9437184
    buffer_load_dwordx4 v9, s[32:35], s44 offen offset:0 lds
    s_add_u32 s45, s60, 9473024
    buffer_load_dwordx4 v9, s[32:35], s45 offen offset:1024 lds
    s_add_u32 s46, s60, 9508864
    buffer_load_dwordx4 v10, s[32:35], s46 offen offset:2048 lds
    s_add_u32 s44, s60, 9544704
    buffer_load_dwordx4 v10, s[32:35], s44 offen offset:3072 lds
    s_and_b32 s25, s54, 3
    s_cmp_eq_u32 s25, 3
    s_cbranch_scc1 chk_31_ok
    s_mov_b32 s51, 0
chk_31:
    buffer_load_dword v3, v2, s[28:31], s50 offen sc1
    s_add_u32 s51, s51, 1
    s_mov_b64 exec, -1
    s_waitcnt vmcnt(0)
    v_cmp_ne_u32 vcc, 0, v3
    s_nop 0
    s_lshr_b64 s[54:55], vcc, s56
    s_and_b32 s25, s54, 3
    s_cmp_eq_u32 s25, 3
    s_cbranch_scc1 chk_31_ok
    s_sleep 1
    s_lshl_b64 exec, 0xff, s56
    s_cmp_lt_u32 s51, 30000
    s_cbranch_scc1 chk_31
    s_mov_b64 exec, -1
chk_31_ok:
    s_lshr_b64 s[54:55], s[54:55], 2
    s_add_u32 s56, s56, 2
    s_add_u32 m0, s4, 24576
    s_add_u32 s25, s61, 258048
    buffer_load_dwordx4 v14, s[28:31], s25 offen offset:0 lds
    buffer_load_dwordx4 v14, s[28:31], s25 offen offset:1024 lds
    buffer_load_dwordx4 v14, s[28:31], s25 offen offset:2048 lds
    s_waitcnt vmcnt(21) lgkmcnt(0)
    s_barrier
    s_add_u32 m0, s24, 81920
    s_add_u32 s44, s60, 10027008
    buffer_load_dwordx4 v9, s[32:35], s44 offen offset:0 lds
    s_add_u32 s45, s60, 10062848
    buffer_load_dwordx4 v9, s[32:35], s45 offen offset:1024 lds
    s_add_u32 s46, s60, 10098688
    buffer_load_dwordx4 v10, s[32:35], s46 offen offset:2048 lds
    s_add_u32 s44, s60, 10134528
    buffer_load_dwordx4 v10, s[32:35], s44 offen offset:3072 lds
    s_and_b32 s25, s54, 3
    s_cmp_eq_u32 s25, 3
    s_cbranch_scc1 chk_32_ok
    s_mov_b32 s51, 0
chk_32:
    buffer_load_dword v3, v2, s[28:31], s50 offen sc1
    s_add_u32 s51, s51, 1
    s_mov_b64 exec, -1
    s_waitcnt vmcnt(0)
    v_cmp_ne_u32 vcc, 0, v3
    s_nop 0
    s_lshr_b64 s[54:55], vcc, s56
    s_and_b32 s25, s54, 3
    s_cmp_eq_u32 s25, 3
    s_cbranch_scc1 chk_32_ok
    s_sleep 1
    s_lshl_b64 exec, 0xff, s56
    s_cmp_lt_u32 s51, 30000
    s_cbranch_scc1 chk_32
    s_mov_b64 exec, -1
chk_32_ok:
    s_lshr_b64 s[54:55], s[54:55], 2
    s_add_u32 s56, s56, 2
    s_add_u32 m0, s4, 36864
    s_add_u32 s25, s61, 270336
    buffer_load_dwordx4 v14, s[28:31], s25 offen offset:0 lds
    buffer_load_dwordx4 v14, s[28:31], s25 offen offset:1024 lds
    buffer_load_dwordx4 v14, s[28:31], s25 offen offset:2048 lds
    s_waitcnt vmcnt(21) lgkmcnt(0)
    s_barrier
    s_add_u32 m0, s24, 0
    s_add_u32 s44, s60, 10616832
    buffer_load_dwordx4 v9, s[32:35], s44 offen offset:0 lds
    s_add_u32 s45, s60, 10652672
    buffer_load_dwordx4 v9, s[32:35], s45 offen offset:1024 lds
    s_add_u32 s46, s60, 10688512
    buffer_load_dwordx4 v10, s[32:35], s46 offen offset:2048 lds
    s_add_u32 s44, s60, 10724352
    buffer_load_dwordx4 v10, s[32:35], s44 offen offset:3072 lds
    s_and_b32 s25, s54, 3
    s_cmp_eq_u32 s25, 3
    s_cbranch_scc1 chk_33_ok
    s_mov_b32 s51, 0
chk_33:
    buffer_load_dword v3, v2, s[28:31], s50 offen sc1
    s_add_u32 s51, s51, 1
    s_mov_b64 exec, -1
    s_waitcnt vmcnt(0)
    v_cmp_ne_u32 vcc, 0, v3
    s_nop 0
    s_lshr_b64 s[54:55], vcc, s56
    s_and_b32 s25, s54, 3
    s_cmp_eq_u32 s25, 3
    s_cbranch_scc1 chk_33_ok
    s_sleep 1
    s_lshl_b64 exec, 0xff, s56
    s_cmp_lt_u32 s51, 30000
    s_cbranch_scc1 chk_33
    s_mov_b64 exec, -1
chk_33_ok:
    s_lshr_b64 s[54:55], s[54:55], 2
    s_add_u32 s56, s56, 2
    s_add_u32 m0, s4, 49152
    s_add_u32 s25, s61, 282624
    buffer_load_dwordx4 v14, s[28:31], s25 offen offset:0 lds
    buffer_load_dwordx4 v14, s[28:31], s25 offen offset:1024 lds
    buffer_load_dwordx4 v14, s[28:31], s25 offen offset:2048 lds
    s_waitcnt vmcnt(21) lgkmcnt(0)
    s_barrier
    s_add_u32 m0, s24, 16384
    s_add_u32 s44, s60, 11206656
    buffer_load_dwordx4 v9, s[32:35], s44 offen offset:0 lds
    s_add_u32 s45, s60, 11242496
    buffer_load_dwordx4 v9, s[32:35], s45 offen offset:1024 lds
    s_add_u32 s46, s60, 11278336
    buffer_load_dwordx4 v10, s[32:35], s46 offen offset:2048 lds
    s_add_u32 s44, s60, 11314176
    buffer_load_dwordx4 v10, s[32:35], s44 offen offset:3072 lds
    s_and_b32 s25, s54, 3
    s_cmp_eq_u32 s25, 3
    s_cbranch_scc1 chk_34_ok
    s_mov_b32 s51, 0
chk_34:
    buffer_load_dword v3, v2, s[28:31], s50 offen sc1
    s_add_u32 s51, s51, 1
    s_mov_b64 exec, -1
    s_waitcnt vmcnt(0)
    v_cmp_ne_u32 vcc, 0, v3
    s_nop 0
    s_lshr_b64 s[54:55], vcc, s56
    s_and_b32 s25, s54, 3
    s_cmp_eq_u32 s25, 3
    s_cbranch_scc1 chk_34_ok
    s_sleep 1
    s_lshl_b64 exec, 0xff, s56
    s_cmp_lt_u32 s51, 30000
    s_cbranch_scc1 chk_34
    s_mov_b64 exec, -1
chk_34_ok:
    s_lshr_b64 s[54:55], s[54:55], 2
    s_add_u32 s56, s56, 2
    s_add_u32 m0, s4, 0
    s_add_u32 s25, s61, 294912
    buffer_load_dwordx4 v14, s[28:31], s25 offen offset:0 lds
    buffer_load_dwordx4 v14, s[28:31], s25 offen offset:1024 lds
    buffer_load_dwordx4 v14, s[28:31], s25 offen offset:2048 lds
    s_waitcnt vmcnt(21) lgkmcnt(0)
    s_barrier
    s_add_u32 m0, s24, 32768
    s_add_u32 s44, s60, 11796480
    buffer_load_dwordx4 v9, s[32:35], s44 offen offset:0 lds
    s_add_u32 s45, s60, 11832320
    buffer_load_dwordx4 v9, s[32:35], s45 offen offset:1024 lds
    s_add_u32 s46, s60, 11868160
    buffer_load_dwordx4 v10, s[32:35], s46 offen offset:2048 lds
    s_add_u32 s44, s60, 11904000
    buffer_load_dwordx4 v10, s[32:35], s44 offen offset:3072 lds
    s_and_b32 s25, s54, 3
    s_cmp_eq_u32 s25, 3
    s_cbranch_scc1 chk_35_ok
    s_mov_b32 s51, 0
chk_35:
    buffer_load_dword v3, v2, s[28:31], s50 offen sc1
    s_add_u32 s51, s51, 1
    s_mov_b64 exec, -1
    s_waitcnt vmcnt(0)
    v_cmp_ne_u32 vcc, 0, v3
    s_nop 0
    s_lshr_b64 s[54:55], vcc, s56
    s_and_b32 s25, s54, 3
    s_cmp_eq_u32 s25, 3
    s_cbranch_scc1 chk_35_ok
    s_sleep 1
    s_lshl_b64 exec, 0xff, s56
    s_cmp_lt_u32 s51, 30000
    s_cbranch_scc1 chk_35
    s_mov_b64 exec, -1
chk_35_ok:
    s_lshr_b64 s[54:55], s[54:55], 2
    s_add_u32 s56, s56, 2
    s_add_u32 m0, s4, 12288
    s_add_u32 s25, s61, 307200
    buffer_load_dwordx4 v14, s[28:31], s25 offen offset:0 lds
    buffer_load_dwordx4 v14, s[28:31], s25 offen offset:1024 lds
    buffer_load_dwordx4 v14, s[28:31], s25 offen offset:2048 lds
    s_waitcnt vmcnt(21) lgkmcnt(0)
    s_barrier
    s_add_u32 m0, s24, 49152
    s_add_u32 s44, s60, 12386304
    buffer_load_dwordx4 v9, s[32:35], s44 offen offset:0 lds
    s_add_u32 s45, s60, 12422144
    buffer_load_dwordx4 v9, s[32:35], s45 offen offset:1024 lds
    s_add_u32 s46, s60, 12457984
    buffer_load_dwordx4 v10, s[32:35], s46 offen offset:2048 lds
    s_add_u32 s44, s60, 12493824
    buffer_load_dwordx4 v10, s[32:35], s44 offen offset:3072 lds
    s_and_b32 s25, s54, 3
    s_cmp_eq_u32 s25, 3
    s_cbranch_scc1 chk_36_ok
    s_mov_b32 s51, 0
chk_36:
    buffer_load_dword v3, v2, s[28:31], s50 offen sc1
    s_add_u32 s51, s51, 1
    s_mov_b64 exec, -1
    s_waitcnt vmcnt(0)
    v_cmp_ne_u32 vcc, 0, v3
    s_nop 0
    s_lshr_b64 s[54:55], vcc, s56
    s_and_b32 s25, s54, 3
    s_cmp_eq_u32 s25, 3
    s_cbranch_scc1 chk_36_ok
    s_sleep 1
    s_lshl_b64 exec, 0xff, s56
    s_cmp_lt_u32 s51, 30000
    s_cbranch_scc1 chk_36
    s_mov_b64 exec, -1
chk_36_ok:
    s_lshr_b64 s[54:55], s[54:55], 2
    s_add_u32 s56, s56, 2
    s_add_u32 m0, s4, 24576
    s_add_u32 s25, s61, 319488
    buffer_load_dwordx4 v14, s[28:31], s25 offen offset:0 lds
    buffer_load_dwordx4 v14, s[28:31], s25 offen offset:1024 lds
    buffer_load_dwordx4 v14, s[28:31], s25 offen offset:2048 lds
    s_waitcnt vmcnt(21) lgkmcnt(0)
    s_barrier
    s_add_u32 m0, s24, 65536
    s_add_u32 s44, s60, 12976128
    buffer_load_dwordx4 v9, s[32:35], s44 offen offset:0 lds
    s_add_u32 s45, s60, 13011968
    buffer_load_dwordx4 v9, s[32:35], s45 offen offset:1024 lds
    s_add_u32 s46, s60, 13047808
    buffer_load_dwordx4 v10, s[32:35], s46 offen offset:2048 lds
    s_add_u32 s44, s60, 13083648
    buffer_load_dwordx4 v10, s[32:35], s44 offen offset:3072 lds
    s_and_b32 s25, s54, 3
    s_cmp_eq_u32 s25, 3
    s_cbranch_scc1 chk_37_ok
    s_mov_b32 s51, 0
chk_37:
    buffer_load_dword v3, v2, s[28:31], s50 offen sc1
    s_add_u32 s51, s51, 1
    s_mov_b64 exec, -1
    s_waitcnt vmcnt(0)
    v_cmp_ne_u32 vcc, 0, v3
    s_nop 0
    s_lshr_b64 s[54:55], vcc, s56
    s_and_b32 s25, s54, 3
    s_cmp_eq_u32 s25, 3
    s_cbranch_scc1 chk_37_ok
    s_sleep 1
    s_lshl_b64 exec, 0xff, s56
    s_cmp_lt_u32 s51, 30000
    s_cbranch_scc1 chk_37
    s_mov_b64 exec, -1
chk_37_ok:
    s_lshr_b64 s[54:55], s[54:55], 2
    s_add_u32 s56, s56, 2
    s_add_u32 m0, s4, 36864
    s_add_u32 s25, s61, 331776
    buffer_load_dwordx4 v14, s[28:31], s25 offen offset:0 lds
    buffer_load_dwordx4 v14, s[28:31], s25 offen offset:1024 lds
    buffer_load_dwordx4 v14, s[28:31], s25 offen offset:2048 lds
    s_waitcnt vmcnt(21) lgkmcnt(0)
    s_barrier
    s_add_u32 m0, s24, 81920
    s_add_u32 s44, s60, 13565952
    buffer_load_dwordx4 v9, s[32:35], s44 offen offset:0 lds
    s_add_u32 s45, s60, 13601792
    buffer_load_dwordx4 v9, s[32:35], s45 offen offset:1024 lds
    s_add_u32 s46, s60, 13637632
    buffer_load_dwordx4 v10, s[32:35], s46 offen offset:2048 lds
    s_add_u32 s44, s60, 13673472
    buffer_load_dwordx4 v10, s[32:35], s44 offen offset:3072 lds
    s_and_b32 s25, s54, 3
    s_cmp_eq_u32 s25, 3
    s_cbranch_scc1 chk_38_ok
    s_mov_b32 s51, 0
chk_38:
    buffer_load_dword v3, v2, s[28:31], s50 offen sc1
    s_add_u32 s51, s51, 1
    s_mov_b64 exec, -1
    s_waitcnt vmcnt(0)
    v_cmp_ne_u32 vcc, 0, v3
    s_nop 0
    s_lshr_b64 s[54:55], vcc, s56
    s_and_b32 s25, s54, 3
    s_cmp_eq_u32 s25, 3
    s_cbranch_scc1 chk_38_ok
    s_sleep 1
    s_lshl_b64 exec, 0xff, s56
    s_cmp_lt_u32 s51, 30000
    s_cbranch_scc1 chk_38
    s_mov_b64 exec, -1
chk_38_ok:
    s_lshr_b64 s[54:55], s[54:55], 2
    s_add_u32 s56, s56, 2
    s_add_u32 m0, s4, 49152
    s_add_u32 s25, s61, 344064
    buffer_load_dwordx4 v14, s[28:31], s25 offen offset:0 lds
    buffer_load_dwordx4 v14, s[28:31], s25 offen offset:1024 lds
    buffer_load_dwordx4 v14, s[28:31], s25 offen offset:2048 lds
    s_waitcnt vmcnt(21) lgkmcnt(0)
    s_barrier
    s_add_u32 m0, s24, 0
    s_add_u32 s44, s60, 14155776
    buffer_load_dwordx4 v9, s[32:35], s44 offen offset:0 lds
    s_add_u32 s45, s60, 14191616
    buffer_load_dwordx4 v9, s[32:35], s45 offen offset:1024 lds
    s_add_u32 s46, s60, 14227456
    buffer_load_dwordx4 v10, s[32:35], s46 offen offset:2048 lds
    s_add_u32 s44, s60, 14263296
    buffer_load_dwordx4 v10, s[32:35], s44 offen offset:3072 lds
    s_and_b32 s25, s54, 3
    s_cmp_eq_u32 s25, 3
    s_cbranch_scc1 chk_39_ok
    s_mov_b32 s51, 0
chk_39:
    buffer_load_dword v3, v2, s[28:31], s50 offen sc1
    s_add_u32 s51, s51, 1
    s_mov_b64 exec, -1
    s_waitcnt vmcnt(0)
    v_cmp_ne_u32 vcc, 0, v3
    s_nop 0
    s_lshr_b64 s[54:55], vcc, s56
    s_and_b32 s25, s54, 3
    s_cmp_eq_u32 s25, 3
    s_cbranch_scc1 chk_39_ok
    s_sleep 1
    s_lshl_b64 exec, 0xff, s56
    s_cmp_lt_u32 s51, 30000
    s_cbranch_scc1 chk_39
    s_mov_b64 exec, -1
chk_39_ok:
    s_lshr_b64 s[54:55], s[54:55], 2
    s_add_u32 s56, s56, 2
    s_add_u32 m0, s4, 0
    s_add_u32 s25, s61, 356352
    buffer_load_dwordx4 v14, s[28:31], s25 offen offset:0 lds
    buffer_load_dwordx4 v14, s[28:31], s25 offen offset:1024 lds
    buffer_load_dwordx4 v14, s[28:31], s25 offen offset:2048 lds
    s_waitcnt vmcnt(21) lgkmcnt(0)
    s_barrier
    s_add_u32 m0, s24, 16384
    s_add_u32 s44, s60, 14745600
    buffer_load_dwordx4 v9, s[32:35], s44 offen offset:0 lds
    s_add_u32 s45, s60, 14781440
    buffer_load_dwordx4 v9, s[32:35], s45 offen offset:1024 lds
    s_add_u32 s46, s60, 14817280
    buffer_load_dwordx4 v10, s[32:35], s46 offen offset:2048 lds
    s_add_u32 s44, s60, 14853120
    buffer_load_dwordx4 v10, s[32:35], s44 offen offset:3072 lds
    s_and_b32 s25, s54, 3
    s_cmp_eq_u32 s25, 3
    s_cbranch_scc1 chk_40_ok
    s_mov_b32 s51, 0
chk_40:
    buffer_load_dword v3, v2, s[28:31], s50 offen sc1
    s_add_u32 s51, s51, 1
    s_mov_b64 exec, -1
    s_waitcnt vmcnt(0)
    v_cmp_ne_u32 vcc, 0, v3
    s_nop 0
    s_lshr_b64 s[54:55], vcc, s56
    s_and_b32 s25, s54, 3
    s_cmp_eq_u32 s25, 3
    s_cbranch_scc1 chk_40_ok
    s_sleep 1
    s_lshl_b64 exec, 0xff, s56
    s_cmp_lt_u32 s51, 30000
    s_cbranch_scc1 chk_40
    s_mov_b64 exec, -1
chk_40_ok:
    s_lshr_b64 s[54:55], s[54:55], 2
    s_add_u32 s56, s56, 2
    s_add_u32 m0, s4, 12288
    s_add_u32 s25, s61, 368640
    buffer_load_dwordx4 v14, s[28:31], s25 offen offset:0 lds
    buffer_load_dwordx4 v14, s[28:31], s25 offen offset:1024 lds
    buffer_load_dwordx4 v14, s[28:31], s25 offen offset:2048 lds
    s_waitcnt vmcnt(21) lgkmcnt(0)
    s_barrier
    s_and_b32 s25, s54, 3
    s_cmp_eq_u32 s25, 3
    s_cbranch_scc1 chk_41_ok
    s_mov_b32 s51, 0
chk_41:
    buffer_load_dword v3, v2, s[28:31], s50 offen sc1
    s_add_u32 s51, s51, 1
    s_mov_b64 exec, -1
    s_waitcnt vmcnt(0)
    v_cmp_ne_u32 vcc, 0, v3
    s_nop 0
    s_lshr_b64 s[54:55], vcc, s56
    s_and_b32 s25, s54, 3
    s_cmp_eq_u32 s25, 3
    s_cbranch_scc1 chk_41_ok
    s_sleep 1
    s_lshl_b64 exec, 0xff, s56
    s_cmp_lt_u32 s51, 30000
    s_cbranch_scc1 chk_41
    s_mov_b64 exec, -1
chk_41_ok:
    s_lshr_b64 s[54:55], s[54:55], 2
    s_add_u32 s56, s56, 2
    s_add_u32 m0, s4, 24576
    s_add_u32 s25, s61, 380928
    buffer_load_dwordx4 v14, s[28:31], s25 offen offset:0 lds
    buffer_load_dwordx4 v14, s[28:31], s25 offen offset:1024 lds
    buffer_load_dwordx4 v14, s[28:31], s25 offen offset:2048 lds
    s_waitcnt vmcnt(17) lgkmcnt(0)
    s_barrier
    s_waitcnt vmcnt(10) lgkmcnt(0)
    s_barrier
    s_waitcnt vmcnt(3) lgkmcnt(0)
    s_barrier
    s_waitcnt vmcnt(0) lgkmcnt(0)
    s_barrier
t_ld2:
    s_lshr_b32 s44, s36, 1
    s_and_b32 s45, s36, 1
    s_lshl_b32 s45, s45, 3
    s_lshr_b32 s46, s37, 2
    s_add_u32 s45, s45, s46
    s_and_b32 s46, s37, 3
    v_lshrrev_b32 v2, 4, v1
    v_and_b32 v3, 15, v1
    v_lshlrev_b32 v9, 1, v2
    v_xor_b32 v9, v9, v3
    v_xor_b32 v10, 8, v9
    v_mul_u32_u24 v2, 4096, v2
    v_lshl_add_u32 v9, v9, 4, v2
    v_lshl_add_u32 v10, v10, 4, v2
    s_mul_i32 s52, s44, 4718592
    s_lshl_b32 s50, s45, 8
    s_add_u32 s52, s52, s50
    s_mul_i32 s50, s39, 65536
    s_add_u32 s52, s52, s50
    s_mul_i32 s53, s46, 144
    s_mul_i32 s50, s44, 36
    s_add_u32 s53, s53, s50
    s_mul_i32 s53, s53, 9216
    s_mul_i32 s4, s39, 4608
    s_add_u32 s53, s53, s4
    s_add_u32 s53, s53, 16777216
    s_add_u32 s4, s4, 81920
    s_lshl_b32 s24, s39, 12
    s_mov_b32 s6, 0x18764320
    s_mov_b32 s7, 5
    s_cmp_eq_u32 s44, 1
    s_cselect_b32 s6, 0x40765321, s6
    s_cselect_b32 s7, 8, s7
    s_cmp_eq_u32 s44, 2
    s_cselect_b32 s6, 0x38654210, s6
    s_cselect_b32 s7, 7, s7
    s_cmp_eq_u32 s44, 3
    s_cselect_b32 s6, 0x28754310, s6
    s_cselect_b32 s7, 6, s7
    v_min_u32 v2, 35, v1
    v_and_b32 v3, 1, v2
    s_mul_i32 s50, s46, 3
    s_and_b32 s51, s39, 1
    s_add_u32 s50, s50, s51
    v_add_u32 v3, s50, v3
    v_and_b32 v4, 60, v2
    v_lshrrev_b64 v[12:13], v4, s[6:7]
    v_and_b32 v4, 15, v12
    v_mul_u32_u24 v4, 6, v4
    v_lshrrev_b32 v7, 1, v3
    v_add_u32 v4, v4, v7
    v_and_b32 v3, 1, v3
    v_lshlrev_b32 v3, 1, v3
    v_bfe_u32 v2, v2, 1, 1
    v_add_u32 v3, v3, v2
    v_lshlrev_b32 v3, 7, v3
    v_lshl_add_u32 v2, v4, 10, v3
    s_mul_i32 s50, s44, 55296
    s_add_u32 s50, s50, 262528
    s_cmp_lt_u32 s2, 216
    s_cbranch_scc0 g2_ld_nobar
    s_barrier
g2_ld_nobar:
    s_bfe_u32 s5, s6, 0x40000
    s_mul_i32 s57, s5, 524288
    s_add_u32 s57, s57, s52
    s_add_u32 m0, s24, 0
    s_nop 0
    buffer_load_dwordx4 v9, s[8:11], s57 offen offset:0 lds
    s_add_u32 s26, s57, 15360
    buffer_load_dwordx4 v10, s[8:11], s26 offen offset:1024 lds
    s_add_u32 s27, s57, 30720
    buffer_load_dwordx4 v9, s[8:11], s27 offen offset:2048 lds
    s_add_u32 s25, s57, 46080
    buffer_load_dwordx4 v10, s[8:11], s25 offen offset:3072 lds
    s_add_u32 m0, s24, 16384
    s_add_u32 s25, s57, 262144
    buffer_load_dwordx4 v9, s[8:11], s25 offen offset:0 lds
    s_add_u32 s26, s57, 277504
    buffer_load_dwordx4 v10, s[8:11], s26 offen offset:1024 lds
    s_add_u32 s27, s57, 292864
    buffer_load_dwordx4 v9, s[8:11], s27 offen offset:2048 lds
    s_add_u32 s25, s57, 308224
    buffer_load_dwordx4 v10, s[8:11], s25 offen offset:3072 lds
    s_bfe_u32 s5, s6, 0x40004
    s_mul_i32 s57, s5, 524288
    s_add_u32 s57, s57, s52
    s_add_u32 m0, s24, 32768
    s_nop 0
    buffer_load_dwordx4 v9, s[8:11], s57 offen offset:0 lds
    s_add_u32 s26, s57, 15360
    buffer_load_dwordx4 v10, s[8:11], s26 offen offset:1024 lds
    s_add_u32 s27, s57, 30720
    buffer_load_dwordx4 v9, s[8:11], s27 offen offset:2048 lds
    s_add_u32 s25, s57, 46080
    buffer_load_dwordx4 v10, s[8:11], s25 offen offset:3072 lds
    s_add_u32 m0, s24, 49152
    s_add_u32 s25, s57, 262144
    buffer_load_dwordx4 v9, s[8:11], s25 offen offset:0 lds
    s_add_u32 s26, s57, 277504
    buffer_load_dwordx4 v10, s[8:11], s26 offen offset:1024 lds
    s_add_u32 s27, s57, 292864
    buffer_load_dwordx4 v9, s[8:11], s27 offen offset:2048 lds
    s_add_u32 s25, s57, 308224
    buffer_load_dwordx4 v10, s[8:11], s25 offen offset:3072 lds
    s_bfe_u32 s5, s6, 0x40008
    s_mul_i32 s57, s5, 524288
    s_add_u32 s57, s57, s52
    s_add_u32 m0, s24, 65536
    s_nop 0
    buffer_load_dwordx4 v9, s[8:11], s57 offen offset:0 lds
    s_add_u32 s26, s57, 15360
    buffer_load_dwordx4 v10, s[8:11], s26 offen offset:1024 lds
    s_add_u32 s27, s57, 30720
    buffer_load_dwordx4 v9, s[8:11], s27 offen offset:2048 lds
    s_add_u32 s25, s57, 46080
    buffer_load_dwordx4 v10, s[8:11], s25 offen offset:3072 lds
    s_cmp_lt_u32 s2, 216
    s_cbranch_scc0 g2_ld_nobar2
    s_barrier
g2_ld_nobar2:
    s_sleep 8
    s_mov_b64 s[54:55], 0
    s_mov_b32 s56, 0
    s_bfe_u32 s5, s6, 0x40000
    s_mul_i32 s58, s5, 36864
    s_add_u32 s58, s58, s53
    s_and_b32 s25, s54, 3
    s_cmp_eq_u32 s25, 3
    s_cbranch_scc1 chk_42_ok
    s_mov_b32 s51, 0
chk_42:
    buffer_load_dword v3, v2, s[28:31], s50 offen sc1
    s_add_u32 s51, s51, 1
    s_mov_b64 exec, -1
    s_waitcnt vmcnt(0)
    v_cmp_ne_u32 vcc, 0, v3
    s_nop 0
    s_lshr_b64 s[54:55], vcc, s56
    s_and_b32 s25, s54, 3
    s_cmp_eq_u32 s25, 3
    s_cbranch_scc1 chk_42_ok
    s_sleep 2
    s_lshl_b64 exec, 0xff, s56
    s_cmp_lt_u32 s51, 30000
    s_cbranch_scc1 chk_42
    s_mov_b64 exec, -1
chk_42_ok:
    s_lshr_b64 s[54:55], s[54:55], 2
    s_add_u32 s56, s56, 2
    s_add_u32 m0, s4, 0
    s_mov_b64 exec, 0xffffffff
    buffer_load_dwordx4 v14, s[28:31], s58 offen lds
    s_mov_b64 exec, -1
    buffer_load_dwordx4 v14, s[28:31], s58 offen offset:512 lds
    buffer_load_dwordx4 v14, s[28:31], s58 offen offset:1536 lds
    buffer_load_dwordx4 v14, s[28:31], s58 offen offset:2560 lds
    buffer_load_dwordx4 v14, s[28:31], s58 offen offset:3584 lds
    s_and_b32 s25, s54, 3
    s_cmp_eq_u32 s25, 3
    s_cbranch_scc1 chk_43_ok
    s_mov_b32 s51, 0
chk_43:
    buffer_load_dword v3, v2, s[28:31], s50 offen sc1
    s_add_u32 s51, s51, 1
    s_mov_b64 exec, -1
    s_waitcnt vmcnt(0)
    v_cmp_ne_u32 vcc, 0, v3
    s_nop 0
    s_lshr_b64 s[54:55], vcc, s56
    s_and_b32 s25, s54, 3
    s_cmp_eq_u32 s25, 3
    s_cbranch_scc1 chk_43_ok
    s_sleep 2
    s_lshl_b64 exec, 0xff, s56
    s_cmp_lt_u32 s51, 30000
    s_cbranch_scc1 chk_43
    s_mov_b64 exec, -1
chk_43_ok:
    s_lshr_b64 s[54:55], s[54:55], 2
    s_add_u32 s56, s56, 2
    s_add_u32 m0, s4, 18432
    s_add_u32 s59, s58, 18432
    s_mov_b64 exec, 0xffffffff
    buffer_load_dwordx4 v14, s[28:31], s59 offen lds
    s_mov_b64 exec, -1
    buffer_load_dwordx4 v14, s[28:31], s59 offen offset:512 lds
    buffer_load_dwordx4 v14, s[28:31], s59 offen offset:1536 lds
    buffer_load_dwordx4 v14, s[28:31], s59 offen offset:2560 lds
    buffer_load_dwordx4 v14, s[28:31], s59 offen offset:3584 lds
    s_bfe_u32 s5, s6, 0x40004
    s_mul_i32 s58, s5, 36864
    s_add_u32 s58, s58, s53
    s_and_b32 s25, s54, 3
    s_cmp_eq_u32 s25, 3
    s_cbranch_scc1 chk_44_ok
    s_mov_b32 s51, 0
chk_44:
    buffer_load_dword v3, v2, s[28:31], s50 offen sc1
    s_add_u32 s51, s51, 1
    s_mov_b64 exec, -1
    s_waitcnt vmcnt(0)
    v_cmp_ne_u32 vcc, 0, v3
    s_nop 0
    s_lshr_b64 s[54:55], vcc, s56
    s_and_b32 s25, s54, 3
    s_cmp_eq_u32 s25, 3
    s_cbranch_scc1 chk_44_ok
    s_sleep 2
    s_lshl_b64 exec, 0xff, s56
    s_cmp_lt_u32 s51, 30000
    s_cbranch_scc1 chk_44
    s_mov_b64 exec, -1
chk_44_ok:
    s_lshr_b64 s[54:55], s[54:55], 2
    s_add_u32 s56, s56, 2
    s_add_u32 m0, s4, 36864
    s_mov_b64 exec, 0xffffffff
    buffer_load_dwordx4 v14, s[28:31], s58 offen lds
    s_mov_b64 exec, -1
    buffer_load_dwordx4 v14, s[28:31], s58 offen offset:512 lds
    buffer_load_dwordx4 v14, s[28:31], s58 offen offset:1536 lds
    buffer_load_dwordx4 v14, s[28:31], s58 offen offset:2560 lds
    buffer_load_dwordx4 v14, s[28:31], s58 offen offset:3584 lds
    s_waitcnt vmcnt(10)
    s_barrier
    s_and_b32 s25, s54, 3
    s_cmp_eq_u32 s25, 3
    s_cbranch_scc1 chk_45_ok
    s_mov_b32 s51, 0
chk_45:
    buffer_load_dword v3, v2, s[28:31], s50 offen sc1
    s_add_u32 s51, s51, 1
    s_mov_b64 exec, -1
    s_waitcnt vmcnt(0)
    v_cmp_ne_u32 vcc, 0, v3
    s_nop 0
    s_lshr_b64 s[54:55], vcc, s56
    s_and_b32 s25, s54, 3
    s_cmp_eq_u32 s25, 3
    s_cbranch_scc1 chk_45_ok
    s_sleep 2
    s_lshl_b64 exec, 0xff, s56
    s_cmp_lt_u32 s51, 30000
    s_cbranch_scc1 chk_45
    s_mov_b64 exec, -1
chk_45_ok:
    s_lshr_b64 s[54:55], s[54:55], 2
    s_add_u32 s56, s56, 2
    s_add_u32 m0, s4, 55296
    s_add_u32 s59, s58, 18432
    s_mov_b64 exec, 0xffffffff
    buffer_load_dwordx4 v14, s[28:31], s59 offen lds
    s_mov_b64 exec, -1
    buffer_load_dwordx4 v14, s[28:31], s59 offen offset:512 lds
    buffer_load_dwordx4 v14, s[28:31], s59 offen offset:1536 lds
    buffer_load_dwordx4 v14, s[28:31], s59 offen offset:2560 lds
    buffer_load_dwordx4 v14, s[28:31], s59 offen offset:3584 lds
    s_waitcnt vmcnt(10)
    s_barrier
    s_add_u32 m0, s24, 0
    s_add_u32 s25, s57, 262144
    buffer_load_dwordx4 v9, s[8:11], s25 offen offset:0 lds
    s_add_u32 s26, s57, 277504
    buffer_load_dwordx4 v10, s[8:11], s26 offen offset:1024 lds
    s_add_u32 s27, s57, 292864
    buffer_load_dwordx4 v9, s[8:11], s27 offen offset:2048 lds
    s_add_u32 s25, s57, 308224
    buffer_load_dwordx4 v10, s[8:11], s25 offen offset:3072 lds
    s_bfe_u32 s5, s6, 0x40008
    s_mul_i32 s58, s5, 36864
    s_add_u32 s58, s58, s53
    s_and_b32 s25, s54, 3
    s_cmp_eq_u32 s25, 3
    s_cbranch_scc1 chk_46_ok
    s_mov_b32 s51, 0
chk_46:
    buffer_load_dword v3, v2, s[28:31], s50 offen sc1
    s_add_u32 s51, s51, 1
    s_mov_b64 exec, -1
    s_waitcnt vmcnt(0)
    v_cmp_ne_u32 vcc, 0, v3
    s_nop 0
    s_lshr_b64 s[54:55], vcc, s56
    s_and_b32 s25, s54, 3
    s_cmp_eq_u32 s25, 3
    s_cbranch_scc1 chk_46_ok
    s_sleep 2
    s_lshl_b64 exec, 0xff, s56
    s_cmp_lt_u32 s51, 30000
    s_cbranch_scc1 chk_46
    s_mov_b64 exec, -1
chk_46_ok:
    s_lshr_b64 s[54:55], s[54:55], 2
    s_add_u32 s56, s56, 2
    s_add_u32 m0, s4, 0
    s_mov_b64 exec, 0xffffffff
    buffer_load_dwordx4 v14, s[28:31], s58 offen lds
    s_mov_b64 exec, -1
    buffer_load_dwordx4 v14, s[28:31], s58 offen offset:512 lds
    buffer_load_dwordx4 v14, s[28:31], s58 offen offset:1536 lds
    buffer_load_dwordx4 v14, s[28:31], s58 offen offset:2560 lds
    buffer_load_dwordx4 v14, s[28:31], s58 offen offset:3584 lds
    s_waitcnt vmcnt(14)
    s_barrier
    s_bfe_u32 s5, s6, 0x4000c
    s_mul_i32 s57, s5, 524288
    s_add_u32 s57, s57, s52
    s_add_u32 m0, s24, 16384
    s_nop 0
    buffer_load_dwordx4 v9, s[8:11], s57 offen offset:0 lds
    s_add_u32 s26, s57, 15360
    buffer_load_dwordx4 v10, s[8:11], s26 offen offset:1024 lds
    s_add_u32 s27, s57, 30720
    buffer_load_dwordx4 v9, s[8:11], s27 offen offset:2048 lds
    s_add_u32 s25, s57, 46080
    buffer_load_dwordx4 v10, s[8:11], s25 offen offset:3072 lds
    s_and_b32 s25, s54, 3
    s_cmp_eq_u32 s25, 3
    s_cbranch_scc1 chk_47_ok
    s_mov_b32 s51, 0
chk_47:
    buffer_load_dword v3, v2, s[28:31], s50 offen sc1
    s_add_u32 s51, s51, 1
    s_mov_b64 exec, -1
    s_waitcnt vmcnt(0)
    v_cmp_ne_u32 vcc, 0, v3
    s_nop 0
    s_lshr_b64 s[54:55], vcc, s56
    s_and_b32 s25, s54, 3
    s_cmp_eq_u32 s25, 3
    s_cbranch_scc1 chk_47_ok
    s_sleep 2
    s_lshl_b64 exec, 0xff, s56
    s_cmp_lt_u32 s51, 30000
    s_cbranch_scc1 chk_47
    s_mov_b64 exec, -1
chk_47_ok:
    s_lshr_b64 s[54:55], s[54:55], 2
    s_add_u32 s56, s56, 2
    s_add_u32 m0, s4, 18432
    s_add_u32 s59, s58, 18432
    s_mov_b64 exec, 0xffffffff
    buffer_load_dwordx4 v14, s[28:31], s59 offen lds
    s_mov_b64 exec, -1
    buffer_load_dwordx4 v14, s[28:31], s59 offen offset:512 lds
    buffer_load_dwordx4 v14, s[28:31], s59 offen offset:1536 lds
    buffer_load_dwordx4 v14, s[28:31], s59 offen offset:2560 lds
    buffer_load_dwordx4 v14, s[28:31], s59 offen offset:3584 lds
    s_waitcnt vmcnt(18)
    s_barrier
    s_add_u32 m0, s24, 32768
    s_add_u32 s25, s57, 262144
    buffer_load_dwordx4 v9, s[8:11], s25 offen offset:0 lds
    s_add_u32 s26, s57, 277504
    buffer_load_dwordx4 v10, s[8:11], s26 offen offset:1024 lds
    s_add_u32 s27, s57, 292864
    buffer_load_dwordx4 v9, s[8:11], s27 offen offset:2048 lds
    s_add_u32 s25, s57, 308224
    buffer_load_dwordx4 v10, s[8:11], s25 offen offset:3072 lds
    s_bfe_u32 s5, s6, 0x4000c
    s_mul_i32 s58, s5, 36864
    s_add_u32 s58, s58, s53
    s_and_b32 s25, s54, 3
    s_cmp_eq_u32 s25, 3
    s_cbranch_scc1 chk_48_ok
    s_mov_b32 s51, 0
chk_48:
    buffer_load_dword v3, v2, s[28:31], s50 offen sc1
    s_add_u32 s51, s51, 1
    s_mov_b64 exec, -1
    s_waitcnt vmcnt(0)
    v_cmp_ne_u32 vcc, 0, v3
    s_nop 0
    s_lshr_b64 s[54:55], vcc, s56
    s_and_b32 s25, s54, 3
    s_cmp_eq_u32 s25, 3
    s_cbranch_scc1 chk_48_ok
    s_sleep 2
    s_lshl_b64 exec, 0xff, s56
    s_cmp_lt_u32 s51, 30000
    s_cbranch_scc1 chk_48
    s_mov_b64 exec, -1
chk_48_ok:
    s_lshr_b64 s[54:55], s[54:55], 2
    s_add_u32 s56, s56, 2
    s_add_u32 m0, s4, 36864
    s_mov_b64 exec, 0xffffffff
    buffer_load_dwordx4 v14, s[28:31], s58 offen lds
    s_mov_b64 exec, -1
    buffer_load_dwordx4 v14, s[28:31], s58 offen offset:512 lds
    buffer_load_dwordx4 v14, s[28:31], s58 offen offset:1536 lds
    buffer_load_dwordx4 v14, s[28:31], s58 offen offset:2560 lds
    buffer_load_dwordx4 v14, s[28:31], s58 offen offset:3584 lds
    s_waitcnt vmcnt(18)
    s_barrier
    s_bfe_u32 s5, s6, 0x40010
    s_mul_i32 s57, s5, 524288
    s_add_u32 s57, s57, s52
    s_add_u32 m0, s24, 49152
    s_nop 0
    buffer_load_dwordx4 v9, s[8:11], s57 offen offset:0 lds
    s_add_u32 s26, s57, 15360
    buffer_load_dwordx4 v10, s[8:11], s26 offen offset:1024 lds
    s_add_u32 s27, s57, 30720
    buffer_load_dwordx4 v9, s[8:11], s27 offen offset:2048 lds
    s_add_u32 s25, s57, 46080
    buffer_load_dwordx4 v10, s[8:11], s25 offen offset:3072 lds
    s_and_b32 s25, s54, 3
    s_cmp_eq_u32 s25, 3
    s_cbranch_scc1 chk_49_ok
    s_mov_b32 s51, 0
chk_49:
    buffer_load_dword v3, v2, s[28:31], s50 offen sc1
    s_add_u32 s51, s51, 1
    s_mov_b64 exec, -1
    s_waitcnt vmcnt(0)
    v_cmp_ne_u32 vcc, 0, v3
    s_nop 0
    s_lshr_b64 s[54:55], vcc, s56
    s_and_b32 s25, s54, 3
    s_cmp_eq_u32 s25, 3
    s_cbranch_scc1 chk_49_ok
    s_sleep 2
    s_lshl_b64 exec, 0xff, s56
    s_cmp_lt_u32 s51, 30000
    s_cbranch_scc1 chk_49
    s_mov_b64 exec, -1
chk_49_ok:
    s_lshr_b64 s[54:55], s[54:55], 2
    s_add_u32 s56, s56, 2
    s_add_u32 m0, s4, 55296
    s_add_u32 s59, s58, 18432
    s_mov_b64 exec, 0xffffffff
    buffer_load_dwordx4 v14, s[28:31], s59 offen lds
    s_mov_b64 exec, -1
    buffer_load_dwordx4 v14, s[28:31], s59 offen offset:512 lds
    buffer_load_dwordx4 v14, s[28:31], s59 offen offset:1536 lds
    buffer_load_dwordx4 v14, s[28:31], s59 offen offset:2560 lds
    buffer_load_dwordx4 v14, s[28:31], s59 offen offset:3584 lds
    s_waitcnt vmcnt(18)
    s_barrier
    s_add_u32 m0, s24, 65536
    s_add_u32 s25, s57, 262144
    buffer_load_dwordx4 v9, s[8:11], s25 offen offset:0 lds
    s_add_u32 s26, s57, 277504
    buffer_load_dwordx4 v10, s[8:11], s26 offen offset:1024 lds
    s_add_u32 s27, s57, 292864
    buffer_load_dwordx4 v9, s[8:11], s27 offen offset:2048 lds
    s_add_u32 s25, s57, 308224
    buffer_load_dwordx4 v10, s[8:11], s25 offen offset:3072 lds
    s_bfe_u32 s5, s6, 0x40010
    s_mul_i32 s58, s5, 36864
    s_add_u32 s58, s58, s53
    s_and_b32 s25, s54, 3
    s_cmp_eq_u32 s25, 3
    s_cbranch_scc1 chk_50_ok
    s_mov_b32 s51, 0
chk_50:
    buffer_load_dword v3, v2, s[28:31], s50 offen sc1
    s_add_u32 s51, s51, 1
    s_mov_b64 exec, -1
    s_waitcnt vmcnt(0)
    v_cmp_ne_u32 vcc, 0, v3
    s_nop 0
    s_lshr_b64 s[54:55], vcc, s56
    s_and_b32 s25, s54, 3
    s_cmp_eq_u32 s25, 3
    s_cbranch_scc1 chk_50_ok
    s_sleep 2
    s_lshl_b64 exec, 0xff, s56
    s_cmp_lt_u32 s51, 30000
    s_cbranch_scc1 chk_50
    s_mov_b64 exec, -1
chk_50_ok:
    s_lshr_b64 s[54:55], s[54:55], 2
    s_add_u32 s56, s56, 2
    s_add_u32 m0, s4, 0
    s_mov_b64 exec, 0xffffffff
    buffer_load_dwordx4 v14, s[28:31], s58 offen lds
    s_mov_b64 exec, -1
    buffer_load_dwordx4 v14, s[28:31], s58 offen offset:512 lds
    buffer_load_dwordx4 v14, s[28:31], s58 offen offset:1536 lds
    buffer_load_dwordx4 v14, s[28:31], s58 offen offset:2560 lds
    buffer_load_dwordx4 v14, s[28:31], s58 offen offset:3584 lds
    s_waitcnt vmcnt(18)
    s_barrier
    s_bfe_u32 s5, s6, 0x40014
    s_mul_i32 s57, s5, 524288
    s_add_u32 s57, s57, s52
    s_add_u32 m0, s24, 0
    s_nop 0
    buffer_load_dwordx4 v9, s[8:11], s57 offen offset:0 lds
    s_add_u32 s26, s57, 15360
    buffer_load_dwordx4 v10, s[8:11], s26 offen offset:1024 lds
    s_add_u32 s27, s57, 30720
    buffer_load_dwordx4 v9, s[8:11], s27 offen offset:2048 lds
    s_add_u32 s25, s57, 46080
    buffer_load_dwordx4 v10, s[8:11], s25 offen offset:3072 lds
    s_and_b32 s25, s54, 3
    s_cmp_eq_u32 s25, 3
    s_cbranch_scc1 chk_51_ok
    s_mov_b32 s51, 0
chk_51:
    buffer_load_dword v3, v2, s[28:31], s50 offen sc1
    s_add_u32 s51, s51, 1
    s_mov_b64 exec, -1
    s_waitcnt vmcnt(0)
    v_cmp_ne_u32 vcc, 0, v3
    s_nop 0
    s_lshr_b64 s[54:55], vcc, s56
    s_and_b32 s25, s54, 3
    s_cmp_eq_u32 s25, 3
    s_cbranch_scc1 chk_51_ok
    s_sleep 2
    s_lshl_b64 exec, 0xff, s56
    s_cmp_lt_u32 s51, 30000
    s_cbranch_scc1 chk_51
    s_mov_b64 exec, -1
chk_51_ok:
    s_lshr_b64 s[54:55], s[54:55], 2
    s_add_u32 s56, s56, 2
    s_add_u32 m0, s4, 18432
    s_add_u32 s59, s58, 18432
    s_mov_b64 exec, 0xffffffff
    buffer_load_dwordx4 v14, s[28:31], s59 offen lds
    s_mov_b64 exec, -1
    buffer_load_dwordx4 v14, s[28:31], s59 offen offset:512 lds
    buffer_load_dwordx4 v14, s[28:31], s59 offen offset:1536 lds
    buffer_load_dwordx4 v14, s[28:31], s59 offen offset:2560 lds
    buffer_load_dwordx4 v14, s[28:31], s59 offen offset:3584 lds
    s_waitcnt vmcnt(18)
    s_barrier
    s_add_u32 m0, s24, 16384
    s_add_u32 s25, s57, 262144
    buffer_load_dwordx4 v9, s[8:11], s25 offen offset:0 lds
    s_add_u32 s26, s57, 277504
    buffer_load_dwordx4 v10, s[8:11], s26 offen offset:1024 lds
    s_add_u32 s27, s57, 292864
    buffer_load_dwordx4 v9, s[8:11], s27 offen offset:2048 lds
    s_add_u32 s25, s57, 308224
    buffer_load_dwordx4 v10, s[8:11], s25 offen offset:3072 lds
    s_bfe_u32 s5, s6, 0x40014
    s_mul_i32 s58, s5, 36864
    s_add_u32 s58, s58, s53
    s_and_b32 s25, s54, 3
    s_cmp_eq_u32 s25, 3
    s_cbranch_scc1 chk_52_ok
    s_mov_b32 s51, 0
chk_52:
    buffer_load_dword v3, v2, s[28:31], s50 offen sc1
    s_add_u32 s51, s51, 1
    s_mov_b64 exec, -1
    s_waitcnt vmcnt(0)
    v_cmp_ne_u32 vcc, 0, v3
    s_nop 0
    s_lshr_b64 s[54:55], vcc, s56
    s_and_b32 s25, s54, 3
    s_cmp_eq_u32 s25, 3
    s_cbranch_scc1 chk_52_ok
    s_sleep 2
    s_lshl_b64 exec, 0xff, s56
    s_cmp_lt_u32 s51, 30000
    s_cbranch_scc1 chk_52
    s_mov_b64 exec, -1
chk_52_ok:
    s_lshr_b64 s[54:55], s[54:55], 2
    s_add_u32 s56, s56, 2
    s_add_u32 m0, s4, 36864
    s_mov_b64 exec, 0xffffffff
    buffer_load_dwordx4 v14, s[28:31], s58 offen lds
    s_mov_b64 exec, -1
    buffer_load_dwordx4 v14, s[28:31], s58 offen offset:512 lds
    buffer_load_dwordx4 v14, s[28:31], s58 offen offset:1536 lds
    buffer_load_dwordx4 v14, s[28:31], s58 offen offset:2560 lds
    buffer_load_dwordx4 v14, s[28:31], s58 offen offset:3584 lds
    s_waitcnt vmcnt(18)
    s_barrier
    s_bfe_u32 s5, s6, 0x40018
    s_mul_i32 s57, s5, 524288
    s_add_u32 s57, s57, s52
    s_add_u32 m0, s24, 32768
    s_nop 0
    buffer_load_dwordx4 v9, s[8:11], s57 offen offset:0 lds
    s_add_u32 s26, s57, 15360
    buffer_load_dwordx4 v10, s[8:11], s26 offen offset:1024 lds
    s_add_u32 s27, s57, 30720
    buffer_load_dwordx4 v9, s[8:11], s27 offen offset:2048 lds
    s_add_u32 s25, s57, 46080
    buffer_load_dwordx4 v10, s[8:11], s25 offen offset:3072 lds
    s_and_b32 s25, s54, 3
    s_cmp_eq_u32 s25, 3
    s_cbranch_scc1 chk_53_ok
    s_mov_b32 s51, 0
chk_53:
    buffer_load_dword v3, v2, s[28:31], s50 offen sc1
    s_add_u32 s51, s51, 1
    s_mov_b64 exec, -1
    s_waitcnt vmcnt(0)
    v_cmp_ne_u32 vcc, 0, v3
    s_nop 0
    s_lshr_b64 s[54:55], vcc, s56
    s_and_b32 s25, s54, 3
    s_cmp_eq_u32 s25, 3
    s_cbranch_scc1 chk_53_ok
    s_sleep 2
    s_lshl_b64 exec, 0xff, s56
    s_cmp_lt_u32 s51, 30000
    s_cbranch_scc1 chk_53
    s_mov_b64 exec, -1
chk_53_ok:
    s_lshr_b64 s[54:55], s[54:55], 2
    s_add_u32 s56, s56, 2
    s_add_u32 m0, s4, 55296
    s_add_u32 s59, s58, 18432
    s_mov_b64 exec, 0xffffffff
    buffer_load_dwordx4 v14, s[28:31], s59 offen lds
    s_mov_b64 exec, -1
    buffer_load_dwordx4 v14, s[28:31], s59 offen offset:512 lds
    buffer_load_dwordx4 v14, s[28:31], s59 offen offset:1536 lds
    buffer_load_dwordx4 v14, s[28:31], s59 offen offset:2560 lds
    buffer_load_dwordx4 v14, s[28:31], s59 offen offset:3584 lds
    s_waitcnt vmcnt(18)
    s_barrier
    s_add_u32 m0, s24, 49152
    s_add_u32 s25, s57, 262144
    buffer_load_dwordx4 v9, s[8:11], s25 offen offset:0 lds
    s_add_u32 s26, s57, 277504
    buffer_load_dwordx4 v10, s[8:11], s26 offen offset:1024 lds
    s_add_u32 s27, s57, 292864
    buffer_load_dwordx4 v9, s[8:11], s27 offen offset:2048 lds
    s_add_u32 s25, s57, 308224
    buffer_load_dwordx4 v10, s[8:11], s25 offen offset:3072 lds
    s_bfe_u32 s5, s6, 0x40018
    s_mul_i32 s58, s5, 36864
    s_add_u32 s58, s58, s53
    s_and_b32 s25, s54, 3
    s_cmp_eq_u32 s25, 3
    s_cbranch_scc1 chk_54_ok
    s_mov_b32 s51, 0
chk_54:
    buffer_load_dword v3, v2, s[28:31], s50 offen sc1
    s_add_u32 s51, s51, 1
    s_mov_b64 exec, -1
    s_waitcnt vmcnt(0)
    v_cmp_ne_u32 vcc, 0, v3
    s_nop 0
    s_lshr_b64 s[54:55], vcc, s56
    s_and_b32 s25, s54, 3
    s_cmp_eq_u32 s25, 3
    s_cbranch_scc1 chk_54_ok
    s_sleep 2
    s_lshl_b64 exec, 0xff, s56
    s_cmp_lt_u32 s51, 30000
    s_cbranch_scc1 chk_54
    s_mov_b64 exec, -1
chk_54_ok:
    s_lshr_b64 s[54:55], s[54:55], 2
    s_add_u32 s56, s56, 2
    s_add_u32 m0, s4, 0
    s_mov_b64 exec, 0xffffffff
    buffer_load_dwordx4 v14, s[28:31], s58 offen lds
    s_mov_b64 exec, -1
    buffer_load_dwordx4 v14, s[28:31], s58 offen offset:512 lds
    buffer_load_dwordx4 v14, s[28:31], s58 offen offset:1536 lds
    buffer_load_dwordx4 v14, s[28:31], s58 offen offset:2560 lds
    buffer_load_dwordx4 v14, s[28:31], s58 offen offset:3584 lds
    s_waitcnt vmcnt(18)
    s_barrier
    s_bfe_u32 s5, s6, 0x4001c
    s_mul_i32 s57, s5, 524288
    s_add_u32 s57, s57, s52
    s_add_u32 m0, s24, 65536
    s_nop 0
    buffer_load_dwordx4 v9, s[8:11], s57 offen offset:0 lds
    s_add_u32 s26, s57, 15360
    buffer_load_dwordx4 v10, s[8:11], s26 offen offset:1024 lds
    s_add_u32 s27, s57, 30720
    buffer_load_dwordx4 v9, s[8:11], s27 offen offset:2048 lds
    s_add_u32 s25, s57, 46080
    buffer_load_dwordx4 v10, s[8:11], s25 offen offset:3072 lds
    s_and_b32 s25, s54, 3
    s_cmp_eq_u32 s25, 3
    s_cbranch_scc1 chk_55_ok
    s_mov_b32 s51, 0
chk_55:
    buffer_load_dword v3, v2, s[28:31], s50 offen sc1
    s_add_u32 s51, s51, 1
    s_mov_b64 exec, -1
    s_waitcnt vmcnt(0)
    v_cmp_ne_u32 vcc, 0, v3
    s_nop 0
    s_lshr_b64 s[54:55], vcc, s56
    s_and_b32 s25, s54, 3
    s_cmp_eq_u32 s25, 3
    s_cbranch_scc1 chk_55_ok
    s_sleep 2
    s_lshl_b64 exec, 0xff, s56
    s_cmp_lt_u32 s51, 30000
    s_cbranch_scc1 chk_55
    s_mov_b64 exec, -1
chk_55_ok:
    s_lshr_b64 s[54:55], s[54:55], 2
    s_add_u32 s56, s56, 2
    s_add_u32 m0, s4, 18432
    s_add_u32 s59, s58, 18432
    s_mov_b64 exec, 0xffffffff
    buffer_load_dwordx4 v14, s[28:31], s59 offen lds
    s_mov_b64 exec, -1
    buffer_load_dwordx4 v14, s[28:31], s59 offen offset:512 lds
    buffer_load_dwordx4 v14, s[28:31], s59 offen offset:1536 lds
    buffer_load_dwordx4 v14, s[28:31], s59 offen offset:2560 lds
    buffer_load_dwordx4 v14, s[28:31], s59 offen offset:3584 lds
    s_waitcnt vmcnt(18)
    s_barrier
    s_add_u32 m0, s24, 0
    s_add_u32 s25, s57, 262144
    buffer_load_dwordx4 v9, s[8:11], s25 offen offset:0 lds
    s_add_u32 s26, s57, 277504
    buffer_load_dwordx4 v10, s[8:11], s26 offen offset:1024 lds
    s_add_u32 s27, s57, 292864
    buffer_load_dwordx4 v9, s[8:11], s27 offen offset:2048 lds
    s_add_u32 s25, s57, 308224
    buffer_load_dwordx4 v10, s[8:11], s25 offen offset:3072 lds
    s_bfe_u32 s5, s6, 0x4001c
    s_mul_i32 s58, s5, 36864
    s_add_u32 s58, s58, s53
    s_and_b32 s25, s54, 3
    s_cmp_eq_u32 s25, 3
    s_cbranch_scc1 chk_56_ok
    s_mov_b32 s51, 0
chk_56:
    buffer_load_dword v3, v2, s[28:31], s50 offen sc1
    s_add_u32 s51, s51, 1
    s_mov_b64 exec, -1
    s_waitcnt vmcnt(0)
    v_cmp_ne_u32 vcc, 0, v3
    s_nop 0
    s_lshr_b64 s[54:55], vcc, s56
    s_and_b32 s25, s54, 3
    s_cmp_eq_u32 s25, 3
    s_cbranch_scc1 chk_56_ok
    s_sleep 2
    s_lshl_b64 exec, 0xff, s56
    s_cmp_lt_u32 s51, 30000
    s_cbranch_scc1 chk_56
    s_mov_b64 exec, -1
chk_56_ok:
    s_lshr_b64 s[54:55], s[54:55], 2
    s_add_u32 s56, s56, 2
    s_add_u32 m0, s4, 36864
    s_mov_b64 exec, 0xffffffff
    buffer_load_dwordx4 v14, s[28:31], s58 offen lds
    s_mov_b64 exec, -1
    buffer_load_dwordx4 v14, s[28:31], s58 offen offset:512 lds
    buffer_load_dwordx4 v14, s[28:31], s58 offen offset:1536 lds
    buffer_load_dwordx4 v14, s[28:31], s58 offen offset:2560 lds
    buffer_load_dwordx4 v14, s[28:31], s58 offen offset:3584 lds
    s_waitcnt vmcnt(18)
    s_barrier
    s_bfe_u32 s5, s7, 0x40000
    s_mul_i32 s57, s5, 524288
    s_add_u32 s57, s57, s52
    s_add_u32 m0, s24, 16384
    s_nop 0
    buffer_load_dwordx4 v9, s[8:11], s57 offen offset:0 lds
    s_add_u32 s26, s57, 15360
    buffer_load_dwordx4 v10, s[8:11], s26 offen offset:1024 lds
    s_add_u32 s27, s57, 30720
    buffer_load_dwordx4 v9, s[8:11], s27 offen offset:2048 lds
    s_add_u32 s25, s57, 46080
    buffer_load_dwordx4 v10, s[8:11], s25 offen offset:3072 lds
    s_and_b32 s25, s54, 3
    s_cmp_eq_u32 s25, 3
    s_cbranch_scc1 chk_57_ok
    s_mov_b32 s51, 0
chk_57:
    buffer_load_dword v3, v2, s[28:31], s50 offen sc1
    s_add_u32 s51, s51, 1
    s_mov_b64 exec, -1
    s_waitcnt vmcnt(0)
    v_cmp_ne_u32 vcc, 0, v3
    s_nop 0
    s_lshr_b64 s[54:55], vcc, s56
    s_and_b32 s25, s54, 3
    s_cmp_eq_u32 s25, 3
    s_cbranch_scc1 chk_57_ok
    s_sleep 2
    s_lshl_b64 exec, 0xff, s56
    s_cmp_lt_u32 s51, 30000
    s_cbranch_scc1 chk_57
    s_mov_b64 exec, -1
chk_57_ok:
    s_lshr_b64 s[54:55], s[54:55], 2
    s_add_u32 s56, s56, 2
    s_add_u32 m0, s4, 55296
    s_add_u32 s59, s58, 18432
    s_mov_b64 exec, 0xffffffff
    buffer_load_dwordx4 v14, s[28:31], s59 offen lds
    s_mov_b64 exec, -1
    buffer_load_dwordx4 v14, s[28:31], s59 offen offset:512 lds
    buffer_load_dwordx4 v14, s[28:31], s59 offen offset:1536 lds
    buffer_load_dwordx4 v14, s[28:31], s59 offen offset:2560 lds
    buffer_load_dwordx4 v14, s[28:31], s59 offen offset:3584 lds
    s_waitcnt vmcnt(18)
    s_barrier
    s_add_u32 m0, s24, 32768
    s_add_u32 s25, s57, 262144
    buffer_load_dwordx4 v9, s[8:11], s25 offen offset:0 lds
    s_add_u32 s26, s57, 277504
    buffer_load_dwordx4 v10, s[8:11], s26 offen offset:1024 lds
    s_add_u32 s27, s57, 292864
    buffer_load_dwordx4 v9, s[8:11], s27 offen offset:2048 lds
    s_add_u32 s25, s57, 308224
    buffer_load_dwordx4 v10, s[8:11], s25 offen offset:3072 lds
    s_bfe_u32 s5, s7, 0x40000
    s_mul_i32 s58, s5, 36864
    s_add_u32 s58, s58, s53
    s_and_b32 s25, s54, 3
    s_cmp_eq_u32 s25, 3
    s_cbranch_scc1 chk_58_ok
    s_mov_b32 s51, 0
chk_58:
    buffer_load_dword v3, v2, s[28:31], s50 offen sc1
    s_add_u32 s51, s51, 1
    s_mov_b64 exec, -1
    s_waitcnt vmcnt(0)
    v_cmp_ne_u32 vcc, 0, v3
    s_nop 0
    s_lshr_b64 s[54:55], vcc, s56
    s_and_b32 s25, s54, 3
    s_cmp_eq_u32 s25, 3
    s_cbranch_scc1 chk_58_ok
    s_sleep 2
    s_lshl_b64 exec, 0xff, s56
    s_cmp_lt_u32 s51, 30000
    s_cbranch_scc1 chk_58
    s_mov_b64 exec, -1
chk_58_ok:
    s_lshr_b64 s[54:55], s[54:55], 2
    s_add_u32 s56, s56, 2
    s_add_u32 m0, s4, 0
    s_mov_b64 exec, 0xffffffff
    buffer_load_dwordx4 v14, s[28:31], s58 offen lds
    s_mov_b64 exec, -1
    buffer_load_dwordx4 v14, s[28:31], s58 offen offset:512 lds
    buffer_load_dwordx4 v14, s[28:31], s58 offen offset:1536 lds
    buffer_load_dwordx4 v14, s[28:31], s58 offen offset:2560 lds
    buffer_load_dwordx4 v14, s[28:31], s58 offen offset:3584 lds
    s_waitcnt vmcnt(18)
    s_barrier
    s_and_b32 s25, s54, 3
    s_cmp_eq_u32 s25, 3
    s_cbranch_scc1 chk_59_ok
    s_mov_b32 s51, 0
chk_59:
    buffer_load_dword v3, v2, s[28:31], s50 offen sc1
    s_add_u32 s51, s51, 1
    s_mov_b64 exec, -1
    s_waitcnt vmcnt(0)
    v_cmp_ne_u32 vcc, 0, v3
    s_nop 0
    s_lshr_b64 s[54:55], vcc, s56
    s_and_b32 s25, s54, 3
    s_cmp_eq_u32 s25, 3
    s_cbranch_scc1 chk_59_ok
    s_sleep 2
    s_lshl_b64 exec, 0xff, s56
    s_cmp_lt_u32 s51, 30000
    s_cbranch_scc1 chk_59
    s_mov_b64 exec, -1
chk_59_ok:
    s_lshr_b64 s[54:55], s[54:55], 2
    s_add_u32 s56, s56, 2
    s_add_u32 m0, s4, 18432
    s_add_u32 s59, s58, 18432
    s_mov_b64 exec, 0xffffffff
    buffer_load_dwordx4 v14, s[28:31], s59 offen lds
    s_mov_b64 exec, -1
    buffer_load_dwordx4 v14, s[28:31], s59 offen offset:512 lds
    buffer_load_dwordx4 v14, s[28:31], s59 offen offset:1536 lds
    buffer_load_dwordx4 v14, s[28:31], s59 offen offset:2560 lds
    buffer_load_dwordx4 v14, s[28:31], s59 offen offset:3584 lds
    s_waitcnt vmcnt(14)
    s_barrier
    s_waitcnt vmcnt(5)
    s_barrier
    s_waitcnt vmcnt(0)
    s_barrier
    s_branch t_end
t_spare:
    s_sub_u32 s50, s37, 27
    s_lshl_b32 s50, s50, 3
    s_add_u32 s50, s50, s3
    s_add_u32 s58, s50, 261
    s_mul_i32 s58, s58, 55296
    s_add_u32 s58, s58, s57
    s_cmp_lt_u32 s50, 80
    s_cbranch_scc0 t4_60
    buffer_load_dword v8, v17, s[32:35], s58 offen
t4_60:
    s_add_u32 s58, s58, 2211840
    s_cmp_lt_u32 s50, 40
    s_cbranch_scc0 t4_61
    buffer_load_dword v8, v17, s[32:35], s58 offen
t4_61:
    s_add_u32 s58, s58, 2211840
    s_sleep 16
    s_sleep 16
    s_sleep 16
    s_sleep 16
    s_waitcnt vmcnt(0)
    s_lshr_b32 s44, s36, 1
    s_mov_b32 s6, 0x18764320
    s_mov_b32 s7, 5
    s_cmp_eq_u32 s44, 1
    s_cselect_b32 s6, 0x40765321, s6
    s_cselect_b32 s7, 8, s7
    s_cmp_eq_u32 s44, 2
    s_cselect_b32 s6, 0x38654210, s6
    s_cselect_b32 s7, 7, s7
    s_cmp_eq_u32 s44, 3
    s_cselect_b32 s6, 0x28754310, s6
    s_cselect_b32 s7, 6, s7
    s_and_b32 s51, s36, 1
    s_lshl_b32 s51, s51, 11
    s_mul_i32 s52, s44, 4718592
    s_add_u32 s51, s51, s52
    s_add_u32 s52, 0, s50
    v_lshrrev_b32 v2, 4, v1
    v_lshlrev_b32 v2, 12, v2
    v_and_b32 v3, 15, v1
    v_lshl_add_u32 v2, v3, 7, v2
    s_lshr_b32 s53, s52, 5
    s_lshl_b32 s53, s53, 2
    s_lshr_b64 s[54:55], s[6:7], s53
    s_and_b32 s54, s54, 15
    s_lshl_b32 s54, s54, 5
    s_and_b32 s53, s52, 31
    s_add_u32 s54, s54, s53
    s_lshl_b32 s54, s54, 14
    s_add_u32 s54, s54, s51
    buffer_load_dword v4, v2, s[8:11], s54 offen
    s_add_u32 s52, s52, 40
    s_lshr_b32 s53, s52, 5
    s_lshl_b32 s53, s53, 2
    s_lshr_b64 s[54:55], s[6:7], s53
    s_and_b32 s54, s54, 15
    s_lshl_b32 s54, s54, 5
    s_and_b32 s53, s52, 31
    s_add_u32 s54, s54, s53
    s_lshl_b32 s54, s54, 14
    s_add_u32 s54, s54, s51
    s_waitcnt vmcnt(0)
    buffer_load_dword v4, v2, s[8:11], s54 offen
    s_add_u32 s52, s52, 40
    s_lshr_b32 s53, s52, 5
    s_lshl_b32 s53, s53, 2
    s_lshr_b64 s[54:55], s[6:7], s53
    s_and_b32 s54, s54, 15
    s_lshl_b32 s54, s54, 5
    s_and_b32 s53, s52, 31
    s_add_u32 s54, s54, s53
    s_lshl_b32 s54, s54, 14
    s_add_u32 s54, s54, s51
    s_waitcnt vmcnt(0)
    buffer_load_dword v4, v2, s[8:11], s54 offen
    s_add_u32 s52, s52, 40
    s_lshr_b32 s53, s52, 5
    s_lshl_b32 s53, s53, 2
    s_lshr_b64 s[54:55], s[6:7], s53
    s_and_b32 s54, s54, 15
    s_lshl_b32 s54, s54, 5
    s_and_b32 s53, s52, 31
    s_add_u32 s54, s54, s53
    s_lshl_b32 s54, s54, 14
    s_add_u32 s54, s54, s51
    s_waitcnt vmcnt(0)
    buffer_load_dword v4, v2, s[8:11], s54 offen
    s_add_u32 s52, s52, 40
    s_lshr_b32 s53, s52, 5
    s_lshl_b32 s53, s53, 2
    s_lshr_b64 s[54:55], s[6:7], s53
    s_and_b32 s54, s54, 15
    s_lshl_b32 s54, s54, 5
    s_and_b32 s53, s52, 31
    s_add_u32 s54, s54, s53
    s_lshl_b32 s54, s54, 14
    s_add_u32 s54, s54, s51
    s_waitcnt vmcnt(0)
    buffer_load_dword v4, v2, s[8:11], s54 offen
    s_add_u32 s52, s52, 40
    s_lshr_b32 s53, s52, 5
    s_lshl_b32 s53, s53, 2
    s_lshr_b64 s[54:55], s[6:7], s53
    s_and_b32 s54, s54, 15
    s_lshl_b32 s54, s54, 5
    s_and_b32 s53, s52, 31
    s_add_u32 s54, s54, s53
    s_lshl_b32 s54, s54, 14
    s_add_u32 s54, s54, s51
    s_waitcnt vmcnt(0)
    buffer_load_dword v4, v2, s[8:11], s54 offen
    s_add_u32 s52, s52, 40
    s_lshr_b32 s53, s52, 5
    s_lshl_b32 s53, s53, 2
    s_lshr_b64 s[54:55], s[6:7], s53
    s_and_b32 s54, s54, 15
    s_lshl_b32 s54, s54, 5
    s_and_b32 s53, s52, 31
    s_add_u32 s54, s54, s53
    s_lshl_b32 s54, s54, 14
    s_add_u32 s54, s54, s51
    s_waitcnt vmcnt(0)
    buffer_load_dword v4, v2, s[8:11], s54 offen
    s_add_u32 s52, s52, 40
    s_cmp_lt_u32 s50, 8
    s_cbranch_scc0 pfskip_62
    s_lshr_b32 s53, s52, 5
    s_lshl_b32 s53, s53, 2
    s_lshr_b64 s[54:55], s[6:7], s53
    s_and_b32 s54, s54, 15
    s_lshl_b32 s54, s54, 5
    s_and_b32 s53, s52, 31
    s_add_u32 s54, s54, s53
    s_lshl_b32 s54, s54, 14
    s_add_u32 s54, s54, s51
    s_waitcnt vmcnt(0)
    buffer_load_dword v4, v2, s[8:11], s54 offen
pfskip_62:
    s_waitcnt vmcnt(0)
    s_cmp_lt_u32 s3, 4
    s_cbranch_scc1 t_cons2
    s_branch t_ld2
t_cons:
    s_and_b32 s46, s3, 1
    s_lshr_b32 s47, s3, 1
    s_lshl_b32 s48, s46, 7
    s_lshl_b32 s49, s62, 8
    s_add_u32 s48, s48, s49
    v_lshlrev_b32 v7, 3, v6
    buffer_load_dwordx2 v[24:25], v7, s[20:23], s48 offen offset:0
    buffer_load_dwordx2 v[26:27], v7, s[20:23], s48 offen offset:32
    buffer_load_dwordx2 v[28:29], v7, s[20:23], s48 offen offset:64
    buffer_load_dwordx2 v[30:31], v7, s[20:23], s48 offen offset:96
    s_lshl_b32 s40, s46, 2
    s_add_u32 s40, s40, 0
    s_lshl_b32 s41, s46, 2
    s_add_u32 s41, s41, 1
    s_lshl_b32 s42, s46, 2
    s_add_u32 s42, s42, 2
    s_lshl_b32 s43, s46, 2
    s_add_u32 s43, s43, 3
    v_lshrrev_b32 v2, 2, v5
    v_and_b32 v3, 1, v6
    v_lshl_add_u32 v3, v3, 2, v2
    v_mad_u32_u24 v2, v6, 8, v2
    v_lshlrev_b32 v2, 8, v2
    v_and_b32 v4, 3, v1
    v_lshl_add_u32 v2, v4, 3, v2
    v_xor_b32 v4, s40, v3
    v_lshl_add_u32 v8, v4, 5, v2
    v_xor_b32 v4, s41, v3
    v_lshl_add_u32 v9, v4, 5, v2
    v_xor_b32 v4, s42, v3
    v_lshl_add_u32 v10, v4, 5, v2
    v_xor_b32 v4, s43, v3
    v_lshl_add_u32 v11, v4, 5, v2
    v_mul_u32_u24 v2, 1536, v6
    v_lshl_add_u32 v2, v5, 4, v2
    s_mul_i32 s48, s47, 768
    v_add_u32 v12, s48, v2
    s_mul_i32 s48, s63, 6
    s_mul_i32 s49, s47, 3
    s_add_u32 s48, s48, s49
    s_lshl_b32 s49, s62, 2
    s_lshl_b32 s50, s46, 1
    s_add_u32 s49, s49, s50
    s_mul_i32 s49, s49, 9
    s_add_u32 s50, s48, 0
    s_mul_i32 s51, s50, 57
    s_lshr_b32 s51, s51, 9
    s_mul_i32 s51, s51, 1287
    s_add_u32 s50, s50, s51
    s_add_u32 s50, s50, s49
    s_lshl_b32 s50, s50, 10
    s_add_u32 s52, s50, 16777216
    s_add_u32 s55, s50, 16786432
    s_add_u32 s50, s48, 1
    s_mul_i32 s51, s50, 57
    s_lshr_b32 s51, s51, 9
    s_mul_i32 s51, s51, 1287
    s_add_u32 s50, s50, s51
    s_add_u32 s50, s50, s49
    s_lshl_b32 s50, s50, 10
    s_add_u32 s53, s50, 16777216
    s_add_u32 s56, s50, 16786432
    s_add_u32 s50, s48, 2
    s_mul_i32 s51, s50, 57
    s_lshr_b32 s51, s51, 9
    s_mul_i32 s51, s51, 1287
    s_add_u32 s50, s50, s51
    s_add_u32 s50, s50, s49
    s_lshl_b32 s50, s50, 10
    s_add_u32 s54, s50, 16777216
    s_add_u32 s57, s50, 16786432
    s_mul_i32 s58, s62, 6
    s_add_u32 s58, s58, s63
    s_lshl_b32 s58, s58, 3
    s_add_u32 s58, s58, s3
    s_lshl_b32 s58, s58, 7
    s_add_u32 s58, s58, 262528
    v_mov_b32 v88, 0
    v_mov_b32 v89, 0
    v_mov_b32 v90, 0
    v_mov_b32 v91, 0
    v_mov_b32 v92, 0
    v_mov_b32 v93, 0
    v_mov_b32 v94, 0
    v_mov_b32 v95, 0
    v_mov_b32 v96, 0
    v_mov_b32 v97, 0
    v_mov_b32 v98, 0
    v_mov_b32 v99, 0
    v_mov_b32 v100, 0
    v_mov_b32 v101, 0
    v_mov_b32 v102, 0
    v_mov_b32 v103, 0
    v_mov_b32 v104, 0
    v_mov_b32 v105, 0
    v_mov_b32 v106, 0
    v_mov_b32 v107, 0
    v_mov_b32 v108, 0
    v_mov_b32 v109, 0
    v_mov_b32 v110, 0
    v_mov_b32 v111, 0
    v_mov_b32 v112, 0
    v_mov_b32 v113, 0
    v_mov_b32 v114, 0
    v_mov_b32 v115, 0
    v_mov_b32 v116, 0
    v_mov_b32 v117, 0
    v_mov_b32 v118, 0
    v_mov_b32 v119, 0
    v_mov_b32 v120, 0
    v_mov_b32 v121, 0
    v_mov_b32 v122, 0
    v_mov_b32 v123, 0
    v_mov_b32 v124, 0
    v_mov_b32 v125, 0
    v_mov_b32 v126, 0
    v_mov_b32 v127, 0
    v_mov_b32 v128, 0
    v_mov_b32 v129, 0
    v_mov_b32 v130, 0
    v_mov_b32 v131, 0
    v_mov_b32 v132, 0
    v_mov_b32 v133, 0
    v_mov_b32 v134, 0
    v_mov_b32 v135, 0
    s_mov_b32 s24, 65536
    s_mov_b32 s4, 12288
    v_add_u32 v16, s24, v8
    v_add_u32 v17, s24, v9
    v_add_u32 v18, s24, v10
    v_add_u32 v19, s24, v11
    v_add_u32 v20, s4, v12
    s_movk_i32 s59, 31
    s_barrier
    ds_read_b128 v[48:51], v20 offset:0
    ds_read_b64_tr_b16 v[32:33], v16 offset:0
    ds_read_b64_tr_b16 v[34:35], v16 offset:1024
    ds_read_b64_tr_b16 v[36:37], v17 offset:0
    ds_read_b64_tr_b16 v[38:39], v17 offset:1024
    ds_read_b64_tr_b16 v[40:41], v18 offset:0
    ds_read_b64_tr_b16 v[42:43], v18 offset:1024
    ds_read_b64_tr_b16 v[44:45], v19 offset:0
    ds_read_b64_tr_b16 v[46:47], v19 offset:1024
    ds_read_b128 v[52:55], v20 offset:256
    ds_read_b128 v[56:59], v20 offset:512
    s_add_u32 s24, s24, 16384
    s_add_u32 s4, s4, 12288
    s_cmp_eq_u32 s24, 163840
    s_cselect_b32 s24, 65536, s24
    s_cmp_eq_u32 s4, 61440
    s_cselect_b32 s4, 0, s4
g1_mm_loop:
    s_waitcnt lgkmcnt(0)
    v_mfma_f32_16x16x32_bf16 v[88:91], v[32:35], v[48:51], v[88:91]
    ds_read_b128 v[76:79], v20 offset:6144
    ds_read_b64_tr_b16 v[60:61], v16 offset:8192
    v_mfma_f32_16x16x32_bf16 v[100:103], v[36:39], v[48:51], v[100:103]
    ds_read_b64_tr_b16 v[62:63], v16 offset:9216
    ds_read_b64_tr_b16 v[64:65], v17 offset:8192
    v_mfma_f32_16x16x32_bf16 v[112:115], v[40:43], v[48:51], v[112:115]
    ds_read_b64_tr_b16 v[66:67], v17 offset:9216
    ds_read_b64_tr_b16 v[68:69], v18 offset:8192
    v_mfma_f32_16x16x32_bf16 v[124:127], v[44:47], v[48:51], v[124:127]
    ds_read_b64_tr_b16 v[70:71], v18 offset:9216
    ds_read_b64_tr_b16 v[72:73], v19 offset:8192
    v_mfma_f32_16x16x32_bf16 v[128:131], v[44:47], v[52:55], v[128:131]
    ds_read_b64_tr_b16 v[74:75], v19 offset:9216
    ds_read_b128 v[80:83], v20 offset:6400
    v_mfma_f32_16x16x32_bf16 v[116:119], v[40:43], v[52:55], v[116:119]
    ds_read_b128 v[84:87], v20 offset:6656
    v_add_u32 v16, s24, v8
    v_mfma_f32_16x16x32_bf16 v[104:107], v[36:39], v[52:55], v[104:107]
    v_add_u32 v17, s24, v9
    v_add_u32 v18, s24, v10
    v_mfma_f32_16x16x32_bf16 v[92:95], v[32:35], v[52:55], v[92:95]
    v_add_u32 v19, s24, v11
    v_add_u32 v20, s4, v12
    v_mfma_f32_16x16x32_bf16 v[96:99], v[32:35], v[56:59], v[96:99]
    v_mfma_f32_16x16x32_bf16 v[108:111], v[36:39], v[56:59], v[108:111]
    s_waitcnt lgkmcnt(0)
    s_barrier
    v_mfma_f32_16x16x32_bf16 v[120:123], v[40:43], v[56:59], v[120:123]
    v_mfma_f32_16x16x32_bf16 v[132:135], v[44:47], v[56:59], v[132:135]
    v_mfma_f32_16x16x32_bf16 v[88:91], v[60:63], v[76:79], v[88:91]
    ds_read_b128 v[48:51], v20 offset:0
    ds_read_b64_tr_b16 v[32:33], v16 offset:0
    v_mfma_f32_16x16x32_bf16 v[100:103], v[64:67], v[76:79], v[100:103]
    ds_read_b64_tr_b16 v[34:35], v16 offset:1024
    ds_read_b64_tr_b16 v[36:37], v17 offset:0
    v_mfma_f32_16x16x32_bf16 v[112:115], v[68:71], v[76:79], v[112:115]
    ds_read_b64_tr_b16 v[38:39], v17 offset:1024
    ds_read_b64_tr_b16 v[40:41], v18 offset:0
    v_mfma_f32_16x16x32_bf16 v[124:127], v[72:75], v[76:79], v[124:127]
    ds_read_b64_tr_b16 v[42:43], v18 offset:1024
    ds_read_b64_tr_b16 v[44:45], v19 offset:0
    v_mfma_f32_16x16x32_bf16 v[128:131], v[72:75], v[80:83], v[128:131]
    ds_read_b64_tr_b16 v[46:47], v19 offset:1024
    ds_read_b128 v[52:55], v20 offset:256
    v_mfma_f32_16x16x32_bf16 v[116:119], v[68:71], v[80:83], v[116:119]
    ds_read_b128 v[56:59], v20 offset:512
    s_add_u32 s24, s24, 16384
    v_mfma_f32_16x16x32_bf16 v[104:107], v[64:67], v[80:83], v[104:107]
    s_add_u32 s4, s4, 12288
    s_cmp_eq_u32 s24, 163840
    v_mfma_f32_16x16x32_bf16 v[92:95], v[60:63], v[80:83], v[92:95]
    s_cselect_b32 s24, 65536, s24
    s_cmp_eq_u32 s4, 61440
    v_mfma_f32_16x16x32_bf16 v[96:99], v[60:63], v[84:87], v[96:99]
    s_cselect_b32 s4, 0, s4
    s_sub_u32 s59, s59, 1
    v_mfma_f32_16x16x32_bf16 v[108:111], v[64:67], v[84:87], v[108:111]
    s_cmp_lg_u32 s59, 0
    v_mfma_f32_16x16x32_bf16 v[120:123], v[68:71], v[84:87], v[120:123]
    v_mfma_f32_16x16x32_bf16 v[132:135], v[72:75], v[84:87], v[132:135]
    s_cbranch_scc1 g1_mm_loop
    s_waitcnt lgkmcnt(0)
    v_mfma_f32_16x16x32_bf16 v[88:91], v[32:35], v[48:51], v[88:91]
    ds_read_b128 v[76:79], v20 offset:6144
    ds_read_b64_tr_b16 v[60:61], v16 offset:8192
    v_mfma_f32_16x16x32_bf16 v[100:103], v[36:39], v[48:51], v[100:103]
    ds_read_b64_tr_b16 v[62:63], v16 offset:9216
    ds_read_b64_tr_b16 v[64:65], v17 offset:8192
    v_mfma_f32_16x16x32_bf16 v[112:115], v[40:43], v[48:51], v[112:115]
    ds_read_b64_tr_b16 v[66:67], v17 offset:9216
    ds_read_b64_tr_b16 v[68:69], v18 offset:8192
    v_mfma_f32_16x16x32_bf16 v[124:127], v[44:47], v[48:51], v[124:127]
    ds_read_b64_tr_b16 v[70:71], v18 offset:9216
    ds_read_b64_tr_b16 v[72:73], v19 offset:8192
    v_mfma_f32_16x16x32_bf16 v[128:131], v[44:47], v[52:55], v[128:131]
    ds_read_b64_tr_b16 v[74:75], v19 offset:9216
    ds_read_b128 v[80:83], v20 offset:6400
    v_mfma_f32_16x16x32_bf16 v[116:119], v[40:43], v[52:55], v[116:119]
    ds_read_b128 v[84:87], v20 offset:6656
    v_mfma_f32_16x16x32_bf16 v[104:107], v[36:39], v[52:55], v[104:107]
    v_mfma_f32_16x16x32_bf16 v[92:95], v[32:35], v[52:55], v[92:95]
    v_mfma_f32_16x16x32_bf16 v[96:99], v[32:35], v[56:59], v[96:99]
    v_mfma_f32_16x16x32_bf16 v[108:111], v[36:39], v[56:59], v[108:111]
    v_mfma_f32_16x16x32_bf16 v[120:123], v[40:43], v[56:59], v[120:123]
    v_mfma_f32_16x16x32_bf16 v[132:135], v[44:47], v[56:59], v[132:135]
    s_waitcnt lgkmcnt(0)
    s_barrier
    v_mfma_f32_16x16x32_bf16 v[88:91], v[60:63], v[76:79], v[88:91]
    v_mfma_f32_16x16x32_bf16 v[100:103], v[64:67], v[76:79], v[100:103]
    v_mfma_f32_16x16x32_bf16 v[112:115], v[68:71], v[76:79], v[112:115]
    v_mfma_f32_16x16x32_bf16 v[124:127], v[72:75], v[76:79], v[124:127]
    v_mfma_f32_16x16x32_bf16 v[128:131], v[72:75], v[80:83], v[128:131]
    v_mfma_f32_16x16x32_bf16 v[116:119], v[68:71], v[80:83], v[116:119]
    v_mfma_f32_16x16x32_bf16 v[104:107], v[64:67], v[80:83], v[104:107]
    v_mfma_f32_16x16x32_bf16 v[92:95], v[60:63], v[80:83], v[92:95]
    v_mfma_f32_16x16x32_bf16 v[96:99], v[60:63], v[84:87], v[96:99]
    v_mfma_f32_16x16x32_bf16 v[108:111], v[64:67], v[84:87], v[108:111]
    v_mfma_f32_16x16x32_bf16 v[120:123], v[68:71], v[84:87], v[120:123]
    v_mfma_f32_16x16x32_bf16 v[132:135], v[72:75], v[84:87], v[132:135]
    s_mov_b32 s42, 0xffff0000
    s_waitcnt vmcnt(0)
    v_lshlrev_b32 v32, 16, v24
    v_and_b32 v33, s42, v24
    v_lshlrev_b32 v34, 16, v25
    v_and_b32 v35, s42, v25
    v_lshlrev_b32 v36, 16, v26
    v_and_b32 v37, s42, v26
    v_lshlrev_b32 v38, 16, v27
    v_and_b32 v39, s42, v27
    v_lshlrev_b32 v40, 16, v28
    v_and_b32 v41, s42, v28
    v_lshlrev_b32 v42, 16, v29
    v_and_b32 v43, s42, v29
    v_lshlrev_b32 v44, 16, v30
    v_and_b32 v45, s42, v30
    v_lshlrev_b32 v46, 16, v31
    v_and_b32 v47, s42, v31
    v_mov_b32 v80, 0xc0135761
    v_mov_b32 v81, 0xc0135761
    v_mov_b32 v82, 0xbdd2d3e8
    v_mov_b32 v83, 0xbdd2d3e8
    v_mov_b32 v84, 0x3f800000
    v_mov_b32 v85, 0x3f800000
    v_pk_add_f32 v[88:89], v[88:89], v[32:33]
    v_pk_add_f32 v[90:91], v[90:91], v[34:35]
    v_pk_add_f32 v[100:101], v[100:101], v[36:37]
    v_pk_add_f32 v[102:103], v[102:103], v[38:39]
    v_pk_mul_f32 v[60:61], v[88:89], v[88:89]
    v_pk_mul_f32 v[62:63], v[90:91], v[90:91]
    v_pk_mul_f32 v[64:65], v[100:101], v[100:101]
    v_pk_mul_f32 v[66:67], v[102:103], v[102:103]
    v_pk_fma_f32 v[60:61], v[60:61], v[82:83], v[80:81]
    v_pk_fma_f32 v[62:63], v[62:63], v[82:83], v[80:81]
    v_pk_fma_f32 v[64:65], v[64:65], v[82:83], v[80:81]
    v_pk_fma_f32 v[66:67], v[66:67], v[82:83], v[80:81]
    v_pk_mul_f32 v[60:61], v[60:61], v[88:89]
    v_pk_mul_f32 v[62:63], v[62:63], v[90:91]
    v_pk_mul_f32 v[64:65], v[64:65], v[100:101]
    v_pk_mul_f32 v[66:67], v[66:67], v[102:103]
    v_exp_f32 v60, v60
    v_exp_f32 v61, v61
    v_exp_f32 v62, v62
    v_exp_f32 v63, v63
    v_exp_f32 v64, v64
    v_exp_f32 v65, v65
    v_exp_f32 v66, v66
    v_exp_f32 v67, v67
    v_pk_add_f32 v[60:61], v[60:61], v[84:85]
    v_pk_add_f32 v[62:63], v[62:63], v[84:85]
    v_pk_add_f32 v[64:65], v[64:65], v[84:85]
    v_pk_add_f32 v[66:67], v[66:67], v[84:85]
    v_rcp_f32 v60, v60
    v_rcp_f32 v61, v61
    v_rcp_f32 v62, v62
    v_rcp_f32 v63, v63
    v_rcp_f32 v64, v64
    v_rcp_f32 v65, v65
    v_rcp_f32 v66, v66
    v_rcp_f32 v67, v67
    v_pk_mul_f32 v[88:89], v[88:89], v[60:61]
    v_pk_mul_f32 v[90:91], v[90:91], v[62:63]
    v_pk_mul_f32 v[100:101], v[100:101], v[64:65]
    v_pk_mul_f32 v[102:103], v[102:103], v[66:67]
    v_cvt_pk_bf16_f32 v72, v88, v89
    v_cvt_pk_bf16_f32 v73, v90, v91
    v_cvt_pk_bf16_f32 v74, v100, v101
    v_cvt_pk_bf16_f32 v75, v102, v103
    buffer_store_dwordx4 v[72:75], v14, s[28:31], s52 offen sc1
    v_pk_add_f32 v[112:113], v[112:113], v[40:41]
    v_pk_add_f32 v[114:115], v[114:115], v[42:43]
    v_pk_add_f32 v[124:125], v[124:125], v[44:45]
    v_pk_add_f32 v[126:127], v[126:127], v[46:47]
    v_pk_mul_f32 v[60:61], v[112:113], v[112:113]
    v_pk_mul_f32 v[62:63], v[114:115], v[114:115]
    v_pk_mul_f32 v[64:65], v[124:125], v[124:125]
    v_pk_mul_f32 v[66:67], v[126:127], v[126:127]
    v_pk_fma_f32 v[60:61], v[60:61], v[82:83], v[80:81]
    v_pk_fma_f32 v[62:63], v[62:63], v[82:83], v[80:81]
    v_pk_fma_f32 v[64:65], v[64:65], v[82:83], v[80:81]
    v_pk_fma_f32 v[66:67], v[66:67], v[82:83], v[80:81]
    v_pk_mul_f32 v[60:61], v[60:61], v[112:113]
    v_pk_mul_f32 v[62:63], v[62:63], v[114:115]
    v_pk_mul_f32 v[64:65], v[64:65], v[124:125]
    v_pk_mul_f32 v[66:67], v[66:67], v[126:127]
    v_exp_f32 v60, v60
    v_exp_f32 v61, v61
    v_exp_f32 v62, v62
    v_exp_f32 v63, v63
    v_exp_f32 v64, v64
    v_exp_f32 v65, v65
    v_exp_f32 v66, v66
    v_exp_f32 v67, v67
    v_pk_add_f32 v[60:61], v[60:61], v[84:85]
    v_pk_add_f32 v[62:63], v[62:63], v[84:85]
    v_pk_add_f32 v[64:65], v[64:65], v[84:85]
    v_pk_add_f32 v[66:67], v[66:67], v[84:85]
    v_rcp_f32 v60, v60
    v_rcp_f32 v61, v61
    v_rcp_f32 v62, v62
    v_rcp_f32 v63, v63
    v_rcp_f32 v64, v64
    v_rcp_f32 v65, v65
    v_rcp_f32 v66, v66
    v_rcp_f32 v67, v67
    v_pk_mul_f32 v[112:113], v[112:113], v[60:61]
    v_pk_mul_f32 v[114:115], v[114:115], v[62:63]
    v_pk_mul_f32 v[124:125], v[124:125], v[64:65]
    v_pk_mul_f32 v[126:127], v[126:127], v[66:67]
    v_cvt_pk_bf16_f32 v76, v112, v113
    v_cvt_pk_bf16_f32 v77, v114, v115
    v_cvt_pk_bf16_f32 v78, v124, v125
    v_cvt_pk_bf16_f32 v79, v126, v127
    buffer_store_dwordx4 v[76:79], v14, s[28:31], s55 offen sc1
    v_pk_add_f32 v[92:93], v[92:93], v[32:33]
    v_pk_add_f32 v[94:95], v[94:95], v[34:35]
    v_pk_add_f32 v[104:105], v[104:105], v[36:37]
    v_pk_add_f32 v[106:107], v[106:107], v[38:39]
    v_pk_mul_f32 v[60:61], v[92:93], v[92:93]
    v_pk_mul_f32 v[62:63], v[94:95], v[94:95]
    v_pk_mul_f32 v[64:65], v[104:105], v[104:105]
    v_pk_mul_f32 v[66:67], v[106:107], v[106:107]
    v_pk_fma_f32 v[60:61], v[60:61], v[82:83], v[80:81]
    v_pk_fma_f32 v[62:63], v[62:63], v[82:83], v[80:81]
    v_pk_fma_f32 v[64:65], v[64:65], v[82:83], v[80:81]
    v_pk_fma_f32 v[66:67], v[66:67], v[82:83], v[80:81]
    v_pk_mul_f32 v[60:61], v[60:61], v[92:93]
    v_pk_mul_f32 v[62:63], v[62:63], v[94:95]
    v_pk_mul_f32 v[64:65], v[64:65], v[104:105]
    v_pk_mul_f32 v[66:67], v[66:67], v[106:107]
    v_exp_f32 v60, v60
    v_exp_f32 v61, v61
    v_exp_f32 v62, v62
    v_exp_f32 v63, v63
    v_exp_f32 v64, v64
    v_exp_f32 v65, v65
    v_exp_f32 v66, v66
    v_exp_f32 v67, v67
    v_pk_add_f32 v[60:61], v[60:61], v[84:85]
    v_pk_add_f32 v[62:63], v[62:63], v[84:85]
    v_pk_add_f32 v[64:65], v[64:65], v[84:85]
    v_pk_add_f32 v[66:67], v[66:67], v[84:85]
    v_rcp_f32 v60, v60
    v_rcp_f32 v61, v61
    v_rcp_f32 v62, v62
    v_rcp_f32 v63, v63
    v_rcp_f32 v64, v64
    v_rcp_f32 v65, v65
    v_rcp_f32 v66, v66
    v_rcp_f32 v67, v67
    v_pk_mul_f32 v[92:93], v[92:93], v[60:61]
    v_pk_mul_f32 v[94:95], v[94:95], v[62:63]
    v_pk_mul_f32 v[104:105], v[104:105], v[64:65]
    v_pk_mul_f32 v[106:107], v[106:107], v[66:67]
    v_cvt_pk_bf16_f32 v72, v92, v93
    v_cvt_pk_bf16_f32 v73, v94, v95
    v_cvt_pk_bf16_f32 v74, v104, v105
    v_cvt_pk_bf16_f32 v75, v106, v107
    buffer_store_dwordx4 v[72:75], v14, s[28:31], s53 offen sc1
    v_pk_add_f32 v[116:117], v[116:117], v[40:41]
    v_pk_add_f32 v[118:119], v[118:119], v[42:43]
    v_pk_add_f32 v[128:129], v[128:129], v[44:45]
    v_pk_add_f32 v[130:131], v[130:131], v[46:47]
    v_pk_mul_f32 v[60:61], v[116:117], v[116:117]
    v_pk_mul_f32 v[62:63], v[118:119], v[118:119]
    v_pk_mul_f32 v[64:65], v[128:129], v[128:129]
    v_pk_mul_f32 v[66:67], v[130:131], v[130:131]
    v_pk_fma_f32 v[60:61], v[60:61], v[82:83], v[80:81]
    v_pk_fma_f32 v[62:63], v[62:63], v[82:83], v[80:81]
    v_pk_fma_f32 v[64:65], v[64:65], v[82:83], v[80:81]
    v_pk_fma_f32 v[66:67], v[66:67], v[82:83], v[80:81]
    v_pk_mul_f32 v[60:61], v[60:61], v[116:117]
    v_pk_mul_f32 v[62:63], v[62:63], v[118:119]
    v_pk_mul_f32 v[64:65], v[64:65], v[128:129]
    v_pk_mul_f32 v[66:67], v[66:67], v[130:131]
    v_exp_f32 v60, v60
    v_exp_f32 v61, v61
    v_exp_f32 v62, v62
    v_exp_f32 v63, v63
    v_exp_f32 v64, v64
    v_exp_f32 v65, v65
    v_exp_f32 v66, v66
    v_exp_f32 v67, v67
    v_pk_add_f32 v[60:61], v[60:61], v[84:85]
    v_pk_add_f32 v[62:63], v[62:63], v[84:85]
    v_pk_add_f32 v[64:65], v[64:65], v[84:85]
    v_pk_add_f32 v[66:67], v[66:67], v[84:85]
    v_rcp_f32 v60, v60
    v_rcp_f32 v61, v61
    v_rcp_f32 v62, v62
    v_rcp_f32 v63, v63
    v_rcp_f32 v64, v64
    v_rcp_f32 v65, v65
    v_rcp_f32 v66, v66
    v_rcp_f32 v67, v67
    v_pk_mul_f32 v[116:117], v[116:117], v[60:61]
    v_pk_mul_f32 v[118:119], v[118:119], v[62:63]
    v_pk_mul_f32 v[128:129], v[128:129], v[64:65]
    v_pk_mul_f32 v[130:131], v[130:131], v[66:67]
    v_cvt_pk_bf16_f32 v76, v116, v117
    v_cvt_pk_bf16_f32 v77, v118, v119
    v_cvt_pk_bf16_f32 v78, v128, v129
    v_cvt_pk_bf16_f32 v79, v130, v131
    buffer_store_dwordx4 v[76:79], v14, s[28:31], s56 offen sc1
    v_pk_add_f32 v[96:97], v[96:97], v[32:33]
    v_pk_add_f32 v[98:99], v[98:99], v[34:35]
    v_pk_add_f32 v[108:109], v[108:109], v[36:37]
    v_pk_add_f32 v[110:111], v[110:111], v[38:39]
    v_pk_mul_f32 v[60:61], v[96:97], v[96:97]
    v_pk_mul_f32 v[62:63], v[98:99], v[98:99]
    v_pk_mul_f32 v[64:65], v[108:109], v[108:109]
    v_pk_mul_f32 v[66:67], v[110:111], v[110:111]
    v_pk_fma_f32 v[60:61], v[60:61], v[82:83], v[80:81]
    v_pk_fma_f32 v[62:63], v[62:63], v[82:83], v[80:81]
    v_pk_fma_f32 v[64:65], v[64:65], v[82:83], v[80:81]
    v_pk_fma_f32 v[66:67], v[66:67], v[82:83], v[80:81]
    v_pk_mul_f32 v[60:61], v[60:61], v[96:97]
    v_pk_mul_f32 v[62:63], v[62:63], v[98:99]
    v_pk_mul_f32 v[64:65], v[64:65], v[108:109]
    v_pk_mul_f32 v[66:67], v[66:67], v[110:111]
    v_exp_f32 v60, v60
    v_exp_f32 v61, v61
    v_exp_f32 v62, v62
    v_exp_f32 v63, v63
    v_exp_f32 v64, v64
    v_exp_f32 v65, v65
    v_exp_f32 v66, v66
    v_exp_f32 v67, v67
    v_pk_add_f32 v[60:61], v[60:61], v[84:85]
    v_pk_add_f32 v[62:63], v[62:63], v[84:85]
    v_pk_add_f32 v[64:65], v[64:65], v[84:85]
    v_pk_add_f32 v[66:67], v[66:67], v[84:85]
    v_rcp_f32 v60, v60
    v_rcp_f32 v61, v61
    v_rcp_f32 v62, v62
    v_rcp_f32 v63, v63
    v_rcp_f32 v64, v64
    v_rcp_f32 v65, v65
    v_rcp_f32 v66, v66
    v_rcp_f32 v67, v67
    v_pk_mul_f32 v[96:97], v[96:97], v[60:61]
    v_pk_mul_f32 v[98:99], v[98:99], v[62:63]
    v_pk_mul_f32 v[108:109], v[108:109], v[64:65]
    v_pk_mul_f32 v[110:111], v[110:111], v[66:67]
    v_cvt_pk_bf16_f32 v72, v96, v97
    v_cvt_pk_bf16_f32 v73, v98, v99
    v_cvt_pk_bf16_f32 v74, v108, v109
    v_cvt_pk_bf16_f32 v75, v110, v111
    buffer_store_dwordx4 v[72:75], v14, s[28:31], s54 offen sc1
    v_pk_add_f32 v[120:121], v[120:121], v[40:41]
    v_pk_add_f32 v[122:123], v[122:123], v[42:43]
    v_pk_add_f32 v[132:133], v[132:133], v[44:45]
    v_pk_add_f32 v[134:135], v[134:135], v[46:47]
    v_pk_mul_f32 v[60:61], v[120:121], v[120:121]
    v_pk_mul_f32 v[62:63], v[122:123], v[122:123]
    v_pk_mul_f32 v[64:65], v[132:133], v[132:133]
    v_pk_mul_f32 v[66:67], v[134:135], v[134:135]
    v_pk_fma_f32 v[60:61], v[60:61], v[82:83], v[80:81]
    v_pk_fma_f32 v[62:63], v[62:63], v[82:83], v[80:81]
    v_pk_fma_f32 v[64:65], v[64:65], v[82:83], v[80:81]
    v_pk_fma_f32 v[66:67], v[66:67], v[82:83], v[80:81]
    v_pk_mul_f32 v[60:61], v[60:61], v[120:121]
    v_pk_mul_f32 v[62:63], v[62:63], v[122:123]
    v_pk_mul_f32 v[64:65], v[64:65], v[132:133]
    v_pk_mul_f32 v[66:67], v[66:67], v[134:135]
    v_exp_f32 v60, v60
    v_exp_f32 v61, v61
    v_exp_f32 v62, v62
    v_exp_f32 v63, v63
    v_exp_f32 v64, v64
    v_exp_f32 v65, v65
    v_exp_f32 v66, v66
    v_exp_f32 v67, v67
    v_pk_add_f32 v[60:61], v[60:61], v[84:85]
    v_pk_add_f32 v[62:63], v[62:63], v[84:85]
    v_pk_add_f32 v[64:65], v[64:65], v[84:85]
    v_pk_add_f32 v[66:67], v[66:67], v[84:85]
    v_rcp_f32 v60, v60
    v_rcp_f32 v61, v61
    v_rcp_f32 v62, v62
    v_rcp_f32 v63, v63
    v_rcp_f32 v64, v64
    v_rcp_f32 v65, v65
    v_rcp_f32 v66, v66
    v_rcp_f32 v67, v67
    v_pk_mul_f32 v[120:121], v[120:121], v[60:61]
    v_pk_mul_f32 v[122:123], v[122:123], v[62:63]
    v_pk_mul_f32 v[132:133], v[132:133], v[64:65]
    v_pk_mul_f32 v[134:135], v[134:135], v[66:67]
    v_cvt_pk_bf16_f32 v76, v120, v121
    v_cvt_pk_bf16_f32 v77, v122, v123
    v_cvt_pk_bf16_f32 v78, v132, v133
    v_cvt_pk_bf16_f32 v79, v134, v135
    buffer_store_dwordx4 v[76:79], v14, s[28:31], s57 offen sc1
    v_mov_b32 v3, 1
    s_waitcnt vmcnt(0)
    s_mov_b64 exec, 1
    buffer_store_dword v3, off, s[28:31], s58 sc1
    s_mov_b64 exec, -1
    s_barrier
t_cons2:
    s_lshr_b32 s44, s36, 1
    s_and_b32 s45, s36, 1
    s_lshl_b32 s45, s45, 3
    s_lshr_b32 s46, s37, 2
    s_add_u32 s45, s45, s46
    s_and_b32 s46, s37, 3
    s_lshr_b32 s47, s44, 1
    s_and_b32 s48, s44, 1
    s_lshl_b32 s40, s3, 1
    s_add_u32 s40, s40, s47
    s_xor_b32 s41, s40, 1
    v_lshrrev_b32 v2, 2, v5
    v_and_b32 v3, 1, v6
    v_lshl_add_u32 v3, v3, 2, v2
    v_mad_u32_u24 v2, v6, 4, v2
    v_lshlrev_b32 v2, 8, v2
    v_and_b32 v4, 3, v1
    v_lshl_add_u32 v2, v4, 3, v2
    v_xor_b32 v4, s40, v3
    v_lshl_add_u32 v8, v4, 5, v2
    v_xor_b32 v4, s41, v3
    v_lshl_add_u32 v9, v4, 5, v2
    s_lshl_b32 s42, s48, 12
    s_add_u32 s43, s42, 81920
    v_add_u32 v10, s43, v14
    s_xor_b32 s43, s43, 4096
    v_add_u32 v11, s43, v14
    v_add_u32 v12, 90112, v14
    s_lshl_b32 s49, s45, 3
    s_add_u32 s49, s49, s40
    s_lshl_b32 s49, s49, 4
    v_add_u32 v2, s49, v5
    v_mov_b32 v230, 0
    v_lshlrev_b32 v3, 1, v2
    buffer_load_short_d16_hi v230, v3, s[12:15], 0 offen
    v_mul_u32_u24 v2, 1152, v2
    v_lshl_add_u32 v22, v6, 3, v2
    s_mul_i32 s49, s46, 288
    s_lshl_b32 s52, s48, 7
    s_add_u32 s52, s52, s49
    s_lshl_b32 s53, s48, 2
    s_add_u32 s53, s53, s49
    s_add_u32 s53, s53, 256
    s_add_u32 s54, s52, 10485760
    s_add_u32 s55, s53, 10485760
    v_lshlrev_b32 v3, 4, v6
    s_lshl_b32 s56, s52, 1
    s_add_u32 s56, s56, 11520
    s_lshl_b32 s57, s53, 1
    s_add_u32 s57, s57, 11520
    v_mov_b32 v115, s26
    v_mov_b32 v119, s26
    v_mov_b32 v123, s26
    v_mov_b32 v235, s26
    v_mov_b32 v239, s26
    v_mov_b32 v243, s26
    v_mov_b32 v247, s26
    v_mov_b32 v251, s26
    v_mov_b32 v255, s26
    s_lshl_b32 s50, s46, 4
    s_add_u32 s50, s50, s45
    s_lshl_b32 s50, s50, 2
    s_add_u32 s50, s50, s3
    s_lshl_b32 s50, s50, 4
    s_xor_b32 s51, s44, 1
    s_lshl_b32 s61, s51, 2
    s_add_u32 s61, s61, s44
    s_add_u32 s61, s61, s50
    s_mul_i32 s61, s61, 3072
    s_add_u32 s61, s61, 25165824
    s_lshl_b32 s5, s44, 2
    s_add_u32 s5, s5, s51
    s_add_u32 s5, s5, s50
    s_mul_i32 s5, s5, 3072
    s_add_u32 s5, s5, 25165824
    s_xor_b32 s51, s44, 2
    s_lshl_b32 s62, s51, 2
    s_add_u32 s62, s62, s44
    s_add_u32 s62, s62, s50
    s_mul_i32 s62, s62, 3072
    s_add_u32 s62, s62, 25165824
    s_lshl_b32 s6, s44, 2
    s_add_u32 s6, s6, s51
    s_add_u32 s6, s6, s50
    s_mul_i32 s6, s6, 3072
    s_add_u32 s6, s6, 25165824
    s_xor_b32 s51, s44, 3
    s_lshl_b32 s63, s51, 2
    s_add_u32 s63, s63, s44
    s_add_u32 s63, s63, s50
    s_mul_i32 s63, s63, 3072
    s_add_u32 s63, s63, 25165824
    s_lshl_b32 s7, s44, 2
    s_add_u32 s7, s7, s51
    s_add_u32 s7, s7, s50
    s_mul_i32 s7, s7, 3072
    s_add_u32 s7, s7, 25165824
    v_mov_b32 v23, s5
    v_writelane_b32 v23, s6, 1
    v_writelane_b32 v23, s7, 2
    s_cmp_lt_u32 s2, 216
    s_cbranch_scc0 g2_late_ops
    buffer_load_dwordx2 v[200:201], v22, s[28:31], s54 offen offset:0
    buffer_load_dwordx2 v[202:203], v22, s[28:31], s54 offen offset:32
    buffer_load_dwordx2 v[204:205], v22, s[28:31], s54 offen offset:64
    buffer_load_dwordx2 v[206:207], v22, s[28:31], s54 offen offset:96
    buffer_load_dword v208, v22, s[28:31], s55 offen
    buffer_load_dwordx4 v[210:213], v3, s[28:31], s56 offen offset:0
    buffer_load_dwordx4 v[214:217], v3, s[28:31], s56 offen offset:64
    buffer_load_dwordx4 v[218:221], v3, s[28:31], s56 offen offset:128
    buffer_load_dwordx4 v[222:225], v3, s[28:31], s56 offen offset:192
    buffer_load_dwordx2 v[226:227], v3, s[28:31], s57 offen
g2_late_ops:
    v_mov_b32 v128, 0
    v_mov_b32 v129, 0
    v_mov_b32 v130, 0
    v_mov_b32 v131, 0
    v_mov_b32 v132, 0
    v_mov_b32 v133, 0
    v_mov_b32 v134, 0
    v_mov_b32 v135, 0
    v_mov_b32 v136, 0
    v_mov_b32 v137, 0
    v_mov_b32 v138, 0
    v_mov_b32 v139, 0
    v_mov_b32 v140, 0
    v_mov_b32 v141, 0
    v_mov_b32 v142, 0
    v_mov_b32 v143, 0
    v_mov_b32 v144, 0
    v_mov_b32 v145, 0
    v_mov_b32 v146, 0
    v_mov_b32 v147, 0
    v_mov_b32 v148, 0
    v_mov_b32 v149, 0
    v_mov_b32 v150, 0
    v_mov_b32 v151, 0
    v_mov_b32 v152, 0
    v_mov_b32 v153, 0
    v_mov_b32 v154, 0
    v_mov_b32 v155, 0
    v_mov_b32 v156, 0
    v_mov_b32 v157, 0
    v_mov_b32 v158, 0
    v_mov_b32 v159, 0
    v_mov_b32 v160, 0
    v_mov_b32 v161, 0
    v_mov_b32 v162, 0
    v_mov_b32 v163, 0
    v_mov_b32 v164, 0
    v_mov_b32 v165, 0
    v_mov_b32 v166, 0
    v_mov_b32 v167, 0
    v_mov_b32 v168, 0
    v_mov_b32 v169, 0
    v_mov_b32 v170, 0
    v_mov_b32 v171, 0
    v_mov_b32 v172, 0
    v_mov_b32 v173, 0
    v_mov_b32 v174, 0
    v_mov_b32 v175, 0
    v_mov_b32 v176, 0
    v_mov_b32 v177, 0
    v_mov_b32 v178, 0
    v_mov_b32 v179, 0
    v_mov_b32 v180, 0
    v_mov_b32 v181, 0
    v_mov_b32 v182, 0
    v_mov_b32 v183, 0
    v_mov_b32 v184, 0
    v_mov_b32 v185, 0
    v_mov_b32 v186, 0
    v_mov_b32 v187, 0
    v_mov_b32 v188, 0
    v_mov_b32 v189, 0
    v_mov_b32 v190, 0
    v_mov_b32 v191, 0
    v_mov_b32 v192, 0
    v_mov_b32 v193, 0
    v_mov_b32 v194, 0
    v_mov_b32 v195, 0
    v_mov_b32 v196, 0
    v_mov_b32 v197, 0
    v_mov_b32 v198, 0
    v_mov_b32 v199, 0
    s_mov_b32 s24, 0
    s_mov_b32 s4, 0
    v_add_u32 v16, s24, v8
    v_add_u32 v17, s24, v9
    v_add_u32 v18, s4, v10
    v_add_u32 v19, s4, v11
    v_add_u32 v20, s4, v12
    s_movk_i32 s59, 17
    s_barrier
    ds_read_b128 v[32:35], v18 offset:0
    ds_read_b64_tr_b16 v[24:25], v16 offset:0
    ds_read_b64_tr_b16 v[26:27], v16 offset:4096
    ds_read_b64_tr_b16 v[28:29], v17 offset:0
    ds_read_b64_tr_b16 v[30:31], v17 offset:4096
    ds_read_b128 v[36:39], v18 offset:1024
    ds_read_b128 v[40:43], v18 offset:2048
    ds_read_b128 v[44:47], v18 offset:3072
    ds_read_b128 v[48:51], v19 offset:0
    ds_read_b128 v[52:55], v19 offset:1024
    ds_read_b128 v[56:59], v19 offset:2048
    ds_read_b128 v[60:63], v19 offset:3072
    ds_read_b128 v[64:67], v20 offset:0
    s_cmp_lt_u32 s2, 216
    s_cbranch_scc1 g2_late_done
    buffer_load_dwordx2 v[200:201], v22, s[28:31], s54 offen offset:0
    buffer_load_dwordx2 v[202:203], v22, s[28:31], s54 offen offset:32
    buffer_load_dwordx2 v[204:205], v22, s[28:31], s54 offen offset:64
    buffer_load_dwordx2 v[206:207], v22, s[28:31], s54 offen offset:96
    buffer_load_dword v208, v22, s[28:31], s55 offen
    buffer_load_dwordx4 v[210:213], v3, s[28:31], s56 offen offset:0
    buffer_load_dwordx4 v[214:217], v3, s[28:31], s56 offen offset:64
    buffer_load_dwordx4 v[218:221], v3, s[28:31], s56 offen offset:128
    buffer_load_dwordx4 v[222:225], v3, s[28:31], s56 offen offset:192
    buffer_load_dwordx2 v[226:227], v3, s[28:31], s57 offen
g2_late_done:
    s_add_u32 s24, s24, 16384
    s_cmp_eq_u32 s24, 81920
    s_cselect_b32 s24, 0, s24
    s_add_u32 s4, s4, 18432
    s_cmp_eq_u32 s4, 73728
    s_cselect_b32 s4, 0, s4
g2_mm_loop:
    s_waitcnt lgkmcnt(0)
    v_mfma_f32_16x16x32_bf16 v[128:131], v[32:35], v[24:27], v[128:131]
    ds_read_b128 v[76:79], v18 offset:9216
    ds_read_b64_tr_b16 v[68:69], v16 offset:8192
    v_mfma_f32_16x16x32_bf16 v[164:167], v[32:35], v[28:31], v[164:167]
    ds_read_b64_tr_b16 v[70:71], v16 offset:12288
    ds_read_b64_tr_b16 v[72:73], v17 offset:8192
    v_mfma_f32_16x16x32_bf16 v[168:171], v[36:39], v[28:31], v[168:171]
    ds_read_b64_tr_b16 v[74:75], v17 offset:12288
    ds_read_b128 v[80:83], v18 offset:10240
    v_mfma_f32_16x16x32_bf16 v[132:135], v[36:39], v[24:27], v[132:135]
    ds_read_b128 v[84:87], v18 offset:11264
    ds_read_b128 v[88:91], v18 offset:12288
    v_mfma_f32_16x16x32_bf16 v[136:139], v[40:43], v[24:27], v[136:139]
    ds_read_b128 v[92:95], v19 offset:9216
    ds_read_b128 v[96:99], v19 offset:10240
    v_mfma_f32_16x16x32_bf16 v[172:175], v[40:43], v[28:31], v[172:175]
    ds_read_b128 v[100:103], v19 offset:11264
    ds_read_b128 v[104:107], v19 offset:12288
    v_mfma_f32_16x16x32_bf16 v[176:179], v[44:47], v[28:31], v[176:179]
    ds_read_b128 v[108:111], v20 offset:9216
    v_add_u32 v16, s24, v8
    v_mfma_f32_16x16x32_bf16 v[140:143], v[44:47], v[24:27], v[140:143]
    v_add_u32 v17, s24, v9
    v_add_u32 v18, s4, v10
    v_mfma_f32_16x16x32_bf16 v[144:147], v[48:51], v[24:27], v[144:147]
    v_add_u32 v19, s4, v11
    v_add_u32 v20, s4, v12
    v_mfma_f32_16x16x32_bf16 v[180:183], v[48:51], v[28:31], v[180:183]
    v_mfma_f32_16x16x32_bf16 v[184:187], v[52:55], v[28:31], v[184:187]
    v_mfma_f32_16x16x32_bf16 v[148:151], v[52:55], v[24:27], v[148:151]
    v_mfma_f32_16x16x32_bf16 v[152:155], v[56:59], v[24:27], v[152:155]
    v_mfma_f32_16x16x32_bf16 v[188:191], v[56:59], v[28:31], v[188:191]
    v_mfma_f32_16x16x32_bf16 v[192:195], v[60:63], v[28:31], v[192:195]
    v_mfma_f32_16x16x32_bf16 v[156:159], v[60:63], v[24:27], v[156:159]
    s_waitcnt lgkmcnt(0)
    s_barrier
    v_mfma_f32_16x16x32_bf16 v[160:163], v[64:67], v[24:27], v[160:163]
    v_mfma_f32_16x16x32_bf16 v[196:199], v[64:67], v[28:31], v[196:199]
    v_mfma_f32_16x16x32_bf16 v[128:131], v[76:79], v[68:71], v[128:131]
    ds_read_b128 v[32:35], v18 offset:0
    ds_read_b64_tr_b16 v[24:25], v16 offset:0
    v_mfma_f32_16x16x32_bf16 v[164:167], v[76:79], v[72:75], v[164:167]
    ds_read_b64_tr_b16 v[26:27], v16 offset:4096
    ds_read_b64_tr_b16 v[28:29], v17 offset:0
    v_mfma_f32_16x16x32_bf16 v[168:171], v[80:83], v[72:75], v[168:171]
    ds_read_b64_tr_b16 v[30:31], v17 offset:4096
    ds_read_b128 v[36:39], v18 offset:1024
    v_mfma_f32_16x16x32_bf16 v[132:135], v[80:83], v[68:71], v[132:135]
    ds_read_b128 v[40:43], v18 offset:2048
    ds_read_b128 v[44:47], v18 offset:3072
    v_mfma_f32_16x16x32_bf16 v[136:139], v[84:87], v[68:71], v[136:139]
    ds_read_b128 v[48:51], v19 offset:0
    ds_read_b128 v[52:55], v19 offset:1024
    v_mfma_f32_16x16x32_bf16 v[172:175], v[84:87], v[72:75], v[172:175]
    ds_read_b128 v[56:59], v19 offset:2048
    ds_read_b128 v[60:63], v19 offset:3072
    v_mfma_f32_16x16x32_bf16 v[176:179], v[88:91], v[72:75], v[176:179]
    ds_read_b128 v[64:67], v20 offset:0
    s_add_u32 s24, s24, 16384
    v_mfma_f32_16x16x32_bf16 v[140:143], v[88:91], v[68:71], v[140:143]
    s_cmp_eq_u32 s24, 81920
    s_cselect_b32 s24, 0, s24
    v_mfma_f32_16x16x32_bf16 v[144:147], v[92:95], v[68:71], v[144:147]
    s_add_u32 s4, s4, 18432
    s_cmp_eq_u32 s4, 73728
    v_mfma_f32_16x16x32_bf16 v[180:183], v[92:95], v[72:75], v[180:183]
    s_cselect_b32 s4, 0, s4
    s_sub_u32 s59, s59, 1
    v_mfma_f32_16x16x32_bf16 v[184:187], v[96:99], v[72:75], v[184:187]
    s_cmp_lg_u32 s59, 0
    v_mfma_f32_16x16x32_bf16 v[148:151], v[96:99], v[68:71], v[148:151]
    v_mfma_f32_16x16x32_bf16 v[152:155], v[100:103], v[68:71], v[152:155]
    v_mfma_f32_16x16x32_bf16 v[188:191], v[100:103], v[72:75], v[188:191]
    v_mfma_f32_16x16x32_bf16 v[192:195], v[104:107], v[72:75], v[192:195]
    v_mfma_f32_16x16x32_bf16 v[156:159], v[104:107], v[68:71], v[156:159]
    v_mfma_f32_16x16x32_bf16 v[160:163], v[108:111], v[68:71], v[160:163]
    v_mfma_f32_16x16x32_bf16 v[196:199], v[108:111], v[72:75], v[196:199]
    s_cbranch_scc1 g2_mm_loop
    s_waitcnt lgkmcnt(0)
    v_mfma_f32_16x16x32_bf16 v[128:131], v[32:35], v[24:27], v[128:131]
    ds_read_b128 v[76:79], v18 offset:9216
    ds_read_b64_tr_b16 v[68:69], v16 offset:8192
    v_mfma_f32_16x16x32_bf16 v[164:167], v[32:35], v[28:31], v[164:167]
    ds_read_b64_tr_b16 v[70:71], v16 offset:12288
    ds_read_b64_tr_b16 v[72:73], v17 offset:8192
    v_mfma_f32_16x16x32_bf16 v[168:171], v[36:39], v[28:31], v[168:171]
    ds_read_b64_tr_b16 v[74:75], v17 offset:12288
    ds_read_b128 v[80:83], v18 offset:10240
    v_mfma_f32_16x16x32_bf16 v[132:135], v[36:39], v[24:27], v[132:135]
    ds_read_b128 v[84:87], v18 offset:11264
    ds_read_b128 v[88:91], v18 offset:12288
    v_mfma_f32_16x16x32_bf16 v[136:139], v[40:43], v[24:27], v[136:139]
    ds_read_b128 v[92:95], v19 offset:9216
    ds_read_b128 v[96:99], v19 offset:10240
    v_mfma_f32_16x16x32_bf16 v[172:175], v[40:43], v[28:31], v[172:175]
    ds_read_b128 v[100:103], v19 offset:11264
    ds_read_b128 v[104:107], v19 offset:12288
    v_mfma_f32_16x16x32_bf16 v[176:179], v[44:47], v[28:31], v[176:179]
    ds_read_b128 v[108:111], v20 offset:9216
    v_mfma_f32_16x16x32_bf16 v[140:143], v[44:47], v[24:27], v[140:143]
    v_mfma_f32_16x16x32_bf16 v[144:147], v[48:51], v[24:27], v[144:147]
    v_mfma_f32_16x16x32_bf16 v[180:183], v[48:51], v[28:31], v[180:183]
    v_mfma_f32_16x16x32_bf16 v[184:187], v[52:55], v[28:31], v[184:187]
    v_mfma_f32_16x16x32_bf16 v[148:151], v[52:55], v[24:27], v[148:151]
    v_mfma_f32_16x16x32_bf16 v[152:155], v[56:59], v[24:27], v[152:155]
    v_mfma_f32_16x16x32_bf16 v[188:191], v[56:59], v[28:31], v[188:191]
    v_mfma_f32_16x16x32_bf16 v[192:195], v[60:63], v[28:31], v[192:195]
    v_mfma_f32_16x16x32_bf16 v[156:159], v[60:63], v[24:27], v[156:159]
    v_mfma_f32_16x16x32_bf16 v[160:163], v[64:67], v[24:27], v[160:163]
    v_mfma_f32_16x16x32_bf16 v[196:199], v[64:67], v[28:31], v[196:199]
    s_waitcnt lgkmcnt(0)
    v_mfma_f32_16x16x32_bf16 v[128:131], v[76:79], v[68:71], v[128:131]
    v_mfma_f32_16x16x32_bf16 v[164:167], v[76:79], v[72:75], v[164:167]
    v_mfma_f32_16x16x32_bf16 v[168:171], v[80:83], v[72:75], v[168:171]
    v_mfma_f32_16x16x32_bf16 v[132:135], v[80:83], v[68:71], v[132:135]
    v_mfma_f32_16x16x32_bf16 v[136:139], v[84:87], v[68:71], v[136:139]
    v_mfma_f32_16x16x32_bf16 v[172:175], v[84:87], v[72:75], v[172:175]
    v_mfma_f32_16x16x32_bf16 v[176:179], v[88:91], v[72:75], v[176:179]
    v_mfma_f32_16x16x32_bf16 v[140:143], v[88:91], v[68:71], v[140:143]
    v_mfma_f32_16x16x32_bf16 v[144:147], v[92:95], v[68:71], v[144:147]
    v_mfma_f32_16x16x32_bf16 v[180:183], v[92:95], v[72:75], v[180:183]
    v_mfma_f32_16x16x32_bf16 v[184:187], v[96:99], v[72:75], v[184:187]
    v_mfma_f32_16x16x32_bf16 v[148:151], v[96:99], v[68:71], v[148:151]
    v_mfma_f32_16x16x32_bf16 v[152:155], v[100:103], v[68:71], v[152:155]
    v_mfma_f32_16x16x32_bf16 v[188:191], v[100:103], v[72:75], v[188:191]
    v_mfma_f32_16x16x32_bf16 v[192:195], v[104:107], v[72:75], v[192:195]
    v_mfma_f32_16x16x32_bf16 v[156:159], v[104:107], v[68:71], v[156:159]
    v_mfma_f32_16x16x32_bf16 v[160:163], v[108:111], v[68:71], v[160:163]
    v_mfma_f32_16x16x32_bf16 v[196:199], v[108:111], v[72:75], v[196:199]
    s_cmp_eq_u32 s48, 1
    s_cbranch_scc0 g2_noswap
    s_nop 4
    v_swap_b32 v160, v162
    v_swap_b32 v161, v163
    v_swap_b32 v196, v198
    v_swap_b32 v197, v199
g2_noswap:
    v_cvt_pk_bf16_f32 v112, v144, v145
    v_cvt_pk_bf16_f32 v113, v146, v147
    v_cvt_pk_bf16_f32 v114, v148, v149
    buffer_store_dwordx4 v[112:115], v14, s[28:31], s61 offen offset:0 sc1
    v_cvt_pk_bf16_f32 v116, v150, v151
    v_cvt_pk_bf16_f32 v117, v152, v153
    v_cvt_pk_bf16_f32 v118, v154, v155
    buffer_store_dwordx4 v[116:119], v14, s[28:31], s61 offen offset:1024 sc1
    v_cvt_pk_bf16_f32 v120, v156, v157
    v_cvt_pk_bf16_f32 v121, v158, v159
    v_cvt_pk_bf16_f32 v122, v162, v163
    buffer_store_dwordx4 v[120:123], v14, s[28:31], s61 offen offset:2048 sc1
    v_cvt_pk_bf16_f32 v232, v164, v165
    v_cvt_pk_bf16_f32 v233, v166, v167
    v_cvt_pk_bf16_f32 v234, v168, v169
    buffer_store_dwordx4 v[232:235], v14, s[28:31], s62 offen offset:0 sc1
    v_cvt_pk_bf16_f32 v236, v170, v171
    v_cvt_pk_bf16_f32 v237, v172, v173
    v_cvt_pk_bf16_f32 v238, v174, v175
    buffer_store_dwordx4 v[236:239], v14, s[28:31], s62 offen offset:1024 sc1
    v_cvt_pk_bf16_f32 v240, v176, v177
    v_cvt_pk_bf16_f32 v241, v178, v179
    v_cvt_pk_bf16_f32 v242, v196, v197
    buffer_store_dwordx4 v[240:243], v14, s[28:31], s62 offen offset:2048 sc1
    v_cvt_pk_bf16_f32 v244, v180, v181
    v_cvt_pk_bf16_f32 v245, v182, v183
    v_cvt_pk_bf16_f32 v246, v184, v185
    buffer_store_dwordx4 v[244:247], v14, s[28:31], s63 offen offset:0 sc1
    v_cvt_pk_bf16_f32 v248, v186, v187
    v_cvt_pk_bf16_f32 v249, v188, v189
    v_cvt_pk_bf16_f32 v250, v190, v191
    buffer_store_dwordx4 v[248:251], v14, s[28:31], s63 offen offset:1024 sc1
    v_cvt_pk_bf16_f32 v252, v192, v193
    v_cvt_pk_bf16_f32 v253, v194, v195
    v_cvt_pk_bf16_f32 v254, v198, v199
    buffer_store_dwordx4 v[252:255], v14, s[28:31], s63 offen offset:2048 sc1
    s_mov_b32 s42, 0xffff0000
    s_waitcnt vmcnt(9)
    v_add_f32 v128, v128, v230
    v_add_f32 v129, v129, v230
    v_add_f32 v130, v130, v230
    v_add_f32 v131, v131, v230
    v_add_f32 v132, v132, v230
    v_add_f32 v133, v133, v230
    v_add_f32 v134, v134, v230
    v_add_f32 v135, v135, v230
    v_add_f32 v136, v136, v230
    v_add_f32 v137, v137, v230
    v_add_f32 v138, v138, v230
    v_add_f32 v139, v139, v230
    v_add_f32 v140, v140, v230
    v_add_f32 v141, v141, v230
    v_add_f32 v142, v142, v230
    v_add_f32 v143, v143, v230
    v_add_f32 v160, v160, v230
    v_add_f32 v161, v161, v230
    v_lshlrev_b32 v32, 16, v200
    v_and_b32 v33, s42, v200
    v_lshlrev_b32 v34, 16, v201
    v_and_b32 v35, s42, v201
    v_lshlrev_b32 v36, 16, v202
    v_and_b32 v37, s42, v202
    v_lshlrev_b32 v38, 16, v203
    v_and_b32 v39, s42, v203
    v_lshlrev_b32 v40, 16, v204
    v_and_b32 v41, s42, v204
    v_lshlrev_b32 v42, 16, v205
    v_and_b32 v43, s42, v205
    v_lshlrev_b32 v44, 16, v206
    v_and_b32 v45, s42, v206
    v_lshlrev_b32 v46, 16, v207
    v_and_b32 v47, s42, v207
    v_lshlrev_b32 v48, 16, v208
    v_and_b32 v49, s42, v208
    s_mov_b32 s49, 0
    s_mov_b64 s[40:41], 7
g2_scout:
    s_mov_b64 exec, s[40:41]
    buffer_load_dword v2, v23, s[28:31], 0 offen offset:3068 sc1
    s_add_u32 s49, s49, 1
    s_waitcnt vmcnt(0)
    v_cmp_eq_u32 vcc, s26, v2
    s_mov_b64 exec, -1
    s_bitcmp1_b32 vcc_lo, 0
    s_cbranch_scc0 g2_sc1
    buffer_load_dwordx4 v[68:71], v14, s[28:31], s5 offen offset:0 sc1
    buffer_load_dwordx4 v[72:75], v14, s[28:31], s5 offen offset:1024 sc1
    buffer_load_dwordx4 v[76:79], v14, s[28:31], s5 offen offset:2048 sc1
g2_sc1:
    s_bitcmp1_b32 vcc_lo, 1
    s_cbranch_scc0 g2_sc2
    buffer_load_dwordx4 v[80:83], v14, s[28:31], s6 offen offset:0 sc1
    buffer_load_dwordx4 v[84:87], v14, s[28:31], s6 offen offset:1024 sc1
    buffer_load_dwordx4 v[88:91], v14, s[28:31], s6 offen offset:2048 sc1
g2_sc2:
    s_bitcmp1_b32 vcc_lo, 2
    s_cbranch_scc0 g2_sc3
    buffer_load_dwordx4 v[92:95], v14, s[28:31], s7 offen offset:0 sc1
    buffer_load_dwordx4 v[96:99], v14, s[28:31], s7 offen offset:1024 sc1
    buffer_load_dwordx4 v[100:103], v14, s[28:31], s7 offen offset:2048 sc1
g2_sc3:
    s_andn2_b32 s40, s40, vcc_lo
    s_cbranch_scc0 g2_check
    s_cmp_lt_u32 s49, 30000
    s_cbranch_scc1 g2_scout
g2_poll:
    buffer_load_dwordx4 v[68:71], v14, s[28:31], s5 offen offset:0 sc1
    buffer_load_dwordx4 v[72:75], v14, s[28:31], s5 offen offset:1024 sc1
    buffer_load_dwordx4 v[76:79], v14, s[28:31], s5 offen offset:2048 sc1
    buffer_load_dwordx4 v[80:83], v14, s[28:31], s6 offen offset:0 sc1
    buffer_load_dwordx4 v[84:87], v14, s[28:31], s6 offen offset:1024 sc1
    buffer_load_dwordx4 v[88:91], v14, s[28:31], s6 offen offset:2048 sc1
    buffer_load_dwordx4 v[92:95], v14, s[28:31], s7 offen offset:0 sc1
    buffer_load_dwordx4 v[96:99], v14, s[28:31], s7 offen offset:1024 sc1
    buffer_load_dwordx4 v[100:103], v14, s[28:31], s7 offen offset:2048 sc1
    s_add_u32 s49, s49, 1
g2_check:
    s_waitcnt vmcnt(0)
    v_xor_b32 v24, s26, v71
    v_xor_b32 v25, s26, v75
    v_xor_b32 v26, s26, v79
    v_xor_b32 v27, s26, v83
    v_xor_b32 v28, s26, v87
    v_xor_b32 v29, s26, v91
    v_xor_b32 v30, s26, v95
    v_xor_b32 v31, s26, v99
    v_xor_b32 v2, s26, v103
    v_or3_b32 v24, v24, v25, v26
    v_or3_b32 v27, v27, v28, v29
    v_or3_b32 v30, v30, v31, v2
    v_or3_b32 v24, v24, v27, v30
    v_cmp_ne_u32 vcc, 0, v24
    s_nop 0
    s_and_b64 exec, vcc, vcc
    s_cbranch_scc0 g2_ready
    s_cmp_lt_u32 s49, 30000
    s_cbranch_scc1 g2_poll
g2_ready:
    s_mov_b64 exec, -1
    v_lshlrev_b32 v24, 16, v68
    v_and_b32 v25, s42, v68
    v_pk_add_f32 v[128:129], v[128:129], v[24:25]
    v_lshlrev_b32 v26, 16, v69
    v_and_b32 v27, s42, v69
    v_pk_add_f32 v[130:131], v[130:131], v[26:27]
    v_lshlrev_b32 v24, 16, v70
    v_and_b32 v25, s42, v70
    v_pk_add_f32 v[132:133], v[132:133], v[24:25]
    v_lshlrev_b32 v26, 16, v72
    v_and_b32 v27, s42, v72
    v_pk_add_f32 v[134:135], v[134:135], v[26:27]
    v_lshlrev_b32 v24, 16, v73
    v_and_b32 v25, s42, v73
    v_pk_add_f32 v[136:137], v[136:137], v[24:25]
    v_lshlrev_b32 v26, 16, v74
    v_and_b32 v27, s42, v74
    v_pk_add_f32 v[138:139], v[138:139], v[26:27]
    v_lshlrev_b32 v24, 16, v76
    v_and_b32 v25, s42, v76
    v_pk_add_f32 v[140:141], v[140:141], v[24:25]
    v_lshlrev_b32 v26, 16, v77
    v_and_b32 v27, s42, v77
    v_pk_add_f32 v[142:143], v[142:143], v[26:27]
    v_lshlrev_b32 v24, 16, v78
    v_and_b32 v25, s42, v78
    v_pk_add_f32 v[160:161], v[160:161], v[24:25]
    v_lshlrev_b32 v24, 16, v80
    v_and_b32 v25, s42, v80
    v_pk_add_f32 v[128:129], v[128:129], v[24:25]
    v_lshlrev_b32 v26, 16, v81
    v_and_b32 v27, s42, v81
    v_pk_add_f32 v[130:131], v[130:131], v[26:27]
    v_lshlrev_b32 v24, 16, v82
    v_and_b32 v25, s42, v82
    v_pk_add_f32 v[132:133], v[132:133], v[24:25]
    v_lshlrev_b32 v26, 16, v84
    v_and_b32 v27, s42, v84
    v_pk_add_f32 v[134:135], v[134:135], v[26:27]
    v_lshlrev_b32 v24, 16, v85
    v_and_b32 v25, s42, v85
    v_pk_add_f32 v[136:137], v[136:137], v[24:25]
    v_lshlrev_b32 v26, 16, v86
    v_and_b32 v27, s42, v86
    v_pk_add_f32 v[138:139], v[138:139], v[26:27]
    v_lshlrev_b32 v24, 16, v88
    v_and_b32 v25, s42, v88
    v_pk_add_f32 v[140:141], v[140:141], v[24:25]
    v_lshlrev_b32 v26, 16, v89
    v_and_b32 v27, s42, v89
    v_pk_add_f32 v[142:143], v[142:143], v[26:27]
    v_lshlrev_b32 v24, 16, v90
    v_and_b32 v25, s42, v90
    v_pk_add_f32 v[160:161], v[160:161], v[24:25]
    v_lshlrev_b32 v24, 16, v92
    v_and_b32 v25, s42, v92
    v_pk_add_f32 v[128:129], v[128:129], v[24:25]
    v_lshlrev_b32 v26, 16, v93
    v_and_b32 v27, s42, v93
    v_pk_add_f32 v[130:131], v[130:131], v[26:27]
    v_lshlrev_b32 v24, 16, v94
    v_and_b32 v25, s42, v94
    v_pk_add_f32 v[132:133], v[132:133], v[24:25]
    v_lshlrev_b32 v26, 16, v96
    v_and_b32 v27, s42, v96
    v_pk_add_f32 v[134:135], v[134:135], v[26:27]
    v_lshlrev_b32 v24, 16, v97
    v_and_b32 v25, s42, v97
    v_pk_add_f32 v[136:137], v[136:137], v[24:25]
    v_lshlrev_b32 v26, 16, v98
    v_and_b32 v27, s42, v98
    v_pk_add_f32 v[138:139], v[138:139], v[26:27]
    v_lshlrev_b32 v24, 16, v100
    v_and_b32 v25, s42, v100
    v_pk_add_f32 v[140:141], v[140:141], v[24:25]
    v_lshlrev_b32 v26, 16, v101
    v_and_b32 v27, s42, v101
    v_pk_add_f32 v[142:143], v[142:143], v[26:27]
    v_lshlrev_b32 v24, 16, v102
    v_and_b32 v25, s42, v102
    v_pk_add_f32 v[160:161], v[160:161], v[24:25]
    v_pk_fma_f32 v[128:129], v[128:129], v[210:211], v[32:33]
    v_cvt_pk_bf16_f32 v68, v128, v129
    v_pk_fma_f32 v[130:131], v[130:131], v[212:213], v[34:35]
    v_cvt_pk_bf16_f32 v69, v130, v131
    buffer_store_dwordx2 v[68:69], v22, s[16:19], s52 offen offset:0
    v_pk_fma_f32 v[132:133], v[132:133], v[214:215], v[36:37]
    v_cvt_pk_bf16_f32 v70, v132, v133
    v_pk_fma_f32 v[134:135], v[134:135], v[216:217], v[38:39]
    v_cvt_pk_bf16_f32 v71, v134, v135
    buffer_store_dwordx2 v[70:71], v22, s[16:19], s52 offen offset:32
    v_pk_fma_f32 v[136:137], v[136:137], v[218:219], v[40:41]
    v_cvt_pk_bf16_f32 v72, v136, v137
    v_pk_fma_f32 v[138:139], v[138:139], v[220:221], v[42:43]
    v_cvt_pk_bf16_f32 v73, v138, v139
    buffer_store_dwordx2 v[72:73], v22, s[16:19], s52 offen offset:64
    v_pk_fma_f32 v[140:141], v[140:141], v[222:223], v[44:45]
    v_cvt_pk_bf16_f32 v74, v140, v141
    v_pk_fma_f32 v[142:143], v[142:143], v[224:225], v[46:47]
    v_cvt_pk_bf16_f32 v75, v142, v143
    buffer_store_dwordx2 v[74:75], v22, s[16:19], s52 offen offset:96
    v_pk_fma_f32 v[160:161], v[160:161], v[226:227], v[48:49]
    v_cvt_pk_bf16_f32 v76, v160, v161
    buffer_store_dword v76, v22, s[16:19], s53 offen
t_end:
f_done:
    s_endpgm
f_end:
.section .rodata,"a"
.p2align 6
.amdhsa_kernel f_kernel
  .amdhsa_next_free_vgpr 256
  .amdhsa_next_free_sgpr 102
  .amdhsa_accum_offset 256
  .amdhsa_group_segment_fixed_size 0
  .amdhsa_kernarg_size 104
  .amdhsa_user_sgpr_count 2
  .amdhsa_user_sgpr_kernarg_segment_ptr 1
  .amdhsa_system_sgpr_workgroup_id_x 1
.end_amdhsa_kernel
```

```asm
; @launch kernel=f_kernel grid=(256,1,1) block=(512,1,1) lds=163840
.amdgcn_target "amdgcn-amd-amdhsa--gfx950"
.text
.globl f_kernel
.p2align 8
.type f_kernel,@function
f_kernel:
    s_cmp_ge_u32 s2, 256
    s_cbranch_scc1 f_done
    s_load_dwordx2 s[16:17], s[0:1], 64
    s_load_dwordx2 s[20:21], s[0:1], 72
    s_load_dwordx2 s[28:29], s[0:1], 96
    s_load_dwordx2 s[4:5], s[0:1], 0
    s_load_dwordx2 s[8:9], s[0:1], 8
    s_load_dwordx2 s[12:13], s[0:1], 16
    s_load_dwordx2 s[24:25], s[0:1], 88
    s_load_dwordx2 s[32:33], s[0:1], 32
    s_mov_b32 s18, 0x480
    s_mov_b32 s19, 0x20000
    s_mov_b32 s22, 0x3cc000
    s_mov_b32 s23, 0x20000
    s_mov_b32 s30, 0x3000000
    s_mov_b32 s31, 0x20000
    s_mov_b32 s6, 0x240000
    s_mov_b32 s7, 0x20000
    s_mov_b32 s10, 0x121000
    s_mov_b32 s11, 0x20000
    s_mov_b32 s14, 0x121000
    s_mov_b32 s15, 0x20000
    s_mov_b32 s26, 0x100
    s_mov_b32 s27, 0x20000
    s_mov_b32 s34, 0x1200000
    s_mov_b32 s35, 0x20000
    v_and_b32 v1, 63, v0
    v_lshrrev_b32 v2, 6, v0
    s_nop 0
    v_readfirstlane_b32 s3, v2
    v_and_b32 v5, 15, v1
    v_lshrrev_b32 v6, 4, v1
    s_and_b32 s36, s2, 7
    s_lshr_b32 s37, s2, 3
    s_sub_u32 s50, s37, 27
    s_cbranch_scc1 cpf_no
    s_cmp_eq_u32 s3, 5
    s_cbranch_scc0 cpf_no
    s_lshl_b32 s50, s50, 13
    s_add_u32 s50, s50, f_kernel-f_kernel
    v_lshl_add_u32 v102, v1, 7, s50
    v_min_u32 v102, f_end-f_kernel-4, v102
    s_getpc_b64 s[50:51]
cpf_pc:
    s_sub_u32 s50, s50, cpf_pc-f_kernel
    s_subb_u32 s51, s51, 0
    global_load_dword v103, v102, s[50:51]
cpf_no:
    s_lshr_b32 s38, s37, 3
    s_sub_u32 s38, 3, s38
    s_lshl_b32 s38, s38, 3
    s_add_u32 s38, s38, s36
    s_lshl_b32 s38, s38, 3
    s_and_b32 s39, s37, 7
    s_add_u32 s38, s38, s39
    s_and_b32 s39, s3, 3
    s_lshr_b32 s40, s3, 2
    s_sub_u32 s41, s2, 0
    s_mul_i32 s43, s41, 171
    s_lshr_b32 s43, s43, 9
    s_mul_i32 s44, s43, 3
    s_sub_u32 s44, s41, s44
    v_lshrrev_b32 v2, 3, v0
    v_and_b32 v3, 7, v0
    v_mul_u32_u24 v4, 6912, v2
    v_lshl_add_u32 v3, v3, 4, v4
    v_lshrrev_b32 v2, 3, v1
    v_min_u32 v2, 2, v2
    v_lshlrev_b32 v2, 6, v2
    v_and_or_b32 v2, v1, 7, v2
    v_lshl_add_u32 v2, s3, 3, v2
    v_lshlrev_b32 v2, 1, v2
    s_mul_i32 s45, s44, 384
    s_mul_i32 s46, s44, 1327104
    s_lshl_b32 s47, s43, 7
    s_add_u32 s46, s46, s47
    s_mul_i32 s48, s44, 9216
    s_lshl_b32 s47, s43, 8
    s_add_u32 s48, s48, s47
    s_add_u32 s47, s47, 131072
    s_cmp_lt_u32 s41, 54
    s_cselect_b32 s47, s47, 167424
    s_add_u32 s48, s48, s47
    s_memrealtime s[52:53]
    v_lshlrev_b32 v125, 2, v1
    v_lshlrev_b32 v109, 4, v1
    v_mov_b32 v68, -1
    v_mov_b32 v69, -1
    v_mov_b32 v70, -1
    v_mov_b32 v71, -1
    v_mov_b32 v44, 0
    v_mov_b32 v45, 0
    v_mov_b32 v46, 0
    s_bfe_u32 s49, s2, 0x10001
    s_lshl_b32 s49, s49, 3
    s_bfe_u32 s50, s2, 0x30003
    s_add_u32 s49, s49, s50
    s_bfe_u32 s50, s2, 0x10002
    s_lshl_b32 s50, s50, 2
    s_lshr_b32 s51, s2, 6
    s_add_u32 s50, s50, s51
    s_lshl_b32 s50, s50, 1
    s_and_b32 s51, s2, 1
    s_add_u32 s50, s50, s51
    s_lshl_b32 s56, s49, 4
    s_add_u32 s56, s56, s50
    s_lshl_b32 s49, s49, 2
    s_add_u32 s49, s49, s39
    s_lshl_b32 s49, s49, 4
    s_add_u32 s49, s49, s50
    s_lshl_b32 s49, s49, 1
    s_add_u32 s49, s49, s40
    s_mul_i32 s49, s49, 1152
    s_lshl_b32 s50, s39, 4
    v_add_u32 v7, s50, v5
    s_mul_i32 s55, s3, 1184
    s_xor_b32 s50, s2, 54
    s_or_b32 s50, s50, s3
    s_waitcnt lgkmcnt(0)
    s_cbranch_scc1 f_nolead
    s_or_b32 s59, s52, 1
    v_mov_b32 v4, s59
    s_mov_b64 exec, 1
    buffer_store_dword v4, off, s[24:27], 0 offset:252 sc1
    s_mov_b64 exec, -1
f_nolead:
    s_or_b32 s59, s52, 1
    s_cmp_lt_u32 s41, 54
    s_cbranch_scc1 f_nonsl
    s_sleep 6
f_nonsl:
    s_cmp_lt_u32 s41, 162
    s_cbranch_scc0 f_nogemv1
    buffer_load_short_d16_hi v44, v2, s[16:19], s45 offen offset:0
    buffer_load_dwordx4 v[48:51], v3, s[20:23], s46 offen
    s_add_u32 s46, s46, 442368
    buffer_load_dwordx4 v[52:55], v3, s[20:23], s46 offen
    s_add_u32 s46, s46, 442368
    buffer_load_dwordx4 v[56:59], v3, s[20:23], s46 offen
    s_cmp_lt_u32 s41, 54
    s_cbranch_scc1 f_issue2
f_nogemv1:
    s_add_u32 m0, s55, 9728
    s_nop 0
    buffer_load_dwordx4 v109, s[4:7], s49 offen lds
    s_mov_b64 exec, 0xff
    buffer_load_dwordx4 v109, s[4:7], s49 offen offset:1024 lds
    s_mov_b64 exec, -1
    s_and_b32 s50, s37, 7
    s_lshl_b32 s50, s50, 2
    s_add_u32 s50, s50, s39
    s_lshl_b32 s50, s50, 3
    s_add_u32 s50, s50, s36
    s_mul_i32 s50, s50, 4624
    s_lshr_b32 s51, s2, 6
    s_mul_i32 s51, s51, 1152
    s_add_u32 s50, s50, s51
    s_mul_i32 s51, s3, 5120
    s_add_u32 m0, s51, 65536
    s_cmp_eq_u32 s40, 0
    s_cselect_b32 s8, s8, s12
    s_cselect_b32 s9, s9, s13
    buffer_load_dwordx4 v109, s[8:11], s50 offen lds
    s_mov_b64 exec, 0x1ff
    buffer_load_dwordx4 v109, s[8:11], s50 offen offset:1024 lds
    s_mov_b64 exec, -1
    s_sub_u32 s50, s2, 176
    s_cmp_lt_u32 s50, 80
    s_cbranch_scc0 f_noslot
    s_lshl_b32 s50, s50, 3
    s_add_u32 s50, s50, s3
    s_mul_i32 s50, s50, 4096
    s_add_u32 s50, s50, 4194304
    buffer_store_dwordx4 v[68:71], v109, s[28:31], s50 offen offset:0 sc1
    buffer_store_dwordx4 v[68:71], v109, s[28:31], s50 offen offset:1024 sc1
    buffer_store_dwordx4 v[68:71], v109, s[28:31], s50 offen offset:2048 sc1
    buffer_store_dwordx4 v[68:71], v109, s[28:31], s50 offen offset:3072 sc1
f_noslot:
f_issue2:
    v_mul_u32_u24 v118, 1152, v6
    v_lshl_add_u32 v118, v7, 1, v118
    s_lshl_b32 s52, s38, 1
    s_add_u32 s52, s52, s40
    s_mul_i32 s52, s52, 4608
    v_mov_b32 v8, 0
    v_mov_b32 v9, 0
    v_mov_b32 v10, 0
    v_mov_b32 v11, 0
    v_mov_b32 v12, 0
    v_mov_b32 v13, 0
    v_mov_b32 v14, 0
    v_mov_b32 v15, 0
    v_mov_b32 v16, 0
    v_mov_b32 v18, 0
    v_mov_b32 v19, 0
    v_mov_b32 v20, 0
    v_mov_b32 v21, 0
    v_mov_b32 v22, 0
    v_mov_b32 v23, 0
    v_mov_b32 v24, 0
    v_mov_b32 v25, 0
    v_mov_b32 v26, 0
    s_add_u32 s53, s38, 64
    s_lshl_b32 s54, s36, 2
    s_add_u32 s54, s54, s37
    s_cmp_lt_u32 s2, 32
    s_cselect_b32 s54, s54, -1
    s_cmp_eq_u32 s2, 32
    s_cselect_b32 s54, 32, s54
    s_cmp_eq_u32 s40, 0
    s_cselect_b32 s42, s53, s54
    s_lshl_b32 s50, s40, 2
    s_add_u32 s50, s50, s39
    s_mul_i32 s50, s50, 272
    s_add_u32 s50, s50, 9728
    v_add_u32 v104, s50, v125
    v_mul_u32_u24 v2, 272, v5
    v_lshl_add_u32 v2, v6, 4, v2
    s_mul_i32 s50, s40, 8704
    s_add_u32 s51, s50, 9728
    v_add_u32 v105, s51, v2
    s_add_u32 s51, s50, 46336
    v_add_u32 v111, s51, v2
    v_mul_u32_u24 v2, 1088, v6
    v_lshl_add_u32 v2, v7, 2, v2
    v_add_u32 v110, s51, v2
    v_lshrrev_b32 v2, 1, v6
    v_lshl_add_u32 v2, v2, 6, v7
    v_and_b32 v3, 1, v6
    v_lshlrev_b32 v3, 4, v3
    v_lshl_add_u32 v2, v2, 5, v3
    s_lshl_b32 s50, s40, 13
    v_add_u32 v106, s50, v2
    v_add_u32 v107, 4096, v2
    v_cmp_lt_u32 vcc, 1, v6
    s_cmp_eq_u32 s40, 1
    s_cselect_b64 s[50:51], vcc, 0
    v_mov_b32 v3, 0x7f000000
    v_cndmask_b32 v106, v106, v3, s[50:51]
    s_mul_i32 s56, s56, 10240
    s_add_u32 s56, s56, 4194304
    v_lshrrev_b32 v2, 1, v5
    v_lshl_add_u32 v2, v6, 4, v2
    v_mul_u32_u24 v2, 10240, v2
    v_and_b32 v3, 1, v5
    v_lshl_add_u32 v108, v3, 4, v2
    v_lshlrev_b32 v2, 6, v7
    v_lshl_add_u32 v112, v6, 4, v2
    v_lshrrev_b32 v2, 1, v1
    s_and_b32 s50, s3, 1
    s_lshl_b32 s50, s50, 5
    v_add_u32 v2, s50, v2
    v_and_b32 v3, 1, v1
    s_lshr_b32 s51, s3, 1
    v_mul_u32_u24 v4, 5760, v3
    v_lshl_add_u32 v4, v2, 3, v4
    s_mul_i32 s50, s51, 576
    s_add_u32 s50, s50, 17920
    v_add_u32 v115, s50, v4
    v_lshlrev_b32 v3, 4, v3
    v_lshl_add_u32 v114, v2, 13, v3
    v_add_u32 v114, 2097152, v114
    v_sub_u32 v4, 64, v2
    v_min_u32 v4, v4, v2
    s_cmp_eq_u32 s51, 0
    s_cselect_b64 vcc, -1, 0
    v_cndmask_b32 v2, v2, v4, vcc
    s_lshl_b32 s51, s51, 19
    v_lshl_add_u32 v113, v2, 13, v3
    v_add_u32 v113, s51, v113
    v_lshrrev_b32 v2, 2, v5
    v_lshl_add_u32 v2, v6, 2, v2
    v_lshlrev_b32 v2, 3, v2
    s_mul_i32 s50, s40, 5760
    s_add_u32 s50, s50, 17920
    v_add_u32 v117, s50, v2
    v_and_b32 v2, 3, v1
    v_add_u32 v2, 1, v2
    v_mul_u32_u24 v2, 576, v2
    v_add_u32 v116, v2, v117
    s_lshl_b32 s50, s40, 7
    s_add_u32 s50, s50, 29440
    v_lshl_add_u32 v119, v6, 5, s50
    s_lshl_b32 s50, s39, 3
    v_add_u32 v120, s50, v119
    s_mov_b32 s50, 391680
    v_lshl_add_u32 v2, v6, 6, v7
    s_lshl_b32 s51, s40, 3
    s_add_u32 s51, s51, 17920
    v_lshl_add_u32 v121, v2, 4, s51
    v_mul_u32_u24 v3, 683, v0
    v_lshrrev_b32 v3, 16, v3
    v_mul_lo_u32 v3, v3, s50
    v_lshl_add_u32 v122, v0, 4, v3
    v_add_u32 v2, 256, v0
    v_mul_u32_u24 v3, 683, v2
    v_lshrrev_b32 v3, 16, v3
    v_mul_lo_u32 v3, v3, s50
    v_lshl_add_u32 v118, v2, 4, v3
    v_add_u32 v123, 1966592, v109
    v_lshlrev_b32 v124, 2, v7
    v_mul_u32_u24 v2, 1184, v6
    v_lshl_add_u32 v2, v7, 1, v2
    s_mul_i32 s50, s40, 4736
    s_add_u32 s50, s50, 0
    v_add_u32 v127, s50, v2
    s_and_b32 s50, s2, 1
    s_mul_i32 s50, s50, 1152
    v_cmp_lt_u32 vcc, 431, v0
    v_mov_b32 v3, s50
    s_nop 0
    v_cndmask_b32 v3, 0, v3, vcc
    v_lshl_add_u32 v126, v0, 4, v3
    s_mul_i32 s57, s36, 4617
    s_lshr_b32 s57, s57, 10
    s_lshl_b32 s57, s57, 8
    v_mul_u32_u24 v2, 26, v1
    v_lshrrev_b32 v2, 8, v2
    v_mul_u32_u24 v2, 7936, v2
    v_lshl_add_u32 v17, v1, 7, v2
    s_cmp_lt_u32 s41, 54
    s_cbranch_scc0 f_notag
    s_add_u32 m0, s55, 9728
    s_nop 0
    buffer_load_dwordx4 v109, s[4:7], s49 offen lds
    s_mov_b64 exec, 0xff
    buffer_load_dwordx4 v109, s[4:7], s49 offen offset:1024 lds
    s_mov_b64 exec, -1
    s_and_b32 s50, s37, 7
    s_lshl_b32 s50, s50, 2
    s_add_u32 s50, s50, s39
    s_lshl_b32 s50, s50, 3
    s_add_u32 s50, s50, s36
    s_mul_i32 s50, s50, 4624
    s_lshr_b32 s51, s2, 6
    s_mul_i32 s51, s51, 1152
    s_add_u32 s50, s50, s51
    s_mul_i32 s51, s3, 5120
    s_add_u32 m0, s51, 65536
    s_cmp_eq_u32 s40, 0
    s_cselect_b32 s8, s8, s12
    s_cselect_b32 s9, s9, s13
    buffer_load_dwordx4 v109, s[8:11], s50 offen lds
    s_mov_b64 exec, 0x1ff
    buffer_load_dwordx4 v109, s[8:11], s50 offen offset:1024 lds
    s_mov_b64 exec, -1
    s_lshl_b32 s50, s41, 2
    v_mov_b32 v4, s59
    s_mov_b64 exec, 1
    s_cmp_eq_u32 s3, 7
    s_cbranch_scc0 f_filler
    buffer_store_dword v4, off, s[24:27], s50 sc1
    s_branch f_filled
f_filler:
    buffer_load_dword v99, off, s[16:19], 0
f_filled:
    s_mov_b64 exec, -1
    s_branch f_c1done
f_notag:
    v_cvt_f32_u32 v84, v7
    v_cvt_f32_u32 v85, v6
    v_mul_f32 v86, v85, v84
    v_mul_f32 v86, 0x3d800000, v86
    v_fmamk_f32 v72, v84, 0x00000000, v86
    v_cos_f32 v73, v72
    v_sin_f32 v74, v72
    v_fmamk_f32 v75, v84, 0x3c800000, v86
    v_cos_f32 v76, v75
    v_sin_f32 v77, v75
    v_cvt_pk_bf16_f32 v128, v73, v74
    v_cvt_pk_bf16_f32 v144, -v74, v73
    v_fmamk_f32 v72, v84, 0x3d000000, v86
    v_cos_f32 v73, v72
    v_sin_f32 v74, v72
    v_cvt_pk_bf16_f32 v129, v76, v77
    v_cvt_pk_bf16_f32 v145, -v77, v76
    v_fmamk_f32 v75, v84, 0x3d400000, v86
    v_cos_f32 v76, v75
    v_sin_f32 v77, v75
    v_cvt_pk_bf16_f32 v130, v73, v74
    v_cvt_pk_bf16_f32 v146, -v74, v73
    v_fmamk_f32 v72, v84, 0x3e800000, v86
    v_cos_f32 v73, v72
    v_sin_f32 v74, v72
    v_cvt_pk_bf16_f32 v131, v76, v77
    v_cvt_pk_bf16_f32 v147, -v77, v76
    v_fmamk_f32 v75, v84, 0x3e880000, v86
    v_cos_f32 v76, v75
    v_sin_f32 v77, v75
    v_cvt_pk_bf16_f32 v132, v73, v74
    v_cvt_pk_bf16_f32 v148, -v74, v73
    v_fmamk_f32 v72, v84, 0x3e900000, v86
    v_cos_f32 v73, v72
    v_sin_f32 v74, v72
    v_cvt_pk_bf16_f32 v133, v76, v77
    v_cvt_pk_bf16_f32 v149, -v77, v76
    v_fmamk_f32 v75, v84, 0x3e980000, v86
    v_cos_f32 v76, v75
    v_sin_f32 v77, v75
    v_cvt_pk_bf16_f32 v134, v73, v74
    v_cvt_pk_bf16_f32 v150, -v74, v73
    v_fmamk_f32 v72, v84, 0x3f000000, v86
    v_cos_f32 v73, v72
    v_sin_f32 v74, v72
    v_cvt_pk_bf16_f32 v135, v76, v77
    v_cvt_pk_bf16_f32 v151, -v77, v76
    v_fmamk_f32 v75, v84, 0x3f040000, v86
    v_cos_f32 v76, v75
    v_sin_f32 v77, v75
    v_cvt_pk_bf16_f32 v136, v73, v74
    v_cvt_pk_bf16_f32 v152, -v74, v73
    v_fmamk_f32 v72, v84, 0x3f080000, v86
    v_cos_f32 v73, v72
    v_sin_f32 v74, v72
    v_cvt_pk_bf16_f32 v137, v76, v77
    v_cvt_pk_bf16_f32 v153, -v77, v76
    v_fmamk_f32 v75, v84, 0x3f0c0000, v86
    v_cos_f32 v76, v75
    v_sin_f32 v77, v75
    v_cvt_pk_bf16_f32 v138, v73, v74
    v_cvt_pk_bf16_f32 v154, -v74, v73
    v_fmamk_f32 v72, v84, 0x3f400000, v86
    v_cos_f32 v73, v72
    v_sin_f32 v74, v72
    v_cvt_pk_bf16_f32 v139, v76, v77
    v_cvt_pk_bf16_f32 v155, -v77, v76
    v_fmamk_f32 v75, v84, 0x3f440000, v86
    v_cos_f32 v76, v75
    v_sin_f32 v77, v75
    v_cvt_pk_bf16_f32 v140, v73, v74
    v_cvt_pk_bf16_f32 v156, -v74, v73
    v_fmamk_f32 v72, v84, 0x3f480000, v86
    v_cos_f32 v73, v72
    v_sin_f32 v74, v72
    v_cvt_pk_bf16_f32 v141, v76, v77
    v_cvt_pk_bf16_f32 v157, -v77, v76
    v_fmamk_f32 v75, v84, 0x3f4c0000, v86
    v_cos_f32 v76, v75
    v_sin_f32 v77, v75
    v_cvt_pk_bf16_f32 v142, v73, v74
    v_cvt_pk_bf16_f32 v158, -v74, v73
    v_cvt_pk_bf16_f32 v143, v76, v77
    v_cvt_pk_bf16_f32 v159, -v77, v76
    v_cvt_f32_u32 v82, v1
    v_mul_f32 v73, 0x3ae38e39, v82
    v_mul_f32 v74, 0x3b638e39, v82
    v_mul_f32 v75, 0x3baaaaab, v82
    v_mul_f32 v76, 0x3be38e39, v82
    v_cos_f32 v208, v73
    v_sin_f32 v212, v73
    v_cos_f32 v209, v74
    v_sin_f32 v213, v74
    v_cos_f32 v210, v75
    v_sin_f32 v214, v75
    v_cos_f32 v211, v76
    v_sin_f32 v215, v76
f_c1done:
    s_lshl_b32 s49, s38, 3
    s_add_u32 s49, s49, s3
    s_mul_i32 s49, s49, 1152
    s_cmp_lt_u32 s41, 162
    s_cbranch_scc0 f_other
    s_mov_b32 s47, 0xffff0000
    s_cmp_lt_u32 s41, 54
    v_lshrrev_b32 v2, 3, v1
    v_lshlrev_b32 v2, 2, v2
    s_waitcnt vmcnt(8)
    s_cbranch_scc1 gw_5
    s_waitcnt vmcnt(7)
gw_5:
    v_mul_f32 v72, 0xbfb8aa3b, v44
    v_exp_f32 v72, v72
    s_nop 0
    v_add_f32 v72, 1.0, v72
    v_rcp_f32 v72, v72
    s_nop 0
    v_mul_f32 v44, v44, v72
    v_cvt_pk_bf16_f32 v44, v44, v44
    v_lshlrev_b32 v44, 16, v44
    ds_bpermute_b32 v45, v2, v44 offset:32
    ds_bpermute_b32 v46, v2, v44 offset:64
    ds_bpermute_b32 v44, v2, v44 offset:0
    s_waitcnt vmcnt(7)
    s_cbranch_scc1 gw_6
    s_waitcnt vmcnt(6)
gw_6:
    v_lshlrev_b32 v72, 16, v48
    v_and_b32 v73, s47, v48
    v_lshlrev_b32 v74, 16, v49
    v_and_b32 v75, s47, v49
    v_lshlrev_b32 v76, 16, v50
    v_and_b32 v77, s47, v50
    v_lshlrev_b32 v78, 16, v51
    v_and_b32 v79, s47, v51
    s_waitcnt lgkmcnt(0)
    v_pk_mul_f32 v[60:61], v[72:73], v[44:45] op_sel_hi:[1,0]
    v_pk_mul_f32 v[62:63], v[74:75], v[44:45] op_sel_hi:[1,0]
    v_pk_mul_f32 v[64:65], v[76:77], v[44:45] op_sel_hi:[1,0]
    v_pk_mul_f32 v[66:67], v[78:79], v[44:45] op_sel_hi:[1,0]
    s_waitcnt vmcnt(6)
    s_cbranch_scc1 gw_7
    s_waitcnt vmcnt(5)
gw_7:
    v_lshlrev_b32 v72, 16, v52
    v_and_b32 v73, s47, v52
    v_lshlrev_b32 v74, 16, v53
    v_and_b32 v75, s47, v53
    v_lshlrev_b32 v76, 16, v54
    v_and_b32 v77, s47, v54
    v_lshlrev_b32 v78, 16, v55
    v_and_b32 v79, s47, v55
    v_pk_fma_f32 v[60:61], v[72:73], v[44:45], v[60:61] op_sel:[0,1,0]
    v_pk_fma_f32 v[62:63], v[74:75], v[44:45], v[62:63] op_sel:[0,1,0]
    v_pk_fma_f32 v[64:65], v[76:77], v[44:45], v[64:65] op_sel:[0,1,0]
    v_pk_fma_f32 v[66:67], v[78:79], v[44:45], v[66:67] op_sel:[0,1,0]
    s_waitcnt vmcnt(5)
    s_cbranch_scc1 gw_8
    s_waitcnt vmcnt(4)
gw_8:
    v_lshlrev_b32 v72, 16, v56
    v_and_b32 v73, s47, v56
    v_lshlrev_b32 v74, 16, v57
    v_and_b32 v75, s47, v57
    v_lshlrev_b32 v76, 16, v58
    v_and_b32 v77, s47, v58
    v_lshlrev_b32 v78, 16, v59
    v_and_b32 v79, s47, v59
    v_pk_fma_f32 v[60:61], v[72:73], v[46:47], v[60:61] op_sel_hi:[1,0,1]
    v_pk_fma_f32 v[62:63], v[74:75], v[46:47], v[62:63] op_sel_hi:[1,0,1]
    v_pk_fma_f32 v[64:65], v[76:77], v[46:47], v[64:65] op_sel_hi:[1,0,1]
    v_pk_fma_f32 v[66:67], v[78:79], v[46:47], v[66:67] op_sel_hi:[1,0,1]
    v_permlane16_swap_b32 v60, v61
    v_permlane16_swap_b32 v62, v63
    v_permlane16_swap_b32 v64, v65
    v_permlane16_swap_b32 v66, v67
    v_add_f32 v60, v60, v61
    v_add_f32 v62, v62, v63
    v_add_f32 v64, v64, v65
    v_add_f32 v66, v66, v67
    v_permlane32_swap_b32 v60, v62
    s_nop 0
    v_permlane32_swap_b32 v64, v66
    v_add_f32 v60, v60, v62
    v_add_f32 v64, v64, v66
    s_nop 0
    v_add_f32_dpp v60, v60, v60 row_ror:8 row_mask:0xf bank_mask:0xf
    v_add_f32_dpp v64, v64, v64 row_ror:8 row_mask:0xf bank_mask:0xf
    v_cmp_lt_u32 vcc, 7, v5
    s_nop 1
    v_cndmask_b32 v60, v60, v64, vcc
    v_and_b32 v2, 7, v5
    v_lshrrev_b32 v3, 3, v5
    v_lshl_add_u32 v2, v2, 1, v3
    v_lshl_add_u32 v2, v2, 2, v6
    s_lshl_b32 s50, s3, 8
    s_add_u32 s50, s50, 4608
    v_lshl_add_u32 v2, v2, 2, s50
    ds_write_b32 v2, v60
    s_cmp_lt_u32 s41, 54
    s_cbranch_scc0 f_other
    s_waitcnt lgkmcnt(0)
    s_barrier
    s_cmp_eq_u32 s3, 7
    s_cbranch_scc0 f_noposta
    ds_read2st64_b32 v[60:61], v125 offset0:18 offset1:19
    ds_read2st64_b32 v[62:63], v125 offset0:20 offset1:21
    ds_read2st64_b32 v[64:65], v125 offset0:22 offset1:23
    ds_read2st64_b32 v[66:67], v125 offset0:24 offset1:25
    v_lshlrev_b32 v2, 3, v1
    s_waitcnt lgkmcnt(0)
    v_pk_add_f32 v[60:61], v[60:61], v[62:63]
    v_pk_add_f32 v[64:65], v[64:65], v[66:67]
    v_pk_add_f32 v[60:61], v[60:61], v[64:65]
    v_add_f32 v60, v60, v61
    v_mov_b32 v61, s59
    buffer_store_dwordx2 v[60:61], v2, s[28:31], s48 offen sc1
    s_waitcnt vmcnt(4)
    s_branch f_ln
f_noposta:
    s_waitcnt vmcnt(3)
    s_branch f_ln
f_other:
    s_waitcnt vmcnt(6)
    s_cmp_lt_u32 s2, 176
    s_cbranch_scc0 f_poi1
    s_waitcnt vmcnt(2)
    s_branch f_ln
f_poi1:
    s_cmp_eq_u32 s3, 7
    s_cbranch_scc0 f_ln
    buffer_load_dword v99, off, s[24:27], 0 offset:252 sc1
f_ln:
    v_lshlrev_b32 v2, 1, v1
    s_add_u32 s50, s55, 9728
    v_add_u32 v2, s50, v2
    ds_read_u16_d16_hi v8, v2 offset:0
    ds_read_u16_d16_hi v9, v2 offset:128
    ds_read_u16_d16_hi v10, v2 offset:256
    ds_read_u16_d16_hi v11, v2 offset:384
    ds_read_u16_d16_hi v12, v2 offset:512
    ds_read_u16_d16_hi v13, v2 offset:640
    ds_read_u16_d16_hi v14, v2 offset:768
    ds_read_u16_d16_hi v15, v2 offset:896
    ds_read_u16_d16_hi v16, v2 offset:1024
    s_waitcnt lgkmcnt(0)
    v_add_f32 v80, v8, v9
    v_add_f32 v80, v80, v10
    v_add_f32 v80, v80, v11
    v_add_f32 v80, v80, v12
    v_add_f32 v80, v80, v13
    v_add_f32 v80, v80, v14
    v_add_f32 v80, v80, v15
    v_add_f32 v80, v80, v16
    s_nop 1
    v_add_f32_dpp v80, v80, v80 quad_perm:[1,0,3,2] row_mask:0xf bank_mask:0xf
    s_nop 1
    v_add_f32_dpp v80, v80, v80 quad_perm:[2,3,0,1] row_mask:0xf bank_mask:0xf
    s_nop 1
    v_add_f32_dpp v80, v80, v80 row_half_mirror row_mask:0xf bank_mask:0xf
    s_nop 1
    v_add_f32_dpp v80, v80, v80 row_mirror row_mask:0xf bank_mask:0xf
    v_mov_b32 v72, v80
    s_nop 1
    v_permlane16_swap_b32 v80, v72
    v_add_f32 v80, v80, v72
    v_mov_b32 v72, v80
    s_nop 1
    v_permlane32_swap_b32 v80, v72
    v_add_f32 v80, v80, v72
    v_mul_f32 v80, 0x3ae38e39, v80
    v_sub_f32 v8, v8, v80
    v_sub_f32 v9, v9, v80
    v_sub_f32 v10, v10, v80
    v_sub_f32 v11, v11, v80
    v_sub_f32 v12, v12, v80
    v_sub_f32 v13, v13, v80
    v_sub_f32 v14, v14, v80
    v_sub_f32 v15, v15, v80
    v_sub_f32 v16, v16, v80
    v_mul_f32 v81, v8, v8
    v_fmac_f32 v81, v9, v9
    v_fmac_f32 v81, v10, v10
    v_fmac_f32 v81, v11, v11
    v_fmac_f32 v81, v12, v12
    v_fmac_f32 v81, v13, v13
    v_fmac_f32 v81, v14, v14
    v_fmac_f32 v81, v15, v15
    v_fmac_f32 v81, v16, v16
    s_nop 1
    v_add_f32_dpp v81, v81, v81 quad_perm:[1,0,3,2] row_mask:0xf bank_mask:0xf
    s_nop 1
    v_add_f32_dpp v81, v81, v81 quad_perm:[2,3,0,1] row_mask:0xf bank_mask:0xf
    s_nop 1
    v_add_f32_dpp v81, v81, v81 row_half_mirror row_mask:0xf bank_mask:0xf
    s_nop 1
    v_add_f32_dpp v81, v81, v81 row_mirror row_mask:0xf bank_mask:0xf
    v_mov_b32 v72, v81
    s_nop 1
    v_permlane16_swap_b32 v81, v72
    v_add_f32 v81, v81, v72
    v_mov_b32 v72, v81
    s_nop 1
    v_permlane32_swap_b32 v81, v72
    v_add_f32 v81, v81, v72
    v_mov_b32 v72, 0x3727c5ac
    v_fmamk_f32 v81, v81, 0x3ae38e39, v72
    v_rsq_f32 v81, v81
    s_nop 0
    v_mul_f32 v8, v8, v81
    v_mul_f32 v9, v9, v81
    v_mul_f32 v10, v10, v81
    v_mul_f32 v11, v11, v81
    v_mul_f32 v12, v12, v81
    v_mul_f32 v13, v13, v81
    v_mul_f32 v14, v14, v81
    v_mul_f32 v15, v15, v81
    v_mul_f32 v16, v16, v81
    s_waitcnt vmcnt(2)
    s_cmp_lt_u32 s41, 54
    s_cselect_b32 s50, s3, 8
    s_cmp_eq_u32 s50, 7
    s_cbranch_scc1 f_b0
    s_waitcnt vmcnt(1)
    s_cmp_lt_u32 s50, 8
    s_cbranch_scc1 f_b0
    s_waitcnt vmcnt(0)
f_b0:
    s_waitcnt lgkmcnt(0)
    s_barrier
    s_cmp_lt_u32 s3, 3
    s_cbranch_scc1 f_nozp2
    s_cmp_eq_u32 s3, 7
    s_cbranch_scc0 f_nopostb
    s_cmp_lt_u32 s2, 176
    s_cbranch_scc1 f_nopoi2
    v_readfirstlane_b32 s50, v99
    s_nop 0
    s_cmp_eq_u32 s50, 0
    s_cbranch_scc0 f_tagok
    s_mov_b64 exec, 1
    s_mov_b32 s50, 0
f_an2b:
    buffer_load_dword v99, off, s[24:27], 0 offset:252 sc1
    s_add_u32 s50, s50, 1
    s_waitcnt vmcnt(0)
    v_cmp_eq_u32 vcc, 0, v99
    s_nop 1
    s_cbranch_vccz f_an2b_ok
    s_sleep 2
    s_cmp_lt_u32 s50, 30000
    s_cbranch_scc1 f_an2b
f_an2b_ok:
    s_mov_b64 exec, -1
f_tagok:
    s_lshl_b32 s50, s2, 6
    s_add_u32 s50, s50, 147456
    s_mov_b64 exec, 1
    buffer_store_dword v99, off, s[28:31], s50 sc1
    s_mov_b64 exec, -1
f_nopoi2:
    s_sub_u32 s50, s41, 54
    s_cmp_lt_u32 s50, 108
    s_cbranch_scc0 f_nopostb
    ds_read2st64_b32 v[60:61], v125 offset0:18 offset1:19
    ds_read2st64_b32 v[62:63], v125 offset0:20 offset1:21
    ds_read2st64_b32 v[64:65], v125 offset0:22 offset1:23
    ds_read2st64_b32 v[66:67], v125 offset0:24 offset1:25
    v_lshlrev_b32 v2, 3, v1
    s_waitcnt lgkmcnt(0)
    v_pk_add_f32 v[60:61], v[60:61], v[62:63]
    v_pk_add_f32 v[64:65], v[64:65], v[66:67]
    v_pk_add_f32 v[60:61], v[60:61], v[64:65]
    v_add_f32 v60, v60, v61
    buffer_store_dword v60, v125, s[28:31], s48 offen sc1
f_nopostb:
    v_subrev_u32 v4, 192, v0
    v_lshlrev_b32 v3, 4, v4
    s_mul_i32 s50, s2, 9344
    s_add_u32 s50, s50, 1048576
    s_add_u32 s51, s50, 5120
    v_and_b32 v2, 1, v0
    v_mul_u32_u24 v2, 577, v2
    v_add_u32 v2, v2, v4
    s_lshr_b32 s46, s2, 6
    s_lshl_b32 s46, s46, 2
    s_add_u32 s46, s46, 65536
    v_add_u32 v2, s46, v2
    ds_read_u16 v28, v2 offset:0
    ds_read_u16 v32, v2 offset:20480
    ds_read_u16 v29, v2 offset:5120
    ds_read_u16 v33, v2 offset:25600
    ds_read_u16 v30, v2 offset:10240
    ds_read_u16 v34, v2 offset:30720
    ds_read_u16 v31, v2 offset:15360
    ds_read_u16 v35, v2 offset:35840
    ds_read_u16 v36, v2 offset:320
    ds_read_u16 v40, v2 offset:20800
    ds_read_u16 v37, v2 offset:5440
    ds_read_u16 v41, v2 offset:25920
    ds_read_u16 v38, v2 offset:10560
    ds_read_u16 v42, v2 offset:31040
    ds_read_u16 v39, v2 offset:15680
    ds_read_u16 v43, v2 offset:36160
    v_cmp_gt_u32 vcc, 264, v4
    v_mov_b32 v4, 0x7f000000
    s_nop 0
    v_cndmask_b32 v4, v4, v3, vcc
    s_waitcnt lgkmcnt(8)
    v_lshl_or_b32 v28, v32, 16, v28
    v_lshl_or_b32 v29, v33, 16, v29
    v_lshl_or_b32 v30, v34, 16, v30
    v_lshl_or_b32 v31, v35, 16, v31
    buffer_store_dwordx4 v[28:31], v3, s[28:31], s50 offen sc1
    s_waitcnt lgkmcnt(0)
    v_lshl_or_b32 v36, v40, 16, v36
    v_lshl_or_b32 v37, v41, 16, v37
    v_lshl_or_b32 v38, v42, 16, v38
    v_lshl_or_b32 v39, v43, 16, v39
    buffer_store_dwordx4 v[36:39], v4, s[28:31], s51 offen sc1
    s_cmp_lt_u32 s3, 4
    s_cbranch_scc1 f_nozp2
    s_lshl_b32 s51, s39, 11
    s_add_u32 s51, s51, 7340032
    s_lshl_b32 s50, s53, 13
    s_add_u32 s50, s50, s51
    buffer_store_dwordx4 v[68:71], v109, s[28:31], s50 offen offset:0 sc1
    buffer_store_dwordx4 v[68:71], v109, s[28:31], s50 offen offset:1024 sc1
    s_cmp_lt_u32 s2, 33
    s_cbranch_scc0 f_nozp2
    s_lshl_b32 s50, s54, 13
    s_add_u32 s50, s50, s51
    buffer_store_dwordx4 v[68:71], v109, s[28:31], s50 offen offset:0 sc1
    buffer_store_dwordx4 v[68:71], v109, s[28:31], s50 offen offset:1024 sc1
f_nozp2:
    s_cmp_lt_u32 s41, 54
    s_cbranch_scc0 f_c1done2
    v_cvt_f32_u32 v84, v7
    v_cvt_f32_u32 v85, v6
    v_mul_f32 v86, v85, v84
    v_mul_f32 v86, 0x3d800000, v86
    v_fmamk_f32 v72, v84, 0x00000000, v86
    v_cos_f32 v73, v72
    v_sin_f32 v74, v72
    v_fmamk_f32 v75, v84, 0x3c800000, v86
    v_cos_f32 v76, v75
    v_sin_f32 v77, v75
    v_cvt_pk_bf16_f32 v128, v73, v74
    v_cvt_pk_bf16_f32 v144, -v74, v73
    v_fmamk_f32 v72, v84, 0x3d000000, v86
    v_cos_f32 v73, v72
    v_sin_f32 v74, v72
    v_cvt_pk_bf16_f32 v129, v76, v77
    v_cvt_pk_bf16_f32 v145, -v77, v76
    v_fmamk_f32 v75, v84, 0x3d400000, v86
    v_cos_f32 v76, v75
    v_sin_f32 v77, v75
    v_cvt_pk_bf16_f32 v130, v73, v74
    v_cvt_pk_bf16_f32 v146, -v74, v73
    v_fmamk_f32 v72, v84, 0x3e800000, v86
    v_cos_f32 v73, v72
    v_sin_f32 v74, v72
    v_cvt_pk_bf16_f32 v131, v76, v77
    v_cvt_pk_bf16_f32 v147, -v77, v76
    v_fmamk_f32 v75, v84, 0x3e880000, v86
    v_cos_f32 v76, v75
    v_sin_f32 v77, v75
    v_cvt_pk_bf16_f32 v132, v73, v74
    v_cvt_pk_bf16_f32 v148, -v74, v73
    v_fmamk_f32 v72, v84, 0x3e900000, v86
    v_cos_f32 v73, v72
    v_sin_f32 v74, v72
    v_cvt_pk_bf16_f32 v133, v76, v77
    v_cvt_pk_bf16_f32 v149, -v77, v76
    v_fmamk_f32 v75, v84, 0x3e980000, v86
    v_cos_f32 v76, v75
    v_sin_f32 v77, v75
    v_cvt_pk_bf16_f32 v134, v73, v74
    v_cvt_pk_bf16_f32 v150, -v74, v73
    v_fmamk_f32 v72, v84, 0x3f000000, v86
    v_cos_f32 v73, v72
    v_sin_f32 v74, v72
    v_cvt_pk_bf16_f32 v135, v76, v77
    v_cvt_pk_bf16_f32 v151, -v77, v76
    v_fmamk_f32 v75, v84, 0x3f040000, v86
    v_cos_f32 v76, v75
    v_sin_f32 v77, v75
    v_cvt_pk_bf16_f32 v136, v73, v74
    v_cvt_pk_bf16_f32 v152, -v74, v73
    v_fmamk_f32 v72, v84, 0x3f080000, v86
    v_cos_f32 v73, v72
    v_sin_f32 v74, v72
    v_cvt_pk_bf16_f32 v137, v76, v77
    v_cvt_pk_bf16_f32 v153, -v77, v76
    v_fmamk_f32 v75, v84, 0x3f0c0000, v86
    v_cos_f32 v76, v75
    v_sin_f32 v77, v75
    v_cvt_pk_bf16_f32 v138, v73, v74
    v_cvt_pk_bf16_f32 v154, -v74, v73
    v_fmamk_f32 v72, v84, 0x3f400000, v86
    v_cos_f32 v73, v72
    v_sin_f32 v74, v72
    v_cvt_pk_bf16_f32 v139, v76, v77
    v_cvt_pk_bf16_f32 v155, -v77, v76
    v_fmamk_f32 v75, v84, 0x3f440000, v86
    v_cos_f32 v76, v75
    v_sin_f32 v77, v75
    v_cvt_pk_bf16_f32 v140, v73, v74
    v_cvt_pk_bf16_f32 v156, -v74, v73
    v_fmamk_f32 v72, v84, 0x3f480000, v86
    v_cos_f32 v73, v72
    v_sin_f32 v74, v72
    v_cvt_pk_bf16_f32 v141, v76, v77
    v_cvt_pk_bf16_f32 v157, -v77, v76
    v_fmamk_f32 v75, v84, 0x3f4c0000, v86
    v_cos_f32 v76, v75
    v_sin_f32 v77, v75
    v_cvt_pk_bf16_f32 v142, v73, v74
    v_cvt_pk_bf16_f32 v158, -v74, v73
    v_cvt_pk_bf16_f32 v143, v76, v77
    v_cvt_pk_bf16_f32 v159, -v77, v76
    v_cvt_f32_u32 v82, v1
    v_mul_f32 v73, 0x3ae38e39, v82
    v_mul_f32 v74, 0x3b638e39, v82
    v_mul_f32 v75, 0x3baaaaab, v82
    v_mul_f32 v76, 0x3be38e39, v82
    v_cos_f32 v208, v73
    v_sin_f32 v212, v73
    v_cos_f32 v209, v74
    v_sin_f32 v213, v74
    v_cos_f32 v210, v75
    v_sin_f32 v214, v75
    v_cos_f32 v211, v76
    v_sin_f32 v215, v76
f_c1done2:
    s_cmp_lt_u32 s41, 54
    s_cbranch_scc1 f_nosl0
    s_sleep 2
f_nosl0:
    s_cmp_lt_u32 s3, 3
    s_cbranch_scc0 f_staged
    v_mul_u32_u24 v2, 48, v0
    s_mov_b32 s44, 0x20000
    s_mov_b32 s45, 0x22400
    s_mov_b32 s46, 0x24800
    v_cmp_lt_u32 vcc, 95, v0
    s_nop 1
    v_cndmask_b32 v3, 0, 1.0, vcc
    s_mov_b32 s47, 0xffff0000
    v_lshrrev_b32 v78, 9, v2
    v_add_u32 v79, 32, v2
    v_lshrrev_b32 v79, 9, v79
    v_add_u32 v80, 16, v2
    v_lshrrev_b32 v80, 9, v80
    v_cmp_ne_u32 s[50:51], v80, v78
    v_mul_u32_u24 v78, 12, v78
    v_mul_u32_u24 v79, 12, v79
    s_mov_b32 s43, 0
    buffer_load_dword v67, off, s[24:27], 0 offset:252
    buffer_load_dwordx3 v[64:66], v78, s[24:27], 0 offen
    buffer_load_dwordx3 v[68:70], v79, s[24:27], 0 offen
    buffer_load_dwordx4 v[28:31], v2, s[28:31], s44 offen offset:0
    buffer_load_dwordx4 v[32:35], v2, s[28:31], s44 offen offset:16
    buffer_load_dwordx4 v[36:39], v2, s[28:31], s44 offen offset:32
    buffer_load_dwordx4 v[40:43], v2, s[28:31], s45 offen offset:0
    buffer_load_dwordx4 v[44:47], v2, s[28:31], s45 offen offset:16
    buffer_load_dwordx4 v[48:51], v2, s[28:31], s45 offen offset:32
    buffer_load_dwordx4 v[52:55], v2, s[28:31], s46 offen offset:0
    buffer_load_dwordx4 v[56:59], v2, s[28:31], s46 offen offset:16
    buffer_load_dwordx4 v[60:63], v2, s[28:31], s46 offen offset:32
    s_branch f_mp_chk
f_mp:
    buffer_load_dword v67, off, s[24:27], 0 offset:252 sc1
    buffer_load_dwordx3 v[64:66], v78, s[24:27], 0 offen sc1
    buffer_load_dwordx3 v[68:70], v79, s[24:27], 0 offen sc1
    buffer_load_dwordx4 v[28:31], v2, s[28:31], s44 offen offset:0 sc1
    buffer_load_dwordx4 v[32:35], v2, s[28:31], s44 offen offset:16 sc1
    buffer_load_dwordx4 v[36:39], v2, s[28:31], s44 offen offset:32 sc1
    buffer_load_dwordx4 v[40:43], v2, s[28:31], s45 offen offset:0 sc1
    buffer_load_dwordx4 v[44:47], v2, s[28:31], s45 offen offset:16 sc1
    buffer_load_dwordx4 v[48:51], v2, s[28:31], s45 offen offset:32 sc1
    buffer_load_dwordx4 v[52:55], v2, s[28:31], s46 offen offset:0 sc1
    buffer_load_dwordx4 v[56:59], v2, s[28:31], s46 offen offset:16 sc1
    buffer_load_dwordx4 v[60:63], v2, s[28:31], s46 offen offset:32 sc1
f_mp_chk:
    s_add_u32 s43, s43, 1
    s_waitcnt vmcnt(9)
    v_cndmask_b32 v74, v64, v68, s[50:51]
    v_cndmask_b32 v75, v65, v69, s[50:51]
    v_cndmask_b32 v76, v66, v70, s[50:51]
    v_min3_u32 v72, v64, v65, v66
    v_min3_u32 v73, v68, v69, v70
    v_min3_u32 v72, v72, v73, v67
    v_cmp_eq_u32 s[58:59], 0, v72
    s_waitcnt vmcnt(6)
    v_xor_b32 v72, v29, v64
    v_xor_b32 v73, v31, v64
    v_bitop3_b32 v72, v33, v74, v72 bitop3:0xbe
    v_bitop3_b32 v73, v35, v74, v73 bitop3:0xbe
    v_bitop3_b32 v72, v37, v68, v72 bitop3:0xbe
    v_bitop3_b32 v73, v39, v68, v73 bitop3:0xbe
    s_waitcnt vmcnt(3)
    v_bitop3_b32 v72, v41, v65, v72 bitop3:0xbe
    v_bitop3_b32 v73, v43, v65, v73 bitop3:0xbe
    v_bitop3_b32 v72, v45, v75, v72 bitop3:0xbe
    v_bitop3_b32 v73, v47, v75, v73 bitop3:0xbe
    v_bitop3_b32 v72, v49, v69, v72 bitop3:0xbe
    v_bitop3_b32 v73, v51, v69, v73 bitop3:0xbe
    s_waitcnt vmcnt(0)
    v_bitop3_b32 v72, v53, v66, v72 bitop3:0xbe
    v_bitop3_b32 v73, v55, v66, v73 bitop3:0xbe
    v_bitop3_b32 v72, v57, v76, v72 bitop3:0xbe
    v_bitop3_b32 v73, v59, v76, v73 bitop3:0xbe
    v_bitop3_b32 v72, v61, v70, v72 bitop3:0xbe
    v_bitop3_b32 v73, v63, v70, v73 bitop3:0xbe
    v_or_b32 v72, v72, v73
    v_cmp_ne_u32 vcc, 0, v72
    s_nop 0
    s_or_b64 exec, vcc, s[58:59]
    s_cbranch_scc0 f_mp_ok
    s_cmp_lt_u32 s43, 30000
    s_cbranch_scc1 f_mp
f_mp_ok:
    s_mov_b64 exec, -1
    s_mov_b32 s50, s43
    v_readfirstlane_b32 s26, v67
    v_lshrrev_b32 v2, 1, v2
    v_add_f32 v74, v28, v40
    v_add_f32 v75, v30, v42
    v_add_f32 v76, v32, v44
    v_add_f32 v77, v34, v46
    v_add_f32 v78, v36, v48
    v_add_f32 v79, v38, v50
    v_add_f32 v74, v74, v52
    v_add_f32 v75, v75, v54
    v_add_f32 v76, v76, v56
    v_add_f32 v77, v77, v58
    v_add_f32 v78, v78, v60
    v_add_f32 v79, v79, v62
    v_cvt_pk_bf16_f32 v72, v74, v75
    v_lshlrev_b32 v74, 16, v72
    v_and_b32 v75, s47, v72
    v_cvt_pk_bf16_f32 v73, v76, v77
    v_lshlrev_b32 v76, 16, v73
    v_and_b32 v77, s47, v73
    v_cvt_pk_bf16_f32 v72, v78, v79
    v_lshlrev_b32 v78, 16, v72
    v_and_b32 v79, s47, v72
    v_add_f32 v74, v74, v3
    v_add_f32 v75, v75, v3
    v_add_f32 v76, v76, v3
    v_add_f32 v77, v77, v3
    v_add_f32 v78, v78, v3
    v_add_f32 v79, v79, v3
    v_cvt_pk_bf16_f32 v72, v74, v75
    v_lshlrev_b32 v74, 16, v72
    v_and_b32 v75, s47, v72
    v_cvt_pk_bf16_f32 v73, v76, v77
    v_lshlrev_b32 v76, 16, v73
    v_and_b32 v77, s47, v73
    v_cvt_pk_bf16_f32 v72, v78, v79
    v_lshlrev_b32 v78, 16, v72
    v_and_b32 v79, s47, v72
    ds_write_b64 v2, v[74:75] offset:0
    ds_write_b64 v2, v[76:77] offset:8
    ds_write_b64 v2, v[78:79] offset:16
f_staged:
    s_load_dwordx2 s[8:9], s[0:1], 48
    s_mov_b32 s10, 0x1200000
    s_load_dwordx2 s[12:13], s[0:1], 56
    s_mov_b32 s14, 0x1000
    s_load_dwordx2 s[16:17], s[0:1], 80
    s_mov_b32 s18, 0x240000
    s_load_dwordx2 s[20:21], s[0:1], 40
    s_mov_b32 s22, 0x2400
    s_waitcnt lgkmcnt(0)
    s_barrier
    s_cmp_eq_u32 s3, 3
    s_cbranch_scc0 f_nofp
    v_lshlrev_b32 v2, 6, v1
    v_min_u32 v3, 960, v2
    s_mov_b32 s51, 158720
    s_mov_b32 s46, 162816
    buffer_load_dword v98, off, s[24:27], 0 offset:252 sc1
    buffer_load_dword v99, v2, s[28:31], s51 offen sc1
    buffer_load_dword v100, v3, s[28:31], s46 offen sc1
f_nofp:
    ds_read2st64_b32 v[36:37], v125 offset0:8 offset1:9
    ds_read2st64_b32 v[38:39], v125 offset0:10 offset1:11
    ds_read2st64_b32 v[40:41], v125 offset0:12 offset1:13
    ds_read2st64_b32 v[42:43], v125 offset0:14 offset1:15
    ds_read2st64_b32 v[44:45], v125 offset0:16 offset1:17
    ds_read2st64_b32 v[28:29], v125 offset0:0 offset1:1
    ds_read2st64_b32 v[30:31], v125 offset0:2 offset1:3
    ds_read2st64_b32 v[32:33], v125 offset0:4 offset1:5
    ds_read2st64_b32 v[34:35], v125 offset0:6 offset1:7
    s_waitcnt lgkmcnt(3)
    v_fma_f32 v8, v8, v37, v28
    v_fma_f32 v9, v9, v38, v29
    s_waitcnt lgkmcnt(2)
    v_fma_f32 v10, v10, v39, v30
    v_fma_f32 v11, v11, v40, v31
    s_waitcnt lgkmcnt(1)
    v_fma_f32 v12, v12, v41, v32
    v_fma_f32 v13, v13, v42, v33
    s_waitcnt lgkmcnt(0)
    v_fma_f32 v14, v14, v43, v34
    v_fma_f32 v15, v15, v44, v35
    v_fma_f32 v16, v16, v45, v36
    v_add_f32 v48, v9, v16
    v_sub_f32 v52, v9, v16
    v_add_f32 v49, v10, v15
    v_sub_f32 v53, v10, v15
    v_add_f32 v50, v11, v14
    v_sub_f32 v54, v11, v14
    v_add_f32 v51, v12, v13
    v_sub_f32 v55, v12, v13
    v_add_f32 v64, v8, v48
    v_add_f32 v65, v49, v50
    v_add_f32 v64, v64, v51
    v_add_f32 v64, v64, v65
    v_fmamk_f32 v56, v48, 0x3f441b7d, v8
    v_fmamk_f32 v57, v48, 0x3e31d0d4, v8
    v_fmamk_f32 v58, v48, 0xbf000000, v8
    v_fmamk_f32 v59, v48, 0xbf708fb2, v8
    v_fmamk_f32 v56, v49, 0x3e31d0d4, v56
    v_fmamk_f32 v57, v49, 0xbf708fb2, v57
    v_fmamk_f32 v58, v49, 0xbf000000, v58
    v_fmamk_f32 v59, v49, 0x3f441b7d, v59
    v_fmamk_f32 v56, v50, 0xbf000000, v56
    v_fmamk_f32 v57, v50, 0xbf000000, v57
    v_fmamk_f32 v58, v50, 0x3f800000, v58
    v_fmamk_f32 v59, v50, 0xbf000000, v59
    v_fmamk_f32 v56, v51, 0xbf708fb2, v56
    v_fmamk_f32 v57, v51, 0x3f441b7d, v57
    v_fmamk_f32 v58, v51, 0xbf000000, v58
    v_fmamk_f32 v59, v51, 0x3e31d0d4, v59
    v_mul_f32 v60, 0xbf248dbb, v52
    v_mul_f32 v61, 0xbf7c1c5c, v52
    v_mul_f32 v62, 0xbf5db3d7, v52
    v_mul_f32 v63, 0xbeaf1d44, v52
    v_fmamk_f32 v60, v53, 0xbf7c1c5c, v60
    v_fmamk_f32 v61, v53, 0xbeaf1d44, v61
    v_fmamk_f32 v62, v53, 0x3f5db3d7, v62
    v_fmamk_f32 v63, v53, 0x3f248dbb, v63
    v_fmamk_f32 v60, v54, 0xbf5db3d7, v60
    v_fmamk_f32 v61, v54, 0x3f5db3d7, v61
    v_fmamk_f32 v63, v54, 0xbf5db3d7, v63
    v_fmamk_f32 v60, v55, 0xbeaf1d44, v60
    v_fmamk_f32 v61, v55, 0x3f248dbb, v61
    v_fmamk_f32 v62, v55, 0xbf5db3d7, v62
    v_fmamk_f32 v63, v55, 0x3f7c1c5c, v63
    v_cvt_pk_bf16_f32 v64, v64, 0
    ds_write_b32 v104, v64
    v_pk_mul_f32 v[68:69], v[56:57], v[208:209]
    v_pk_mul_f32 v[72:73], v[60:61], v[208:209]
    v_pk_mul_f32 v[70:71], v[58:59], v[210:211]
    v_pk_mul_f32 v[74:75], v[62:63], v[210:211]
    v_pk_fma_f32 v[68:69], v[60:61], v[212:213], v[68:69]
    v_pk_fma_f32 v[72:73], v[56:57], v[212:213], v[72:73] neg_lo:[1,0,0] neg_hi:[1,0,0]
    v_pk_fma_f32 v[70:71], v[62:63], v[214:215], v[70:71]
    v_pk_fma_f32 v[74:75], v[58:59], v[214:215], v[74:75] neg_lo:[1,0,0] neg_hi:[1,0,0]
    v_cvt_pk_bf16_f32 v9, v68, v72
    ds_write_b32 v104, v9 offset:2176
    v_cvt_pk_bf16_f32 v10, v69, v73
    ds_write_b32 v104, v10 offset:4352
    v_cvt_pk_bf16_f32 v11, v70, v74
    ds_write_b32 v104, v11 offset:6528
    v_cvt_pk_bf16_f32 v12, v71, v75
    ds_write_b32 v104, v12 offset:8704
    s_cmp_lt_u32 s39, 2
    s_cselect_b32 s47, 0, 0x80000000
    s_waitcnt vmcnt(0) lgkmcnt(0)
    s_cmp_eq_u32 s3, 3
    s_cbranch_scc0 f_pf_ok
    s_mov_b32 s50, 0
f_pf:
    v_xor_b32 v99, v99, v98
    v_bitop3_b32 v99, v100, v98, v99 bitop3:0xbe
    v_cmp_eq_u32 s[58:59], 0, v98
    v_cmp_ne_u32 vcc, 0, v99
    s_nop 0
    s_or_b64 vcc, vcc, s[58:59]
    s_cbranch_scc0 f_pf_got
    s_cmp_lt_u32 s50, 30000
    s_cbranch_scc0 f_pf_got
    v_lshlrev_b32 v2, 6, v1
    v_min_u32 v3, 960, v2
    s_mov_b32 s51, 158720
    s_mov_b32 s46, 162816
    buffer_load_dword v98, off, s[24:27], 0 offset:252 sc1
    buffer_load_dword v99, v2, s[28:31], s51 offen sc1
    buffer_load_dword v100, v3, s[28:31], s46 offen sc1
    s_add_u32 s50, s50, 1
    s_waitcnt vmcnt(0)
    s_branch f_pf
f_pf_got:
    v_readfirstlane_b32 s26, v98
f_pf_ok:
    s_barrier
    ds_read_b128 v[28:31], v105 offset:0
    ds_read_b128 v[32:35], v105 offset:64
    ds_read_b128 v[36:39], v105 offset:128
    ds_read_b128 v[40:43], v105 offset:192
    s_cmp_eq_u32 s40, 1
    s_cbranch_scc1 f_p1_one
    ds_read_b128 v[44:47], v105 offset:4352
    ds_read_b128 v[48:51], v105 offset:4416
    ds_read_b128 v[52:55], v105 offset:4480
    ds_read_b128 v[56:59], v105 offset:4544
    s_waitcnt lgkmcnt(7)
    v_mfma_f32_16x16x32_bf16 v[60:63], v[28:31], v[128:131], 0
    v_mfma_f32_16x16x32_bf16 v[64:67], v[28:31], v[144:147], 0
    s_waitcnt lgkmcnt(6)
    v_mfma_f32_16x16x32_bf16 v[60:63], v[32:35], v[132:135], v[60:63]
    v_mfma_f32_16x16x32_bf16 v[64:67], v[32:35], v[148:151], v[64:67]
    s_waitcnt lgkmcnt(5)
    v_mfma_f32_16x16x32_bf16 v[60:63], v[36:39], v[136:139], v[60:63]
    v_mfma_f32_16x16x32_bf16 v[64:67], v[36:39], v[152:155], v[64:67]
    s_waitcnt lgkmcnt(4)
    v_mfma_f32_16x16x32_bf16 v[60:63], v[40:43], v[140:143], v[60:63]
    v_mfma_f32_16x16x32_bf16 v[64:67], v[40:43], v[156:159], v[64:67]
    s_waitcnt lgkmcnt(3)
    v_mfma_f32_16x16x32_bf16 v[68:71], v[44:47], v[128:131], 0
    v_mfma_f32_16x16x32_bf16 v[72:75], v[44:47], v[144:147], 0
    s_waitcnt lgkmcnt(2)
    v_mfma_f32_16x16x32_bf16 v[68:71], v[48:51], v[132:135], v[68:71]
    v_mfma_f32_16x16x32_bf16 v[72:75], v[48:51], v[148:151], v[72:75]
    s_waitcnt lgkmcnt(1)
    v_mfma_f32_16x16x32_bf16 v[68:71], v[52:55], v[136:139], v[68:71]
    v_mfma_f32_16x16x32_bf16 v[72:75], v[52:55], v[152:155], v[72:75]
    s_waitcnt lgkmcnt(0)
    v_mfma_f32_16x16x32_bf16 v[68:71], v[56:59], v[140:143], v[68:71]
    v_mfma_f32_16x16x32_bf16 v[72:75], v[56:59], v[156:159], v[72:75]
    v_cvt_pk_bf16_f32 v76, v60, v64
    v_cvt_pk_bf16_f32 v77, v61, v65
    v_cvt_pk_bf16_f32 v78, v62, v66
    v_cvt_pk_bf16_f32 v79, v63, v67
    v_xor_b32 v76, s47, v76
    v_xor_b32 v77, s47, v77
    v_xor_b32 v78, s47, v78
    v_xor_b32 v79, s47, v79
    buffer_store_dwordx4 v[76:79], v106, s[28:31], s56 offen sc1
    v_cvt_pk_bf16_f32 v80, v68, v72
    v_cvt_pk_bf16_f32 v81, v69, v73
    v_cvt_pk_bf16_f32 v82, v70, v74
    v_cvt_pk_bf16_f32 v83, v71, v75
    v_xor_b32 v80, s47, v80
    v_xor_b32 v81, s47, v81
    v_xor_b32 v82, s47, v82
    v_xor_b32 v83, s47, v83
    buffer_store_dwordx4 v[80:83], v107, s[28:31], s56 offen sc1
    s_branch f_p1_join
f_p1_one:
    s_waitcnt lgkmcnt(3)
    v_mfma_f32_16x16x32_bf16 v[60:63], v[28:31], v[128:131], 0
    v_mfma_f32_16x16x32_bf16 v[64:67], v[28:31], v[144:147], 0
    s_waitcnt lgkmcnt(2)
    v_mfma_f32_16x16x32_bf16 v[60:63], v[32:35], v[132:135], v[60:63]
    v_mfma_f32_16x16x32_bf16 v[64:67], v[32:35], v[148:151], v[64:67]
    s_waitcnt lgkmcnt(1)
    v_mfma_f32_16x16x32_bf16 v[60:63], v[36:39], v[136:139], v[60:63]
    v_mfma_f32_16x16x32_bf16 v[64:67], v[36:39], v[152:155], v[64:67]
    s_waitcnt lgkmcnt(0)
    v_mfma_f32_16x16x32_bf16 v[60:63], v[40:43], v[140:143], v[60:63]
    v_mfma_f32_16x16x32_bf16 v[64:67], v[40:43], v[156:159], v[64:67]
    s_nop 7
    v_cvt_pk_bf16_f32 v76, v60, v64
    v_cvt_pk_bf16_f32 v77, v61, v65
    v_cvt_pk_bf16_f32 v78, v62, v66
    v_cvt_pk_bf16_f32 v79, v63, v67
    v_xor_b32 v76, s47, v76
    v_xor_b32 v77, s47, v77
    v_xor_b32 v78, s47, v78
    v_xor_b32 v79, s47, v79
    buffer_store_dwordx4 v[76:79], v106, s[28:31], s56 offen sc1
f_p1_join:
    s_cmp_eq_u32 s3, 6
    s_cbranch_scc0 f_nofl
    s_lshl_b32 s50, s2, 10
    s_add_u32 s50, s50, 262144
    buffer_store_dwordx4 v[18:21], v109, s[28:31], s50 offen sc1
f_nofl:
    s_cmp_lt_u32 s38, 64
    s_cbranch_scc0 f_noh2p
    v_mov_b32 v28, -1
    v_mov_b32 v29, -1
    v_mov_b32 v30, -1
    v_mov_b32 v31, -1
    s_mul_i32 s50, s38, 1536
    s_add_u32 s50, s50, 13631488
    buffer_store_dwordx4 v[28:31], v122, s[28:31], s50 offen sc1
    s_cmp_eq_u32 s3, 1
    s_cbranch_scc0 f_noh2p
    buffer_store_dwordx4 v[28:31], v123, s[28:31], s50 offen sc1
f_noh2p:
    s_cmp_eq_u32 s42, -1
    s_cbranch_scc1 f_c3now
    v_cvt_f32_u32 v96, v7
    v_cvt_f32_u32 v97, v6
    v_mul_f32 v98, v97, v96
    v_mul_f32 v98, 0x3d800000, v98
    v_mul_f32 v98, 0x3d000000, v98
    v_fmamk_f32 v84, v96, 0x00000000, v98
    v_fmamk_f32 v85, v96, 0x3a000000, v98
    v_fmamk_f32 v86, v96, 0x3a800000, v98
    v_fmamk_f32 v87, v96, 0x3ac00000, v98
    v_cos_f32 v192, v84
    v_sin_f32 v200, v84
    v_cos_f32 v193, v85
    v_sin_f32 v201, v85
    v_cos_f32 v194, v86
    v_sin_f32 v202, v86
    v_cos_f32 v195, v87
    v_sin_f32 v203, v87
    v_fmamk_f32 v84, v96, 0x3c000000, v98
    v_fmamk_f32 v85, v96, 0x3c080000, v98
    v_fmamk_f32 v86, v96, 0x3c100000, v98
    v_fmamk_f32 v87, v96, 0x3c180000, v98
    v_cos_f32 v196, v84
    v_sin_f32 v204, v84
    v_cos_f32 v197, v85
    v_sin_f32 v205, v85
    v_cos_f32 v198, v86
    v_sin_f32 v206, v86
    v_cos_f32 v199, v87
    v_sin_f32 v207, v87
    v_add_u32 v96, 0, v5
    v_cvt_f32_u32 v96, v96
    v_mul_f32 v98, v97, v96
    v_mul_f32 v98, 0x3e000000, v98
    v_fmamk_f32 v84, v96, 0x00000000, v98
    v_fmamk_f32 v85, v96, 0x3d000000, v98
    v_fmamk_f32 v86, v96, 0x3d800000, v98
    v_fmamk_f32 v87, v96, 0x3dc00000, v98
    v_cos_f32 v88, v84
    v_sin_f32 v92, v84
    v_cos_f32 v89, v85
    v_sin_f32 v93, v85
    v_cos_f32 v90, v86
    v_sin_f32 v94, v86
    v_cos_f32 v91, v87
    v_sin_f32 v95, v87
    v_cvt_pk_bf16_f32 v160, v88, v89
    v_cvt_pk_bf16_f32 v161, v90, v91
    v_cvt_pk_bf16_f32 v178, v88, v89
    v_cvt_pk_bf16_f32 v179, v90, v91
    v_cvt_pk_bf16_f32 v162, v92, v93
    v_cvt_pk_bf16_f32 v163, v94, v95
    v_cvt_pk_bf16_f32 v176, -v92, -v93
    v_cvt_pk_bf16_f32 v177, -v94, -v95
    v_fmamk_f32 v84, v96, 0x3f000000, v98
    v_fmamk_f32 v85, v96, 0x3f080000, v98
    v_fmamk_f32 v86, v96, 0x3f100000, v98
    v_fmamk_f32 v87, v96, 0x3f180000, v98
    v_cos_f32 v88, v84
    v_sin_f32 v92, v84
    v_cos_f32 v89, v85
    v_sin_f32 v93, v85
    v_cos_f32 v90, v86
    v_sin_f32 v94, v86
    v_cos_f32 v91, v87
    v_sin_f32 v95, v87
    v_cvt_pk_bf16_f32 v164, v88, v89
    v_cvt_pk_bf16_f32 v165, v90, v91
    v_cvt_pk_bf16_f32 v182, v88, v89
    v_cvt_pk_bf16_f32 v183, v90, v91
    v_cvt_pk_bf16_f32 v166, v92, v93
    v_cvt_pk_bf16_f32 v167, v94, v95
    v_cvt_pk_bf16_f32 v180, -v92, -v93
    v_cvt_pk_bf16_f32 v181, -v94, -v95
    v_add_u32 v96, 16, v5
    v_cvt_f32_u32 v96, v96
    v_mul_f32 v98, v97, v96
    v_mul_f32 v98, 0x3e000000, v98
    v_fmamk_f32 v84, v96, 0x00000000, v98
    v_fmamk_f32 v85, v96, 0x3d000000, v98
    v_fmamk_f32 v86, v96, 0x3d800000, v98
    v_fmamk_f32 v87, v96, 0x3dc00000, v98
    v_cos_f32 v88, v84
    v_sin_f32 v92, v84
    v_cos_f32 v89, v85
    v_sin_f32 v93, v85
    v_cos_f32 v90, v86
    v_sin_f32 v94, v86
    v_cos_f32 v91, v87
    v_sin_f32 v95, v87
    v_cvt_pk_bf16_f32 v168, v88, v89
    v_cvt_pk_bf16_f32 v169, v90, v91
    v_cvt_pk_bf16_f32 v186, v88, v89
    v_cvt_pk_bf16_f32 v187, v90, v91
    v_cvt_pk_bf16_f32 v170, v92, v93
    v_cvt_pk_bf16_f32 v171, v94, v95
    v_cvt_pk_bf16_f32 v184, -v92, -v93
    v_cvt_pk_bf16_f32 v185, -v94, -v95
    v_fmamk_f32 v84, v96, 0x3f000000, v98
    v_fmamk_f32 v85, v96, 0x3f080000, v98
    v_fmamk_f32 v86, v96, 0x3f100000, v98
    v_fmamk_f32 v87, v96, 0x3f180000, v98
    v_cos_f32 v88, v84
    v_sin_f32 v92, v84
    v_cos_f32 v89, v85
    v_sin_f32 v93, v85
    v_cos_f32 v90, v86
    v_sin_f32 v94, v86
    v_cos_f32 v91, v87
    v_sin_f32 v95, v87
    v_cvt_pk_bf16_f32 v172, v88, v89
    v_cvt_pk_bf16_f32 v173, v90, v91
    v_cvt_pk_bf16_f32 v190, v88, v89
    v_cvt_pk_bf16_f32 v191, v90, v91
    v_cvt_pk_bf16_f32 v174, v92, v93
    v_cvt_pk_bf16_f32 v175, v94, v95
    v_cvt_pk_bf16_f32 v188, -v92, -v93
    v_cvt_pk_bf16_f32 v189, -v94, -v95
    s_branch f_c3done
f_c3now:
    v_cvt_f32_u32 v96, v7
    v_cvt_f32_u32 v97, v6
    v_mul_f32 v97, v97, v96
    v_mul_f32 v97, 0x3d800000, v97
    v_fmamk_f32 v84, v96, 0x00000000, v97
    v_fmamk_f32 v85, v96, 0x3c800000, v97
    v_fmamk_f32 v86, v96, 0x3d000000, v97
    v_fmamk_f32 v87, v96, 0x3d400000, v97
    v_cos_f32 v88, v84
    v_sin_f32 v92, v84
    v_cos_f32 v89, v85
    v_sin_f32 v93, v85
    v_cos_f32 v90, v86
    v_sin_f32 v94, v86
    v_cos_f32 v91, v87
    v_sin_f32 v95, v87
    v_cvt_pk_bf16_f32 v216, v88, v89
    v_cvt_pk_bf16_f32 v217, v90, v91
    v_cvt_pk_bf16_f32 v234, -v88, -v89
    v_cvt_pk_bf16_f32 v235, -v90, -v91
    v_cvt_pk_bf16_f32 v218, v92, v93
    v_cvt_pk_bf16_f32 v219, v94, v95
    v_cvt_pk_bf16_f32 v232, v92, v93
    v_cvt_pk_bf16_f32 v233, v94, v95
    v_fmamk_f32 v84, v96, 0x3e800000, v97
    v_fmamk_f32 v85, v96, 0x3e880000, v97
    v_fmamk_f32 v86, v96, 0x3e900000, v97
    v_fmamk_f32 v87, v96, 0x3e980000, v97
    v_cos_f32 v88, v84
    v_sin_f32 v92, v84
    v_cos_f32 v89, v85
    v_sin_f32 v93, v85
    v_cos_f32 v90, v86
    v_sin_f32 v94, v86
    v_cos_f32 v91, v87
    v_sin_f32 v95, v87
    v_cvt_pk_bf16_f32 v220, v88, v89
    v_cvt_pk_bf16_f32 v221, v90, v91
    v_cvt_pk_bf16_f32 v238, -v88, -v89
    v_cvt_pk_bf16_f32 v239, -v90, -v91
    v_cvt_pk_bf16_f32 v222, v92, v93
    v_cvt_pk_bf16_f32 v223, v94, v95
    v_cvt_pk_bf16_f32 v236, v92, v93
    v_cvt_pk_bf16_f32 v237, v94, v95
    v_fmamk_f32 v84, v96, 0x3f000000, v97
    v_fmamk_f32 v85, v96, 0x3f040000, v97
    v_fmamk_f32 v86, v96, 0x3f080000, v97
    v_fmamk_f32 v87, v96, 0x3f0c0000, v97
    v_cos_f32 v88, v84
    v_sin_f32 v92, v84
    v_cos_f32 v89, v85
    v_sin_f32 v93, v85
    v_cos_f32 v90, v86
    v_sin_f32 v94, v86
    v_cos_f32 v91, v87
    v_sin_f32 v95, v87
    v_cvt_pk_bf16_f32 v224, v88, v89
    v_cvt_pk_bf16_f32 v225, v90, v91
    v_cvt_pk_bf16_f32 v242, v88, v89
    v_cvt_pk_bf16_f32 v243, v90, v91
    v_cvt_pk_bf16_f32 v226, -v92, -v93
    v_cvt_pk_bf16_f32 v227, -v94, -v95
    v_cvt_pk_bf16_f32 v240, v92, v93
    v_cvt_pk_bf16_f32 v241, v94, v95
    v_fmamk_f32 v84, v96, 0x3f400000, v97
    v_fmamk_f32 v85, v96, 0x3f440000, v97
    v_fmamk_f32 v86, v96, 0x3f480000, v97
    v_fmamk_f32 v87, v96, 0x3f4c0000, v97
    v_cos_f32 v88, v84
    v_sin_f32 v92, v84
    v_cos_f32 v89, v85
    v_sin_f32 v93, v85
    v_cos_f32 v90, v86
    v_sin_f32 v94, v86
    v_cos_f32 v91, v87
    v_sin_f32 v95, v87
    v_cvt_pk_bf16_f32 v228, v88, v89
    v_cvt_pk_bf16_f32 v229, v90, v91
    v_cvt_pk_bf16_f32 v246, v88, v89
    v_cvt_pk_bf16_f32 v247, v90, v91
    v_cvt_pk_bf16_f32 v230, -v92, -v93
    v_cvt_pk_bf16_f32 v231, -v94, -v95
    v_cvt_pk_bf16_f32 v244, v92, v93
    v_cvt_pk_bf16_f32 v245, v94, v95
    v_mul_f32 v85, 0x3ae38e39, v96
    v_mul_f32 v86, 0x3b638e39, v96
    v_mul_f32 v87, 0x3baaaaab, v96
    v_mul_f32 v88, 0x3be38e39, v96
    v_cos_f32 v248, v85
    v_sin_f32 v252, v85
    v_cos_f32 v249, v86
    v_sin_f32 v253, v86
    v_cos_f32 v250, v87
    v_sin_f32 v254, v87
    v_cos_f32 v251, v88
    v_sin_f32 v255, v88
    v_mul_f32 v248, 0x35e38e39, v248
    v_mul_f32 v249, 0x35e38e39, v249
    v_mul_f32 v250, 0x35e38e39, v250
    v_mul_f32 v251, 0x35e38e39, v251
    v_mul_f32 v252, 0x35e38e39, v252
    v_mul_f32 v253, 0x35e38e39, v253
    v_mul_f32 v254, 0x35e38e39, v254
    v_mul_f32 v255, 0x35e38e39, v255
f_c3done:
    s_mul_i32 s63, s36, 27
    s_add_u32 s63, s63, s37
    s_mul_i32 s62, s63, 171
    s_lshr_b32 s62, s62, 10
    s_mul_i32 s60, s62, 6
    s_sub_u32 s63, s63, s60
    s_lshl_b32 s60, s62, 8
    s_mul_i32 s61, s39, 147456
    s_add_u32 s60, s60, s61
    s_mul_i32 s61, s63, 393216
    s_mul_i32 s24, s39, 3072
    s_add_u32 s61, s61, s24
    s_add_u32 s61, s61, 13631488
    s_lshl_b32 s24, s39, 12
    s_add_u32 s24, s24, 65536
    v_lshrrev_b32 v2, 4, v1
    v_and_b32 v3, 15, v1
    v_lshlrev_b32 v9, 1, v2
    v_xor_b32 v9, v9, v3
    v_xor_b32 v10, 8, v9
    v_mul_u32_u24 v2, 9216, v2
    v_lshl_add_u32 v9, v9, 4, v2
    v_lshl_add_u32 v10, v10, 4, v2
    v_lshlrev_b32 v14, 4, v1
    v_lshlrev_b32 v15, 2, v1
    s_cmp_eq_u32 s42, -1
    s_cbranch_scc1 f_p2_idle
    s_and_b32 s50, s39, 1
    s_lshl_b32 s50, s50, 4
    s_lshr_b32 s51, s39, 1
    s_add_u32 s50, s50, s51
    s_mul_i32 s50, s50, 81920
    s_lshl_b32 s51, s42, 5
    s_add_u32 s50, s50, s51
    s_add_u32 s44, s50, 4194304
    s_add_u32 s45, s44, 655360
    s_lshl_b32 s50, s3, 11
    s_add_u32 s50, s50, 29952
    v_add_u32 v2, s50, v109
    s_lshl_b32 s50, s40, 13
    s_add_u32 s50, s50, 29952
    v_add_u32 v3, s50, v109
    s_lshr_b32 s50, s42, 6
    s_and_b32 s51, s42, 63
    s_mul_i32 s46, s51, 9
    s_add_u32 s46, s46, s50
    s_sub_u32 s50, 576, s46
    s_cmp_lt_u32 s51, 32
    s_cselect_b32 s46, s46, s50
    s_lshl_b32 s46, s46, 5
    s_mul_i32 s50, s39, 18688
    s_add_u32 s46, s46, s50
    s_add_u32 s46, s46, 1048576
    s_add_u32 s51, s46, 299008
    v_bfe_u32 v4, v1, 3, 1
    v_lshl_add_u32 v4, v6, 3, v4
    v_bfe_u32 v84, v1, 1, 2
    v_lshl_add_u32 v4, v84, 6, v4
    v_mul_u32_u24 v4, 9344, v4
    v_and_b32 v84, 1, v1
    v_lshl_add_u32 v4, v84, 4, v4
    s_lshl_b32 s48, s42, 13
    s_add_u32 s48, s48, 7340032
    s_mov_b32 s47, 0xffff0000
    s_waitcnt vmcnt(0)
    s_mov_b32 s50, 0
f_hb:
    buffer_load_dwordx4 v[28:31], v108, s[28:31], s44 offen sc1
    buffer_load_dwordx4 v[32:35], v108, s[28:31], s45 offen sc1
f_hb_chk:
    s_add_u32 s50, s50, 1
    s_waitcnt vmcnt(0)
    v_max3_u32 v84, v28, v29, v30
    v_max3_u32 v84, v84, v31, v32
    v_max3_u32 v84, v84, v33, v34
    v_max_u32 v84, v84, v35
    v_cmp_eq_u32 vcc, -1, v84
    s_nop 0
    s_and_b64 exec, vcc, vcc
    s_cbranch_scc0 f_hb_ok
    s_cmp_lt_u32 s50, 30000
    s_cbranch_scc1 f_hb
f_hb_ok:
    s_mov_b64 exec, -1
    buffer_load_dwordx4 v[96:99], v4, s[28:31], s46 offen
    buffer_load_dwordx4 v[100:103], v4, s[28:31], s51 offen
    ds_write_b128 v2, v[28:31] offset:0
    ds_write_b128 v2, v[32:35] offset:1024
    s_waitcnt lgkmcnt(0)
    s_barrier
    s_add_u32 m0, s55, 0
    s_nop 0
    buffer_load_dwordx4 v109, s[4:7], s49 offen lds
    s_mov_b64 exec, 0xff
    buffer_load_dwordx4 v109, s[4:7], s49 offen offset:1024 lds
    s_mov_b64 exec, -1
    ds_read_b128 v[28:31], v3 offset:0
    ds_read_b128 v[44:47], v3 offset:4096
    ds_read_b128 v[32:35], v3 offset:1024
    ds_read_b128 v[48:51], v3 offset:5120
    ds_read_b128 v[36:39], v3 offset:2048
    ds_read_b128 v[52:55], v3 offset:6144
    ds_read_b128 v[40:43], v3 offset:3072
    ds_read_b128 v[56:59], v3 offset:7168
    s_waitcnt lgkmcnt(7)
    v_mfma_f32_16x16x32_bf16 v[60:63], v[28:31], v[128:131], 0
    v_mfma_f32_16x16x32_bf16 v[64:67], v[28:31], v[144:147], 0
    s_waitcnt lgkmcnt(6)
    v_mfma_f32_16x16x32_bf16 v[68:71], v[44:47], v[128:131], 0
    v_mfma_f32_16x16x32_bf16 v[72:75], v[44:47], v[144:147], 0
    s_waitcnt lgkmcnt(5)
    v_mfma_f32_16x16x32_bf16 v[60:63], v[32:35], v[132:135], v[60:63]
    v_mfma_f32_16x16x32_bf16 v[64:67], v[32:35], v[148:151], v[64:67]
    s_waitcnt lgkmcnt(4)
    v_mfma_f32_16x16x32_bf16 v[68:71], v[48:51], v[132:135], v[68:71]
    v_mfma_f32_16x16x32_bf16 v[72:75], v[48:51], v[148:151], v[72:75]
    s_waitcnt lgkmcnt(3)
    v_mfma_f32_16x16x32_bf16 v[60:63], v[36:39], v[136:139], v[60:63]
    v_mfma_f32_16x16x32_bf16 v[64:67], v[36:39], v[152:155], v[64:67]
    s_waitcnt lgkmcnt(2)
    v_mfma_f32_16x16x32_bf16 v[68:71], v[52:55], v[136:139], v[68:71]
    v_mfma_f32_16x16x32_bf16 v[72:75], v[52:55], v[152:155], v[72:75]
    s_waitcnt lgkmcnt(1)
    v_mfma_f32_16x16x32_bf16 v[60:63], v[40:43], v[140:143], v[60:63]
    v_mfma_f32_16x16x32_bf16 v[64:67], v[40:43], v[156:159], v[64:67]
    s_waitcnt lgkmcnt(0)
    v_mfma_f32_16x16x32_bf16 v[68:71], v[56:59], v[140:143], v[68:71]
    v_mfma_f32_16x16x32_bf16 v[72:75], v[56:59], v[156:159], v[72:75]
    s_nop 3
    v_pk_mul_f32 v[84:85], v[60:61], v[192:193]
    v_pk_mul_f32 v[88:89], v[64:65], v[192:193]
    v_pk_mul_f32 v[86:87], v[62:63], v[194:195]
    v_pk_mul_f32 v[90:91], v[66:67], v[194:195]
    v_pk_fma_f32 v[84:85], v[64:65], v[200:201], v[84:85]
    v_pk_fma_f32 v[88:89], v[60:61], v[200:201], v[88:89] neg_lo:[1,0,0] neg_hi:[1,0,0]
    v_pk_fma_f32 v[86:87], v[66:67], v[202:203], v[86:87]
    v_pk_fma_f32 v[90:91], v[62:63], v[202:203], v[90:91] neg_lo:[1,0,0] neg_hi:[1,0,0]
    v_cvt_pk_bf16_f32 v76, v84, v85
    v_cvt_pk_bf16_f32 v77, v86, v87
    v_cvt_pk_bf16_f32 v78, v88, v89
    v_cvt_pk_bf16_f32 v79, v90, v91
    v_pk_mul_f32 v[84:85], v[68:69], v[196:197]
    v_pk_mul_f32 v[88:89], v[72:73], v[196:197]
    v_pk_mul_f32 v[86:87], v[70:71], v[198:199]
    v_pk_mul_f32 v[90:91], v[74:75], v[198:199]
    v_pk_fma_f32 v[84:85], v[72:73], v[204:205], v[84:85]
    v_pk_fma_f32 v[88:89], v[68:69], v[204:205], v[88:89] neg_lo:[1,0,0] neg_hi:[1,0,0]
    v_pk_fma_f32 v[86:87], v[74:75], v[206:207], v[86:87]
    v_pk_fma_f32 v[90:91], v[70:71], v[206:207], v[90:91] neg_lo:[1,0,0] neg_hi:[1,0,0]
    v_cvt_pk_bf16_f32 v80, v84, v85
    v_cvt_pk_bf16_f32 v81, v86, v87
    v_cvt_pk_bf16_f32 v82, v88, v89
    v_cvt_pk_bf16_f32 v83, v90, v91
    v_mfma_f32_16x16x32_bf16 v[60:63], v[160:163], v[76:79], 0
    v_mfma_f32_16x16x32_bf16 v[64:67], v[176:179], v[76:79], 0
    v_mfma_f32_16x16x32_bf16 v[68:71], v[168:171], v[76:79], 0
    v_mfma_f32_16x16x32_bf16 v[72:75], v[184:187], v[76:79], 0
    v_mfma_f32_16x16x32_bf16 v[60:63], v[164:167], v[80:83], v[60:63]
    v_mfma_f32_16x16x32_bf16 v[64:67], v[180:183], v[80:83], v[64:67]
    v_mfma_f32_16x16x32_bf16 v[68:71], v[172:175], v[80:83], v[68:71]
    v_mfma_f32_16x16x32_bf16 v[72:75], v[188:191], v[80:83], v[72:75]
    s_waitcnt vmcnt(2)
    v_lshlrev_b32 v28, 16, v96
    v_and_b32 v36, s47, v96
    v_lshlrev_b32 v29, 16, v97
    v_and_b32 v37, s47, v97
    v_lshlrev_b32 v30, 16, v98
    v_and_b32 v38, s47, v98
    v_lshlrev_b32 v31, 16, v99
    v_and_b32 v39, s47, v99
    v_lshlrev_b32 v32, 16, v100
    v_and_b32 v40, s47, v100
    v_lshlrev_b32 v33, 16, v101
    v_and_b32 v41, s47, v101
    v_lshlrev_b32 v34, 16, v102
    v_and_b32 v42, s47, v102
    v_lshlrev_b32 v35, 16, v103
    v_and_b32 v43, s47, v103
    v_pk_mul_f32 v[84:85], v[60:61], v[28:29]
    v_pk_mul_f32 v[88:89], v[64:65], v[28:29] neg_lo:[1,0] neg_hi:[1,0]
    v_pk_mul_f32 v[86:87], v[62:63], v[30:31]
    v_pk_mul_f32 v[90:91], v[66:67], v[30:31] neg_lo:[1,0] neg_hi:[1,0]
    v_pk_fma_f32 v[84:85], v[64:65], v[36:37], v[84:85] neg_lo:[1,0,0] neg_hi:[1,0,0]
    v_pk_fma_f32 v[88:89], v[60:61], v[36:37], v[88:89] neg_lo:[1,0,0] neg_hi:[1,0,0]
    v_pk_fma_f32 v[86:87], v[66:67], v[38:39], v[86:87] neg_lo:[1,0,0] neg_hi:[1,0,0]
    v_pk_fma_f32 v[90:91], v[62:63], v[38:39], v[90:91] neg_lo:[1,0,0] neg_hi:[1,0,0]
    v_cvt_pk_bf16_f32 v76, v84, v85
    v_cvt_pk_bf16_f32 v77, v86, v87
    v_cvt_pk_bf16_f32 v78, v88, v89
    v_cvt_pk_bf16_f32 v79, v90, v91
    v_pk_mul_f32 v[84:85], v[68:69], v[32:33]
    v_pk_mul_f32 v[88:89], v[72:73], v[32:33] neg_lo:[1,0] neg_hi:[1,0]
    v_pk_mul_f32 v[86:87], v[70:71], v[34:35]
    v_pk_mul_f32 v[90:91], v[74:75], v[34:35] neg_lo:[1,0] neg_hi:[1,0]
    v_pk_fma_f32 v[84:85], v[72:73], v[40:41], v[84:85] neg_lo:[1,0,0] neg_hi:[1,0,0]
    v_pk_fma_f32 v[88:89], v[68:69], v[40:41], v[88:89] neg_lo:[1,0,0] neg_hi:[1,0,0]
    v_pk_fma_f32 v[86:87], v[74:75], v[42:43], v[86:87] neg_lo:[1,0,0] neg_hi:[1,0,0]
    v_pk_fma_f32 v[90:91], v[70:71], v[42:43], v[90:91] neg_lo:[1,0,0] neg_hi:[1,0,0]
    v_cvt_pk_bf16_f32 v80, v84, v85
    v_cvt_pk_bf16_f32 v81, v86, v87
    v_cvt_pk_bf16_f32 v82, v88, v89
    v_cvt_pk_bf16_f32 v83, v90, v91
    v_mfma_f32_16x16x32_bf16 v[60:63], v[160:163], v[76:79], 0
    v_mfma_f32_16x16x32_bf16 v[64:67], v[176:179], v[76:79], 0
    v_mfma_f32_16x16x32_bf16 v[68:71], v[168:171], v[76:79], 0
    v_mfma_f32_16x16x32_bf16 v[72:75], v[184:187], v[76:79], 0
    v_mfma_f32_16x16x32_bf16 v[60:63], v[164:167], v[80:83], v[60:63]
    v_mfma_f32_16x16x32_bf16 v[64:67], v[180:183], v[80:83], v[64:67]
    v_mfma_f32_16x16x32_bf16 v[68:71], v[172:175], v[80:83], v[68:71]
    v_mfma_f32_16x16x32_bf16 v[72:75], v[188:191], v[80:83], v[72:75]
    s_nop 4
    v_pk_mul_f32 v[84:85], v[60:61], v[192:193]
    v_pk_mul_f32 v[88:89], v[64:65], v[192:193]
    v_pk_mul_f32 v[86:87], v[62:63], v[194:195]
    v_pk_mul_f32 v[90:91], v[66:67], v[194:195]
    v_pk_fma_f32 v[84:85], v[64:65], v[200:201], v[84:85]
    v_pk_fma_f32 v[88:89], v[60:61], v[200:201], v[88:89] neg_lo:[1,0,0] neg_hi:[1,0,0]
    v_pk_fma_f32 v[86:87], v[66:67], v[202:203], v[86:87]
    v_pk_fma_f32 v[90:91], v[62:63], v[202:203], v[90:91] neg_lo:[1,0,0] neg_hi:[1,0,0]
    v_cvt_pk_bf16_f32 v92, v84, v88
    ds_write_b32 v110, v92 offset:0
    v_cvt_pk_bf16_f32 v93, v85, v89
    ds_write_b32 v110, v93 offset:272
    v_cvt_pk_bf16_f32 v94, v86, v90
    ds_write_b32 v110, v94 offset:544
    v_cvt_pk_bf16_f32 v95, v87, v91
    ds_write_b32 v110, v95 offset:816
    v_pk_mul_f32 v[84:85], v[68:69], v[196:197]
    v_pk_mul_f32 v[88:89], v[72:73], v[196:197]
    v_pk_mul_f32 v[86:87], v[70:71], v[198:199]
    v_pk_mul_f32 v[90:91], v[74:75], v[198:199]
    v_pk_fma_f32 v[84:85], v[72:73], v[204:205], v[84:85]
    v_pk_fma_f32 v[88:89], v[68:69], v[204:205], v[88:89] neg_lo:[1,0,0] neg_hi:[1,0,0]
    v_pk_fma_f32 v[86:87], v[74:75], v[206:207], v[86:87]
    v_pk_fma_f32 v[90:91], v[70:71], v[206:207], v[90:91] neg_lo:[1,0,0] neg_hi:[1,0,0]
    v_cvt_pk_bf16_f32 v92, v84, v88
    ds_write_b32 v110, v92 offset:4352
    v_cvt_pk_bf16_f32 v93, v85, v89
    ds_write_b32 v110, v93 offset:4624
    v_cvt_pk_bf16_f32 v94, v86, v90
    ds_write_b32 v110, v94 offset:4896
    v_cvt_pk_bf16_f32 v95, v87, v91
    ds_write_b32 v110, v95 offset:5168
    s_waitcnt lgkmcnt(0)
    s_barrier
    ds_read_b128 v[28:31], v111 offset:0
    ds_read_b128 v[44:47], v111 offset:4352
    ds_read_b128 v[32:35], v111 offset:64
    ds_read_b128 v[48:51], v111 offset:4416
    ds_read_b128 v[36:39], v111 offset:128
    ds_read_b128 v[52:55], v111 offset:4480
    ds_read_b128 v[40:43], v111 offset:192
    ds_read_b128 v[56:59], v111 offset:4544
    s_waitcnt lgkmcnt(7)
    v_mfma_f32_16x16x32_bf16 v[60:63], v[28:31], v[128:131], 0
    v_mfma_f32_16x16x32_bf16 v[64:67], v[28:31], v[144:147], 0
    s_waitcnt lgkmcnt(6)
    v_mfma_f32_16x16x32_bf16 v[68:71], v[44:47], v[128:131], 0
    v_mfma_f32_16x16x32_bf16 v[72:75], v[44:47], v[144:147], 0
    s_waitcnt lgkmcnt(5)
    v_mfma_f32_16x16x32_bf16 v[60:63], v[32:35], v[132:135], v[60:63]
    v_mfma_f32_16x16x32_bf16 v[64:67], v[32:35], v[148:151], v[64:67]
    s_waitcnt lgkmcnt(4)
    v_mfma_f32_16x16x32_bf16 v[68:71], v[48:51], v[132:135], v[68:71]
    v_mfma_f32_16x16x32_bf16 v[72:75], v[48:51], v[148:151], v[72:75]
    s_waitcnt lgkmcnt(3)
    v_mfma_f32_16x16x32_bf16 v[60:63], v[36:39], v[136:139], v[60:63]
    v_mfma_f32_16x16x32_bf16 v[64:67], v[36:39], v[152:155], v[64:67]
    s_waitcnt lgkmcnt(2)
    v_mfma_f32_16x16x32_bf16 v[68:71], v[52:55], v[136:139], v[68:71]
    v_mfma_f32_16x16x32_bf16 v[72:75], v[52:55], v[152:155], v[72:75]
    s_waitcnt lgkmcnt(1)
    v_mfma_f32_16x16x32_bf16 v[60:63], v[40:43], v[140:143], v[60:63]
    v_mfma_f32_16x16x32_bf16 v[64:67], v[40:43], v[156:159], v[64:67]
    s_waitcnt lgkmcnt(0)
    v_mfma_f32_16x16x32_bf16 v[68:71], v[56:59], v[140:143], v[68:71]
    v_mfma_f32_16x16x32_bf16 v[72:75], v[56:59], v[156:159], v[72:75]
    s_nop 3
    v_cvt_pk_bf16_f32 v84, v60, v61
    v_cvt_pk_bf16_f32 v85, v62, v63
    v_cvt_pk_bf16_f32 v86, v64, v65
    v_cvt_pk_bf16_f32 v87, v66, v67
    buffer_store_dwordx4 v[84:87], v112, s[28:31], s48 offen sc1
    v_cvt_pk_bf16_f32 v88, v68, v69
    v_cvt_pk_bf16_f32 v89, v70, v71
    v_cvt_pk_bf16_f32 v90, v72, v73
    v_cvt_pk_bf16_f32 v91, v74, v75
    s_add_u32 s48, s48, 4096
    buffer_store_dwordx4 v[88:91], v112, s[28:31], s48 offen sc1
    s_branch f_p2_done
f_p2_idle:
    s_waitcnt vmcnt(0)
    s_barrier
    s_add_u32 m0, s55, 0
    s_nop 0
    buffer_load_dwordx4 v109, s[4:7], s49 offen lds
    s_mov_b64 exec, 0xff
    buffer_load_dwordx4 v109, s[4:7], s49 offen offset:1024 lds
    s_mov_b64 exec, -1
    s_cmp_lt_u32 s2, 216
    s_cbranch_scc0 f_pla
    s_mov_b32 m0, s24
    s_nop 0
    buffer_load_dwordx4 v9, s[32:35], s60 offen offset:0 lds
    s_add_u32 s25, s60, 35840
    buffer_load_dwordx4 v9, s[32:35], s25 offen offset:1024 lds
    s_add_u32 s26, s60, 71680
    buffer_load_dwordx4 v10, s[32:35], s26 offen offset:2048 lds
    s_add_u32 s27, s60, 107520
    buffer_load_dwordx4 v10, s[32:35], s27 offen offset:3072 lds
    s_add_u32 s60, s60, 589824
    s_add_u32 s24, s24, 16384
    s_mov_b32 m0, s24
    s_nop 0
    buffer_load_dwordx4 v9, s[32:35], s60 offen offset:0 lds
    s_add_u32 s25, s60, 35840
    buffer_load_dwordx4 v9, s[32:35], s25 offen offset:1024 lds
    s_add_u32 s26, s60, 71680
    buffer_load_dwordx4 v10, s[32:35], s26 offen offset:2048 lds
    s_add_u32 s27, s60, 107520
    buffer_load_dwordx4 v10, s[32:35], s27 offen offset:3072 lds
    s_add_u32 s60, s60, 589824
    s_add_u32 s24, s24, 16384
f_pla:
    s_barrier
f_p2_done:
    s_mov_b32 s44, 0x2a000
    s_mov_b32 s45, 0x2c400
    s_mov_b32 s46, 0x2e800
    buffer_load_dwordx4 v[28:31], v126, s[28:31], s44 offen
    buffer_load_dwordx4 v[32:35], v126, s[28:31], s45 offen
    buffer_load_dwordx4 v[36:39], v126, s[28:31], s46 offen
    s_bfe_u32 s50, s38, 0x10001
    s_lshl_b32 s50, s50, 6
    s_lshr_b32 s51, s38, 2
    s_add_u32 s50, s50, s51
    s_lshl_b32 s50, s50, 1
    s_and_b32 s51, s38, 1
    s_add_u32 s50, s50, s51
    s_lshl_b32 s50, s50, 5
    s_add_u32 s48, s50, 7340032
    v_subrev_u32 v2, 288, v0
    v_cmp_gt_u32 vcc, 144, v2
    s_nop 1
    v_cndmask_b32 v3, 0, 1.0, vcc
    v_lshlrev_b32 v2, 4, v0
    s_mov_b32 s47, 0xffff0000
    s_cmp_eq_u32 s42, -1
    s_cbranch_scc1 f_c3late
    v_cvt_f32_u32 v72, v7
    v_cvt_f32_u32 v73, v6
    v_mul_f32 v73, v73, v72
    v_mul_f32 v73, 0x3d800000, v73
    v_fmamk_f32 v60, v72, 0x00000000, v73
    v_fmamk_f32 v61, v72, 0x3c800000, v73
    v_fmamk_f32 v62, v72, 0x3d000000, v73
    v_fmamk_f32 v63, v72, 0x3d400000, v73
    v_cos_f32 v64, v60
    v_sin_f32 v68, v60
    v_cos_f32 v65, v61
    v_sin_f32 v69, v61
    v_cos_f32 v66, v62
    v_sin_f32 v70, v62
    v_cos_f32 v67, v63
    v_sin_f32 v71, v63
    v_cvt_pk_bf16_f32 v216, v64, v65
    v_cvt_pk_bf16_f32 v217, v66, v67
    v_cvt_pk_bf16_f32 v234, -v64, -v65
    v_cvt_pk_bf16_f32 v235, -v66, -v67
    v_cvt_pk_bf16_f32 v218, v68, v69
    v_cvt_pk_bf16_f32 v219, v70, v71
    v_cvt_pk_bf16_f32 v232, v68, v69
    v_cvt_pk_bf16_f32 v233, v70, v71
    v_fmamk_f32 v60, v72, 0x3e800000, v73
    v_fmamk_f32 v61, v72, 0x3e880000, v73
    v_fmamk_f32 v62, v72, 0x3e900000, v73
    v_fmamk_f32 v63, v72, 0x3e980000, v73
    v_cos_f32 v64, v60
    v_sin_f32 v68, v60
    v_cos_f32 v65, v61
    v_sin_f32 v69, v61
    v_cos_f32 v66, v62
    v_sin_f32 v70, v62
    v_cos_f32 v67, v63
    v_sin_f32 v71, v63
    v_cvt_pk_bf16_f32 v220, v64, v65
    v_cvt_pk_bf16_f32 v221, v66, v67
    v_cvt_pk_bf16_f32 v238, -v64, -v65
    v_cvt_pk_bf16_f32 v239, -v66, -v67
    v_cvt_pk_bf16_f32 v222, v68, v69
    v_cvt_pk_bf16_f32 v223, v70, v71
    v_cvt_pk_bf16_f32 v236, v68, v69
    v_cvt_pk_bf16_f32 v237, v70, v71
    v_fmamk_f32 v60, v72, 0x3f000000, v73
    v_fmamk_f32 v61, v72, 0x3f040000, v73
    v_fmamk_f32 v62, v72, 0x3f080000, v73
    v_fmamk_f32 v63, v72, 0x3f0c0000, v73
    v_cos_f32 v64, v60
    v_sin_f32 v68, v60
    v_cos_f32 v65, v61
    v_sin_f32 v69, v61
    v_cos_f32 v66, v62
    v_sin_f32 v70, v62
    v_cos_f32 v67, v63
    v_sin_f32 v71, v63
    v_cvt_pk_bf16_f32 v224, v64, v65
    v_cvt_pk_bf16_f32 v225, v66, v67
    v_cvt_pk_bf16_f32 v242, v64, v65
    v_cvt_pk_bf16_f32 v243, v66, v67
    v_cvt_pk_bf16_f32 v226, -v68, -v69
    v_cvt_pk_bf16_f32 v227, -v70, -v71
    v_cvt_pk_bf16_f32 v240, v68, v69
    v_cvt_pk_bf16_f32 v241, v70, v71
    v_fmamk_f32 v60, v72, 0x3f400000, v73
    v_fmamk_f32 v61, v72, 0x3f440000, v73
    v_fmamk_f32 v62, v72, 0x3f480000, v73
    v_fmamk_f32 v63, v72, 0x3f4c0000, v73
    v_cos_f32 v64, v60
    v_sin_f32 v68, v60
    v_cos_f32 v65, v61
    v_sin_f32 v69, v61
    v_cos_f32 v66, v62
    v_sin_f32 v70, v62
    v_cos_f32 v67, v63
    v_sin_f32 v71, v63
    v_cvt_pk_bf16_f32 v228, v64, v65
    v_cvt_pk_bf16_f32 v229, v66, v67
    v_cvt_pk_bf16_f32 v246, v64, v65
    v_cvt_pk_bf16_f32 v247, v66, v67
    v_cvt_pk_bf16_f32 v230, -v68, -v69
    v_cvt_pk_bf16_f32 v231, -v70, -v71
    v_cvt_pk_bf16_f32 v244, v68, v69
    v_cvt_pk_bf16_f32 v245, v70, v71
    v_mul_f32 v61, 0x3ae38e39, v72
    v_mul_f32 v62, 0x3b638e39, v72
    v_mul_f32 v63, 0x3baaaaab, v72
    v_mul_f32 v64, 0x3be38e39, v72
    v_cos_f32 v248, v61
    v_sin_f32 v252, v61
    v_cos_f32 v249, v62
    v_sin_f32 v253, v62
    v_cos_f32 v250, v63
    v_sin_f32 v254, v63
    v_cos_f32 v251, v64
    v_sin_f32 v255, v64
    v_mul_f32 v248, 0x35e38e39, v248
    v_mul_f32 v249, 0x35e38e39, v249
    v_mul_f32 v250, 0x35e38e39, v250
    v_mul_f32 v251, 0x35e38e39, v251
    v_mul_f32 v252, 0x35e38e39, v252
    v_mul_f32 v253, 0x35e38e39, v253
    v_mul_f32 v254, 0x35e38e39, v254
    v_mul_f32 v255, 0x35e38e39, v255
f_c3late:
    s_waitcnt vmcnt(0)
    v_pk_add_f32 v[28:29], v[28:29], v[32:33]
    v_pk_add_f32 v[30:31], v[30:31], v[34:35]
    v_pk_add_f32 v[28:29], v[28:29], v[36:37]
    v_pk_add_f32 v[30:31], v[30:31], v[38:39]
    v_cvt_pk_bf16_f32 v48, v28, v29
    v_lshlrev_b32 v28, 16, v48
    v_and_b32 v29, s47, v48
    v_cvt_pk_bf16_f32 v49, v30, v31
    v_lshlrev_b32 v30, 16, v49
    v_and_b32 v31, s47, v49
    v_add_f32 v28, v28, v3
    v_add_f32 v29, v29, v3
    v_add_f32 v30, v30, v3
    v_add_f32 v31, v31, v3
    v_cvt_pk_bf16_f32 v48, v28, v29
    v_lshlrev_b32 v28, 16, v48
    v_and_b32 v29, s47, v48
    v_cvt_pk_bf16_f32 v49, v30, v31
    v_lshlrev_b32 v30, 16, v49
    v_and_b32 v31, s47, v49
    ds_write_b128 v2, v[28:31] offset:9728
    s_cmp_ge_u32 s2, 254
    s_cselect_b32 s50, s3, 0
    s_cmp_ge_u32 s50, 6
    s_cbranch_scc0 f_nogb
    v_subrev_u32 v2, 432, v0
    v_cmp_gt_u32 vcc, 72, v2
    v_mov_b32 v3, 0x7f000000
    s_nop 0
    v_cndmask_b32 v2, v3, v126, vcc
    s_movk_i32 s50, 4608
    buffer_store_dwordx4 v[28:31], v2, s[28:31], s50 offen sc1
    s_waitcnt vmcnt(0)
f_nogb:
    s_cmp_lt_u32 s2, 33
    s_cbranch_scc1 f_nozsl
    s_sleep 32
f_nozsl:
    s_cmp_lt_u32 s3, 2
    s_cbranch_scc1 f_z2
    s_mov_b32 s50, 0
f_za:
    buffer_load_dwordx4 v[40:43], v113, s[28:31], s48 offen sc1
f_za_chk:
    s_add_u32 s50, s50, 1
    s_waitcnt vmcnt(0)
    v_max3_u32 v48, v40, v41, v42
    v_max_u32 v48, v48, v43
    v_cmp_eq_u32 vcc, -1, v48
    s_nop 0
    s_and_b64 exec, vcc, vcc
    s_cbranch_scc0 f_za_ok
    s_sleep 4
    s_cmp_lt_u32 s50, 30000
    s_cbranch_scc1 f_za
f_za_ok:
    s_mov_b64 exec, -1
    s_branch f_zj
f_z2:
    s_mov_b32 s50, 0
f_zb:
    buffer_load_dwordx4 v[40:43], v113, s[28:31], s48 offen sc1
    buffer_load_dwordx4 v[44:47], v114, s[28:31], s48 offen sc1
f_zb_chk:
    s_add_u32 s50, s50, 1
    s_waitcnt vmcnt(0)
    v_max3_u32 v48, v40, v41, v42
    v_max3_u32 v48, v48, v43, v44
    v_max3_u32 v48, v48, v45, v46
    v_max_u32 v48, v48, v47
    v_cmp_eq_u32 vcc, -1, v48
    s_nop 0
    s_and_b64 exec, vcc, vcc
    s_cbranch_scc0 f_zb_ok
    s_sleep 4
    s_cmp_lt_u32 s50, 30000
    s_cbranch_scc1 f_zb
f_zb_ok:
    s_mov_b64 exec, -1
    ds_write_b64 v115, v[44:45] offset:2304
    ds_write_b64 v115, v[46:47] offset:5184
f_zj:
    ds_write_b64 v115, v[40:41]
    ds_write_b64 v115, v[42:43] offset:2880
    s_cmp_lt_u32 s3, 4
    s_cbranch_scc1 f_plb_done0
    s_cmp_lt_u32 s2, 33
    s_cbranch_scc0 f_plb0
    s_cmp_lt_u32 s2, 216
    s_cbranch_scc0 f_plb00
    s_mov_b32 m0, s24
    s_nop 0
    buffer_load_dwordx4 v9, s[32:35], s60 offen offset:0 lds
    s_add_u32 s25, s60, 35840
    buffer_load_dwordx4 v9, s[32:35], s25 offen offset:1024 lds
    s_add_u32 s26, s60, 71680
    buffer_load_dwordx4 v10, s[32:35], s26 offen offset:2048 lds
    s_add_u32 s27, s60, 107520
    buffer_load_dwordx4 v10, s[32:35], s27 offen offset:3072 lds
    s_add_u32 s60, s60, 589824
    s_add_u32 s24, s24, 16384
    s_mov_b32 m0, s24
    s_nop 0
    buffer_load_dwordx4 v9, s[32:35], s60 offen offset:0 lds
    s_add_u32 s25, s60, 35840
    buffer_load_dwordx4 v9, s[32:35], s25 offen offset:1024 lds
    s_add_u32 s26, s60, 71680
    buffer_load_dwordx4 v10, s[32:35], s26 offen offset:2048 lds
    s_add_u32 s27, s60, 107520
    buffer_load_dwordx4 v10, s[32:35], s27 offen offset:3072 lds
    s_add_u32 s60, s60, 589824
    s_add_u32 s24, s24, 16384
f_plb00:
f_plb0:
    s_cmp_lt_u32 s2, 216
    s_cbranch_scc0 f_plb10
    s_mov_b32 m0, s24
    s_nop 0
    buffer_load_dwordx4 v9, s[32:35], s60 offen offset:0 lds
    s_add_u32 s25, s60, 35840
    buffer_load_dwordx4 v9, s[32:35], s25 offen offset:1024 lds
    s_add_u32 s26, s60, 71680
    buffer_load_dwordx4 v10, s[32:35], s26 offen offset:2048 lds
    s_add_u32 s27, s60, 107520
    buffer_load_dwordx4 v10, s[32:35], s27 offen offset:3072 lds
    s_add_u32 s60, s60, 589824
    s_add_u32 s24, s24, 16384
    s_mov_b32 m0, s24
    s_nop 0
    buffer_load_dwordx4 v9, s[32:35], s60 offen offset:0 lds
    s_add_u32 s25, s60, 35840
    buffer_load_dwordx4 v9, s[32:35], s25 offen offset:1024 lds
    s_add_u32 s26, s60, 71680
    buffer_load_dwordx4 v10, s[32:35], s26 offen offset:2048 lds
    s_add_u32 s27, s60, 107520
    buffer_load_dwordx4 v10, s[32:35], s27 offen offset:3072 lds
    s_add_u32 s60, s60, 589824
    s_add_u32 s24, s24, 16384
f_plb10:
f_plb_done0:
    s_waitcnt lgkmcnt(0)
    s_barrier
    s_cmp_lt_u32 s3, 4
    s_cbranch_scc1 f_plb_done1
    s_cmp_lt_u32 s3, 4
    s_cbranch_scc1 f_not3
    s_sub_u32 s50, s37, 0
    s_cbranch_scc1 f_not3
    s_lshl_b32 s50, s50, 2
    s_add_u32 s50, s50, s39
    s_add_u32 s58, s50, 64
    s_mul_i32 s58, s58, 55296
    s_add_u32 s58, s58, s57
    buffer_load_dword v8, v17, s[32:35], s58 offen
    s_add_u32 s58, s58, 7077888
    s_cmp_lt_u32 s50, 69
    s_cbranch_scc0 ftch_9
    buffer_load_dword v8, v17, s[32:35], s58 offen
ftch_9:
f_not3:
f_plb_done1:
    v_cmp_eq_u32 s[44:45], 1, v6
    v_cmp_eq_u32 s[50:51], 2, v6
    v_cmp_eq_u32 s[58:59], 3, v6
    ds_read_b64_tr_b16 v[28:29], v116 offset:0
    ds_read_b64_tr_b16 v[30:31], v116 offset:2880
    ds_read_b64_tr_b16 v[32:33], v116 offset:128
    ds_read_b64_tr_b16 v[34:35], v116 offset:3008
    ds_read_b64_tr_b16 v[36:37], v116 offset:256
    ds_read_b64_tr_b16 v[38:39], v116 offset:3136
    ds_read_b64_tr_b16 v[40:41], v116 offset:384
    ds_read_b64_tr_b16 v[42:43], v116 offset:3264
    ds_read_b64_tr_b16 v[44:45], v117 offset:0
    ds_read_b64_tr_b16 v[46:47], v117 offset:2880
    ds_read_b64_tr_b16 v[48:49], v117 offset:128
    ds_read_b64_tr_b16 v[50:51], v117 offset:3008
    ds_read_b64_tr_b16 v[52:53], v117 offset:256
    ds_read_b64_tr_b16 v[54:55], v117 offset:3136
    ds_read_b64_tr_b16 v[56:57], v117 offset:384
    ds_read_b64_tr_b16 v[58:59], v117 offset:3264
    s_waitcnt lgkmcnt(14)
    v_mfma_f32_16x16x32_bf16 v[60:63], v[28:31], v[216:219], 0
    v_mfma_f32_16x16x32_bf16 v[64:67], v[28:31], v[232:235], 0
    s_waitcnt lgkmcnt(12)
    v_mfma_f32_16x16x32_bf16 v[60:63], v[32:35], v[220:223], v[60:63]
    v_mfma_f32_16x16x32_bf16 v[64:67], v[32:35], v[236:239], v[64:67]
    s_waitcnt lgkmcnt(10)
    v_mfma_f32_16x16x32_bf16 v[60:63], v[36:39], v[224:227], v[60:63]
    v_mfma_f32_16x16x32_bf16 v[64:67], v[36:39], v[240:243], v[64:67]
    s_waitcnt lgkmcnt(8)
    v_mfma_f32_16x16x32_bf16 v[60:63], v[40:43], v[228:231], v[60:63]
    v_mfma_f32_16x16x32_bf16 v[64:67], v[40:43], v[244:247], v[64:67]
    s_waitcnt lgkmcnt(6)
    v_mfma_f32_16x16x32_bf16 v[68:71], v[44:47], v[216:219], 0
    s_waitcnt lgkmcnt(4)
    v_mfma_f32_16x16x32_bf16 v[68:71], v[48:51], v[220:223], v[68:71]
    s_waitcnt lgkmcnt(2)
    v_mfma_f32_16x16x32_bf16 v[68:71], v[52:55], v[224:227], v[68:71]
    s_waitcnt lgkmcnt(0)
    v_mfma_f32_16x16x32_bf16 v[68:71], v[56:59], v[228:231], v[68:71]
    ds_read_u16_d16_hi v18, v127 offset:0
    ds_read_u16_d16_hi v19, v127 offset:128
    ds_read_u16_d16_hi v20, v127 offset:256
    ds_read_u16_d16_hi v21, v127 offset:384
    ds_read_u16_d16_hi v22, v127 offset:512
    ds_read_u16_d16_hi v23, v127 offset:640
    ds_read_u16_d16_hi v24, v127 offset:768
    ds_read_u16_d16_hi v25, v127 offset:896
    ds_read_u16_d16_hi v26, v127 offset:1024
    ds_read2st64_b32 v[72:73], v124 offset0:38 offset1:39
    ds_read2st64_b32 v[74:75], v124 offset0:40 offset1:41
    ds_read2st64_b32 v[76:77], v124 offset0:42 offset1:43
    ds_read2st64_b32 v[78:79], v124 offset0:44 offset1:45
    ds_read2st64_b32 v[80:81], v124 offset0:46 offset1:47
    ds_read2st64_b32 v[82:83], v124 offset0:48 offset1:49
    ds_read2st64_b32 v[84:85], v124 offset0:50 offset1:51
    ds_read2st64_b32 v[86:87], v124 offset0:52 offset1:53
    ds_read2st64_b32 v[88:89], v124 offset0:54 offset1:55
    ds_read2st64_b32 v[90:91], v124 offset0:56 offset1:57
    ds_read2st64_b32 v[92:93], v124 offset0:58 offset1:59
    ds_read2st64_b32 v[94:95], v124 offset0:60 offset1:61
    ds_read2st64_b32 v[96:97], v124 offset0:62 offset1:63
    ds_read_b32 v98, v124 offset:16384
    v_permlane32_swap_b32 v60, v62
    v_permlane32_swap_b32 v61, v63
    v_permlane32_swap_b32 v64, v66
    v_permlane32_swap_b32 v65, v67
    v_permlane16_swap_b32 v60, v61
    v_permlane16_swap_b32 v62, v63
    v_permlane16_swap_b32 v64, v65
    v_permlane16_swap_b32 v66, v67
    v_pk_mul_f32 v[28:29], v[60:61], v[248:249]
    v_pk_mul_f32 v[32:33], v[64:65], v[248:249]
    v_pk_mul_f32 v[30:31], v[62:63], v[250:251]
    v_pk_mul_f32 v[34:35], v[66:67], v[250:251]
    v_pk_fma_f32 v[28:29], v[64:65], v[252:253], v[28:29] neg_lo:[1,0,0] neg_hi:[1,0,0]
    v_pk_fma_f32 v[32:33], v[60:61], v[252:253], v[32:33]
    v_pk_fma_f32 v[30:31], v[66:67], v[254:255], v[30:31] neg_lo:[1,0,0] neg_hi:[1,0,0]
    v_pk_fma_f32 v[34:35], v[62:63], v[254:255], v[34:35]
    v_cndmask_b32 v36, v68, v69, s[44:45]
    v_cndmask_b32 v36, v36, v70, s[50:51]
    v_cndmask_b32 v36, v36, v71, s[58:59]
    v_mul_f32 v36, 0x35638e39, v36
    v_add_f32 v37, v36, v28
    v_add_f32 v38, v29, v30
    v_add_f32 v37, v37, v31
    v_add_f32 v37, v37, v38
    v_fmamk_f32 v40, v28, 0x3f441b7d, v36
    v_fmamk_f32 v41, v28, 0x3e31d0d4, v36
    v_fmamk_f32 v42, v28, 0xbf000000, v36
    v_fmamk_f32 v43, v28, 0xbf708fb2, v36
    v_fmamk_f32 v40, v29, 0x3e31d0d4, v40
    v_fmamk_f32 v41, v29, 0xbf708fb2, v41
    v_fmamk_f32 v42, v29, 0xbf000000, v42
    v_fmamk_f32 v43, v29, 0x3f441b7d, v43
    v_fmamk_f32 v40, v30, 0xbf000000, v40
    v_fmamk_f32 v41, v30, 0xbf000000, v41
    v_fmamk_f32 v42, v30, 0x3f800000, v42
    v_fmamk_f32 v43, v30, 0xbf000000, v43
    v_fmamk_f32 v40, v31, 0xbf708fb2, v40
    v_fmamk_f32 v41, v31, 0x3f441b7d, v41
    v_fmamk_f32 v42, v31, 0xbf000000, v42
    v_fmamk_f32 v43, v31, 0x3e31d0d4, v43
    v_mul_f32 v44, 0x3f248dbb, v32
    v_mul_f32 v45, 0x3f7c1c5c, v32
    v_mul_f32 v46, 0x3f5db3d7, v32
    v_mul_f32 v47, 0x3eaf1d44, v32
    v_fmamk_f32 v44, v33, 0x3f7c1c5c, v44
    v_fmamk_f32 v45, v33, 0x3eaf1d44, v45
    v_fmamk_f32 v46, v33, 0xbf5db3d7, v46
    v_fmamk_f32 v47, v33, 0xbf248dbb, v47
    v_fmamk_f32 v44, v34, 0x3f5db3d7, v44
    v_fmamk_f32 v45, v34, 0xbf5db3d7, v45
    v_fmamk_f32 v47, v34, 0x3f5db3d7, v47
    v_fmamk_f32 v44, v35, 0x3eaf1d44, v44
    v_fmamk_f32 v45, v35, 0xbf248dbb, v45
    v_fmamk_f32 v46, v35, 0x3f5db3d7, v46
    v_fmamk_f32 v47, v35, 0xbf7c1c5c, v47
    s_waitcnt lgkmcnt(9)
    v_fmac_f32 v18, v37, v72
    v_sub_f32 v50, v40, v44
    v_add_f32 v51, v40, v44
    v_fmac_f32 v19, v50, v73
    v_fmac_f32 v26, v51, v80
    v_sub_f32 v48, v41, v45
    v_add_f32 v49, v41, v45
    v_fmac_f32 v20, v48, v74
    v_fmac_f32 v25, v49, v79
    v_sub_f32 v50, v42, v46
    v_add_f32 v51, v42, v46
    v_fmac_f32 v21, v50, v75
    v_fmac_f32 v24, v51, v78
    v_sub_f32 v48, v43, v47
    v_add_f32 v49, v43, v47
    v_fmac_f32 v22, v48, v76
    v_fmac_f32 v23, v49, v77
    v_cvt_pk_bf16_f32 v60, v18, v19
    v_cvt_pk_bf16_f32 v61, v20, v21
    v_cvt_pk_bf16_f32 v62, v22, v23
    v_cvt_pk_bf16_f32 v63, v24, v25
    v_cvt_pk_bf16_f32 v64, v26, v26
    v_lshlrev_b32 v18, 16, v60
    v_and_b32 v19, s47, v60
    v_lshlrev_b32 v20, 16, v61
    v_and_b32 v21, s47, v61
    v_lshlrev_b32 v22, 16, v62
    v_and_b32 v23, s47, v62
    v_lshlrev_b32 v24, 16, v63
    v_and_b32 v25, s47, v63
    v_lshlrev_b32 v26, 16, v64
    ds_write_b16 v127, v60 offset:0
    ds_write_b16_d16_hi v127, v60 offset:128
    ds_write_b16 v127, v61 offset:256
    ds_write_b16_d16_hi v127, v61 offset:384
    ds_write_b16 v127, v62 offset:512
    ds_write_b16_d16_hi v127, v62 offset:640
    ds_write_b16 v127, v63 offset:768
    ds_write_b16_d16_hi v127, v63 offset:896
    ds_write_b16 v127, v64 offset:1024
    s_add_u32 s52, s49, 10485760
    s_add_u32 s50, s55, 0
    v_add_u32 v2, s50, v109
    v_cmp_eq_u32 s[44:45], 0, v5
    v_add_f32 v56, v18, v19
    v_mul_f32 v57, v18, v18
    v_fmac_f32 v57, v19, v19
    v_add_f32 v56, v56, v20
    v_fmac_f32 v57, v20, v20
    v_add_f32 v56, v56, v21
    v_fmac_f32 v57, v21, v21
    v_add_f32 v56, v56, v22
    v_fmac_f32 v57, v22, v22
    v_add_f32 v56, v56, v23
    v_fmac_f32 v57, v23, v23
    v_add_f32 v56, v56, v24
    v_fmac_f32 v57, v24, v24
    v_add_f32 v56, v56, v25
    v_fmac_f32 v57, v25, v25
    v_add_f32 v56, v56, v26
    v_fmac_f32 v57, v26, v26
    s_nop 0
    v_add_f32_dpp v56, v56, v56 quad_perm:[1,0,3,2] row_mask:0xf bank_mask:0xf
    v_add_f32_dpp v57, v57, v57 quad_perm:[1,0,3,2] row_mask:0xf bank_mask:0xf
    s_nop 0
    v_add_f32_dpp v56, v56, v56 quad_perm:[2,3,0,1] row_mask:0xf bank_mask:0xf
    v_add_f32_dpp v57, v57, v57 quad_perm:[2,3,0,1] row_mask:0xf bank_mask:0xf
    s_nop 0
    v_add_f32_dpp v56, v56, v56 row_half_mirror row_mask:0xf bank_mask:0xf
    v_add_f32_dpp v57, v57, v57 row_half_mirror row_mask:0xf bank_mask:0xf
    s_nop 0
    v_add_f32_dpp v56, v56, v56 row_mirror row_mask:0xf bank_mask:0xf
    v_add_f32_dpp v57, v57, v57 row_mirror row_mask:0xf bank_mask:0xf
    s_mov_b64 exec, s[44:45]
    ds_write_b64 v120, v[56:57] offset:0
    s_mov_b64 exec, -1
    s_waitcnt lgkmcnt(0)
    s_barrier
    ds_read_b128 v[48:51], v119 offset:0
    ds_read_b128 v[52:55], v119 offset:16
    v_mov_b32 v58, 0x3727c5ac
    s_waitcnt lgkmcnt(0)
    s_cmp_lt_u32 s3, 4
    s_cbranch_scc0 f_nox1r
    ds_read_b128 v[28:31], v2 offset:0
    ds_read_b128 v[32:35], v2 offset:1024
    ds_read_b128 v[36:39], v2 offset:4736
    ds_read_b128 v[40:43], v2 offset:5760
f_nox1r:
    v_pk_add_f32 v[48:49], v[48:49], v[50:51]
    v_pk_add_f32 v[52:53], v[52:53], v[54:55]
    v_pk_add_f32 v[48:49], v[48:49], v[52:53]
    v_mul_f32 v56, 0x3ae38e39, v48
    v_fmamk_f32 v57, v49, 0x3ae38e39, v58
    v_fma_f32 v57, -v56, v56, v57
    v_rsq_f32 v57, v57
    s_nop 0
    v_mul_f32 v56, -v56, v57
    v_fma_f32 v18, v18, v57, v56
    v_fma_f32 v19, v19, v57, v56
    v_fma_f32 v20, v20, v57, v56
    v_fma_f32 v21, v21, v57, v56
    v_fma_f32 v22, v22, v57, v56
    v_fma_f32 v23, v23, v57, v56
    v_fma_f32 v24, v24, v57, v56
    v_fma_f32 v25, v25, v57, v56
    v_fma_f32 v26, v26, v57, v56
    s_cmp_lt_u32 s3, 4
    s_cbranch_scc0 f_nox1s
    s_add_u32 s50, s52, 4608
    s_waitcnt lgkmcnt(0)
    buffer_store_dwordx4 v[28:31], v109, s[28:31], s52 offen sc1
    buffer_store_dwordx4 v[36:39], v109, s[28:31], s50 offen sc1
    s_mov_b64 exec, 0xff
    buffer_store_dwordx4 v[32:35], v109, s[28:31], s52 offen offset:1024 sc1
    buffer_store_dwordx4 v[40:43], v109, s[28:31], s50 offen offset:1024 sc1
    s_mov_b64 exec, -1
f_nox1s:
    v_fma_f32 v18, v18, v90, v81
    v_fma_f32 v19, v19, v91, v82
    v_fma_f32 v20, v20, v92, v83
    v_fma_f32 v21, v21, v93, v84
    v_fma_f32 v22, v22, v94, v85
    v_fma_f32 v23, v23, v95, v86
    v_fma_f32 v24, v24, v96, v87
    v_fma_f32 v25, v25, v97, v88
    v_fma_f32 v26, v26, v98, v89
    v_add_f32 v56, v18, v19
    v_mul_f32 v57, v18, v18
    v_fmac_f32 v57, v19, v19
    v_add_f32 v56, v56, v20
    v_fmac_f32 v57, v20, v20
    v_add_f32 v56, v56, v21
    v_fmac_f32 v57, v21, v21
    v_add_f32 v56, v56, v22
    v_fmac_f32 v57, v22, v22
    v_add_f32 v56, v56, v23
    v_fmac_f32 v57, v23, v23
    v_add_f32 v56, v56, v24
    v_fmac_f32 v57, v24, v24
    v_add_f32 v56, v56, v25
    v_fmac_f32 v57, v25, v25
    v_add_f32 v56, v56, v26
    v_fmac_f32 v57, v26, v26
    s_nop 0
    v_add_f32_dpp v56, v56, v56 quad_perm:[1,0,3,2] row_mask:0xf bank_mask:0xf
    v_add_f32_dpp v57, v57, v57 quad_perm:[1,0,3,2] row_mask:0xf bank_mask:0xf
    s_nop 0
    v_add_f32_dpp v56, v56, v56 quad_perm:[2,3,0,1] row_mask:0xf bank_mask:0xf
    v_add_f32_dpp v57, v57, v57 quad_perm:[2,3,0,1] row_mask:0xf bank_mask:0xf
    s_nop 0
    v_add_f32_dpp v56, v56, v56 row_half_mirror row_mask:0xf bank_mask:0xf
    v_add_f32_dpp v57, v57, v57 row_half_mirror row_mask:0xf bank_mask:0xf
    s_nop 0
    v_add_f32_dpp v56, v56, v56 row_mirror row_mask:0xf bank_mask:0xf
    v_add_f32_dpp v57, v57, v57 row_mirror row_mask:0xf bank_mask:0xf
    s_mov_b64 exec, s[44:45]
    ds_write_b64 v120, v[56:57] offset:256
    s_mov_b64 exec, -1
    s_waitcnt lgkmcnt(0)
    s_barrier
    ds_read_b128 v[48:51], v119 offset:256
    ds_read_b128 v[52:55], v119 offset:272
    v_mov_b32 v58, 0x3727c5ac
    s_waitcnt lgkmcnt(0)
    v_pk_add_f32 v[48:49], v[48:49], v[50:51]
    v_pk_add_f32 v[52:53], v[52:53], v[54:55]
    v_pk_add_f32 v[48:49], v[48:49], v[52:53]
    v_mul_f32 v56, 0x3ae38e39, v48
    v_fmamk_f32 v57, v49, 0x3ae38e39, v58
    v_fma_f32 v57, -v56, v56, v57
    v_rsq_f32 v57, v57
    s_nop 0
    v_mul_f32 v56, -v56, v57
    v_fma_f32 v18, v18, v57, v56
    v_fma_f32 v19, v19, v57, v56
    v_fma_f32 v20, v20, v57, v56
    v_fma_f32 v21, v21, v57, v56
    v_fma_f32 v22, v22, v57, v56
    v_fma_f32 v23, v23, v57, v56
    v_fma_f32 v24, v24, v57, v56
    v_fma_f32 v25, v25, v57, v56
    v_fma_f32 v26, v26, v57, v56
    v_mov_b32 v27, 0
    v_permlane16_swap_b32 v18, v19
    v_permlane16_swap_b32 v20, v21
    v_permlane16_swap_b32 v22, v23
    v_permlane16_swap_b32 v24, v25
    v_permlane16_swap_b32 v26, v27
    v_cvt_pk_bf16_f32 v28, v18, v19
    v_cvt_pk_bf16_f32 v29, v20, v21
    v_cvt_pk_bf16_f32 v30, v22, v23
    v_cvt_pk_bf16_f32 v31, v24, v25
    v_cvt_pk_bf16_f32 v32, v26, v27
    v_mov_b32 v33, 0
    v_permlane32_swap_b32 v28, v29
    v_permlane32_swap_b32 v30, v31
    v_permlane32_swap_b32 v32, v33
    s_mul_i32 s50, s38, 1536
    ds_write_b64 v121, v[28:29]
    ds_write_b64 v121, v[30:31] offset:4096
    s_mov_b64 exec, 0xffff
    ds_write_b64 v121, v[32:33] offset:8192
    s_mov_b64 exec, -1
    s_add_u32 s50, s50, 13631488
    v_lshlrev_b32 v2, 4, v0
    v_add_u32 v3, 8192, v2
    v_add_u32 v4, 8192, v109
    s_waitcnt lgkmcnt(0)
    s_barrier
    s_cmp_lt_u32 s3, 4
    s_cbranch_scc1 f_plb_done3
    s_cmp_lt_u32 s2, 216
    s_cbranch_scc0 f_plb13
    s_mov_b32 m0, s24
    s_nop 0
    buffer_load_dwordx4 v9, s[32:35], s60 offen offset:0 lds
    s_add_u32 s25, s60, 35840
    buffer_load_dwordx4 v9, s[32:35], s25 offen offset:1024 lds
    s_add_u32 s26, s60, 71680
    buffer_load_dwordx4 v10, s[32:35], s26 offen offset:2048 lds
    s_add_u32 s27, s60, 107520
    buffer_load_dwordx4 v10, s[32:35], s27 offen offset:3072 lds
    s_add_u32 s60, s60, 589824
    s_add_u32 s24, s24, 16384
    s_mov_b32 m0, s24
    s_nop 0
    buffer_load_dwordx4 v9, s[32:35], s60 offen offset:0 lds
    s_add_u32 s25, s60, 35840
    buffer_load_dwordx4 v9, s[32:35], s25 offen offset:1024 lds
    s_add_u32 s26, s60, 71680
    buffer_load_dwordx4 v10, s[32:35], s26 offen offset:2048 lds
    s_add_u32 s27, s60, 107520
    buffer_load_dwordx4 v10, s[32:35], s27 offen offset:3072 lds
    s_add_u32 s60, s60, 589824
    s_add_u32 s24, s24, 16384
f_plb13:
f_plb_done3:
    s_cmp_lt_u32 s3, 4
    s_cbranch_scc0 f_h2none
    ds_read_b128 v[28:31], v2 offset:17920
    ds_read_b128 v[32:35], v3 offset:13824
    s_cmp_eq_u32 s3, 1
    s_cbranch_scc0 f_h2one
    ds_read_b128 v[36:39], v4 offset:17920
    s_waitcnt lgkmcnt(0)
    buffer_store_dwordx4 v[36:39], v123, s[28:31], s50 offen sc1
f_h2one:
    s_waitcnt lgkmcnt(1)
    buffer_store_dwordx4 v[28:31], v122, s[28:31], s50 offen sc1
    s_waitcnt lgkmcnt(0)
    buffer_store_dwordx4 v[32:35], v118, s[28:31], s50 offen sc1
    s_waitcnt vmcnt(0)
f_h2none:
    v_mov_b32 v3, 1
    s_lshl_b32 s50, s38, 10
    s_add_u32 s50, s50, 262400
    s_barrier
    s_cmp_eq_u32 s3, 0
    s_cbranch_scc0 t_noflag
    s_mov_b64 exec, 1
    buffer_store_dword v3, off, s[28:31], s50 sc1
    s_mov_b64 exec, -1
t_noflag:
    s_cmp_ge_u32 s2, 216
    s_cbranch_scc1 t_spare
    s_cmp_lt_u32 s3, 4
    s_cbranch_scc1 t_cons
    s_mul_i32 s4, s39, 3072
    s_add_u32 m0, s4, 12288
    s_nop 0
    buffer_load_dwordx4 v14, s[28:31], s61 offen offset:0 lds
    buffer_load_dwordx4 v14, s[28:31], s61 offen offset:1024 lds
    buffer_load_dwordx4 v14, s[28:31], s61 offen offset:2048 lds
    s_add_u32 m0, s4, 24576
    s_add_u32 s25, s61, 12288
    buffer_load_dwordx4 v14, s[28:31], s25 offen offset:0 lds
    buffer_load_dwordx4 v14, s[28:31], s25 offen offset:1024 lds
    buffer_load_dwordx4 v14, s[28:31], s25 offen offset:2048 lds
    s_add_u32 m0, s4, 36864
    s_add_u32 s25, s61, 24576
    buffer_load_dwordx4 v14, s[28:31], s25 offen offset:0 lds
    buffer_load_dwordx4 v14, s[28:31], s25 offen offset:1024 lds
    buffer_load_dwordx4 v14, s[28:31], s25 offen offset:2048 lds
    s_add_u32 m0, s4, 49152
    s_add_u32 s25, s61, 36864
    buffer_load_dwordx4 v14, s[28:31], s25 offen offset:0 lds
    buffer_load_dwordx4 v14, s[28:31], s25 offen offset:1024 lds
    buffer_load_dwordx4 v14, s[28:31], s25 offen offset:2048 lds
    v_lshrrev_b32 v2, 1, v1
    v_lshlrev_b32 v2, 13, v2
    v_and_b32 v3, 1, v1
    v_lshl_add_u32 v2, v3, 10, v2
    s_lshl_b32 s50, s39, 11
    s_add_u32 s50, s50, 262400
    s_mul_i32 s4, s39, 3072
    s_sub_u32 s24, s24, 98304
    v_add_u32 v18, s24, v14
    v_add_u32 v19, 65536, v18
    s_mov_b64 s[54:55], 0
    s_mov_b32 s56, 16
    v_add_u32 v16, s4, v14
    s_waitcnt vmcnt(9) lgkmcnt(0)
    s_mov_b32 s51, 0
val_10:
    ds_read_b128 v[24:27], v16 offset:12288
    ds_read_b128 v[28:31], v16 offset:13312
    ds_read_b128 v[32:35], v16 offset:14336
    s_waitcnt lgkmcnt(2)
    v_max3_u32 v24, v24, v25, v26
    v_max_u32 v24, v24, v27
    s_waitcnt lgkmcnt(1)
    v_max3_u32 v28, v28, v29, v30
    v_max3_u32 v28, v28, v31, v24
    s_waitcnt lgkmcnt(0)
    v_max3_u32 v32, v32, v33, v34
    v_max3_u32 v32, v32, v35, v28
    v_cmp_eq_u32 vcc, -1, v32
    s_nop 0
    s_and_b64 exec, vcc, vcc
    s_cbranch_scc0 val_10_ok
    s_cmp_lt_u32 s51, 30000
    s_cbranch_scc0 val_10_ok
    s_cmp_eq_u32 s51, 0
    s_cbranch_scc1 val_10_ns
    s_sleep 2
val_10_ns:
    s_add_u32 s51, s51, 1
    s_add_u32 m0, s4, 12288
    s_nop 0
    buffer_load_dwordx4 v14, s[28:31], s61 offen offset:0 sc1 lds
    buffer_load_dwordx4 v14, s[28:31], s61 offen offset:1024 sc1 lds
    buffer_load_dwordx4 v14, s[28:31], s61 offen offset:2048 sc1 lds
    s_mov_b64 exec, -1
    s_waitcnt vmcnt(0)
    s_branch val_10
val_10_ok:
    s_mov_b64 exec, -1
    s_barrier
    s_add_u32 m0, s4, 0
    s_add_u32 s25, s61, 49152
    buffer_load_dwordx4 v14, s[28:31], s25 offen offset:0 lds
    buffer_load_dwordx4 v14, s[28:31], s25 offen offset:1024 lds
    buffer_load_dwordx4 v14, s[28:31], s25 offen offset:2048 lds
    s_waitcnt vmcnt(9) lgkmcnt(0)
    s_mov_b32 s51, 0
val_11:
    ds_read_b128 v[24:27], v16 offset:24576
    ds_read_b128 v[28:31], v16 offset:25600
    ds_read_b128 v[32:35], v16 offset:26624
    s_waitcnt lgkmcnt(2)
    v_max3_u32 v24, v24, v25, v26
    v_max_u32 v24, v24, v27
    s_waitcnt lgkmcnt(1)
    v_max3_u32 v28, v28, v29, v30
    v_max3_u32 v28, v28, v31, v24
    s_waitcnt lgkmcnt(0)
    v_max3_u32 v32, v32, v33, v34
    v_max3_u32 v32, v32, v35, v28
    v_cmp_eq_u32 vcc, -1, v32
    s_nop 0
    s_and_b64 exec, vcc, vcc
    s_cbranch_scc0 val_11_ok
    s_cmp_lt_u32 s51, 30000
    s_cbranch_scc0 val_11_ok
    s_cmp_eq_u32 s51, 0
    s_cbranch_scc1 val_11_ns
    s_sleep 2
val_11_ns:
    s_add_u32 s51, s51, 1
    s_add_u32 m0, s4, 24576
    s_add_u32 s25, s61, 12288
    buffer_load_dwordx4 v14, s[28:31], s25 offen offset:0 sc1 lds
    buffer_load_dwordx4 v14, s[28:31], s25 offen offset:1024 sc1 lds
    buffer_load_dwordx4 v14, s[28:31], s25 offen offset:2048 sc1 lds
    s_mov_b64 exec, -1
    s_waitcnt vmcnt(0)
    s_branch val_11
val_11_ok:
    s_mov_b64 exec, -1
    s_barrier
    s_add_u32 m0, s24, 0
    s_nop 0
    buffer_load_dwordx4 v9, s[32:35], s60 offen offset:0 lds
    s_add_u32 s45, s60, 35840
    buffer_load_dwordx4 v9, s[32:35], s45 offen offset:1024 lds
    s_add_u32 s46, s60, 71680
    buffer_load_dwordx4 v10, s[32:35], s46 offen offset:2048 lds
    s_add_u32 s44, s60, 107520
    buffer_load_dwordx4 v10, s[32:35], s44 offen offset:3072 lds
    s_add_u32 m0, s4, 12288
    s_add_u32 s25, s61, 61440
    buffer_load_dwordx4 v14, s[28:31], s25 offen offset:0 lds
    buffer_load_dwordx4 v14, s[28:31], s25 offen offset:1024 lds
    buffer_load_dwordx4 v14, s[28:31], s25 offen offset:2048 lds
    s_waitcnt vmcnt(13) lgkmcnt(0)
    s_mov_b32 s51, 0
val_12:
    ds_read_b128 v[24:27], v16 offset:36864
    ds_read_b128 v[28:31], v16 offset:37888
    ds_read_b128 v[32:35], v16 offset:38912
    s_waitcnt lgkmcnt(2)
    v_max3_u32 v24, v24, v25, v26
    v_max_u32 v24, v24, v27
    s_waitcnt lgkmcnt(1)
    v_max3_u32 v28, v28, v29, v30
    v_max3_u32 v28, v28, v31, v24
    s_waitcnt lgkmcnt(0)
    v_max3_u32 v32, v32, v33, v34
    v_max3_u32 v32, v32, v35, v28
    v_cmp_eq_u32 vcc, -1, v32
    s_nop 0
    s_and_b64 exec, vcc, vcc
    s_cbranch_scc0 val_12_ok
    s_cmp_lt_u32 s51, 30000
    s_cbranch_scc0 val_12_ok
    s_cmp_eq_u32 s51, 0
    s_cbranch_scc1 val_12_ns
    s_sleep 2
val_12_ns:
    s_add_u32 s51, s51, 1
    s_add_u32 m0, s4, 36864
    s_add_u32 s25, s61, 24576
    buffer_load_dwordx4 v14, s[28:31], s25 offen offset:0 sc1 lds
    buffer_load_dwordx4 v14, s[28:31], s25 offen offset:1024 sc1 lds
    buffer_load_dwordx4 v14, s[28:31], s25 offen offset:2048 sc1 lds
    s_mov_b64 exec, -1
    s_waitcnt vmcnt(0)
    s_branch val_12
val_12_ok:
    s_mov_b64 exec, -1
    s_barrier
    s_add_u32 m0, s24, 16384
    s_add_u32 s44, s60, 589824
    buffer_load_dwordx4 v9, s[32:35], s44 offen offset:0 lds
    s_add_u32 s45, s60, 625664
    buffer_load_dwordx4 v9, s[32:35], s45 offen offset:1024 lds
    s_add_u32 s46, s60, 661504
    buffer_load_dwordx4 v10, s[32:35], s46 offen offset:2048 lds
    s_add_u32 s44, s60, 697344
    buffer_load_dwordx4 v10, s[32:35], s44 offen offset:3072 lds
    s_add_u32 m0, s4, 24576
    s_add_u32 s25, s61, 73728
    buffer_load_dwordx4 v14, s[28:31], s25 offen offset:0 lds
    buffer_load_dwordx4 v14, s[28:31], s25 offen offset:1024 lds
    buffer_load_dwordx4 v14, s[28:31], s25 offen offset:2048 lds
    s_waitcnt vmcnt(17) lgkmcnt(0)
    s_mov_b32 s51, 0
val_13:
    ds_read_b128 v[24:27], v16 offset:49152
    ds_read_b128 v[28:31], v16 offset:50176
    ds_read_b128 v[32:35], v16 offset:51200
    s_waitcnt lgkmcnt(2)
    v_max3_u32 v24, v24, v25, v26
    v_max_u32 v24, v24, v27
    s_waitcnt lgkmcnt(1)
    v_max3_u32 v28, v28, v29, v30
    v_max3_u32 v28, v28, v31, v24
    s_waitcnt lgkmcnt(0)
    v_max3_u32 v32, v32, v33, v34
    v_max3_u32 v32, v32, v35, v28
    v_cmp_eq_u32 vcc, -1, v32
    s_nop 0
    s_and_b64 exec, vcc, vcc
    s_cbranch_scc0 val_13_ok
    s_cmp_lt_u32 s51, 30000
    s_cbranch_scc0 val_13_ok
    s_cmp_eq_u32 s51, 0
    s_cbranch_scc1 val_13_ns
    s_sleep 2
val_13_ns:
    s_add_u32 s51, s51, 1
    s_add_u32 m0, s4, 49152
    s_add_u32 s25, s61, 36864
    buffer_load_dwordx4 v14, s[28:31], s25 offen offset:0 sc1 lds
    buffer_load_dwordx4 v14, s[28:31], s25 offen offset:1024 sc1 lds
    buffer_load_dwordx4 v14, s[28:31], s25 offen offset:2048 sc1 lds
    s_mov_b64 exec, -1
    s_waitcnt vmcnt(0)
    s_branch val_13
val_13_ok:
    s_mov_b64 exec, -1
    s_barrier
    buffer_load_dword v3, v2, s[28:31], s50 offen sc1
    s_add_u32 m0, s24, 32768
    s_add_u32 s44, s60, 1179648
    buffer_load_dwordx4 v9, s[32:35], s44 offen offset:0 lds
    s_add_u32 s45, s60, 1215488
    buffer_load_dwordx4 v9, s[32:35], s45 offen offset:1024 lds
    s_add_u32 s46, s60, 1251328
    buffer_load_dwordx4 v10, s[32:35], s46 offen offset:2048 lds
    s_add_u32 s44, s60, 1287168
    buffer_load_dwordx4 v10, s[32:35], s44 offen offset:3072 lds
    s_add_u32 m0, s4, 36864
    s_add_u32 s25, s61, 86016
    buffer_load_dwordx4 v14, s[28:31], s25 offen offset:0 lds
    buffer_load_dwordx4 v14, s[28:31], s25 offen offset:1024 lds
    buffer_load_dwordx4 v14, s[28:31], s25 offen offset:2048 lds
    s_waitcnt vmcnt(22) lgkmcnt(0)
    s_mov_b32 s51, 0
val_14:
    ds_read_b128 v[24:27], v16 offset:0
    ds_read_b128 v[28:31], v16 offset:1024
    ds_read_b128 v[32:35], v16 offset:2048
    s_waitcnt lgkmcnt(2)
    v_max3_u32 v24, v24, v25, v26
    v_max_u32 v24, v24, v27
    s_waitcnt lgkmcnt(1)
    v_max3_u32 v28, v28, v29, v30
    v_max3_u32 v28, v28, v31, v24
    s_waitcnt lgkmcnt(0)
    v_max3_u32 v32, v32, v33, v34
    v_max3_u32 v32, v32, v35, v28
    v_cmp_eq_u32 vcc, -1, v32
    s_nop 0
    s_and_b64 exec, vcc, vcc
    s_cbranch_scc0 val_14_ok
    s_cmp_lt_u32 s51, 30000
    s_cbranch_scc0 val_14_ok
    s_cmp_eq_u32 s51, 0
    s_cbranch_scc1 val_14_ns
    s_sleep 2
val_14_ns:
    s_add_u32 s51, s51, 1
    s_add_u32 m0, s4, 0
    s_add_u32 s25, s61, 49152
    buffer_load_dwordx4 v14, s[28:31], s25 offen offset:0 sc1 lds
    buffer_load_dwordx4 v14, s[28:31], s25 offen offset:1024 sc1 lds
    buffer_load_dwordx4 v14, s[28:31], s25 offen offset:2048 sc1 lds
    s_mov_b64 exec, -1
    s_waitcnt vmcnt(0)
    s_branch val_14
val_14_ok:
    s_mov_b64 exec, -1
    s_barrier
    s_add_u32 m0, s24, 49152
    s_add_u32 s44, s60, 1769472
    buffer_load_dwordx4 v9, s[32:35], s44 offen offset:0 lds
    s_add_u32 s45, s60, 1805312
    buffer_load_dwordx4 v9, s[32:35], s45 offen offset:1024 lds
    s_add_u32 s46, s60, 1841152
    buffer_load_dwordx4 v10, s[32:35], s46 offen offset:2048 lds
    s_add_u32 s44, s60, 1876992
    buffer_load_dwordx4 v10, s[32:35], s44 offen offset:3072 lds
    s_waitcnt vmcnt(11)
    v_cmp_ne_u32 vcc, 0, v3
    s_nop 0
    s_lshr_b64 s[54:55], vcc, s56
    s_andn2_b64 exec, 0xffff, vcc
    s_cbranch_scc0 g1_skipped_ok
    s_mov_b32 s51, 0
g1_skipped:
    buffer_load_dword v3, v2, s[28:31], s50 offen offset:0 sc1
    s_add_u32 s51, s51, 1
    s_waitcnt vmcnt(0)
    v_cmp_eq_u32 vcc, 0, v3
    s_nop 0
    s_and_b64 exec, vcc, vcc
    s_cbranch_scc0 g1_skipped_ok
    s_sleep 2
    s_cmp_lt_u32 s51, 30000
    s_cbranch_scc1 g1_skipped
g1_skipped_ok:
    s_mov_b64 exec, -1
    s_and_b32 s25, s54, 3
    s_cmp_eq_u32 s25, 3
    s_cbranch_scc1 chk_15_ok
    s_mov_b32 s51, 0
chk_15:
    buffer_load_dword v3, v2, s[28:31], s50 offen sc1
    s_add_u32 s51, s51, 1
    s_mov_b64 exec, -1
    s_waitcnt vmcnt(0)
    v_cmp_ne_u32 vcc, 0, v3
    s_nop 0
    s_lshr_b64 s[54:55], vcc, s56
    s_and_b32 s25, s54, 3
    s_cmp_eq_u32 s25, 3
    s_cbranch_scc1 chk_15_ok
    s_sleep 1
    s_lshl_b64 exec, 0xff, s56
    s_cmp_lt_u32 s51, 30000
    s_cbranch_scc1 chk_15
    s_mov_b64 exec, -1
chk_15_ok:
    s_lshr_b64 s[54:55], s[54:55], 2
    s_add_u32 s56, s56, 2
    s_add_u32 m0, s4, 49152
    s_add_u32 s25, s61, 98304
    buffer_load_dwordx4 v14, s[28:31], s25 offen offset:0 lds
    buffer_load_dwordx4 v14, s[28:31], s25 offen offset:1024 lds
    buffer_load_dwordx4 v14, s[28:31], s25 offen offset:2048 lds
    s_waitcnt vmcnt(22) lgkmcnt(0)
    s_mov_b32 s51, 0
val_16:
    ds_read_b128 v[24:27], v16 offset:12288
    ds_read_b128 v[28:31], v16 offset:13312
    ds_read_b128 v[32:35], v16 offset:14336
    s_waitcnt lgkmcnt(2)
    v_max3_u32 v24, v24, v25, v26
    v_max_u32 v24, v24, v27
    s_waitcnt lgkmcnt(1)
    v_max3_u32 v28, v28, v29, v30
    v_max3_u32 v28, v28, v31, v24
    s_waitcnt lgkmcnt(0)
    v_max3_u32 v32, v32, v33, v34
    v_max3_u32 v32, v32, v35, v28
    v_cmp_eq_u32 vcc, -1, v32
    s_nop 0
    s_and_b64 exec, vcc, vcc
    s_cbranch_scc0 val_16_ok
    s_cmp_lt_u32 s51, 30000
    s_cbranch_scc0 val_16_ok
    s_cmp_eq_u32 s51, 0
    s_cbranch_scc1 val_16_ns
    s_sleep 2
val_16_ns:
    s_add_u32 s51, s51, 1
    s_add_u32 m0, s4, 12288
    s_add_u32 s25, s61, 61440
    buffer_load_dwordx4 v14, s[28:31], s25 offen offset:0 sc1 lds
    buffer_load_dwordx4 v14, s[28:31], s25 offen offset:1024 sc1 lds
    buffer_load_dwordx4 v14, s[28:31], s25 offen offset:2048 sc1 lds
    s_mov_b64 exec, -1
    s_waitcnt vmcnt(0)
    s_branch val_16
val_16_ok:
    s_mov_b64 exec, -1
    s_barrier
    s_add_u32 m0, s24, 65536
    s_add_u32 s44, s60, 2359296
    buffer_load_dwordx4 v9, s[32:35], s44 offen offset:0 lds
    s_add_u32 s45, s60, 2395136
    buffer_load_dwordx4 v9, s[32:35], s45 offen offset:1024 lds
    s_add_u32 s46, s60, 2430976
    buffer_load_dwordx4 v10, s[32:35], s46 offen offset:2048 lds
    s_add_u32 s44, s60, 2466816
    buffer_load_dwordx4 v10, s[32:35], s44 offen offset:3072 lds
    s_and_b32 s25, s54, 3
    s_cmp_eq_u32 s25, 3
    s_cbranch_scc1 chk_17_ok
    s_mov_b32 s51, 0
chk_17:
    buffer_load_dword v3, v2, s[28:31], s50 offen sc1
    s_add_u32 s51, s51, 1
    s_mov_b64 exec, -1
    s_waitcnt vmcnt(0)
    v_cmp_ne_u32 vcc, 0, v3
    s_nop 0
    s_lshr_b64 s[54:55], vcc, s56
    s_and_b32 s25, s54, 3
    s_cmp_eq_u32 s25, 3
    s_cbranch_scc1 chk_17_ok
    s_sleep 1
    s_lshl_b64 exec, 0xff, s56
    s_cmp_lt_u32 s51, 30000
    s_cbranch_scc1 chk_17
    s_mov_b64 exec, -1
chk_17_ok:
    s_lshr_b64 s[54:55], s[54:55], 2
    s_add_u32 s56, s56, 2
    s_add_u32 m0, s4, 0
    s_add_u32 s25, s61, 110592
    buffer_load_dwordx4 v14, s[28:31], s25 offen offset:0 lds
    buffer_load_dwordx4 v14, s[28:31], s25 offen offset:1024 lds
    buffer_load_dwordx4 v14, s[28:31], s25 offen offset:2048 lds
    s_waitcnt vmcnt(22) lgkmcnt(0)
    s_mov_b32 s51, 0
val_18:
    ds_read_b128 v[24:27], v16 offset:24576
    ds_read_b128 v[28:31], v16 offset:25600
    ds_read_b128 v[32:35], v16 offset:26624
    s_waitcnt lgkmcnt(2)
    v_max3_u32 v24, v24, v25, v26
    v_max_u32 v24, v24, v27
    s_waitcnt lgkmcnt(1)
    v_max3_u32 v28, v28, v29, v30
    v_max3_u32 v28, v28, v31, v24
    s_waitcnt lgkmcnt(0)
    v_max3_u32 v32, v32, v33, v34
    v_max3_u32 v32, v32, v35, v28
    v_cmp_eq_u32 vcc, -1, v32
    s_nop 0
    s_and_b64 exec, vcc, vcc
    s_cbranch_scc0 val_18_ok
    s_cmp_lt_u32 s51, 30000
    s_cbranch_scc0 val_18_ok
    s_cmp_eq_u32 s51, 0
    s_cbranch_scc1 val_18_ns
    s_sleep 2
val_18_ns:
    s_add_u32 s51, s51, 1
    s_add_u32 m0, s4, 24576
    s_add_u32 s25, s61, 73728
    buffer_load_dwordx4 v14, s[28:31], s25 offen offset:0 sc1 lds
    buffer_load_dwordx4 v14, s[28:31], s25 offen offset:1024 sc1 lds
    buffer_load_dwordx4 v14, s[28:31], s25 offen offset:2048 sc1 lds
    s_mov_b64 exec, -1
    s_waitcnt vmcnt(0)
    s_branch val_18
val_18_ok:
    s_mov_b64 exec, -1
    s_barrier
    s_add_u32 m0, s24, 81920
    s_add_u32 s44, s60, 2949120
    buffer_load_dwordx4 v9, s[32:35], s44 offen offset:0 lds
    s_add_u32 s45, s60, 2984960
    buffer_load_dwordx4 v9, s[32:35], s45 offen offset:1024 lds
    s_add_u32 s46, s60, 3020800
    buffer_load_dwordx4 v10, s[32:35], s46 offen offset:2048 lds
    s_add_u32 s44, s60, 3056640
    buffer_load_dwordx4 v10, s[32:35], s44 offen offset:3072 lds
    s_and_b32 s25, s54, 3
    s_cmp_eq_u32 s25, 3
    s_cbranch_scc1 chk_19_ok
    s_mov_b32 s51, 0
chk_19:
    buffer_load_dword v3, v2, s[28:31], s50 offen sc1
    s_add_u32 s51, s51, 1
    s_mov_b64 exec, -1
    s_waitcnt vmcnt(0)
    v_cmp_ne_u32 vcc, 0, v3
    s_nop 0
    s_lshr_b64 s[54:55], vcc, s56
    s_and_b32 s25, s54, 3
    s_cmp_eq_u32 s25, 3
    s_cbranch_scc1 chk_19_ok
    s_sleep 1
    s_lshl_b64 exec, 0xff, s56
    s_cmp_lt_u32 s51, 30000
    s_cbranch_scc1 chk_19
    s_mov_b64 exec, -1
chk_19_ok:
    s_lshr_b64 s[54:55], s[54:55], 2
    s_add_u32 s56, s56, 2
    s_add_u32 m0, s4, 12288
    s_add_u32 s25, s61, 122880
    buffer_load_dwordx4 v14, s[28:31], s25 offen offset:0 lds
    buffer_load_dwordx4 v14, s[28:31], s25 offen offset:1024 lds
    buffer_load_dwordx4 v14, s[28:31], s25 offen offset:2048 lds
    s_waitcnt vmcnt(21) lgkmcnt(0)
    s_mov_b32 s51, 0
val_20:
    ds_read_b128 v[24:27], v16 offset:36864
    ds_read_b128 v[28:31], v16 offset:37888
    ds_read_b128 v[32:35], v16 offset:38912
    s_waitcnt lgkmcnt(2)
    v_max3_u32 v24, v24, v25, v26
    v_max_u32 v24, v24, v27
    s_waitcnt lgkmcnt(1)
    v_max3_u32 v28, v28, v29, v30
    v_max3_u32 v28, v28, v31, v24
    s_waitcnt lgkmcnt(0)
    v_max3_u32 v32, v32, v33, v34
    v_max3_u32 v32, v32, v35, v28
    v_cmp_eq_u32 vcc, -1, v32
    s_nop 0
    s_and_b64 exec, vcc, vcc
    s_cbranch_scc0 val_20_ok
    s_cmp_lt_u32 s51, 30000
    s_cbranch_scc0 val_20_ok
    s_cmp_eq_u32 s51, 0
    s_cbranch_scc1 val_20_ns
    s_sleep 2
val_20_ns:
    s_add_u32 s51, s51, 1
    s_add_u32 m0, s4, 36864
    s_add_u32 s25, s61, 86016
    buffer_load_dwordx4 v14, s[28:31], s25 offen offset:0 sc1 lds
    buffer_load_dwordx4 v14, s[28:31], s25 offen offset:1024 sc1 lds
    buffer_load_dwordx4 v14, s[28:31], s25 offen offset:2048 sc1 lds
    s_mov_b64 exec, -1
    s_waitcnt vmcnt(0)
    s_branch val_20
val_20_ok:
    s_mov_b64 exec, -1
    s_barrier
    s_add_u32 m0, s24, 0
    s_add_u32 s44, s60, 3538944
    buffer_load_dwordx4 v9, s[32:35], s44 offen offset:0 lds
    s_add_u32 s45, s60, 3574784
    buffer_load_dwordx4 v9, s[32:35], s45 offen offset:1024 lds
    s_add_u32 s46, s60, 3610624
    buffer_load_dwordx4 v10, s[32:35], s46 offen offset:2048 lds
    s_add_u32 s44, s60, 3646464
    buffer_load_dwordx4 v10, s[32:35], s44 offen offset:3072 lds
    s_and_b32 s25, s54, 3
    s_cmp_eq_u32 s25, 3
    s_cbranch_scc1 chk_21_ok
    s_mov_b32 s51, 0
chk_21:
    buffer_load_dword v3, v2, s[28:31], s50 offen sc1
    s_add_u32 s51, s51, 1
    s_mov_b64 exec, -1
    s_waitcnt vmcnt(0)
    v_cmp_ne_u32 vcc, 0, v3
    s_nop 0
    s_lshr_b64 s[54:55], vcc, s56
    s_and_b32 s25, s54, 3
    s_cmp_eq_u32 s25, 3
    s_cbranch_scc1 chk_21_ok
    s_sleep 1
    s_lshl_b64 exec, 0xff, s56
    s_cmp_lt_u32 s51, 30000
    s_cbranch_scc1 chk_21
    s_mov_b64 exec, -1
chk_21_ok:
    s_lshr_b64 s[54:55], s[54:55], 2
    s_add_u32 s56, s56, 2
    s_add_u32 m0, s4, 24576
    s_add_u32 s25, s61, 135168
    buffer_load_dwordx4 v14, s[28:31], s25 offen offset:0 lds
    buffer_load_dwordx4 v14, s[28:31], s25 offen offset:1024 lds
    buffer_load_dwordx4 v14, s[28:31], s25 offen offset:2048 lds
    s_waitcnt vmcnt(21) lgkmcnt(0)
    s_barrier
    s_add_u32 m0, s24, 16384
    s_add_u32 s44, s60, 4128768
    buffer_load_dwordx4 v9, s[32:35], s44 offen offset:0 lds
    s_add_u32 s45, s60, 4164608
    buffer_load_dwordx4 v9, s[32:35], s45 offen offset:1024 lds
    s_add_u32 s46, s60, 4200448
    buffer_load_dwordx4 v10, s[32:35], s46 offen offset:2048 lds
    s_add_u32 s44, s60, 4236288
    buffer_load_dwordx4 v10, s[32:35], s44 offen offset:3072 lds
    s_and_b32 s25, s54, 3
    s_cmp_eq_u32 s25, 3
    s_cbranch_scc1 chk_22_ok
    s_mov_b32 s51, 0
chk_22:
    buffer_load_dword v3, v2, s[28:31], s50 offen sc1
    s_add_u32 s51, s51, 1
    s_mov_b64 exec, -1
    s_waitcnt vmcnt(0)
    v_cmp_ne_u32 vcc, 0, v3
    s_nop 0
    s_lshr_b64 s[54:55], vcc, s56
    s_and_b32 s25, s54, 3
    s_cmp_eq_u32 s25, 3
    s_cbranch_scc1 chk_22_ok
    s_sleep 1
    s_lshl_b64 exec, 0xff, s56
    s_cmp_lt_u32 s51, 30000
    s_cbranch_scc1 chk_22
    s_mov_b64 exec, -1
chk_22_ok:
    s_lshr_b64 s[54:55], s[54:55], 2
    s_add_u32 s56, s56, 2
    s_add_u32 m0, s4, 36864
    s_add_u32 s25, s61, 147456
    buffer_load_dwordx4 v14, s[28:31], s25 offen offset:0 lds
    buffer_load_dwordx4 v14, s[28:31], s25 offen offset:1024 lds
    buffer_load_dwordx4 v14, s[28:31], s25 offen offset:2048 lds
    s_waitcnt vmcnt(21) lgkmcnt(0)
    s_barrier
    s_add_u32 m0, s24, 32768
    s_add_u32 s44, s60, 4718592
    buffer_load_dwordx4 v9, s[32:35], s44 offen offset:0 lds
    s_add_u32 s45, s60, 4754432
    buffer_load_dwordx4 v9, s[32:35], s45 offen offset:1024 lds
    s_add_u32 s46, s60, 4790272
    buffer_load_dwordx4 v10, s[32:35], s46 offen offset:2048 lds
    s_add_u32 s44, s60, 4826112
    buffer_load_dwordx4 v10, s[32:35], s44 offen offset:3072 lds
    s_and_b32 s25, s54, 3
    s_cmp_eq_u32 s25, 3
    s_cbranch_scc1 chk_23_ok
    s_mov_b32 s51, 0
chk_23:
    buffer_load_dword v3, v2, s[28:31], s50 offen sc1
    s_add_u32 s51, s51, 1
    s_mov_b64 exec, -1
    s_waitcnt vmcnt(0)
    v_cmp_ne_u32 vcc, 0, v3
    s_nop 0
    s_lshr_b64 s[54:55], vcc, s56
    s_and_b32 s25, s54, 3
    s_cmp_eq_u32 s25, 3
    s_cbranch_scc1 chk_23_ok
    s_sleep 1
    s_lshl_b64 exec, 0xff, s56
    s_cmp_lt_u32 s51, 30000
    s_cbranch_scc1 chk_23
    s_mov_b64 exec, -1
chk_23_ok:
    s_lshr_b64 s[54:55], s[54:55], 2
    s_add_u32 s56, s56, 2
    s_add_u32 m0, s4, 49152
    s_add_u32 s25, s61, 159744
    buffer_load_dwordx4 v14, s[28:31], s25 offen offset:0 lds
    buffer_load_dwordx4 v14, s[28:31], s25 offen offset:1024 lds
    buffer_load_dwordx4 v14, s[28:31], s25 offen offset:2048 lds
    s_waitcnt vmcnt(21) lgkmcnt(0)
    s_barrier
    s_add_u32 m0, s24, 49152
    s_add_u32 s44, s60, 5308416
    buffer_load_dwordx4 v9, s[32:35], s44 offen offset:0 lds
    s_add_u32 s45, s60, 5344256
    buffer_load_dwordx4 v9, s[32:35], s45 offen offset:1024 lds
    s_add_u32 s46, s60, 5380096
    buffer_load_dwordx4 v10, s[32:35], s46 offen offset:2048 lds
    s_add_u32 s44, s60, 5415936
    buffer_load_dwordx4 v10, s[32:35], s44 offen offset:3072 lds
    s_and_b32 s25, s54, 3
    s_cmp_eq_u32 s25, 3
    s_cbranch_scc1 chk_24_ok
    s_mov_b32 s51, 0
chk_24:
    buffer_load_dword v3, v2, s[28:31], s50 offen sc1
    s_add_u32 s51, s51, 1
    s_mov_b64 exec, -1
    s_waitcnt vmcnt(0)
    v_cmp_ne_u32 vcc, 0, v3
    s_nop 0
    s_lshr_b64 s[54:55], vcc, s56
    s_and_b32 s25, s54, 3
    s_cmp_eq_u32 s25, 3
    s_cbranch_scc1 chk_24_ok
    s_sleep 1
    s_lshl_b64 exec, 0xff, s56
    s_cmp_lt_u32 s51, 30000
    s_cbranch_scc1 chk_24
    s_mov_b64 exec, -1
chk_24_ok:
    s_lshr_b64 s[54:55], s[54:55], 2
    s_add_u32 s56, s56, 2
    s_add_u32 m0, s4, 0
    s_add_u32 s25, s61, 172032
    buffer_load_dwordx4 v14, s[28:31], s25 offen offset:0 lds
    buffer_load_dwordx4 v14, s[28:31], s25 offen offset:1024 lds
    buffer_load_dwordx4 v14, s[28:31], s25 offen offset:2048 lds
    s_waitcnt vmcnt(21) lgkmcnt(0)
    s_barrier
    s_add_u32 m0, s24, 65536
    s_add_u32 s44, s60, 5898240
    buffer_load_dwordx4 v9, s[32:35], s44 offen offset:0 lds
    s_add_u32 s45, s60, 5934080
    buffer_load_dwordx4 v9, s[32:35], s45 offen offset:1024 lds
    s_add_u32 s46, s60, 5969920
    buffer_load_dwordx4 v10, s[32:35], s46 offen offset:2048 lds
    s_add_u32 s44, s60, 6005760
    buffer_load_dwordx4 v10, s[32:35], s44 offen offset:3072 lds
    s_and_b32 s25, s54, 3
    s_cmp_eq_u32 s25, 3
    s_cbranch_scc1 chk_25_ok
    s_mov_b32 s51, 0
chk_25:
    buffer_load_dword v3, v2, s[28:31], s50 offen sc1
    s_add_u32 s51, s51, 1
    s_mov_b64 exec, -1
    s_waitcnt vmcnt(0)
    v_cmp_ne_u32 vcc, 0, v3
    s_nop 0
    s_lshr_b64 s[54:55], vcc, s56
    s_and_b32 s25, s54, 3
    s_cmp_eq_u32 s25, 3
    s_cbranch_scc1 chk_25_ok
    s_sleep 1
    s_lshl_b64 exec, 0xff, s56
    s_cmp_lt_u32 s51, 30000
    s_cbranch_scc1 chk_25
    s_mov_b64 exec, -1
chk_25_ok:
    s_lshr_b64 s[54:55], s[54:55], 2
    s_add_u32 s56, s56, 2
    s_add_u32 m0, s4, 12288
    s_add_u32 s25, s61, 184320
    buffer_load_dwordx4 v14, s[28:31], s25 offen offset:0 lds
    buffer_load_dwordx4 v14, s[28:31], s25 offen offset:1024 lds
    buffer_load_dwordx4 v14, s[28:31], s25 offen offset:2048 lds
    s_waitcnt vmcnt(21) lgkmcnt(0)
    s_barrier
    s_add_u32 m0, s24, 81920
    s_add_u32 s44, s60, 6488064
    buffer_load_dwordx4 v9, s[32:35], s44 offen offset:0 lds
    s_add_u32 s45, s60, 6523904
    buffer_load_dwordx4 v9, s[32:35], s45 offen offset:1024 lds
    s_add_u32 s46, s60, 6559744
    buffer_load_dwordx4 v10, s[32:35], s46 offen offset:2048 lds
    s_add_u32 s44, s60, 6595584
    buffer_load_dwordx4 v10, s[32:35], s44 offen offset:3072 lds
    s_and_b32 s25, s54, 3
    s_cmp_eq_u32 s25, 3
    s_cbranch_scc1 chk_26_ok
    s_mov_b32 s51, 0
chk_26:
    buffer_load_dword v3, v2, s[28:31], s50 offen sc1
    s_add_u32 s51, s51, 1
    s_mov_b64 exec, -1
    s_waitcnt vmcnt(0)
    v_cmp_ne_u32 vcc, 0, v3
    s_nop 0
    s_lshr_b64 s[54:55], vcc, s56
    s_and_b32 s25, s54, 3
    s_cmp_eq_u32 s25, 3
    s_cbranch_scc1 chk_26_ok
    s_sleep 1
    s_lshl_b64 exec, 0xff, s56
    s_cmp_lt_u32 s51, 30000
    s_cbranch_scc1 chk_26
    s_mov_b64 exec, -1
chk_26_ok:
    s_lshr_b64 s[54:55], s[54:55], 2
    s_add_u32 s56, s56, 2
    s_add_u32 m0, s4, 24576
    s_add_u32 s25, s61, 196608
    buffer_load_dwordx4 v14, s[28:31], s25 offen offset:0 lds
    buffer_load_dwordx4 v14, s[28:31], s25 offen offset:1024 lds
    buffer_load_dwordx4 v14, s[28:31], s25 offen offset:2048 lds
    s_waitcnt vmcnt(21) lgkmcnt(0)
    s_barrier
    s_add_u32 m0, s24, 0
    s_add_u32 s44, s60, 7077888
    buffer_load_dwordx4 v9, s[32:35], s44 offen offset:0 lds
    s_add_u32 s45, s60, 7113728
    buffer_load_dwordx4 v9, s[32:35], s45 offen offset:1024 lds
    s_add_u32 s46, s60, 7149568
    buffer_load_dwordx4 v10, s[32:35], s46 offen offset:2048 lds
    s_add_u32 s44, s60, 7185408
    buffer_load_dwordx4 v10, s[32:35], s44 offen offset:3072 lds
    s_and_b32 s25, s54, 3
    s_cmp_eq_u32 s25, 3
    s_cbranch_scc1 chk_27_ok
    s_mov_b32 s51, 0
chk_27:
    buffer_load_dword v3, v2, s[28:31], s50 offen sc1
    s_add_u32 s51, s51, 1
    s_mov_b64 exec, -1
    s_waitcnt vmcnt(0)
    v_cmp_ne_u32 vcc, 0, v3
    s_nop 0
    s_lshr_b64 s[54:55], vcc, s56
    s_and_b32 s25, s54, 3
    s_cmp_eq_u32 s25, 3
    s_cbranch_scc1 chk_27_ok
    s_sleep 1
    s_lshl_b64 exec, 0xff, s56
    s_cmp_lt_u32 s51, 30000
    s_cbranch_scc1 chk_27
    s_mov_b64 exec, -1
chk_27_ok:
    s_lshr_b64 s[54:55], s[54:55], 2
    s_add_u32 s56, s56, 2
    s_add_u32 m0, s4, 36864
    s_add_u32 s25, s61, 208896
    buffer_load_dwordx4 v14, s[28:31], s25 offen offset:0 lds
    buffer_load_dwordx4 v14, s[28:31], s25 offen offset:1024 lds
    buffer_load_dwordx4 v14, s[28:31], s25 offen offset:2048 lds
    s_waitcnt vmcnt(21) lgkmcnt(0)
    s_barrier
    s_add_u32 m0, s24, 16384
    s_add_u32 s44, s60, 7667712
    buffer_load_dwordx4 v9, s[32:35], s44 offen offset:0 lds
    s_add_u32 s45, s60, 7703552
    buffer_load_dwordx4 v9, s[32:35], s45 offen offset:1024 lds
    s_add_u32 s46, s60, 7739392
    buffer_load_dwordx4 v10, s[32:35], s46 offen offset:2048 lds
    s_add_u32 s44, s60, 7775232
    buffer_load_dwordx4 v10, s[32:35], s44 offen offset:3072 lds
    s_and_b32 s25, s54, 3
    s_cmp_eq_u32 s25, 3
    s_cbranch_scc1 chk_28_ok
    s_mov_b32 s51, 0
chk_28:
    buffer_load_dword v3, v2, s[28:31], s50 offen sc1
    s_add_u32 s51, s51, 1
    s_mov_b64 exec, -1
    s_waitcnt vmcnt(0)
    v_cmp_ne_u32 vcc, 0, v3
    s_nop 0
    s_lshr_b64 s[54:55], vcc, s56
    s_and_b32 s25, s54, 3
    s_cmp_eq_u32 s25, 3
    s_cbranch_scc1 chk_28_ok
    s_sleep 1
    s_lshl_b64 exec, 0xff, s56
    s_cmp_lt_u32 s51, 30000
    s_cbranch_scc1 chk_28
    s_mov_b64 exec, -1
chk_28_ok:
    s_lshr_b64 s[54:55], s[54:55], 2
    s_add_u32 s56, s56, 2
    s_add_u32 m0, s4, 49152
    s_add_u32 s25, s61, 221184
    buffer_load_dwordx4 v14, s[28:31], s25 offen offset:0 lds
    buffer_load_dwordx4 v14, s[28:31], s25 offen offset:1024 lds
    buffer_load_dwordx4 v14, s[28:31], s25 offen offset:2048 lds
    s_waitcnt vmcnt(21) lgkmcnt(0)
    s_barrier
    s_add_u32 m0, s24, 32768
    s_add_u32 s44, s60, 8257536
    buffer_load_dwordx4 v9, s[32:35], s44 offen offset:0 lds
    s_add_u32 s45, s60, 8293376
    buffer_load_dwordx4 v9, s[32:35], s45 offen offset:1024 lds
    s_add_u32 s46, s60, 8329216
    buffer_load_dwordx4 v10, s[32:35], s46 offen offset:2048 lds
    s_add_u32 s44, s60, 8365056
    buffer_load_dwordx4 v10, s[32:35], s44 offen offset:3072 lds
    s_and_b32 s25, s54, 3
    s_cmp_eq_u32 s25, 3
    s_cbranch_scc1 chk_29_ok
    s_mov_b32 s51, 0
chk_29:
    buffer_load_dword v3, v2, s[28:31], s50 offen sc1
    s_add_u32 s51, s51, 1
    s_mov_b64 exec, -1
    s_waitcnt vmcnt(0)
    v_cmp_ne_u32 vcc, 0, v3
    s_nop 0
    s_lshr_b64 s[54:55], vcc, s56
    s_and_b32 s25, s54, 3
    s_cmp_eq_u32 s25, 3
    s_cbranch_scc1 chk_29_ok
    s_sleep 1
    s_lshl_b64 exec, 0xff, s56
    s_cmp_lt_u32 s51, 30000
    s_cbranch_scc1 chk_29
    s_mov_b64 exec, -1
chk_29_ok:
    s_lshr_b64 s[54:55], s[54:55], 2
    s_add_u32 s56, s56, 2
    s_add_u32 m0, s4, 0
    s_add_u32 s25, s61, 233472
    buffer_load_dwordx4 v14, s[28:31], s25 offen offset:0 lds
    buffer_load_dwordx4 v14, s[28:31], s25 offen offset:1024 lds
    buffer_load_dwordx4 v14, s[28:31], s25 offen offset:2048 lds
    s_waitcnt vmcnt(21) lgkmcnt(0)
    s_barrier
    s_add_u32 m0, s24, 49152
    s_add_u32 s44, s60, 8847360
    buffer_load_dwordx4 v9, s[32:35], s44 offen offset:0 lds
    s_add_u32 s45, s60, 8883200
    buffer_load_dwordx4 v9, s[32:35], s45 offen offset:1024 lds
    s_add_u32 s46, s60, 8919040
    buffer_load_dwordx4 v10, s[32:35], s46 offen offset:2048 lds
    s_add_u32 s44, s60, 8954880
    buffer_load_dwordx4 v10, s[32:35], s44 offen offset:3072 lds
    s_and_b32 s25, s54, 3
    s_cmp_eq_u32 s25, 3
    s_cbranch_scc1 chk_30_ok
    s_mov_b32 s51, 0
chk_30:
    buffer_load_dword v3, v2, s[28:31], s50 offen sc1
    s_add_u32 s51, s51, 1
    s_mov_b64 exec, -1
    s_waitcnt vmcnt(0)
    v_cmp_ne_u32 vcc, 0, v3
    s_nop 0
    s_lshr_b64 s[54:55], vcc, s56
    s_and_b32 s25, s54, 3
    s_cmp_eq_u32 s25, 3
    s_cbranch_scc1 chk_30_ok
    s_sleep 1
    s_lshl_b64 exec, 0xff, s56
    s_cmp_lt_u32 s51, 30000
    s_cbranch_scc1 chk_30
    s_mov_b64 exec, -1
chk_30_ok:
    s_lshr_b64 s[54:55], s[54:55], 2
    s_add_u32 s56, s56, 2
    s_add_u32 m0, s4, 12288
    s_add_u32 s25, s61, 245760
    buffer_load_dwordx4 v14, s[28:31], s25 offen offset:0 lds
    buffer_load_dwordx4 v14, s[28:31], s25 offen offset:1024 lds
    buffer_load_dwordx4 v14, s[28:31], s25 offen offset:2048 lds
    s_waitcnt vmcnt(21) lgkmcnt(0)
    s_barrier
    s_add_u32 m0, s24, 65536
    s_add_u32 s44, s60, 9437184
    buffer_load_dwordx4 v9, s[32:35], s44 offen offset:0 lds
    s_add_u32 s45, s60, 9473024
    buffer_load_dwordx4 v9, s[32:35], s45 offen offset:1024 lds
    s_add_u32 s46, s60, 9508864
    buffer_load_dwordx4 v10, s[32:35], s46 offen offset:2048 lds
    s_add_u32 s44, s60, 9544704
    buffer_load_dwordx4 v10, s[32:35], s44 offen offset:3072 lds
    s_and_b32 s25, s54, 3
    s_cmp_eq_u32 s25, 3
    s_cbranch_scc1 chk_31_ok
    s_mov_b32 s51, 0
chk_31:
    buffer_load_dword v3, v2, s[28:31], s50 offen sc1
    s_add_u32 s51, s51, 1
    s_mov_b64 exec, -1
    s_waitcnt vmcnt(0)
    v_cmp_ne_u32 vcc, 0, v3
    s_nop 0
    s_lshr_b64 s[54:55], vcc, s56
    s_and_b32 s25, s54, 3
    s_cmp_eq_u32 s25, 3
    s_cbranch_scc1 chk_31_ok
    s_sleep 1
    s_lshl_b64 exec, 0xff, s56
    s_cmp_lt_u32 s51, 30000
    s_cbranch_scc1 chk_31
    s_mov_b64 exec, -1
chk_31_ok:
    s_lshr_b64 s[54:55], s[54:55], 2
    s_add_u32 s56, s56, 2
    s_add_u32 m0, s4, 24576
    s_add_u32 s25, s61, 258048
    buffer_load_dwordx4 v14, s[28:31], s25 offen offset:0 lds
    buffer_load_dwordx4 v14, s[28:31], s25 offen offset:1024 lds
    buffer_load_dwordx4 v14, s[28:31], s25 offen offset:2048 lds
    s_waitcnt vmcnt(21) lgkmcnt(0)
    s_barrier
    s_add_u32 m0, s24, 81920
    s_add_u32 s44, s60, 10027008
    buffer_load_dwordx4 v9, s[32:35], s44 offen offset:0 lds
    s_add_u32 s45, s60, 10062848
    buffer_load_dwordx4 v9, s[32:35], s45 offen offset:1024 lds
    s_add_u32 s46, s60, 10098688
    buffer_load_dwordx4 v10, s[32:35], s46 offen offset:2048 lds
    s_add_u32 s44, s60, 10134528
    buffer_load_dwordx4 v10, s[32:35], s44 offen offset:3072 lds
    s_and_b32 s25, s54, 3
    s_cmp_eq_u32 s25, 3
    s_cbranch_scc1 chk_32_ok
    s_mov_b32 s51, 0
chk_32:
    buffer_load_dword v3, v2, s[28:31], s50 offen sc1
    s_add_u32 s51, s51, 1
    s_mov_b64 exec, -1
    s_waitcnt vmcnt(0)
    v_cmp_ne_u32 vcc, 0, v3
    s_nop 0
    s_lshr_b64 s[54:55], vcc, s56
    s_and_b32 s25, s54, 3
    s_cmp_eq_u32 s25, 3
    s_cbranch_scc1 chk_32_ok
    s_sleep 1
    s_lshl_b64 exec, 0xff, s56
    s_cmp_lt_u32 s51, 30000
    s_cbranch_scc1 chk_32
    s_mov_b64 exec, -1
chk_32_ok:
    s_lshr_b64 s[54:55], s[54:55], 2
    s_add_u32 s56, s56, 2
    s_add_u32 m0, s4, 36864
    s_add_u32 s25, s61, 270336
    buffer_load_dwordx4 v14, s[28:31], s25 offen offset:0 lds
    buffer_load_dwordx4 v14, s[28:31], s25 offen offset:1024 lds
    buffer_load_dwordx4 v14, s[28:31], s25 offen offset:2048 lds
    s_waitcnt vmcnt(21) lgkmcnt(0)
    s_barrier
    s_add_u32 m0, s24, 0
    s_add_u32 s44, s60, 10616832
    buffer_load_dwordx4 v9, s[32:35], s44 offen offset:0 lds
    s_add_u32 s45, s60, 10652672
    buffer_load_dwordx4 v9, s[32:35], s45 offen offset:1024 lds
    s_add_u32 s46, s60, 10688512
    buffer_load_dwordx4 v10, s[32:35], s46 offen offset:2048 lds
    s_add_u32 s44, s60, 10724352
    buffer_load_dwordx4 v10, s[32:35], s44 offen offset:3072 lds
    s_and_b32 s25, s54, 3
    s_cmp_eq_u32 s25, 3
    s_cbranch_scc1 chk_33_ok
    s_mov_b32 s51, 0
chk_33:
    buffer_load_dword v3, v2, s[28:31], s50 offen sc1
    s_add_u32 s51, s51, 1
    s_mov_b64 exec, -1
    s_waitcnt vmcnt(0)
    v_cmp_ne_u32 vcc, 0, v3
    s_nop 0
    s_lshr_b64 s[54:55], vcc, s56
    s_and_b32 s25, s54, 3
    s_cmp_eq_u32 s25, 3
    s_cbranch_scc1 chk_33_ok
    s_sleep 1
    s_lshl_b64 exec, 0xff, s56
    s_cmp_lt_u32 s51, 30000
    s_cbranch_scc1 chk_33
    s_mov_b64 exec, -1
chk_33_ok:
    s_lshr_b64 s[54:55], s[54:55], 2
    s_add_u32 s56, s56, 2
    s_add_u32 m0, s4, 49152
    s_add_u32 s25, s61, 282624
    buffer_load_dwordx4 v14, s[28:31], s25 offen offset:0 lds
    buffer_load_dwordx4 v14, s[28:31], s25 offen offset:1024 lds
    buffer_load_dwordx4 v14, s[28:31], s25 offen offset:2048 lds
    s_waitcnt vmcnt(21) lgkmcnt(0)
    s_barrier
    s_add_u32 m0, s24, 16384
    s_add_u32 s44, s60, 11206656
    buffer_load_dwordx4 v9, s[32:35], s44 offen offset:0 lds
    s_add_u32 s45, s60, 11242496
    buffer_load_dwordx4 v9, s[32:35], s45 offen offset:1024 lds
    s_add_u32 s46, s60, 11278336
    buffer_load_dwordx4 v10, s[32:35], s46 offen offset:2048 lds
    s_add_u32 s44, s60, 11314176
    buffer_load_dwordx4 v10, s[32:35], s44 offen offset:3072 lds
    s_and_b32 s25, s54, 3
    s_cmp_eq_u32 s25, 3
    s_cbranch_scc1 chk_34_ok
    s_mov_b32 s51, 0
chk_34:
    buffer_load_dword v3, v2, s[28:31], s50 offen sc1
    s_add_u32 s51, s51, 1
    s_mov_b64 exec, -1
    s_waitcnt vmcnt(0)
    v_cmp_ne_u32 vcc, 0, v3
    s_nop 0
    s_lshr_b64 s[54:55], vcc, s56
    s_and_b32 s25, s54, 3
    s_cmp_eq_u32 s25, 3
    s_cbranch_scc1 chk_34_ok
    s_sleep 1
    s_lshl_b64 exec, 0xff, s56
    s_cmp_lt_u32 s51, 30000
    s_cbranch_scc1 chk_34
    s_mov_b64 exec, -1
chk_34_ok:
    s_lshr_b64 s[54:55], s[54:55], 2
    s_add_u32 s56, s56, 2
    s_add_u32 m0, s4, 0
    s_add_u32 s25, s61, 294912
    buffer_load_dwordx4 v14, s[28:31], s25 offen offset:0 lds
    buffer_load_dwordx4 v14, s[28:31], s25 offen offset:1024 lds
    buffer_load_dwordx4 v14, s[28:31], s25 offen offset:2048 lds
    s_waitcnt vmcnt(21) lgkmcnt(0)
    s_barrier
    s_add_u32 m0, s24, 32768
    s_add_u32 s44, s60, 11796480
    buffer_load_dwordx4 v9, s[32:35], s44 offen offset:0 lds
    s_add_u32 s45, s60, 11832320
    buffer_load_dwordx4 v9, s[32:35], s45 offen offset:1024 lds
    s_add_u32 s46, s60, 11868160
    buffer_load_dwordx4 v10, s[32:35], s46 offen offset:2048 lds
    s_add_u32 s44, s60, 11904000
    buffer_load_dwordx4 v10, s[32:35], s44 offen offset:3072 lds
    s_and_b32 s25, s54, 3
    s_cmp_eq_u32 s25, 3
    s_cbranch_scc1 chk_35_ok
    s_mov_b32 s51, 0
chk_35:
    buffer_load_dword v3, v2, s[28:31], s50 offen sc1
    s_add_u32 s51, s51, 1
    s_mov_b64 exec, -1
    s_waitcnt vmcnt(0)
    v_cmp_ne_u32 vcc, 0, v3
    s_nop 0
    s_lshr_b64 s[54:55], vcc, s56
    s_and_b32 s25, s54, 3
    s_cmp_eq_u32 s25, 3
    s_cbranch_scc1 chk_35_ok
    s_sleep 1
    s_lshl_b64 exec, 0xff, s56
    s_cmp_lt_u32 s51, 30000
    s_cbranch_scc1 chk_35
    s_mov_b64 exec, -1
chk_35_ok:
    s_lshr_b64 s[54:55], s[54:55], 2
    s_add_u32 s56, s56, 2
    s_add_u32 m0, s4, 12288
    s_add_u32 s25, s61, 307200
    buffer_load_dwordx4 v14, s[28:31], s25 offen offset:0 lds
    buffer_load_dwordx4 v14, s[28:31], s25 offen offset:1024 lds
    buffer_load_dwordx4 v14, s[28:31], s25 offen offset:2048 lds
    s_waitcnt vmcnt(21) lgkmcnt(0)
    s_barrier
    s_add_u32 m0, s24, 49152
    s_add_u32 s44, s60, 12386304
    buffer_load_dwordx4 v9, s[32:35], s44 offen offset:0 lds
    s_add_u32 s45, s60, 12422144
    buffer_load_dwordx4 v9, s[32:35], s45 offen offset:1024 lds
    s_add_u32 s46, s60, 12457984
    buffer_load_dwordx4 v10, s[32:35], s46 offen offset:2048 lds
    s_add_u32 s44, s60, 12493824
    buffer_load_dwordx4 v10, s[32:35], s44 offen offset:3072 lds
    s_and_b32 s25, s54, 3
    s_cmp_eq_u32 s25, 3
    s_cbranch_scc1 chk_36_ok
    s_mov_b32 s51, 0
chk_36:
    buffer_load_dword v3, v2, s[28:31], s50 offen sc1
    s_add_u32 s51, s51, 1
    s_mov_b64 exec, -1
    s_waitcnt vmcnt(0)
    v_cmp_ne_u32 vcc, 0, v3
    s_nop 0
    s_lshr_b64 s[54:55], vcc, s56
    s_and_b32 s25, s54, 3
    s_cmp_eq_u32 s25, 3
    s_cbranch_scc1 chk_36_ok
    s_sleep 1
    s_lshl_b64 exec, 0xff, s56
    s_cmp_lt_u32 s51, 30000
    s_cbranch_scc1 chk_36
    s_mov_b64 exec, -1
chk_36_ok:
    s_lshr_b64 s[54:55], s[54:55], 2
    s_add_u32 s56, s56, 2
    s_add_u32 m0, s4, 24576
    s_add_u32 s25, s61, 319488
    buffer_load_dwordx4 v14, s[28:31], s25 offen offset:0 lds
    buffer_load_dwordx4 v14, s[28:31], s25 offen offset:1024 lds
    buffer_load_dwordx4 v14, s[28:31], s25 offen offset:2048 lds
    s_waitcnt vmcnt(21) lgkmcnt(0)
    s_barrier
    s_add_u32 m0, s24, 65536
    s_add_u32 s44, s60, 12976128
    buffer_load_dwordx4 v9, s[32:35], s44 offen offset:0 lds
    s_add_u32 s45, s60, 13011968
    buffer_load_dwordx4 v9, s[32:35], s45 offen offset:1024 lds
    s_add_u32 s46, s60, 13047808
    buffer_load_dwordx4 v10, s[32:35], s46 offen offset:2048 lds
    s_add_u32 s44, s60, 13083648
    buffer_load_dwordx4 v10, s[32:35], s44 offen offset:3072 lds
    s_and_b32 s25, s54, 3
    s_cmp_eq_u32 s25, 3
    s_cbranch_scc1 chk_37_ok
    s_mov_b32 s51, 0
chk_37:
    buffer_load_dword v3, v2, s[28:31], s50 offen sc1
    s_add_u32 s51, s51, 1
    s_mov_b64 exec, -1
    s_waitcnt vmcnt(0)
    v_cmp_ne_u32 vcc, 0, v3
    s_nop 0
    s_lshr_b64 s[54:55], vcc, s56
    s_and_b32 s25, s54, 3
    s_cmp_eq_u32 s25, 3
    s_cbranch_scc1 chk_37_ok
    s_sleep 1
    s_lshl_b64 exec, 0xff, s56
    s_cmp_lt_u32 s51, 30000
    s_cbranch_scc1 chk_37
    s_mov_b64 exec, -1
chk_37_ok:
    s_lshr_b64 s[54:55], s[54:55], 2
    s_add_u32 s56, s56, 2
    s_add_u32 m0, s4, 36864
    s_add_u32 s25, s61, 331776
    buffer_load_dwordx4 v14, s[28:31], s25 offen offset:0 lds
    buffer_load_dwordx4 v14, s[28:31], s25 offen offset:1024 lds
    buffer_load_dwordx4 v14, s[28:31], s25 offen offset:2048 lds
    s_waitcnt vmcnt(21) lgkmcnt(0)
    s_barrier
    s_add_u32 m0, s24, 81920
    s_add_u32 s44, s60, 13565952
    buffer_load_dwordx4 v9, s[32:35], s44 offen offset:0 lds
    s_add_u32 s45, s60, 13601792
    buffer_load_dwordx4 v9, s[32:35], s45 offen offset:1024 lds
    s_add_u32 s46, s60, 13637632
    buffer_load_dwordx4 v10, s[32:35], s46 offen offset:2048 lds
    s_add_u32 s44, s60, 13673472
    buffer_load_dwordx4 v10, s[32:35], s44 offen offset:3072 lds
    s_and_b32 s25, s54, 3
    s_cmp_eq_u32 s25, 3
    s_cbranch_scc1 chk_38_ok
    s_mov_b32 s51, 0
chk_38:
    buffer_load_dword v3, v2, s[28:31], s50 offen sc1
    s_add_u32 s51, s51, 1
    s_mov_b64 exec, -1
    s_waitcnt vmcnt(0)
    v_cmp_ne_u32 vcc, 0, v3
    s_nop 0
    s_lshr_b64 s[54:55], vcc, s56
    s_and_b32 s25, s54, 3
    s_cmp_eq_u32 s25, 3
    s_cbranch_scc1 chk_38_ok
    s_sleep 1
    s_lshl_b64 exec, 0xff, s56
    s_cmp_lt_u32 s51, 30000
    s_cbranch_scc1 chk_38
    s_mov_b64 exec, -1
chk_38_ok:
    s_lshr_b64 s[54:55], s[54:55], 2
    s_add_u32 s56, s56, 2
    s_add_u32 m0, s4, 49152
    s_add_u32 s25, s61, 344064
    buffer_load_dwordx4 v14, s[28:31], s25 offen offset:0 lds
    buffer_load_dwordx4 v14, s[28:31], s25 offen offset:1024 lds
    buffer_load_dwordx4 v14, s[28:31], s25 offen offset:2048 lds
    s_waitcnt vmcnt(21) lgkmcnt(0)
    s_barrier
    s_add_u32 m0, s24, 0
    s_add_u32 s44, s60, 14155776
    buffer_load_dwordx4 v9, s[32:35], s44 offen offset:0 lds
    s_add_u32 s45, s60, 14191616
    buffer_load_dwordx4 v9, s[32:35], s45 offen offset:1024 lds
    s_add_u32 s46, s60, 14227456
    buffer_load_dwordx4 v10, s[32:35], s46 offen offset:2048 lds
    s_add_u32 s44, s60, 14263296
    buffer_load_dwordx4 v10, s[32:35], s44 offen offset:3072 lds
    s_and_b32 s25, s54, 3
    s_cmp_eq_u32 s25, 3
    s_cbranch_scc1 chk_39_ok
    s_mov_b32 s51, 0
chk_39:
    buffer_load_dword v3, v2, s[28:31], s50 offen sc1
    s_add_u32 s51, s51, 1
    s_mov_b64 exec, -1
    s_waitcnt vmcnt(0)
    v_cmp_ne_u32 vcc, 0, v3
    s_nop 0
    s_lshr_b64 s[54:55], vcc, s56
    s_and_b32 s25, s54, 3
    s_cmp_eq_u32 s25, 3
    s_cbranch_scc1 chk_39_ok
    s_sleep 1
    s_lshl_b64 exec, 0xff, s56
    s_cmp_lt_u32 s51, 30000
    s_cbranch_scc1 chk_39
    s_mov_b64 exec, -1
chk_39_ok:
    s_lshr_b64 s[54:55], s[54:55], 2
    s_add_u32 s56, s56, 2
    s_add_u32 m0, s4, 0
    s_add_u32 s25, s61, 356352
    buffer_load_dwordx4 v14, s[28:31], s25 offen offset:0 lds
    buffer_load_dwordx4 v14, s[28:31], s25 offen offset:1024 lds
    buffer_load_dwordx4 v14, s[28:31], s25 offen offset:2048 lds
    s_waitcnt vmcnt(21) lgkmcnt(0)
    s_barrier
    s_add_u32 m0, s24, 16384
    s_add_u32 s44, s60, 14745600
    buffer_load_dwordx4 v9, s[32:35], s44 offen offset:0 lds
    s_add_u32 s45, s60, 14781440
    buffer_load_dwordx4 v9, s[32:35], s45 offen offset:1024 lds
    s_add_u32 s46, s60, 14817280
    buffer_load_dwordx4 v10, s[32:35], s46 offen offset:2048 lds
    s_add_u32 s44, s60, 14853120
    buffer_load_dwordx4 v10, s[32:35], s44 offen offset:3072 lds
    s_and_b32 s25, s54, 3
    s_cmp_eq_u32 s25, 3
    s_cbranch_scc1 chk_40_ok
    s_mov_b32 s51, 0
chk_40:
    buffer_load_dword v3, v2, s[28:31], s50 offen sc1
    s_add_u32 s51, s51, 1
    s_mov_b64 exec, -1
    s_waitcnt vmcnt(0)
    v_cmp_ne_u32 vcc, 0, v3
    s_nop 0
    s_lshr_b64 s[54:55], vcc, s56
    s_and_b32 s25, s54, 3
    s_cmp_eq_u32 s25, 3
    s_cbranch_scc1 chk_40_ok
    s_sleep 1
    s_lshl_b64 exec, 0xff, s56
    s_cmp_lt_u32 s51, 30000
    s_cbranch_scc1 chk_40
    s_mov_b64 exec, -1
chk_40_ok:
    s_lshr_b64 s[54:55], s[54:55], 2
    s_add_u32 s56, s56, 2
    s_add_u32 m0, s4, 12288
    s_add_u32 s25, s61, 368640
    buffer_load_dwordx4 v14, s[28:31], s25 offen offset:0 lds
    buffer_load_dwordx4 v14, s[28:31], s25 offen offset:1024 lds
    buffer_load_dwordx4 v14, s[28:31], s25 offen offset:2048 lds
    s_waitcnt vmcnt(21) lgkmcnt(0)
    s_barrier
    s_and_b32 s25, s54, 3
    s_cmp_eq_u32 s25, 3
    s_cbranch_scc1 chk_41_ok
    s_mov_b32 s51, 0
chk_41:
    buffer_load_dword v3, v2, s[28:31], s50 offen sc1
    s_add_u32 s51, s51, 1
    s_mov_b64 exec, -1
    s_waitcnt vmcnt(0)
    v_cmp_ne_u32 vcc, 0, v3
    s_nop 0
    s_lshr_b64 s[54:55], vcc, s56
    s_and_b32 s25, s54, 3
    s_cmp_eq_u32 s25, 3
    s_cbranch_scc1 chk_41_ok
    s_sleep 1
    s_lshl_b64 exec, 0xff, s56
    s_cmp_lt_u32 s51, 30000
    s_cbranch_scc1 chk_41
    s_mov_b64 exec, -1
chk_41_ok:
    s_lshr_b64 s[54:55], s[54:55], 2
    s_add_u32 s56, s56, 2
    s_add_u32 m0, s4, 24576
    s_add_u32 s25, s61, 380928
    buffer_load_dwordx4 v14, s[28:31], s25 offen offset:0 lds
    buffer_load_dwordx4 v14, s[28:31], s25 offen offset:1024 lds
    buffer_load_dwordx4 v14, s[28:31], s25 offen offset:2048 lds
    s_waitcnt vmcnt(17) lgkmcnt(0)
    s_barrier
    s_waitcnt vmcnt(10) lgkmcnt(0)
    s_barrier
    s_waitcnt vmcnt(3) lgkmcnt(0)
    s_barrier
    s_waitcnt vmcnt(0) lgkmcnt(0)
    s_barrier
t_ld2:
    s_lshr_b32 s44, s36, 1
    s_and_b32 s45, s36, 1
    s_lshl_b32 s45, s45, 3
    s_lshr_b32 s46, s37, 2
    s_add_u32 s45, s45, s46
    s_and_b32 s46, s37, 3
    v_lshrrev_b32 v2, 4, v1
    v_and_b32 v3, 15, v1
    v_lshlrev_b32 v9, 1, v2
    v_xor_b32 v9, v9, v3
    v_xor_b32 v10, 8, v9
    v_mul_u32_u24 v2, 4096, v2
    v_lshl_add_u32 v9, v9, 4, v2
    v_lshl_add_u32 v10, v10, 4, v2
    s_mul_i32 s52, s44, 4718592
    s_lshl_b32 s50, s45, 8
    s_add_u32 s52, s52, s50
    s_mul_i32 s50, s39, 65536
    s_add_u32 s52, s52, s50
    s_mul_i32 s53, s46, 144
    s_mul_i32 s50, s44, 36
    s_add_u32 s53, s53, s50
    s_mul_i32 s53, s53, 9216
    s_mul_i32 s4, s39, 4608
    s_add_u32 s53, s53, s4
    s_add_u32 s53, s53, 16777216
    s_add_u32 s4, s4, 81920
    s_lshl_b32 s24, s39, 12
    s_mov_b32 s6, 0x18764320
    s_mov_b32 s7, 5
    s_cmp_eq_u32 s44, 1
    s_cselect_b32 s6, 0x40765321, s6
    s_cselect_b32 s7, 8, s7
    s_cmp_eq_u32 s44, 2
    s_cselect_b32 s6, 0x38654210, s6
    s_cselect_b32 s7, 7, s7
    s_cmp_eq_u32 s44, 3
    s_cselect_b32 s6, 0x28754310, s6
    s_cselect_b32 s7, 6, s7
    v_min_u32 v2, 35, v1
    v_and_b32 v3, 1, v2
    s_mul_i32 s50, s46, 3
    s_and_b32 s51, s39, 1
    s_add_u32 s50, s50, s51
    v_add_u32 v3, s50, v3
    v_and_b32 v4, 60, v2
    v_lshrrev_b64 v[12:13], v4, s[6:7]
    v_and_b32 v4, 15, v12
    v_mul_u32_u24 v4, 6, v4
    v_lshrrev_b32 v7, 1, v3
    v_add_u32 v4, v4, v7
    v_and_b32 v3, 1, v3
    v_lshlrev_b32 v3, 1, v3
    v_bfe_u32 v2, v2, 1, 1
    v_add_u32 v3, v3, v2
    v_lshlrev_b32 v3, 7, v3
    v_lshl_add_u32 v2, v4, 10, v3
    s_mul_i32 s50, s44, 55296
    s_add_u32 s50, s50, 262528
    s_cmp_lt_u32 s2, 216
    s_cbranch_scc0 g2_ld_nobar
    s_barrier
g2_ld_nobar:
    s_bfe_u32 s5, s6, 0x40000
    s_mul_i32 s57, s5, 524288
    s_add_u32 s57, s57, s52
    s_add_u32 m0, s24, 0
    s_nop 0
    buffer_load_dwordx4 v9, s[8:11], s57 offen offset:0 lds
    s_add_u32 s26, s57, 15360
    buffer_load_dwordx4 v10, s[8:11], s26 offen offset:1024 lds
    s_add_u32 s27, s57, 30720
    buffer_load_dwordx4 v9, s[8:11], s27 offen offset:2048 lds
    s_add_u32 s25, s57, 46080
    buffer_load_dwordx4 v10, s[8:11], s25 offen offset:3072 lds
    s_add_u32 m0, s24, 16384
    s_add_u32 s25, s57, 262144
    buffer_load_dwordx4 v9, s[8:11], s25 offen offset:0 lds
    s_add_u32 s26, s57, 277504
    buffer_load_dwordx4 v10, s[8:11], s26 offen offset:1024 lds
    s_add_u32 s27, s57, 292864
    buffer_load_dwordx4 v9, s[8:11], s27 offen offset:2048 lds
    s_add_u32 s25, s57, 308224
    buffer_load_dwordx4 v10, s[8:11], s25 offen offset:3072 lds
    s_bfe_u32 s5, s6, 0x40004
    s_mul_i32 s57, s5, 524288
    s_add_u32 s57, s57, s52
    s_add_u32 m0, s24, 32768
    s_nop 0
    buffer_load_dwordx4 v9, s[8:11], s57 offen offset:0 lds
    s_add_u32 s26, s57, 15360
    buffer_load_dwordx4 v10, s[8:11], s26 offen offset:1024 lds
    s_add_u32 s27, s57, 30720
    buffer_load_dwordx4 v9, s[8:11], s27 offen offset:2048 lds
    s_add_u32 s25, s57, 46080
    buffer_load_dwordx4 v10, s[8:11], s25 offen offset:3072 lds
    s_add_u32 m0, s24, 49152
    s_add_u32 s25, s57, 262144
    buffer_load_dwordx4 v9, s[8:11], s25 offen offset:0 lds
    s_add_u32 s26, s57, 277504
    buffer_load_dwordx4 v10, s[8:11], s26 offen offset:1024 lds
    s_add_u32 s27, s57, 292864
    buffer_load_dwordx4 v9, s[8:11], s27 offen offset:2048 lds
    s_add_u32 s25, s57, 308224
    buffer_load_dwordx4 v10, s[8:11], s25 offen offset:3072 lds
    s_bfe_u32 s5, s6, 0x40008
    s_mul_i32 s57, s5, 524288
    s_add_u32 s57, s57, s52
    s_add_u32 m0, s24, 65536
    s_nop 0
    buffer_load_dwordx4 v9, s[8:11], s57 offen offset:0 lds
    s_add_u32 s26, s57, 15360
    buffer_load_dwordx4 v10, s[8:11], s26 offen offset:1024 lds
    s_add_u32 s27, s57, 30720
    buffer_load_dwordx4 v9, s[8:11], s27 offen offset:2048 lds
    s_add_u32 s25, s57, 46080
    buffer_load_dwordx4 v10, s[8:11], s25 offen offset:3072 lds
    s_cmp_lt_u32 s2, 216
    s_cbranch_scc0 g2_ld_nobar2
    s_barrier
g2_ld_nobar2:
    s_sleep 8
    s_mov_b64 s[54:55], 0
    s_mov_b32 s56, 0
    s_bfe_u32 s5, s6, 0x40000
    s_mul_i32 s58, s5, 36864
    s_add_u32 s58, s58, s53
    s_and_b32 s25, s54, 3
    s_cmp_eq_u32 s25, 3
    s_cbranch_scc1 chk_42_ok
    s_mov_b32 s51, 0
chk_42:
    buffer_load_dword v3, v2, s[28:31], s50 offen sc1
    s_add_u32 s51, s51, 1
    s_mov_b64 exec, -1
    s_waitcnt vmcnt(0)
    v_cmp_ne_u32 vcc, 0, v3
    s_nop 0
    s_lshr_b64 s[54:55], vcc, s56
    s_and_b32 s25, s54, 3
    s_cmp_eq_u32 s25, 3
    s_cbranch_scc1 chk_42_ok
    s_sleep 2
    s_lshl_b64 exec, 0xff, s56
    s_cmp_lt_u32 s51, 30000
    s_cbranch_scc1 chk_42
    s_mov_b64 exec, -1
chk_42_ok:
    s_lshr_b64 s[54:55], s[54:55], 2
    s_add_u32 s56, s56, 2
    s_add_u32 m0, s4, 0
    s_mov_b64 exec, 0xffffffff
    buffer_load_dwordx4 v14, s[28:31], s58 offen lds
    s_mov_b64 exec, -1
    buffer_load_dwordx4 v14, s[28:31], s58 offen offset:512 lds
    buffer_load_dwordx4 v14, s[28:31], s58 offen offset:1536 lds
    buffer_load_dwordx4 v14, s[28:31], s58 offen offset:2560 lds
    buffer_load_dwordx4 v14, s[28:31], s58 offen offset:3584 lds
    s_and_b32 s25, s54, 3
    s_cmp_eq_u32 s25, 3
    s_cbranch_scc1 chk_43_ok
    s_mov_b32 s51, 0
chk_43:
    buffer_load_dword v3, v2, s[28:31], s50 offen sc1
    s_add_u32 s51, s51, 1
    s_mov_b64 exec, -1
    s_waitcnt vmcnt(0)
    v_cmp_ne_u32 vcc, 0, v3
    s_nop 0
    s_lshr_b64 s[54:55], vcc, s56
    s_and_b32 s25, s54, 3
    s_cmp_eq_u32 s25, 3
    s_cbranch_scc1 chk_43_ok
    s_sleep 2
    s_lshl_b64 exec, 0xff, s56
    s_cmp_lt_u32 s51, 30000
    s_cbranch_scc1 chk_43
    s_mov_b64 exec, -1
chk_43_ok:
    s_lshr_b64 s[54:55], s[54:55], 2
    s_add_u32 s56, s56, 2
    s_add_u32 m0, s4, 18432
    s_add_u32 s59, s58, 18432
    s_mov_b64 exec, 0xffffffff
    buffer_load_dwordx4 v14, s[28:31], s59 offen lds
    s_mov_b64 exec, -1
    buffer_load_dwordx4 v14, s[28:31], s59 offen offset:512 lds
    buffer_load_dwordx4 v14, s[28:31], s59 offen offset:1536 lds
    buffer_load_dwordx4 v14, s[28:31], s59 offen offset:2560 lds
    buffer_load_dwordx4 v14, s[28:31], s59 offen offset:3584 lds
    s_bfe_u32 s5, s6, 0x40004
    s_mul_i32 s58, s5, 36864
    s_add_u32 s58, s58, s53
    s_and_b32 s25, s54, 3
    s_cmp_eq_u32 s25, 3
    s_cbranch_scc1 chk_44_ok
    s_mov_b32 s51, 0
chk_44:
    buffer_load_dword v3, v2, s[28:31], s50 offen sc1
    s_add_u32 s51, s51, 1
    s_mov_b64 exec, -1
    s_waitcnt vmcnt(0)
    v_cmp_ne_u32 vcc, 0, v3
    s_nop 0
    s_lshr_b64 s[54:55], vcc, s56
    s_and_b32 s25, s54, 3
    s_cmp_eq_u32 s25, 3
    s_cbranch_scc1 chk_44_ok
    s_sleep 2
    s_lshl_b64 exec, 0xff, s56
    s_cmp_lt_u32 s51, 30000
    s_cbranch_scc1 chk_44
    s_mov_b64 exec, -1
chk_44_ok:
    s_lshr_b64 s[54:55], s[54:55], 2
    s_add_u32 s56, s56, 2
    s_add_u32 m0, s4, 36864
    s_mov_b64 exec, 0xffffffff
    buffer_load_dwordx4 v14, s[28:31], s58 offen lds
    s_mov_b64 exec, -1
    buffer_load_dwordx4 v14, s[28:31], s58 offen offset:512 lds
    buffer_load_dwordx4 v14, s[28:31], s58 offen offset:1536 lds
    buffer_load_dwordx4 v14, s[28:31], s58 offen offset:2560 lds
    buffer_load_dwordx4 v14, s[28:31], s58 offen offset:3584 lds
    s_waitcnt vmcnt(10)
    s_barrier
    s_and_b32 s25, s54, 3
    s_cmp_eq_u32 s25, 3
    s_cbranch_scc1 chk_45_ok
    s_mov_b32 s51, 0
chk_45:
    buffer_load_dword v3, v2, s[28:31], s50 offen sc1
    s_add_u32 s51, s51, 1
    s_mov_b64 exec, -1
    s_waitcnt vmcnt(0)
    v_cmp_ne_u32 vcc, 0, v3
    s_nop 0
    s_lshr_b64 s[54:55], vcc, s56
    s_and_b32 s25, s54, 3
    s_cmp_eq_u32 s25, 3
    s_cbranch_scc1 chk_45_ok
    s_sleep 2
    s_lshl_b64 exec, 0xff, s56
    s_cmp_lt_u32 s51, 30000
    s_cbranch_scc1 chk_45
    s_mov_b64 exec, -1
chk_45_ok:
    s_lshr_b64 s[54:55], s[54:55], 2
    s_add_u32 s56, s56, 2
    s_add_u32 m0, s4, 55296
    s_add_u32 s59, s58, 18432
    s_mov_b64 exec, 0xffffffff
    buffer_load_dwordx4 v14, s[28:31], s59 offen lds
    s_mov_b64 exec, -1
    buffer_load_dwordx4 v14, s[28:31], s59 offen offset:512 lds
    buffer_load_dwordx4 v14, s[28:31], s59 offen offset:1536 lds
    buffer_load_dwordx4 v14, s[28:31], s59 offen offset:2560 lds
    buffer_load_dwordx4 v14, s[28:31], s59 offen offset:3584 lds
    s_waitcnt vmcnt(10)
    s_barrier
    s_add_u32 m0, s24, 0
    s_add_u32 s25, s57, 262144
    buffer_load_dwordx4 v9, s[8:11], s25 offen offset:0 lds
    s_add_u32 s26, s57, 277504
    buffer_load_dwordx4 v10, s[8:11], s26 offen offset:1024 lds
    s_add_u32 s27, s57, 292864
    buffer_load_dwordx4 v9, s[8:11], s27 offen offset:2048 lds
    s_add_u32 s25, s57, 308224
    buffer_load_dwordx4 v10, s[8:11], s25 offen offset:3072 lds
    s_bfe_u32 s5, s6, 0x40008
    s_mul_i32 s58, s5, 36864
    s_add_u32 s58, s58, s53
    s_and_b32 s25, s54, 3
    s_cmp_eq_u32 s25, 3
    s_cbranch_scc1 chk_46_ok
    s_mov_b32 s51, 0
chk_46:
    buffer_load_dword v3, v2, s[28:31], s50 offen sc1
    s_add_u32 s51, s51, 1
    s_mov_b64 exec, -1
    s_waitcnt vmcnt(0)
    v_cmp_ne_u32 vcc, 0, v3
    s_nop 0
    s_lshr_b64 s[54:55], vcc, s56
    s_and_b32 s25, s54, 3
    s_cmp_eq_u32 s25, 3
    s_cbranch_scc1 chk_46_ok
    s_sleep 2
    s_lshl_b64 exec, 0xff, s56
    s_cmp_lt_u32 s51, 30000
    s_cbranch_scc1 chk_46
    s_mov_b64 exec, -1
chk_46_ok:
    s_lshr_b64 s[54:55], s[54:55], 2
    s_add_u32 s56, s56, 2
    s_add_u32 m0, s4, 0
    s_mov_b64 exec, 0xffffffff
    buffer_load_dwordx4 v14, s[28:31], s58 offen lds
    s_mov_b64 exec, -1
    buffer_load_dwordx4 v14, s[28:31], s58 offen offset:512 lds
    buffer_load_dwordx4 v14, s[28:31], s58 offen offset:1536 lds
    buffer_load_dwordx4 v14, s[28:31], s58 offen offset:2560 lds
    buffer_load_dwordx4 v14, s[28:31], s58 offen offset:3584 lds
    s_waitcnt vmcnt(14)
    s_barrier
    s_bfe_u32 s5, s6, 0x4000c
    s_mul_i32 s57, s5, 524288
    s_add_u32 s57, s57, s52
    s_add_u32 m0, s24, 16384
    s_nop 0
    buffer_load_dwordx4 v9, s[8:11], s57 offen offset:0 lds
    s_add_u32 s26, s57, 15360
    buffer_load_dwordx4 v10, s[8:11], s26 offen offset:1024 lds
    s_add_u32 s27, s57, 30720
    buffer_load_dwordx4 v9, s[8:11], s27 offen offset:2048 lds
    s_add_u32 s25, s57, 46080
    buffer_load_dwordx4 v10, s[8:11], s25 offen offset:3072 lds
    s_and_b32 s25, s54, 3
    s_cmp_eq_u32 s25, 3
    s_cbranch_scc1 chk_47_ok
    s_mov_b32 s51, 0
chk_47:
    buffer_load_dword v3, v2, s[28:31], s50 offen sc1
    s_add_u32 s51, s51, 1
    s_mov_b64 exec, -1
    s_waitcnt vmcnt(0)
    v_cmp_ne_u32 vcc, 0, v3
    s_nop 0
    s_lshr_b64 s[54:55], vcc, s56
    s_and_b32 s25, s54, 3
    s_cmp_eq_u32 s25, 3
    s_cbranch_scc1 chk_47_ok
    s_sleep 2
    s_lshl_b64 exec, 0xff, s56
    s_cmp_lt_u32 s51, 30000
    s_cbranch_scc1 chk_47
    s_mov_b64 exec, -1
chk_47_ok:
    s_lshr_b64 s[54:55], s[54:55], 2
    s_add_u32 s56, s56, 2
    s_add_u32 m0, s4, 18432
    s_add_u32 s59, s58, 18432
    s_mov_b64 exec, 0xffffffff
    buffer_load_dwordx4 v14, s[28:31], s59 offen lds
    s_mov_b64 exec, -1
    buffer_load_dwordx4 v14, s[28:31], s59 offen offset:512 lds
    buffer_load_dwordx4 v14, s[28:31], s59 offen offset:1536 lds
    buffer_load_dwordx4 v14, s[28:31], s59 offen offset:2560 lds
    buffer_load_dwordx4 v14, s[28:31], s59 offen offset:3584 lds
    s_waitcnt vmcnt(18)
    s_barrier
    s_add_u32 m0, s24, 32768
    s_add_u32 s25, s57, 262144
    buffer_load_dwordx4 v9, s[8:11], s25 offen offset:0 lds
    s_add_u32 s26, s57, 277504
    buffer_load_dwordx4 v10, s[8:11], s26 offen offset:1024 lds
    s_add_u32 s27, s57, 292864
    buffer_load_dwordx4 v9, s[8:11], s27 offen offset:2048 lds
    s_add_u32 s25, s57, 308224
    buffer_load_dwordx4 v10, s[8:11], s25 offen offset:3072 lds
    s_bfe_u32 s5, s6, 0x4000c
    s_mul_i32 s58, s5, 36864
    s_add_u32 s58, s58, s53
    s_and_b32 s25, s54, 3
    s_cmp_eq_u32 s25, 3
    s_cbranch_scc1 chk_48_ok
    s_mov_b32 s51, 0
chk_48:
    buffer_load_dword v3, v2, s[28:31], s50 offen sc1
    s_add_u32 s51, s51, 1
    s_mov_b64 exec, -1
    s_waitcnt vmcnt(0)
    v_cmp_ne_u32 vcc, 0, v3
    s_nop 0
    s_lshr_b64 s[54:55], vcc, s56
    s_and_b32 s25, s54, 3
    s_cmp_eq_u32 s25, 3
    s_cbranch_scc1 chk_48_ok
    s_sleep 2
    s_lshl_b64 exec, 0xff, s56
    s_cmp_lt_u32 s51, 30000
    s_cbranch_scc1 chk_48
    s_mov_b64 exec, -1
chk_48_ok:
    s_lshr_b64 s[54:55], s[54:55], 2
    s_add_u32 s56, s56, 2
    s_add_u32 m0, s4, 36864
    s_mov_b64 exec, 0xffffffff
    buffer_load_dwordx4 v14, s[28:31], s58 offen lds
    s_mov_b64 exec, -1
    buffer_load_dwordx4 v14, s[28:31], s58 offen offset:512 lds
    buffer_load_dwordx4 v14, s[28:31], s58 offen offset:1536 lds
    buffer_load_dwordx4 v14, s[28:31], s58 offen offset:2560 lds
    buffer_load_dwordx4 v14, s[28:31], s58 offen offset:3584 lds
    s_waitcnt vmcnt(18)
    s_barrier
    s_bfe_u32 s5, s6, 0x40010
    s_mul_i32 s57, s5, 524288
    s_add_u32 s57, s57, s52
    s_add_u32 m0, s24, 49152
    s_nop 0
    buffer_load_dwordx4 v9, s[8:11], s57 offen offset:0 lds
    s_add_u32 s26, s57, 15360
    buffer_load_dwordx4 v10, s[8:11], s26 offen offset:1024 lds
    s_add_u32 s27, s57, 30720
    buffer_load_dwordx4 v9, s[8:11], s27 offen offset:2048 lds
    s_add_u32 s25, s57, 46080
    buffer_load_dwordx4 v10, s[8:11], s25 offen offset:3072 lds
    s_and_b32 s25, s54, 3
    s_cmp_eq_u32 s25, 3
    s_cbranch_scc1 chk_49_ok
    s_mov_b32 s51, 0
chk_49:
    buffer_load_dword v3, v2, s[28:31], s50 offen sc1
    s_add_u32 s51, s51, 1
    s_mov_b64 exec, -1
    s_waitcnt vmcnt(0)
    v_cmp_ne_u32 vcc, 0, v3
    s_nop 0
    s_lshr_b64 s[54:55], vcc, s56
    s_and_b32 s25, s54, 3
    s_cmp_eq_u32 s25, 3
    s_cbranch_scc1 chk_49_ok
    s_sleep 2
    s_lshl_b64 exec, 0xff, s56
    s_cmp_lt_u32 s51, 30000
    s_cbranch_scc1 chk_49
    s_mov_b64 exec, -1
chk_49_ok:
    s_lshr_b64 s[54:55], s[54:55], 2
    s_add_u32 s56, s56, 2
    s_add_u32 m0, s4, 55296
    s_add_u32 s59, s58, 18432
    s_mov_b64 exec, 0xffffffff
    buffer_load_dwordx4 v14, s[28:31], s59 offen lds
    s_mov_b64 exec, -1
    buffer_load_dwordx4 v14, s[28:31], s59 offen offset:512 lds
    buffer_load_dwordx4 v14, s[28:31], s59 offen offset:1536 lds
    buffer_load_dwordx4 v14, s[28:31], s59 offen offset:2560 lds
    buffer_load_dwordx4 v14, s[28:31], s59 offen offset:3584 lds
    s_waitcnt vmcnt(18)
    s_barrier
    s_add_u32 m0, s24, 65536
    s_add_u32 s25, s57, 262144
    buffer_load_dwordx4 v9, s[8:11], s25 offen offset:0 lds
    s_add_u32 s26, s57, 277504
    buffer_load_dwordx4 v10, s[8:11], s26 offen offset:1024 lds
    s_add_u32 s27, s57, 292864
    buffer_load_dwordx4 v9, s[8:11], s27 offen offset:2048 lds
    s_add_u32 s25, s57, 308224
    buffer_load_dwordx4 v10, s[8:11], s25 offen offset:3072 lds
    s_bfe_u32 s5, s6, 0x40010
    s_mul_i32 s58, s5, 36864
    s_add_u32 s58, s58, s53
    s_and_b32 s25, s54, 3
    s_cmp_eq_u32 s25, 3
    s_cbranch_scc1 chk_50_ok
    s_mov_b32 s51, 0
chk_50:
    buffer_load_dword v3, v2, s[28:31], s50 offen sc1
    s_add_u32 s51, s51, 1
    s_mov_b64 exec, -1
    s_waitcnt vmcnt(0)
    v_cmp_ne_u32 vcc, 0, v3
    s_nop 0
    s_lshr_b64 s[54:55], vcc, s56
    s_and_b32 s25, s54, 3
    s_cmp_eq_u32 s25, 3
    s_cbranch_scc1 chk_50_ok
    s_sleep 2
    s_lshl_b64 exec, 0xff, s56
    s_cmp_lt_u32 s51, 30000
    s_cbranch_scc1 chk_50
    s_mov_b64 exec, -1
chk_50_ok:
    s_lshr_b64 s[54:55], s[54:55], 2
    s_add_u32 s56, s56, 2
    s_add_u32 m0, s4, 0
    s_mov_b64 exec, 0xffffffff
    buffer_load_dwordx4 v14, s[28:31], s58 offen lds
    s_mov_b64 exec, -1
    buffer_load_dwordx4 v14, s[28:31], s58 offen offset:512 lds
    buffer_load_dwordx4 v14, s[28:31], s58 offen offset:1536 lds
    buffer_load_dwordx4 v14, s[28:31], s58 offen offset:2560 lds
    buffer_load_dwordx4 v14, s[28:31], s58 offen offset:3584 lds
    s_waitcnt vmcnt(18)
    s_barrier
    s_bfe_u32 s5, s6, 0x40014
    s_mul_i32 s57, s5, 524288
    s_add_u32 s57, s57, s52
    s_add_u32 m0, s24, 0
    s_nop 0
    buffer_load_dwordx4 v9, s[8:11], s57 offen offset:0 lds
    s_add_u32 s26, s57, 15360
    buffer_load_dwordx4 v10, s[8:11], s26 offen offset:1024 lds
    s_add_u32 s27, s57, 30720
    buffer_load_dwordx4 v9, s[8:11], s27 offen offset:2048 lds
    s_add_u32 s25, s57, 46080
    buffer_load_dwordx4 v10, s[8:11], s25 offen offset:3072 lds
    s_and_b32 s25, s54, 3
    s_cmp_eq_u32 s25, 3
    s_cbranch_scc1 chk_51_ok
    s_mov_b32 s51, 0
chk_51:
    buffer_load_dword v3, v2, s[28:31], s50 offen sc1
    s_add_u32 s51, s51, 1
    s_mov_b64 exec, -1
    s_waitcnt vmcnt(0)
    v_cmp_ne_u32 vcc, 0, v3
    s_nop 0
    s_lshr_b64 s[54:55], vcc, s56
    s_and_b32 s25, s54, 3
    s_cmp_eq_u32 s25, 3
    s_cbranch_scc1 chk_51_ok
    s_sleep 2
    s_lshl_b64 exec, 0xff, s56
    s_cmp_lt_u32 s51, 30000
    s_cbranch_scc1 chk_51
    s_mov_b64 exec, -1
chk_51_ok:
    s_lshr_b64 s[54:55], s[54:55], 2
    s_add_u32 s56, s56, 2
    s_add_u32 m0, s4, 18432
    s_add_u32 s59, s58, 18432
    s_mov_b64 exec, 0xffffffff
    buffer_load_dwordx4 v14, s[28:31], s59 offen lds
    s_mov_b64 exec, -1
    buffer_load_dwordx4 v14, s[28:31], s59 offen offset:512 lds
    buffer_load_dwordx4 v14, s[28:31], s59 offen offset:1536 lds
    buffer_load_dwordx4 v14, s[28:31], s59 offen offset:2560 lds
    buffer_load_dwordx4 v14, s[28:31], s59 offen offset:3584 lds
    s_waitcnt vmcnt(18)
    s_barrier
    s_add_u32 m0, s24, 16384
    s_add_u32 s25, s57, 262144
    buffer_load_dwordx4 v9, s[8:11], s25 offen offset:0 lds
    s_add_u32 s26, s57, 277504
    buffer_load_dwordx4 v10, s[8:11], s26 offen offset:1024 lds
    s_add_u32 s27, s57, 292864
    buffer_load_dwordx4 v9, s[8:11], s27 offen offset:2048 lds
    s_add_u32 s25, s57, 308224
    buffer_load_dwordx4 v10, s[8:11], s25 offen offset:3072 lds
    s_bfe_u32 s5, s6, 0x40014
    s_mul_i32 s58, s5, 36864
    s_add_u32 s58, s58, s53
    s_and_b32 s25, s54, 3
    s_cmp_eq_u32 s25, 3
    s_cbranch_scc1 chk_52_ok
    s_mov_b32 s51, 0
chk_52:
    buffer_load_dword v3, v2, s[28:31], s50 offen sc1
    s_add_u32 s51, s51, 1
    s_mov_b64 exec, -1
    s_waitcnt vmcnt(0)
    v_cmp_ne_u32 vcc, 0, v3
    s_nop 0
    s_lshr_b64 s[54:55], vcc, s56
    s_and_b32 s25, s54, 3
    s_cmp_eq_u32 s25, 3
    s_cbranch_scc1 chk_52_ok
    s_sleep 2
    s_lshl_b64 exec, 0xff, s56
    s_cmp_lt_u32 s51, 30000
    s_cbranch_scc1 chk_52
    s_mov_b64 exec, -1
chk_52_ok:
    s_lshr_b64 s[54:55], s[54:55], 2
    s_add_u32 s56, s56, 2
    s_add_u32 m0, s4, 36864
    s_mov_b64 exec, 0xffffffff
    buffer_load_dwordx4 v14, s[28:31], s58 offen lds
    s_mov_b64 exec, -1
    buffer_load_dwordx4 v14, s[28:31], s58 offen offset:512 lds
    buffer_load_dwordx4 v14, s[28:31], s58 offen offset:1536 lds
    buffer_load_dwordx4 v14, s[28:31], s58 offen offset:2560 lds
    buffer_load_dwordx4 v14, s[28:31], s58 offen offset:3584 lds
    s_waitcnt vmcnt(18)
    s_barrier
    s_bfe_u32 s5, s6, 0x40018
    s_mul_i32 s57, s5, 524288
    s_add_u32 s57, s57, s52
    s_add_u32 m0, s24, 32768
    s_nop 0
    buffer_load_dwordx4 v9, s[8:11], s57 offen offset:0 lds
    s_add_u32 s26, s57, 15360
    buffer_load_dwordx4 v10, s[8:11], s26 offen offset:1024 lds
    s_add_u32 s27, s57, 30720
    buffer_load_dwordx4 v9, s[8:11], s27 offen offset:2048 lds
    s_add_u32 s25, s57, 46080
    buffer_load_dwordx4 v10, s[8:11], s25 offen offset:3072 lds
    s_and_b32 s25, s54, 3
    s_cmp_eq_u32 s25, 3
    s_cbranch_scc1 chk_53_ok
    s_mov_b32 s51, 0
chk_53:
    buffer_load_dword v3, v2, s[28:31], s50 offen sc1
    s_add_u32 s51, s51, 1
    s_mov_b64 exec, -1
    s_waitcnt vmcnt(0)
    v_cmp_ne_u32 vcc, 0, v3
    s_nop 0
    s_lshr_b64 s[54:55], vcc, s56
    s_and_b32 s25, s54, 3
    s_cmp_eq_u32 s25, 3
    s_cbranch_scc1 chk_53_ok
    s_sleep 2
    s_lshl_b64 exec, 0xff, s56
    s_cmp_lt_u32 s51, 30000
    s_cbranch_scc1 chk_53
    s_mov_b64 exec, -1
chk_53_ok:
    s_lshr_b64 s[54:55], s[54:55], 2
    s_add_u32 s56, s56, 2
    s_add_u32 m0, s4, 55296
    s_add_u32 s59, s58, 18432
    s_mov_b64 exec, 0xffffffff
    buffer_load_dwordx4 v14, s[28:31], s59 offen lds
    s_mov_b64 exec, -1
    buffer_load_dwordx4 v14, s[28:31], s59 offen offset:512 lds
    buffer_load_dwordx4 v14, s[28:31], s59 offen offset:1536 lds
    buffer_load_dwordx4 v14, s[28:31], s59 offen offset:2560 lds
    buffer_load_dwordx4 v14, s[28:31], s59 offen offset:3584 lds
    s_waitcnt vmcnt(18)
    s_barrier
    s_add_u32 m0, s24, 49152
    s_add_u32 s25, s57, 262144
    buffer_load_dwordx4 v9, s[8:11], s25 offen offset:0 lds
    s_add_u32 s26, s57, 277504
    buffer_load_dwordx4 v10, s[8:11], s26 offen offset:1024 lds
    s_add_u32 s27, s57, 292864
    buffer_load_dwordx4 v9, s[8:11], s27 offen offset:2048 lds
    s_add_u32 s25, s57, 308224
    buffer_load_dwordx4 v10, s[8:11], s25 offen offset:3072 lds
    s_bfe_u32 s5, s6, 0x40018
    s_mul_i32 s58, s5, 36864
    s_add_u32 s58, s58, s53
    s_and_b32 s25, s54, 3
    s_cmp_eq_u32 s25, 3
    s_cbranch_scc1 chk_54_ok
    s_mov_b32 s51, 0
chk_54:
    buffer_load_dword v3, v2, s[28:31], s50 offen sc1
    s_add_u32 s51, s51, 1
    s_mov_b64 exec, -1
    s_waitcnt vmcnt(0)
    v_cmp_ne_u32 vcc, 0, v3
    s_nop 0
    s_lshr_b64 s[54:55], vcc, s56
    s_and_b32 s25, s54, 3
    s_cmp_eq_u32 s25, 3
    s_cbranch_scc1 chk_54_ok
    s_sleep 2
    s_lshl_b64 exec, 0xff, s56
    s_cmp_lt_u32 s51, 30000
    s_cbranch_scc1 chk_54
    s_mov_b64 exec, -1
chk_54_ok:
    s_lshr_b64 s[54:55], s[54:55], 2
    s_add_u32 s56, s56, 2
    s_add_u32 m0, s4, 0
    s_mov_b64 exec, 0xffffffff
    buffer_load_dwordx4 v14, s[28:31], s58 offen lds
    s_mov_b64 exec, -1
    buffer_load_dwordx4 v14, s[28:31], s58 offen offset:512 lds
    buffer_load_dwordx4 v14, s[28:31], s58 offen offset:1536 lds
    buffer_load_dwordx4 v14, s[28:31], s58 offen offset:2560 lds
    buffer_load_dwordx4 v14, s[28:31], s58 offen offset:3584 lds
    s_waitcnt vmcnt(18)
    s_barrier
    s_bfe_u32 s5, s6, 0x4001c
    s_mul_i32 s57, s5, 524288
    s_add_u32 s57, s57, s52
    s_add_u32 m0, s24, 65536
    s_nop 0
    buffer_load_dwordx4 v9, s[8:11], s57 offen offset:0 lds
    s_add_u32 s26, s57, 15360
    buffer_load_dwordx4 v10, s[8:11], s26 offen offset:1024 lds
    s_add_u32 s27, s57, 30720
    buffer_load_dwordx4 v9, s[8:11], s27 offen offset:2048 lds
    s_add_u32 s25, s57, 46080
    buffer_load_dwordx4 v10, s[8:11], s25 offen offset:3072 lds
    s_and_b32 s25, s54, 3
    s_cmp_eq_u32 s25, 3
    s_cbranch_scc1 chk_55_ok
    s_mov_b32 s51, 0
chk_55:
    buffer_load_dword v3, v2, s[28:31], s50 offen sc1
    s_add_u32 s51, s51, 1
    s_mov_b64 exec, -1
    s_waitcnt vmcnt(0)
    v_cmp_ne_u32 vcc, 0, v3
    s_nop 0
    s_lshr_b64 s[54:55], vcc, s56
    s_and_b32 s25, s54, 3
    s_cmp_eq_u32 s25, 3
    s_cbranch_scc1 chk_55_ok
    s_sleep 2
    s_lshl_b64 exec, 0xff, s56
    s_cmp_lt_u32 s51, 30000
    s_cbranch_scc1 chk_55
    s_mov_b64 exec, -1
chk_55_ok:
    s_lshr_b64 s[54:55], s[54:55], 2
    s_add_u32 s56, s56, 2
    s_add_u32 m0, s4, 18432
    s_add_u32 s59, s58, 18432
    s_mov_b64 exec, 0xffffffff
    buffer_load_dwordx4 v14, s[28:31], s59 offen lds
    s_mov_b64 exec, -1
    buffer_load_dwordx4 v14, s[28:31], s59 offen offset:512 lds
    buffer_load_dwordx4 v14, s[28:31], s59 offen offset:1536 lds
    buffer_load_dwordx4 v14, s[28:31], s59 offen offset:2560 lds
    buffer_load_dwordx4 v14, s[28:31], s59 offen offset:3584 lds
    s_waitcnt vmcnt(18)
    s_barrier
    s_add_u32 m0, s24, 0
    s_add_u32 s25, s57, 262144
    buffer_load_dwordx4 v9, s[8:11], s25 offen offset:0 lds
    s_add_u32 s26, s57, 277504
    buffer_load_dwordx4 v10, s[8:11], s26 offen offset:1024 lds
    s_add_u32 s27, s57, 292864
    buffer_load_dwordx4 v9, s[8:11], s27 offen offset:2048 lds
    s_add_u32 s25, s57, 308224
    buffer_load_dwordx4 v10, s[8:11], s25 offen offset:3072 lds
    s_bfe_u32 s5, s6, 0x4001c
    s_mul_i32 s58, s5, 36864
    s_add_u32 s58, s58, s53
    s_and_b32 s25, s54, 3
    s_cmp_eq_u32 s25, 3
    s_cbranch_scc1 chk_56_ok
    s_mov_b32 s51, 0
chk_56:
    buffer_load_dword v3, v2, s[28:31], s50 offen sc1
    s_add_u32 s51, s51, 1
    s_mov_b64 exec, -1
    s_waitcnt vmcnt(0)
    v_cmp_ne_u32 vcc, 0, v3
    s_nop 0
    s_lshr_b64 s[54:55], vcc, s56
    s_and_b32 s25, s54, 3
    s_cmp_eq_u32 s25, 3
    s_cbranch_scc1 chk_56_ok
    s_sleep 2
    s_lshl_b64 exec, 0xff, s56
    s_cmp_lt_u32 s51, 30000
    s_cbranch_scc1 chk_56
    s_mov_b64 exec, -1
chk_56_ok:
    s_lshr_b64 s[54:55], s[54:55], 2
    s_add_u32 s56, s56, 2
    s_add_u32 m0, s4, 36864
    s_mov_b64 exec, 0xffffffff
    buffer_load_dwordx4 v14, s[28:31], s58 offen lds
    s_mov_b64 exec, -1
    buffer_load_dwordx4 v14, s[28:31], s58 offen offset:512 lds
    buffer_load_dwordx4 v14, s[28:31], s58 offen offset:1536 lds
    buffer_load_dwordx4 v14, s[28:31], s58 offen offset:2560 lds
    buffer_load_dwordx4 v14, s[28:31], s58 offen offset:3584 lds
    s_waitcnt vmcnt(18)
    s_barrier
    s_bfe_u32 s5, s7, 0x40000
    s_mul_i32 s57, s5, 524288
    s_add_u32 s57, s57, s52
    s_add_u32 m0, s24, 16384
    s_nop 0
    buffer_load_dwordx4 v9, s[8:11], s57 offen offset:0 lds
    s_add_u32 s26, s57, 15360
    buffer_load_dwordx4 v10, s[8:11], s26 offen offset:1024 lds
    s_add_u32 s27, s57, 30720
    buffer_load_dwordx4 v9, s[8:11], s27 offen offset:2048 lds
    s_add_u32 s25, s57, 46080
    buffer_load_dwordx4 v10, s[8:11], s25 offen offset:3072 lds
    s_and_b32 s25, s54, 3
    s_cmp_eq_u32 s25, 3
    s_cbranch_scc1 chk_57_ok
    s_mov_b32 s51, 0
chk_57:
    buffer_load_dword v3, v2, s[28:31], s50 offen sc1
    s_add_u32 s51, s51, 1
    s_mov_b64 exec, -1
    s_waitcnt vmcnt(0)
    v_cmp_ne_u32 vcc, 0, v3
    s_nop 0
    s_lshr_b64 s[54:55], vcc, s56
    s_and_b32 s25, s54, 3
    s_cmp_eq_u32 s25, 3
    s_cbranch_scc1 chk_57_ok
    s_sleep 2
    s_lshl_b64 exec, 0xff, s56
    s_cmp_lt_u32 s51, 30000
    s_cbranch_scc1 chk_57
    s_mov_b64 exec, -1
chk_57_ok:
    s_lshr_b64 s[54:55], s[54:55], 2
    s_add_u32 s56, s56, 2
    s_add_u32 m0, s4, 55296
    s_add_u32 s59, s58, 18432
    s_mov_b64 exec, 0xffffffff
    buffer_load_dwordx4 v14, s[28:31], s59 offen lds
    s_mov_b64 exec, -1
    buffer_load_dwordx4 v14, s[28:31], s59 offen offset:512 lds
    buffer_load_dwordx4 v14, s[28:31], s59 offen offset:1536 lds
    buffer_load_dwordx4 v14, s[28:31], s59 offen offset:2560 lds
    buffer_load_dwordx4 v14, s[28:31], s59 offen offset:3584 lds
    s_waitcnt vmcnt(18)
    s_barrier
    s_add_u32 m0, s24, 32768
    s_add_u32 s25, s57, 262144
    buffer_load_dwordx4 v9, s[8:11], s25 offen offset:0 lds
    s_add_u32 s26, s57, 277504
    buffer_load_dwordx4 v10, s[8:11], s26 offen offset:1024 lds
    s_add_u32 s27, s57, 292864
    buffer_load_dwordx4 v9, s[8:11], s27 offen offset:2048 lds
    s_add_u32 s25, s57, 308224
    buffer_load_dwordx4 v10, s[8:11], s25 offen offset:3072 lds
    s_bfe_u32 s5, s7, 0x40000
    s_mul_i32 s58, s5, 36864
    s_add_u32 s58, s58, s53
    s_and_b32 s25, s54, 3
    s_cmp_eq_u32 s25, 3
    s_cbranch_scc1 chk_58_ok
    s_mov_b32 s51, 0
chk_58:
    buffer_load_dword v3, v2, s[28:31], s50 offen sc1
    s_add_u32 s51, s51, 1
    s_mov_b64 exec, -1
    s_waitcnt vmcnt(0)
    v_cmp_ne_u32 vcc, 0, v3
    s_nop 0
    s_lshr_b64 s[54:55], vcc, s56
    s_and_b32 s25, s54, 3
    s_cmp_eq_u32 s25, 3
    s_cbranch_scc1 chk_58_ok
    s_sleep 2
    s_lshl_b64 exec, 0xff, s56
    s_cmp_lt_u32 s51, 30000
    s_cbranch_scc1 chk_58
    s_mov_b64 exec, -1
chk_58_ok:
    s_lshr_b64 s[54:55], s[54:55], 2
    s_add_u32 s56, s56, 2
    s_add_u32 m0, s4, 0
    s_mov_b64 exec, 0xffffffff
    buffer_load_dwordx4 v14, s[28:31], s58 offen lds
    s_mov_b64 exec, -1
    buffer_load_dwordx4 v14, s[28:31], s58 offen offset:512 lds
    buffer_load_dwordx4 v14, s[28:31], s58 offen offset:1536 lds
    buffer_load_dwordx4 v14, s[28:31], s58 offen offset:2560 lds
    buffer_load_dwordx4 v14, s[28:31], s58 offen offset:3584 lds
    s_waitcnt vmcnt(18)
    s_barrier
    s_and_b32 s25, s54, 3
    s_cmp_eq_u32 s25, 3
    s_cbranch_scc1 chk_59_ok
    s_mov_b32 s51, 0
chk_59:
    buffer_load_dword v3, v2, s[28:31], s50 offen sc1
    s_add_u32 s51, s51, 1
    s_mov_b64 exec, -1
    s_waitcnt vmcnt(0)
    v_cmp_ne_u32 vcc, 0, v3
    s_nop 0
    s_lshr_b64 s[54:55], vcc, s56
    s_and_b32 s25, s54, 3
    s_cmp_eq_u32 s25, 3
    s_cbranch_scc1 chk_59_ok
    s_sleep 2
    s_lshl_b64 exec, 0xff, s56
    s_cmp_lt_u32 s51, 30000
    s_cbranch_scc1 chk_59
    s_mov_b64 exec, -1
chk_59_ok:
    s_lshr_b64 s[54:55], s[54:55], 2
    s_add_u32 s56, s56, 2
    s_add_u32 m0, s4, 18432
    s_add_u32 s59, s58, 18432
    s_mov_b64 exec, 0xffffffff
    buffer_load_dwordx4 v14, s[28:31], s59 offen lds
    s_mov_b64 exec, -1
    buffer_load_dwordx4 v14, s[28:31], s59 offen offset:512 lds
    buffer_load_dwordx4 v14, s[28:31], s59 offen offset:1536 lds
    buffer_load_dwordx4 v14, s[28:31], s59 offen offset:2560 lds
    buffer_load_dwordx4 v14, s[28:31], s59 offen offset:3584 lds
    s_waitcnt vmcnt(14)
    s_barrier
    s_waitcnt vmcnt(5)
    s_barrier
    s_waitcnt vmcnt(0)
    s_barrier
    s_branch t_end
t_spare:
    s_sub_u32 s50, s37, 27
    s_lshl_b32 s50, s50, 3
    s_add_u32 s50, s50, s3
    s_add_u32 s58, s50, 261
    s_mul_i32 s58, s58, 55296
    s_add_u32 s58, s58, s57
    s_cmp_lt_u32 s50, 80
    s_cbranch_scc0 t4_60
    buffer_load_dword v8, v17, s[32:35], s58 offen
t4_60:
    s_add_u32 s58, s58, 2211840
    s_cmp_lt_u32 s50, 40
    s_cbranch_scc0 t4_61
    buffer_load_dword v8, v17, s[32:35], s58 offen
t4_61:
    s_add_u32 s58, s58, 2211840
    s_sleep 16
    s_sleep 16
    s_sleep 16
    s_sleep 16
    s_waitcnt vmcnt(0)
    s_lshr_b32 s44, s36, 1
    s_mov_b32 s6, 0x18764320
    s_mov_b32 s7, 5
    s_cmp_eq_u32 s44, 1
    s_cselect_b32 s6, 0x40765321, s6
    s_cselect_b32 s7, 8, s7
    s_cmp_eq_u32 s44, 2
    s_cselect_b32 s6, 0x38654210, s6
    s_cselect_b32 s7, 7, s7
    s_cmp_eq_u32 s44, 3
    s_cselect_b32 s6, 0x28754310, s6
    s_cselect_b32 s7, 6, s7
    s_and_b32 s51, s36, 1
    s_lshl_b32 s51, s51, 11
    s_mul_i32 s52, s44, 4718592
    s_add_u32 s51, s51, s52
    s_add_u32 s52, 0, s50
    v_lshrrev_b32 v2, 4, v1
    v_lshlrev_b32 v2, 12, v2
    v_and_b32 v3, 15, v1
    v_lshl_add_u32 v2, v3, 7, v2
    s_lshr_b32 s53, s52, 5
    s_lshl_b32 s53, s53, 2
    s_lshr_b64 s[54:55], s[6:7], s53
    s_and_b32 s54, s54, 15
    s_lshl_b32 s54, s54, 5
    s_and_b32 s53, s52, 31
    s_add_u32 s54, s54, s53
    s_lshl_b32 s54, s54, 14
    s_add_u32 s54, s54, s51
    buffer_load_dword v4, v2, s[8:11], s54 offen
    s_add_u32 s52, s52, 40
    s_lshr_b32 s53, s52, 5
    s_lshl_b32 s53, s53, 2
    s_lshr_b64 s[54:55], s[6:7], s53
    s_and_b32 s54, s54, 15
    s_lshl_b32 s54, s54, 5
    s_and_b32 s53, s52, 31
    s_add_u32 s54, s54, s53
    s_lshl_b32 s54, s54, 14
    s_add_u32 s54, s54, s51
    s_waitcnt vmcnt(0)
    buffer_load_dword v4, v2, s[8:11], s54 offen
    s_add_u32 s52, s52, 40
    s_lshr_b32 s53, s52, 5
    s_lshl_b32 s53, s53, 2
    s_lshr_b64 s[54:55], s[6:7], s53
    s_and_b32 s54, s54, 15
    s_lshl_b32 s54, s54, 5
    s_and_b32 s53, s52, 31
    s_add_u32 s54, s54, s53
    s_lshl_b32 s54, s54, 14
    s_add_u32 s54, s54, s51
    s_waitcnt vmcnt(0)
    buffer_load_dword v4, v2, s[8:11], s54 offen
    s_add_u32 s52, s52, 40
    s_lshr_b32 s53, s52, 5
    s_lshl_b32 s53, s53, 2
    s_lshr_b64 s[54:55], s[6:7], s53
    s_and_b32 s54, s54, 15
    s_lshl_b32 s54, s54, 5
    s_and_b32 s53, s52, 31
    s_add_u32 s54, s54, s53
    s_lshl_b32 s54, s54, 14
    s_add_u32 s54, s54, s51
    s_waitcnt vmcnt(0)
    buffer_load_dword v4, v2, s[8:11], s54 offen
    s_add_u32 s52, s52, 40
    s_lshr_b32 s53, s52, 5
    s_lshl_b32 s53, s53, 2
    s_lshr_b64 s[54:55], s[6:7], s53
    s_and_b32 s54, s54, 15
    s_lshl_b32 s54, s54, 5
    s_and_b32 s53, s52, 31
    s_add_u32 s54, s54, s53
    s_lshl_b32 s54, s54, 14
    s_add_u32 s54, s54, s51
    s_waitcnt vmcnt(0)
    buffer_load_dword v4, v2, s[8:11], s54 offen
    s_add_u32 s52, s52, 40
    s_lshr_b32 s53, s52, 5
    s_lshl_b32 s53, s53, 2
    s_lshr_b64 s[54:55], s[6:7], s53
    s_and_b32 s54, s54, 15
    s_lshl_b32 s54, s54, 5
    s_and_b32 s53, s52, 31
    s_add_u32 s54, s54, s53
    s_lshl_b32 s54, s54, 14
    s_add_u32 s54, s54, s51
    s_waitcnt vmcnt(0)
    buffer_load_dword v4, v2, s[8:11], s54 offen
    s_add_u32 s52, s52, 40
    s_lshr_b32 s53, s52, 5
    s_lshl_b32 s53, s53, 2
    s_lshr_b64 s[54:55], s[6:7], s53
    s_and_b32 s54, s54, 15
    s_lshl_b32 s54, s54, 5
    s_and_b32 s53, s52, 31
    s_add_u32 s54, s54, s53
    s_lshl_b32 s54, s54, 14
    s_add_u32 s54, s54, s51
    s_waitcnt vmcnt(0)
    buffer_load_dword v4, v2, s[8:11], s54 offen
    s_add_u32 s52, s52, 40
    s_cmp_lt_u32 s50, 8
    s_cbranch_scc0 pfskip_62
    s_lshr_b32 s53, s52, 5
    s_lshl_b32 s53, s53, 2
    s_lshr_b64 s[54:55], s[6:7], s53
    s_and_b32 s54, s54, 15
    s_lshl_b32 s54, s54, 5
    s_and_b32 s53, s52, 31
    s_add_u32 s54, s54, s53
    s_lshl_b32 s54, s54, 14
    s_add_u32 s54, s54, s51
    s_waitcnt vmcnt(0)
    buffer_load_dword v4, v2, s[8:11], s54 offen
pfskip_62:
    s_waitcnt vmcnt(0)
    s_cmp_lt_u32 s3, 4
    s_cbranch_scc1 t_cons2
    s_branch t_ld2
t_cons:
    s_and_b32 s46, s3, 1
    s_lshr_b32 s47, s3, 1
    s_lshl_b32 s48, s46, 7
    s_lshl_b32 s49, s62, 8
    s_add_u32 s48, s48, s49
    v_lshlrev_b32 v7, 3, v6
    buffer_load_dwordx2 v[24:25], v7, s[20:23], s48 offen offset:0
    buffer_load_dwordx2 v[26:27], v7, s[20:23], s48 offen offset:32
    buffer_load_dwordx2 v[28:29], v7, s[20:23], s48 offen offset:64
    buffer_load_dwordx2 v[30:31], v7, s[20:23], s48 offen offset:96
    s_lshl_b32 s40, s46, 2
    s_add_u32 s40, s40, 0
    s_lshl_b32 s41, s46, 2
    s_add_u32 s41, s41, 1
    s_lshl_b32 s42, s46, 2
    s_add_u32 s42, s42, 2
    s_lshl_b32 s43, s46, 2
    s_add_u32 s43, s43, 3
    v_lshrrev_b32 v2, 2, v5
    v_and_b32 v3, 1, v6
    v_lshl_add_u32 v3, v3, 2, v2
    v_mad_u32_u24 v2, v6, 8, v2
    v_lshlrev_b32 v2, 8, v2
    v_and_b32 v4, 3, v1
    v_lshl_add_u32 v2, v4, 3, v2
    v_xor_b32 v4, s40, v3
    v_lshl_add_u32 v8, v4, 5, v2
    v_xor_b32 v4, s41, v3
    v_lshl_add_u32 v9, v4, 5, v2
    v_xor_b32 v4, s42, v3
    v_lshl_add_u32 v10, v4, 5, v2
    v_xor_b32 v4, s43, v3
    v_lshl_add_u32 v11, v4, 5, v2
    v_mul_u32_u24 v2, 1536, v6
    v_lshl_add_u32 v2, v5, 4, v2
    s_mul_i32 s48, s47, 768
    v_add_u32 v12, s48, v2
    s_mul_i32 s48, s63, 6
    s_mul_i32 s49, s47, 3
    s_add_u32 s48, s48, s49
    s_lshl_b32 s49, s62, 2
    s_lshl_b32 s50, s46, 1
    s_add_u32 s49, s49, s50
    s_mul_i32 s49, s49, 9
    s_add_u32 s50, s48, 0
    s_mul_i32 s51, s50, 57
    s_lshr_b32 s51, s51, 9
    s_mul_i32 s51, s51, 1287
    s_add_u32 s50, s50, s51
    s_add_u32 s50, s50, s49
    s_lshl_b32 s50, s50, 10
    s_add_u32 s52, s50, 16777216
    s_add_u32 s55, s50, 16786432
    s_add_u32 s50, s48, 1
    s_mul_i32 s51, s50, 57
    s_lshr_b32 s51, s51, 9
    s_mul_i32 s51, s51, 1287
    s_add_u32 s50, s50, s51
    s_add_u32 s50, s50, s49
    s_lshl_b32 s50, s50, 10
    s_add_u32 s53, s50, 16777216
    s_add_u32 s56, s50, 16786432
    s_add_u32 s50, s48, 2
    s_mul_i32 s51, s50, 57
    s_lshr_b32 s51, s51, 9
    s_mul_i32 s51, s51, 1287
    s_add_u32 s50, s50, s51
    s_add_u32 s50, s50, s49
    s_lshl_b32 s50, s50, 10
    s_add_u32 s54, s50, 16777216
    s_add_u32 s57, s50, 16786432
    s_mul_i32 s58, s62, 6
    s_add_u32 s58, s58, s63
    s_lshl_b32 s58, s58, 3
    s_add_u32 s58, s58, s3
    s_lshl_b32 s58, s58, 7
    s_add_u32 s58, s58, 262528
    v_mov_b32 v88, 0
    v_mov_b32 v89, 0
    v_mov_b32 v90, 0
    v_mov_b32 v91, 0
    v_mov_b32 v92, 0
    v_mov_b32 v93, 0
    v_mov_b32 v94, 0
    v_mov_b32 v95, 0
    v_mov_b32 v96, 0
    v_mov_b32 v97, 0
    v_mov_b32 v98, 0
    v_mov_b32 v99, 0
    v_mov_b32 v100, 0
    v_mov_b32 v101, 0
    v_mov_b32 v102, 0
    v_mov_b32 v103, 0
    v_mov_b32 v104, 0
    v_mov_b32 v105, 0
    v_mov_b32 v106, 0
    v_mov_b32 v107, 0
    v_mov_b32 v108, 0
    v_mov_b32 v109, 0
    v_mov_b32 v110, 0
    v_mov_b32 v111, 0
    v_mov_b32 v112, 0
    v_mov_b32 v113, 0
    v_mov_b32 v114, 0
    v_mov_b32 v115, 0
    v_mov_b32 v116, 0
    v_mov_b32 v117, 0
    v_mov_b32 v118, 0
    v_mov_b32 v119, 0
    v_mov_b32 v120, 0
    v_mov_b32 v121, 0
    v_mov_b32 v122, 0
    v_mov_b32 v123, 0
    v_mov_b32 v124, 0
    v_mov_b32 v125, 0
    v_mov_b32 v126, 0
    v_mov_b32 v127, 0
    v_mov_b32 v128, 0
    v_mov_b32 v129, 0
    v_mov_b32 v130, 0
    v_mov_b32 v131, 0
    v_mov_b32 v132, 0
    v_mov_b32 v133, 0
    v_mov_b32 v134, 0
    v_mov_b32 v135, 0
    s_mov_b32 s24, 65536
    s_mov_b32 s4, 12288
    v_add_u32 v16, s24, v8
    v_add_u32 v17, s24, v9
    v_add_u32 v18, s24, v10
    v_add_u32 v19, s24, v11
    v_add_u32 v20, s4, v12
    s_movk_i32 s59, 31
    s_barrier
    ds_read_b128 v[48:51], v20 offset:0
    ds_read_b64_tr_b16 v[32:33], v16 offset:0
    ds_read_b64_tr_b16 v[34:35], v16 offset:1024
    ds_read_b64_tr_b16 v[36:37], v17 offset:0
    ds_read_b64_tr_b16 v[38:39], v17 offset:1024
    ds_read_b64_tr_b16 v[40:41], v18 offset:0
    ds_read_b64_tr_b16 v[42:43], v18 offset:1024
    ds_read_b64_tr_b16 v[44:45], v19 offset:0
    ds_read_b64_tr_b16 v[46:47], v19 offset:1024
    ds_read_b128 v[52:55], v20 offset:256
    ds_read_b128 v[56:59], v20 offset:512
    s_add_u32 s24, s24, 16384
    s_add_u32 s4, s4, 12288
    s_cmp_eq_u32 s24, 163840
    s_cselect_b32 s24, 65536, s24
    s_cmp_eq_u32 s4, 61440
    s_cselect_b32 s4, 0, s4
g1_mm_loop:
    s_waitcnt lgkmcnt(0)
    v_mfma_f32_16x16x32_bf16 v[88:91], v[32:35], v[48:51], v[88:91]
    ds_read_b128 v[76:79], v20 offset:6144
    ds_read_b64_tr_b16 v[60:61], v16 offset:8192
    v_mfma_f32_16x16x32_bf16 v[100:103], v[36:39], v[48:51], v[100:103]
    ds_read_b64_tr_b16 v[62:63], v16 offset:9216
    ds_read_b64_tr_b16 v[64:65], v17 offset:8192
    v_mfma_f32_16x16x32_bf16 v[112:115], v[40:43], v[48:51], v[112:115]
    ds_read_b64_tr_b16 v[66:67], v17 offset:9216
    ds_read_b64_tr_b16 v[68:69], v18 offset:8192
    v_mfma_f32_16x16x32_bf16 v[124:127], v[44:47], v[48:51], v[124:127]
    ds_read_b64_tr_b16 v[70:71], v18 offset:9216
    ds_read_b64_tr_b16 v[72:73], v19 offset:8192
    v_mfma_f32_16x16x32_bf16 v[128:131], v[44:47], v[52:55], v[128:131]
    ds_read_b64_tr_b16 v[74:75], v19 offset:9216
    ds_read_b128 v[80:83], v20 offset:6400
    v_mfma_f32_16x16x32_bf16 v[116:119], v[40:43], v[52:55], v[116:119]
    ds_read_b128 v[84:87], v20 offset:6656
    v_add_u32 v16, s24, v8
    v_mfma_f32_16x16x32_bf16 v[104:107], v[36:39], v[52:55], v[104:107]
    v_add_u32 v17, s24, v9
    v_add_u32 v18, s24, v10
    v_mfma_f32_16x16x32_bf16 v[92:95], v[32:35], v[52:55], v[92:95]
    v_add_u32 v19, s24, v11
    v_add_u32 v20, s4, v12
    v_mfma_f32_16x16x32_bf16 v[96:99], v[32:35], v[56:59], v[96:99]
    v_mfma_f32_16x16x32_bf16 v[108:111], v[36:39], v[56:59], v[108:111]
    s_waitcnt lgkmcnt(0)
    s_barrier
    v_mfma_f32_16x16x32_bf16 v[120:123], v[40:43], v[56:59], v[120:123]
    v_mfma_f32_16x16x32_bf16 v[132:135], v[44:47], v[56:59], v[132:135]
    v_mfma_f32_16x16x32_bf16 v[88:91], v[60:63], v[76:79], v[88:91]
    ds_read_b128 v[48:51], v20 offset:0
    ds_read_b64_tr_b16 v[32:33], v16 offset:0
    v_mfma_f32_16x16x32_bf16 v[100:103], v[64:67], v[76:79], v[100:103]
    ds_read_b64_tr_b16 v[34:35], v16 offset:1024
    ds_read_b64_tr_b16 v[36:37], v17 offset:0
    v_mfma_f32_16x16x32_bf16 v[112:115], v[68:71], v[76:79], v[112:115]
    ds_read_b64_tr_b16 v[38:39], v17 offset:1024
    ds_read_b64_tr_b16 v[40:41], v18 offset:0
    v_mfma_f32_16x16x32_bf16 v[124:127], v[72:75], v[76:79], v[124:127]
    ds_read_b64_tr_b16 v[42:43], v18 offset:1024
    ds_read_b64_tr_b16 v[44:45], v19 offset:0
    v_mfma_f32_16x16x32_bf16 v[128:131], v[72:75], v[80:83], v[128:131]
    ds_read_b64_tr_b16 v[46:47], v19 offset:1024
    ds_read_b128 v[52:55], v20 offset:256
    v_mfma_f32_16x16x32_bf16 v[116:119], v[68:71], v[80:83], v[116:119]
    ds_read_b128 v[56:59], v20 offset:512
    s_add_u32 s24, s24, 16384
    v_mfma_f32_16x16x32_bf16 v[104:107], v[64:67], v[80:83], v[104:107]
    s_add_u32 s4, s4, 12288
    s_cmp_eq_u32 s24, 163840
    v_mfma_f32_16x16x32_bf16 v[92:95], v[60:63], v[80:83], v[92:95]
    s_cselect_b32 s24, 65536, s24
    s_cmp_eq_u32 s4, 61440
    v_mfma_f32_16x16x32_bf16 v[96:99], v[60:63], v[84:87], v[96:99]
    s_cselect_b32 s4, 0, s4
    s_sub_u32 s59, s59, 1
    v_mfma_f32_16x16x32_bf16 v[108:111], v[64:67], v[84:87], v[108:111]
    s_cmp_lg_u32 s59, 0
    v_mfma_f32_16x16x32_bf16 v[120:123], v[68:71], v[84:87], v[120:123]
    v_mfma_f32_16x16x32_bf16 v[132:135], v[72:75], v[84:87], v[132:135]
    s_cbranch_scc1 g1_mm_loop
    s_waitcnt lgkmcnt(0)
    v_mfma_f32_16x16x32_bf16 v[88:91], v[32:35], v[48:51], v[88:91]
    ds_read_b128 v[76:79], v20 offset:6144
    ds_read_b64_tr_b16 v[60:61], v16 offset:8192
    v_mfma_f32_16x16x32_bf16 v[100:103], v[36:39], v[48:51], v[100:103]
    ds_read_b64_tr_b16 v[62:63], v16 offset:9216
    ds_read_b64_tr_b16 v[64:65], v17 offset:8192
    v_mfma_f32_16x16x32_bf16 v[112:115], v[40:43], v[48:51], v[112:115]
    ds_read_b64_tr_b16 v[66:67], v17 offset:9216
    ds_read_b64_tr_b16 v[68:69], v18 offset:8192
    v_mfma_f32_16x16x32_bf16 v[124:127], v[44:47], v[48:51], v[124:127]
    ds_read_b64_tr_b16 v[70:71], v18 offset:9216
    ds_read_b64_tr_b16 v[72:73], v19 offset:8192
    v_mfma_f32_16x16x32_bf16 v[128:131], v[44:47], v[52:55], v[128:131]
    ds_read_b64_tr_b16 v[74:75], v19 offset:9216
    ds_read_b128 v[80:83], v20 offset:6400
    v_mfma_f32_16x16x32_bf16 v[116:119], v[40:43], v[52:55], v[116:119]
    ds_read_b128 v[84:87], v20 offset:6656
    v_mfma_f32_16x16x32_bf16 v[104:107], v[36:39], v[52:55], v[104:107]
    v_mfma_f32_16x16x32_bf16 v[92:95], v[32:35], v[52:55], v[92:95]
    v_mfma_f32_16x16x32_bf16 v[96:99], v[32:35], v[56:59], v[96:99]
    v_mfma_f32_16x16x32_bf16 v[108:111], v[36:39], v[56:59], v[108:111]
    v_mfma_f32_16x16x32_bf16 v[120:123], v[40:43], v[56:59], v[120:123]
    v_mfma_f32_16x16x32_bf16 v[132:135], v[44:47], v[56:59], v[132:135]
    s_waitcnt lgkmcnt(0)
    s_barrier
    v_mfma_f32_16x16x32_bf16 v[88:91], v[60:63], v[76:79], v[88:91]
    v_mfma_f32_16x16x32_bf16 v[100:103], v[64:67], v[76:79], v[100:103]
    v_mfma_f32_16x16x32_bf16 v[112:115], v[68:71], v[76:79], v[112:115]
    v_mfma_f32_16x16x32_bf16 v[124:127], v[72:75], v[76:79], v[124:127]
    v_mfma_f32_16x16x32_bf16 v[128:131], v[72:75], v[80:83], v[128:131]
    v_mfma_f32_16x16x32_bf16 v[116:119], v[68:71], v[80:83], v[116:119]
    v_mfma_f32_16x16x32_bf16 v[104:107], v[64:67], v[80:83], v[104:107]
    v_mfma_f32_16x16x32_bf16 v[92:95], v[60:63], v[80:83], v[92:95]
    v_mfma_f32_16x16x32_bf16 v[96:99], v[60:63], v[84:87], v[96:99]
    v_mfma_f32_16x16x32_bf16 v[108:111], v[64:67], v[84:87], v[108:111]
    v_mfma_f32_16x16x32_bf16 v[120:123], v[68:71], v[84:87], v[120:123]
    v_mfma_f32_16x16x32_bf16 v[132:135], v[72:75], v[84:87], v[132:135]
    s_mov_b32 s42, 0xffff0000
    s_waitcnt vmcnt(0)
    v_lshlrev_b32 v32, 16, v24
    v_and_b32 v33, s42, v24
    v_lshlrev_b32 v34, 16, v25
    v_and_b32 v35, s42, v25
    v_lshlrev_b32 v36, 16, v26
    v_and_b32 v37, s42, v26
    v_lshlrev_b32 v38, 16, v27
    v_and_b32 v39, s42, v27
    v_lshlrev_b32 v40, 16, v28
    v_and_b32 v41, s42, v28
    v_lshlrev_b32 v42, 16, v29
    v_and_b32 v43, s42, v29
    v_lshlrev_b32 v44, 16, v30
    v_and_b32 v45, s42, v30
    v_lshlrev_b32 v46, 16, v31
    v_and_b32 v47, s42, v31
    v_mov_b32 v80, 0xc0135761
    v_mov_b32 v81, 0xc0135761
    v_mov_b32 v82, 0xbdd2d3e8
    v_mov_b32 v83, 0xbdd2d3e8
    v_mov_b32 v84, 0x3f800000
    v_mov_b32 v85, 0x3f800000
    v_pk_add_f32 v[88:89], v[88:89], v[32:33]
    v_pk_add_f32 v[90:91], v[90:91], v[34:35]
    v_pk_add_f32 v[100:101], v[100:101], v[36:37]
    v_pk_add_f32 v[102:103], v[102:103], v[38:39]
    v_pk_mul_f32 v[60:61], v[88:89], v[88:89]
    v_pk_mul_f32 v[62:63], v[90:91], v[90:91]
    v_pk_mul_f32 v[64:65], v[100:101], v[100:101]
    v_pk_mul_f32 v[66:67], v[102:103], v[102:103]
    v_pk_fma_f32 v[60:61], v[60:61], v[82:83], v[80:81]
    v_pk_fma_f32 v[62:63], v[62:63], v[82:83], v[80:81]
    v_pk_fma_f32 v[64:65], v[64:65], v[82:83], v[80:81]
    v_pk_fma_f32 v[66:67], v[66:67], v[82:83], v[80:81]
    v_pk_mul_f32 v[60:61], v[60:61], v[88:89]
    v_pk_mul_f32 v[62:63], v[62:63], v[90:91]
    v_pk_mul_f32 v[64:65], v[64:65], v[100:101]
    v_pk_mul_f32 v[66:67], v[66:67], v[102:103]
    v_exp_f32 v60, v60
    v_exp_f32 v61, v61
    v_exp_f32 v62, v62
    v_exp_f32 v63, v63
    v_exp_f32 v64, v64
    v_exp_f32 v65, v65
    v_exp_f32 v66, v66
    v_exp_f32 v67, v67
    v_pk_add_f32 v[60:61], v[60:61], v[84:85]
    v_pk_add_f32 v[62:63], v[62:63], v[84:85]
    v_pk_add_f32 v[64:65], v[64:65], v[84:85]
    v_pk_add_f32 v[66:67], v[66:67], v[84:85]
    v_rcp_f32 v60, v60
    v_rcp_f32 v61, v61
    v_rcp_f32 v62, v62
    v_rcp_f32 v63, v63
    v_rcp_f32 v64, v64
    v_rcp_f32 v65, v65
    v_rcp_f32 v66, v66
    v_rcp_f32 v67, v67
    v_pk_mul_f32 v[88:89], v[88:89], v[60:61]
    v_pk_mul_f32 v[90:91], v[90:91], v[62:63]
    v_pk_mul_f32 v[100:101], v[100:101], v[64:65]
    v_pk_mul_f32 v[102:103], v[102:103], v[66:67]
    v_cvt_pk_bf16_f32 v72, v88, v89
    v_cvt_pk_bf16_f32 v73, v90, v91
    v_cvt_pk_bf16_f32 v74, v100, v101
    v_cvt_pk_bf16_f32 v75, v102, v103
    buffer_store_dwordx4 v[72:75], v14, s[28:31], s52 offen sc1
    v_pk_add_f32 v[112:113], v[112:113], v[40:41]
    v_pk_add_f32 v[114:115], v[114:115], v[42:43]
    v_pk_add_f32 v[124:125], v[124:125], v[44:45]
    v_pk_add_f32 v[126:127], v[126:127], v[46:47]
    v_pk_mul_f32 v[60:61], v[112:113], v[112:113]
    v_pk_mul_f32 v[62:63], v[114:115], v[114:115]
    v_pk_mul_f32 v[64:65], v[124:125], v[124:125]
    v_pk_mul_f32 v[66:67], v[126:127], v[126:127]
    v_pk_fma_f32 v[60:61], v[60:61], v[82:83], v[80:81]
    v_pk_fma_f32 v[62:63], v[62:63], v[82:83], v[80:81]
    v_pk_fma_f32 v[64:65], v[64:65], v[82:83], v[80:81]
    v_pk_fma_f32 v[66:67], v[66:67], v[82:83], v[80:81]
    v_pk_mul_f32 v[60:61], v[60:61], v[112:113]
    v_pk_mul_f32 v[62:63], v[62:63], v[114:115]
    v_pk_mul_f32 v[64:65], v[64:65], v[124:125]
    v_pk_mul_f32 v[66:67], v[66:67], v[126:127]
    v_exp_f32 v60, v60
    v_exp_f32 v61, v61
    v_exp_f32 v62, v62
    v_exp_f32 v63, v63
    v_exp_f32 v64, v64
    v_exp_f32 v65, v65
    v_exp_f32 v66, v66
    v_exp_f32 v67, v67
    v_pk_add_f32 v[60:61], v[60:61], v[84:85]
    v_pk_add_f32 v[62:63], v[62:63], v[84:85]
    v_pk_add_f32 v[64:65], v[64:65], v[84:85]
    v_pk_add_f32 v[66:67], v[66:67], v[84:85]
    v_rcp_f32 v60, v60
    v_rcp_f32 v61, v61
    v_rcp_f32 v62, v62
    v_rcp_f32 v63, v63
    v_rcp_f32 v64, v64
    v_rcp_f32 v65, v65
    v_rcp_f32 v66, v66
    v_rcp_f32 v67, v67
    v_pk_mul_f32 v[112:113], v[112:113], v[60:61]
    v_pk_mul_f32 v[114:115], v[114:115], v[62:63]
    v_pk_mul_f32 v[124:125], v[124:125], v[64:65]
    v_pk_mul_f32 v[126:127], v[126:127], v[66:67]
    v_cvt_pk_bf16_f32 v76, v112, v113
    v_cvt_pk_bf16_f32 v77, v114, v115
    v_cvt_pk_bf16_f32 v78, v124, v125
    v_cvt_pk_bf16_f32 v79, v126, v127
    buffer_store_dwordx4 v[76:79], v14, s[28:31], s55 offen sc1
    v_pk_add_f32 v[92:93], v[92:93], v[32:33]
    v_pk_add_f32 v[94:95], v[94:95], v[34:35]
    v_pk_add_f32 v[104:105], v[104:105], v[36:37]
    v_pk_add_f32 v[106:107], v[106:107], v[38:39]
    v_pk_mul_f32 v[60:61], v[92:93], v[92:93]
    v_pk_mul_f32 v[62:63], v[94:95], v[94:95]
    v_pk_mul_f32 v[64:65], v[104:105], v[104:105]
    v_pk_mul_f32 v[66:67], v[106:107], v[106:107]
    v_pk_fma_f32 v[60:61], v[60:61], v[82:83], v[80:81]
    v_pk_fma_f32 v[62:63], v[62:63], v[82:83], v[80:81]
    v_pk_fma_f32 v[64:65], v[64:65], v[82:83], v[80:81]
    v_pk_fma_f32 v[66:67], v[66:67], v[82:83], v[80:81]
    v_pk_mul_f32 v[60:61], v[60:61], v[92:93]
    v_pk_mul_f32 v[62:63], v[62:63], v[94:95]
    v_pk_mul_f32 v[64:65], v[64:65], v[104:105]
    v_pk_mul_f32 v[66:67], v[66:67], v[106:107]
    v_exp_f32 v60, v60
    v_exp_f32 v61, v61
    v_exp_f32 v62, v62
    v_exp_f32 v63, v63
    v_exp_f32 v64, v64
    v_exp_f32 v65, v65
    v_exp_f32 v66, v66
    v_exp_f32 v67, v67
    v_pk_add_f32 v[60:61], v[60:61], v[84:85]
    v_pk_add_f32 v[62:63], v[62:63], v[84:85]
    v_pk_add_f32 v[64:65], v[64:65], v[84:85]
    v_pk_add_f32 v[66:67], v[66:67], v[84:85]
    v_rcp_f32 v60, v60
    v_rcp_f32 v61, v61
    v_rcp_f32 v62, v62
    v_rcp_f32 v63, v63
    v_rcp_f32 v64, v64
    v_rcp_f32 v65, v65
    v_rcp_f32 v66, v66
    v_rcp_f32 v67, v67
    v_pk_mul_f32 v[92:93], v[92:93], v[60:61]
    v_pk_mul_f32 v[94:95], v[94:95], v[62:63]
    v_pk_mul_f32 v[104:105], v[104:105], v[64:65]
    v_pk_mul_f32 v[106:107], v[106:107], v[66:67]
    v_cvt_pk_bf16_f32 v72, v92, v93
    v_cvt_pk_bf16_f32 v73, v94, v95
    v_cvt_pk_bf16_f32 v74, v104, v105
    v_cvt_pk_bf16_f32 v75, v106, v107
    buffer_store_dwordx4 v[72:75], v14, s[28:31], s53 offen sc1
    v_pk_add_f32 v[116:117], v[116:117], v[40:41]
    v_pk_add_f32 v[118:119], v[118:119], v[42:43]
    v_pk_add_f32 v[128:129], v[128:129], v[44:45]
    v_pk_add_f32 v[130:131], v[130:131], v[46:47]
    v_pk_mul_f32 v[60:61], v[116:117], v[116:117]
    v_pk_mul_f32 v[62:63], v[118:119], v[118:119]
    v_pk_mul_f32 v[64:65], v[128:129], v[128:129]
    v_pk_mul_f32 v[66:67], v[130:131], v[130:131]
    v_pk_fma_f32 v[60:61], v[60:61], v[82:83], v[80:81]
    v_pk_fma_f32 v[62:63], v[62:63], v[82:83], v[80:81]
    v_pk_fma_f32 v[64:65], v[64:65], v[82:83], v[80:81]
    v_pk_fma_f32 v[66:67], v[66:67], v[82:83], v[80:81]
    v_pk_mul_f32 v[60:61], v[60:61], v[116:117]
    v_pk_mul_f32 v[62:63], v[62:63], v[118:119]
    v_pk_mul_f32 v[64:65], v[64:65], v[128:129]
    v_pk_mul_f32 v[66:67], v[66:67], v[130:131]
    v_exp_f32 v60, v60
    v_exp_f32 v61, v61
    v_exp_f32 v62, v62
    v_exp_f32 v63, v63
    v_exp_f32 v64, v64
    v_exp_f32 v65, v65
    v_exp_f32 v66, v66
    v_exp_f32 v67, v67
    v_pk_add_f32 v[60:61], v[60:61], v[84:85]
    v_pk_add_f32 v[62:63], v[62:63], v[84:85]
    v_pk_add_f32 v[64:65], v[64:65], v[84:85]
    v_pk_add_f32 v[66:67], v[66:67], v[84:85]
    v_rcp_f32 v60, v60
    v_rcp_f32 v61, v61
    v_rcp_f32 v62, v62
    v_rcp_f32 v63, v63
    v_rcp_f32 v64, v64
    v_rcp_f32 v65, v65
    v_rcp_f32 v66, v66
    v_rcp_f32 v67, v67
    v_pk_mul_f32 v[116:117], v[116:117], v[60:61]
    v_pk_mul_f32 v[118:119], v[118:119], v[62:63]
    v_pk_mul_f32 v[128:129], v[128:129], v[64:65]
    v_pk_mul_f32 v[130:131], v[130:131], v[66:67]
    v_cvt_pk_bf16_f32 v76, v116, v117
    v_cvt_pk_bf16_f32 v77, v118, v119
    v_cvt_pk_bf16_f32 v78, v128, v129
    v_cvt_pk_bf16_f32 v79, v130, v131
    buffer_store_dwordx4 v[76:79], v14, s[28:31], s56 offen sc1
    v_pk_add_f32 v[96:97], v[96:97], v[32:33]
    v_pk_add_f32 v[98:99], v[98:99], v[34:35]
    v_pk_add_f32 v[108:109], v[108:109], v[36:37]
    v_pk_add_f32 v[110:111], v[110:111], v[38:39]
    v_pk_mul_f32 v[60:61], v[96:97], v[96:97]
    v_pk_mul_f32 v[62:63], v[98:99], v[98:99]
    v_pk_mul_f32 v[64:65], v[108:109], v[108:109]
    v_pk_mul_f32 v[66:67], v[110:111], v[110:111]
    v_pk_fma_f32 v[60:61], v[60:61], v[82:83], v[80:81]
    v_pk_fma_f32 v[62:63], v[62:63], v[82:83], v[80:81]
    v_pk_fma_f32 v[64:65], v[64:65], v[82:83], v[80:81]
    v_pk_fma_f32 v[66:67], v[66:67], v[82:83], v[80:81]
    v_pk_mul_f32 v[60:61], v[60:61], v[96:97]
    v_pk_mul_f32 v[62:63], v[62:63], v[98:99]
    v_pk_mul_f32 v[64:65], v[64:65], v[108:109]
    v_pk_mul_f32 v[66:67], v[66:67], v[110:111]
    v_exp_f32 v60, v60
    v_exp_f32 v61, v61
    v_exp_f32 v62, v62
    v_exp_f32 v63, v63
    v_exp_f32 v64, v64
    v_exp_f32 v65, v65
    v_exp_f32 v66, v66
    v_exp_f32 v67, v67
    v_pk_add_f32 v[60:61], v[60:61], v[84:85]
    v_pk_add_f32 v[62:63], v[62:63], v[84:85]
    v_pk_add_f32 v[64:65], v[64:65], v[84:85]
    v_pk_add_f32 v[66:67], v[66:67], v[84:85]
    v_rcp_f32 v60, v60
    v_rcp_f32 v61, v61
    v_rcp_f32 v62, v62
    v_rcp_f32 v63, v63
    v_rcp_f32 v64, v64
    v_rcp_f32 v65, v65
    v_rcp_f32 v66, v66
    v_rcp_f32 v67, v67
    v_pk_mul_f32 v[96:97], v[96:97], v[60:61]
    v_pk_mul_f32 v[98:99], v[98:99], v[62:63]
    v_pk_mul_f32 v[108:109], v[108:109], v[64:65]
    v_pk_mul_f32 v[110:111], v[110:111], v[66:67]
    v_cvt_pk_bf16_f32 v72, v96, v97
    v_cvt_pk_bf16_f32 v73, v98, v99
    v_cvt_pk_bf16_f32 v74, v108, v109
    v_cvt_pk_bf16_f32 v75, v110, v111
    buffer_store_dwordx4 v[72:75], v14, s[28:31], s54 offen sc1
    v_pk_add_f32 v[120:121], v[120:121], v[40:41]
    v_pk_add_f32 v[122:123], v[122:123], v[42:43]
    v_pk_add_f32 v[132:133], v[132:133], v[44:45]
    v_pk_add_f32 v[134:135], v[134:135], v[46:47]
    v_pk_mul_f32 v[60:61], v[120:121], v[120:121]
    v_pk_mul_f32 v[62:63], v[122:123], v[122:123]
    v_pk_mul_f32 v[64:65], v[132:133], v[132:133]
    v_pk_mul_f32 v[66:67], v[134:135], v[134:135]
    v_pk_fma_f32 v[60:61], v[60:61], v[82:83], v[80:81]
    v_pk_fma_f32 v[62:63], v[62:63], v[82:83], v[80:81]
    v_pk_fma_f32 v[64:65], v[64:65], v[82:83], v[80:81]
    v_pk_fma_f32 v[66:67], v[66:67], v[82:83], v[80:81]
    v_pk_mul_f32 v[60:61], v[60:61], v[120:121]
    v_pk_mul_f32 v[62:63], v[62:63], v[122:123]
    v_pk_mul_f32 v[64:65], v[64:65], v[132:133]
    v_pk_mul_f32 v[66:67], v[66:67], v[134:135]
    v_exp_f32 v60, v60
    v_exp_f32 v61, v61
    v_exp_f32 v62, v62
    v_exp_f32 v63, v63
    v_exp_f32 v64, v64
    v_exp_f32 v65, v65
    v_exp_f32 v66, v66
    v_exp_f32 v67, v67
    v_pk_add_f32 v[60:61], v[60:61], v[84:85]
    v_pk_add_f32 v[62:63], v[62:63], v[84:85]
    v_pk_add_f32 v[64:65], v[64:65], v[84:85]
    v_pk_add_f32 v[66:67], v[66:67], v[84:85]
    v_rcp_f32 v60, v60
    v_rcp_f32 v61, v61
    v_rcp_f32 v62, v62
    v_rcp_f32 v63, v63
    v_rcp_f32 v64, v64
    v_rcp_f32 v65, v65
    v_rcp_f32 v66, v66
    v_rcp_f32 v67, v67
    v_pk_mul_f32 v[120:121], v[120:121], v[60:61]
    v_pk_mul_f32 v[122:123], v[122:123], v[62:63]
    v_pk_mul_f32 v[132:133], v[132:133], v[64:65]
    v_pk_mul_f32 v[134:135], v[134:135], v[66:67]
    v_cvt_pk_bf16_f32 v76, v120, v121
    v_cvt_pk_bf16_f32 v77, v122, v123
    v_cvt_pk_bf16_f32 v78, v132, v133
    v_cvt_pk_bf16_f32 v79, v134, v135
    buffer_store_dwordx4 v[76:79], v14, s[28:31], s57 offen sc1
    v_mov_b32 v3, 1
    s_waitcnt vmcnt(0)
    s_mov_b64 exec, 1
    buffer_store_dword v3, off, s[28:31], s58 sc1
    s_mov_b64 exec, -1
    s_barrier
t_cons2:
    s_lshr_b32 s44, s36, 1
    s_and_b32 s45, s36, 1
    s_lshl_b32 s45, s45, 3
    s_lshr_b32 s46, s37, 2
    s_add_u32 s45, s45, s46
    s_and_b32 s46, s37, 3
    s_lshr_b32 s47, s44, 1
    s_and_b32 s48, s44, 1
    s_lshl_b32 s40, s3, 1
    s_add_u32 s40, s40, s47
    s_xor_b32 s41, s40, 1
    v_lshrrev_b32 v2, 2, v5
    v_and_b32 v3, 1, v6
    v_lshl_add_u32 v3, v3, 2, v2
    v_mad_u32_u24 v2, v6, 4, v2
    v_lshlrev_b32 v2, 8, v2
    v_and_b32 v4, 3, v1
    v_lshl_add_u32 v2, v4, 3, v2
    v_xor_b32 v4, s40, v3
    v_lshl_add_u32 v8, v4, 5, v2
    v_xor_b32 v4, s41, v3
    v_lshl_add_u32 v9, v4, 5, v2
    s_lshl_b32 s42, s48, 12
    s_add_u32 s43, s42, 81920
    v_add_u32 v10, s43, v14
    s_xor_b32 s43, s43, 4096
    v_add_u32 v11, s43, v14
    v_add_u32 v12, 90112, v14
    s_lshl_b32 s49, s45, 3
    s_add_u32 s49, s49, s40
    s_lshl_b32 s49, s49, 4
    v_add_u32 v2, s49, v5
    v_mov_b32 v230, 0
    v_lshlrev_b32 v3, 1, v2
    buffer_load_short_d16_hi v230, v3, s[12:15], 0 offen
    v_mul_u32_u24 v2, 1152, v2
    v_lshl_add_u32 v22, v6, 3, v2
    s_mul_i32 s49, s46, 288
    s_lshl_b32 s52, s48, 7
    s_add_u32 s52, s52, s49
    s_lshl_b32 s53, s48, 2
    s_add_u32 s53, s53, s49
    s_add_u32 s53, s53, 256
    s_add_u32 s54, s52, 10485760
    s_add_u32 s55, s53, 10485760
    v_lshlrev_b32 v3, 4, v6
    s_lshl_b32 s56, s52, 1
    s_add_u32 s56, s56, 11520
    s_lshl_b32 s57, s53, 1
    s_add_u32 s57, s57, 11520
    v_mov_b32 v115, s26
    v_mov_b32 v119, s26
    v_mov_b32 v123, s26
    v_mov_b32 v235, s26
    v_mov_b32 v239, s26
    v_mov_b32 v243, s26
    v_mov_b32 v247, s26
    v_mov_b32 v251, s26
    v_mov_b32 v255, s26
    s_lshl_b32 s50, s46, 4
    s_add_u32 s50, s50, s45
    s_lshl_b32 s50, s50, 2
    s_add_u32 s50, s50, s3
    s_lshl_b32 s50, s50, 4
    s_xor_b32 s51, s44, 1
    s_lshl_b32 s61, s51, 2
    s_add_u32 s61, s61, s44
    s_add_u32 s61, s61, s50
    s_mul_i32 s61, s61, 3072
    s_add_u32 s61, s61, 25165824
    s_lshl_b32 s5, s44, 2
    s_add_u32 s5, s5, s51
    s_add_u32 s5, s5, s50
    s_mul_i32 s5, s5, 3072
    s_add_u32 s5, s5, 25165824
    s_xor_b32 s51, s44, 2
    s_lshl_b32 s62, s51, 2
    s_add_u32 s62, s62, s44
    s_add_u32 s62, s62, s50
    s_mul_i32 s62, s62, 3072
    s_add_u32 s62, s62, 25165824
    s_lshl_b32 s6, s44, 2
    s_add_u32 s6, s6, s51
    s_add_u32 s6, s6, s50
    s_mul_i32 s6, s6, 3072
    s_add_u32 s6, s6, 25165824
    s_xor_b32 s51, s44, 3
    s_lshl_b32 s63, s51, 2
    s_add_u32 s63, s63, s44
    s_add_u32 s63, s63, s50
    s_mul_i32 s63, s63, 3072
    s_add_u32 s63, s63, 25165824
    s_lshl_b32 s7, s44, 2
    s_add_u32 s7, s7, s51
    s_add_u32 s7, s7, s50
    s_mul_i32 s7, s7, 3072
    s_add_u32 s7, s7, 25165824
    v_mov_b32 v23, s5
    v_writelane_b32 v23, s6, 1
    v_writelane_b32 v23, s7, 2
    s_cmp_lt_u32 s2, 216
    s_cbranch_scc0 g2_late_ops
    buffer_load_dwordx2 v[200:201], v22, s[28:31], s54 offen offset:0
    buffer_load_dwordx2 v[202:203], v22, s[28:31], s54 offen offset:32
    buffer_load_dwordx2 v[204:205], v22, s[28:31], s54 offen offset:64
    buffer_load_dwordx2 v[206:207], v22, s[28:31], s54 offen offset:96
    buffer_load_dword v208, v22, s[28:31], s55 offen
    buffer_load_dwordx4 v[210:213], v3, s[28:31], s56 offen offset:0
    buffer_load_dwordx4 v[214:217], v3, s[28:31], s56 offen offset:64
    buffer_load_dwordx4 v[218:221], v3, s[28:31], s56 offen offset:128
    buffer_load_dwordx4 v[222:225], v3, s[28:31], s56 offen offset:192
    buffer_load_dwordx2 v[226:227], v3, s[28:31], s57 offen
g2_late_ops:
    v_mov_b32 v128, 0
    v_mov_b32 v129, 0
    v_mov_b32 v130, 0
    v_mov_b32 v131, 0
    v_mov_b32 v132, 0
    v_mov_b32 v133, 0
    v_mov_b32 v134, 0
    v_mov_b32 v135, 0
    v_mov_b32 v136, 0
    v_mov_b32 v137, 0
    v_mov_b32 v138, 0
    v_mov_b32 v139, 0
    v_mov_b32 v140, 0
    v_mov_b32 v141, 0
    v_mov_b32 v142, 0
    v_mov_b32 v143, 0
    v_mov_b32 v144, 0
    v_mov_b32 v145, 0
    v_mov_b32 v146, 0
    v_mov_b32 v147, 0
    v_mov_b32 v148, 0
    v_mov_b32 v149, 0
    v_mov_b32 v150, 0
    v_mov_b32 v151, 0
    v_mov_b32 v152, 0
    v_mov_b32 v153, 0
    v_mov_b32 v154, 0
    v_mov_b32 v155, 0
    v_mov_b32 v156, 0
    v_mov_b32 v157, 0
    v_mov_b32 v158, 0
    v_mov_b32 v159, 0
    v_mov_b32 v160, 0
    v_mov_b32 v161, 0
    v_mov_b32 v162, 0
    v_mov_b32 v163, 0
    v_mov_b32 v164, 0
    v_mov_b32 v165, 0
    v_mov_b32 v166, 0
    v_mov_b32 v167, 0
    v_mov_b32 v168, 0
    v_mov_b32 v169, 0
    v_mov_b32 v170, 0
    v_mov_b32 v171, 0
    v_mov_b32 v172, 0
    v_mov_b32 v173, 0
    v_mov_b32 v174, 0
    v_mov_b32 v175, 0
    v_mov_b32 v176, 0
    v_mov_b32 v177, 0
    v_mov_b32 v178, 0
    v_mov_b32 v179, 0
    v_mov_b32 v180, 0
    v_mov_b32 v181, 0
    v_mov_b32 v182, 0
    v_mov_b32 v183, 0
    v_mov_b32 v184, 0
    v_mov_b32 v185, 0
    v_mov_b32 v186, 0
    v_mov_b32 v187, 0
    v_mov_b32 v188, 0
    v_mov_b32 v189, 0
    v_mov_b32 v190, 0
    v_mov_b32 v191, 0
    v_mov_b32 v192, 0
    v_mov_b32 v193, 0
    v_mov_b32 v194, 0
    v_mov_b32 v195, 0
    v_mov_b32 v196, 0
    v_mov_b32 v197, 0
    v_mov_b32 v198, 0
    v_mov_b32 v199, 0
    s_mov_b32 s24, 0
    s_mov_b32 s4, 0
    v_add_u32 v16, s24, v8
    v_add_u32 v17, s24, v9
    v_add_u32 v18, s4, v10
    v_add_u32 v19, s4, v11
    v_add_u32 v20, s4, v12
    s_movk_i32 s59, 17
    s_barrier
    ds_read_b128 v[32:35], v18 offset:0
    ds_read_b64_tr_b16 v[24:25], v16 offset:0
    ds_read_b64_tr_b16 v[26:27], v16 offset:4096
    ds_read_b64_tr_b16 v[28:29], v17 offset:0
    ds_read_b64_tr_b16 v[30:31], v17 offset:4096
    ds_read_b128 v[36:39], v18 offset:1024
    ds_read_b128 v[40:43], v18 offset:2048
    ds_read_b128 v[44:47], v18 offset:3072
    ds_read_b128 v[48:51], v19 offset:0
    ds_read_b128 v[52:55], v19 offset:1024
    ds_read_b128 v[56:59], v19 offset:2048
    ds_read_b128 v[60:63], v19 offset:3072
    ds_read_b128 v[64:67], v20 offset:0
    s_cmp_lt_u32 s2, 216
    s_cbranch_scc1 g2_late_done
    buffer_load_dwordx2 v[200:201], v22, s[28:31], s54 offen offset:0
    buffer_load_dwordx2 v[202:203], v22, s[28:31], s54 offen offset:32
    buffer_load_dwordx2 v[204:205], v22, s[28:31], s54 offen offset:64
    buffer_load_dwordx2 v[206:207], v22, s[28:31], s54 offen offset:96
    buffer_load_dword v208, v22, s[28:31], s55 offen
    buffer_load_dwordx4 v[210:213], v3, s[28:31], s56 offen offset:0
    buffer_load_dwordx4 v[214:217], v3, s[28:31], s56 offen offset:64
    buffer_load_dwordx4 v[218:221], v3, s[28:31], s56 offen offset:128
    buffer_load_dwordx4 v[222:225], v3, s[28:31], s56 offen offset:192
    buffer_load_dwordx2 v[226:227], v3, s[28:31], s57 offen
g2_late_done:
    s_add_u32 s24, s24, 16384
    s_cmp_eq_u32 s24, 81920
    s_cselect_b32 s24, 0, s24
    s_add_u32 s4, s4, 18432
    s_cmp_eq_u32 s4, 73728
    s_cselect_b32 s4, 0, s4
g2_mm_loop:
    s_waitcnt lgkmcnt(0)
    v_mfma_f32_16x16x32_bf16 v[128:131], v[32:35], v[24:27], v[128:131]
    ds_read_b128 v[76:79], v18 offset:9216
    ds_read_b64_tr_b16 v[68:69], v16 offset:8192
    v_mfma_f32_16x16x32_bf16 v[164:167], v[32:35], v[28:31], v[164:167]
    ds_read_b64_tr_b16 v[70:71], v16 offset:12288
    ds_read_b64_tr_b16 v[72:73], v17 offset:8192
    v_mfma_f32_16x16x32_bf16 v[168:171], v[36:39], v[28:31], v[168:171]
    ds_read_b64_tr_b16 v[74:75], v17 offset:12288
    ds_read_b128 v[80:83], v18 offset:10240
    v_mfma_f32_16x16x32_bf16 v[132:135], v[36:39], v[24:27], v[132:135]
    ds_read_b128 v[84:87], v18 offset:11264
    ds_read_b128 v[88:91], v18 offset:12288
    v_mfma_f32_16x16x32_bf16 v[136:139], v[40:43], v[24:27], v[136:139]
    ds_read_b128 v[92:95], v19 offset:9216
    ds_read_b128 v[96:99], v19 offset:10240
    v_mfma_f32_16x16x32_bf16 v[172:175], v[40:43], v[28:31], v[172:175]
    ds_read_b128 v[100:103], v19 offset:11264
    ds_read_b128 v[104:107], v19 offset:12288
    v_mfma_f32_16x16x32_bf16 v[176:179], v[44:47], v[28:31], v[176:179]
    ds_read_b128 v[108:111], v20 offset:9216
    v_add_u32 v16, s24, v8
    v_mfma_f32_16x16x32_bf16 v[140:143], v[44:47], v[24:27], v[140:143]
    v_add_u32 v17, s24, v9
    v_add_u32 v18, s4, v10
    v_mfma_f32_16x16x32_bf16 v[144:147], v[48:51], v[24:27], v[144:147]
    v_add_u32 v19, s4, v11
    v_add_u32 v20, s4, v12
    v_mfma_f32_16x16x32_bf16 v[180:183], v[48:51], v[28:31], v[180:183]
    v_mfma_f32_16x16x32_bf16 v[184:187], v[52:55], v[28:31], v[184:187]
    v_mfma_f32_16x16x32_bf16 v[148:151], v[52:55], v[24:27], v[148:151]
    v_mfma_f32_16x16x32_bf16 v[152:155], v[56:59], v[24:27], v[152:155]
    v_mfma_f32_16x16x32_bf16 v[188:191], v[56:59], v[28:31], v[188:191]
    v_mfma_f32_16x16x32_bf16 v[192:195], v[60:63], v[28:31], v[192:195]
    v_mfma_f32_16x16x32_bf16 v[156:159], v[60:63], v[24:27], v[156:159]
    s_waitcnt lgkmcnt(0)
    s_barrier
    v_mfma_f32_16x16x32_bf16 v[160:163], v[64:67], v[24:27], v[160:163]
    v_mfma_f32_16x16x32_bf16 v[196:199], v[64:67], v[28:31], v[196:199]
    v_mfma_f32_16x16x32_bf16 v[128:131], v[76:79], v[68:71], v[128:131]
    ds_read_b128 v[32:35], v18 offset:0
    ds_read_b64_tr_b16 v[24:25], v16 offset:0
    v_mfma_f32_16x16x32_bf16 v[164:167], v[76:79], v[72:75], v[164:167]
    ds_read_b64_tr_b16 v[26:27], v16 offset:4096
    ds_read_b64_tr_b16 v[28:29], v17 offset:0
    v_mfma_f32_16x16x32_bf16 v[168:171], v[80:83], v[72:75], v[168:171]
    ds_read_b64_tr_b16 v[30:31], v17 offset:4096
    ds_read_b128 v[36:39], v18 offset:1024
    v_mfma_f32_16x16x32_bf16 v[132:135], v[80:83], v[68:71], v[132:135]
    ds_read_b128 v[40:43], v18 offset:2048
    ds_read_b128 v[44:47], v18 offset:3072
    v_mfma_f32_16x16x32_bf16 v[136:139], v[84:87], v[68:71], v[136:139]
    ds_read_b128 v[48:51], v19 offset:0
    ds_read_b128 v[52:55], v19 offset:1024
    v_mfma_f32_16x16x32_bf16 v[172:175], v[84:87], v[72:75], v[172:175]
    ds_read_b128 v[56:59], v19 offset:2048
    ds_read_b128 v[60:63], v19 offset:3072
    v_mfma_f32_16x16x32_bf16 v[176:179], v[88:91], v[72:75], v[176:179]
    ds_read_b128 v[64:67], v20 offset:0
    s_add_u32 s24, s24, 16384
    v_mfma_f32_16x16x32_bf16 v[140:143], v[88:91], v[68:71], v[140:143]
    s_cmp_eq_u32 s24, 81920
    s_cselect_b32 s24, 0, s24
    v_mfma_f32_16x16x32_bf16 v[144:147], v[92:95], v[68:71], v[144:147]
    s_add_u32 s4, s4, 18432
    s_cmp_eq_u32 s4, 73728
    v_mfma_f32_16x16x32_bf16 v[180:183], v[92:95], v[72:75], v[180:183]
    s_cselect_b32 s4, 0, s4
    s_sub_u32 s59, s59, 1
    v_mfma_f32_16x16x32_bf16 v[184:187], v[96:99], v[72:75], v[184:187]
    s_cmp_lg_u32 s59, 0
    v_mfma_f32_16x16x32_bf16 v[148:151], v[96:99], v[68:71], v[148:151]
    v_mfma_f32_16x16x32_bf16 v[152:155], v[100:103], v[68:71], v[152:155]
    v_mfma_f32_16x16x32_bf16 v[188:191], v[100:103], v[72:75], v[188:191]
    v_mfma_f32_16x16x32_bf16 v[192:195], v[104:107], v[72:75], v[192:195]
    v_mfma_f32_16x16x32_bf16 v[156:159], v[104:107], v[68:71], v[156:159]
    v_mfma_f32_16x16x32_bf16 v[160:163], v[108:111], v[68:71], v[160:163]
    v_mfma_f32_16x16x32_bf16 v[196:199], v[108:111], v[72:75], v[196:199]
    s_cbranch_scc1 g2_mm_loop
    s_waitcnt lgkmcnt(0)
    v_mfma_f32_16x16x32_bf16 v[128:131], v[32:35], v[24:27], v[128:131]
    ds_read_b128 v[76:79], v18 offset:9216
    ds_read_b64_tr_b16 v[68:69], v16 offset:8192
    v_mfma_f32_16x16x32_bf16 v[164:167], v[32:35], v[28:31], v[164:167]
    ds_read_b64_tr_b16 v[70:71], v16 offset:12288
    ds_read_b64_tr_b16 v[72:73], v17 offset:8192
    v_mfma_f32_16x16x32_bf16 v[168:171], v[36:39], v[28:31], v[168:171]
    ds_read_b64_tr_b16 v[74:75], v17 offset:12288
    ds_read_b128 v[80:83], v18 offset:10240
    v_mfma_f32_16x16x32_bf16 v[132:135], v[36:39], v[24:27], v[132:135]
    ds_read_b128 v[84:87], v18 offset:11264
    ds_read_b128 v[88:91], v18 offset:12288
    v_mfma_f32_16x16x32_bf16 v[136:139], v[40:43], v[24:27], v[136:139]
    ds_read_b128 v[92:95], v19 offset:9216
    ds_read_b128 v[96:99], v19 offset:10240
    v_mfma_f32_16x16x32_bf16 v[172:175], v[40:43], v[28:31], v[172:175]
    ds_read_b128 v[100:103], v19 offset:11264
    ds_read_b128 v[104:107], v19 offset:12288
    v_mfma_f32_16x16x32_bf16 v[176:179], v[44:47], v[28:31], v[176:179]
    ds_read_b128 v[108:111], v20 offset:9216
    v_mfma_f32_16x16x32_bf16 v[140:143], v[44:47], v[24:27], v[140:143]
    v_mfma_f32_16x16x32_bf16 v[144:147], v[48:51], v[24:27], v[144:147]
    v_mfma_f32_16x16x32_bf16 v[180:183], v[48:51], v[28:31], v[180:183]
    v_mfma_f32_16x16x32_bf16 v[184:187], v[52:55], v[28:31], v[184:187]
    v_mfma_f32_16x16x32_bf16 v[148:151], v[52:55], v[24:27], v[148:151]
    v_mfma_f32_16x16x32_bf16 v[152:155], v[56:59], v[24:27], v[152:155]
    v_mfma_f32_16x16x32_bf16 v[188:191], v[56:59], v[28:31], v[188:191]
    v_mfma_f32_16x16x32_bf16 v[192:195], v[60:63], v[28:31], v[192:195]
    v_mfma_f32_16x16x32_bf16 v[156:159], v[60:63], v[24:27], v[156:159]
    v_mfma_f32_16x16x32_bf16 v[160:163], v[64:67], v[24:27], v[160:163]
    v_mfma_f32_16x16x32_bf16 v[196:199], v[64:67], v[28:31], v[196:199]
    s_waitcnt lgkmcnt(0)
    v_mfma_f32_16x16x32_bf16 v[128:131], v[76:79], v[68:71], v[128:131]
    v_mfma_f32_16x16x32_bf16 v[164:167], v[76:79], v[72:75], v[164:167]
    v_mfma_f32_16x16x32_bf16 v[168:171], v[80:83], v[72:75], v[168:171]
    v_mfma_f32_16x16x32_bf16 v[132:135], v[80:83], v[68:71], v[132:135]
    v_mfma_f32_16x16x32_bf16 v[136:139], v[84:87], v[68:71], v[136:139]
    v_mfma_f32_16x16x32_bf16 v[172:175], v[84:87], v[72:75], v[172:175]
    v_mfma_f32_16x16x32_bf16 v[176:179], v[88:91], v[72:75], v[176:179]
    v_mfma_f32_16x16x32_bf16 v[140:143], v[88:91], v[68:71], v[140:143]
    v_mfma_f32_16x16x32_bf16 v[144:147], v[92:95], v[68:71], v[144:147]
    v_mfma_f32_16x16x32_bf16 v[180:183], v[92:95], v[72:75], v[180:183]
    v_mfma_f32_16x16x32_bf16 v[184:187], v[96:99], v[72:75], v[184:187]
    v_mfma_f32_16x16x32_bf16 v[148:151], v[96:99], v[68:71], v[148:151]
    v_mfma_f32_16x16x32_bf16 v[152:155], v[100:103], v[68:71], v[152:155]
    v_mfma_f32_16x16x32_bf16 v[188:191], v[100:103], v[72:75], v[188:191]
    v_mfma_f32_16x16x32_bf16 v[192:195], v[104:107], v[72:75], v[192:195]
    v_mfma_f32_16x16x32_bf16 v[156:159], v[104:107], v[68:71], v[156:159]
    v_mfma_f32_16x16x32_bf16 v[160:163], v[108:111], v[68:71], v[160:163]
    v_mfma_f32_16x16x32_bf16 v[196:199], v[108:111], v[72:75], v[196:199]
    s_cmp_eq_u32 s48, 1
    s_cbranch_scc0 g2_noswap
    s_nop 4
    v_swap_b32 v160, v162
    v_swap_b32 v161, v163
    v_swap_b32 v196, v198
    v_swap_b32 v197, v199
g2_noswap:
    v_cvt_pk_bf16_f32 v112, v144, v145
    v_cvt_pk_bf16_f32 v113, v146, v147
    v_cvt_pk_bf16_f32 v114, v148, v149
    buffer_store_dwordx4 v[112:115], v14, s[28:31], s61 offen offset:0 sc1
    v_cvt_pk_bf16_f32 v116, v150, v151
    v_cvt_pk_bf16_f32 v117, v152, v153
    v_cvt_pk_bf16_f32 v118, v154, v155
    buffer_store_dwordx4 v[116:119], v14, s[28:31], s61 offen offset:1024 sc1
    v_cvt_pk_bf16_f32 v120, v156, v157
    v_cvt_pk_bf16_f32 v121, v158, v159
    v_cvt_pk_bf16_f32 v122, v162, v163
    buffer_store_dwordx4 v[120:123], v14, s[28:31], s61 offen offset:2048 sc1
    v_cvt_pk_bf16_f32 v232, v164, v165
    v_cvt_pk_bf16_f32 v233, v166, v167
    v_cvt_pk_bf16_f32 v234, v168, v169
    buffer_store_dwordx4 v[232:235], v14, s[28:31], s62 offen offset:0 sc1
    v_cvt_pk_bf16_f32 v236, v170, v171
    v_cvt_pk_bf16_f32 v237, v172, v173
    v_cvt_pk_bf16_f32 v238, v174, v175
    buffer_store_dwordx4 v[236:239], v14, s[28:31], s62 offen offset:1024 sc1
    v_cvt_pk_bf16_f32 v240, v176, v177
    v_cvt_pk_bf16_f32 v241, v178, v179
    v_cvt_pk_bf16_f32 v242, v196, v197
    buffer_store_dwordx4 v[240:243], v14, s[28:31], s62 offen offset:2048 sc1
    v_cvt_pk_bf16_f32 v244, v180, v181
    v_cvt_pk_bf16_f32 v245, v182, v183
    v_cvt_pk_bf16_f32 v246, v184, v185
    buffer_store_dwordx4 v[244:247], v14, s[28:31], s63 offen offset:0 sc1
    v_cvt_pk_bf16_f32 v248, v186, v187
    v_cvt_pk_bf16_f32 v249, v188, v189
    v_cvt_pk_bf16_f32 v250, v190, v191
    buffer_store_dwordx4 v[248:251], v14, s[28:31], s63 offen offset:1024 sc1
    v_cvt_pk_bf16_f32 v252, v192, v193
    v_cvt_pk_bf16_f32 v253, v194, v195
    v_cvt_pk_bf16_f32 v254, v198, v199
    buffer_store_dwordx4 v[252:255], v14, s[28:31], s63 offen offset:2048 sc1
    s_mov_b32 s42, 0xffff0000
    s_waitcnt vmcnt(9)
    v_add_f32 v128, v128, v230
    v_add_f32 v129, v129, v230
    v_add_f32 v130, v130, v230
    v_add_f32 v131, v131, v230
    v_add_f32 v132, v132, v230
    v_add_f32 v133, v133, v230
    v_add_f32 v134, v134, v230
    v_add_f32 v135, v135, v230
    v_add_f32 v136, v136, v230
    v_add_f32 v137, v137, v230
    v_add_f32 v138, v138, v230
    v_add_f32 v139, v139, v230
    v_add_f32 v140, v140, v230
    v_add_f32 v141, v141, v230
    v_add_f32 v142, v142, v230
    v_add_f32 v143, v143, v230
    v_add_f32 v160, v160, v230
    v_add_f32 v161, v161, v230
    v_lshlrev_b32 v32, 16, v200
    v_and_b32 v33, s42, v200
    v_lshlrev_b32 v34, 16, v201
    v_and_b32 v35, s42, v201
    v_lshlrev_b32 v36, 16, v202
    v_and_b32 v37, s42, v202
    v_lshlrev_b32 v38, 16, v203
    v_and_b32 v39, s42, v203
    v_lshlrev_b32 v40, 16, v204
    v_and_b32 v41, s42, v204
    v_lshlrev_b32 v42, 16, v205
    v_and_b32 v43, s42, v205
    v_lshlrev_b32 v44, 16, v206
    v_and_b32 v45, s42, v206
    v_lshlrev_b32 v46, 16, v207
    v_and_b32 v47, s42, v207
    v_lshlrev_b32 v48, 16, v208
    v_and_b32 v49, s42, v208
    s_mov_b32 s49, 0
    s_mov_b64 s[40:41], 7
g2_scout:
    s_mov_b64 exec, s[40:41]
    buffer_load_dword v2, v23, s[28:31], 0 offen offset:3068 sc1
    s_add_u32 s49, s49, 1
    s_waitcnt vmcnt(0)
    v_cmp_eq_u32 vcc, s26, v2
    s_mov_b64 exec, -1
    s_bitcmp1_b32 vcc_lo, 0
    s_cbranch_scc0 g2_sc1
    buffer_load_dwordx4 v[68:71], v14, s[28:31], s5 offen offset:0 sc1
    buffer_load_dwordx4 v[72:75], v14, s[28:31], s5 offen offset:1024 sc1
    buffer_load_dwordx4 v[76:79], v14, s[28:31], s5 offen offset:2048 sc1
g2_sc1:
    s_bitcmp1_b32 vcc_lo, 1
    s_cbranch_scc0 g2_sc2
    buffer_load_dwordx4 v[80:83], v14, s[28:31], s6 offen offset:0 sc1
    buffer_load_dwordx4 v[84:87], v14, s[28:31], s6 offen offset:1024 sc1
    buffer_load_dwordx4 v[88:91], v14, s[28:31], s6 offen offset:2048 sc1
g2_sc2:
    s_bitcmp1_b32 vcc_lo, 2
    s_cbranch_scc0 g2_sc3
    buffer_load_dwordx4 v[92:95], v14, s[28:31], s7 offen offset:0 sc1
    buffer_load_dwordx4 v[96:99], v14, s[28:31], s7 offen offset:1024 sc1
    buffer_load_dwordx4 v[100:103], v14, s[28:31], s7 offen offset:2048 sc1
g2_sc3:
    s_andn2_b32 s40, s40, vcc_lo
    s_cbranch_scc0 g2_check
    s_cmp_lt_u32 s49, 30000
    s_cbranch_scc1 g2_scout
g2_poll:
    buffer_load_dwordx4 v[68:71], v14, s[28:31], s5 offen offset:0 sc1
    buffer_load_dwordx4 v[72:75], v14, s[28:31], s5 offen offset:1024 sc1
    buffer_load_dwordx4 v[76:79], v14, s[28:31], s5 offen offset:2048 sc1
    buffer_load_dwordx4 v[80:83], v14, s[28:31], s6 offen offset:0 sc1
    buffer_load_dwordx4 v[84:87], v14, s[28:31], s6 offen offset:1024 sc1
    buffer_load_dwordx4 v[88:91], v14, s[28:31], s6 offen offset:2048 sc1
    buffer_load_dwordx4 v[92:95], v14, s[28:31], s7 offen offset:0 sc1
    buffer_load_dwordx4 v[96:99], v14, s[28:31], s7 offen offset:1024 sc1
    buffer_load_dwordx4 v[100:103], v14, s[28:31], s7 offen offset:2048 sc1
    s_add_u32 s49, s49, 1
g2_check:
    s_waitcnt vmcnt(0)
    v_xor_b32 v24, s26, v71
    v_xor_b32 v25, s26, v75
    v_xor_b32 v26, s26, v79
    v_xor_b32 v27, s26, v83
    v_xor_b32 v28, s26, v87
    v_xor_b32 v29, s26, v91
    v_xor_b32 v30, s26, v95
    v_xor_b32 v31, s26, v99
    v_xor_b32 v2, s26, v103
    v_or3_b32 v24, v24, v25, v26
    v_or3_b32 v27, v27, v28, v29
    v_or3_b32 v30, v30, v31, v2
    v_or3_b32 v24, v24, v27, v30
    v_cmp_ne_u32 vcc, 0, v24
    s_nop 0
    s_and_b64 exec, vcc, vcc
    s_cbranch_scc0 g2_ready
    s_cmp_lt_u32 s49, 30000
    s_cbranch_scc1 g2_poll
g2_ready:
    s_mov_b64 exec, -1
    v_lshlrev_b32 v24, 16, v68
    v_and_b32 v25, s42, v68
    v_pk_add_f32 v[128:129], v[128:129], v[24:25]
    v_lshlrev_b32 v26, 16, v69
    v_and_b32 v27, s42, v69
    v_pk_add_f32 v[130:131], v[130:131], v[26:27]
    v_lshlrev_b32 v24, 16, v70
    v_and_b32 v25, s42, v70
    v_pk_add_f32 v[132:133], v[132:133], v[24:25]
    v_lshlrev_b32 v26, 16, v72
    v_and_b32 v27, s42, v72
    v_pk_add_f32 v[134:135], v[134:135], v[26:27]
    v_lshlrev_b32 v24, 16, v73
    v_and_b32 v25, s42, v73
    v_pk_add_f32 v[136:137], v[136:137], v[24:25]
    v_lshlrev_b32 v26, 16, v74
    v_and_b32 v27, s42, v74
    v_pk_add_f32 v[138:139], v[138:139], v[26:27]
    v_lshlrev_b32 v24, 16, v76
    v_and_b32 v25, s42, v76
    v_pk_add_f32 v[140:141], v[140:141], v[24:25]
    v_lshlrev_b32 v26, 16, v77
    v_and_b32 v27, s42, v77
    v_pk_add_f32 v[142:143], v[142:143], v[26:27]
    v_lshlrev_b32 v24, 16, v78
    v_and_b32 v25, s42, v78
    v_pk_add_f32 v[160:161], v[160:161], v[24:25]
    v_lshlrev_b32 v24, 16, v80
    v_and_b32 v25, s42, v80
    v_pk_add_f32 v[128:129], v[128:129], v[24:25]
    v_lshlrev_b32 v26, 16, v81
    v_and_b32 v27, s42, v81
    v_pk_add_f32 v[130:131], v[130:131], v[26:27]
    v_lshlrev_b32 v24, 16, v82
    v_and_b32 v25, s42, v82
    v_pk_add_f32 v[132:133], v[132:133], v[24:25]
    v_lshlrev_b32 v26, 16, v84
    v_and_b32 v27, s42, v84
    v_pk_add_f32 v[134:135], v[134:135], v[26:27]
    v_lshlrev_b32 v24, 16, v85
    v_and_b32 v25, s42, v85
    v_pk_add_f32 v[136:137], v[136:137], v[24:25]
    v_lshlrev_b32 v26, 16, v86
    v_and_b32 v27, s42, v86
    v_pk_add_f32 v[138:139], v[138:139], v[26:27]
    v_lshlrev_b32 v24, 16, v88
    v_and_b32 v25, s42, v88
    v_pk_add_f32 v[140:141], v[140:141], v[24:25]
    v_lshlrev_b32 v26, 16, v89
    v_and_b32 v27, s42, v89
    v_pk_add_f32 v[142:143], v[142:143], v[26:27]
    v_lshlrev_b32 v24, 16, v90
    v_and_b32 v25, s42, v90
    v_pk_add_f32 v[160:161], v[160:161], v[24:25]
    v_lshlrev_b32 v24, 16, v92
    v_and_b32 v25, s42, v92
    v_pk_add_f32 v[128:129], v[128:129], v[24:25]
    v_lshlrev_b32 v26, 16, v93
    v_and_b32 v27, s42, v93
    v_pk_add_f32 v[130:131], v[130:131], v[26:27]
    v_lshlrev_b32 v24, 16, v94
    v_and_b32 v25, s42, v94
    v_pk_add_f32 v[132:133], v[132:133], v[24:25]
    v_lshlrev_b32 v26, 16, v96
    v_and_b32 v27, s42, v96
    v_pk_add_f32 v[134:135], v[134:135], v[26:27]
    v_lshlrev_b32 v24, 16, v97
    v_and_b32 v25, s42, v97
    v_pk_add_f32 v[136:137], v[136:137], v[24:25]
    v_lshlrev_b32 v26, 16, v98
    v_and_b32 v27, s42, v98
    v_pk_add_f32 v[138:139], v[138:139], v[26:27]
    v_lshlrev_b32 v24, 16, v100
    v_and_b32 v25, s42, v100
    v_pk_add_f32 v[140:141], v[140:141], v[24:25]
    v_lshlrev_b32 v26, 16, v101
    v_and_b32 v27, s42, v101
    v_pk_add_f32 v[142:143], v[142:143], v[26:27]
    v_lshlrev_b32 v24, 16, v102
    v_and_b32 v25, s42, v102
    v_pk_add_f32 v[160:161], v[160:161], v[24:25]
    v_pk_fma_f32 v[128:129], v[128:129], v[210:211], v[32:33]
    v_cvt_pk_bf16_f32 v68, v128, v129
    v_pk_fma_f32 v[130:131], v[130:131], v[212:213], v[34:35]
    v_cvt_pk_bf16_f32 v69, v130, v131
    buffer_store_dwordx2 v[68:69], v22, s[16:19], s52 offen offset:0
    v_pk_fma_f32 v[132:133], v[132:133], v[214:215], v[36:37]
    v_cvt_pk_bf16_f32 v70, v132, v133
    v_pk_fma_f32 v[134:135], v[134:135], v[216:217], v[38:39]
    v_cvt_pk_bf16_f32 v71, v134, v135
    buffer_store_dwordx2 v[70:71], v22, s[16:19], s52 offen offset:32
    v_pk_fma_f32 v[136:137], v[136:137], v[218:219], v[40:41]
    v_cvt_pk_bf16_f32 v72, v136, v137
    v_pk_fma_f32 v[138:139], v[138:139], v[220:221], v[42:43]
    v_cvt_pk_bf16_f32 v73, v138, v139
    buffer_store_dwordx2 v[72:73], v22, s[16:19], s52 offen offset:64
    v_pk_fma_f32 v[140:141], v[140:141], v[222:223], v[44:45]
    v_cvt_pk_bf16_f32 v74, v140, v141
    v_pk_fma_f32 v[142:143], v[142:143], v[224:225], v[46:47]
    v_cvt_pk_bf16_f32 v75, v142, v143
    buffer_store_dwordx2 v[74:75], v22, s[16:19], s52 offen offset:96
    v_pk_fma_f32 v[160:161], v[160:161], v[226:227], v[48:49]
    v_cvt_pk_bf16_f32 v76, v160, v161
    buffer_store_dword v76, v22, s[16:19], s53 offen
t_end:
f_done:
    s_endpgm
f_end:
.section .rodata,"a"
.p2align 6
.amdhsa_kernel f_kernel
  .amdhsa_next_free_vgpr 256
  .amdhsa_next_free_sgpr 102
  .amdhsa_accum_offset 256
  .amdhsa_group_segment_fixed_size 0
  .amdhsa_kernarg_size 104
  .amdhsa_user_sgpr_count 2
  .amdhsa_user_sgpr_kernarg_segment_ptr 1
  .amdhsa_system_sgpr_workgroup_id_x 1
.end_amdhsa_kernel
```

```asm
; @launch kernel=f_kernel grid=(256,1,1) block=(512,1,1) lds=163840
.amdgcn_target "amdgcn-amd-amdhsa--gfx950"
.text
.globl f_kernel
.p2align 8
.type f_kernel,@function
f_kernel:
    s_cmp_ge_u32 s2, 256
    s_cbranch_scc1 f_done
    s_load_dwordx2 s[16:17], s[0:1], 64
    s_load_dwordx2 s[20:21], s[0:1], 72
    s_load_dwordx2 s[28:29], s[0:1], 96
    s_load_dwordx2 s[4:5], s[0:1], 0
    s_load_dwordx2 s[8:9], s[0:1], 8
    s_load_dwordx2 s[12:13], s[0:1], 16
    s_load_dwordx2 s[24:25], s[0:1], 88
    s_load_dwordx2 s[32:33], s[0:1], 32
    s_mov_b32 s18, 0x480
    s_mov_b32 s19, 0x20000
    s_mov_b32 s22, 0x3cc000
    s_mov_b32 s23, 0x20000
    s_mov_b32 s30, 0x3000000
    s_mov_b32 s31, 0x20000
    s_mov_b32 s6, 0x240000
    s_mov_b32 s7, 0x20000
    s_mov_b32 s10, 0x121000
    s_mov_b32 s11, 0x20000
    s_mov_b32 s14, 0x121000
    s_mov_b32 s15, 0x20000
    s_mov_b32 s26, 0x100
    s_mov_b32 s27, 0x20000
    s_mov_b32 s34, 0x1200000
    s_mov_b32 s35, 0x20000
    v_and_b32 v1, 63, v0
    v_lshrrev_b32 v2, 6, v0
    s_nop 0
    v_readfirstlane_b32 s3, v2
    v_and_b32 v5, 15, v1
    v_lshrrev_b32 v6, 4, v1
    s_and_b32 s36, s2, 7
    s_lshr_b32 s37, s2, 3
    s_sub_u32 s50, s37, 27
    s_cbranch_scc1 cpf_no
    s_cmp_eq_u32 s3, 5
    s_cbranch_scc0 cpf_no
    s_lshl_b32 s50, s50, 13
    s_add_u32 s50, s50, f_kernel-f_kernel
    v_lshl_add_u32 v102, v1, 7, s50
    v_min_u32 v102, f_end-f_kernel-4, v102
    s_getpc_b64 s[50:51]
cpf_pc:
    s_sub_u32 s50, s50, cpf_pc-f_kernel
    s_subb_u32 s51, s51, 0
    global_load_dword v103, v102, s[50:51]
cpf_no:
    s_lshr_b32 s38, s37, 3
    s_sub_u32 s38, 3, s38
    s_lshl_b32 s38, s38, 3
    s_add_u32 s38, s38, s36
    s_lshl_b32 s38, s38, 3
    s_and_b32 s39, s37, 7
    s_add_u32 s38, s38, s39
    s_and_b32 s39, s3, 3
    s_lshr_b32 s40, s3, 2
    s_sub_u32 s41, s2, 0
    s_mul_i32 s43, s41, 171
    s_lshr_b32 s43, s43, 9
    s_mul_i32 s44, s43, 3
    s_sub_u32 s44, s41, s44
    v_lshrrev_b32 v2, 3, v0
    v_and_b32 v3, 7, v0
    v_mul_u32_u24 v4, 6912, v2
    v_lshl_add_u32 v3, v3, 4, v4
    v_lshrrev_b32 v2, 3, v1
    v_min_u32 v2, 2, v2
    v_lshlrev_b32 v2, 6, v2
    v_and_or_b32 v2, v1, 7, v2
    v_lshl_add_u32 v2, s3, 3, v2
    v_lshlrev_b32 v2, 1, v2
    s_mul_i32 s45, s44, 384
    s_mul_i32 s46, s44, 1327104
    s_lshl_b32 s47, s43, 7
    s_add_u32 s46, s46, s47
    s_mul_i32 s48, s44, 9216
    s_lshl_b32 s47, s43, 8
    s_add_u32 s48, s48, s47
    s_add_u32 s47, s47, 131072
    s_cmp_lt_u32 s41, 54
    s_cselect_b32 s47, s47, 167424
    s_add_u32 s48, s48, s47
    s_memrealtime s[52:53]
    v_lshlrev_b32 v125, 2, v1
    v_lshlrev_b32 v109, 4, v1
    v_mov_b32 v68, -1
    v_mov_b32 v69, -1
    v_mov_b32 v70, -1
    v_mov_b32 v71, -1
    v_mov_b32 v44, 0
    v_mov_b32 v45, 0
    v_mov_b32 v46, 0
    s_bfe_u32 s49, s2, 0x10001
    s_lshl_b32 s49, s49, 3
    s_bfe_u32 s50, s2, 0x30003
    s_add_u32 s49, s49, s50
    s_bfe_u32 s50, s2, 0x10002
    s_lshl_b32 s50, s50, 2
    s_lshr_b32 s51, s2, 6
    s_add_u32 s50, s50, s51
    s_lshl_b32 s50, s50, 1
    s_and_b32 s51, s2, 1
    s_add_u32 s50, s50, s51
    s_lshl_b32 s56, s49, 4
    s_add_u32 s56, s56, s50
    s_lshl_b32 s49, s49, 2
    s_add_u32 s49, s49, s39
    s_lshl_b32 s49, s49, 4
    s_add_u32 s49, s49, s50
    s_lshl_b32 s49, s49, 1
    s_add_u32 s49, s49, s40
    s_mul_i32 s49, s49, 1152
    s_lshl_b32 s50, s39, 4
    v_add_u32 v7, s50, v5
    s_mul_i32 s55, s3, 1184
    s_xor_b32 s50, s2, 54
    s_or_b32 s50, s50, s3
    s_waitcnt lgkmcnt(0)
    s_cbranch_scc1 f_nolead
    s_or_b32 s59, s52, 1
    v_mov_b32 v4, s59
    s_mov_b64 exec, 1
    buffer_store_dword v4, off, s[24:27], 0 offset:252 sc1
    s_mov_b64 exec, -1
f_nolead:
    s_or_b32 s59, s52, 1
    s_cmp_lt_u32 s41, 54
    s_cbranch_scc1 f_nonsl
    s_sleep 6
f_nonsl:
    s_cmp_lt_u32 s41, 162
    s_cbranch_scc0 f_nogemv1
    buffer_load_short_d16_hi v44, v2, s[16:19], s45 offen offset:0
    buffer_load_dwordx4 v[48:51], v3, s[20:23], s46 offen
    s_add_u32 s46, s46, 442368
    buffer_load_dwordx4 v[52:55], v3, s[20:23], s46 offen
    s_add_u32 s46, s46, 442368
    buffer_load_dwordx4 v[56:59], v3, s[20:23], s46 offen
    s_cmp_lt_u32 s41, 54
    s_cbranch_scc1 f_issue2
f_nogemv1:
    s_add_u32 m0, s55, 9728
    s_nop 0
    buffer_load_dwordx4 v109, s[4:7], s49 offen lds
    s_mov_b64 exec, 0xff
    buffer_load_dwordx4 v109, s[4:7], s49 offen offset:1024 lds
    s_mov_b64 exec, -1
    s_and_b32 s50, s37, 7
    s_lshl_b32 s50, s50, 2
    s_add_u32 s50, s50, s39
    s_lshl_b32 s50, s50, 3
    s_add_u32 s50, s50, s36
    s_mul_i32 s50, s50, 4624
    s_lshr_b32 s51, s2, 6
    s_mul_i32 s51, s51, 1152
    s_add_u32 s50, s50, s51
    s_mul_i32 s51, s3, 5120
    s_add_u32 m0, s51, 65536
    s_cmp_eq_u32 s40, 0
    s_cselect_b32 s8, s8, s12
    s_cselect_b32 s9, s9, s13
    buffer_load_dwordx4 v109, s[8:11], s50 offen lds
    s_mov_b64 exec, 0x1ff
    buffer_load_dwordx4 v109, s[8:11], s50 offen offset:1024 lds
    s_mov_b64 exec, -1
    s_sub_u32 s50, s2, 176
    s_cmp_lt_u32 s50, 80
    s_cbranch_scc0 f_noslot
    s_lshl_b32 s50, s50, 3
    s_add_u32 s50, s50, s3
    s_mul_i32 s50, s50, 4096
    s_add_u32 s50, s50, 4194304
    buffer_store_dwordx4 v[68:71], v109, s[28:31], s50 offen offset:0 sc1
    buffer_store_dwordx4 v[68:71], v109, s[28:31], s50 offen offset:1024 sc1
    buffer_store_dwordx4 v[68:71], v109, s[28:31], s50 offen offset:2048 sc1
    buffer_store_dwordx4 v[68:71], v109, s[28:31], s50 offen offset:3072 sc1
f_noslot:
f_issue2:
    v_mul_u32_u24 v118, 1152, v6
    v_lshl_add_u32 v118, v7, 1, v118
    s_lshl_b32 s52, s38, 1
    s_add_u32 s52, s52, s40
    s_mul_i32 s52, s52, 4608
    v_mov_b32 v8, 0
    v_mov_b32 v9, 0
    v_mov_b32 v10, 0
    v_mov_b32 v11, 0
    v_mov_b32 v12, 0
    v_mov_b32 v13, 0
    v_mov_b32 v14, 0
    v_mov_b32 v15, 0
    v_mov_b32 v16, 0
    v_mov_b32 v18, 0
    v_mov_b32 v19, 0
    v_mov_b32 v20, 0
    v_mov_b32 v21, 0
    v_mov_b32 v22, 0
    v_mov_b32 v23, 0
    v_mov_b32 v24, 0
    v_mov_b32 v25, 0
    v_mov_b32 v26, 0
    s_add_u32 s53, s38, 64
    s_lshl_b32 s54, s36, 2
    s_add_u32 s54, s54, s37
    s_cmp_lt_u32 s2, 32
    s_cselect_b32 s54, s54, -1
    s_cmp_eq_u32 s2, 32
    s_cselect_b32 s54, 32, s54
    s_cmp_eq_u32 s40, 0
    s_cselect_b32 s42, s53, s54
    s_lshl_b32 s50, s40, 2
    s_add_u32 s50, s50, s39
    s_mul_i32 s50, s50, 272
    s_add_u32 s50, s50, 9728
    v_add_u32 v104, s50, v125
    v_mul_u32_u24 v2, 272, v5
    v_lshl_add_u32 v2, v6, 4, v2
    s_mul_i32 s50, s40, 8704
    s_add_u32 s51, s50, 9728
    v_add_u32 v105, s51, v2
    s_add_u32 s51, s50, 46336
    v_add_u32 v111, s51, v2
    v_mul_u32_u24 v2, 1088, v6
    v_lshl_add_u32 v2, v7, 2, v2
    v_add_u32 v110, s51, v2
    v_lshrrev_b32 v2, 1, v6
    v_lshl_add_u32 v2, v2, 6, v7
    v_and_b32 v3, 1, v6
    v_lshlrev_b32 v3, 4, v3
    v_lshl_add_u32 v2, v2, 5, v3
    s_lshl_b32 s50, s40, 13
    v_add_u32 v106, s50, v2
    v_add_u32 v107, 4096, v2
    v_cmp_lt_u32 vcc, 1, v6
    s_cmp_eq_u32 s40, 1
    s_cselect_b64 s[50:51], vcc, 0
    v_mov_b32 v3, 0x7f000000
    v_cndmask_b32 v106, v106, v3, s[50:51]
    s_mul_i32 s56, s56, 10240
    s_add_u32 s56, s56, 4194304
    v_lshrrev_b32 v2, 1, v5
    v_lshl_add_u32 v2, v6, 4, v2
    v_mul_u32_u24 v2, 10240, v2
    v_and_b32 v3, 1, v5
    v_lshl_add_u32 v108, v3, 4, v2
    v_lshlrev_b32 v2, 6, v7
    v_lshl_add_u32 v112, v6, 4, v2
    v_lshrrev_b32 v2, 1, v1
    s_and_b32 s50, s3, 1
    s_lshl_b32 s50, s50, 5
    v_add_u32 v2, s50, v2
    v_and_b32 v3, 1, v1
    s_lshr_b32 s51, s3, 1
    v_mul_u32_u24 v4, 5760, v3
    v_lshl_add_u32 v4, v2, 3, v4
    s_mul_i32 s50, s51, 576
    s_add_u32 s50, s50, 17920
    v_add_u32 v115, s50, v4
    v_lshlrev_b32 v3, 4, v3
    v_lshl_add_u32 v114, v2, 13, v3
    v_add_u32 v114, 2097152, v114
    v_sub_u32 v4, 64, v2
    v_min_u32 v4, v4, v2
    s_cmp_eq_u32 s51, 0
    s_cselect_b64 vcc, -1, 0
    v_cndmask_b32 v2, v2, v4, vcc
    s_lshl_b32 s51, s51, 19
    v_lshl_add_u32 v113, v2, 13, v3
    v_add_u32 v113, s51, v113
    v_lshrrev_b32 v2, 2, v5
    v_lshl_add_u32 v2, v6, 2, v2
    v_lshlrev_b32 v2, 3, v2
    s_mul_i32 s50, s40, 5760
    s_add_u32 s50, s50, 17920
    v_add_u32 v117, s50, v2
    v_and_b32 v2, 3, v1
    v_add_u32 v2, 1, v2
    v_mul_u32_u24 v2, 576, v2
    v_add_u32 v116, v2, v117
    s_lshl_b32 s50, s40, 7
    s_add_u32 s50, s50, 29440
    v_lshl_add_u32 v119, v6, 5, s50
    s_lshl_b32 s50, s39, 3
    v_add_u32 v120, s50, v119
    s_mov_b32 s50, 391680
    v_lshl_add_u32 v2, v6, 6, v7
    s_lshl_b32 s51, s40, 3
    s_add_u32 s51, s51, 17920
    v_lshl_add_u32 v121, v2, 4, s51
    v_mul_u32_u24 v3, 683, v0
    v_lshrrev_b32 v3, 16, v3
    v_mul_lo_u32 v3, v3, s50
    v_lshl_add_u32 v122, v0, 4, v3
    v_add_u32 v2, 256, v0
    v_mul_u32_u24 v3, 683, v2
    v_lshrrev_b32 v3, 16, v3
    v_mul_lo_u32 v3, v3, s50
    v_lshl_add_u32 v118, v2, 4, v3
    v_add_u32 v123, 1966592, v109
    v_lshlrev_b32 v124, 2, v7
    v_mul_u32_u24 v2, 1184, v6
    v_lshl_add_u32 v2, v7, 1, v2
    s_mul_i32 s50, s40, 4736
    s_add_u32 s50, s50, 0
    v_add_u32 v127, s50, v2
    s_and_b32 s50, s2, 1
    s_mul_i32 s50, s50, 1152
    v_cmp_lt_u32 vcc, 431, v0
    v_mov_b32 v3, s50
    s_nop 0
    v_cndmask_b32 v3, 0, v3, vcc
    v_lshl_add_u32 v126, v0, 4, v3
    s_mul_i32 s57, s36, 4617
    s_lshr_b32 s57, s57, 10
    s_lshl_b32 s57, s57, 8
    v_mul_u32_u24 v2, 26, v1
    v_lshrrev_b32 v2, 8, v2
    v_mul_u32_u24 v2, 7936, v2
    v_lshl_add_u32 v17, v1, 7, v2
    s_cmp_lt_u32 s41, 54
    s_cbranch_scc0 f_notag
    s_add_u32 m0, s55, 9728
    s_nop 0
    buffer_load_dwordx4 v109, s[4:7], s49 offen lds
    s_mov_b64 exec, 0xff
    buffer_load_dwordx4 v109, s[4:7], s49 offen offset:1024 lds
    s_mov_b64 exec, -1
    s_and_b32 s50, s37, 7
    s_lshl_b32 s50, s50, 2
    s_add_u32 s50, s50, s39
    s_lshl_b32 s50, s50, 3
    s_add_u32 s50, s50, s36
    s_mul_i32 s50, s50, 4624
    s_lshr_b32 s51, s2, 6
    s_mul_i32 s51, s51, 1152
    s_add_u32 s50, s50, s51
    s_mul_i32 s51, s3, 5120
    s_add_u32 m0, s51, 65536
    s_cmp_eq_u32 s40, 0
    s_cselect_b32 s8, s8, s12
    s_cselect_b32 s9, s9, s13
    buffer_load_dwordx4 v109, s[8:11], s50 offen lds
    s_mov_b64 exec, 0x1ff
    buffer_load_dwordx4 v109, s[8:11], s50 offen offset:1024 lds
    s_mov_b64 exec, -1
    s_lshl_b32 s50, s41, 2
    v_mov_b32 v4, s59
    s_mov_b64 exec, 1
    s_cmp_eq_u32 s3, 7
    s_cbranch_scc0 f_filler
    buffer_store_dword v4, off, s[24:27], s50 sc1
    s_branch f_filled
f_filler:
    buffer_load_dword v99, off, s[16:19], 0
f_filled:
    s_mov_b64 exec, -1
    s_branch f_c1done
f_notag:
    v_cvt_f32_u32 v84, v7
    v_cvt_f32_u32 v85, v6
    v_mul_f32 v86, v85, v84
    v_mul_f32 v86, 0x3d800000, v86
    v_fmamk_f32 v72, v84, 0x00000000, v86
    v_cos_f32 v73, v72
    v_sin_f32 v74, v72
    v_fmamk_f32 v75, v84, 0x3c800000, v86
    v_cos_f32 v76, v75
    v_sin_f32 v77, v75
    v_cvt_pk_bf16_f32 v128, v73, v74
    v_cvt_pk_bf16_f32 v144, -v74, v73
    v_fmamk_f32 v72, v84, 0x3d000000, v86
    v_cos_f32 v73, v72
    v_sin_f32 v74, v72
    v_cvt_pk_bf16_f32 v129, v76, v77
    v_cvt_pk_bf16_f32 v145, -v77, v76
    v_fmamk_f32 v75, v84, 0x3d400000, v86
    v_cos_f32 v76, v75
    v_sin_f32 v77, v75
    v_cvt_pk_bf16_f32 v130, v73, v74
    v_cvt_pk_bf16_f32 v146, -v74, v73
    v_fmamk_f32 v72, v84, 0x3e800000, v86
    v_cos_f32 v73, v72
    v_sin_f32 v74, v72
    v_cvt_pk_bf16_f32 v131, v76, v77
    v_cvt_pk_bf16_f32 v147, -v77, v76
    v_fmamk_f32 v75, v84, 0x3e880000, v86
    v_cos_f32 v76, v75
    v_sin_f32 v77, v75
    v_cvt_pk_bf16_f32 v132, v73, v74
    v_cvt_pk_bf16_f32 v148, -v74, v73
    v_fmamk_f32 v72, v84, 0x3e900000, v86
    v_cos_f32 v73, v72
    v_sin_f32 v74, v72
    v_cvt_pk_bf16_f32 v133, v76, v77
    v_cvt_pk_bf16_f32 v149, -v77, v76
    v_fmamk_f32 v75, v84, 0x3e980000, v86
    v_cos_f32 v76, v75
    v_sin_f32 v77, v75
    v_cvt_pk_bf16_f32 v134, v73, v74
    v_cvt_pk_bf16_f32 v150, -v74, v73
    v_fmamk_f32 v72, v84, 0x3f000000, v86
    v_cos_f32 v73, v72
    v_sin_f32 v74, v72
    v_cvt_pk_bf16_f32 v135, v76, v77
    v_cvt_pk_bf16_f32 v151, -v77, v76
    v_fmamk_f32 v75, v84, 0x3f040000, v86
    v_cos_f32 v76, v75
    v_sin_f32 v77, v75
    v_cvt_pk_bf16_f32 v136, v73, v74
    v_cvt_pk_bf16_f32 v152, -v74, v73
    v_fmamk_f32 v72, v84, 0x3f080000, v86
    v_cos_f32 v73, v72
    v_sin_f32 v74, v72
    v_cvt_pk_bf16_f32 v137, v76, v77
    v_cvt_pk_bf16_f32 v153, -v77, v76
    v_fmamk_f32 v75, v84, 0x3f0c0000, v86
    v_cos_f32 v76, v75
    v_sin_f32 v77, v75
    v_cvt_pk_bf16_f32 v138, v73, v74
    v_cvt_pk_bf16_f32 v154, -v74, v73
    v_fmamk_f32 v72, v84, 0x3f400000, v86
    v_cos_f32 v73, v72
    v_sin_f32 v74, v72
    v_cvt_pk_bf16_f32 v139, v76, v77
    v_cvt_pk_bf16_f32 v155, -v77, v76
    v_fmamk_f32 v75, v84, 0x3f440000, v86
    v_cos_f32 v76, v75
    v_sin_f32 v77, v75
    v_cvt_pk_bf16_f32 v140, v73, v74
    v_cvt_pk_bf16_f32 v156, -v74, v73
    v_fmamk_f32 v72, v84, 0x3f480000, v86
    v_cos_f32 v73, v72
    v_sin_f32 v74, v72
    v_cvt_pk_bf16_f32 v141, v76, v77
    v_cvt_pk_bf16_f32 v157, -v77, v76
    v_fmamk_f32 v75, v84, 0x3f4c0000, v86
    v_cos_f32 v76, v75
    v_sin_f32 v77, v75
    v_cvt_pk_bf16_f32 v142, v73, v74
    v_cvt_pk_bf16_f32 v158, -v74, v73
    v_cvt_pk_bf16_f32 v143, v76, v77
    v_cvt_pk_bf16_f32 v159, -v77, v76
    v_cvt_f32_u32 v82, v1
    v_mul_f32 v73, 0x3ae38e39, v82
    v_mul_f32 v74, 0x3b638e39, v82
    v_mul_f32 v75, 0x3baaaaab, v82
    v_mul_f32 v76, 0x3be38e39, v82
    v_cos_f32 v208, v73
    v_sin_f32 v212, v73
    v_cos_f32 v209, v74
    v_sin_f32 v213, v74
    v_cos_f32 v210, v75
    v_sin_f32 v214, v75
    v_cos_f32 v211, v76
    v_sin_f32 v215, v76
f_c1done:
    s_lshl_b32 s49, s38, 3
    s_add_u32 s49, s49, s3
    s_mul_i32 s49, s49, 1152
    s_cmp_lt_u32 s41, 162
    s_cbranch_scc0 f_other
    s_mov_b32 s47, 0xffff0000
    s_cmp_lt_u32 s41, 54
    v_lshrrev_b32 v2, 3, v1
    v_lshlrev_b32 v2, 2, v2
    s_waitcnt vmcnt(8)
    s_cbranch_scc1 gw_5
    s_waitcnt vmcnt(7)
gw_5:
    v_mul_f32 v72, 0xbfb8aa3b, v44
    v_exp_f32 v72, v72
    s_nop 0
    v_add_f32 v72, 1.0, v72
    v_rcp_f32 v72, v72
    s_nop 0
    v_mul_f32 v44, v44, v72
    v_cvt_pk_bf16_f32 v44, v44, v44
    v_lshlrev_b32 v44, 16, v44
    ds_bpermute_b32 v45, v2, v44 offset:32
    ds_bpermute_b32 v46, v2, v44 offset:64
    ds_bpermute_b32 v44, v2, v44 offset:0
    s_waitcnt vmcnt(7)
    s_cbranch_scc1 gw_6
    s_waitcnt vmcnt(6)
gw_6:
    v_lshlrev_b32 v72, 16, v48
    v_and_b32 v73, s47, v48
    v_lshlrev_b32 v74, 16, v49
    v_and_b32 v75, s47, v49
    v_lshlrev_b32 v76, 16, v50
    v_and_b32 v77, s47, v50
    v_lshlrev_b32 v78, 16, v51
    v_and_b32 v79, s47, v51
    s_waitcnt lgkmcnt(0)
    v_pk_mul_f32 v[60:61], v[72:73], v[44:45] op_sel_hi:[1,0]
    v_pk_mul_f32 v[62:63], v[74:75], v[44:45] op_sel_hi:[1,0]
    v_pk_mul_f32 v[64:65], v[76:77], v[44:45] op_sel_hi:[1,0]
    v_pk_mul_f32 v[66:67], v[78:79], v[44:45] op_sel_hi:[1,0]
    s_waitcnt vmcnt(6)
    s_cbranch_scc1 gw_7
    s_waitcnt vmcnt(5)
gw_7:
    v_lshlrev_b32 v72, 16, v52
    v_and_b32 v73, s47, v52
    v_lshlrev_b32 v74, 16, v53
    v_and_b32 v75, s47, v53
    v_lshlrev_b32 v76, 16, v54
    v_and_b32 v77, s47, v54
    v_lshlrev_b32 v78, 16, v55
    v_and_b32 v79, s47, v55
    v_pk_fma_f32 v[60:61], v[72:73], v[44:45], v[60:61] op_sel:[0,1,0]
    v_pk_fma_f32 v[62:63], v[74:75], v[44:45], v[62:63] op_sel:[0,1,0]
    v_pk_fma_f32 v[64:65], v[76:77], v[44:45], v[64:65] op_sel:[0,1,0]
    v_pk_fma_f32 v[66:67], v[78:79], v[44:45], v[66:67] op_sel:[0,1,0]
    s_waitcnt vmcnt(5)
    s_cbranch_scc1 gw_8
    s_waitcnt vmcnt(4)
gw_8:
    v_lshlrev_b32 v72, 16, v56
    v_and_b32 v73, s47, v56
    v_lshlrev_b32 v74, 16, v57
    v_and_b32 v75, s47, v57
    v_lshlrev_b32 v76, 16, v58
    v_and_b32 v77, s47, v58
    v_lshlrev_b32 v78, 16, v59
    v_and_b32 v79, s47, v59
    v_pk_fma_f32 v[60:61], v[72:73], v[46:47], v[60:61] op_sel_hi:[1,0,1]
    v_pk_fma_f32 v[62:63], v[74:75], v[46:47], v[62:63] op_sel_hi:[1,0,1]
    v_pk_fma_f32 v[64:65], v[76:77], v[46:47], v[64:65] op_sel_hi:[1,0,1]
    v_pk_fma_f32 v[66:67], v[78:79], v[46:47], v[66:67] op_sel_hi:[1,0,1]
    v_permlane16_swap_b32 v60, v61
    v_permlane16_swap_b32 v62, v63
    v_permlane16_swap_b32 v64, v65
    v_permlane16_swap_b32 v66, v67
    v_add_f32 v60, v60, v61
    v_add_f32 v62, v62, v63
    v_add_f32 v64, v64, v65
    v_add_f32 v66, v66, v67
    v_permlane32_swap_b32 v60, v62
    s_nop 0
    v_permlane32_swap_b32 v64, v66
    v_add_f32 v60, v60, v62
    v_add_f32 v64, v64, v66
    s_nop 0
    v_add_f32_dpp v60, v60, v60 row_ror:8 row_mask:0xf bank_mask:0xf
    v_add_f32_dpp v64, v64, v64 row_ror:8 row_mask:0xf bank_mask:0xf
    v_cmp_lt_u32 vcc, 7, v5
    s_nop 1
    v_cndmask_b32 v60, v60, v64, vcc
    v_and_b32 v2, 7, v5
    v_lshrrev_b32 v3, 3, v5
    v_lshl_add_u32 v2, v2, 1, v3
    v_lshl_add_u32 v2, v2, 2, v6
    s_lshl_b32 s50, s3, 8
    s_add_u32 s50, s50, 4608
    v_lshl_add_u32 v2, v2, 2, s50
    ds_write_b32 v2, v60
    s_cmp_lt_u32 s41, 54
    s_cbranch_scc0 f_other
    s_waitcnt lgkmcnt(0)
    s_barrier
    s_cmp_eq_u32 s3, 7
    s_cbranch_scc0 f_noposta
    ds_read2st64_b32 v[60:61], v125 offset0:18 offset1:19
    ds_read2st64_b32 v[62:63], v125 offset0:20 offset1:21
    ds_read2st64_b32 v[64:65], v125 offset0:22 offset1:23
    ds_read2st64_b32 v[66:67], v125 offset0:24 offset1:25
    v_lshlrev_b32 v2, 3, v1
    s_waitcnt lgkmcnt(0)
    v_pk_add_f32 v[60:61], v[60:61], v[62:63]
    v_pk_add_f32 v[64:65], v[64:65], v[66:67]
    v_pk_add_f32 v[60:61], v[60:61], v[64:65]
    v_add_f32 v60, v60, v61
    v_mov_b32 v61, s59
    buffer_store_dwordx2 v[60:61], v2, s[28:31], s48 offen sc1
    s_waitcnt vmcnt(4)
    s_branch f_ln
f_noposta:
    s_waitcnt vmcnt(3)
    s_branch f_ln
f_other:
    s_waitcnt vmcnt(6)
    s_cmp_lt_u32 s2, 176
    s_cbranch_scc0 f_poi1
    s_waitcnt vmcnt(2)
    s_branch f_ln
f_poi1:
    s_cmp_eq_u32 s3, 7
    s_cbranch_scc0 f_ln
    buffer_load_dword v99, off, s[24:27], 0 offset:252 sc1
f_ln:
    v_lshlrev_b32 v2, 1, v1
    s_add_u32 s50, s55, 9728
    v_add_u32 v2, s50, v2
    ds_read_u16_d16_hi v8, v2 offset:0
    ds_read_u16_d16_hi v9, v2 offset:128
    ds_read_u16_d16_hi v10, v2 offset:256
    ds_read_u16_d16_hi v11, v2 offset:384
    ds_read_u16_d16_hi v12, v2 offset:512
    ds_read_u16_d16_hi v13, v2 offset:640
    ds_read_u16_d16_hi v14, v2 offset:768
    ds_read_u16_d16_hi v15, v2 offset:896
    ds_read_u16_d16_hi v16, v2 offset:1024
    s_waitcnt lgkmcnt(0)
    v_add_f32 v80, v8, v9
    v_add_f32 v80, v80, v10
    v_add_f32 v80, v80, v11
    v_add_f32 v80, v80, v12
    v_add_f32 v80, v80, v13
    v_add_f32 v80, v80, v14
    v_add_f32 v80, v80, v15
    v_add_f32 v80, v80, v16
    s_nop 1
    v_add_f32_dpp v80, v80, v80 quad_perm:[1,0,3,2] row_mask:0xf bank_mask:0xf
    s_nop 1
    v_add_f32_dpp v80, v80, v80 quad_perm:[2,3,0,1] row_mask:0xf bank_mask:0xf
    s_nop 1
    v_add_f32_dpp v80, v80, v80 row_half_mirror row_mask:0xf bank_mask:0xf
    s_nop 1
    v_add_f32_dpp v80, v80, v80 row_mirror row_mask:0xf bank_mask:0xf
    v_mov_b32 v72, v80
    s_nop 1
    v_permlane16_swap_b32 v80, v72
    v_add_f32 v80, v80, v72
    v_mov_b32 v72, v80
    s_nop 1
    v_permlane32_swap_b32 v80, v72
    v_add_f32 v80, v80, v72
    v_mul_f32 v80, 0x3ae38e39, v80
    v_sub_f32 v8, v8, v80
    v_sub_f32 v9, v9, v80
    v_sub_f32 v10, v10, v80
    v_sub_f32 v11, v11, v80
    v_sub_f32 v12, v12, v80
    v_sub_f32 v13, v13, v80
    v_sub_f32 v14, v14, v80
    v_sub_f32 v15, v15, v80
    v_sub_f32 v16, v16, v80
    v_mul_f32 v81, v8, v8
    v_fmac_f32 v81, v9, v9
    v_fmac_f32 v81, v10, v10
    v_fmac_f32 v81, v11, v11
    v_fmac_f32 v81, v12, v12
    v_fmac_f32 v81, v13, v13
    v_fmac_f32 v81, v14, v14
    v_fmac_f32 v81, v15, v15
    v_fmac_f32 v81, v16, v16
    s_nop 1
    v_add_f32_dpp v81, v81, v81 quad_perm:[1,0,3,2] row_mask:0xf bank_mask:0xf
    s_nop 1
    v_add_f32_dpp v81, v81, v81 quad_perm:[2,3,0,1] row_mask:0xf bank_mask:0xf
    s_nop 1
    v_add_f32_dpp v81, v81, v81 row_half_mirror row_mask:0xf bank_mask:0xf
    s_nop 1
    v_add_f32_dpp v81, v81, v81 row_mirror row_mask:0xf bank_mask:0xf
    v_mov_b32 v72, v81
    s_nop 1
    v_permlane16_swap_b32 v81, v72
    v_add_f32 v81, v81, v72
    v_mov_b32 v72, v81
    s_nop 1
    v_permlane32_swap_b32 v81, v72
    v_add_f32 v81, v81, v72
    v_mov_b32 v72, 0x3727c5ac
    v_fmamk_f32 v81, v81, 0x3ae38e39, v72
    v_rsq_f32 v81, v81
    s_nop 0
    v_mul_f32 v8, v8, v81
    v_mul_f32 v9, v9, v81
    v_mul_f32 v10, v10, v81
    v_mul_f32 v11, v11, v81
    v_mul_f32 v12, v12, v81
    v_mul_f32 v13, v13, v81
    v_mul_f32 v14, v14, v81
    v_mul_f32 v15, v15, v81
    v_mul_f32 v16, v16, v81
    s_waitcnt vmcnt(2)
    s_cmp_lt_u32 s41, 54
    s_cselect_b32 s50, s3, 8
    s_cmp_eq_u32 s50, 7
    s_cbranch_scc1 f_b0
    s_waitcnt vmcnt(1)
    s_cmp_lt_u32 s50, 8
    s_cbranch_scc1 f_b0
    s_waitcnt vmcnt(0)
f_b0:
    s_waitcnt lgkmcnt(0)
    s_barrier
    s_cmp_lt_u32 s3, 3
    s_cbranch_scc1 f_nozp2
    s_cmp_eq_u32 s3, 7
    s_cbranch_scc0 f_nopostb
    s_cmp_lt_u32 s2, 176
    s_cbranch_scc1 f_nopoi2
    v_readfirstlane_b32 s50, v99
    s_nop 0
    s_cmp_eq_u32 s50, 0
    s_cbranch_scc0 f_tagok
    s_mov_b64 exec, 1
    s_mov_b32 s50, 0
f_an2b:
    buffer_load_dword v99, off, s[24:27], 0 offset:252 sc1
    s_add_u32 s50, s50, 1
    s_waitcnt vmcnt(0)
    v_cmp_eq_u32 vcc, 0, v99
    s_nop 1
    s_cbranch_vccz f_an2b_ok
    s_sleep 2
    s_cmp_lt_u32 s50, 30000
    s_cbranch_scc1 f_an2b
f_an2b_ok:
    s_mov_b64 exec, -1
f_tagok:
    s_lshl_b32 s50, s2, 6
    s_add_u32 s50, s50, 147456
    s_mov_b64 exec, 1
    buffer_store_dword v99, off, s[28:31], s50 sc1
    s_mov_b64 exec, -1
f_nopoi2:
    s_sub_u32 s50, s41, 54
    s_cmp_lt_u32 s50, 108
    s_cbranch_scc0 f_nopostb
    ds_read2st64_b32 v[60:61], v125 offset0:18 offset1:19
    ds_read2st64_b32 v[62:63], v125 offset0:20 offset1:21
    ds_read2st64_b32 v[64:65], v125 offset0:22 offset1:23
    ds_read2st64_b32 v[66:67], v125 offset0:24 offset1:25
    v_lshlrev_b32 v2, 3, v1
    s_waitcnt lgkmcnt(0)
    v_pk_add_f32 v[60:61], v[60:61], v[62:63]
    v_pk_add_f32 v[64:65], v[64:65], v[66:67]
    v_pk_add_f32 v[60:61], v[60:61], v[64:65]
    v_add_f32 v60, v60, v61
    buffer_store_dword v60, v125, s[28:31], s48 offen sc1
f_nopostb:
    v_subrev_u32 v4, 192, v0
    v_lshlrev_b32 v3, 4, v4
    s_mul_i32 s50, s2, 9344
    s_add_u32 s50, s50, 1048576
    s_add_u32 s51, s50, 5120
    v_and_b32 v2, 1, v0
    v_mul_u32_u24 v2, 577, v2
    v_add_u32 v2, v2, v4
    s_lshr_b32 s46, s2, 6
    s_lshl_b32 s46, s46, 2
    s_add_u32 s46, s46, 65536
    v_add_u32 v2, s46, v2
    ds_read_u16 v28, v2 offset:0
    ds_read_u16 v32, v2 offset:20480
    ds_read_u16 v29, v2 offset:5120
    ds_read_u16 v33, v2 offset:25600
    ds_read_u16 v30, v2 offset:10240
    ds_read_u16 v34, v2 offset:30720
    ds_read_u16 v31, v2 offset:15360
    ds_read_u16 v35, v2 offset:35840
    ds_read_u16 v36, v2 offset:320
    ds_read_u16 v40, v2 offset:20800
    ds_read_u16 v37, v2 offset:5440
    ds_read_u16 v41, v2 offset:25920
    ds_read_u16 v38, v2 offset:10560
    ds_read_u16 v42, v2 offset:31040
    ds_read_u16 v39, v2 offset:15680
    ds_read_u16 v43, v2 offset:36160
    v_cmp_gt_u32 vcc, 264, v4
    v_mov_b32 v4, 0x7f000000
    s_nop 0
    v_cndmask_b32 v4, v4, v3, vcc
    s_waitcnt lgkmcnt(8)
    v_lshl_or_b32 v28, v32, 16, v28
    v_lshl_or_b32 v29, v33, 16, v29
    v_lshl_or_b32 v30, v34, 16, v30
    v_lshl_or_b32 v31, v35, 16, v31
    buffer_store_dwordx4 v[28:31], v3, s[28:31], s50 offen sc1
    s_waitcnt lgkmcnt(0)
    v_lshl_or_b32 v36, v40, 16, v36
    v_lshl_or_b32 v37, v41, 16, v37
    v_lshl_or_b32 v38, v42, 16, v38
    v_lshl_or_b32 v39, v43, 16, v39
    buffer_store_dwordx4 v[36:39], v4, s[28:31], s51 offen sc1
    s_cmp_lt_u32 s3, 4
    s_cbranch_scc1 f_nozp2
    s_lshl_b32 s51, s39, 11
    s_add_u32 s51, s51, 7340032
    s_lshl_b32 s50, s53, 13
    s_add_u32 s50, s50, s51
    buffer_store_dwordx4 v[68:71], v109, s[28:31], s50 offen offset:0 sc1
    buffer_store_dwordx4 v[68:71], v109, s[28:31], s50 offen offset:1024 sc1
    s_cmp_lt_u32 s2, 33
    s_cbranch_scc0 f_nozp2
    s_lshl_b32 s50, s54, 13
    s_add_u32 s50, s50, s51
    buffer_store_dwordx4 v[68:71], v109, s[28:31], s50 offen offset:0 sc1
    buffer_store_dwordx4 v[68:71], v109, s[28:31], s50 offen offset:1024 sc1
f_nozp2:
    s_cmp_lt_u32 s41, 54
    s_cbranch_scc0 f_c1done2
    v_cvt_f32_u32 v84, v7
    v_cvt_f32_u32 v85, v6
    v_mul_f32 v86, v85, v84
    v_mul_f32 v86, 0x3d800000, v86
    v_fmamk_f32 v72, v84, 0x00000000, v86
    v_cos_f32 v73, v72
    v_sin_f32 v74, v72
    v_fmamk_f32 v75, v84, 0x3c800000, v86
    v_cos_f32 v76, v75
    v_sin_f32 v77, v75
    v_cvt_pk_bf16_f32 v128, v73, v74
    v_cvt_pk_bf16_f32 v144, -v74, v73
    v_fmamk_f32 v72, v84, 0x3d000000, v86
    v_cos_f32 v73, v72
    v_sin_f32 v74, v72
    v_cvt_pk_bf16_f32 v129, v76, v77
    v_cvt_pk_bf16_f32 v145, -v77, v76
    v_fmamk_f32 v75, v84, 0x3d400000, v86
    v_cos_f32 v76, v75
    v_sin_f32 v77, v75
    v_cvt_pk_bf16_f32 v130, v73, v74
    v_cvt_pk_bf16_f32 v146, -v74, v73
    v_fmamk_f32 v72, v84, 0x3e800000, v86
    v_cos_f32 v73, v72
    v_sin_f32 v74, v72
    v_cvt_pk_bf16_f32 v131, v76, v77
    v_cvt_pk_bf16_f32 v147, -v77, v76
    v_fmamk_f32 v75, v84, 0x3e880000, v86
    v_cos_f32 v76, v75
    v_sin_f32 v77, v75
    v_cvt_pk_bf16_f32 v132, v73, v74
    v_cvt_pk_bf16_f32 v148, -v74, v73
    v_fmamk_f32 v72, v84, 0x3e900000, v86
    v_cos_f32 v73, v72
    v_sin_f32 v74, v72
    v_cvt_pk_bf16_f32 v133, v76, v77
    v_cvt_pk_bf16_f32 v149, -v77, v76
    v_fmamk_f32 v75, v84, 0x3e980000, v86
    v_cos_f32 v76, v75
    v_sin_f32 v77, v75
    v_cvt_pk_bf16_f32 v134, v73, v74
    v_cvt_pk_bf16_f32 v150, -v74, v73
    v_fmamk_f32 v72, v84, 0x3f000000, v86
    v_cos_f32 v73, v72
    v_sin_f32 v74, v72
    v_cvt_pk_bf16_f32 v135, v76, v77
    v_cvt_pk_bf16_f32 v151, -v77, v76
    v_fmamk_f32 v75, v84, 0x3f040000, v86
    v_cos_f32 v76, v75
    v_sin_f32 v77, v75
    v_cvt_pk_bf16_f32 v136, v73, v74
    v_cvt_pk_bf16_f32 v152, -v74, v73
    v_fmamk_f32 v72, v84, 0x3f080000, v86
    v_cos_f32 v73, v72
    v_sin_f32 v74, v72
    v_cvt_pk_bf16_f32 v137, v76, v77
    v_cvt_pk_bf16_f32 v153, -v77, v76
    v_fmamk_f32 v75, v84, 0x3f0c0000, v86
    v_cos_f32 v76, v75
    v_sin_f32 v77, v75
    v_cvt_pk_bf16_f32 v138, v73, v74
    v_cvt_pk_bf16_f32 v154, -v74, v73
    v_fmamk_f32 v72, v84, 0x3f400000, v86
    v_cos_f32 v73, v72
    v_sin_f32 v74, v72
    v_cvt_pk_bf16_f32 v139, v76, v77
    v_cvt_pk_bf16_f32 v155, -v77, v76
    v_fmamk_f32 v75, v84, 0x3f440000, v86
    v_cos_f32 v76, v75
    v_sin_f32 v77, v75
    v_cvt_pk_bf16_f32 v140, v73, v74
    v_cvt_pk_bf16_f32 v156, -v74, v73
    v_fmamk_f32 v72, v84, 0x3f480000, v86
    v_cos_f32 v73, v72
    v_sin_f32 v74, v72
    v_cvt_pk_bf16_f32 v141, v76, v77
    v_cvt_pk_bf16_f32 v157, -v77, v76
    v_fmamk_f32 v75, v84, 0x3f4c0000, v86
    v_cos_f32 v76, v75
    v_sin_f32 v77, v75
    v_cvt_pk_bf16_f32 v142, v73, v74
    v_cvt_pk_bf16_f32 v158, -v74, v73
    v_cvt_pk_bf16_f32 v143, v76, v77
    v_cvt_pk_bf16_f32 v159, -v77, v76
    v_cvt_f32_u32 v82, v1
    v_mul_f32 v73, 0x3ae38e39, v82
    v_mul_f32 v74, 0x3b638e39, v82
    v_mul_f32 v75, 0x3baaaaab, v82
    v_mul_f32 v76, 0x3be38e39, v82
    v_cos_f32 v208, v73
    v_sin_f32 v212, v73
    v_cos_f32 v209, v74
    v_sin_f32 v213, v74
    v_cos_f32 v210, v75
    v_sin_f32 v214, v75
    v_cos_f32 v211, v76
    v_sin_f32 v215, v76
f_c1done2:
    s_cmp_lt_u32 s41, 54
    s_cbranch_scc1 f_nosl0
    s_sleep 2
f_nosl0:
    s_cmp_lt_u32 s3, 3
    s_cbranch_scc0 f_staged
    v_mul_u32_u24 v2, 48, v0
    s_mov_b32 s44, 0x20000
    s_mov_b32 s45, 0x22400
    s_mov_b32 s46, 0x24800
    v_cmp_lt_u32 vcc, 95, v0
    s_nop 1
    v_cndmask_b32 v3, 0, 1.0, vcc
    s_mov_b32 s47, 0xffff0000
    v_lshrrev_b32 v78, 9, v2
    v_add_u32 v79, 32, v2
    v_lshrrev_b32 v79, 9, v79
    v_add_u32 v80, 16, v2
    v_lshrrev_b32 v80, 9, v80
    v_cmp_ne_u32 s[50:51], v80, v78
    v_mul_u32_u24 v78, 12, v78
    v_mul_u32_u24 v79, 12, v79
    s_mov_b32 s43, 0
    buffer_load_dword v67, off, s[24:27], 0 offset:252
    buffer_load_dwordx3 v[64:66], v78, s[24:27], 0 offen
    buffer_load_dwordx3 v[68:70], v79, s[24:27], 0 offen
    buffer_load_dwordx4 v[28:31], v2, s[28:31], s44 offen offset:0
    buffer_load_dwordx4 v[32:35], v2, s[28:31], s44 offen offset:16
    buffer_load_dwordx4 v[36:39], v2, s[28:31], s44 offen offset:32
    buffer_load_dwordx4 v[40:43], v2, s[28:31], s45 offen offset:0
    buffer_load_dwordx4 v[44:47], v2, s[28:31], s45 offen offset:16
    buffer_load_dwordx4 v[48:51], v2, s[28:31], s45 offen offset:32
    buffer_load_dwordx4 v[52:55], v2, s[28:31], s46 offen offset:0
    buffer_load_dwordx4 v[56:59], v2, s[28:31], s46 offen offset:16
    buffer_load_dwordx4 v[60:63], v2, s[28:31], s46 offen offset:32
    s_branch f_mp_chk
f_mp:
    buffer_load_dword v67, off, s[24:27], 0 offset:252 sc1
    buffer_load_dwordx3 v[64:66], v78, s[24:27], 0 offen sc1
    buffer_load_dwordx3 v[68:70], v79, s[24:27], 0 offen sc1
    buffer_load_dwordx4 v[28:31], v2, s[28:31], s44 offen offset:0 sc1
    buffer_load_dwordx4 v[32:35], v2, s[28:31], s44 offen offset:16 sc1
    buffer_load_dwordx4 v[36:39], v2, s[28:31], s44 offen offset:32 sc1
    buffer_load_dwordx4 v[40:43], v2, s[28:31], s45 offen offset:0 sc1
    buffer_load_dwordx4 v[44:47], v2, s[28:31], s45 offen offset:16 sc1
    buffer_load_dwordx4 v[48:51], v2, s[28:31], s45 offen offset:32 sc1
    buffer_load_dwordx4 v[52:55], v2, s[28:31], s46 offen offset:0 sc1
    buffer_load_dwordx4 v[56:59], v2, s[28:31], s46 offen offset:16 sc1
    buffer_load_dwordx4 v[60:63], v2, s[28:31], s46 offen offset:32 sc1
f_mp_chk:
    s_add_u32 s43, s43, 1
    s_waitcnt vmcnt(9)
    v_cndmask_b32 v74, v64, v68, s[50:51]
    v_cndmask_b32 v75, v65, v69, s[50:51]
    v_cndmask_b32 v76, v66, v70, s[50:51]
    v_min3_u32 v72, v64, v65, v66
    v_min3_u32 v73, v68, v69, v70
    v_min3_u32 v72, v72, v73, v67
    v_cmp_eq_u32 s[58:59], 0, v72
    s_waitcnt vmcnt(6)
    v_xor_b32 v72, v29, v64
    v_xor_b32 v73, v31, v64
    v_bitop3_b32 v72, v33, v74, v72 bitop3:0xbe
    v_bitop3_b32 v73, v35, v74, v73 bitop3:0xbe
    v_bitop3_b32 v72, v37, v68, v72 bitop3:0xbe
    v_bitop3_b32 v73, v39, v68, v73 bitop3:0xbe
    s_waitcnt vmcnt(3)
    v_bitop3_b32 v72, v41, v65, v72 bitop3:0xbe
    v_bitop3_b32 v73, v43, v65, v73 bitop3:0xbe
    v_bitop3_b32 v72, v45, v75, v72 bitop3:0xbe
    v_bitop3_b32 v73, v47, v75, v73 bitop3:0xbe
    v_bitop3_b32 v72, v49, v69, v72 bitop3:0xbe
    v_bitop3_b32 v73, v51, v69, v73 bitop3:0xbe
    s_waitcnt vmcnt(0)
    v_bitop3_b32 v72, v53, v66, v72 bitop3:0xbe
    v_bitop3_b32 v73, v55, v66, v73 bitop3:0xbe
    v_bitop3_b32 v72, v57, v76, v72 bitop3:0xbe
    v_bitop3_b32 v73, v59, v76, v73 bitop3:0xbe
    v_bitop3_b32 v72, v61, v70, v72 bitop3:0xbe
    v_bitop3_b32 v73, v63, v70, v73 bitop3:0xbe
    v_or_b32 v72, v72, v73
    v_cmp_ne_u32 vcc, 0, v72
    s_nop 0
    s_or_b64 exec, vcc, s[58:59]
    s_cbranch_scc0 f_mp_ok
    s_cmp_lt_u32 s43, 30000
    s_cbranch_scc1 f_mp
f_mp_ok:
    s_mov_b64 exec, -1
    s_mov_b32 s50, s43
    v_readfirstlane_b32 s26, v67
    v_lshrrev_b32 v2, 1, v2
    v_add_f32 v74, v28, v40
    v_add_f32 v75, v30, v42
    v_add_f32 v76, v32, v44
    v_add_f32 v77, v34, v46
    v_add_f32 v78, v36, v48
    v_add_f32 v79, v38, v50
    v_add_f32 v74, v74, v52
    v_add_f32 v75, v75, v54
    v_add_f32 v76, v76, v56
    v_add_f32 v77, v77, v58
    v_add_f32 v78, v78, v60
    v_add_f32 v79, v79, v62
    v_cvt_pk_bf16_f32 v72, v74, v75
    v_lshlrev_b32 v74, 16, v72
    v_and_b32 v75, s47, v72
    v_cvt_pk_bf16_f32 v73, v76, v77
    v_lshlrev_b32 v76, 16, v73
    v_and_b32 v77, s47, v73
    v_cvt_pk_bf16_f32 v72, v78, v79
    v_lshlrev_b32 v78, 16, v72
    v_and_b32 v79, s47, v72
    v_add_f32 v74, v74, v3
    v_add_f32 v75, v75, v3
    v_add_f32 v76, v76, v3
    v_add_f32 v77, v77, v3
    v_add_f32 v78, v78, v3
    v_add_f32 v79, v79, v3
    v_cvt_pk_bf16_f32 v72, v74, v75
    v_lshlrev_b32 v74, 16, v72
    v_and_b32 v75, s47, v72
    v_cvt_pk_bf16_f32 v73, v76, v77
    v_lshlrev_b32 v76, 16, v73
    v_and_b32 v77, s47, v73
    v_cvt_pk_bf16_f32 v72, v78, v79
    v_lshlrev_b32 v78, 16, v72
    v_and_b32 v79, s47, v72
    ds_write_b64 v2, v[74:75] offset:0
    ds_write_b64 v2, v[76:77] offset:8
    ds_write_b64 v2, v[78:79] offset:16
f_staged:
    s_load_dwordx2 s[8:9], s[0:1], 48
    s_mov_b32 s10, 0x1200000
    s_load_dwordx2 s[12:13], s[0:1], 56
    s_mov_b32 s14, 0x1000
    s_load_dwordx2 s[16:17], s[0:1], 80
    s_mov_b32 s18, 0x240000
    s_load_dwordx2 s[20:21], s[0:1], 40
    s_mov_b32 s22, 0x2400
    s_waitcnt lgkmcnt(0)
    s_barrier
    s_cmp_eq_u32 s3, 3
    s_cbranch_scc0 f_nofp
    v_lshlrev_b32 v2, 6, v1
    v_min_u32 v3, 960, v2
    s_mov_b32 s51, 158720
    s_mov_b32 s46, 162816
    buffer_load_dword v98, off, s[24:27], 0 offset:252 sc1
    buffer_load_dword v99, v2, s[28:31], s51 offen sc1
    buffer_load_dword v100, v3, s[28:31], s46 offen sc1
f_nofp:
    ds_read2st64_b32 v[36:37], v125 offset0:8 offset1:9
    ds_read2st64_b32 v[38:39], v125 offset0:10 offset1:11
    ds_read2st64_b32 v[40:41], v125 offset0:12 offset1:13
    ds_read2st64_b32 v[42:43], v125 offset0:14 offset1:15
    ds_read2st64_b32 v[44:45], v125 offset0:16 offset1:17
    ds_read2st64_b32 v[28:29], v125 offset0:0 offset1:1
    ds_read2st64_b32 v[30:31], v125 offset0:2 offset1:3
    ds_read2st64_b32 v[32:33], v125 offset0:4 offset1:5
    ds_read2st64_b32 v[34:35], v125 offset0:6 offset1:7
    s_waitcnt lgkmcnt(3)
    v_fma_f32 v8, v8, v37, v28
    v_fma_f32 v9, v9, v38, v29
    s_waitcnt lgkmcnt(2)
    v_fma_f32 v10, v10, v39, v30
    v_fma_f32 v11, v11, v40, v31
    s_waitcnt lgkmcnt(1)
    v_fma_f32 v12, v12, v41, v32
    v_fma_f32 v13, v13, v42, v33
    s_waitcnt lgkmcnt(0)
    v_fma_f32 v14, v14, v43, v34
    v_fma_f32 v15, v15, v44, v35
    v_fma_f32 v16, v16, v45, v36
    v_add_f32 v48, v9, v16
    v_sub_f32 v52, v9, v16
    v_add_f32 v49, v10, v15
    v_sub_f32 v53, v10, v15
    v_add_f32 v50, v11, v14
    v_sub_f32 v54, v11, v14
    v_add_f32 v51, v12, v13
    v_sub_f32 v55, v12, v13
    v_add_f32 v64, v8, v48
    v_add_f32 v65, v49, v50
    v_add_f32 v64, v64, v51
    v_add_f32 v64, v64, v65
    v_fmamk_f32 v56, v48, 0x3f441b7d, v8
    v_fmamk_f32 v57, v48, 0x3e31d0d4, v8
    v_fmamk_f32 v58, v48, 0xbf000000, v8
    v_fmamk_f32 v59, v48, 0xbf708fb2, v8
    v_fmamk_f32 v56, v49, 0x3e31d0d4, v56
    v_fmamk_f32 v57, v49, 0xbf708fb2, v57
    v_fmamk_f32 v58, v49, 0xbf000000, v58
    v_fmamk_f32 v59, v49, 0x3f441b7d, v59
    v_fmamk_f32 v56, v50, 0xbf000000, v56
    v_fmamk_f32 v57, v50, 0xbf000000, v57
    v_fmamk_f32 v58, v50, 0x3f800000, v58
    v_fmamk_f32 v59, v50, 0xbf000000, v59
    v_fmamk_f32 v56, v51, 0xbf708fb2, v56
    v_fmamk_f32 v57, v51, 0x3f441b7d, v57
    v_fmamk_f32 v58, v51, 0xbf000000, v58
    v_fmamk_f32 v59, v51, 0x3e31d0d4, v59
    v_mul_f32 v60, 0xbf248dbb, v52
    v_mul_f32 v61, 0xbf7c1c5c, v52
    v_mul_f32 v62, 0xbf5db3d7, v52
    v_mul_f32 v63, 0xbeaf1d44, v52
    v_fmamk_f32 v60, v53, 0xbf7c1c5c, v60
    v_fmamk_f32 v61, v53, 0xbeaf1d44, v61
    v_fmamk_f32 v62, v53, 0x3f5db3d7, v62
    v_fmamk_f32 v63, v53, 0x3f248dbb, v63
    v_fmamk_f32 v60, v54, 0xbf5db3d7, v60
    v_fmamk_f32 v61, v54, 0x3f5db3d7, v61
    v_fmamk_f32 v63, v54, 0xbf5db3d7, v63
    v_fmamk_f32 v60, v55, 0xbeaf1d44, v60
    v_fmamk_f32 v61, v55, 0x3f248dbb, v61
    v_fmamk_f32 v62, v55, 0xbf5db3d7, v62
    v_fmamk_f32 v63, v55, 0x3f7c1c5c, v63
    v_cvt_pk_bf16_f32 v64, v64, 0
    ds_write_b32 v104, v64
    v_pk_mul_f32 v[68:69], v[56:57], v[208:209]
    v_pk_mul_f32 v[72:73], v[60:61], v[208:209]
    v_pk_mul_f32 v[70:71], v[58:59], v[210:211]
    v_pk_mul_f32 v[74:75], v[62:63], v[210:211]
    v_pk_fma_f32 v[68:69], v[60:61], v[212:213], v[68:69]
    v_pk_fma_f32 v[72:73], v[56:57], v[212:213], v[72:73] neg_lo:[1,0,0] neg_hi:[1,0,0]
    v_pk_fma_f32 v[70:71], v[62:63], v[214:215], v[70:71]
    v_pk_fma_f32 v[74:75], v[58:59], v[214:215], v[74:75] neg_lo:[1,0,0] neg_hi:[1,0,0]
    v_cvt_pk_bf16_f32 v9, v68, v72
    ds_write_b32 v104, v9 offset:2176
    v_cvt_pk_bf16_f32 v10, v69, v73
    ds_write_b32 v104, v10 offset:4352
    v_cvt_pk_bf16_f32 v11, v70, v74
    ds_write_b32 v104, v11 offset:6528
    v_cvt_pk_bf16_f32 v12, v71, v75
    ds_write_b32 v104, v12 offset:8704
    s_cmp_lt_u32 s39, 2
    s_cselect_b32 s47, 0, 0x80000000
    s_waitcnt vmcnt(0) lgkmcnt(0)
    s_cmp_eq_u32 s3, 3
    s_cbranch_scc0 f_pf_ok
    s_mov_b32 s50, 0
f_pf:
    v_xor_b32 v99, v99, v98
    v_bitop3_b32 v99, v100, v98, v99 bitop3:0xbe
    v_cmp_eq_u32 s[58:59], 0, v98
    v_cmp_ne_u32 vcc, 0, v99
    s_nop 0
    s_or_b64 vcc, vcc, s[58:59]
    s_cbranch_scc0 f_pf_got
    s_cmp_lt_u32 s50, 30000
    s_cbranch_scc0 f_pf_got
    v_lshlrev_b32 v2, 6, v1
    v_min_u32 v3, 960, v2
    s_mov_b32 s51, 158720
    s_mov_b32 s46, 162816
    buffer_load_dword v98, off, s[24:27], 0 offset:252 sc1
    buffer_load_dword v99, v2, s[28:31], s51 offen sc1
    buffer_load_dword v100, v3, s[28:31], s46 offen sc1
    s_add_u32 s50, s50, 1
    s_waitcnt vmcnt(0)
    s_branch f_pf
f_pf_got:
    v_readfirstlane_b32 s26, v98
f_pf_ok:
    s_barrier
    ds_read_b128 v[28:31], v105 offset:0
    ds_read_b128 v[32:35], v105 offset:64
    ds_read_b128 v[36:39], v105 offset:128
    ds_read_b128 v[40:43], v105 offset:192
    s_cmp_eq_u32 s40, 1
    s_cbranch_scc1 f_p1_one
    ds_read_b128 v[44:47], v105 offset:4352
    ds_read_b128 v[48:51], v105 offset:4416
    ds_read_b128 v[52:55], v105 offset:4480
    ds_read_b128 v[56:59], v105 offset:4544
    s_waitcnt lgkmcnt(7)
    v_mfma_f32_16x16x32_bf16 v[60:63], v[28:31], v[128:131], 0
    v_mfma_f32_16x16x32_bf16 v[64:67], v[28:31], v[144:147], 0
    s_waitcnt lgkmcnt(6)
    v_mfma_f32_16x16x32_bf16 v[60:63], v[32:35], v[132:135], v[60:63]
    v_mfma_f32_16x16x32_bf16 v[64:67], v[32:35], v[148:151], v[64:67]
    s_waitcnt lgkmcnt(5)
    v_mfma_f32_16x16x32_bf16 v[60:63], v[36:39], v[136:139], v[60:63]
    v_mfma_f32_16x16x32_bf16 v[64:67], v[36:39], v[152:155], v[64:67]
    s_waitcnt lgkmcnt(4)
    v_mfma_f32_16x16x32_bf16 v[60:63], v[40:43], v[140:143], v[60:63]
    v_mfma_f32_16x16x32_bf16 v[64:67], v[40:43], v[156:159], v[64:67]
    s_waitcnt lgkmcnt(3)
    v_mfma_f32_16x16x32_bf16 v[68:71], v[44:47], v[128:131], 0
    v_mfma_f32_16x16x32_bf16 v[72:75], v[44:47], v[144:147], 0
    s_waitcnt lgkmcnt(2)
    v_mfma_f32_16x16x32_bf16 v[68:71], v[48:51], v[132:135], v[68:71]
    v_mfma_f32_16x16x32_bf16 v[72:75], v[48:51], v[148:151], v[72:75]
    s_waitcnt lgkmcnt(1)
    v_mfma_f32_16x16x32_bf16 v[68:71], v[52:55], v[136:139], v[68:71]
    v_mfma_f32_16x16x32_bf16 v[72:75], v[52:55], v[152:155], v[72:75]
    s_waitcnt lgkmcnt(0)
    v_mfma_f32_16x16x32_bf16 v[68:71], v[56:59], v[140:143], v[68:71]
    v_mfma_f32_16x16x32_bf16 v[72:75], v[56:59], v[156:159], v[72:75]
    v_cvt_pk_bf16_f32 v76, v60, v64
    v_cvt_pk_bf16_f32 v77, v61, v65
    v_cvt_pk_bf16_f32 v78, v62, v66
    v_cvt_pk_bf16_f32 v79, v63, v67
    v_xor_b32 v76, s47, v76
    v_xor_b32 v77, s47, v77
    v_xor_b32 v78, s47, v78
    v_xor_b32 v79, s47, v79
    buffer_store_dwordx4 v[76:79], v106, s[28:31], s56 offen sc1
    v_cvt_pk_bf16_f32 v80, v68, v72
    v_cvt_pk_bf16_f32 v81, v69, v73
    v_cvt_pk_bf16_f32 v82, v70, v74
    v_cvt_pk_bf16_f32 v83, v71, v75
    v_xor_b32 v80, s47, v80
    v_xor_b32 v81, s47, v81
    v_xor_b32 v82, s47, v82
    v_xor_b32 v83, s47, v83
    buffer_store_dwordx4 v[80:83], v107, s[28:31], s56 offen sc1
    s_branch f_p1_join
f_p1_one:
    s_waitcnt lgkmcnt(3)
    v_mfma_f32_16x16x32_bf16 v[60:63], v[28:31], v[128:131], 0
    v_mfma_f32_16x16x32_bf16 v[64:67], v[28:31], v[144:147], 0
    s_waitcnt lgkmcnt(2)
    v_mfma_f32_16x16x32_bf16 v[60:63], v[32:35], v[132:135], v[60:63]
    v_mfma_f32_16x16x32_bf16 v[64:67], v[32:35], v[148:151], v[64:67]
    s_waitcnt lgkmcnt(1)
    v_mfma_f32_16x16x32_bf16 v[60:63], v[36:39], v[136:139], v[60:63]
    v_mfma_f32_16x16x32_bf16 v[64:67], v[36:39], v[152:155], v[64:67]
    s_waitcnt lgkmcnt(0)
    v_mfma_f32_16x16x32_bf16 v[60:63], v[40:43], v[140:143], v[60:63]
    v_mfma_f32_16x16x32_bf16 v[64:67], v[40:43], v[156:159], v[64:67]
    s_nop 7
    v_cvt_pk_bf16_f32 v76, v60, v64
    v_cvt_pk_bf16_f32 v77, v61, v65
    v_cvt_pk_bf16_f32 v78, v62, v66
    v_cvt_pk_bf16_f32 v79, v63, v67
    v_xor_b32 v76, s47, v76
    v_xor_b32 v77, s47, v77
    v_xor_b32 v78, s47, v78
    v_xor_b32 v79, s47, v79
    buffer_store_dwordx4 v[76:79], v106, s[28:31], s56 offen sc1
f_p1_join:
    s_cmp_eq_u32 s3, 6
    s_cbranch_scc0 f_nofl
    s_lshl_b32 s50, s2, 10
    s_add_u32 s50, s50, 262144
    buffer_store_dwordx4 v[18:21], v109, s[28:31], s50 offen sc1
f_nofl:
    s_cmp_lt_u32 s38, 64
    s_cbranch_scc0 f_noh2p
    v_mov_b32 v28, -1
    v_mov_b32 v29, -1
    v_mov_b32 v30, -1
    v_mov_b32 v31, -1
    s_mul_i32 s50, s38, 1536
    s_add_u32 s50, s50, 13631488
    buffer_store_dwordx4 v[28:31], v122, s[28:31], s50 offen sc1
    s_cmp_eq_u32 s3, 1
    s_cbranch_scc0 f_noh2p
    buffer_store_dwordx4 v[28:31], v123, s[28:31], s50 offen sc1
f_noh2p:
    s_cmp_eq_u32 s42, -1
    s_cbranch_scc1 f_c3now
    v_cvt_f32_u32 v96, v7
    v_cvt_f32_u32 v97, v6
    v_mul_f32 v98, v97, v96
    v_mul_f32 v98, 0x3d800000, v98
    v_mul_f32 v98, 0x3d000000, v98
    v_fmamk_f32 v84, v96, 0x00000000, v98
    v_fmamk_f32 v85, v96, 0x3a000000, v98
    v_fmamk_f32 v86, v96, 0x3a800000, v98
    v_fmamk_f32 v87, v96, 0x3ac00000, v98
    v_cos_f32 v192, v84
    v_sin_f32 v200, v84
    v_cos_f32 v193, v85
    v_sin_f32 v201, v85
    v_cos_f32 v194, v86
    v_sin_f32 v202, v86
    v_cos_f32 v195, v87
    v_sin_f32 v203, v87
    v_fmamk_f32 v84, v96, 0x3c000000, v98
    v_fmamk_f32 v85, v96, 0x3c080000, v98
    v_fmamk_f32 v86, v96, 0x3c100000, v98
    v_fmamk_f32 v87, v96, 0x3c180000, v98
    v_cos_f32 v196, v84
    v_sin_f32 v204, v84
    v_cos_f32 v197, v85
    v_sin_f32 v205, v85
    v_cos_f32 v198, v86
    v_sin_f32 v206, v86
    v_cos_f32 v199, v87
    v_sin_f32 v207, v87
    v_add_u32 v96, 0, v5
    v_cvt_f32_u32 v96, v96
    v_mul_f32 v98, v97, v96
    v_mul_f32 v98, 0x3e000000, v98
    v_fmamk_f32 v84, v96, 0x00000000, v98
    v_fmamk_f32 v85, v96, 0x3d000000, v98
    v_fmamk_f32 v86, v96, 0x3d800000, v98
    v_fmamk_f32 v87, v96, 0x3dc00000, v98
    v_cos_f32 v88, v84
    v_sin_f32 v92, v84
    v_cos_f32 v89, v85
    v_sin_f32 v93, v85
    v_cos_f32 v90, v86
    v_sin_f32 v94, v86
    v_cos_f32 v91, v87
    v_sin_f32 v95, v87
    v_cvt_pk_bf16_f32 v160, v88, v89
    v_cvt_pk_bf16_f32 v161, v90, v91
    v_cvt_pk_bf16_f32 v178, v88, v89
    v_cvt_pk_bf16_f32 v179, v90, v91
    v_cvt_pk_bf16_f32 v162, v92, v93
    v_cvt_pk_bf16_f32 v163, v94, v95
    v_cvt_pk_bf16_f32 v176, -v92, -v93
    v_cvt_pk_bf16_f32 v177, -v94, -v95
    v_fmamk_f32 v84, v96, 0x3f000000, v98
    v_fmamk_f32 v85, v96, 0x3f080000, v98
    v_fmamk_f32 v86, v96, 0x3f100000, v98
    v_fmamk_f32 v87, v96, 0x3f180000, v98
    v_cos_f32 v88, v84
    v_sin_f32 v92, v84
    v_cos_f32 v89, v85
    v_sin_f32 v93, v85
    v_cos_f32 v90, v86
    v_sin_f32 v94, v86
    v_cos_f32 v91, v87
    v_sin_f32 v95, v87
    v_cvt_pk_bf16_f32 v164, v88, v89
    v_cvt_pk_bf16_f32 v165, v90, v91
    v_cvt_pk_bf16_f32 v182, v88, v89
    v_cvt_pk_bf16_f32 v183, v90, v91
    v_cvt_pk_bf16_f32 v166, v92, v93
    v_cvt_pk_bf16_f32 v167, v94, v95
    v_cvt_pk_bf16_f32 v180, -v92, -v93
    v_cvt_pk_bf16_f32 v181, -v94, -v95
    v_add_u32 v96, 16, v5
    v_cvt_f32_u32 v96, v96
    v_mul_f32 v98, v97, v96
    v_mul_f32 v98, 0x3e000000, v98
    v_fmamk_f32 v84, v96, 0x00000000, v98
    v_fmamk_f32 v85, v96, 0x3d000000, v98
    v_fmamk_f32 v86, v96, 0x3d800000, v98
    v_fmamk_f32 v87, v96, 0x3dc00000, v98
    v_cos_f32 v88, v84
    v_sin_f32 v92, v84
    v_cos_f32 v89, v85
    v_sin_f32 v93, v85
    v_cos_f32 v90, v86
    v_sin_f32 v94, v86
    v_cos_f32 v91, v87
    v_sin_f32 v95, v87
    v_cvt_pk_bf16_f32 v168, v88, v89
    v_cvt_pk_bf16_f32 v169, v90, v91
    v_cvt_pk_bf16_f32 v186, v88, v89
    v_cvt_pk_bf16_f32 v187, v90, v91
    v_cvt_pk_bf16_f32 v170, v92, v93
    v_cvt_pk_bf16_f32 v171, v94, v95
    v_cvt_pk_bf16_f32 v184, -v92, -v93
    v_cvt_pk_bf16_f32 v185, -v94, -v95
    v_fmamk_f32 v84, v96, 0x3f000000, v98
    v_fmamk_f32 v85, v96, 0x3f080000, v98
    v_fmamk_f32 v86, v96, 0x3f100000, v98
    v_fmamk_f32 v87, v96, 0x3f180000, v98
    v_cos_f32 v88, v84
    v_sin_f32 v92, v84
    v_cos_f32 v89, v85
    v_sin_f32 v93, v85
    v_cos_f32 v90, v86
    v_sin_f32 v94, v86
    v_cos_f32 v91, v87
    v_sin_f32 v95, v87
    v_cvt_pk_bf16_f32 v172, v88, v89
    v_cvt_pk_bf16_f32 v173, v90, v91
    v_cvt_pk_bf16_f32 v190, v88, v89
    v_cvt_pk_bf16_f32 v191, v90, v91
    v_cvt_pk_bf16_f32 v174, v92, v93
    v_cvt_pk_bf16_f32 v175, v94, v95
    v_cvt_pk_bf16_f32 v188, -v92, -v93
    v_cvt_pk_bf16_f32 v189, -v94, -v95
    s_branch f_c3done
f_c3now:
    v_cvt_f32_u32 v96, v7
    v_cvt_f32_u32 v97, v6
    v_mul_f32 v97, v97, v96
    v_mul_f32 v97, 0x3d800000, v97
    v_fmamk_f32 v84, v96, 0x00000000, v97
    v_fmamk_f32 v85, v96, 0x3c800000, v97
    v_fmamk_f32 v86, v96, 0x3d000000, v97
    v_fmamk_f32 v87, v96, 0x3d400000, v97
    v_cos_f32 v88, v84
    v_sin_f32 v92, v84
    v_cos_f32 v89, v85
    v_sin_f32 v93, v85
    v_cos_f32 v90, v86
    v_sin_f32 v94, v86
    v_cos_f32 v91, v87
    v_sin_f32 v95, v87
    v_cvt_pk_bf16_f32 v216, v88, v89
    v_cvt_pk_bf16_f32 v217, v90, v91
    v_cvt_pk_bf16_f32 v234, -v88, -v89
    v_cvt_pk_bf16_f32 v235, -v90, -v91
    v_cvt_pk_bf16_f32 v218, v92, v93
    v_cvt_pk_bf16_f32 v219, v94, v95
    v_cvt_pk_bf16_f32 v232, v92, v93
    v_cvt_pk_bf16_f32 v233, v94, v95
    v_fmamk_f32 v84, v96, 0x3e800000, v97
    v_fmamk_f32 v85, v96, 0x3e880000, v97
    v_fmamk_f32 v86, v96, 0x3e900000, v97
    v_fmamk_f32 v87, v96, 0x3e980000, v97
    v_cos_f32 v88, v84
    v_sin_f32 v92, v84
    v_cos_f32 v89, v85
    v_sin_f32 v93, v85
    v_cos_f32 v90, v86
    v_sin_f32 v94, v86
    v_cos_f32 v91, v87
    v_sin_f32 v95, v87
    v_cvt_pk_bf16_f32 v220, v88, v89
    v_cvt_pk_bf16_f32 v221, v90, v91
    v_cvt_pk_bf16_f32 v238, -v88, -v89
    v_cvt_pk_bf16_f32 v239, -v90, -v91
    v_cvt_pk_bf16_f32 v222, v92, v93
    v_cvt_pk_bf16_f32 v223, v94, v95
    v_cvt_pk_bf16_f32 v236, v92, v93
    v_cvt_pk_bf16_f32 v237, v94, v95
    v_fmamk_f32 v84, v96, 0x3f000000, v97
    v_fmamk_f32 v85, v96, 0x3f040000, v97
    v_fmamk_f32 v86, v96, 0x3f080000, v97
    v_fmamk_f32 v87, v96, 0x3f0c0000, v97
    v_cos_f32 v88, v84
    v_sin_f32 v92, v84
    v_cos_f32 v89, v85
    v_sin_f32 v93, v85
    v_cos_f32 v90, v86
    v_sin_f32 v94, v86
    v_cos_f32 v91, v87
    v_sin_f32 v95, v87
    v_cvt_pk_bf16_f32 v224, v88, v89
    v_cvt_pk_bf16_f32 v225, v90, v91
    v_cvt_pk_bf16_f32 v242, v88, v89
    v_cvt_pk_bf16_f32 v243, v90, v91
    v_cvt_pk_bf16_f32 v226, -v92, -v93
    v_cvt_pk_bf16_f32 v227, -v94, -v95
    v_cvt_pk_bf16_f32 v240, v92, v93
    v_cvt_pk_bf16_f32 v241, v94, v95
    v_fmamk_f32 v84, v96, 0x3f400000, v97
    v_fmamk_f32 v85, v96, 0x3f440000, v97
    v_fmamk_f32 v86, v96, 0x3f480000, v97
    v_fmamk_f32 v87, v96, 0x3f4c0000, v97
    v_cos_f32 v88, v84
    v_sin_f32 v92, v84
    v_cos_f32 v89, v85
    v_sin_f32 v93, v85
    v_cos_f32 v90, v86
    v_sin_f32 v94, v86
    v_cos_f32 v91, v87
    v_sin_f32 v95, v87
    v_cvt_pk_bf16_f32 v228, v88, v89
    v_cvt_pk_bf16_f32 v229, v90, v91
    v_cvt_pk_bf16_f32 v246, v88, v89
    v_cvt_pk_bf16_f32 v247, v90, v91
    v_cvt_pk_bf16_f32 v230, -v92, -v93
    v_cvt_pk_bf16_f32 v231, -v94, -v95
    v_cvt_pk_bf16_f32 v244, v92, v93
    v_cvt_pk_bf16_f32 v245, v94, v95
    v_mul_f32 v85, 0x3ae38e39, v96
    v_mul_f32 v86, 0x3b638e39, v96
    v_mul_f32 v87, 0x3baaaaab, v96
    v_mul_f32 v88, 0x3be38e39, v96
    v_cos_f32 v248, v85
    v_sin_f32 v252, v85
    v_cos_f32 v249, v86
    v_sin_f32 v253, v86
    v_cos_f32 v250, v87
    v_sin_f32 v254, v87
    v_cos_f32 v251, v88
    v_sin_f32 v255, v88
    v_mul_f32 v248, 0x35e38e39, v248
    v_mul_f32 v249, 0x35e38e39, v249
    v_mul_f32 v250, 0x35e38e39, v250
    v_mul_f32 v251, 0x35e38e39, v251
    v_mul_f32 v252, 0x35e38e39, v252
    v_mul_f32 v253, 0x35e38e39, v253
    v_mul_f32 v254, 0x35e38e39, v254
    v_mul_f32 v255, 0x35e38e39, v255
f_c3done:
    s_mul_i32 s63, s36, 27
    s_add_u32 s63, s63, s37
    s_mul_i32 s62, s63, 171
    s_lshr_b32 s62, s62, 10
    s_mul_i32 s60, s62, 6
    s_sub_u32 s63, s63, s60
    s_lshl_b32 s60, s62, 8
    s_mul_i32 s61, s39, 147456
    s_add_u32 s60, s60, s61
    s_mul_i32 s61, s63, 393216
    s_mul_i32 s24, s39, 3072
    s_add_u32 s61, s61, s24
    s_add_u32 s61, s61, 13631488
    s_lshl_b32 s24, s39, 12
    s_add_u32 s24, s24, 65536
    v_lshrrev_b32 v2, 4, v1
    v_and_b32 v3, 15, v1
    v_lshlrev_b32 v9, 1, v2
    v_xor_b32 v9, v9, v3
    v_xor_b32 v10, 8, v9
    v_mul_u32_u24 v2, 9216, v2
    v_lshl_add_u32 v9, v9, 4, v2
    v_lshl_add_u32 v10, v10, 4, v2
    v_lshlrev_b32 v14, 4, v1
    v_lshlrev_b32 v15, 2, v1
    s_cmp_eq_u32 s42, -1
    s_cbranch_scc1 f_p2_idle
    s_and_b32 s50, s39, 1
    s_lshl_b32 s50, s50, 4
    s_lshr_b32 s51, s39, 1
    s_add_u32 s50, s50, s51
    s_mul_i32 s50, s50, 81920
    s_lshl_b32 s51, s42, 5
    s_add_u32 s50, s50, s51
    s_add_u32 s44, s50, 4194304
    s_add_u32 s45, s44, 655360
    s_lshl_b32 s50, s3, 11
    s_add_u32 s50, s50, 29952
    v_add_u32 v2, s50, v109
    s_lshl_b32 s50, s40, 13
    s_add_u32 s50, s50, 29952
    v_add_u32 v3, s50, v109
    s_lshr_b32 s50, s42, 6
    s_and_b32 s51, s42, 63
    s_mul_i32 s46, s51, 9
    s_add_u32 s46, s46, s50
    s_sub_u32 s50, 576, s46
    s_cmp_lt_u32 s51, 32
    s_cselect_b32 s46, s46, s50
    s_lshl_b32 s46, s46, 5
    s_mul_i32 s50, s39, 18688
    s_add_u32 s46, s46, s50
    s_add_u32 s46, s46, 1048576
    s_add_u32 s51, s46, 299008
    v_bfe_u32 v4, v1, 3, 1
    v_lshl_add_u32 v4, v6, 3, v4
    v_bfe_u32 v84, v1, 1, 2
    v_lshl_add_u32 v4, v84, 6, v4
    v_mul_u32_u24 v4, 9344, v4
    v_and_b32 v84, 1, v1
    v_lshl_add_u32 v4, v84, 4, v4
    s_lshl_b32 s48, s42, 13
    s_add_u32 s48, s48, 7340032
    s_mov_b32 s47, 0xffff0000
    s_waitcnt vmcnt(0)
    s_mov_b32 s50, 0
f_hb:
    buffer_load_dwordx4 v[28:31], v108, s[28:31], s44 offen sc1
    buffer_load_dwordx4 v[32:35], v108, s[28:31], s45 offen sc1
f_hb_chk:
    s_add_u32 s50, s50, 1
    s_waitcnt vmcnt(0)
    v_max3_u32 v84, v28, v29, v30
    v_max3_u32 v84, v84, v31, v32
    v_max3_u32 v84, v84, v33, v34
    v_max_u32 v84, v84, v35
    v_cmp_eq_u32 vcc, -1, v84
    s_nop 0
    s_and_b64 exec, vcc, vcc
    s_cbranch_scc0 f_hb_ok
    s_cmp_lt_u32 s50, 30000
    s_cbranch_scc1 f_hb
f_hb_ok:
    s_mov_b64 exec, -1
    buffer_load_dwordx4 v[96:99], v4, s[28:31], s46 offen
    buffer_load_dwordx4 v[100:103], v4, s[28:31], s51 offen
    ds_write_b128 v2, v[28:31] offset:0
    ds_write_b128 v2, v[32:35] offset:1024
    s_waitcnt lgkmcnt(0)
    s_barrier
    s_add_u32 m0, s55, 0
    s_nop 0
    buffer_load_dwordx4 v109, s[4:7], s49 offen lds
    s_mov_b64 exec, 0xff
    buffer_load_dwordx4 v109, s[4:7], s49 offen offset:1024 lds
    s_mov_b64 exec, -1
    ds_read_b128 v[28:31], v3 offset:0
    ds_read_b128 v[44:47], v3 offset:4096
    ds_read_b128 v[32:35], v3 offset:1024
    ds_read_b128 v[48:51], v3 offset:5120
    ds_read_b128 v[36:39], v3 offset:2048
    ds_read_b128 v[52:55], v3 offset:6144
    ds_read_b128 v[40:43], v3 offset:3072
    ds_read_b128 v[56:59], v3 offset:7168
    s_waitcnt lgkmcnt(7)
    v_mfma_f32_16x16x32_bf16 v[60:63], v[28:31], v[128:131], 0
    v_mfma_f32_16x16x32_bf16 v[64:67], v[28:31], v[144:147], 0
    s_waitcnt lgkmcnt(6)
    v_mfma_f32_16x16x32_bf16 v[68:71], v[44:47], v[128:131], 0
    v_mfma_f32_16x16x32_bf16 v[72:75], v[44:47], v[144:147], 0
    s_waitcnt lgkmcnt(5)
    v_mfma_f32_16x16x32_bf16 v[60:63], v[32:35], v[132:135], v[60:63]
    v_mfma_f32_16x16x32_bf16 v[64:67], v[32:35], v[148:151], v[64:67]
    s_waitcnt lgkmcnt(4)
    v_mfma_f32_16x16x32_bf16 v[68:71], v[48:51], v[132:135], v[68:71]
    v_mfma_f32_16x16x32_bf16 v[72:75], v[48:51], v[148:151], v[72:75]
    s_waitcnt lgkmcnt(3)
    v_mfma_f32_16x16x32_bf16 v[60:63], v[36:39], v[136:139], v[60:63]
    v_mfma_f32_16x16x32_bf16 v[64:67], v[36:39], v[152:155], v[64:67]
    s_waitcnt lgkmcnt(2)
    v_mfma_f32_16x16x32_bf16 v[68:71], v[52:55], v[136:139], v[68:71]
    v_mfma_f32_16x16x32_bf16 v[72:75], v[52:55], v[152:155], v[72:75]
    s_waitcnt lgkmcnt(1)
    v_mfma_f32_16x16x32_bf16 v[60:63], v[40:43], v[140:143], v[60:63]
    v_mfma_f32_16x16x32_bf16 v[64:67], v[40:43], v[156:159], v[64:67]
    s_waitcnt lgkmcnt(0)
    v_mfma_f32_16x16x32_bf16 v[68:71], v[56:59], v[140:143], v[68:71]
    v_mfma_f32_16x16x32_bf16 v[72:75], v[56:59], v[156:159], v[72:75]
    s_nop 3
    v_pk_mul_f32 v[84:85], v[60:61], v[192:193]
    v_pk_mul_f32 v[88:89], v[64:65], v[192:193]
    v_pk_mul_f32 v[86:87], v[62:63], v[194:195]
    v_pk_mul_f32 v[90:91], v[66:67], v[194:195]
    v_pk_fma_f32 v[84:85], v[64:65], v[200:201], v[84:85]
    v_pk_fma_f32 v[88:89], v[60:61], v[200:201], v[88:89] neg_lo:[1,0,0] neg_hi:[1,0,0]
    v_pk_fma_f32 v[86:87], v[66:67], v[202:203], v[86:87]
    v_pk_fma_f32 v[90:91], v[62:63], v[202:203], v[90:91] neg_lo:[1,0,0] neg_hi:[1,0,0]
    v_cvt_pk_bf16_f32 v76, v84, v85
    v_cvt_pk_bf16_f32 v77, v86, v87
    v_cvt_pk_bf16_f32 v78, v88, v89
    v_cvt_pk_bf16_f32 v79, v90, v91
    v_pk_mul_f32 v[84:85], v[68:69], v[196:197]
    v_pk_mul_f32 v[88:89], v[72:73], v[196:197]
    v_pk_mul_f32 v[86:87], v[70:71], v[198:199]
    v_pk_mul_f32 v[90:91], v[74:75], v[198:199]
    v_pk_fma_f32 v[84:85], v[72:73], v[204:205], v[84:85]
    v_pk_fma_f32 v[88:89], v[68:69], v[204:205], v[88:89] neg_lo:[1,0,0] neg_hi:[1,0,0]
    v_pk_fma_f32 v[86:87], v[74:75], v[206:207], v[86:87]
    v_pk_fma_f32 v[90:91], v[70:71], v[206:207], v[90:91] neg_lo:[1,0,0] neg_hi:[1,0,0]
    v_cvt_pk_bf16_f32 v80, v84, v85
    v_cvt_pk_bf16_f32 v81, v86, v87
    v_cvt_pk_bf16_f32 v82, v88, v89
    v_cvt_pk_bf16_f32 v83, v90, v91
    v_mfma_f32_16x16x32_bf16 v[60:63], v[160:163], v[76:79], 0
    v_mfma_f32_16x16x32_bf16 v[64:67], v[176:179], v[76:79], 0
    v_mfma_f32_16x16x32_bf16 v[68:71], v[168:171], v[76:79], 0
    v_mfma_f32_16x16x32_bf16 v[72:75], v[184:187], v[76:79], 0
    v_mfma_f32_16x16x32_bf16 v[60:63], v[164:167], v[80:83], v[60:63]
    v_mfma_f32_16x16x32_bf16 v[64:67], v[180:183], v[80:83], v[64:67]
    v_mfma_f32_16x16x32_bf16 v[68:71], v[172:175], v[80:83], v[68:71]
    v_mfma_f32_16x16x32_bf16 v[72:75], v[188:191], v[80:83], v[72:75]
    s_waitcnt vmcnt(2)
    v_lshlrev_b32 v28, 16, v96
    v_and_b32 v36, s47, v96
    v_lshlrev_b32 v29, 16, v97
    v_and_b32 v37, s47, v97
    v_lshlrev_b32 v30, 16, v98
    v_and_b32 v38, s47, v98
    v_lshlrev_b32 v31, 16, v99
    v_and_b32 v39, s47, v99
    v_lshlrev_b32 v32, 16, v100
    v_and_b32 v40, s47, v100
    v_lshlrev_b32 v33, 16, v101
    v_and_b32 v41, s47, v101
    v_lshlrev_b32 v34, 16, v102
    v_and_b32 v42, s47, v102
    v_lshlrev_b32 v35, 16, v103
    v_and_b32 v43, s47, v103
    v_pk_mul_f32 v[84:85], v[60:61], v[28:29]
    v_pk_mul_f32 v[88:89], v[64:65], v[28:29] neg_lo:[1,0] neg_hi:[1,0]
    v_pk_mul_f32 v[86:87], v[62:63], v[30:31]
    v_pk_mul_f32 v[90:91], v[66:67], v[30:31] neg_lo:[1,0] neg_hi:[1,0]
    v_pk_fma_f32 v[84:85], v[64:65], v[36:37], v[84:85] neg_lo:[1,0,0] neg_hi:[1,0,0]
    v_pk_fma_f32 v[88:89], v[60:61], v[36:37], v[88:89] neg_lo:[1,0,0] neg_hi:[1,0,0]
    v_pk_fma_f32 v[86:87], v[66:67], v[38:39], v[86:87] neg_lo:[1,0,0] neg_hi:[1,0,0]
    v_pk_fma_f32 v[90:91], v[62:63], v[38:39], v[90:91] neg_lo:[1,0,0] neg_hi:[1,0,0]
    v_cvt_pk_bf16_f32 v76, v84, v85
    v_cvt_pk_bf16_f32 v77, v86, v87
    v_cvt_pk_bf16_f32 v78, v88, v89
    v_cvt_pk_bf16_f32 v79, v90, v91
    v_pk_mul_f32 v[84:85], v[68:69], v[32:33]
    v_pk_mul_f32 v[88:89], v[72:73], v[32:33] neg_lo:[1,0] neg_hi:[1,0]
    v_pk_mul_f32 v[86:87], v[70:71], v[34:35]
    v_pk_mul_f32 v[90:91], v[74:75], v[34:35] neg_lo:[1,0] neg_hi:[1,0]
    v_pk_fma_f32 v[84:85], v[72:73], v[40:41], v[84:85] neg_lo:[1,0,0] neg_hi:[1,0,0]
    v_pk_fma_f32 v[88:89], v[68:69], v[40:41], v[88:89] neg_lo:[1,0,0] neg_hi:[1,0,0]
    v_pk_fma_f32 v[86:87], v[74:75], v[42:43], v[86:87] neg_lo:[1,0,0] neg_hi:[1,0,0]
    v_pk_fma_f32 v[90:91], v[70:71], v[42:43], v[90:91] neg_lo:[1,0,0] neg_hi:[1,0,0]
    v_cvt_pk_bf16_f32 v80, v84, v85
    v_cvt_pk_bf16_f32 v81, v86, v87
    v_cvt_pk_bf16_f32 v82, v88, v89
    v_cvt_pk_bf16_f32 v83, v90, v91
    v_mfma_f32_16x16x32_bf16 v[60:63], v[160:163], v[76:79], 0
    v_mfma_f32_16x16x32_bf16 v[64:67], v[176:179], v[76:79], 0
    v_mfma_f32_16x16x32_bf16 v[68:71], v[168:171], v[76:79], 0
    v_mfma_f32_16x16x32_bf16 v[72:75], v[184:187], v[76:79], 0
    v_mfma_f32_16x16x32_bf16 v[60:63], v[164:167], v[80:83], v[60:63]
    v_mfma_f32_16x16x32_bf16 v[64:67], v[180:183], v[80:83], v[64:67]
    v_mfma_f32_16x16x32_bf16 v[68:71], v[172:175], v[80:83], v[68:71]
    v_mfma_f32_16x16x32_bf16 v[72:75], v[188:191], v[80:83], v[72:75]
    s_nop 4
    v_pk_mul_f32 v[84:85], v[60:61], v[192:193]
    v_pk_mul_f32 v[88:89], v[64:65], v[192:193]
    v_pk_mul_f32 v[86:87], v[62:63], v[194:195]
    v_pk_mul_f32 v[90:91], v[66:67], v[194:195]
    v_pk_fma_f32 v[84:85], v[64:65], v[200:201], v[84:85]
    v_pk_fma_f32 v[88:89], v[60:61], v[200:201], v[88:89] neg_lo:[1,0,0] neg_hi:[1,0,0]
    v_pk_fma_f32 v[86:87], v[66:67], v[202:203], v[86:87]
    v_pk_fma_f32 v[90:91], v[62:63], v[202:203], v[90:91] neg_lo:[1,0,0] neg_hi:[1,0,0]
    v_cvt_pk_bf16_f32 v92, v84, v88
    ds_write_b32 v110, v92 offset:0
    v_cvt_pk_bf16_f32 v93, v85, v89
    ds_write_b32 v110, v93 offset:272
    v_cvt_pk_bf16_f32 v94, v86, v90
    ds_write_b32 v110, v94 offset:544
    v_cvt_pk_bf16_f32 v95, v87, v91
    ds_write_b32 v110, v95 offset:816
    v_pk_mul_f32 v[84:85], v[68:69], v[196:197]
    v_pk_mul_f32 v[88:89], v[72:73], v[196:197]
    v_pk_mul_f32 v[86:87], v[70:71], v[198:199]
    v_pk_mul_f32 v[90:91], v[74:75], v[198:199]
    v_pk_fma_f32 v[84:85], v[72:73], v[204:205], v[84:85]
    v_pk_fma_f32 v[88:89], v[68:69], v[204:205], v[88:89] neg_lo:[1,0,0] neg_hi:[1,0,0]
    v_pk_fma_f32 v[86:87], v[74:75], v[206:207], v[86:87]
    v_pk_fma_f32 v[90:91], v[70:71], v[206:207], v[90:91] neg_lo:[1,0,0] neg_hi:[1,0,0]
    v_cvt_pk_bf16_f32 v92, v84, v88
    ds_write_b32 v110, v92 offset:4352
    v_cvt_pk_bf16_f32 v93, v85, v89
    ds_write_b32 v110, v93 offset:4624
    v_cvt_pk_bf16_f32 v94, v86, v90
    ds_write_b32 v110, v94 offset:4896
    v_cvt_pk_bf16_f32 v95, v87, v91
    ds_write_b32 v110, v95 offset:5168
    s_waitcnt lgkmcnt(0)
    s_barrier
    ds_read_b128 v[28:31], v111 offset:0
    ds_read_b128 v[44:47], v111 offset:4352
    ds_read_b128 v[32:35], v111 offset:64
    ds_read_b128 v[48:51], v111 offset:4416
    ds_read_b128 v[36:39], v111 offset:128
    ds_read_b128 v[52:55], v111 offset:4480
    ds_read_b128 v[40:43], v111 offset:192
    ds_read_b128 v[56:59], v111 offset:4544
    s_waitcnt lgkmcnt(7)
    v_mfma_f32_16x16x32_bf16 v[60:63], v[28:31], v[128:131], 0
    v_mfma_f32_16x16x32_bf16 v[64:67], v[28:31], v[144:147], 0
    s_waitcnt lgkmcnt(6)
    v_mfma_f32_16x16x32_bf16 v[68:71], v[44:47], v[128:131], 0
    v_mfma_f32_16x16x32_bf16 v[72:75], v[44:47], v[144:147], 0
    s_waitcnt lgkmcnt(5)
    v_mfma_f32_16x16x32_bf16 v[60:63], v[32:35], v[132:135], v[60:63]
    v_mfma_f32_16x16x32_bf16 v[64:67], v[32:35], v[148:151], v[64:67]
    s_waitcnt lgkmcnt(4)
    v_mfma_f32_16x16x32_bf16 v[68:71], v[48:51], v[132:135], v[68:71]
    v_mfma_f32_16x16x32_bf16 v[72:75], v[48:51], v[148:151], v[72:75]
    s_waitcnt lgkmcnt(3)
    v_mfma_f32_16x16x32_bf16 v[60:63], v[36:39], v[136:139], v[60:63]
    v_mfma_f32_16x16x32_bf16 v[64:67], v[36:39], v[152:155], v[64:67]
    s_waitcnt lgkmcnt(2)
    v_mfma_f32_16x16x32_bf16 v[68:71], v[52:55], v[136:139], v[68:71]
    v_mfma_f32_16x16x32_bf16 v[72:75], v[52:55], v[152:155], v[72:75]
    s_waitcnt lgkmcnt(1)
    v_mfma_f32_16x16x32_bf16 v[60:63], v[40:43], v[140:143], v[60:63]
    v_mfma_f32_16x16x32_bf16 v[64:67], v[40:43], v[156:159], v[64:67]
    s_waitcnt lgkmcnt(0)
    v_mfma_f32_16x16x32_bf16 v[68:71], v[56:59], v[140:143], v[68:71]
    v_mfma_f32_16x16x32_bf16 v[72:75], v[56:59], v[156:159], v[72:75]
    s_nop 3
    v_cvt_pk_bf16_f32 v84, v60, v61
    v_cvt_pk_bf16_f32 v85, v62, v63
    v_cvt_pk_bf16_f32 v86, v64, v65
    v_cvt_pk_bf16_f32 v87, v66, v67
    buffer_store_dwordx4 v[84:87], v112, s[28:31], s48 offen sc1
    v_cvt_pk_bf16_f32 v88, v68, v69
    v_cvt_pk_bf16_f32 v89, v70, v71
    v_cvt_pk_bf16_f32 v90, v72, v73
    v_cvt_pk_bf16_f32 v91, v74, v75
    s_add_u32 s48, s48, 4096
    buffer_store_dwordx4 v[88:91], v112, s[28:31], s48 offen sc1
    s_branch f_p2_done
f_p2_idle:
    s_waitcnt vmcnt(0)
    s_barrier
    s_add_u32 m0, s55, 0
    s_nop 0
    buffer_load_dwordx4 v109, s[4:7], s49 offen lds
    s_mov_b64 exec, 0xff
    buffer_load_dwordx4 v109, s[4:7], s49 offen offset:1024 lds
    s_mov_b64 exec, -1
    s_cmp_lt_u32 s2, 216
    s_cbranch_scc0 f_pla
    s_mov_b32 m0, s24
    s_nop 0
    buffer_load_dwordx4 v9, s[32:35], s60 offen offset:0 lds
    s_add_u32 s25, s60, 35840
    buffer_load_dwordx4 v9, s[32:35], s25 offen offset:1024 lds
    s_add_u32 s26, s60, 71680
    buffer_load_dwordx4 v10, s[32:35], s26 offen offset:2048 lds
    s_add_u32 s27, s60, 107520
    buffer_load_dwordx4 v10, s[32:35], s27 offen offset:3072 lds
    s_add_u32 s60, s60, 589824
    s_add_u32 s24, s24, 16384
    s_mov_b32 m0, s24
    s_nop 0
    buffer_load_dwordx4 v9, s[32:35], s60 offen offset:0 lds
    s_add_u32 s25, s60, 35840
    buffer_load_dwordx4 v9, s[32:35], s25 offen offset:1024 lds
    s_add_u32 s26, s60, 71680
    buffer_load_dwordx4 v10, s[32:35], s26 offen offset:2048 lds
    s_add_u32 s27, s60, 107520
    buffer_load_dwordx4 v10, s[32:35], s27 offen offset:3072 lds
    s_add_u32 s60, s60, 589824
    s_add_u32 s24, s24, 16384
f_pla:
    s_barrier
f_p2_done:
    s_mov_b32 s44, 0x2a000
    s_mov_b32 s45, 0x2c400
    s_mov_b32 s46, 0x2e800
    buffer_load_dwordx4 v[28:31], v126, s[28:31], s44 offen
    buffer_load_dwordx4 v[32:35], v126, s[28:31], s45 offen
    buffer_load_dwordx4 v[36:39], v126, s[28:31], s46 offen
    s_bfe_u32 s50, s38, 0x10001
    s_lshl_b32 s50, s50, 6
    s_lshr_b32 s51, s38, 2
    s_add_u32 s50, s50, s51
    s_lshl_b32 s50, s50, 1
    s_and_b32 s51, s38, 1
    s_add_u32 s50, s50, s51
    s_lshl_b32 s50, s50, 5
    s_add_u32 s48, s50, 7340032
    v_subrev_u32 v2, 288, v0
    v_cmp_gt_u32 vcc, 144, v2
    s_nop 1
    v_cndmask_b32 v3, 0, 1.0, vcc
    v_lshlrev_b32 v2, 4, v0
    s_mov_b32 s47, 0xffff0000
    s_cmp_eq_u32 s42, -1
    s_cbranch_scc1 f_c3late
    v_cvt_f32_u32 v72, v7
    v_cvt_f32_u32 v73, v6
    v_mul_f32 v73, v73, v72
    v_mul_f32 v73, 0x3d800000, v73
    v_fmamk_f32 v60, v72, 0x00000000, v73
    v_fmamk_f32 v61, v72, 0x3c800000, v73
    v_fmamk_f32 v62, v72, 0x3d000000, v73
    v_fmamk_f32 v63, v72, 0x3d400000, v73
    v_cos_f32 v64, v60
    v_sin_f32 v68, v60
    v_cos_f32 v65, v61
    v_sin_f32 v69, v61
    v_cos_f32 v66, v62
    v_sin_f32 v70, v62
    v_cos_f32 v67, v63
    v_sin_f32 v71, v63
    v_cvt_pk_bf16_f32 v216, v64, v65
    v_cvt_pk_bf16_f32 v217, v66, v67
    v_cvt_pk_bf16_f32 v234, -v64, -v65
    v_cvt_pk_bf16_f32 v235, -v66, -v67
    v_cvt_pk_bf16_f32 v218, v68, v69
    v_cvt_pk_bf16_f32 v219, v70, v71
    v_cvt_pk_bf16_f32 v232, v68, v69
    v_cvt_pk_bf16_f32 v233, v70, v71
    v_fmamk_f32 v60, v72, 0x3e800000, v73
    v_fmamk_f32 v61, v72, 0x3e880000, v73
    v_fmamk_f32 v62, v72, 0x3e900000, v73
    v_fmamk_f32 v63, v72, 0x3e980000, v73
    v_cos_f32 v64, v60
    v_sin_f32 v68, v60
    v_cos_f32 v65, v61
    v_sin_f32 v69, v61
    v_cos_f32 v66, v62
    v_sin_f32 v70, v62
    v_cos_f32 v67, v63
    v_sin_f32 v71, v63
    v_cvt_pk_bf16_f32 v220, v64, v65
    v_cvt_pk_bf16_f32 v221, v66, v67
    v_cvt_pk_bf16_f32 v238, -v64, -v65
    v_cvt_pk_bf16_f32 v239, -v66, -v67
    v_cvt_pk_bf16_f32 v222, v68, v69
    v_cvt_pk_bf16_f32 v223, v70, v71
    v_cvt_pk_bf16_f32 v236, v68, v69
    v_cvt_pk_bf16_f32 v237, v70, v71
    v_fmamk_f32 v60, v72, 0x3f000000, v73
    v_fmamk_f32 v61, v72, 0x3f040000, v73
    v_fmamk_f32 v62, v72, 0x3f080000, v73
    v_fmamk_f32 v63, v72, 0x3f0c0000, v73
    v_cos_f32 v64, v60
    v_sin_f32 v68, v60
    v_cos_f32 v65, v61
    v_sin_f32 v69, v61
    v_cos_f32 v66, v62
    v_sin_f32 v70, v62
    v_cos_f32 v67, v63
    v_sin_f32 v71, v63
    v_cvt_pk_bf16_f32 v224, v64, v65
    v_cvt_pk_bf16_f32 v225, v66, v67
    v_cvt_pk_bf16_f32 v242, v64, v65
    v_cvt_pk_bf16_f32 v243, v66, v67
    v_cvt_pk_bf16_f32 v226, -v68, -v69
    v_cvt_pk_bf16_f32 v227, -v70, -v71
    v_cvt_pk_bf16_f32 v240, v68, v69
    v_cvt_pk_bf16_f32 v241, v70, v71
    v_fmamk_f32 v60, v72, 0x3f400000, v73
    v_fmamk_f32 v61, v72, 0x3f440000, v73
    v_fmamk_f32 v62, v72, 0x3f480000, v73
    v_fmamk_f32 v63, v72, 0x3f4c0000, v73
    v_cos_f32 v64, v60
    v_sin_f32 v68, v60
    v_cos_f32 v65, v61
    v_sin_f32 v69, v61
    v_cos_f32 v66, v62
    v_sin_f32 v70, v62
    v_cos_f32 v67, v63
    v_sin_f32 v71, v63
    v_cvt_pk_bf16_f32 v228, v64, v65
    v_cvt_pk_bf16_f32 v229, v66, v67
    v_cvt_pk_bf16_f32 v246, v64, v65
    v_cvt_pk_bf16_f32 v247, v66, v67
    v_cvt_pk_bf16_f32 v230, -v68, -v69
    v_cvt_pk_bf16_f32 v231, -v70, -v71
    v_cvt_pk_bf16_f32 v244, v68, v69
    v_cvt_pk_bf16_f32 v245, v70, v71
    v_mul_f32 v61, 0x3ae38e39, v72
    v_mul_f32 v62, 0x3b638e39, v72
    v_mul_f32 v63, 0x3baaaaab, v72
    v_mul_f32 v64, 0x3be38e39, v72
    v_cos_f32 v248, v61
    v_sin_f32 v252, v61
    v_cos_f32 v249, v62
    v_sin_f32 v253, v62
    v_cos_f32 v250, v63
    v_sin_f32 v254, v63
    v_cos_f32 v251, v64
    v_sin_f32 v255, v64
    v_mul_f32 v248, 0x35e38e39, v248
    v_mul_f32 v249, 0x35e38e39, v249
    v_mul_f32 v250, 0x35e38e39, v250
    v_mul_f32 v251, 0x35e38e39, v251
    v_mul_f32 v252, 0x35e38e39, v252
    v_mul_f32 v253, 0x35e38e39, v253
    v_mul_f32 v254, 0x35e38e39, v254
    v_mul_f32 v255, 0x35e38e39, v255
f_c3late:
    s_waitcnt vmcnt(0)
    v_pk_add_f32 v[28:29], v[28:29], v[32:33]
    v_pk_add_f32 v[30:31], v[30:31], v[34:35]
    v_pk_add_f32 v[28:29], v[28:29], v[36:37]
    v_pk_add_f32 v[30:31], v[30:31], v[38:39]
    v_cvt_pk_bf16_f32 v48, v28, v29
    v_lshlrev_b32 v28, 16, v48
    v_and_b32 v29, s47, v48
    v_cvt_pk_bf16_f32 v49, v30, v31
    v_lshlrev_b32 v30, 16, v49
    v_and_b32 v31, s47, v49
    v_add_f32 v28, v28, v3
    v_add_f32 v29, v29, v3
    v_add_f32 v30, v30, v3
    v_add_f32 v31, v31, v3
    v_cvt_pk_bf16_f32 v48, v28, v29
    v_lshlrev_b32 v28, 16, v48
    v_and_b32 v29, s47, v48
    v_cvt_pk_bf16_f32 v49, v30, v31
    v_lshlrev_b32 v30, 16, v49
    v_and_b32 v31, s47, v49
    ds_write_b128 v2, v[28:31] offset:9728
    s_cmp_ge_u32 s2, 254
    s_cselect_b32 s50, s3, 0
    s_cmp_ge_u32 s50, 6
    s_cbranch_scc0 f_nogb
    v_subrev_u32 v2, 432, v0
    v_cmp_gt_u32 vcc, 72, v2
    v_mov_b32 v3, 0x7f000000
    s_nop 0
    v_cndmask_b32 v2, v3, v126, vcc
    s_movk_i32 s50, 4608
    buffer_store_dwordx4 v[28:31], v2, s[28:31], s50 offen sc1
    s_waitcnt vmcnt(0)
f_nogb:
    s_cmp_lt_u32 s2, 33
    s_cbranch_scc1 f_nozsl
    s_sleep 32
f_nozsl:
    s_cmp_lt_u32 s3, 2
    s_cbranch_scc1 f_z2
    s_mov_b32 s50, 0
f_za:
    buffer_load_dwordx4 v[40:43], v113, s[28:31], s48 offen sc1
f_za_chk:
    s_add_u32 s50, s50, 1
    s_waitcnt vmcnt(0)
    v_max3_u32 v48, v40, v41, v42
    v_max_u32 v48, v48, v43
    v_cmp_eq_u32 vcc, -1, v48
    s_nop 0
    s_and_b64 exec, vcc, vcc
    s_cbranch_scc0 f_za_ok
    s_sleep 4
    s_cmp_lt_u32 s50, 30000
    s_cbranch_scc1 f_za
f_za_ok:
    s_mov_b64 exec, -1
    s_branch f_zj
f_z2:
    s_mov_b32 s50, 0
f_zb:
    buffer_load_dwordx4 v[40:43], v113, s[28:31], s48 offen sc1
    buffer_load_dwordx4 v[44:47], v114, s[28:31], s48 offen sc1
f_zb_chk:
    s_add_u32 s50, s50, 1
    s_waitcnt vmcnt(0)
    v_max3_u32 v48, v40, v41, v42
    v_max3_u32 v48, v48, v43, v44
    v_max3_u32 v48, v48, v45, v46
    v_max_u32 v48, v48, v47
    v_cmp_eq_u32 vcc, -1, v48
    s_nop 0
    s_and_b64 exec, vcc, vcc
    s_cbranch_scc0 f_zb_ok
    s_sleep 4
    s_cmp_lt_u32 s50, 30000
    s_cbranch_scc1 f_zb
f_zb_ok:
    s_mov_b64 exec, -1
    ds_write_b64 v115, v[44:45] offset:2304
    ds_write_b64 v115, v[46:47] offset:5184
f_zj:
    s_and_b32 s25, s3, 1
    s_lshl1_add_u32 s25, s62, s25
    s_lshl_b32 s25, s25, 7
    v_lshrrev_b32 v168, 4, v1
    v_lshlrev_b32 v168, 3, v168
    buffer_load_dwordx2 v[160:161], v168, s[20:23], s25 offen offset:0
    buffer_load_dwordx2 v[162:163], v168, s[20:23], s25 offen offset:32
    buffer_load_dwordx2 v[164:165], v168, s[20:23], s25 offen offset:64
    buffer_load_dwordx2 v[166:167], v168, s[20:23], s25 offen offset:96
    ds_write_b64 v115, v[40:41]
    ds_write_b64 v115, v[42:43] offset:2880
    s_cmp_lt_u32 s3, 4
    s_cbranch_scc1 f_plb_done0
    s_cmp_lt_u32 s2, 33
    s_cbranch_scc0 f_plb0
    s_cmp_lt_u32 s2, 216
    s_cbranch_scc0 f_plb00
    s_mov_b32 m0, s24
    s_nop 0
    buffer_load_dwordx4 v9, s[32:35], s60 offen offset:0 lds
    s_add_u32 s25, s60, 35840
    buffer_load_dwordx4 v9, s[32:35], s25 offen offset:1024 lds
    s_add_u32 s26, s60, 71680
    buffer_load_dwordx4 v10, s[32:35], s26 offen offset:2048 lds
    s_add_u32 s27, s60, 107520
    buffer_load_dwordx4 v10, s[32:35], s27 offen offset:3072 lds
    s_add_u32 s60, s60, 589824
    s_add_u32 s24, s24, 16384
    s_mov_b32 m0, s24
    s_nop 0
    buffer_load_dwordx4 v9, s[32:35], s60 offen offset:0 lds
    s_add_u32 s25, s60, 35840
    buffer_load_dwordx4 v9, s[32:35], s25 offen offset:1024 lds
    s_add_u32 s26, s60, 71680
    buffer_load_dwordx4 v10, s[32:35], s26 offen offset:2048 lds
    s_add_u32 s27, s60, 107520
    buffer_load_dwordx4 v10, s[32:35], s27 offen offset:3072 lds
    s_add_u32 s60, s60, 589824
    s_add_u32 s24, s24, 16384
f_plb00:
f_plb0:
    s_cmp_lt_u32 s2, 216
    s_cbranch_scc0 f_plb10
    s_mov_b32 m0, s24
    s_nop 0
    buffer_load_dwordx4 v9, s[32:35], s60 offen offset:0 lds
    s_add_u32 s25, s60, 35840
    buffer_load_dwordx4 v9, s[32:35], s25 offen offset:1024 lds
    s_add_u32 s26, s60, 71680
    buffer_load_dwordx4 v10, s[32:35], s26 offen offset:2048 lds
    s_add_u32 s27, s60, 107520
    buffer_load_dwordx4 v10, s[32:35], s27 offen offset:3072 lds
    s_add_u32 s60, s60, 589824
    s_add_u32 s24, s24, 16384
    s_mov_b32 m0, s24
    s_nop 0
    buffer_load_dwordx4 v9, s[32:35], s60 offen offset:0 lds
    s_add_u32 s25, s60, 35840
    buffer_load_dwordx4 v9, s[32:35], s25 offen offset:1024 lds
    s_add_u32 s26, s60, 71680
    buffer_load_dwordx4 v10, s[32:35], s26 offen offset:2048 lds
    s_add_u32 s27, s60, 107520
    buffer_load_dwordx4 v10, s[32:35], s27 offen offset:3072 lds
    s_add_u32 s60, s60, 589824
    s_add_u32 s24, s24, 16384
f_plb10:
f_plb_done0:
    s_waitcnt lgkmcnt(0)
    s_barrier
    s_cmp_lt_u32 s3, 4
    s_cbranch_scc1 f_plb_done1
    s_cmp_lt_u32 s3, 4
    s_cbranch_scc1 f_not3
    s_sub_u32 s50, s37, 0
    s_cbranch_scc1 f_not3
    s_lshl_b32 s50, s50, 2
    s_add_u32 s50, s50, s39
    s_add_u32 s58, s50, 64
    s_mul_i32 s58, s58, 55296
    s_add_u32 s58, s58, s57
    buffer_load_dword v8, v17, s[32:35], s58 offen
    s_add_u32 s58, s58, 7077888
    s_cmp_lt_u32 s50, 69
    s_cbranch_scc0 ftch_9
    buffer_load_dword v8, v17, s[32:35], s58 offen
ftch_9:
f_not3:
f_plb_done1:
    v_cmp_eq_u32 s[44:45], 1, v6
    v_cmp_eq_u32 s[50:51], 2, v6
    v_cmp_eq_u32 s[58:59], 3, v6
    ds_read_b64_tr_b16 v[28:29], v116 offset:0
    ds_read_b64_tr_b16 v[30:31], v116 offset:2880
    ds_read_b64_tr_b16 v[32:33], v116 offset:128
    ds_read_b64_tr_b16 v[34:35], v116 offset:3008
    ds_read_b64_tr_b16 v[36:37], v116 offset:256
    ds_read_b64_tr_b16 v[38:39], v116 offset:3136
    ds_read_b64_tr_b16 v[40:41], v116 offset:384
    ds_read_b64_tr_b16 v[42:43], v116 offset:3264
    ds_read_b64_tr_b16 v[44:45], v117 offset:0
    ds_read_b64_tr_b16 v[46:47], v117 offset:2880
    ds_read_b64_tr_b16 v[48:49], v117 offset:128
    ds_read_b64_tr_b16 v[50:51], v117 offset:3008
    ds_read_b64_tr_b16 v[52:53], v117 offset:256
    ds_read_b64_tr_b16 v[54:55], v117 offset:3136
    ds_read_b64_tr_b16 v[56:57], v117 offset:384
    ds_read_b64_tr_b16 v[58:59], v117 offset:3264
    s_waitcnt lgkmcnt(14)
    v_mfma_f32_16x16x32_bf16 v[60:63], v[28:31], v[216:219], 0
    v_mfma_f32_16x16x32_bf16 v[64:67], v[28:31], v[232:235], 0
    s_waitcnt lgkmcnt(12)
    v_mfma_f32_16x16x32_bf16 v[60:63], v[32:35], v[220:223], v[60:63]
    v_mfma_f32_16x16x32_bf16 v[64:67], v[32:35], v[236:239], v[64:67]
    s_waitcnt lgkmcnt(10)
    v_mfma_f32_16x16x32_bf16 v[60:63], v[36:39], v[224:227], v[60:63]
    v_mfma_f32_16x16x32_bf16 v[64:67], v[36:39], v[240:243], v[64:67]
    s_waitcnt lgkmcnt(8)
    v_mfma_f32_16x16x32_bf16 v[60:63], v[40:43], v[228:231], v[60:63]
    v_mfma_f32_16x16x32_bf16 v[64:67], v[40:43], v[244:247], v[64:67]
    s_waitcnt lgkmcnt(6)
    v_mfma_f32_16x16x32_bf16 v[68:71], v[44:47], v[216:219], 0
    s_waitcnt lgkmcnt(4)
    v_mfma_f32_16x16x32_bf16 v[68:71], v[48:51], v[220:223], v[68:71]
    s_waitcnt lgkmcnt(2)
    v_mfma_f32_16x16x32_bf16 v[68:71], v[52:55], v[224:227], v[68:71]
    s_waitcnt lgkmcnt(0)
    v_mfma_f32_16x16x32_bf16 v[68:71], v[56:59], v[228:231], v[68:71]
    ds_read_u16_d16_hi v18, v127 offset:0
    ds_read_u16_d16_hi v19, v127 offset:128
    ds_read_u16_d16_hi v20, v127 offset:256
    ds_read_u16_d16_hi v21, v127 offset:384
    ds_read_u16_d16_hi v22, v127 offset:512
    ds_read_u16_d16_hi v23, v127 offset:640
    ds_read_u16_d16_hi v24, v127 offset:768
    ds_read_u16_d16_hi v25, v127 offset:896
    ds_read_u16_d16_hi v26, v127 offset:1024
    ds_read2st64_b32 v[72:73], v124 offset0:38 offset1:39
    ds_read2st64_b32 v[74:75], v124 offset0:40 offset1:41
    ds_read2st64_b32 v[76:77], v124 offset0:42 offset1:43
    ds_read2st64_b32 v[78:79], v124 offset0:44 offset1:45
    ds_read2st64_b32 v[80:81], v124 offset0:46 offset1:47
    ds_read2st64_b32 v[82:83], v124 offset0:48 offset1:49
    ds_read2st64_b32 v[84:85], v124 offset0:50 offset1:51
    ds_read2st64_b32 v[86:87], v124 offset0:52 offset1:53
    ds_read2st64_b32 v[88:89], v124 offset0:54 offset1:55
    ds_read2st64_b32 v[90:91], v124 offset0:56 offset1:57
    ds_read2st64_b32 v[92:93], v124 offset0:58 offset1:59
    ds_read2st64_b32 v[94:95], v124 offset0:60 offset1:61
    ds_read2st64_b32 v[96:97], v124 offset0:62 offset1:63
    ds_read_b32 v98, v124 offset:16384
    v_permlane32_swap_b32 v60, v62
    v_permlane32_swap_b32 v61, v63
    v_permlane32_swap_b32 v64, v66
    v_permlane32_swap_b32 v65, v67
    v_permlane16_swap_b32 v60, v61
    v_permlane16_swap_b32 v62, v63
    v_permlane16_swap_b32 v64, v65
    v_permlane16_swap_b32 v66, v67
    v_pk_mul_f32 v[28:29], v[60:61], v[248:249]
    v_pk_mul_f32 v[32:33], v[64:65], v[248:249]
    v_pk_mul_f32 v[30:31], v[62:63], v[250:251]
    v_pk_mul_f32 v[34:35], v[66:67], v[250:251]
    v_pk_fma_f32 v[28:29], v[64:65], v[252:253], v[28:29] neg_lo:[1,0,0] neg_hi:[1,0,0]
    v_pk_fma_f32 v[32:33], v[60:61], v[252:253], v[32:33]
    v_pk_fma_f32 v[30:31], v[66:67], v[254:255], v[30:31] neg_lo:[1,0,0] neg_hi:[1,0,0]
    v_pk_fma_f32 v[34:35], v[62:63], v[254:255], v[34:35]
    v_cndmask_b32 v36, v68, v69, s[44:45]
    v_cndmask_b32 v36, v36, v70, s[50:51]
    v_cndmask_b32 v36, v36, v71, s[58:59]
    v_mul_f32 v36, 0x35638e39, v36
    v_add_f32 v37, v36, v28
    v_add_f32 v38, v29, v30
    v_add_f32 v37, v37, v31
    v_add_f32 v37, v37, v38
    v_fmamk_f32 v40, v28, 0x3f441b7d, v36
    v_fmamk_f32 v41, v28, 0x3e31d0d4, v36
    v_fmamk_f32 v42, v28, 0xbf000000, v36
    v_fmamk_f32 v43, v28, 0xbf708fb2, v36
    v_fmamk_f32 v40, v29, 0x3e31d0d4, v40
    v_fmamk_f32 v41, v29, 0xbf708fb2, v41
    v_fmamk_f32 v42, v29, 0xbf000000, v42
    v_fmamk_f32 v43, v29, 0x3f441b7d, v43
    v_fmamk_f32 v40, v30, 0xbf000000, v40
    v_fmamk_f32 v41, v30, 0xbf000000, v41
    v_fmamk_f32 v42, v30, 0x3f800000, v42
    v_fmamk_f32 v43, v30, 0xbf000000, v43
    v_fmamk_f32 v40, v31, 0xbf708fb2, v40
    v_fmamk_f32 v41, v31, 0x3f441b7d, v41
    v_fmamk_f32 v42, v31, 0xbf000000, v42
    v_fmamk_f32 v43, v31, 0x3e31d0d4, v43
    v_mul_f32 v44, 0x3f248dbb, v32
    v_mul_f32 v45, 0x3f7c1c5c, v32
    v_mul_f32 v46, 0x3f5db3d7, v32
    v_mul_f32 v47, 0x3eaf1d44, v32
    v_fmamk_f32 v44, v33, 0x3f7c1c5c, v44
    v_fmamk_f32 v45, v33, 0x3eaf1d44, v45
    v_fmamk_f32 v46, v33, 0xbf5db3d7, v46
    v_fmamk_f32 v47, v33, 0xbf248dbb, v47
    v_fmamk_f32 v44, v34, 0x3f5db3d7, v44
    v_fmamk_f32 v45, v34, 0xbf5db3d7, v45
    v_fmamk_f32 v47, v34, 0x3f5db3d7, v47
    v_fmamk_f32 v44, v35, 0x3eaf1d44, v44
    v_fmamk_f32 v45, v35, 0xbf248dbb, v45
    v_fmamk_f32 v46, v35, 0x3f5db3d7, v46
    v_fmamk_f32 v47, v35, 0xbf7c1c5c, v47
    s_waitcnt lgkmcnt(9)
    v_fmac_f32 v18, v37, v72
    v_sub_f32 v50, v40, v44
    v_add_f32 v51, v40, v44
    v_fmac_f32 v19, v50, v73
    v_fmac_f32 v26, v51, v80
    v_sub_f32 v48, v41, v45
    v_add_f32 v49, v41, v45
    v_fmac_f32 v20, v48, v74
    v_fmac_f32 v25, v49, v79
    v_sub_f32 v50, v42, v46
    v_add_f32 v51, v42, v46
    v_fmac_f32 v21, v50, v75
    v_fmac_f32 v24, v51, v78
    v_sub_f32 v48, v43, v47
    v_add_f32 v49, v43, v47
    v_fmac_f32 v22, v48, v76
    v_fmac_f32 v23, v49, v77
    v_cvt_pk_bf16_f32 v60, v18, v19
    v_cvt_pk_bf16_f32 v61, v20, v21
    v_cvt_pk_bf16_f32 v62, v22, v23
    v_cvt_pk_bf16_f32 v63, v24, v25
    v_cvt_pk_bf16_f32 v64, v26, v26
    v_lshlrev_b32 v18, 16, v60
    v_and_b32 v19, s47, v60
    v_lshlrev_b32 v20, 16, v61
    v_and_b32 v21, s47, v61
    v_lshlrev_b32 v22, 16, v62
    v_and_b32 v23, s47, v62
    v_lshlrev_b32 v24, 16, v63
    v_and_b32 v25, s47, v63
    v_lshlrev_b32 v26, 16, v64
    ds_write_b16 v127, v60 offset:0
    ds_write_b16_d16_hi v127, v60 offset:128
    ds_write_b16 v127, v61 offset:256
    ds_write_b16_d16_hi v127, v61 offset:384
    ds_write_b16 v127, v62 offset:512
    ds_write_b16_d16_hi v127, v62 offset:640
    ds_write_b16 v127, v63 offset:768
    ds_write_b16_d16_hi v127, v63 offset:896
    ds_write_b16 v127, v64 offset:1024
    s_add_u32 s52, s49, 10485760
    s_add_u32 s50, s55, 0
    v_add_u32 v2, s50, v109
    v_cmp_eq_u32 s[44:45], 0, v5
    v_add_f32 v56, v18, v19
    v_mul_f32 v57, v18, v18
    v_fmac_f32 v57, v19, v19
    v_add_f32 v56, v56, v20
    v_fmac_f32 v57, v20, v20
    v_add_f32 v56, v56, v21
    v_fmac_f32 v57, v21, v21
    v_add_f32 v56, v56, v22
    v_fmac_f32 v57, v22, v22
    v_add_f32 v56, v56, v23
    v_fmac_f32 v57, v23, v23
    v_add_f32 v56, v56, v24
    v_fmac_f32 v57, v24, v24
    v_add_f32 v56, v56, v25
    v_fmac_f32 v57, v25, v25
    v_add_f32 v56, v56, v26
    v_fmac_f32 v57, v26, v26
    s_nop 0
    v_add_f32_dpp v56, v56, v56 quad_perm:[1,0,3,2] row_mask:0xf bank_mask:0xf
    v_add_f32_dpp v57, v57, v57 quad_perm:[1,0,3,2] row_mask:0xf bank_mask:0xf
    s_nop 0
    v_add_f32_dpp v56, v56, v56 quad_perm:[2,3,0,1] row_mask:0xf bank_mask:0xf
    v_add_f32_dpp v57, v57, v57 quad_perm:[2,3,0,1] row_mask:0xf bank_mask:0xf
    s_nop 0
    v_add_f32_dpp v56, v56, v56 row_half_mirror row_mask:0xf bank_mask:0xf
    v_add_f32_dpp v57, v57, v57 row_half_mirror row_mask:0xf bank_mask:0xf
    s_nop 0
    v_add_f32_dpp v56, v56, v56 row_mirror row_mask:0xf bank_mask:0xf
    v_add_f32_dpp v57, v57, v57 row_mirror row_mask:0xf bank_mask:0xf
    s_mov_b64 exec, s[44:45]
    ds_write_b64 v120, v[56:57] offset:0
    s_mov_b64 exec, -1
    s_waitcnt lgkmcnt(0)
    s_barrier
    ds_read_b128 v[48:51], v119 offset:0
    ds_read_b128 v[52:55], v119 offset:16
    v_mov_b32 v58, 0x3727c5ac
    s_waitcnt lgkmcnt(0)
    s_cmp_lt_u32 s3, 4
    s_cbranch_scc0 f_nox1r
    ds_read_b128 v[28:31], v2 offset:0
    ds_read_b128 v[32:35], v2 offset:1024
    ds_read_b128 v[36:39], v2 offset:4736
    ds_read_b128 v[40:43], v2 offset:5760
f_nox1r:
    v_pk_add_f32 v[48:49], v[48:49], v[50:51]
    v_pk_add_f32 v[52:53], v[52:53], v[54:55]
    v_pk_add_f32 v[48:49], v[48:49], v[52:53]
    v_mul_f32 v56, 0x3ae38e39, v48
    v_fmamk_f32 v57, v49, 0x3ae38e39, v58
    v_fma_f32 v57, -v56, v56, v57
    v_rsq_f32 v57, v57
    s_nop 0
    v_mul_f32 v56, -v56, v57
    v_fma_f32 v18, v18, v57, v56
    v_fma_f32 v19, v19, v57, v56
    v_fma_f32 v20, v20, v57, v56
    v_fma_f32 v21, v21, v57, v56
    v_fma_f32 v22, v22, v57, v56
    v_fma_f32 v23, v23, v57, v56
    v_fma_f32 v24, v24, v57, v56
    v_fma_f32 v25, v25, v57, v56
    v_fma_f32 v26, v26, v57, v56
    s_cmp_lt_u32 s3, 4
    s_cbranch_scc0 f_nox1s
    s_add_u32 s50, s52, 4608
    s_waitcnt lgkmcnt(0)
    buffer_store_dwordx4 v[28:31], v109, s[28:31], s52 offen sc1
    buffer_store_dwordx4 v[36:39], v109, s[28:31], s50 offen sc1
    s_mov_b64 exec, 0xff
    buffer_store_dwordx4 v[32:35], v109, s[28:31], s52 offen offset:1024 sc1
    buffer_store_dwordx4 v[40:43], v109, s[28:31], s50 offen offset:1024 sc1
    s_mov_b64 exec, -1
f_nox1s:
    v_fma_f32 v18, v18, v90, v81
    v_fma_f32 v19, v19, v91, v82
    v_fma_f32 v20, v20, v92, v83
    v_fma_f32 v21, v21, v93, v84
    v_fma_f32 v22, v22, v94, v85
    v_fma_f32 v23, v23, v95, v86
    v_fma_f32 v24, v24, v96, v87
    v_fma_f32 v25, v25, v97, v88
    v_fma_f32 v26, v26, v98, v89
    v_add_f32 v56, v18, v19
    v_mul_f32 v57, v18, v18
    v_fmac_f32 v57, v19, v19
    v_add_f32 v56, v56, v20
    v_fmac_f32 v57, v20, v20
    v_add_f32 v56, v56, v21
    v_fmac_f32 v57, v21, v21
    v_add_f32 v56, v56, v22
    v_fmac_f32 v57, v22, v22
    v_add_f32 v56, v56, v23
    v_fmac_f32 v57, v23, v23
    v_add_f32 v56, v56, v24
    v_fmac_f32 v57, v24, v24
    v_add_f32 v56, v56, v25
    v_fmac_f32 v57, v25, v25
    v_add_f32 v56, v56, v26
    v_fmac_f32 v57, v26, v26
    s_nop 0
    v_add_f32_dpp v56, v56, v56 quad_perm:[1,0,3,2] row_mask:0xf bank_mask:0xf
    v_add_f32_dpp v57, v57, v57 quad_perm:[1,0,3,2] row_mask:0xf bank_mask:0xf
    s_nop 0
    v_add_f32_dpp v56, v56, v56 quad_perm:[2,3,0,1] row_mask:0xf bank_mask:0xf
    v_add_f32_dpp v57, v57, v57 quad_perm:[2,3,0,1] row_mask:0xf bank_mask:0xf
    s_nop 0
    v_add_f32_dpp v56, v56, v56 row_half_mirror row_mask:0xf bank_mask:0xf
    v_add_f32_dpp v57, v57, v57 row_half_mirror row_mask:0xf bank_mask:0xf
    s_nop 0
    v_add_f32_dpp v56, v56, v56 row_mirror row_mask:0xf bank_mask:0xf
    v_add_f32_dpp v57, v57, v57 row_mirror row_mask:0xf bank_mask:0xf
    s_mov_b64 exec, s[44:45]
    ds_write_b64 v120, v[56:57] offset:256
    s_mov_b64 exec, -1
    s_waitcnt lgkmcnt(0)
    s_barrier
    ds_read_b128 v[48:51], v119 offset:256
    ds_read_b128 v[52:55], v119 offset:272
    v_mov_b32 v58, 0x3727c5ac
    s_waitcnt lgkmcnt(0)
    v_pk_add_f32 v[48:49], v[48:49], v[50:51]
    v_pk_add_f32 v[52:53], v[52:53], v[54:55]
    v_pk_add_f32 v[48:49], v[48:49], v[52:53]
    v_mul_f32 v56, 0x3ae38e39, v48
    v_fmamk_f32 v57, v49, 0x3ae38e39, v58
    v_fma_f32 v57, -v56, v56, v57
    v_rsq_f32 v57, v57
    s_nop 0
    v_mul_f32 v56, -v56, v57
    v_fma_f32 v18, v18, v57, v56
    v_fma_f32 v19, v19, v57, v56
    v_fma_f32 v20, v20, v57, v56
    v_fma_f32 v21, v21, v57, v56
    v_fma_f32 v22, v22, v57, v56
    v_fma_f32 v23, v23, v57, v56
    v_fma_f32 v24, v24, v57, v56
    v_fma_f32 v25, v25, v57, v56
    v_fma_f32 v26, v26, v57, v56
    v_mov_b32 v27, 0
    v_permlane16_swap_b32 v18, v19
    v_permlane16_swap_b32 v20, v21
    v_permlane16_swap_b32 v22, v23
    v_permlane16_swap_b32 v24, v25
    v_permlane16_swap_b32 v26, v27
    v_cvt_pk_bf16_f32 v28, v18, v19
    v_cvt_pk_bf16_f32 v29, v20, v21
    v_cvt_pk_bf16_f32 v30, v22, v23
    v_cvt_pk_bf16_f32 v31, v24, v25
    v_cvt_pk_bf16_f32 v32, v26, v27
    v_mov_b32 v33, 0
    v_permlane32_swap_b32 v28, v29
    v_permlane32_swap_b32 v30, v31
    v_permlane32_swap_b32 v32, v33
    s_mul_i32 s50, s38, 1536
    ds_write_b64 v121, v[28:29]
    ds_write_b64 v121, v[30:31] offset:4096
    s_mov_b64 exec, 0xffff
    ds_write_b64 v121, v[32:33] offset:8192
    s_mov_b64 exec, -1
    s_add_u32 s50, s50, 13631488
    v_lshlrev_b32 v2, 4, v0
    v_add_u32 v3, 8192, v2
    v_add_u32 v4, 8192, v109
    s_waitcnt lgkmcnt(0)
    s_barrier
    s_cmp_lt_u32 s3, 4
    s_cbranch_scc1 f_plb_done3
    s_cmp_lt_u32 s2, 216
    s_cbranch_scc0 f_plb13
    s_mov_b32 m0, s24
    s_nop 0
    buffer_load_dwordx4 v9, s[32:35], s60 offen offset:0 lds
    s_add_u32 s25, s60, 35840
    buffer_load_dwordx4 v9, s[32:35], s25 offen offset:1024 lds
    s_add_u32 s26, s60, 71680
    buffer_load_dwordx4 v10, s[32:35], s26 offen offset:2048 lds
    s_add_u32 s27, s60, 107520
    buffer_load_dwordx4 v10, s[32:35], s27 offen offset:3072 lds
    s_add_u32 s60, s60, 589824
    s_add_u32 s24, s24, 16384
    s_mov_b32 m0, s24
    s_nop 0
    buffer_load_dwordx4 v9, s[32:35], s60 offen offset:0 lds
    s_add_u32 s25, s60, 35840
    buffer_load_dwordx4 v9, s[32:35], s25 offen offset:1024 lds
    s_add_u32 s26, s60, 71680
    buffer_load_dwordx4 v10, s[32:35], s26 offen offset:2048 lds
    s_add_u32 s27, s60, 107520
    buffer_load_dwordx4 v10, s[32:35], s27 offen offset:3072 lds
    s_add_u32 s60, s60, 589824
    s_add_u32 s24, s24, 16384
f_plb13:
f_plb_done3:
    s_cmp_lt_u32 s3, 4
    s_cbranch_scc0 f_h2none
    ds_read_b128 v[28:31], v2 offset:17920
    ds_read_b128 v[32:35], v3 offset:13824
    s_cmp_eq_u32 s3, 1
    s_cbranch_scc0 f_h2one
    ds_read_b128 v[36:39], v4 offset:17920
    s_waitcnt lgkmcnt(0)
    buffer_store_dwordx4 v[36:39], v123, s[28:31], s50 offen sc1
f_h2one:
    s_waitcnt lgkmcnt(1)
    buffer_store_dwordx4 v[28:31], v122, s[28:31], s50 offen sc1
    s_waitcnt lgkmcnt(0)
    buffer_store_dwordx4 v[32:35], v118, s[28:31], s50 offen sc1
    s_waitcnt vmcnt(0)
f_h2none:
    v_mov_b32 v3, 1
    s_lshl_b32 s50, s38, 10
    s_add_u32 s50, s50, 262400
    s_barrier
    s_cmp_eq_u32 s3, 0
    s_cbranch_scc0 t_noflag
    s_mov_b64 exec, 1
    buffer_store_dword v3, off, s[28:31], s50 sc1
    s_mov_b64 exec, -1
t_noflag:
    s_cmp_ge_u32 s2, 216
    s_cbranch_scc1 t_spare
    s_cmp_lt_u32 s3, 4
    s_cbranch_scc1 t_cons
    s_mul_i32 s4, s39, 3072
    s_add_u32 m0, s4, 12288
    s_nop 0
    buffer_load_dwordx4 v14, s[28:31], s61 offen offset:0 lds
    buffer_load_dwordx4 v14, s[28:31], s61 offen offset:1024 lds
    buffer_load_dwordx4 v14, s[28:31], s61 offen offset:2048 lds
    s_add_u32 m0, s4, 24576
    s_add_u32 s25, s61, 12288
    buffer_load_dwordx4 v14, s[28:31], s25 offen offset:0 lds
    buffer_load_dwordx4 v14, s[28:31], s25 offen offset:1024 lds
    buffer_load_dwordx4 v14, s[28:31], s25 offen offset:2048 lds
    s_add_u32 m0, s4, 36864
    s_add_u32 s25, s61, 24576
    buffer_load_dwordx4 v14, s[28:31], s25 offen offset:0 lds
    buffer_load_dwordx4 v14, s[28:31], s25 offen offset:1024 lds
    buffer_load_dwordx4 v14, s[28:31], s25 offen offset:2048 lds
    s_add_u32 m0, s4, 49152
    s_add_u32 s25, s61, 36864
    buffer_load_dwordx4 v14, s[28:31], s25 offen offset:0 lds
    buffer_load_dwordx4 v14, s[28:31], s25 offen offset:1024 lds
    buffer_load_dwordx4 v14, s[28:31], s25 offen offset:2048 lds
    v_lshrrev_b32 v2, 1, v1
    v_lshlrev_b32 v2, 13, v2
    v_and_b32 v3, 1, v1
    v_lshl_add_u32 v2, v3, 10, v2
    s_lshl_b32 s50, s39, 11
    s_add_u32 s50, s50, 262400
    s_mul_i32 s4, s39, 3072
    s_sub_u32 s24, s24, 98304
    v_add_u32 v18, s24, v14
    v_add_u32 v19, 65536, v18
    s_mov_b64 s[54:55], 0
    s_mov_b32 s56, 16
    v_add_u32 v16, s4, v14
    s_waitcnt vmcnt(9) lgkmcnt(0)
    s_mov_b32 s51, 0
val_10:
    ds_read_b128 v[24:27], v16 offset:12288
    ds_read_b128 v[28:31], v16 offset:13312
    ds_read_b128 v[32:35], v16 offset:14336
    s_waitcnt lgkmcnt(2)
    v_max3_u32 v24, v24, v25, v26
    v_max_u32 v24, v24, v27
    s_waitcnt lgkmcnt(1)
    v_max3_u32 v28, v28, v29, v30
    v_max3_u32 v28, v28, v31, v24
    s_waitcnt lgkmcnt(0)
    v_max3_u32 v32, v32, v33, v34
    v_max3_u32 v32, v32, v35, v28
    v_cmp_eq_u32 vcc, -1, v32
    s_nop 0
    s_and_b64 exec, vcc, vcc
    s_cbranch_scc0 val_10_ok
    s_cmp_lt_u32 s51, 30000
    s_cbranch_scc0 val_10_ok
    s_cmp_eq_u32 s51, 0
    s_cbranch_scc1 val_10_ns
    s_sleep 2
val_10_ns:
    s_add_u32 s51, s51, 1
    s_add_u32 m0, s4, 12288
    s_nop 0
    buffer_load_dwordx4 v14, s[28:31], s61 offen offset:0 sc1 lds
    buffer_load_dwordx4 v14, s[28:31], s61 offen offset:1024 sc1 lds
    buffer_load_dwordx4 v14, s[28:31], s61 offen offset:2048 sc1 lds
    s_mov_b64 exec, -1
    s_waitcnt vmcnt(0)
    s_branch val_10
val_10_ok:
    s_mov_b64 exec, -1
    s_barrier
    s_add_u32 m0, s4, 0
    s_add_u32 s25, s61, 49152
    buffer_load_dwordx4 v14, s[28:31], s25 offen offset:0 lds
    buffer_load_dwordx4 v14, s[28:31], s25 offen offset:1024 lds
    buffer_load_dwordx4 v14, s[28:31], s25 offen offset:2048 lds
    s_waitcnt vmcnt(9) lgkmcnt(0)
    s_mov_b32 s51, 0
val_11:
    ds_read_b128 v[24:27], v16 offset:24576
    ds_read_b128 v[28:31], v16 offset:25600
    ds_read_b128 v[32:35], v16 offset:26624
    s_waitcnt lgkmcnt(2)
    v_max3_u32 v24, v24, v25, v26
    v_max_u32 v24, v24, v27
    s_waitcnt lgkmcnt(1)
    v_max3_u32 v28, v28, v29, v30
    v_max3_u32 v28, v28, v31, v24
    s_waitcnt lgkmcnt(0)
    v_max3_u32 v32, v32, v33, v34
    v_max3_u32 v32, v32, v35, v28
    v_cmp_eq_u32 vcc, -1, v32
    s_nop 0
    s_and_b64 exec, vcc, vcc
    s_cbranch_scc0 val_11_ok
    s_cmp_lt_u32 s51, 30000
    s_cbranch_scc0 val_11_ok
    s_cmp_eq_u32 s51, 0
    s_cbranch_scc1 val_11_ns
    s_sleep 2
val_11_ns:
    s_add_u32 s51, s51, 1
    s_add_u32 m0, s4, 24576
    s_add_u32 s25, s61, 12288
    buffer_load_dwordx4 v14, s[28:31], s25 offen offset:0 sc1 lds
    buffer_load_dwordx4 v14, s[28:31], s25 offen offset:1024 sc1 lds
    buffer_load_dwordx4 v14, s[28:31], s25 offen offset:2048 sc1 lds
    s_mov_b64 exec, -1
    s_waitcnt vmcnt(0)
    s_branch val_11
val_11_ok:
    s_mov_b64 exec, -1
    s_barrier
    s_add_u32 m0, s24, 0
    s_nop 0
    buffer_load_dwordx4 v9, s[32:35], s60 offen offset:0 lds
    s_add_u32 s45, s60, 35840
    buffer_load_dwordx4 v9, s[32:35], s45 offen offset:1024 lds
    s_add_u32 s46, s60, 71680
    buffer_load_dwordx4 v10, s[32:35], s46 offen offset:2048 lds
    s_add_u32 s44, s60, 107520
    buffer_load_dwordx4 v10, s[32:35], s44 offen offset:3072 lds
    s_add_u32 m0, s4, 12288
    s_add_u32 s25, s61, 61440
    buffer_load_dwordx4 v14, s[28:31], s25 offen offset:0 lds
    buffer_load_dwordx4 v14, s[28:31], s25 offen offset:1024 lds
    buffer_load_dwordx4 v14, s[28:31], s25 offen offset:2048 lds
    s_waitcnt vmcnt(13) lgkmcnt(0)
    s_mov_b32 s51, 0
val_12:
    ds_read_b128 v[24:27], v16 offset:36864
    ds_read_b128 v[28:31], v16 offset:37888
    ds_read_b128 v[32:35], v16 offset:38912
    s_waitcnt lgkmcnt(2)
    v_max3_u32 v24, v24, v25, v26
    v_max_u32 v24, v24, v27
    s_waitcnt lgkmcnt(1)
    v_max3_u32 v28, v28, v29, v30
    v_max3_u32 v28, v28, v31, v24
    s_waitcnt lgkmcnt(0)
    v_max3_u32 v32, v32, v33, v34
    v_max3_u32 v32, v32, v35, v28
    v_cmp_eq_u32 vcc, -1, v32
    s_nop 0
    s_and_b64 exec, vcc, vcc
    s_cbranch_scc0 val_12_ok
    s_cmp_lt_u32 s51, 30000
    s_cbranch_scc0 val_12_ok
    s_cmp_eq_u32 s51, 0
    s_cbranch_scc1 val_12_ns
    s_sleep 2
val_12_ns:
    s_add_u32 s51, s51, 1
    s_add_u32 m0, s4, 36864
    s_add_u32 s25, s61, 24576
    buffer_load_dwordx4 v14, s[28:31], s25 offen offset:0 sc1 lds
    buffer_load_dwordx4 v14, s[28:31], s25 offen offset:1024 sc1 lds
    buffer_load_dwordx4 v14, s[28:31], s25 offen offset:2048 sc1 lds
    s_mov_b64 exec, -1
    s_waitcnt vmcnt(0)
    s_branch val_12
val_12_ok:
    s_mov_b64 exec, -1
    s_barrier
    s_add_u32 m0, s24, 16384
    s_add_u32 s44, s60, 589824
    buffer_load_dwordx4 v9, s[32:35], s44 offen offset:0 lds
    s_add_u32 s45, s60, 625664
    buffer_load_dwordx4 v9, s[32:35], s45 offen offset:1024 lds
    s_add_u32 s46, s60, 661504
    buffer_load_dwordx4 v10, s[32:35], s46 offen offset:2048 lds
    s_add_u32 s44, s60, 697344
    buffer_load_dwordx4 v10, s[32:35], s44 offen offset:3072 lds
    s_add_u32 m0, s4, 24576
    s_add_u32 s25, s61, 73728
    buffer_load_dwordx4 v14, s[28:31], s25 offen offset:0 lds
    buffer_load_dwordx4 v14, s[28:31], s25 offen offset:1024 lds
    buffer_load_dwordx4 v14, s[28:31], s25 offen offset:2048 lds
    s_waitcnt vmcnt(17) lgkmcnt(0)
    s_mov_b32 s51, 0
val_13:
    ds_read_b128 v[24:27], v16 offset:49152
    ds_read_b128 v[28:31], v16 offset:50176
    ds_read_b128 v[32:35], v16 offset:51200
    s_waitcnt lgkmcnt(2)
    v_max3_u32 v24, v24, v25, v26
    v_max_u32 v24, v24, v27
    s_waitcnt lgkmcnt(1)
    v_max3_u32 v28, v28, v29, v30
    v_max3_u32 v28, v28, v31, v24
    s_waitcnt lgkmcnt(0)
    v_max3_u32 v32, v32, v33, v34
    v_max3_u32 v32, v32, v35, v28
    v_cmp_eq_u32 vcc, -1, v32
    s_nop 0
    s_and_b64 exec, vcc, vcc
    s_cbranch_scc0 val_13_ok
    s_cmp_lt_u32 s51, 30000
    s_cbranch_scc0 val_13_ok
    s_cmp_eq_u32 s51, 0
    s_cbranch_scc1 val_13_ns
    s_sleep 2
val_13_ns:
    s_add_u32 s51, s51, 1
    s_add_u32 m0, s4, 49152
    s_add_u32 s25, s61, 36864
    buffer_load_dwordx4 v14, s[28:31], s25 offen offset:0 sc1 lds
    buffer_load_dwordx4 v14, s[28:31], s25 offen offset:1024 sc1 lds
    buffer_load_dwordx4 v14, s[28:31], s25 offen offset:2048 sc1 lds
    s_mov_b64 exec, -1
    s_waitcnt vmcnt(0)
    s_branch val_13
val_13_ok:
    s_mov_b64 exec, -1
    s_barrier
    buffer_load_dword v3, v2, s[28:31], s50 offen sc1
    s_add_u32 m0, s24, 32768
    s_add_u32 s44, s60, 1179648
    buffer_load_dwordx4 v9, s[32:35], s44 offen offset:0 lds
    s_add_u32 s45, s60, 1215488
    buffer_load_dwordx4 v9, s[32:35], s45 offen offset:1024 lds
    s_add_u32 s46, s60, 1251328
    buffer_load_dwordx4 v10, s[32:35], s46 offen offset:2048 lds
    s_add_u32 s44, s60, 1287168
    buffer_load_dwordx4 v10, s[32:35], s44 offen offset:3072 lds
    s_add_u32 m0, s4, 36864
    s_add_u32 s25, s61, 86016
    buffer_load_dwordx4 v14, s[28:31], s25 offen offset:0 lds
    buffer_load_dwordx4 v14, s[28:31], s25 offen offset:1024 lds
    buffer_load_dwordx4 v14, s[28:31], s25 offen offset:2048 lds
    s_waitcnt vmcnt(22) lgkmcnt(0)
    s_mov_b32 s51, 0
val_14:
    ds_read_b128 v[24:27], v16 offset:0
    ds_read_b128 v[28:31], v16 offset:1024
    ds_read_b128 v[32:35], v16 offset:2048
    s_waitcnt lgkmcnt(2)
    v_max3_u32 v24, v24, v25, v26
    v_max_u32 v24, v24, v27
    s_waitcnt lgkmcnt(1)
    v_max3_u32 v28, v28, v29, v30
    v_max3_u32 v28, v28, v31, v24
    s_waitcnt lgkmcnt(0)
    v_max3_u32 v32, v32, v33, v34
    v_max3_u32 v32, v32, v35, v28
    v_cmp_eq_u32 vcc, -1, v32
    s_nop 0
    s_and_b64 exec, vcc, vcc
    s_cbranch_scc0 val_14_ok
    s_cmp_lt_u32 s51, 30000
    s_cbranch_scc0 val_14_ok
    s_cmp_eq_u32 s51, 0
    s_cbranch_scc1 val_14_ns
    s_sleep 2
val_14_ns:
    s_add_u32 s51, s51, 1
    s_add_u32 m0, s4, 0
    s_add_u32 s25, s61, 49152
    buffer_load_dwordx4 v14, s[28:31], s25 offen offset:0 sc1 lds
    buffer_load_dwordx4 v14, s[28:31], s25 offen offset:1024 sc1 lds
    buffer_load_dwordx4 v14, s[28:31], s25 offen offset:2048 sc1 lds
    s_mov_b64 exec, -1
    s_waitcnt vmcnt(0)
    s_branch val_14
val_14_ok:
    s_mov_b64 exec, -1
    s_barrier
    s_add_u32 m0, s24, 49152
    s_add_u32 s44, s60, 1769472
    buffer_load_dwordx4 v9, s[32:35], s44 offen offset:0 lds
    s_add_u32 s45, s60, 1805312
    buffer_load_dwordx4 v9, s[32:35], s45 offen offset:1024 lds
    s_add_u32 s46, s60, 1841152
    buffer_load_dwordx4 v10, s[32:35], s46 offen offset:2048 lds
    s_add_u32 s44, s60, 1876992
    buffer_load_dwordx4 v10, s[32:35], s44 offen offset:3072 lds
    s_waitcnt vmcnt(11)
    v_cmp_ne_u32 vcc, 0, v3
    s_nop 0
    s_lshr_b64 s[54:55], vcc, s56
    s_andn2_b64 exec, 0xffff, vcc
    s_cbranch_scc0 g1_skipped_ok
    s_mov_b32 s51, 0
g1_skipped:
    buffer_load_dword v3, v2, s[28:31], s50 offen offset:0 sc1
    s_add_u32 s51, s51, 1
    s_waitcnt vmcnt(0)
    v_cmp_eq_u32 vcc, 0, v3
    s_nop 0
    s_and_b64 exec, vcc, vcc
    s_cbranch_scc0 g1_skipped_ok
    s_sleep 2
    s_cmp_lt_u32 s51, 30000
    s_cbranch_scc1 g1_skipped
g1_skipped_ok:
    s_mov_b64 exec, -1
    s_and_b32 s25, s54, 3
    s_cmp_eq_u32 s25, 3
    s_cbranch_scc1 chk_15_ok
    s_mov_b32 s51, 0
chk_15:
    buffer_load_dword v3, v2, s[28:31], s50 offen sc1
    s_add_u32 s51, s51, 1
    s_mov_b64 exec, -1
    s_waitcnt vmcnt(0)
    v_cmp_ne_u32 vcc, 0, v3
    s_nop 0
    s_lshr_b64 s[54:55], vcc, s56
    s_and_b32 s25, s54, 3
    s_cmp_eq_u32 s25, 3
    s_cbranch_scc1 chk_15_ok
    s_sleep 1
    s_lshl_b64 exec, 0xff, s56
    s_cmp_lt_u32 s51, 30000
    s_cbranch_scc1 chk_15
    s_mov_b64 exec, -1
chk_15_ok:
    s_lshr_b64 s[54:55], s[54:55], 2
    s_add_u32 s56, s56, 2
    s_add_u32 m0, s4, 49152
    s_add_u32 s25, s61, 98304
    buffer_load_dwordx4 v14, s[28:31], s25 offen offset:0 lds
    buffer_load_dwordx4 v14, s[28:31], s25 offen offset:1024 lds
    buffer_load_dwordx4 v14, s[28:31], s25 offen offset:2048 lds
    s_waitcnt vmcnt(22) lgkmcnt(0)
    s_mov_b32 s51, 0
val_16:
    ds_read_b128 v[24:27], v16 offset:12288
    ds_read_b128 v[28:31], v16 offset:13312
    ds_read_b128 v[32:35], v16 offset:14336
    s_waitcnt lgkmcnt(2)
    v_max3_u32 v24, v24, v25, v26
    v_max_u32 v24, v24, v27
    s_waitcnt lgkmcnt(1)
    v_max3_u32 v28, v28, v29, v30
    v_max3_u32 v28, v28, v31, v24
    s_waitcnt lgkmcnt(0)
    v_max3_u32 v32, v32, v33, v34
    v_max3_u32 v32, v32, v35, v28
    v_cmp_eq_u32 vcc, -1, v32
    s_nop 0
    s_and_b64 exec, vcc, vcc
    s_cbranch_scc0 val_16_ok
    s_cmp_lt_u32 s51, 30000
    s_cbranch_scc0 val_16_ok
    s_cmp_eq_u32 s51, 0
    s_cbranch_scc1 val_16_ns
    s_sleep 2
val_16_ns:
    s_add_u32 s51, s51, 1
    s_add_u32 m0, s4, 12288
    s_add_u32 s25, s61, 61440
    buffer_load_dwordx4 v14, s[28:31], s25 offen offset:0 sc1 lds
    buffer_load_dwordx4 v14, s[28:31], s25 offen offset:1024 sc1 lds
    buffer_load_dwordx4 v14, s[28:31], s25 offen offset:2048 sc1 lds
    s_mov_b64 exec, -1
    s_waitcnt vmcnt(0)
    s_branch val_16
val_16_ok:
    s_mov_b64 exec, -1
    s_barrier
    s_add_u32 m0, s24, 65536
    s_add_u32 s44, s60, 2359296
    buffer_load_dwordx4 v9, s[32:35], s44 offen offset:0 lds
    s_add_u32 s45, s60, 2395136
    buffer_load_dwordx4 v9, s[32:35], s45 offen offset:1024 lds
    s_add_u32 s46, s60, 2430976
    buffer_load_dwordx4 v10, s[32:35], s46 offen offset:2048 lds
    s_add_u32 s44, s60, 2466816
    buffer_load_dwordx4 v10, s[32:35], s44 offen offset:3072 lds
    s_and_b32 s25, s54, 3
    s_cmp_eq_u32 s25, 3
    s_cbranch_scc1 chk_17_ok
    s_mov_b32 s51, 0
chk_17:
    buffer_load_dword v3, v2, s[28:31], s50 offen sc1
    s_add_u32 s51, s51, 1
    s_mov_b64 exec, -1
    s_waitcnt vmcnt(0)
    v_cmp_ne_u32 vcc, 0, v3
    s_nop 0
    s_lshr_b64 s[54:55], vcc, s56
    s_and_b32 s25, s54, 3
    s_cmp_eq_u32 s25, 3
    s_cbranch_scc1 chk_17_ok
    s_sleep 1
    s_lshl_b64 exec, 0xff, s56
    s_cmp_lt_u32 s51, 30000
    s_cbranch_scc1 chk_17
    s_mov_b64 exec, -1
chk_17_ok:
    s_lshr_b64 s[54:55], s[54:55], 2
    s_add_u32 s56, s56, 2
    s_add_u32 m0, s4, 0
    s_add_u32 s25, s61, 110592
    buffer_load_dwordx4 v14, s[28:31], s25 offen offset:0 lds
    buffer_load_dwordx4 v14, s[28:31], s25 offen offset:1024 lds
    buffer_load_dwordx4 v14, s[28:31], s25 offen offset:2048 lds
    s_waitcnt vmcnt(22) lgkmcnt(0)
    s_mov_b32 s51, 0
val_18:
    ds_read_b128 v[24:27], v16 offset:24576
    ds_read_b128 v[28:31], v16 offset:25600
    ds_read_b128 v[32:35], v16 offset:26624
    s_waitcnt lgkmcnt(2)
    v_max3_u32 v24, v24, v25, v26
    v_max_u32 v24, v24, v27
    s_waitcnt lgkmcnt(1)
    v_max3_u32 v28, v28, v29, v30
    v_max3_u32 v28, v28, v31, v24
    s_waitcnt lgkmcnt(0)
    v_max3_u32 v32, v32, v33, v34
    v_max3_u32 v32, v32, v35, v28
    v_cmp_eq_u32 vcc, -1, v32
    s_nop 0
    s_and_b64 exec, vcc, vcc
    s_cbranch_scc0 val_18_ok
    s_cmp_lt_u32 s51, 30000
    s_cbranch_scc0 val_18_ok
    s_cmp_eq_u32 s51, 0
    s_cbranch_scc1 val_18_ns
    s_sleep 2
val_18_ns:
    s_add_u32 s51, s51, 1
    s_add_u32 m0, s4, 24576
    s_add_u32 s25, s61, 73728
    buffer_load_dwordx4 v14, s[28:31], s25 offen offset:0 sc1 lds
    buffer_load_dwordx4 v14, s[28:31], s25 offen offset:1024 sc1 lds
    buffer_load_dwordx4 v14, s[28:31], s25 offen offset:2048 sc1 lds
    s_mov_b64 exec, -1
    s_waitcnt vmcnt(0)
    s_branch val_18
val_18_ok:
    s_mov_b64 exec, -1
    s_barrier
    s_add_u32 m0, s24, 81920
    s_add_u32 s44, s60, 2949120
    buffer_load_dwordx4 v9, s[32:35], s44 offen offset:0 lds
    s_add_u32 s45, s60, 2984960
    buffer_load_dwordx4 v9, s[32:35], s45 offen offset:1024 lds
    s_add_u32 s46, s60, 3020800
    buffer_load_dwordx4 v10, s[32:35], s46 offen offset:2048 lds
    s_add_u32 s44, s60, 3056640
    buffer_load_dwordx4 v10, s[32:35], s44 offen offset:3072 lds
    s_and_b32 s25, s54, 3
    s_cmp_eq_u32 s25, 3
    s_cbranch_scc1 chk_19_ok
    s_mov_b32 s51, 0
chk_19:
    buffer_load_dword v3, v2, s[28:31], s50 offen sc1
    s_add_u32 s51, s51, 1
    s_mov_b64 exec, -1
    s_waitcnt vmcnt(0)
    v_cmp_ne_u32 vcc, 0, v3
    s_nop 0
    s_lshr_b64 s[54:55], vcc, s56
    s_and_b32 s25, s54, 3
    s_cmp_eq_u32 s25, 3
    s_cbranch_scc1 chk_19_ok
    s_sleep 1
    s_lshl_b64 exec, 0xff, s56
    s_cmp_lt_u32 s51, 30000
    s_cbranch_scc1 chk_19
    s_mov_b64 exec, -1
chk_19_ok:
    s_lshr_b64 s[54:55], s[54:55], 2
    s_add_u32 s56, s56, 2
    s_add_u32 m0, s4, 12288
    s_add_u32 s25, s61, 122880
    buffer_load_dwordx4 v14, s[28:31], s25 offen offset:0 lds
    buffer_load_dwordx4 v14, s[28:31], s25 offen offset:1024 lds
    buffer_load_dwordx4 v14, s[28:31], s25 offen offset:2048 lds
    s_waitcnt vmcnt(21) lgkmcnt(0)
    s_mov_b32 s51, 0
val_20:
    ds_read_b128 v[24:27], v16 offset:36864
    ds_read_b128 v[28:31], v16 offset:37888
    ds_read_b128 v[32:35], v16 offset:38912
    s_waitcnt lgkmcnt(2)
    v_max3_u32 v24, v24, v25, v26
    v_max_u32 v24, v24, v27
    s_waitcnt lgkmcnt(1)
    v_max3_u32 v28, v28, v29, v30
    v_max3_u32 v28, v28, v31, v24
    s_waitcnt lgkmcnt(0)
    v_max3_u32 v32, v32, v33, v34
    v_max3_u32 v32, v32, v35, v28
    v_cmp_eq_u32 vcc, -1, v32
    s_nop 0
    s_and_b64 exec, vcc, vcc
    s_cbranch_scc0 val_20_ok
    s_cmp_lt_u32 s51, 30000
    s_cbranch_scc0 val_20_ok
    s_cmp_eq_u32 s51, 0
    s_cbranch_scc1 val_20_ns
    s_sleep 2
val_20_ns:
    s_add_u32 s51, s51, 1
    s_add_u32 m0, s4, 36864
    s_add_u32 s25, s61, 86016
    buffer_load_dwordx4 v14, s[28:31], s25 offen offset:0 sc1 lds
    buffer_load_dwordx4 v14, s[28:31], s25 offen offset:1024 sc1 lds
    buffer_load_dwordx4 v14, s[28:31], s25 offen offset:2048 sc1 lds
    s_mov_b64 exec, -1
    s_waitcnt vmcnt(0)
    s_branch val_20
val_20_ok:
    s_mov_b64 exec, -1
    s_barrier
    s_add_u32 m0, s24, 0
    s_add_u32 s44, s60, 3538944
    buffer_load_dwordx4 v9, s[32:35], s44 offen offset:0 lds
    s_add_u32 s45, s60, 3574784
    buffer_load_dwordx4 v9, s[32:35], s45 offen offset:1024 lds
    s_add_u32 s46, s60, 3610624
    buffer_load_dwordx4 v10, s[32:35], s46 offen offset:2048 lds
    s_add_u32 s44, s60, 3646464
    buffer_load_dwordx4 v10, s[32:35], s44 offen offset:3072 lds
    s_and_b32 s25, s54, 3
    s_cmp_eq_u32 s25, 3
    s_cbranch_scc1 chk_21_ok
    s_mov_b32 s51, 0
chk_21:
    buffer_load_dword v3, v2, s[28:31], s50 offen sc1
    s_add_u32 s51, s51, 1
    s_mov_b64 exec, -1
    s_waitcnt vmcnt(0)
    v_cmp_ne_u32 vcc, 0, v3
    s_nop 0
    s_lshr_b64 s[54:55], vcc, s56
    s_and_b32 s25, s54, 3
    s_cmp_eq_u32 s25, 3
    s_cbranch_scc1 chk_21_ok
    s_sleep 1
    s_lshl_b64 exec, 0xff, s56
    s_cmp_lt_u32 s51, 30000
    s_cbranch_scc1 chk_21
    s_mov_b64 exec, -1
chk_21_ok:
    s_lshr_b64 s[54:55], s[54:55], 2
    s_add_u32 s56, s56, 2
    s_add_u32 m0, s4, 24576
    s_add_u32 s25, s61, 135168
    buffer_load_dwordx4 v14, s[28:31], s25 offen offset:0 lds
    buffer_load_dwordx4 v14, s[28:31], s25 offen offset:1024 lds
    buffer_load_dwordx4 v14, s[28:31], s25 offen offset:2048 lds
    s_waitcnt vmcnt(21) lgkmcnt(0)
    s_barrier
    s_add_u32 m0, s24, 16384
    s_add_u32 s44, s60, 4128768
    buffer_load_dwordx4 v9, s[32:35], s44 offen offset:0 lds
    s_add_u32 s45, s60, 4164608
    buffer_load_dwordx4 v9, s[32:35], s45 offen offset:1024 lds
    s_add_u32 s46, s60, 4200448
    buffer_load_dwordx4 v10, s[32:35], s46 offen offset:2048 lds
    s_add_u32 s44, s60, 4236288
    buffer_load_dwordx4 v10, s[32:35], s44 offen offset:3072 lds
    s_and_b32 s25, s54, 3
    s_cmp_eq_u32 s25, 3
    s_cbranch_scc1 chk_22_ok
    s_mov_b32 s51, 0
chk_22:
    buffer_load_dword v3, v2, s[28:31], s50 offen sc1
    s_add_u32 s51, s51, 1
    s_mov_b64 exec, -1
    s_waitcnt vmcnt(0)
    v_cmp_ne_u32 vcc, 0, v3
    s_nop 0
    s_lshr_b64 s[54:55], vcc, s56
    s_and_b32 s25, s54, 3
    s_cmp_eq_u32 s25, 3
    s_cbranch_scc1 chk_22_ok
    s_sleep 1
    s_lshl_b64 exec, 0xff, s56
    s_cmp_lt_u32 s51, 30000
    s_cbranch_scc1 chk_22
    s_mov_b64 exec, -1
chk_22_ok:
    s_lshr_b64 s[54:55], s[54:55], 2
    s_add_u32 s56, s56, 2
    s_add_u32 m0, s4, 36864
    s_add_u32 s25, s61, 147456
    buffer_load_dwordx4 v14, s[28:31], s25 offen offset:0 lds
    buffer_load_dwordx4 v14, s[28:31], s25 offen offset:1024 lds
    buffer_load_dwordx4 v14, s[28:31], s25 offen offset:2048 lds
    s_waitcnt vmcnt(21) lgkmcnt(0)
    s_barrier
    s_add_u32 m0, s24, 32768
    s_add_u32 s44, s60, 4718592
    buffer_load_dwordx4 v9, s[32:35], s44 offen offset:0 lds
    s_add_u32 s45, s60, 4754432
    buffer_load_dwordx4 v9, s[32:35], s45 offen offset:1024 lds
    s_add_u32 s46, s60, 4790272
    buffer_load_dwordx4 v10, s[32:35], s46 offen offset:2048 lds
    s_add_u32 s44, s60, 4826112
    buffer_load_dwordx4 v10, s[32:35], s44 offen offset:3072 lds
    s_and_b32 s25, s54, 3
    s_cmp_eq_u32 s25, 3
    s_cbranch_scc1 chk_23_ok
    s_mov_b32 s51, 0
chk_23:
    buffer_load_dword v3, v2, s[28:31], s50 offen sc1
    s_add_u32 s51, s51, 1
    s_mov_b64 exec, -1
    s_waitcnt vmcnt(0)
    v_cmp_ne_u32 vcc, 0, v3
    s_nop 0
    s_lshr_b64 s[54:55], vcc, s56
    s_and_b32 s25, s54, 3
    s_cmp_eq_u32 s25, 3
    s_cbranch_scc1 chk_23_ok
    s_sleep 1
    s_lshl_b64 exec, 0xff, s56
    s_cmp_lt_u32 s51, 30000
    s_cbranch_scc1 chk_23
    s_mov_b64 exec, -1
chk_23_ok:
    s_lshr_b64 s[54:55], s[54:55], 2
    s_add_u32 s56, s56, 2
    s_add_u32 m0, s4, 49152
    s_add_u32 s25, s61, 159744
    buffer_load_dwordx4 v14, s[28:31], s25 offen offset:0 lds
    buffer_load_dwordx4 v14, s[28:31], s25 offen offset:1024 lds
    buffer_load_dwordx4 v14, s[28:31], s25 offen offset:2048 lds
    s_waitcnt vmcnt(21) lgkmcnt(0)
    s_barrier
    s_add_u32 m0, s24, 49152
    s_add_u32 s44, s60, 5308416
    buffer_load_dwordx4 v9, s[32:35], s44 offen offset:0 lds
    s_add_u32 s45, s60, 5344256
    buffer_load_dwordx4 v9, s[32:35], s45 offen offset:1024 lds
    s_add_u32 s46, s60, 5380096
    buffer_load_dwordx4 v10, s[32:35], s46 offen offset:2048 lds
    s_add_u32 s44, s60, 5415936
    buffer_load_dwordx4 v10, s[32:35], s44 offen offset:3072 lds
    s_and_b32 s25, s54, 3
    s_cmp_eq_u32 s25, 3
    s_cbranch_scc1 chk_24_ok
    s_mov_b32 s51, 0
chk_24:
    buffer_load_dword v3, v2, s[28:31], s50 offen sc1
    s_add_u32 s51, s51, 1
    s_mov_b64 exec, -1
    s_waitcnt vmcnt(0)
    v_cmp_ne_u32 vcc, 0, v3
    s_nop 0
    s_lshr_b64 s[54:55], vcc, s56
    s_and_b32 s25, s54, 3
    s_cmp_eq_u32 s25, 3
    s_cbranch_scc1 chk_24_ok
    s_sleep 1
    s_lshl_b64 exec, 0xff, s56
    s_cmp_lt_u32 s51, 30000
    s_cbranch_scc1 chk_24
    s_mov_b64 exec, -1
chk_24_ok:
    s_lshr_b64 s[54:55], s[54:55], 2
    s_add_u32 s56, s56, 2
    s_add_u32 m0, s4, 0
    s_add_u32 s25, s61, 172032
    buffer_load_dwordx4 v14, s[28:31], s25 offen offset:0 lds
    buffer_load_dwordx4 v14, s[28:31], s25 offen offset:1024 lds
    buffer_load_dwordx4 v14, s[28:31], s25 offen offset:2048 lds
    s_waitcnt vmcnt(21) lgkmcnt(0)
    s_barrier
    s_add_u32 m0, s24, 65536
    s_add_u32 s44, s60, 5898240
    buffer_load_dwordx4 v9, s[32:35], s44 offen offset:0 lds
    s_add_u32 s45, s60, 5934080
    buffer_load_dwordx4 v9, s[32:35], s45 offen offset:1024 lds
    s_add_u32 s46, s60, 5969920
    buffer_load_dwordx4 v10, s[32:35], s46 offen offset:2048 lds
    s_add_u32 s44, s60, 6005760
    buffer_load_dwordx4 v10, s[32:35], s44 offen offset:3072 lds
    s_and_b32 s25, s54, 3
    s_cmp_eq_u32 s25, 3
    s_cbranch_scc1 chk_25_ok
    s_mov_b32 s51, 0
chk_25:
    buffer_load_dword v3, v2, s[28:31], s50 offen sc1
    s_add_u32 s51, s51, 1
    s_mov_b64 exec, -1
    s_waitcnt vmcnt(0)
    v_cmp_ne_u32 vcc, 0, v3
    s_nop 0
    s_lshr_b64 s[54:55], vcc, s56
    s_and_b32 s25, s54, 3
    s_cmp_eq_u32 s25, 3
    s_cbranch_scc1 chk_25_ok
    s_sleep 1
    s_lshl_b64 exec, 0xff, s56
    s_cmp_lt_u32 s51, 30000
    s_cbranch_scc1 chk_25
    s_mov_b64 exec, -1
chk_25_ok:
    s_lshr_b64 s[54:55], s[54:55], 2
    s_add_u32 s56, s56, 2
    s_add_u32 m0, s4, 12288
    s_add_u32 s25, s61, 184320
    buffer_load_dwordx4 v14, s[28:31], s25 offen offset:0 lds
    buffer_load_dwordx4 v14, s[28:31], s25 offen offset:1024 lds
    buffer_load_dwordx4 v14, s[28:31], s25 offen offset:2048 lds
    s_waitcnt vmcnt(21) lgkmcnt(0)
    s_barrier
    s_add_u32 m0, s24, 81920
    s_add_u32 s44, s60, 6488064
    buffer_load_dwordx4 v9, s[32:35], s44 offen offset:0 lds
    s_add_u32 s45, s60, 6523904
    buffer_load_dwordx4 v9, s[32:35], s45 offen offset:1024 lds
    s_add_u32 s46, s60, 6559744
    buffer_load_dwordx4 v10, s[32:35], s46 offen offset:2048 lds
    s_add_u32 s44, s60, 6595584
    buffer_load_dwordx4 v10, s[32:35], s44 offen offset:3072 lds
    s_and_b32 s25, s54, 3
    s_cmp_eq_u32 s25, 3
    s_cbranch_scc1 chk_26_ok
    s_mov_b32 s51, 0
chk_26:
    buffer_load_dword v3, v2, s[28:31], s50 offen sc1
    s_add_u32 s51, s51, 1
    s_mov_b64 exec, -1
    s_waitcnt vmcnt(0)
    v_cmp_ne_u32 vcc, 0, v3
    s_nop 0
    s_lshr_b64 s[54:55], vcc, s56
    s_and_b32 s25, s54, 3
    s_cmp_eq_u32 s25, 3
    s_cbranch_scc1 chk_26_ok
    s_sleep 1
    s_lshl_b64 exec, 0xff, s56
    s_cmp_lt_u32 s51, 30000
    s_cbranch_scc1 chk_26
    s_mov_b64 exec, -1
chk_26_ok:
    s_lshr_b64 s[54:55], s[54:55], 2
    s_add_u32 s56, s56, 2
    s_add_u32 m0, s4, 24576
    s_add_u32 s25, s61, 196608
    buffer_load_dwordx4 v14, s[28:31], s25 offen offset:0 lds
    buffer_load_dwordx4 v14, s[28:31], s25 offen offset:1024 lds
    buffer_load_dwordx4 v14, s[28:31], s25 offen offset:2048 lds
    s_waitcnt vmcnt(21) lgkmcnt(0)
    s_barrier
    s_add_u32 m0, s24, 0
    s_add_u32 s44, s60, 7077888
    buffer_load_dwordx4 v9, s[32:35], s44 offen offset:0 lds
    s_add_u32 s45, s60, 7113728
    buffer_load_dwordx4 v9, s[32:35], s45 offen offset:1024 lds
    s_add_u32 s46, s60, 7149568
    buffer_load_dwordx4 v10, s[32:35], s46 offen offset:2048 lds
    s_add_u32 s44, s60, 7185408
    buffer_load_dwordx4 v10, s[32:35], s44 offen offset:3072 lds
    s_and_b32 s25, s54, 3
    s_cmp_eq_u32 s25, 3
    s_cbranch_scc1 chk_27_ok
    s_mov_b32 s51, 0
chk_27:
    buffer_load_dword v3, v2, s[28:31], s50 offen sc1
    s_add_u32 s51, s51, 1
    s_mov_b64 exec, -1
    s_waitcnt vmcnt(0)
    v_cmp_ne_u32 vcc, 0, v3
    s_nop 0
    s_lshr_b64 s[54:55], vcc, s56
    s_and_b32 s25, s54, 3
    s_cmp_eq_u32 s25, 3
    s_cbranch_scc1 chk_27_ok
    s_sleep 1
    s_lshl_b64 exec, 0xff, s56
    s_cmp_lt_u32 s51, 30000
    s_cbranch_scc1 chk_27
    s_mov_b64 exec, -1
chk_27_ok:
    s_lshr_b64 s[54:55], s[54:55], 2
    s_add_u32 s56, s56, 2
    s_add_u32 m0, s4, 36864
    s_add_u32 s25, s61, 208896
    buffer_load_dwordx4 v14, s[28:31], s25 offen offset:0 lds
    buffer_load_dwordx4 v14, s[28:31], s25 offen offset:1024 lds
    buffer_load_dwordx4 v14, s[28:31], s25 offen offset:2048 lds
    s_waitcnt vmcnt(21) lgkmcnt(0)
    s_barrier
    s_add_u32 m0, s24, 16384
    s_add_u32 s44, s60, 7667712
    buffer_load_dwordx4 v9, s[32:35], s44 offen offset:0 lds
    s_add_u32 s45, s60, 7703552
    buffer_load_dwordx4 v9, s[32:35], s45 offen offset:1024 lds
    s_add_u32 s46, s60, 7739392
    buffer_load_dwordx4 v10, s[32:35], s46 offen offset:2048 lds
    s_add_u32 s44, s60, 7775232
    buffer_load_dwordx4 v10, s[32:35], s44 offen offset:3072 lds
    s_and_b32 s25, s54, 3
    s_cmp_eq_u32 s25, 3
    s_cbranch_scc1 chk_28_ok
    s_mov_b32 s51, 0
chk_28:
    buffer_load_dword v3, v2, s[28:31], s50 offen sc1
    s_add_u32 s51, s51, 1
    s_mov_b64 exec, -1
    s_waitcnt vmcnt(0)
    v_cmp_ne_u32 vcc, 0, v3
    s_nop 0
    s_lshr_b64 s[54:55], vcc, s56
    s_and_b32 s25, s54, 3
    s_cmp_eq_u32 s25, 3
    s_cbranch_scc1 chk_28_ok
    s_sleep 1
    s_lshl_b64 exec, 0xff, s56
    s_cmp_lt_u32 s51, 30000
    s_cbranch_scc1 chk_28
    s_mov_b64 exec, -1
chk_28_ok:
    s_lshr_b64 s[54:55], s[54:55], 2
    s_add_u32 s56, s56, 2
    s_add_u32 m0, s4, 49152
    s_add_u32 s25, s61, 221184
    buffer_load_dwordx4 v14, s[28:31], s25 offen offset:0 lds
    buffer_load_dwordx4 v14, s[28:31], s25 offen offset:1024 lds
    buffer_load_dwordx4 v14, s[28:31], s25 offen offset:2048 lds
    s_waitcnt vmcnt(21) lgkmcnt(0)
    s_barrier
    s_add_u32 m0, s24, 32768
    s_add_u32 s44, s60, 8257536
    buffer_load_dwordx4 v9, s[32:35], s44 offen offset:0 lds
    s_add_u32 s45, s60, 8293376
    buffer_load_dwordx4 v9, s[32:35], s45 offen offset:1024 lds
    s_add_u32 s46, s60, 8329216
    buffer_load_dwordx4 v10, s[32:35], s46 offen offset:2048 lds
    s_add_u32 s44, s60, 8365056
    buffer_load_dwordx4 v10, s[32:35], s44 offen offset:3072 lds
    s_and_b32 s25, s54, 3
    s_cmp_eq_u32 s25, 3
    s_cbranch_scc1 chk_29_ok
    s_mov_b32 s51, 0
chk_29:
    buffer_load_dword v3, v2, s[28:31], s50 offen sc1
    s_add_u32 s51, s51, 1
    s_mov_b64 exec, -1
    s_waitcnt vmcnt(0)
    v_cmp_ne_u32 vcc, 0, v3
    s_nop 0
    s_lshr_b64 s[54:55], vcc, s56
    s_and_b32 s25, s54, 3
    s_cmp_eq_u32 s25, 3
    s_cbranch_scc1 chk_29_ok
    s_sleep 1
    s_lshl_b64 exec, 0xff, s56
    s_cmp_lt_u32 s51, 30000
    s_cbranch_scc1 chk_29
    s_mov_b64 exec, -1
chk_29_ok:
    s_lshr_b64 s[54:55], s[54:55], 2
    s_add_u32 s56, s56, 2
    s_add_u32 m0, s4, 0
    s_add_u32 s25, s61, 233472
    buffer_load_dwordx4 v14, s[28:31], s25 offen offset:0 lds
    buffer_load_dwordx4 v14, s[28:31], s25 offen offset:1024 lds
    buffer_load_dwordx4 v14, s[28:31], s25 offen offset:2048 lds
    s_waitcnt vmcnt(21) lgkmcnt(0)
    s_barrier
    s_add_u32 m0, s24, 49152
    s_add_u32 s44, s60, 8847360
    buffer_load_dwordx4 v9, s[32:35], s44 offen offset:0 lds
    s_add_u32 s45, s60, 8883200
    buffer_load_dwordx4 v9, s[32:35], s45 offen offset:1024 lds
    s_add_u32 s46, s60, 8919040
    buffer_load_dwordx4 v10, s[32:35], s46 offen offset:2048 lds
    s_add_u32 s44, s60, 8954880
    buffer_load_dwordx4 v10, s[32:35], s44 offen offset:3072 lds
    s_and_b32 s25, s54, 3
    s_cmp_eq_u32 s25, 3
    s_cbranch_scc1 chk_30_ok
    s_mov_b32 s51, 0
chk_30:
    buffer_load_dword v3, v2, s[28:31], s50 offen sc1
    s_add_u32 s51, s51, 1
    s_mov_b64 exec, -1
    s_waitcnt vmcnt(0)
    v_cmp_ne_u32 vcc, 0, v3
    s_nop 0
    s_lshr_b64 s[54:55], vcc, s56
    s_and_b32 s25, s54, 3
    s_cmp_eq_u32 s25, 3
    s_cbranch_scc1 chk_30_ok
    s_sleep 1
    s_lshl_b64 exec, 0xff, s56
    s_cmp_lt_u32 s51, 30000
    s_cbranch_scc1 chk_30
    s_mov_b64 exec, -1
chk_30_ok:
    s_lshr_b64 s[54:55], s[54:55], 2
    s_add_u32 s56, s56, 2
    s_add_u32 m0, s4, 12288
    s_add_u32 s25, s61, 245760
    buffer_load_dwordx4 v14, s[28:31], s25 offen offset:0 lds
    buffer_load_dwordx4 v14, s[28:31], s25 offen offset:1024 lds
    buffer_load_dwordx4 v14, s[28:31], s25 offen offset:2048 lds
    s_waitcnt vmcnt(21) lgkmcnt(0)
    s_barrier
    s_add_u32 m0, s24, 65536
    s_add_u32 s44, s60, 9437184
    buffer_load_dwordx4 v9, s[32:35], s44 offen offset:0 lds
    s_add_u32 s45, s60, 9473024
    buffer_load_dwordx4 v9, s[32:35], s45 offen offset:1024 lds
    s_add_u32 s46, s60, 9508864
    buffer_load_dwordx4 v10, s[32:35], s46 offen offset:2048 lds
    s_add_u32 s44, s60, 9544704
    buffer_load_dwordx4 v10, s[32:35], s44 offen offset:3072 lds
    s_and_b32 s25, s54, 3
    s_cmp_eq_u32 s25, 3
    s_cbranch_scc1 chk_31_ok
    s_mov_b32 s51, 0
chk_31:
    buffer_load_dword v3, v2, s[28:31], s50 offen sc1
    s_add_u32 s51, s51, 1
    s_mov_b64 exec, -1
    s_waitcnt vmcnt(0)
    v_cmp_ne_u32 vcc, 0, v3
    s_nop 0
    s_lshr_b64 s[54:55], vcc, s56
    s_and_b32 s25, s54, 3
    s_cmp_eq_u32 s25, 3
    s_cbranch_scc1 chk_31_ok
    s_sleep 1
    s_lshl_b64 exec, 0xff, s56
    s_cmp_lt_u32 s51, 30000
    s_cbranch_scc1 chk_31
    s_mov_b64 exec, -1
chk_31_ok:
    s_lshr_b64 s[54:55], s[54:55], 2
    s_add_u32 s56, s56, 2
    s_add_u32 m0, s4, 24576
    s_add_u32 s25, s61, 258048
    buffer_load_dwordx4 v14, s[28:31], s25 offen offset:0 lds
    buffer_load_dwordx4 v14, s[28:31], s25 offen offset:1024 lds
    buffer_load_dwordx4 v14, s[28:31], s25 offen offset:2048 lds
    s_waitcnt vmcnt(21) lgkmcnt(0)
    s_barrier
    s_add_u32 m0, s24, 81920
    s_add_u32 s44, s60, 10027008
    buffer_load_dwordx4 v9, s[32:35], s44 offen offset:0 lds
    s_add_u32 s45, s60, 10062848
    buffer_load_dwordx4 v9, s[32:35], s45 offen offset:1024 lds
    s_add_u32 s46, s60, 10098688
    buffer_load_dwordx4 v10, s[32:35], s46 offen offset:2048 lds
    s_add_u32 s44, s60, 10134528
    buffer_load_dwordx4 v10, s[32:35], s44 offen offset:3072 lds
    s_and_b32 s25, s54, 3
    s_cmp_eq_u32 s25, 3
    s_cbranch_scc1 chk_32_ok
    s_mov_b32 s51, 0
chk_32:
    buffer_load_dword v3, v2, s[28:31], s50 offen sc1
    s_add_u32 s51, s51, 1
    s_mov_b64 exec, -1
    s_waitcnt vmcnt(0)
    v_cmp_ne_u32 vcc, 0, v3
    s_nop 0
    s_lshr_b64 s[54:55], vcc, s56
    s_and_b32 s25, s54, 3
    s_cmp_eq_u32 s25, 3
    s_cbranch_scc1 chk_32_ok
    s_sleep 1
    s_lshl_b64 exec, 0xff, s56
    s_cmp_lt_u32 s51, 30000
    s_cbranch_scc1 chk_32
    s_mov_b64 exec, -1
chk_32_ok:
    s_lshr_b64 s[54:55], s[54:55], 2
    s_add_u32 s56, s56, 2
    s_add_u32 m0, s4, 36864
    s_add_u32 s25, s61, 270336
    buffer_load_dwordx4 v14, s[28:31], s25 offen offset:0 lds
    buffer_load_dwordx4 v14, s[28:31], s25 offen offset:1024 lds
    buffer_load_dwordx4 v14, s[28:31], s25 offen offset:2048 lds
    s_waitcnt vmcnt(21) lgkmcnt(0)
    s_barrier
    s_add_u32 m0, s24, 0
    s_add_u32 s44, s60, 10616832
    buffer_load_dwordx4 v9, s[32:35], s44 offen offset:0 lds
    s_add_u32 s45, s60, 10652672
    buffer_load_dwordx4 v9, s[32:35], s45 offen offset:1024 lds
    s_add_u32 s46, s60, 10688512
    buffer_load_dwordx4 v10, s[32:35], s46 offen offset:2048 lds
    s_add_u32 s44, s60, 10724352
    buffer_load_dwordx4 v10, s[32:35], s44 offen offset:3072 lds
    s_and_b32 s25, s54, 3
    s_cmp_eq_u32 s25, 3
    s_cbranch_scc1 chk_33_ok
    s_mov_b32 s51, 0
chk_33:
    buffer_load_dword v3, v2, s[28:31], s50 offen sc1
    s_add_u32 s51, s51, 1
    s_mov_b64 exec, -1
    s_waitcnt vmcnt(0)
    v_cmp_ne_u32 vcc, 0, v3
    s_nop 0
    s_lshr_b64 s[54:55], vcc, s56
    s_and_b32 s25, s54, 3
    s_cmp_eq_u32 s25, 3
    s_cbranch_scc1 chk_33_ok
    s_sleep 1
    s_lshl_b64 exec, 0xff, s56
    s_cmp_lt_u32 s51, 30000
    s_cbranch_scc1 chk_33
    s_mov_b64 exec, -1
chk_33_ok:
    s_lshr_b64 s[54:55], s[54:55], 2
    s_add_u32 s56, s56, 2
    s_add_u32 m0, s4, 49152
    s_add_u32 s25, s61, 282624
    buffer_load_dwordx4 v14, s[28:31], s25 offen offset:0 lds
    buffer_load_dwordx4 v14, s[28:31], s25 offen offset:1024 lds
    buffer_load_dwordx4 v14, s[28:31], s25 offen offset:2048 lds
    s_waitcnt vmcnt(21) lgkmcnt(0)
    s_barrier
    s_add_u32 m0, s24, 16384
    s_add_u32 s44, s60, 11206656
    buffer_load_dwordx4 v9, s[32:35], s44 offen offset:0 lds
    s_add_u32 s45, s60, 11242496
    buffer_load_dwordx4 v9, s[32:35], s45 offen offset:1024 lds
    s_add_u32 s46, s60, 11278336
    buffer_load_dwordx4 v10, s[32:35], s46 offen offset:2048 lds
    s_add_u32 s44, s60, 11314176
    buffer_load_dwordx4 v10, s[32:35], s44 offen offset:3072 lds
    s_and_b32 s25, s54, 3
    s_cmp_eq_u32 s25, 3
    s_cbranch_scc1 chk_34_ok
    s_mov_b32 s51, 0
chk_34:
    buffer_load_dword v3, v2, s[28:31], s50 offen sc1
    s_add_u32 s51, s51, 1
    s_mov_b64 exec, -1
    s_waitcnt vmcnt(0)
    v_cmp_ne_u32 vcc, 0, v3
    s_nop 0
    s_lshr_b64 s[54:55], vcc, s56
    s_and_b32 s25, s54, 3
    s_cmp_eq_u32 s25, 3
    s_cbranch_scc1 chk_34_ok
    s_sleep 1
    s_lshl_b64 exec, 0xff, s56
    s_cmp_lt_u32 s51, 30000
    s_cbranch_scc1 chk_34
    s_mov_b64 exec, -1
chk_34_ok:
    s_lshr_b64 s[54:55], s[54:55], 2
    s_add_u32 s56, s56, 2
    s_add_u32 m0, s4, 0
    s_add_u32 s25, s61, 294912
    buffer_load_dwordx4 v14, s[28:31], s25 offen offset:0 lds
    buffer_load_dwordx4 v14, s[28:31], s25 offen offset:1024 lds
    buffer_load_dwordx4 v14, s[28:31], s25 offen offset:2048 lds
    s_waitcnt vmcnt(21) lgkmcnt(0)
    s_barrier
    s_add_u32 m0, s24, 32768
    s_add_u32 s44, s60, 11796480
    buffer_load_dwordx4 v9, s[32:35], s44 offen offset:0 lds
    s_add_u32 s45, s60, 11832320
    buffer_load_dwordx4 v9, s[32:35], s45 offen offset:1024 lds
    s_add_u32 s46, s60, 11868160
    buffer_load_dwordx4 v10, s[32:35], s46 offen offset:2048 lds
    s_add_u32 s44, s60, 11904000
    buffer_load_dwordx4 v10, s[32:35], s44 offen offset:3072 lds
    s_and_b32 s25, s54, 3
    s_cmp_eq_u32 s25, 3
    s_cbranch_scc1 chk_35_ok
    s_mov_b32 s51, 0
chk_35:
    buffer_load_dword v3, v2, s[28:31], s50 offen sc1
    s_add_u32 s51, s51, 1
    s_mov_b64 exec, -1
    s_waitcnt vmcnt(0)
    v_cmp_ne_u32 vcc, 0, v3
    s_nop 0
    s_lshr_b64 s[54:55], vcc, s56
    s_and_b32 s25, s54, 3
    s_cmp_eq_u32 s25, 3
    s_cbranch_scc1 chk_35_ok
    s_sleep 1
    s_lshl_b64 exec, 0xff, s56
    s_cmp_lt_u32 s51, 30000
    s_cbranch_scc1 chk_35
    s_mov_b64 exec, -1
chk_35_ok:
    s_lshr_b64 s[54:55], s[54:55], 2
    s_add_u32 s56, s56, 2
    s_add_u32 m0, s4, 12288
    s_add_u32 s25, s61, 307200
    buffer_load_dwordx4 v14, s[28:31], s25 offen offset:0 lds
    buffer_load_dwordx4 v14, s[28:31], s25 offen offset:1024 lds
    buffer_load_dwordx4 v14, s[28:31], s25 offen offset:2048 lds
    s_waitcnt vmcnt(21) lgkmcnt(0)
    s_barrier
    s_add_u32 m0, s24, 49152
    s_add_u32 s44, s60, 12386304
    buffer_load_dwordx4 v9, s[32:35], s44 offen offset:0 lds
    s_add_u32 s45, s60, 12422144
    buffer_load_dwordx4 v9, s[32:35], s45 offen offset:1024 lds
    s_add_u32 s46, s60, 12457984
    buffer_load_dwordx4 v10, s[32:35], s46 offen offset:2048 lds
    s_add_u32 s44, s60, 12493824
    buffer_load_dwordx4 v10, s[32:35], s44 offen offset:3072 lds
    s_and_b32 s25, s54, 3
    s_cmp_eq_u32 s25, 3
    s_cbranch_scc1 chk_36_ok
    s_mov_b32 s51, 0
chk_36:
    buffer_load_dword v3, v2, s[28:31], s50 offen sc1
    s_add_u32 s51, s51, 1
    s_mov_b64 exec, -1
    s_waitcnt vmcnt(0)
    v_cmp_ne_u32 vcc, 0, v3
    s_nop 0
    s_lshr_b64 s[54:55], vcc, s56
    s_and_b32 s25, s54, 3
    s_cmp_eq_u32 s25, 3
    s_cbranch_scc1 chk_36_ok
    s_sleep 1
    s_lshl_b64 exec, 0xff, s56
    s_cmp_lt_u32 s51, 30000
    s_cbranch_scc1 chk_36
    s_mov_b64 exec, -1
chk_36_ok:
    s_lshr_b64 s[54:55], s[54:55], 2
    s_add_u32 s56, s56, 2
    s_add_u32 m0, s4, 24576
    s_add_u32 s25, s61, 319488
    buffer_load_dwordx4 v14, s[28:31], s25 offen offset:0 lds
    buffer_load_dwordx4 v14, s[28:31], s25 offen offset:1024 lds
    buffer_load_dwordx4 v14, s[28:31], s25 offen offset:2048 lds
    s_waitcnt vmcnt(21) lgkmcnt(0)
    s_barrier
    s_add_u32 m0, s24, 65536
    s_add_u32 s44, s60, 12976128
    buffer_load_dwordx4 v9, s[32:35], s44 offen offset:0 lds
    s_add_u32 s45, s60, 13011968
    buffer_load_dwordx4 v9, s[32:35], s45 offen offset:1024 lds
    s_add_u32 s46, s60, 13047808
    buffer_load_dwordx4 v10, s[32:35], s46 offen offset:2048 lds
    s_add_u32 s44, s60, 13083648
    buffer_load_dwordx4 v10, s[32:35], s44 offen offset:3072 lds
    s_and_b32 s25, s54, 3
    s_cmp_eq_u32 s25, 3
    s_cbranch_scc1 chk_37_ok
    s_mov_b32 s51, 0
chk_37:
    buffer_load_dword v3, v2, s[28:31], s50 offen sc1
    s_add_u32 s51, s51, 1
    s_mov_b64 exec, -1
    s_waitcnt vmcnt(0)
    v_cmp_ne_u32 vcc, 0, v3
    s_nop 0
    s_lshr_b64 s[54:55], vcc, s56
    s_and_b32 s25, s54, 3
    s_cmp_eq_u32 s25, 3
    s_cbranch_scc1 chk_37_ok
    s_sleep 1
    s_lshl_b64 exec, 0xff, s56
    s_cmp_lt_u32 s51, 30000
    s_cbranch_scc1 chk_37
    s_mov_b64 exec, -1
chk_37_ok:
    s_lshr_b64 s[54:55], s[54:55], 2
    s_add_u32 s56, s56, 2
    s_add_u32 m0, s4, 36864
    s_add_u32 s25, s61, 331776
    buffer_load_dwordx4 v14, s[28:31], s25 offen offset:0 lds
    buffer_load_dwordx4 v14, s[28:31], s25 offen offset:1024 lds
    buffer_load_dwordx4 v14, s[28:31], s25 offen offset:2048 lds
    s_waitcnt vmcnt(21) lgkmcnt(0)
    s_barrier
    s_add_u32 m0, s24, 81920
    s_add_u32 s44, s60, 13565952
    buffer_load_dwordx4 v9, s[32:35], s44 offen offset:0 lds
    s_add_u32 s45, s60, 13601792
    buffer_load_dwordx4 v9, s[32:35], s45 offen offset:1024 lds
    s_add_u32 s46, s60, 13637632
    buffer_load_dwordx4 v10, s[32:35], s46 offen offset:2048 lds
    s_add_u32 s44, s60, 13673472
    buffer_load_dwordx4 v10, s[32:35], s44 offen offset:3072 lds
    s_and_b32 s25, s54, 3
    s_cmp_eq_u32 s25, 3
    s_cbranch_scc1 chk_38_ok
    s_mov_b32 s51, 0
chk_38:
    buffer_load_dword v3, v2, s[28:31], s50 offen sc1
    s_add_u32 s51, s51, 1
    s_mov_b64 exec, -1
    s_waitcnt vmcnt(0)
    v_cmp_ne_u32 vcc, 0, v3
    s_nop 0
    s_lshr_b64 s[54:55], vcc, s56
    s_and_b32 s25, s54, 3
    s_cmp_eq_u32 s25, 3
    s_cbranch_scc1 chk_38_ok
    s_sleep 1
    s_lshl_b64 exec, 0xff, s56
    s_cmp_lt_u32 s51, 30000
    s_cbranch_scc1 chk_38
    s_mov_b64 exec, -1
chk_38_ok:
    s_lshr_b64 s[54:55], s[54:55], 2
    s_add_u32 s56, s56, 2
    s_add_u32 m0, s4, 49152
    s_add_u32 s25, s61, 344064
    buffer_load_dwordx4 v14, s[28:31], s25 offen offset:0 lds
    buffer_load_dwordx4 v14, s[28:31], s25 offen offset:1024 lds
    buffer_load_dwordx4 v14, s[28:31], s25 offen offset:2048 lds
    s_waitcnt vmcnt(21) lgkmcnt(0)
    s_barrier
    s_add_u32 m0, s24, 0
    s_add_u32 s44, s60, 14155776
    buffer_load_dwordx4 v9, s[32:35], s44 offen offset:0 lds
    s_add_u32 s45, s60, 14191616
    buffer_load_dwordx4 v9, s[32:35], s45 offen offset:1024 lds
    s_add_u32 s46, s60, 14227456
    buffer_load_dwordx4 v10, s[32:35], s46 offen offset:2048 lds
    s_add_u32 s44, s60, 14263296
    buffer_load_dwordx4 v10, s[32:35], s44 offen offset:3072 lds
    s_and_b32 s25, s54, 3
    s_cmp_eq_u32 s25, 3
    s_cbranch_scc1 chk_39_ok
    s_mov_b32 s51, 0
chk_39:
    buffer_load_dword v3, v2, s[28:31], s50 offen sc1
    s_add_u32 s51, s51, 1
    s_mov_b64 exec, -1
    s_waitcnt vmcnt(0)
    v_cmp_ne_u32 vcc, 0, v3
    s_nop 0
    s_lshr_b64 s[54:55], vcc, s56
    s_and_b32 s25, s54, 3
    s_cmp_eq_u32 s25, 3
    s_cbranch_scc1 chk_39_ok
    s_sleep 1
    s_lshl_b64 exec, 0xff, s56
    s_cmp_lt_u32 s51, 30000
    s_cbranch_scc1 chk_39
    s_mov_b64 exec, -1
chk_39_ok:
    s_lshr_b64 s[54:55], s[54:55], 2
    s_add_u32 s56, s56, 2
    s_add_u32 m0, s4, 0
    s_add_u32 s25, s61, 356352
    buffer_load_dwordx4 v14, s[28:31], s25 offen offset:0 lds
    buffer_load_dwordx4 v14, s[28:31], s25 offen offset:1024 lds
    buffer_load_dwordx4 v14, s[28:31], s25 offen offset:2048 lds
    s_waitcnt vmcnt(21) lgkmcnt(0)
    s_barrier
    s_add_u32 m0, s24, 16384
    s_add_u32 s44, s60, 14745600
    buffer_load_dwordx4 v9, s[32:35], s44 offen offset:0 lds
    s_add_u32 s45, s60, 14781440
    buffer_load_dwordx4 v9, s[32:35], s45 offen offset:1024 lds
    s_add_u32 s46, s60, 14817280
    buffer_load_dwordx4 v10, s[32:35], s46 offen offset:2048 lds
    s_add_u32 s44, s60, 14853120
    buffer_load_dwordx4 v10, s[32:35], s44 offen offset:3072 lds
    s_and_b32 s25, s54, 3
    s_cmp_eq_u32 s25, 3
    s_cbranch_scc1 chk_40_ok
    s_mov_b32 s51, 0
chk_40:
    buffer_load_dword v3, v2, s[28:31], s50 offen sc1
    s_add_u32 s51, s51, 1
    s_mov_b64 exec, -1
    s_waitcnt vmcnt(0)
    v_cmp_ne_u32 vcc, 0, v3
    s_nop 0
    s_lshr_b64 s[54:55], vcc, s56
    s_and_b32 s25, s54, 3
    s_cmp_eq_u32 s25, 3
    s_cbranch_scc1 chk_40_ok
    s_sleep 1
    s_lshl_b64 exec, 0xff, s56
    s_cmp_lt_u32 s51, 30000
    s_cbranch_scc1 chk_40
    s_mov_b64 exec, -1
chk_40_ok:
    s_lshr_b64 s[54:55], s[54:55], 2
    s_add_u32 s56, s56, 2
    s_add_u32 m0, s4, 12288
    s_add_u32 s25, s61, 368640
    buffer_load_dwordx4 v14, s[28:31], s25 offen offset:0 lds
    buffer_load_dwordx4 v14, s[28:31], s25 offen offset:1024 lds
    buffer_load_dwordx4 v14, s[28:31], s25 offen offset:2048 lds
    s_waitcnt vmcnt(21) lgkmcnt(0)
    s_barrier
    s_and_b32 s25, s54, 3
    s_cmp_eq_u32 s25, 3
    s_cbranch_scc1 chk_41_ok
    s_mov_b32 s51, 0
chk_41:
    buffer_load_dword v3, v2, s[28:31], s50 offen sc1
    s_add_u32 s51, s51, 1
    s_mov_b64 exec, -1
    s_waitcnt vmcnt(0)
    v_cmp_ne_u32 vcc, 0, v3
    s_nop 0
    s_lshr_b64 s[54:55], vcc, s56
    s_and_b32 s25, s54, 3
    s_cmp_eq_u32 s25, 3
    s_cbranch_scc1 chk_41_ok
    s_sleep 1
    s_lshl_b64 exec, 0xff, s56
    s_cmp_lt_u32 s51, 30000
    s_cbranch_scc1 chk_41
    s_mov_b64 exec, -1
chk_41_ok:
    s_lshr_b64 s[54:55], s[54:55], 2
    s_add_u32 s56, s56, 2
    s_add_u32 m0, s4, 24576
    s_add_u32 s25, s61, 380928
    buffer_load_dwordx4 v14, s[28:31], s25 offen offset:0 lds
    buffer_load_dwordx4 v14, s[28:31], s25 offen offset:1024 lds
    buffer_load_dwordx4 v14, s[28:31], s25 offen offset:2048 lds
    s_waitcnt vmcnt(17) lgkmcnt(0)
    s_barrier
    s_waitcnt vmcnt(10) lgkmcnt(0)
    s_barrier
    s_waitcnt vmcnt(3) lgkmcnt(0)
    s_barrier
    s_waitcnt vmcnt(0) lgkmcnt(0)
    s_barrier
t_ld2:
    s_lshr_b32 s44, s36, 1
    s_and_b32 s45, s36, 1
    s_lshl_b32 s45, s45, 3
    s_lshr_b32 s46, s37, 2
    s_add_u32 s45, s45, s46
    s_and_b32 s46, s37, 3
    v_lshrrev_b32 v2, 4, v1
    v_and_b32 v3, 15, v1
    v_lshlrev_b32 v9, 1, v2
    v_xor_b32 v9, v9, v3
    v_xor_b32 v10, 8, v9
    v_mul_u32_u24 v2, 4096, v2
    v_lshl_add_u32 v9, v9, 4, v2
    v_lshl_add_u32 v10, v10, 4, v2
    s_mul_i32 s52, s44, 4718592
    s_lshl_b32 s50, s45, 8
    s_add_u32 s52, s52, s50
    s_mul_i32 s50, s39, 65536
    s_add_u32 s52, s52, s50
    s_mul_i32 s53, s46, 144
    s_mul_i32 s50, s44, 36
    s_add_u32 s53, s53, s50
    s_mul_i32 s53, s53, 9216
    s_mul_i32 s4, s39, 4608
    s_add_u32 s53, s53, s4
    s_add_u32 s53, s53, 16777216
    s_add_u32 s4, s4, 81920
    s_lshl_b32 s24, s39, 12
    s_mov_b32 s6, 0x18764320
    s_mov_b32 s7, 5
    s_cmp_eq_u32 s44, 1
    s_cselect_b32 s6, 0x40765321, s6
    s_cselect_b32 s7, 8, s7
    s_cmp_eq_u32 s44, 2
    s_cselect_b32 s6, 0x38654210, s6
    s_cselect_b32 s7, 7, s7
    s_cmp_eq_u32 s44, 3
    s_cselect_b32 s6, 0x28754310, s6
    s_cselect_b32 s7, 6, s7
    v_min_u32 v2, 35, v1
    v_and_b32 v3, 1, v2
    s_mul_i32 s50, s46, 3
    s_and_b32 s51, s39, 1
    s_add_u32 s50, s50, s51
    v_add_u32 v3, s50, v3
    v_and_b32 v4, 60, v2
    v_lshrrev_b64 v[12:13], v4, s[6:7]
    v_and_b32 v4, 15, v12
    v_mul_u32_u24 v4, 6, v4
    v_lshrrev_b32 v7, 1, v3
    v_add_u32 v4, v4, v7
    v_and_b32 v3, 1, v3
    v_lshlrev_b32 v3, 1, v3
    v_bfe_u32 v2, v2, 1, 1
    v_add_u32 v3, v3, v2
    v_lshlrev_b32 v3, 7, v3
    v_lshl_add_u32 v2, v4, 10, v3
    s_mul_i32 s50, s44, 55296
    s_add_u32 s50, s50, 262528
    s_cmp_lt_u32 s2, 216
    s_cbranch_scc0 g2_ld_nobar
    s_barrier
g2_ld_nobar:
    s_bfe_u32 s5, s6, 0x40000
    s_mul_i32 s57, s5, 524288
    s_add_u32 s57, s57, s52
    s_add_u32 m0, s24, 0
    s_nop 0
    buffer_load_dwordx4 v9, s[8:11], s57 offen offset:0 lds
    s_add_u32 s26, s57, 15360
    buffer_load_dwordx4 v10, s[8:11], s26 offen offset:1024 lds
    s_add_u32 s27, s57, 30720
    buffer_load_dwordx4 v9, s[8:11], s27 offen offset:2048 lds
    s_add_u32 s25, s57, 46080
    buffer_load_dwordx4 v10, s[8:11], s25 offen offset:3072 lds
    s_add_u32 m0, s24, 16384
    s_add_u32 s25, s57, 262144
    buffer_load_dwordx4 v9, s[8:11], s25 offen offset:0 lds
    s_add_u32 s26, s57, 277504
    buffer_load_dwordx4 v10, s[8:11], s26 offen offset:1024 lds
    s_add_u32 s27, s57, 292864
    buffer_load_dwordx4 v9, s[8:11], s27 offen offset:2048 lds
    s_add_u32 s25, s57, 308224
    buffer_load_dwordx4 v10, s[8:11], s25 offen offset:3072 lds
    s_bfe_u32 s5, s6, 0x40004
    s_mul_i32 s57, s5, 524288
    s_add_u32 s57, s57, s52
    s_add_u32 m0, s24, 32768
    s_nop 0
    buffer_load_dwordx4 v9, s[8:11], s57 offen offset:0 lds
    s_add_u32 s26, s57, 15360
    buffer_load_dwordx4 v10, s[8:11], s26 offen offset:1024 lds
    s_add_u32 s27, s57, 30720
    buffer_load_dwordx4 v9, s[8:11], s27 offen offset:2048 lds
    s_add_u32 s25, s57, 46080
    buffer_load_dwordx4 v10, s[8:11], s25 offen offset:3072 lds
    s_add_u32 m0, s24, 49152
    s_add_u32 s25, s57, 262144
    buffer_load_dwordx4 v9, s[8:11], s25 offen offset:0 lds
    s_add_u32 s26, s57, 277504
    buffer_load_dwordx4 v10, s[8:11], s26 offen offset:1024 lds
    s_add_u32 s27, s57, 292864
    buffer_load_dwordx4 v9, s[8:11], s27 offen offset:2048 lds
    s_add_u32 s25, s57, 308224
    buffer_load_dwordx4 v10, s[8:11], s25 offen offset:3072 lds
    s_bfe_u32 s5, s6, 0x40008
    s_mul_i32 s57, s5, 524288
    s_add_u32 s57, s57, s52
    s_add_u32 m0, s24, 65536
    s_nop 0
    buffer_load_dwordx4 v9, s[8:11], s57 offen offset:0 lds
    s_add_u32 s26, s57, 15360
    buffer_load_dwordx4 v10, s[8:11], s26 offen offset:1024 lds
    s_add_u32 s27, s57, 30720
    buffer_load_dwordx4 v9, s[8:11], s27 offen offset:2048 lds
    s_add_u32 s25, s57, 46080
    buffer_load_dwordx4 v10, s[8:11], s25 offen offset:3072 lds
    s_cmp_lt_u32 s2, 216
    s_cbranch_scc0 g2_ld_nobar2
    s_barrier
g2_ld_nobar2:
    s_sleep 8
    s_mov_b64 s[54:55], 0
    s_mov_b32 s56, 0
    s_bfe_u32 s5, s6, 0x40000
    s_mul_i32 s58, s5, 36864
    s_add_u32 s58, s58, s53
    s_and_b32 s25, s54, 3
    s_cmp_eq_u32 s25, 3
    s_cbranch_scc1 chk_42_ok
    s_mov_b32 s51, 0
chk_42:
    buffer_load_dword v3, v2, s[28:31], s50 offen sc1
    s_add_u32 s51, s51, 1
    s_mov_b64 exec, -1
    s_waitcnt vmcnt(0)
    v_cmp_ne_u32 vcc, 0, v3
    s_nop 0
    s_lshr_b64 s[54:55], vcc, s56
    s_and_b32 s25, s54, 3
    s_cmp_eq_u32 s25, 3
    s_cbranch_scc1 chk_42_ok
    s_sleep 2
    s_lshl_b64 exec, 0xff, s56
    s_cmp_lt_u32 s51, 30000
    s_cbranch_scc1 chk_42
    s_mov_b64 exec, -1
chk_42_ok:
    s_lshr_b64 s[54:55], s[54:55], 2
    s_add_u32 s56, s56, 2
    s_add_u32 m0, s4, 0
    s_mov_b64 exec, 0xffffffff
    buffer_load_dwordx4 v14, s[28:31], s58 offen lds
    s_mov_b64 exec, -1
    buffer_load_dwordx4 v14, s[28:31], s58 offen offset:512 lds
    buffer_load_dwordx4 v14, s[28:31], s58 offen offset:1536 lds
    buffer_load_dwordx4 v14, s[28:31], s58 offen offset:2560 lds
    buffer_load_dwordx4 v14, s[28:31], s58 offen offset:3584 lds
    s_and_b32 s25, s54, 3
    s_cmp_eq_u32 s25, 3
    s_cbranch_scc1 chk_43_ok
    s_mov_b32 s51, 0
chk_43:
    buffer_load_dword v3, v2, s[28:31], s50 offen sc1
    s_add_u32 s51, s51, 1
    s_mov_b64 exec, -1
    s_waitcnt vmcnt(0)
    v_cmp_ne_u32 vcc, 0, v3
    s_nop 0
    s_lshr_b64 s[54:55], vcc, s56
    s_and_b32 s25, s54, 3
    s_cmp_eq_u32 s25, 3
    s_cbranch_scc1 chk_43_ok
    s_sleep 2
    s_lshl_b64 exec, 0xff, s56
    s_cmp_lt_u32 s51, 30000
    s_cbranch_scc1 chk_43
    s_mov_b64 exec, -1
chk_43_ok:
    s_lshr_b64 s[54:55], s[54:55], 2
    s_add_u32 s56, s56, 2
    s_add_u32 m0, s4, 18432
    s_add_u32 s59, s58, 18432
    s_mov_b64 exec, 0xffffffff
    buffer_load_dwordx4 v14, s[28:31], s59 offen lds
    s_mov_b64 exec, -1
    buffer_load_dwordx4 v14, s[28:31], s59 offen offset:512 lds
    buffer_load_dwordx4 v14, s[28:31], s59 offen offset:1536 lds
    buffer_load_dwordx4 v14, s[28:31], s59 offen offset:2560 lds
    buffer_load_dwordx4 v14, s[28:31], s59 offen offset:3584 lds
    s_bfe_u32 s5, s6, 0x40004
    s_mul_i32 s58, s5, 36864
    s_add_u32 s58, s58, s53
    s_and_b32 s25, s54, 3
    s_cmp_eq_u32 s25, 3
    s_cbranch_scc1 chk_44_ok
    s_mov_b32 s51, 0
chk_44:
    buffer_load_dword v3, v2, s[28:31], s50 offen sc1
    s_add_u32 s51, s51, 1
    s_mov_b64 exec, -1
    s_waitcnt vmcnt(0)
    v_cmp_ne_u32 vcc, 0, v3
    s_nop 0
    s_lshr_b64 s[54:55], vcc, s56
    s_and_b32 s25, s54, 3
    s_cmp_eq_u32 s25, 3
    s_cbranch_scc1 chk_44_ok
    s_sleep 2
    s_lshl_b64 exec, 0xff, s56
    s_cmp_lt_u32 s51, 30000
    s_cbranch_scc1 chk_44
    s_mov_b64 exec, -1
chk_44_ok:
    s_lshr_b64 s[54:55], s[54:55], 2
    s_add_u32 s56, s56, 2
    s_add_u32 m0, s4, 36864
    s_mov_b64 exec, 0xffffffff
    buffer_load_dwordx4 v14, s[28:31], s58 offen lds
    s_mov_b64 exec, -1
    buffer_load_dwordx4 v14, s[28:31], s58 offen offset:512 lds
    buffer_load_dwordx4 v14, s[28:31], s58 offen offset:1536 lds
    buffer_load_dwordx4 v14, s[28:31], s58 offen offset:2560 lds
    buffer_load_dwordx4 v14, s[28:31], s58 offen offset:3584 lds
    s_waitcnt vmcnt(10)
    s_barrier
    s_and_b32 s25, s54, 3
    s_cmp_eq_u32 s25, 3
    s_cbranch_scc1 chk_45_ok
    s_mov_b32 s51, 0
chk_45:
    buffer_load_dword v3, v2, s[28:31], s50 offen sc1
    s_add_u32 s51, s51, 1
    s_mov_b64 exec, -1
    s_waitcnt vmcnt(0)
    v_cmp_ne_u32 vcc, 0, v3
    s_nop 0
    s_lshr_b64 s[54:55], vcc, s56
    s_and_b32 s25, s54, 3
    s_cmp_eq_u32 s25, 3
    s_cbranch_scc1 chk_45_ok
    s_sleep 2
    s_lshl_b64 exec, 0xff, s56
    s_cmp_lt_u32 s51, 30000
    s_cbranch_scc1 chk_45
    s_mov_b64 exec, -1
chk_45_ok:
    s_lshr_b64 s[54:55], s[54:55], 2
    s_add_u32 s56, s56, 2
    s_add_u32 m0, s4, 55296
    s_add_u32 s59, s58, 18432
    s_mov_b64 exec, 0xffffffff
    buffer_load_dwordx4 v14, s[28:31], s59 offen lds
    s_mov_b64 exec, -1
    buffer_load_dwordx4 v14, s[28:31], s59 offen offset:512 lds
    buffer_load_dwordx4 v14, s[28:31], s59 offen offset:1536 lds
    buffer_load_dwordx4 v14, s[28:31], s59 offen offset:2560 lds
    buffer_load_dwordx4 v14, s[28:31], s59 offen offset:3584 lds
    s_waitcnt vmcnt(10)
    s_barrier
    s_add_u32 m0, s24, 0
    s_add_u32 s25, s57, 262144
    buffer_load_dwordx4 v9, s[8:11], s25 offen offset:0 lds
    s_add_u32 s26, s57, 277504
    buffer_load_dwordx4 v10, s[8:11], s26 offen offset:1024 lds
    s_add_u32 s27, s57, 292864
    buffer_load_dwordx4 v9, s[8:11], s27 offen offset:2048 lds
    s_add_u32 s25, s57, 308224
    buffer_load_dwordx4 v10, s[8:11], s25 offen offset:3072 lds
    s_bfe_u32 s5, s6, 0x40008
    s_mul_i32 s58, s5, 36864
    s_add_u32 s58, s58, s53
    s_and_b32 s25, s54, 3
    s_cmp_eq_u32 s25, 3
    s_cbranch_scc1 chk_46_ok
    s_mov_b32 s51, 0
chk_46:
    buffer_load_dword v3, v2, s[28:31], s50 offen sc1
    s_add_u32 s51, s51, 1
    s_mov_b64 exec, -1
    s_waitcnt vmcnt(0)
    v_cmp_ne_u32 vcc, 0, v3
    s_nop 0
    s_lshr_b64 s[54:55], vcc, s56
    s_and_b32 s25, s54, 3
    s_cmp_eq_u32 s25, 3
    s_cbranch_scc1 chk_46_ok
    s_sleep 2
    s_lshl_b64 exec, 0xff, s56
    s_cmp_lt_u32 s51, 30000
    s_cbranch_scc1 chk_46
    s_mov_b64 exec, -1
chk_46_ok:
    s_lshr_b64 s[54:55], s[54:55], 2
    s_add_u32 s56, s56, 2
    s_add_u32 m0, s4, 0
    s_mov_b64 exec, 0xffffffff
    buffer_load_dwordx4 v14, s[28:31], s58 offen lds
    s_mov_b64 exec, -1
    buffer_load_dwordx4 v14, s[28:31], s58 offen offset:512 lds
    buffer_load_dwordx4 v14, s[28:31], s58 offen offset:1536 lds
    buffer_load_dwordx4 v14, s[28:31], s58 offen offset:2560 lds
    buffer_load_dwordx4 v14, s[28:31], s58 offen offset:3584 lds
    s_waitcnt vmcnt(14)
    s_barrier
    s_bfe_u32 s5, s6, 0x4000c
    s_mul_i32 s57, s5, 524288
    s_add_u32 s57, s57, s52
    s_add_u32 m0, s24, 16384
    s_nop 0
    buffer_load_dwordx4 v9, s[8:11], s57 offen offset:0 lds
    s_add_u32 s26, s57, 15360
    buffer_load_dwordx4 v10, s[8:11], s26 offen offset:1024 lds
    s_add_u32 s27, s57, 30720
    buffer_load_dwordx4 v9, s[8:11], s27 offen offset:2048 lds
    s_add_u32 s25, s57, 46080
    buffer_load_dwordx4 v10, s[8:11], s25 offen offset:3072 lds
    s_and_b32 s25, s54, 3
    s_cmp_eq_u32 s25, 3
    s_cbranch_scc1 chk_47_ok
    s_mov_b32 s51, 0
chk_47:
    buffer_load_dword v3, v2, s[28:31], s50 offen sc1
    s_add_u32 s51, s51, 1
    s_mov_b64 exec, -1
    s_waitcnt vmcnt(0)
    v_cmp_ne_u32 vcc, 0, v3
    s_nop 0
    s_lshr_b64 s[54:55], vcc, s56
    s_and_b32 s25, s54, 3
    s_cmp_eq_u32 s25, 3
    s_cbranch_scc1 chk_47_ok
    s_sleep 2
    s_lshl_b64 exec, 0xff, s56
    s_cmp_lt_u32 s51, 30000
    s_cbranch_scc1 chk_47
    s_mov_b64 exec, -1
chk_47_ok:
    s_lshr_b64 s[54:55], s[54:55], 2
    s_add_u32 s56, s56, 2
    s_add_u32 m0, s4, 18432
    s_add_u32 s59, s58, 18432
    s_mov_b64 exec, 0xffffffff
    buffer_load_dwordx4 v14, s[28:31], s59 offen lds
    s_mov_b64 exec, -1
    buffer_load_dwordx4 v14, s[28:31], s59 offen offset:512 lds
    buffer_load_dwordx4 v14, s[28:31], s59 offen offset:1536 lds
    buffer_load_dwordx4 v14, s[28:31], s59 offen offset:2560 lds
    buffer_load_dwordx4 v14, s[28:31], s59 offen offset:3584 lds
    s_waitcnt vmcnt(18)
    s_barrier
    s_add_u32 m0, s24, 32768
    s_add_u32 s25, s57, 262144
    buffer_load_dwordx4 v9, s[8:11], s25 offen offset:0 lds
    s_add_u32 s26, s57, 277504
    buffer_load_dwordx4 v10, s[8:11], s26 offen offset:1024 lds
    s_add_u32 s27, s57, 292864
    buffer_load_dwordx4 v9, s[8:11], s27 offen offset:2048 lds
    s_add_u32 s25, s57, 308224
    buffer_load_dwordx4 v10, s[8:11], s25 offen offset:3072 lds
    s_bfe_u32 s5, s6, 0x4000c
    s_mul_i32 s58, s5, 36864
    s_add_u32 s58, s58, s53
    s_and_b32 s25, s54, 3
    s_cmp_eq_u32 s25, 3
    s_cbranch_scc1 chk_48_ok
    s_mov_b32 s51, 0
chk_48:
    buffer_load_dword v3, v2, s[28:31], s50 offen sc1
    s_add_u32 s51, s51, 1
    s_mov_b64 exec, -1
    s_waitcnt vmcnt(0)
    v_cmp_ne_u32 vcc, 0, v3
    s_nop 0
    s_lshr_b64 s[54:55], vcc, s56
    s_and_b32 s25, s54, 3
    s_cmp_eq_u32 s25, 3
    s_cbranch_scc1 chk_48_ok
    s_sleep 2
    s_lshl_b64 exec, 0xff, s56
    s_cmp_lt_u32 s51, 30000
    s_cbranch_scc1 chk_48
    s_mov_b64 exec, -1
chk_48_ok:
    s_lshr_b64 s[54:55], s[54:55], 2
    s_add_u32 s56, s56, 2
    s_add_u32 m0, s4, 36864
    s_mov_b64 exec, 0xffffffff
    buffer_load_dwordx4 v14, s[28:31], s58 offen lds
    s_mov_b64 exec, -1
    buffer_load_dwordx4 v14, s[28:31], s58 offen offset:512 lds
    buffer_load_dwordx4 v14, s[28:31], s58 offen offset:1536 lds
    buffer_load_dwordx4 v14, s[28:31], s58 offen offset:2560 lds
    buffer_load_dwordx4 v14, s[28:31], s58 offen offset:3584 lds
    s_waitcnt vmcnt(18)
    s_barrier
    s_bfe_u32 s5, s6, 0x40010
    s_mul_i32 s57, s5, 524288
    s_add_u32 s57, s57, s52
    s_add_u32 m0, s24, 49152
    s_nop 0
    buffer_load_dwordx4 v9, s[8:11], s57 offen offset:0 lds
    s_add_u32 s26, s57, 15360
    buffer_load_dwordx4 v10, s[8:11], s26 offen offset:1024 lds
    s_add_u32 s27, s57, 30720
    buffer_load_dwordx4 v9, s[8:11], s27 offen offset:2048 lds
    s_add_u32 s25, s57, 46080
    buffer_load_dwordx4 v10, s[8:11], s25 offen offset:3072 lds
    s_and_b32 s25, s54, 3
    s_cmp_eq_u32 s25, 3
    s_cbranch_scc1 chk_49_ok
    s_mov_b32 s51, 0
chk_49:
    buffer_load_dword v3, v2, s[28:31], s50 offen sc1
    s_add_u32 s51, s51, 1
    s_mov_b64 exec, -1
    s_waitcnt vmcnt(0)
    v_cmp_ne_u32 vcc, 0, v3
    s_nop 0
    s_lshr_b64 s[54:55], vcc, s56
    s_and_b32 s25, s54, 3
    s_cmp_eq_u32 s25, 3
    s_cbranch_scc1 chk_49_ok
    s_sleep 2
    s_lshl_b64 exec, 0xff, s56
    s_cmp_lt_u32 s51, 30000
    s_cbranch_scc1 chk_49
    s_mov_b64 exec, -1
chk_49_ok:
    s_lshr_b64 s[54:55], s[54:55], 2
    s_add_u32 s56, s56, 2
    s_add_u32 m0, s4, 55296
    s_add_u32 s59, s58, 18432
    s_mov_b64 exec, 0xffffffff
    buffer_load_dwordx4 v14, s[28:31], s59 offen lds
    s_mov_b64 exec, -1
    buffer_load_dwordx4 v14, s[28:31], s59 offen offset:512 lds
    buffer_load_dwordx4 v14, s[28:31], s59 offen offset:1536 lds
    buffer_load_dwordx4 v14, s[28:31], s59 offen offset:2560 lds
    buffer_load_dwordx4 v14, s[28:31], s59 offen offset:3584 lds
    s_waitcnt vmcnt(18)
    s_barrier
    s_add_u32 m0, s24, 65536
    s_add_u32 s25, s57, 262144
    buffer_load_dwordx4 v9, s[8:11], s25 offen offset:0 lds
    s_add_u32 s26, s57, 277504
    buffer_load_dwordx4 v10, s[8:11], s26 offen offset:1024 lds
    s_add_u32 s27, s57, 292864
    buffer_load_dwordx4 v9, s[8:11], s27 offen offset:2048 lds
    s_add_u32 s25, s57, 308224
    buffer_load_dwordx4 v10, s[8:11], s25 offen offset:3072 lds
    s_bfe_u32 s5, s6, 0x40010
    s_mul_i32 s58, s5, 36864
    s_add_u32 s58, s58, s53
    s_and_b32 s25, s54, 3
    s_cmp_eq_u32 s25, 3
    s_cbranch_scc1 chk_50_ok
    s_mov_b32 s51, 0
chk_50:
    buffer_load_dword v3, v2, s[28:31], s50 offen sc1
    s_add_u32 s51, s51, 1
    s_mov_b64 exec, -1
    s_waitcnt vmcnt(0)
    v_cmp_ne_u32 vcc, 0, v3
    s_nop 0
    s_lshr_b64 s[54:55], vcc, s56
    s_and_b32 s25, s54, 3
    s_cmp_eq_u32 s25, 3
    s_cbranch_scc1 chk_50_ok
    s_sleep 2
    s_lshl_b64 exec, 0xff, s56
    s_cmp_lt_u32 s51, 30000
    s_cbranch_scc1 chk_50
    s_mov_b64 exec, -1
chk_50_ok:
    s_lshr_b64 s[54:55], s[54:55], 2
    s_add_u32 s56, s56, 2
    s_add_u32 m0, s4, 0
    s_mov_b64 exec, 0xffffffff
    buffer_load_dwordx4 v14, s[28:31], s58 offen lds
    s_mov_b64 exec, -1
    buffer_load_dwordx4 v14, s[28:31], s58 offen offset:512 lds
    buffer_load_dwordx4 v14, s[28:31], s58 offen offset:1536 lds
    buffer_load_dwordx4 v14, s[28:31], s58 offen offset:2560 lds
    buffer_load_dwordx4 v14, s[28:31], s58 offen offset:3584 lds
    s_waitcnt vmcnt(18)
    s_barrier
    s_bfe_u32 s5, s6, 0x40014
    s_mul_i32 s57, s5, 524288
    s_add_u32 s57, s57, s52
    s_add_u32 m0, s24, 0
    s_nop 0
    buffer_load_dwordx4 v9, s[8:11], s57 offen offset:0 lds
    s_add_u32 s26, s57, 15360
    buffer_load_dwordx4 v10, s[8:11], s26 offen offset:1024 lds
    s_add_u32 s27, s57, 30720
    buffer_load_dwordx4 v9, s[8:11], s27 offen offset:2048 lds
    s_add_u32 s25, s57, 46080
    buffer_load_dwordx4 v10, s[8:11], s25 offen offset:3072 lds
    s_and_b32 s25, s54, 3
    s_cmp_eq_u32 s25, 3
    s_cbranch_scc1 chk_51_ok
    s_mov_b32 s51, 0
chk_51:
    buffer_load_dword v3, v2, s[28:31], s50 offen sc1
    s_add_u32 s51, s51, 1
    s_mov_b64 exec, -1
    s_waitcnt vmcnt(0)
    v_cmp_ne_u32 vcc, 0, v3
    s_nop 0
    s_lshr_b64 s[54:55], vcc, s56
    s_and_b32 s25, s54, 3
    s_cmp_eq_u32 s25, 3
    s_cbranch_scc1 chk_51_ok
    s_sleep 2
    s_lshl_b64 exec, 0xff, s56
    s_cmp_lt_u32 s51, 30000
    s_cbranch_scc1 chk_51
    s_mov_b64 exec, -1
chk_51_ok:
    s_lshr_b64 s[54:55], s[54:55], 2
    s_add_u32 s56, s56, 2
    s_add_u32 m0, s4, 18432
    s_add_u32 s59, s58, 18432
    s_mov_b64 exec, 0xffffffff
    buffer_load_dwordx4 v14, s[28:31], s59 offen lds
    s_mov_b64 exec, -1
    buffer_load_dwordx4 v14, s[28:31], s59 offen offset:512 lds
    buffer_load_dwordx4 v14, s[28:31], s59 offen offset:1536 lds
    buffer_load_dwordx4 v14, s[28:31], s59 offen offset:2560 lds
    buffer_load_dwordx4 v14, s[28:31], s59 offen offset:3584 lds
    s_waitcnt vmcnt(18)
    s_barrier
    s_add_u32 m0, s24, 16384
    s_add_u32 s25, s57, 262144
    buffer_load_dwordx4 v9, s[8:11], s25 offen offset:0 lds
    s_add_u32 s26, s57, 277504
    buffer_load_dwordx4 v10, s[8:11], s26 offen offset:1024 lds
    s_add_u32 s27, s57, 292864
    buffer_load_dwordx4 v9, s[8:11], s27 offen offset:2048 lds
    s_add_u32 s25, s57, 308224
    buffer_load_dwordx4 v10, s[8:11], s25 offen offset:3072 lds
    s_bfe_u32 s5, s6, 0x40014
    s_mul_i32 s58, s5, 36864
    s_add_u32 s58, s58, s53
    s_and_b32 s25, s54, 3
    s_cmp_eq_u32 s25, 3
    s_cbranch_scc1 chk_52_ok
    s_mov_b32 s51, 0
chk_52:
    buffer_load_dword v3, v2, s[28:31], s50 offen sc1
    s_add_u32 s51, s51, 1
    s_mov_b64 exec, -1
    s_waitcnt vmcnt(0)
    v_cmp_ne_u32 vcc, 0, v3
    s_nop 0
    s_lshr_b64 s[54:55], vcc, s56
    s_and_b32 s25, s54, 3
    s_cmp_eq_u32 s25, 3
    s_cbranch_scc1 chk_52_ok
    s_sleep 2
    s_lshl_b64 exec, 0xff, s56
    s_cmp_lt_u32 s51, 30000
    s_cbranch_scc1 chk_52
    s_mov_b64 exec, -1
chk_52_ok:
    s_lshr_b64 s[54:55], s[54:55], 2
    s_add_u32 s56, s56, 2
    s_add_u32 m0, s4, 36864
    s_mov_b64 exec, 0xffffffff
    buffer_load_dwordx4 v14, s[28:31], s58 offen lds
    s_mov_b64 exec, -1
    buffer_load_dwordx4 v14, s[28:31], s58 offen offset:512 lds
    buffer_load_dwordx4 v14, s[28:31], s58 offen offset:1536 lds
    buffer_load_dwordx4 v14, s[28:31], s58 offen offset:2560 lds
    buffer_load_dwordx4 v14, s[28:31], s58 offen offset:3584 lds
    s_waitcnt vmcnt(18)
    s_barrier
    s_bfe_u32 s5, s6, 0x40018
    s_mul_i32 s57, s5, 524288
    s_add_u32 s57, s57, s52
    s_add_u32 m0, s24, 32768
    s_nop 0
    buffer_load_dwordx4 v9, s[8:11], s57 offen offset:0 lds
    s_add_u32 s26, s57, 15360
    buffer_load_dwordx4 v10, s[8:11], s26 offen offset:1024 lds
    s_add_u32 s27, s57, 30720
    buffer_load_dwordx4 v9, s[8:11], s27 offen offset:2048 lds
    s_add_u32 s25, s57, 46080
    buffer_load_dwordx4 v10, s[8:11], s25 offen offset:3072 lds
    s_and_b32 s25, s54, 3
    s_cmp_eq_u32 s25, 3
    s_cbranch_scc1 chk_53_ok
    s_mov_b32 s51, 0
chk_53:
    buffer_load_dword v3, v2, s[28:31], s50 offen sc1
    s_add_u32 s51, s51, 1
    s_mov_b64 exec, -1
    s_waitcnt vmcnt(0)
    v_cmp_ne_u32 vcc, 0, v3
    s_nop 0
    s_lshr_b64 s[54:55], vcc, s56
    s_and_b32 s25, s54, 3
    s_cmp_eq_u32 s25, 3
    s_cbranch_scc1 chk_53_ok
    s_sleep 2
    s_lshl_b64 exec, 0xff, s56
    s_cmp_lt_u32 s51, 30000
    s_cbranch_scc1 chk_53
    s_mov_b64 exec, -1
chk_53_ok:
    s_lshr_b64 s[54:55], s[54:55], 2
    s_add_u32 s56, s56, 2
    s_add_u32 m0, s4, 55296
    s_add_u32 s59, s58, 18432
    s_mov_b64 exec, 0xffffffff
    buffer_load_dwordx4 v14, s[28:31], s59 offen lds
    s_mov_b64 exec, -1
    buffer_load_dwordx4 v14, s[28:31], s59 offen offset:512 lds
    buffer_load_dwordx4 v14, s[28:31], s59 offen offset:1536 lds
    buffer_load_dwordx4 v14, s[28:31], s59 offen offset:2560 lds
    buffer_load_dwordx4 v14, s[28:31], s59 offen offset:3584 lds
    s_waitcnt vmcnt(18)
    s_barrier
    s_add_u32 m0, s24, 49152
    s_add_u32 s25, s57, 262144
    buffer_load_dwordx4 v9, s[8:11], s25 offen offset:0 lds
    s_add_u32 s26, s57, 277504
    buffer_load_dwordx4 v10, s[8:11], s26 offen offset:1024 lds
    s_add_u32 s27, s57, 292864
    buffer_load_dwordx4 v9, s[8:11], s27 offen offset:2048 lds
    s_add_u32 s25, s57, 308224
    buffer_load_dwordx4 v10, s[8:11], s25 offen offset:3072 lds
    s_bfe_u32 s5, s6, 0x40018
    s_mul_i32 s58, s5, 36864
    s_add_u32 s58, s58, s53
    s_and_b32 s25, s54, 3
    s_cmp_eq_u32 s25, 3
    s_cbranch_scc1 chk_54_ok
    s_mov_b32 s51, 0
chk_54:
    buffer_load_dword v3, v2, s[28:31], s50 offen sc1
    s_add_u32 s51, s51, 1
    s_mov_b64 exec, -1
    s_waitcnt vmcnt(0)
    v_cmp_ne_u32 vcc, 0, v3
    s_nop 0
    s_lshr_b64 s[54:55], vcc, s56
    s_and_b32 s25, s54, 3
    s_cmp_eq_u32 s25, 3
    s_cbranch_scc1 chk_54_ok
    s_sleep 2
    s_lshl_b64 exec, 0xff, s56
    s_cmp_lt_u32 s51, 30000
    s_cbranch_scc1 chk_54
    s_mov_b64 exec, -1
chk_54_ok:
    s_lshr_b64 s[54:55], s[54:55], 2
    s_add_u32 s56, s56, 2
    s_add_u32 m0, s4, 0
    s_mov_b64 exec, 0xffffffff
    buffer_load_dwordx4 v14, s[28:31], s58 offen lds
    s_mov_b64 exec, -1
    buffer_load_dwordx4 v14, s[28:31], s58 offen offset:512 lds
    buffer_load_dwordx4 v14, s[28:31], s58 offen offset:1536 lds
    buffer_load_dwordx4 v14, s[28:31], s58 offen offset:2560 lds
    buffer_load_dwordx4 v14, s[28:31], s58 offen offset:3584 lds
    s_waitcnt vmcnt(18)
    s_barrier
    s_bfe_u32 s5, s6, 0x4001c
    s_mul_i32 s57, s5, 524288
    s_add_u32 s57, s57, s52
    s_add_u32 m0, s24, 65536
    s_nop 0
    buffer_load_dwordx4 v9, s[8:11], s57 offen offset:0 lds
    s_add_u32 s26, s57, 15360
    buffer_load_dwordx4 v10, s[8:11], s26 offen offset:1024 lds
    s_add_u32 s27, s57, 30720
    buffer_load_dwordx4 v9, s[8:11], s27 offen offset:2048 lds
    s_add_u32 s25, s57, 46080
    buffer_load_dwordx4 v10, s[8:11], s25 offen offset:3072 lds
    s_and_b32 s25, s54, 3
    s_cmp_eq_u32 s25, 3
    s_cbranch_scc1 chk_55_ok
    s_mov_b32 s51, 0
chk_55:
    buffer_load_dword v3, v2, s[28:31], s50 offen sc1
    s_add_u32 s51, s51, 1
    s_mov_b64 exec, -1
    s_waitcnt vmcnt(0)
    v_cmp_ne_u32 vcc, 0, v3
    s_nop 0
    s_lshr_b64 s[54:55], vcc, s56
    s_and_b32 s25, s54, 3
    s_cmp_eq_u32 s25, 3
    s_cbranch_scc1 chk_55_ok
    s_sleep 2
    s_lshl_b64 exec, 0xff, s56
    s_cmp_lt_u32 s51, 30000
    s_cbranch_scc1 chk_55
    s_mov_b64 exec, -1
chk_55_ok:
    s_lshr_b64 s[54:55], s[54:55], 2
    s_add_u32 s56, s56, 2
    s_add_u32 m0, s4, 18432
    s_add_u32 s59, s58, 18432
    s_mov_b64 exec, 0xffffffff
    buffer_load_dwordx4 v14, s[28:31], s59 offen lds
    s_mov_b64 exec, -1
    buffer_load_dwordx4 v14, s[28:31], s59 offen offset:512 lds
    buffer_load_dwordx4 v14, s[28:31], s59 offen offset:1536 lds
    buffer_load_dwordx4 v14, s[28:31], s59 offen offset:2560 lds
    buffer_load_dwordx4 v14, s[28:31], s59 offen offset:3584 lds
    s_waitcnt vmcnt(18)
    s_barrier
    s_add_u32 m0, s24, 0
    s_add_u32 s25, s57, 262144
    buffer_load_dwordx4 v9, s[8:11], s25 offen offset:0 lds
    s_add_u32 s26, s57, 277504
    buffer_load_dwordx4 v10, s[8:11], s26 offen offset:1024 lds
    s_add_u32 s27, s57, 292864
    buffer_load_dwordx4 v9, s[8:11], s27 offen offset:2048 lds
    s_add_u32 s25, s57, 308224
    buffer_load_dwordx4 v10, s[8:11], s25 offen offset:3072 lds
    s_bfe_u32 s5, s6, 0x4001c
    s_mul_i32 s58, s5, 36864
    s_add_u32 s58, s58, s53
    s_and_b32 s25, s54, 3
    s_cmp_eq_u32 s25, 3
    s_cbranch_scc1 chk_56_ok
    s_mov_b32 s51, 0
chk_56:
    buffer_load_dword v3, v2, s[28:31], s50 offen sc1
    s_add_u32 s51, s51, 1
    s_mov_b64 exec, -1
    s_waitcnt vmcnt(0)
    v_cmp_ne_u32 vcc, 0, v3
    s_nop 0
    s_lshr_b64 s[54:55], vcc, s56
    s_and_b32 s25, s54, 3
    s_cmp_eq_u32 s25, 3
    s_cbranch_scc1 chk_56_ok
    s_sleep 2
    s_lshl_b64 exec, 0xff, s56
    s_cmp_lt_u32 s51, 30000
    s_cbranch_scc1 chk_56
    s_mov_b64 exec, -1
chk_56_ok:
    s_lshr_b64 s[54:55], s[54:55], 2
    s_add_u32 s56, s56, 2
    s_add_u32 m0, s4, 36864
    s_mov_b64 exec, 0xffffffff
    buffer_load_dwordx4 v14, s[28:31], s58 offen lds
    s_mov_b64 exec, -1
    buffer_load_dwordx4 v14, s[28:31], s58 offen offset:512 lds
    buffer_load_dwordx4 v14, s[28:31], s58 offen offset:1536 lds
    buffer_load_dwordx4 v14, s[28:31], s58 offen offset:2560 lds
    buffer_load_dwordx4 v14, s[28:31], s58 offen offset:3584 lds
    s_waitcnt vmcnt(18)
    s_barrier
    s_bfe_u32 s5, s7, 0x40000
    s_mul_i32 s57, s5, 524288
    s_add_u32 s57, s57, s52
    s_add_u32 m0, s24, 16384
    s_nop 0
    buffer_load_dwordx4 v9, s[8:11], s57 offen offset:0 lds
    s_add_u32 s26, s57, 15360
    buffer_load_dwordx4 v10, s[8:11], s26 offen offset:1024 lds
    s_add_u32 s27, s57, 30720
    buffer_load_dwordx4 v9, s[8:11], s27 offen offset:2048 lds
    s_add_u32 s25, s57, 46080
    buffer_load_dwordx4 v10, s[8:11], s25 offen offset:3072 lds
    s_and_b32 s25, s54, 3
    s_cmp_eq_u32 s25, 3
    s_cbranch_scc1 chk_57_ok
    s_mov_b32 s51, 0
chk_57:
    buffer_load_dword v3, v2, s[28:31], s50 offen sc1
    s_add_u32 s51, s51, 1
    s_mov_b64 exec, -1
    s_waitcnt vmcnt(0)
    v_cmp_ne_u32 vcc, 0, v3
    s_nop 0
    s_lshr_b64 s[54:55], vcc, s56
    s_and_b32 s25, s54, 3
    s_cmp_eq_u32 s25, 3
    s_cbranch_scc1 chk_57_ok
    s_sleep 2
    s_lshl_b64 exec, 0xff, s56
    s_cmp_lt_u32 s51, 30000
    s_cbranch_scc1 chk_57
    s_mov_b64 exec, -1
chk_57_ok:
    s_lshr_b64 s[54:55], s[54:55], 2
    s_add_u32 s56, s56, 2
    s_add_u32 m0, s4, 55296
    s_add_u32 s59, s58, 18432
    s_mov_b64 exec, 0xffffffff
    buffer_load_dwordx4 v14, s[28:31], s59 offen lds
    s_mov_b64 exec, -1
    buffer_load_dwordx4 v14, s[28:31], s59 offen offset:512 lds
    buffer_load_dwordx4 v14, s[28:31], s59 offen offset:1536 lds
    buffer_load_dwordx4 v14, s[28:31], s59 offen offset:2560 lds
    buffer_load_dwordx4 v14, s[28:31], s59 offen offset:3584 lds
    s_waitcnt vmcnt(18)
    s_barrier
    s_add_u32 m0, s24, 32768
    s_add_u32 s25, s57, 262144
    buffer_load_dwordx4 v9, s[8:11], s25 offen offset:0 lds
    s_add_u32 s26, s57, 277504
    buffer_load_dwordx4 v10, s[8:11], s26 offen offset:1024 lds
    s_add_u32 s27, s57, 292864
    buffer_load_dwordx4 v9, s[8:11], s27 offen offset:2048 lds
    s_add_u32 s25, s57, 308224
    buffer_load_dwordx4 v10, s[8:11], s25 offen offset:3072 lds
    s_bfe_u32 s5, s7, 0x40000
    s_mul_i32 s58, s5, 36864
    s_add_u32 s58, s58, s53
    s_and_b32 s25, s54, 3
    s_cmp_eq_u32 s25, 3
    s_cbranch_scc1 chk_58_ok
    s_mov_b32 s51, 0
chk_58:
    buffer_load_dword v3, v2, s[28:31], s50 offen sc1
    s_add_u32 s51, s51, 1
    s_mov_b64 exec, -1
    s_waitcnt vmcnt(0)
    v_cmp_ne_u32 vcc, 0, v3
    s_nop 0
    s_lshr_b64 s[54:55], vcc, s56
    s_and_b32 s25, s54, 3
    s_cmp_eq_u32 s25, 3
    s_cbranch_scc1 chk_58_ok
    s_sleep 2
    s_lshl_b64 exec, 0xff, s56
    s_cmp_lt_u32 s51, 30000
    s_cbranch_scc1 chk_58
    s_mov_b64 exec, -1
chk_58_ok:
    s_lshr_b64 s[54:55], s[54:55], 2
    s_add_u32 s56, s56, 2
    s_add_u32 m0, s4, 0
    s_mov_b64 exec, 0xffffffff
    buffer_load_dwordx4 v14, s[28:31], s58 offen lds
    s_mov_b64 exec, -1
    buffer_load_dwordx4 v14, s[28:31], s58 offen offset:512 lds
    buffer_load_dwordx4 v14, s[28:31], s58 offen offset:1536 lds
    buffer_load_dwordx4 v14, s[28:31], s58 offen offset:2560 lds
    buffer_load_dwordx4 v14, s[28:31], s58 offen offset:3584 lds
    s_waitcnt vmcnt(18)
    s_barrier
    s_and_b32 s25, s54, 3
    s_cmp_eq_u32 s25, 3
    s_cbranch_scc1 chk_59_ok
    s_mov_b32 s51, 0
chk_59:
    buffer_load_dword v3, v2, s[28:31], s50 offen sc1
    s_add_u32 s51, s51, 1
    s_mov_b64 exec, -1
    s_waitcnt vmcnt(0)
    v_cmp_ne_u32 vcc, 0, v3
    s_nop 0
    s_lshr_b64 s[54:55], vcc, s56
    s_and_b32 s25, s54, 3
    s_cmp_eq_u32 s25, 3
    s_cbranch_scc1 chk_59_ok
    s_sleep 2
    s_lshl_b64 exec, 0xff, s56
    s_cmp_lt_u32 s51, 30000
    s_cbranch_scc1 chk_59
    s_mov_b64 exec, -1
chk_59_ok:
    s_lshr_b64 s[54:55], s[54:55], 2
    s_add_u32 s56, s56, 2
    s_add_u32 m0, s4, 18432
    s_add_u32 s59, s58, 18432
    s_mov_b64 exec, 0xffffffff
    buffer_load_dwordx4 v14, s[28:31], s59 offen lds
    s_mov_b64 exec, -1
    buffer_load_dwordx4 v14, s[28:31], s59 offen offset:512 lds
    buffer_load_dwordx4 v14, s[28:31], s59 offen offset:1536 lds
    buffer_load_dwordx4 v14, s[28:31], s59 offen offset:2560 lds
    buffer_load_dwordx4 v14, s[28:31], s59 offen offset:3584 lds
    s_waitcnt vmcnt(14)
    s_barrier
    s_waitcnt vmcnt(5)
    s_barrier
    s_waitcnt vmcnt(0)
    s_barrier
    s_branch t_end
t_spare:
    s_sub_u32 s50, s37, 27
    s_lshl_b32 s50, s50, 3
    s_add_u32 s50, s50, s3
    s_add_u32 s58, s50, 261
    s_mul_i32 s58, s58, 55296
    s_add_u32 s58, s58, s57
    s_cmp_lt_u32 s50, 80
    s_cbranch_scc0 t4_60
    buffer_load_dword v8, v17, s[32:35], s58 offen
t4_60:
    s_add_u32 s58, s58, 2211840
    s_cmp_lt_u32 s50, 40
    s_cbranch_scc0 t4_61
    buffer_load_dword v8, v17, s[32:35], s58 offen
t4_61:
    s_add_u32 s58, s58, 2211840
    s_sleep 16
    s_sleep 16
    s_sleep 16
    s_sleep 16
    s_waitcnt vmcnt(0)
    s_lshr_b32 s44, s36, 1
    s_mov_b32 s6, 0x18764320
    s_mov_b32 s7, 5
    s_cmp_eq_u32 s44, 1
    s_cselect_b32 s6, 0x40765321, s6
    s_cselect_b32 s7, 8, s7
    s_cmp_eq_u32 s44, 2
    s_cselect_b32 s6, 0x38654210, s6
    s_cselect_b32 s7, 7, s7
    s_cmp_eq_u32 s44, 3
    s_cselect_b32 s6, 0x28754310, s6
    s_cselect_b32 s7, 6, s7
    s_and_b32 s51, s36, 1
    s_lshl_b32 s51, s51, 11
    s_mul_i32 s52, s44, 4718592
    s_add_u32 s51, s51, s52
    s_add_u32 s52, 0, s50
    v_lshrrev_b32 v2, 4, v1
    v_lshlrev_b32 v2, 12, v2
    v_and_b32 v3, 15, v1
    v_lshl_add_u32 v2, v3, 7, v2
    s_lshr_b32 s53, s52, 5
    s_lshl_b32 s53, s53, 2
    s_lshr_b64 s[54:55], s[6:7], s53
    s_and_b32 s54, s54, 15
    s_lshl_b32 s54, s54, 5
    s_and_b32 s53, s52, 31
    s_add_u32 s54, s54, s53
    s_lshl_b32 s54, s54, 14
    s_add_u32 s54, s54, s51
    buffer_load_dword v4, v2, s[8:11], s54 offen
    s_add_u32 s52, s52, 40
    s_lshr_b32 s53, s52, 5
    s_lshl_b32 s53, s53, 2
    s_lshr_b64 s[54:55], s[6:7], s53
    s_and_b32 s54, s54, 15
    s_lshl_b32 s54, s54, 5
    s_and_b32 s53, s52, 31
    s_add_u32 s54, s54, s53
    s_lshl_b32 s54, s54, 14
    s_add_u32 s54, s54, s51
    s_waitcnt vmcnt(0)
    buffer_load_dword v4, v2, s[8:11], s54 offen
    s_add_u32 s52, s52, 40
    s_lshr_b32 s53, s52, 5
    s_lshl_b32 s53, s53, 2
    s_lshr_b64 s[54:55], s[6:7], s53
    s_and_b32 s54, s54, 15
    s_lshl_b32 s54, s54, 5
    s_and_b32 s53, s52, 31
    s_add_u32 s54, s54, s53
    s_lshl_b32 s54, s54, 14
    s_add_u32 s54, s54, s51
    s_waitcnt vmcnt(0)
    buffer_load_dword v4, v2, s[8:11], s54 offen
    s_add_u32 s52, s52, 40
    s_lshr_b32 s53, s52, 5
    s_lshl_b32 s53, s53, 2
    s_lshr_b64 s[54:55], s[6:7], s53
    s_and_b32 s54, s54, 15
    s_lshl_b32 s54, s54, 5
    s_and_b32 s53, s52, 31
    s_add_u32 s54, s54, s53
    s_lshl_b32 s54, s54, 14
    s_add_u32 s54, s54, s51
    s_waitcnt vmcnt(0)
    buffer_load_dword v4, v2, s[8:11], s54 offen
    s_add_u32 s52, s52, 40
    s_lshr_b32 s53, s52, 5
    s_lshl_b32 s53, s53, 2
    s_lshr_b64 s[54:55], s[6:7], s53
    s_and_b32 s54, s54, 15
    s_lshl_b32 s54, s54, 5
    s_and_b32 s53, s52, 31
    s_add_u32 s54, s54, s53
    s_lshl_b32 s54, s54, 14
    s_add_u32 s54, s54, s51
    s_waitcnt vmcnt(0)
    buffer_load_dword v4, v2, s[8:11], s54 offen
    s_add_u32 s52, s52, 40
    s_lshr_b32 s53, s52, 5
    s_lshl_b32 s53, s53, 2
    s_lshr_b64 s[54:55], s[6:7], s53
    s_and_b32 s54, s54, 15
    s_lshl_b32 s54, s54, 5
    s_and_b32 s53, s52, 31
    s_add_u32 s54, s54, s53
    s_lshl_b32 s54, s54, 14
    s_add_u32 s54, s54, s51
    s_waitcnt vmcnt(0)
    buffer_load_dword v4, v2, s[8:11], s54 offen
    s_add_u32 s52, s52, 40
    s_lshr_b32 s53, s52, 5
    s_lshl_b32 s53, s53, 2
    s_lshr_b64 s[54:55], s[6:7], s53
    s_and_b32 s54, s54, 15
    s_lshl_b32 s54, s54, 5
    s_and_b32 s53, s52, 31
    s_add_u32 s54, s54, s53
    s_lshl_b32 s54, s54, 14
    s_add_u32 s54, s54, s51
    s_waitcnt vmcnt(0)
    buffer_load_dword v4, v2, s[8:11], s54 offen
    s_add_u32 s52, s52, 40
    s_cmp_lt_u32 s50, 8
    s_cbranch_scc0 pfskip_62
    s_lshr_b32 s53, s52, 5
    s_lshl_b32 s53, s53, 2
    s_lshr_b64 s[54:55], s[6:7], s53
    s_and_b32 s54, s54, 15
    s_lshl_b32 s54, s54, 5
    s_and_b32 s53, s52, 31
    s_add_u32 s54, s54, s53
    s_lshl_b32 s54, s54, 14
    s_add_u32 s54, s54, s51
    s_waitcnt vmcnt(0)
    buffer_load_dword v4, v2, s[8:11], s54 offen
pfskip_62:
    s_waitcnt vmcnt(0)
    s_cmp_lt_u32 s3, 4
    s_cbranch_scc1 t_cons2
    s_branch t_ld2
t_cons:
    s_and_b32 s46, s3, 1
    s_lshr_b32 s47, s3, 1
    s_lshl_b32 s48, s46, 7
    s_lshl_b32 s49, s62, 8
    s_add_u32 s48, s48, s49
    v_lshlrev_b32 v7, 3, v6
    s_lshl_b32 s40, s46, 2
    s_add_u32 s40, s40, 0
    s_lshl_b32 s41, s46, 2
    s_add_u32 s41, s41, 1
    s_lshl_b32 s42, s46, 2
    s_add_u32 s42, s42, 2
    s_lshl_b32 s43, s46, 2
    s_add_u32 s43, s43, 3
    v_lshrrev_b32 v2, 2, v5
    v_and_b32 v3, 1, v6
    v_lshl_add_u32 v3, v3, 2, v2
    v_mad_u32_u24 v2, v6, 8, v2
    v_lshlrev_b32 v2, 8, v2
    v_and_b32 v4, 3, v1
    v_lshl_add_u32 v2, v4, 3, v2
    v_xor_b32 v4, s40, v3
    v_lshl_add_u32 v8, v4, 5, v2
    v_xor_b32 v4, s41, v3
    v_lshl_add_u32 v9, v4, 5, v2
    v_xor_b32 v4, s42, v3
    v_lshl_add_u32 v10, v4, 5, v2
    v_xor_b32 v4, s43, v3
    v_lshl_add_u32 v11, v4, 5, v2
    v_mul_u32_u24 v2, 1536, v6
    v_lshl_add_u32 v2, v5, 4, v2
    s_mul_i32 s48, s47, 768
    v_add_u32 v12, s48, v2
    s_mul_i32 s48, s63, 6
    s_mul_i32 s49, s47, 3
    s_add_u32 s48, s48, s49
    s_lshl_b32 s49, s62, 2
    s_lshl_b32 s50, s46, 1
    s_add_u32 s49, s49, s50
    s_mul_i32 s49, s49, 9
    s_add_u32 s50, s48, 0
    s_mul_i32 s51, s50, 57
    s_lshr_b32 s51, s51, 9
    s_mul_i32 s51, s51, 1287
    s_add_u32 s50, s50, s51
    s_add_u32 s50, s50, s49
    s_lshl_b32 s50, s50, 10
    s_add_u32 s52, s50, 16777216
    s_add_u32 s55, s50, 16786432
    s_add_u32 s50, s48, 1
    s_mul_i32 s51, s50, 57
    s_lshr_b32 s51, s51, 9
    s_mul_i32 s51, s51, 1287
    s_add_u32 s50, s50, s51
    s_add_u32 s50, s50, s49
    s_lshl_b32 s50, s50, 10
    s_add_u32 s53, s50, 16777216
    s_add_u32 s56, s50, 16786432
    s_add_u32 s50, s48, 2
    s_mul_i32 s51, s50, 57
    s_lshr_b32 s51, s51, 9
    s_mul_i32 s51, s51, 1287
    s_add_u32 s50, s50, s51
    s_add_u32 s50, s50, s49
    s_lshl_b32 s50, s50, 10
    s_add_u32 s54, s50, 16777216
    s_add_u32 s57, s50, 16786432
    s_mul_i32 s58, s62, 6
    s_add_u32 s58, s58, s63
    s_lshl_b32 s58, s58, 3
    s_add_u32 s58, s58, s3
    s_lshl_b32 s58, s58, 7
    s_add_u32 s58, s58, 262528
    v_mov_b32 v140, 0xc0135761
    v_mov_b32 v141, 0xc0135761
    v_mov_b32 v142, 0xbdd2d3e8
    v_mov_b32 v143, 0xbdd2d3e8
    v_mov_b32 v144, 0x3f800000
    v_mov_b32 v145, 0x3f800000
    s_mov_b32 s42, 0xffff0000
    v_lshlrev_b32 v88, 16, v160
    v_and_b32 v89, s42, v160
    v_lshlrev_b32 v90, 16, v161
    v_and_b32 v91, s42, v161
    v_lshlrev_b32 v92, 16, v160
    v_and_b32 v93, s42, v160
    v_lshlrev_b32 v94, 16, v161
    v_and_b32 v95, s42, v161
    v_lshlrev_b32 v96, 16, v160
    v_and_b32 v97, s42, v160
    v_lshlrev_b32 v98, 16, v161
    v_and_b32 v99, s42, v161
    v_lshlrev_b32 v100, 16, v162
    v_and_b32 v101, s42, v162
    v_lshlrev_b32 v102, 16, v163
    v_and_b32 v103, s42, v163
    v_lshlrev_b32 v104, 16, v162
    v_and_b32 v105, s42, v162
    v_lshlrev_b32 v106, 16, v163
    v_and_b32 v107, s42, v163
    v_lshlrev_b32 v108, 16, v162
    v_and_b32 v109, s42, v162
    v_lshlrev_b32 v110, 16, v163
    v_and_b32 v111, s42, v163
    v_lshlrev_b32 v112, 16, v164
    v_and_b32 v113, s42, v164
    v_lshlrev_b32 v114, 16, v165
    v_and_b32 v115, s42, v165
    v_lshlrev_b32 v116, 16, v164
    v_and_b32 v117, s42, v164
    v_lshlrev_b32 v118, 16, v165
    v_and_b32 v119, s42, v165
    v_lshlrev_b32 v120, 16, v164
    v_and_b32 v121, s42, v164
    v_lshlrev_b32 v122, 16, v165
    v_and_b32 v123, s42, v165
    v_lshlrev_b32 v124, 16, v166
    v_and_b32 v125, s42, v166
    v_lshlrev_b32 v126, 16, v167
    v_and_b32 v127, s42, v167
    v_lshlrev_b32 v128, 16, v166
    v_and_b32 v129, s42, v166
    v_lshlrev_b32 v130, 16, v167
    v_and_b32 v131, s42, v167
    v_lshlrev_b32 v132, 16, v166
    v_and_b32 v133, s42, v166
    v_lshlrev_b32 v134, 16, v167
    v_and_b32 v135, s42, v167
    s_mov_b32 s24, 65536
    s_mov_b32 s4, 12288
    v_add_u32 v16, s24, v8
    v_add_u32 v17, s24, v9
    v_add_u32 v18, s24, v10
    v_add_u32 v19, s24, v11
    v_add_u32 v20, s4, v12
    s_movk_i32 s59, 31
    s_barrier
    ds_read_b128 v[48:51], v20 offset:0
    ds_read_b64_tr_b16 v[32:33], v16 offset:0
    ds_read_b64_tr_b16 v[34:35], v16 offset:1024
    ds_read_b64_tr_b16 v[36:37], v17 offset:0
    ds_read_b64_tr_b16 v[38:39], v17 offset:1024
    ds_read_b64_tr_b16 v[40:41], v18 offset:0
    ds_read_b64_tr_b16 v[42:43], v18 offset:1024
    ds_read_b64_tr_b16 v[44:45], v19 offset:0
    ds_read_b64_tr_b16 v[46:47], v19 offset:1024
    ds_read_b128 v[52:55], v20 offset:256
    ds_read_b128 v[56:59], v20 offset:512
    s_add_u32 s24, s24, 16384
    s_add_u32 s4, s4, 12288
    s_cmp_eq_u32 s24, 163840
    s_cselect_b32 s24, 65536, s24
    s_cmp_eq_u32 s4, 61440
    s_cselect_b32 s4, 0, s4
    .p2align 6
g1_mm_loop:
    s_waitcnt lgkmcnt(0)
    v_mfma_f32_16x16x32_bf16 v[88:91], v[32:35], v[48:51], v[88:91]
    ds_read_b128 v[76:79], v20 offset:6144
    ds_read_b64_tr_b16 v[60:61], v16 offset:8192
    v_mfma_f32_16x16x32_bf16 v[100:103], v[36:39], v[48:51], v[100:103]
    ds_read_b64_tr_b16 v[62:63], v16 offset:9216
    ds_read_b64_tr_b16 v[64:65], v17 offset:8192
    v_mfma_f32_16x16x32_bf16 v[112:115], v[40:43], v[48:51], v[112:115]
    ds_read_b64_tr_b16 v[66:67], v17 offset:9216
    ds_read_b64_tr_b16 v[68:69], v18 offset:8192
    v_mfma_f32_16x16x32_bf16 v[124:127], v[44:47], v[48:51], v[124:127]
    ds_read_b64_tr_b16 v[70:71], v18 offset:9216
    ds_read_b64_tr_b16 v[72:73], v19 offset:8192
    v_mfma_f32_16x16x32_bf16 v[128:131], v[44:47], v[52:55], v[128:131]
    ds_read_b64_tr_b16 v[74:75], v19 offset:9216
    ds_read_b128 v[80:83], v20 offset:6400
    v_mfma_f32_16x16x32_bf16 v[116:119], v[40:43], v[52:55], v[116:119]
    ds_read_b128 v[84:87], v20 offset:6656
    v_add_u32 v16, s24, v8
    v_mfma_f32_16x16x32_bf16 v[104:107], v[36:39], v[52:55], v[104:107]
    v_add_u32 v17, s24, v9
    v_add_u32 v18, s24, v10
    v_mfma_f32_16x16x32_bf16 v[92:95], v[32:35], v[52:55], v[92:95]
    v_add_u32 v19, s24, v11
    v_add_u32 v20, s4, v12
    v_mfma_f32_16x16x32_bf16 v[96:99], v[32:35], v[56:59], v[96:99]
    v_mfma_f32_16x16x32_bf16 v[108:111], v[36:39], v[56:59], v[108:111]
    s_waitcnt lgkmcnt(0)
    s_barrier
    v_mfma_f32_16x16x32_bf16 v[120:123], v[40:43], v[56:59], v[120:123]
    v_mfma_f32_16x16x32_bf16 v[132:135], v[44:47], v[56:59], v[132:135]
    v_mfma_f32_16x16x32_bf16 v[88:91], v[60:63], v[76:79], v[88:91]
    ds_read_b128 v[48:51], v20 offset:0
    ds_read_b64_tr_b16 v[32:33], v16 offset:0
    v_mfma_f32_16x16x32_bf16 v[100:103], v[64:67], v[76:79], v[100:103]
    ds_read_b64_tr_b16 v[34:35], v16 offset:1024
    ds_read_b64_tr_b16 v[36:37], v17 offset:0
    v_mfma_f32_16x16x32_bf16 v[112:115], v[68:71], v[76:79], v[112:115]
    ds_read_b64_tr_b16 v[38:39], v17 offset:1024
    ds_read_b64_tr_b16 v[40:41], v18 offset:0
    v_mfma_f32_16x16x32_bf16 v[124:127], v[72:75], v[76:79], v[124:127]
    ds_read_b64_tr_b16 v[42:43], v18 offset:1024
    ds_read_b64_tr_b16 v[44:45], v19 offset:0
    v_mfma_f32_16x16x32_bf16 v[128:131], v[72:75], v[80:83], v[128:131]
    ds_read_b64_tr_b16 v[46:47], v19 offset:1024
    ds_read_b128 v[52:55], v20 offset:256
    v_mfma_f32_16x16x32_bf16 v[116:119], v[68:71], v[80:83], v[116:119]
    ds_read_b128 v[56:59], v20 offset:512
    s_add_u32 s24, s24, 16384
    v_mfma_f32_16x16x32_bf16 v[104:107], v[64:67], v[80:83], v[104:107]
    s_add_u32 s4, s4, 12288
    s_cmp_eq_u32 s24, 163840
    v_mfma_f32_16x16x32_bf16 v[92:95], v[60:63], v[80:83], v[92:95]
    s_cselect_b32 s24, 65536, s24
    s_cmp_eq_u32 s4, 61440
    v_mfma_f32_16x16x32_bf16 v[96:99], v[60:63], v[84:87], v[96:99]
    s_cselect_b32 s4, 0, s4
    s_sub_u32 s59, s59, 1
    v_mfma_f32_16x16x32_bf16 v[108:111], v[64:67], v[84:87], v[108:111]
    s_cmp_lg_u32 s59, 0
    v_mfma_f32_16x16x32_bf16 v[120:123], v[68:71], v[84:87], v[120:123]
    v_mfma_f32_16x16x32_bf16 v[132:135], v[72:75], v[84:87], v[132:135]
    s_cbranch_scc1 g1_mm_loop
    s_waitcnt lgkmcnt(0)
    v_mfma_f32_16x16x32_bf16 v[88:91], v[32:35], v[48:51], v[88:91]
    ds_read_b128 v[76:79], v20 offset:6144
    ds_read_b64_tr_b16 v[60:61], v16 offset:8192
    v_mfma_f32_16x16x32_bf16 v[100:103], v[36:39], v[48:51], v[100:103]
    ds_read_b64_tr_b16 v[62:63], v16 offset:9216
    ds_read_b64_tr_b16 v[64:65], v17 offset:8192
    v_mfma_f32_16x16x32_bf16 v[112:115], v[40:43], v[48:51], v[112:115]
    ds_read_b64_tr_b16 v[66:67], v17 offset:9216
    ds_read_b64_tr_b16 v[68:69], v18 offset:8192
    v_mfma_f32_16x16x32_bf16 v[124:127], v[44:47], v[48:51], v[124:127]
    ds_read_b64_tr_b16 v[70:71], v18 offset:9216
    ds_read_b64_tr_b16 v[72:73], v19 offset:8192
    v_mfma_f32_16x16x32_bf16 v[128:131], v[44:47], v[52:55], v[128:131]
    ds_read_b64_tr_b16 v[74:75], v19 offset:9216
    ds_read_b128 v[80:83], v20 offset:6400
    v_mfma_f32_16x16x32_bf16 v[116:119], v[40:43], v[52:55], v[116:119]
    ds_read_b128 v[84:87], v20 offset:6656
    v_mfma_f32_16x16x32_bf16 v[104:107], v[36:39], v[52:55], v[104:107]
    v_mfma_f32_16x16x32_bf16 v[92:95], v[32:35], v[52:55], v[92:95]
    v_mfma_f32_16x16x32_bf16 v[96:99], v[32:35], v[56:59], v[96:99]
    v_mfma_f32_16x16x32_bf16 v[108:111], v[36:39], v[56:59], v[108:111]
    v_mfma_f32_16x16x32_bf16 v[120:123], v[40:43], v[56:59], v[120:123]
    v_mfma_f32_16x16x32_bf16 v[132:135], v[44:47], v[56:59], v[132:135]
    s_waitcnt lgkmcnt(0)
    s_barrier
    v_mfma_f32_16x16x32_bf16 v[88:91], v[60:63], v[76:79], v[88:91]
    v_mfma_f32_16x16x32_bf16 v[100:103], v[64:67], v[76:79], v[100:103]
    v_mfma_f32_16x16x32_bf16 v[112:115], v[68:71], v[76:79], v[112:115]
    v_mfma_f32_16x16x32_bf16 v[124:127], v[72:75], v[76:79], v[124:127]
    v_mfma_f32_16x16x32_bf16 v[128:131], v[72:75], v[80:83], v[128:131]
    v_mfma_f32_16x16x32_bf16 v[116:119], v[68:71], v[80:83], v[116:119]
    v_mfma_f32_16x16x32_bf16 v[104:107], v[64:67], v[80:83], v[104:107]
    v_mfma_f32_16x16x32_bf16 v[92:95], v[60:63], v[80:83], v[92:95]
    v_mfma_f32_16x16x32_bf16 v[96:99], v[60:63], v[84:87], v[96:99]
    v_mfma_f32_16x16x32_bf16 v[108:111], v[64:67], v[84:87], v[108:111]
    v_mfma_f32_16x16x32_bf16 v[120:123], v[68:71], v[84:87], v[120:123]
    v_mfma_f32_16x16x32_bf16 v[132:135], v[72:75], v[84:87], v[132:135]
    v_pk_mul_f32 v[60:61], v[88:89], v[88:89]
    v_pk_mul_f32 v[62:63], v[90:91], v[90:91]
    v_pk_mul_f32 v[64:65], v[100:101], v[100:101]
    v_pk_mul_f32 v[66:67], v[102:103], v[102:103]
    v_pk_fma_f32 v[60:61], v[60:61], v[142:143], v[140:141]
    v_pk_fma_f32 v[62:63], v[62:63], v[142:143], v[140:141]
    v_pk_fma_f32 v[64:65], v[64:65], v[142:143], v[140:141]
    v_pk_fma_f32 v[66:67], v[66:67], v[142:143], v[140:141]
    v_pk_mul_f32 v[60:61], v[60:61], v[88:89]
    v_pk_mul_f32 v[62:63], v[62:63], v[90:91]
    v_pk_mul_f32 v[64:65], v[64:65], v[100:101]
    v_pk_mul_f32 v[66:67], v[66:67], v[102:103]
    v_exp_f32 v60, v60
    v_exp_f32 v61, v61
    v_exp_f32 v62, v62
    v_exp_f32 v63, v63
    v_exp_f32 v64, v64
    v_exp_f32 v65, v65
    v_exp_f32 v66, v66
    v_exp_f32 v67, v67
    v_pk_add_f32 v[60:61], v[60:61], v[144:145]
    v_pk_add_f32 v[62:63], v[62:63], v[144:145]
    v_pk_add_f32 v[64:65], v[64:65], v[144:145]
    v_pk_add_f32 v[66:67], v[66:67], v[144:145]
    v_rcp_f32 v60, v60
    v_rcp_f32 v61, v61
    v_rcp_f32 v62, v62
    v_rcp_f32 v63, v63
    v_rcp_f32 v64, v64
    v_rcp_f32 v65, v65
    v_rcp_f32 v66, v66
    v_rcp_f32 v67, v67
    v_pk_mul_f32 v[88:89], v[88:89], v[60:61]
    v_pk_mul_f32 v[90:91], v[90:91], v[62:63]
    v_pk_mul_f32 v[100:101], v[100:101], v[64:65]
    v_pk_mul_f32 v[102:103], v[102:103], v[66:67]
    v_cvt_pk_bf16_f32 v72, v88, v89
    v_cvt_pk_bf16_f32 v73, v90, v91
    v_cvt_pk_bf16_f32 v74, v100, v101
    v_cvt_pk_bf16_f32 v75, v102, v103
    buffer_store_dwordx4 v[72:75], v14, s[28:31], s52 offen sc1
    v_pk_mul_f32 v[60:61], v[112:113], v[112:113]
    v_pk_mul_f32 v[62:63], v[114:115], v[114:115]
    v_pk_mul_f32 v[64:65], v[124:125], v[124:125]
    v_pk_mul_f32 v[66:67], v[126:127], v[126:127]
    v_pk_fma_f32 v[60:61], v[60:61], v[142:143], v[140:141]
    v_pk_fma_f32 v[62:63], v[62:63], v[142:143], v[140:141]
    v_pk_fma_f32 v[64:65], v[64:65], v[142:143], v[140:141]
    v_pk_fma_f32 v[66:67], v[66:67], v[142:143], v[140:141]
    v_pk_mul_f32 v[60:61], v[60:61], v[112:113]
    v_pk_mul_f32 v[62:63], v[62:63], v[114:115]
    v_pk_mul_f32 v[64:65], v[64:65], v[124:125]
    v_pk_mul_f32 v[66:67], v[66:67], v[126:127]
    v_exp_f32 v60, v60
    v_exp_f32 v61, v61
    v_exp_f32 v62, v62
    v_exp_f32 v63, v63
    v_exp_f32 v64, v64
    v_exp_f32 v65, v65
    v_exp_f32 v66, v66
    v_exp_f32 v67, v67
    v_pk_add_f32 v[60:61], v[60:61], v[144:145]
    v_pk_add_f32 v[62:63], v[62:63], v[144:145]
    v_pk_add_f32 v[64:65], v[64:65], v[144:145]
    v_pk_add_f32 v[66:67], v[66:67], v[144:145]
    v_rcp_f32 v60, v60
    v_rcp_f32 v61, v61
    v_rcp_f32 v62, v62
    v_rcp_f32 v63, v63
    v_rcp_f32 v64, v64
    v_rcp_f32 v65, v65
    v_rcp_f32 v66, v66
    v_rcp_f32 v67, v67
    v_pk_mul_f32 v[112:113], v[112:113], v[60:61]
    v_pk_mul_f32 v[114:115], v[114:115], v[62:63]
    v_pk_mul_f32 v[124:125], v[124:125], v[64:65]
    v_pk_mul_f32 v[126:127], v[126:127], v[66:67]
    v_cvt_pk_bf16_f32 v76, v112, v113
    v_cvt_pk_bf16_f32 v77, v114, v115
    v_cvt_pk_bf16_f32 v78, v124, v125
    v_cvt_pk_bf16_f32 v79, v126, v127
    buffer_store_dwordx4 v[76:79], v14, s[28:31], s55 offen sc1
    v_pk_mul_f32 v[60:61], v[92:93], v[92:93]
    v_pk_mul_f32 v[62:63], v[94:95], v[94:95]
    v_pk_mul_f32 v[64:65], v[104:105], v[104:105]
    v_pk_mul_f32 v[66:67], v[106:107], v[106:107]
    v_pk_fma_f32 v[60:61], v[60:61], v[142:143], v[140:141]
    v_pk_fma_f32 v[62:63], v[62:63], v[142:143], v[140:141]
    v_pk_fma_f32 v[64:65], v[64:65], v[142:143], v[140:141]
    v_pk_fma_f32 v[66:67], v[66:67], v[142:143], v[140:141]
    v_pk_mul_f32 v[60:61], v[60:61], v[92:93]
    v_pk_mul_f32 v[62:63], v[62:63], v[94:95]
    v_pk_mul_f32 v[64:65], v[64:65], v[104:105]
    v_pk_mul_f32 v[66:67], v[66:67], v[106:107]
    v_exp_f32 v60, v60
    v_exp_f32 v61, v61
    v_exp_f32 v62, v62
    v_exp_f32 v63, v63
    v_exp_f32 v64, v64
    v_exp_f32 v65, v65
    v_exp_f32 v66, v66
    v_exp_f32 v67, v67
    v_pk_add_f32 v[60:61], v[60:61], v[144:145]
    v_pk_add_f32 v[62:63], v[62:63], v[144:145]
    v_pk_add_f32 v[64:65], v[64:65], v[144:145]
    v_pk_add_f32 v[66:67], v[66:67], v[144:145]
    v_rcp_f32 v60, v60
    v_rcp_f32 v61, v61
    v_rcp_f32 v62, v62
    v_rcp_f32 v63, v63
    v_rcp_f32 v64, v64
    v_rcp_f32 v65, v65
    v_rcp_f32 v66, v66
    v_rcp_f32 v67, v67
    v_pk_mul_f32 v[92:93], v[92:93], v[60:61]
    v_pk_mul_f32 v[94:95], v[94:95], v[62:63]
    v_pk_mul_f32 v[104:105], v[104:105], v[64:65]
    v_pk_mul_f32 v[106:107], v[106:107], v[66:67]
    v_cvt_pk_bf16_f32 v72, v92, v93
    v_cvt_pk_bf16_f32 v73, v94, v95
    v_cvt_pk_bf16_f32 v74, v104, v105
    v_cvt_pk_bf16_f32 v75, v106, v107
    buffer_store_dwordx4 v[72:75], v14, s[28:31], s53 offen sc1
    v_pk_mul_f32 v[60:61], v[116:117], v[116:117]
    v_pk_mul_f32 v[62:63], v[118:119], v[118:119]
    v_pk_mul_f32 v[64:65], v[128:129], v[128:129]
    v_pk_mul_f32 v[66:67], v[130:131], v[130:131]
    v_pk_fma_f32 v[60:61], v[60:61], v[142:143], v[140:141]
    v_pk_fma_f32 v[62:63], v[62:63], v[142:143], v[140:141]
    v_pk_fma_f32 v[64:65], v[64:65], v[142:143], v[140:141]
    v_pk_fma_f32 v[66:67], v[66:67], v[142:143], v[140:141]
    v_pk_mul_f32 v[60:61], v[60:61], v[116:117]
    v_pk_mul_f32 v[62:63], v[62:63], v[118:119]
    v_pk_mul_f32 v[64:65], v[64:65], v[128:129]
    v_pk_mul_f32 v[66:67], v[66:67], v[130:131]
    v_exp_f32 v60, v60
    v_exp_f32 v61, v61
    v_exp_f32 v62, v62
    v_exp_f32 v63, v63
    v_exp_f32 v64, v64
    v_exp_f32 v65, v65
    v_exp_f32 v66, v66
    v_exp_f32 v67, v67
    v_pk_add_f32 v[60:61], v[60:61], v[144:145]
    v_pk_add_f32 v[62:63], v[62:63], v[144:145]
    v_pk_add_f32 v[64:65], v[64:65], v[144:145]
    v_pk_add_f32 v[66:67], v[66:67], v[144:145]
    v_rcp_f32 v60, v60
    v_rcp_f32 v61, v61
    v_rcp_f32 v62, v62
    v_rcp_f32 v63, v63
    v_rcp_f32 v64, v64
    v_rcp_f32 v65, v65
    v_rcp_f32 v66, v66
    v_rcp_f32 v67, v67
    v_pk_mul_f32 v[116:117], v[116:117], v[60:61]
    v_pk_mul_f32 v[118:119], v[118:119], v[62:63]
    v_pk_mul_f32 v[128:129], v[128:129], v[64:65]
    v_pk_mul_f32 v[130:131], v[130:131], v[66:67]
    v_cvt_pk_bf16_f32 v76, v116, v117
    v_cvt_pk_bf16_f32 v77, v118, v119
    v_cvt_pk_bf16_f32 v78, v128, v129
    v_cvt_pk_bf16_f32 v79, v130, v131
    buffer_store_dwordx4 v[76:79], v14, s[28:31], s56 offen sc1
    v_pk_mul_f32 v[60:61], v[96:97], v[96:97]
    v_pk_mul_f32 v[62:63], v[98:99], v[98:99]
    v_pk_mul_f32 v[64:65], v[108:109], v[108:109]
    v_pk_mul_f32 v[66:67], v[110:111], v[110:111]
    v_pk_fma_f32 v[60:61], v[60:61], v[142:143], v[140:141]
    v_pk_fma_f32 v[62:63], v[62:63], v[142:143], v[140:141]
    v_pk_fma_f32 v[64:65], v[64:65], v[142:143], v[140:141]
    v_pk_fma_f32 v[66:67], v[66:67], v[142:143], v[140:141]
    v_pk_mul_f32 v[60:61], v[60:61], v[96:97]
    v_pk_mul_f32 v[62:63], v[62:63], v[98:99]
    v_pk_mul_f32 v[64:65], v[64:65], v[108:109]
    v_pk_mul_f32 v[66:67], v[66:67], v[110:111]
    v_exp_f32 v60, v60
    v_exp_f32 v61, v61
    v_exp_f32 v62, v62
    v_exp_f32 v63, v63
    v_exp_f32 v64, v64
    v_exp_f32 v65, v65
    v_exp_f32 v66, v66
    v_exp_f32 v67, v67
    v_pk_add_f32 v[60:61], v[60:61], v[144:145]
    v_pk_add_f32 v[62:63], v[62:63], v[144:145]
    v_pk_add_f32 v[64:65], v[64:65], v[144:145]
    v_pk_add_f32 v[66:67], v[66:67], v[144:145]
    v_rcp_f32 v60, v60
    v_rcp_f32 v61, v61
    v_rcp_f32 v62, v62
    v_rcp_f32 v63, v63
    v_rcp_f32 v64, v64
    v_rcp_f32 v65, v65
    v_rcp_f32 v66, v66
    v_rcp_f32 v67, v67
    v_pk_mul_f32 v[96:97], v[96:97], v[60:61]
    v_pk_mul_f32 v[98:99], v[98:99], v[62:63]
    v_pk_mul_f32 v[108:109], v[108:109], v[64:65]
    v_pk_mul_f32 v[110:111], v[110:111], v[66:67]
    v_cvt_pk_bf16_f32 v72, v96, v97
    v_cvt_pk_bf16_f32 v73, v98, v99
    v_cvt_pk_bf16_f32 v74, v108, v109
    v_cvt_pk_bf16_f32 v75, v110, v111
    buffer_store_dwordx4 v[72:75], v14, s[28:31], s54 offen sc1
    v_pk_mul_f32 v[60:61], v[120:121], v[120:121]
    v_pk_mul_f32 v[62:63], v[122:123], v[122:123]
    v_pk_mul_f32 v[64:65], v[132:133], v[132:133]
    v_pk_mul_f32 v[66:67], v[134:135], v[134:135]
    v_pk_fma_f32 v[60:61], v[60:61], v[142:143], v[140:141]
    v_pk_fma_f32 v[62:63], v[62:63], v[142:143], v[140:141]
    v_pk_fma_f32 v[64:65], v[64:65], v[142:143], v[140:141]
    v_pk_fma_f32 v[66:67], v[66:67], v[142:143], v[140:141]
    v_pk_mul_f32 v[60:61], v[60:61], v[120:121]
    v_pk_mul_f32 v[62:63], v[62:63], v[122:123]
    v_pk_mul_f32 v[64:65], v[64:65], v[132:133]
    v_pk_mul_f32 v[66:67], v[66:67], v[134:135]
    v_exp_f32 v60, v60
    v_exp_f32 v61, v61
    v_exp_f32 v62, v62
    v_exp_f32 v63, v63
    v_exp_f32 v64, v64
    v_exp_f32 v65, v65
    v_exp_f32 v66, v66
    v_exp_f32 v67, v67
    v_pk_add_f32 v[60:61], v[60:61], v[144:145]
    v_pk_add_f32 v[62:63], v[62:63], v[144:145]
    v_pk_add_f32 v[64:65], v[64:65], v[144:145]
    v_pk_add_f32 v[66:67], v[66:67], v[144:145]
    v_rcp_f32 v60, v60
    v_rcp_f32 v61, v61
    v_rcp_f32 v62, v62
    v_rcp_f32 v63, v63
    v_rcp_f32 v64, v64
    v_rcp_f32 v65, v65
    v_rcp_f32 v66, v66
    v_rcp_f32 v67, v67
    v_pk_mul_f32 v[120:121], v[120:121], v[60:61]
    v_pk_mul_f32 v[122:123], v[122:123], v[62:63]
    v_pk_mul_f32 v[132:133], v[132:133], v[64:65]
    v_pk_mul_f32 v[134:135], v[134:135], v[66:67]
    v_cvt_pk_bf16_f32 v76, v120, v121
    v_cvt_pk_bf16_f32 v77, v122, v123
    v_cvt_pk_bf16_f32 v78, v132, v133
    v_cvt_pk_bf16_f32 v79, v134, v135
    buffer_store_dwordx4 v[76:79], v14, s[28:31], s57 offen sc1
    v_mov_b32 v3, 1
    s_waitcnt vmcnt(0)
    s_mov_b64 exec, 1
    buffer_store_dword v3, off, s[28:31], s58 sc1
    s_mov_b64 exec, -1
    s_barrier
t_cons2:
    s_lshr_b32 s44, s36, 1
    s_and_b32 s45, s36, 1
    s_lshl_b32 s45, s45, 3
    s_lshr_b32 s46, s37, 2
    s_add_u32 s45, s45, s46
    s_and_b32 s46, s37, 3
    s_lshr_b32 s47, s44, 1
    s_and_b32 s48, s44, 1
    s_lshl_b32 s40, s3, 1
    s_add_u32 s40, s40, s47
    s_xor_b32 s41, s40, 1
    v_lshrrev_b32 v2, 2, v5
    v_and_b32 v3, 1, v6
    v_lshl_add_u32 v3, v3, 2, v2
    v_mad_u32_u24 v2, v6, 4, v2
    v_lshlrev_b32 v2, 8, v2
    v_and_b32 v4, 3, v1
    v_lshl_add_u32 v2, v4, 3, v2
    v_xor_b32 v4, s40, v3
    v_lshl_add_u32 v8, v4, 5, v2
    v_xor_b32 v4, s41, v3
    v_lshl_add_u32 v9, v4, 5, v2
    s_lshl_b32 s42, s48, 12
    s_add_u32 s43, s42, 81920
    v_add_u32 v10, s43, v14
    s_xor_b32 s43, s43, 4096
    v_add_u32 v11, s43, v14
    v_add_u32 v12, 90112, v14
    s_lshl_b32 s49, s45, 3
    s_add_u32 s49, s49, s40
    s_lshl_b32 s49, s49, 4
    v_add_u32 v2, s49, v5
    v_mov_b32 v230, 0
    v_lshlrev_b32 v3, 1, v2
    buffer_load_short_d16_hi v230, v3, s[12:15], 0 offen
    v_mul_u32_u24 v2, 1152, v2
    v_lshl_add_u32 v22, v6, 3, v2
    s_mul_i32 s49, s46, 288
    s_lshl_b32 s52, s48, 7
    s_add_u32 s52, s52, s49
    s_lshl_b32 s53, s48, 2
    s_add_u32 s53, s53, s49
    s_add_u32 s53, s53, 256
    s_add_u32 s54, s52, 10485760
    s_add_u32 s55, s53, 10485760
    v_lshlrev_b32 v3, 4, v6
    s_lshl_b32 s56, s52, 1
    s_add_u32 s56, s56, 11520
    s_lshl_b32 s57, s53, 1
    s_add_u32 s57, s57, 11520
    v_mov_b32 v115, s26
    v_mov_b32 v119, s26
    v_mov_b32 v123, s26
    v_mov_b32 v235, s26
    v_mov_b32 v239, s26
    v_mov_b32 v243, s26
    v_mov_b32 v247, s26
    v_mov_b32 v251, s26
    v_mov_b32 v255, s26
    s_lshl_b32 s50, s46, 4
    s_add_u32 s50, s50, s45
    s_lshl_b32 s50, s50, 2
    s_add_u32 s50, s50, s3
    s_lshl_b32 s50, s50, 4
    s_xor_b32 s51, s44, 1
    s_lshl_b32 s61, s51, 2
    s_add_u32 s61, s61, s44
    s_add_u32 s61, s61, s50
    s_mul_i32 s61, s61, 3072
    s_add_u32 s61, s61, 25165824
    s_lshl_b32 s5, s44, 2
    s_add_u32 s5, s5, s51
    s_add_u32 s5, s5, s50
    s_mul_i32 s5, s5, 3072
    s_add_u32 s5, s5, 25165824
    s_xor_b32 s51, s44, 2
    s_lshl_b32 s62, s51, 2
    s_add_u32 s62, s62, s44
    s_add_u32 s62, s62, s50
    s_mul_i32 s62, s62, 3072
    s_add_u32 s62, s62, 25165824
    s_lshl_b32 s6, s44, 2
    s_add_u32 s6, s6, s51
    s_add_u32 s6, s6, s50
    s_mul_i32 s6, s6, 3072
    s_add_u32 s6, s6, 25165824
    s_xor_b32 s51, s44, 3
    s_lshl_b32 s63, s51, 2
    s_add_u32 s63, s63, s44
    s_add_u32 s63, s63, s50
    s_mul_i32 s63, s63, 3072
    s_add_u32 s63, s63, 25165824
    s_lshl_b32 s7, s44, 2
    s_add_u32 s7, s7, s51
    s_add_u32 s7, s7, s50
    s_mul_i32 s7, s7, 3072
    s_add_u32 s7, s7, 25165824
    v_mov_b32 v23, s5
    v_writelane_b32 v23, s6, 1
    v_writelane_b32 v23, s7, 2
    s_cmp_lt_u32 s2, 216
    s_cbranch_scc0 g2_late_ops
    buffer_load_dwordx2 v[200:201], v22, s[28:31], s54 offen offset:0
    buffer_load_dwordx2 v[202:203], v22, s[28:31], s54 offen offset:32
    buffer_load_dwordx2 v[204:205], v22, s[28:31], s54 offen offset:64
    buffer_load_dwordx2 v[206:207], v22, s[28:31], s54 offen offset:96
    buffer_load_dword v208, v22, s[28:31], s55 offen
    buffer_load_dwordx4 v[210:213], v3, s[28:31], s56 offen offset:0
    buffer_load_dwordx4 v[214:217], v3, s[28:31], s56 offen offset:64
    buffer_load_dwordx4 v[218:221], v3, s[28:31], s56 offen offset:128
    buffer_load_dwordx4 v[222:225], v3, s[28:31], s56 offen offset:192
    buffer_load_dwordx2 v[226:227], v3, s[28:31], s57 offen
g2_late_ops:
    v_mov_b32 v128, 0
    v_mov_b32 v129, 0
    v_mov_b32 v130, 0
    v_mov_b32 v131, 0
    v_mov_b32 v132, 0
    v_mov_b32 v133, 0
    v_mov_b32 v134, 0
    v_mov_b32 v135, 0
    v_mov_b32 v136, 0
    v_mov_b32 v137, 0
    v_mov_b32 v138, 0
    v_mov_b32 v139, 0
    v_mov_b32 v140, 0
    v_mov_b32 v141, 0
    v_mov_b32 v142, 0
    v_mov_b32 v143, 0
    v_mov_b32 v144, 0
    v_mov_b32 v145, 0
    v_mov_b32 v146, 0
    v_mov_b32 v147, 0
    v_mov_b32 v148, 0
    v_mov_b32 v149, 0
    v_mov_b32 v150, 0
    v_mov_b32 v151, 0
    v_mov_b32 v152, 0
    v_mov_b32 v153, 0
    v_mov_b32 v154, 0
    v_mov_b32 v155, 0
    v_mov_b32 v156, 0
    v_mov_b32 v157, 0
    v_mov_b32 v158, 0
    v_mov_b32 v159, 0
    v_mov_b32 v160, 0
    v_mov_b32 v161, 0
    v_mov_b32 v162, 0
    v_mov_b32 v163, 0
    v_mov_b32 v164, 0
    v_mov_b32 v165, 0
    v_mov_b32 v166, 0
    v_mov_b32 v167, 0
    v_mov_b32 v168, 0
    v_mov_b32 v169, 0
    v_mov_b32 v170, 0
    v_mov_b32 v171, 0
    v_mov_b32 v172, 0
    v_mov_b32 v173, 0
    v_mov_b32 v174, 0
    v_mov_b32 v175, 0
    v_mov_b32 v176, 0
    v_mov_b32 v177, 0
    v_mov_b32 v178, 0
    v_mov_b32 v179, 0
    v_mov_b32 v180, 0
    v_mov_b32 v181, 0
    v_mov_b32 v182, 0
    v_mov_b32 v183, 0
    v_mov_b32 v184, 0
    v_mov_b32 v185, 0
    v_mov_b32 v186, 0
    v_mov_b32 v187, 0
    v_mov_b32 v188, 0
    v_mov_b32 v189, 0
    v_mov_b32 v190, 0
    v_mov_b32 v191, 0
    v_mov_b32 v192, 0
    v_mov_b32 v193, 0
    v_mov_b32 v194, 0
    v_mov_b32 v195, 0
    v_mov_b32 v196, 0
    v_mov_b32 v197, 0
    v_mov_b32 v198, 0
    v_mov_b32 v199, 0
    s_mov_b32 s24, 0
    s_mov_b32 s4, 0
    v_add_u32 v16, s24, v8
    v_add_u32 v17, s24, v9
    v_add_u32 v18, s4, v10
    v_add_u32 v19, s4, v11
    v_add_u32 v20, s4, v12
    s_movk_i32 s59, 17
    s_barrier
    ds_read_b128 v[32:35], v18 offset:0
    ds_read_b64_tr_b16 v[24:25], v16 offset:0
    ds_read_b64_tr_b16 v[26:27], v16 offset:4096
    ds_read_b64_tr_b16 v[28:29], v17 offset:0
    ds_read_b64_tr_b16 v[30:31], v17 offset:4096
    ds_read_b128 v[36:39], v18 offset:1024
    ds_read_b128 v[40:43], v18 offset:2048
    ds_read_b128 v[44:47], v18 offset:3072
    ds_read_b128 v[48:51], v19 offset:0
    ds_read_b128 v[52:55], v19 offset:1024
    ds_read_b128 v[56:59], v19 offset:2048
    ds_read_b128 v[60:63], v19 offset:3072
    ds_read_b128 v[64:67], v20 offset:0
    s_cmp_lt_u32 s2, 216
    s_cbranch_scc1 g2_late_done
    buffer_load_dwordx2 v[200:201], v22, s[28:31], s54 offen offset:0
    buffer_load_dwordx2 v[202:203], v22, s[28:31], s54 offen offset:32
    buffer_load_dwordx2 v[204:205], v22, s[28:31], s54 offen offset:64
    buffer_load_dwordx2 v[206:207], v22, s[28:31], s54 offen offset:96
    buffer_load_dword v208, v22, s[28:31], s55 offen
    buffer_load_dwordx4 v[210:213], v3, s[28:31], s56 offen offset:0
    buffer_load_dwordx4 v[214:217], v3, s[28:31], s56 offen offset:64
    buffer_load_dwordx4 v[218:221], v3, s[28:31], s56 offen offset:128
    buffer_load_dwordx4 v[222:225], v3, s[28:31], s56 offen offset:192
    buffer_load_dwordx2 v[226:227], v3, s[28:31], s57 offen
g2_late_done:
    s_add_u32 s24, s24, 16384
    s_cmp_eq_u32 s24, 81920
    s_cselect_b32 s24, 0, s24
    s_add_u32 s4, s4, 18432
    s_cmp_eq_u32 s4, 73728
    s_cselect_b32 s4, 0, s4
    .p2align 6
g2_mm_loop:
    s_waitcnt lgkmcnt(0)
    v_mfma_f32_16x16x32_bf16 v[128:131], v[32:35], v[24:27], v[128:131]
    ds_read_b128 v[76:79], v18 offset:9216
    ds_read_b64_tr_b16 v[68:69], v16 offset:8192
    v_mfma_f32_16x16x32_bf16 v[164:167], v[32:35], v[28:31], v[164:167]
    ds_read_b64_tr_b16 v[70:71], v16 offset:12288
    ds_read_b64_tr_b16 v[72:73], v17 offset:8192
    v_mfma_f32_16x16x32_bf16 v[168:171], v[36:39], v[28:31], v[168:171]
    ds_read_b64_tr_b16 v[74:75], v17 offset:12288
    ds_read_b128 v[80:83], v18 offset:10240
    v_mfma_f32_16x16x32_bf16 v[132:135], v[36:39], v[24:27], v[132:135]
    ds_read_b128 v[84:87], v18 offset:11264
    ds_read_b128 v[88:91], v18 offset:12288
    v_mfma_f32_16x16x32_bf16 v[136:139], v[40:43], v[24:27], v[136:139]
    ds_read_b128 v[92:95], v19 offset:9216
    ds_read_b128 v[96:99], v19 offset:10240
    v_mfma_f32_16x16x32_bf16 v[172:175], v[40:43], v[28:31], v[172:175]
    ds_read_b128 v[100:103], v19 offset:11264
    ds_read_b128 v[104:107], v19 offset:12288
    v_mfma_f32_16x16x32_bf16 v[176:179], v[44:47], v[28:31], v[176:179]
    ds_read_b128 v[108:111], v20 offset:9216
    v_add_u32 v16, s24, v8
    v_mfma_f32_16x16x32_bf16 v[140:143], v[44:47], v[24:27], v[140:143]
    v_add_u32 v17, s24, v9
    v_add_u32 v18, s4, v10
    v_mfma_f32_16x16x32_bf16 v[144:147], v[48:51], v[24:27], v[144:147]
    v_add_u32 v19, s4, v11
    v_add_u32 v20, s4, v12
    v_mfma_f32_16x16x32_bf16 v[180:183], v[48:51], v[28:31], v[180:183]
    v_mfma_f32_16x16x32_bf16 v[184:187], v[52:55], v[28:31], v[184:187]
    v_mfma_f32_16x16x32_bf16 v[148:151], v[52:55], v[24:27], v[148:151]
    v_mfma_f32_16x16x32_bf16 v[152:155], v[56:59], v[24:27], v[152:155]
    v_mfma_f32_16x16x32_bf16 v[188:191], v[56:59], v[28:31], v[188:191]
    v_mfma_f32_16x16x32_bf16 v[192:195], v[60:63], v[28:31], v[192:195]
    v_mfma_f32_16x16x32_bf16 v[156:159], v[60:63], v[24:27], v[156:159]
    s_waitcnt lgkmcnt(0)
    s_barrier
    v_mfma_f32_16x16x32_bf16 v[160:163], v[64:67], v[24:27], v[160:163]
    v_mfma_f32_16x16x32_bf16 v[196:199], v[64:67], v[28:31], v[196:199]
    v_mfma_f32_16x16x32_bf16 v[128:131], v[76:79], v[68:71], v[128:131]
    ds_read_b128 v[32:35], v18 offset:0
    ds_read_b64_tr_b16 v[24:25], v16 offset:0
    v_mfma_f32_16x16x32_bf16 v[164:167], v[76:79], v[72:75], v[164:167]
    ds_read_b64_tr_b16 v[26:27], v16 offset:4096
    ds_read_b64_tr_b16 v[28:29], v17 offset:0
    v_mfma_f32_16x16x32_bf16 v[168:171], v[80:83], v[72:75], v[168:171]
    ds_read_b64_tr_b16 v[30:31], v17 offset:4096
    ds_read_b128 v[36:39], v18 offset:1024
    v_mfma_f32_16x16x32_bf16 v[132:135], v[80:83], v[68:71], v[132:135]
    ds_read_b128 v[40:43], v18 offset:2048
    ds_read_b128 v[44:47], v18 offset:3072
    v_mfma_f32_16x16x32_bf16 v[136:139], v[84:87], v[68:71], v[136:139]
    ds_read_b128 v[48:51], v19 offset:0
    ds_read_b128 v[52:55], v19 offset:1024
    v_mfma_f32_16x16x32_bf16 v[172:175], v[84:87], v[72:75], v[172:175]
    ds_read_b128 v[56:59], v19 offset:2048
    ds_read_b128 v[60:63], v19 offset:3072
    v_mfma_f32_16x16x32_bf16 v[176:179], v[88:91], v[72:75], v[176:179]
    ds_read_b128 v[64:67], v20 offset:0
    s_add_u32 s24, s24, 16384
    v_mfma_f32_16x16x32_bf16 v[140:143], v[88:91], v[68:71], v[140:143]
    s_cmp_eq_u32 s24, 81920
    s_cselect_b32 s24, 0, s24
    v_mfma_f32_16x16x32_bf16 v[144:147], v[92:95], v[68:71], v[144:147]
    s_add_u32 s4, s4, 18432
    s_cmp_eq_u32 s4, 73728
    v_mfma_f32_16x16x32_bf16 v[180:183], v[92:95], v[72:75], v[180:183]
    s_cselect_b32 s4, 0, s4
    s_sub_u32 s59, s59, 1
    v_mfma_f32_16x16x32_bf16 v[184:187], v[96:99], v[72:75], v[184:187]
    s_cmp_lg_u32 s59, 0
    v_mfma_f32_16x16x32_bf16 v[148:151], v[96:99], v[68:71], v[148:151]
    v_mfma_f32_16x16x32_bf16 v[152:155], v[100:103], v[68:71], v[152:155]
    v_mfma_f32_16x16x32_bf16 v[188:191], v[100:103], v[72:75], v[188:191]
    v_mfma_f32_16x16x32_bf16 v[192:195], v[104:107], v[72:75], v[192:195]
    v_mfma_f32_16x16x32_bf16 v[156:159], v[104:107], v[68:71], v[156:159]
    v_mfma_f32_16x16x32_bf16 v[160:163], v[108:111], v[68:71], v[160:163]
    v_mfma_f32_16x16x32_bf16 v[196:199], v[108:111], v[72:75], v[196:199]
    s_cbranch_scc1 g2_mm_loop
    s_waitcnt lgkmcnt(0)
    v_mfma_f32_16x16x32_bf16 v[128:131], v[32:35], v[24:27], v[128:131]
    ds_read_b128 v[76:79], v18 offset:9216
    ds_read_b64_tr_b16 v[68:69], v16 offset:8192
    v_mfma_f32_16x16x32_bf16 v[164:167], v[32:35], v[28:31], v[164:167]
    ds_read_b64_tr_b16 v[70:71], v16 offset:12288
    ds_read_b64_tr_b16 v[72:73], v17 offset:8192
    v_mfma_f32_16x16x32_bf16 v[168:171], v[36:39], v[28:31], v[168:171]
    ds_read_b64_tr_b16 v[74:75], v17 offset:12288
    ds_read_b128 v[80:83], v18 offset:10240
    v_mfma_f32_16x16x32_bf16 v[132:135], v[36:39], v[24:27], v[132:135]
    ds_read_b128 v[84:87], v18 offset:11264
    ds_read_b128 v[88:91], v18 offset:12288
    v_mfma_f32_16x16x32_bf16 v[136:139], v[40:43], v[24:27], v[136:139]
    ds_read_b128 v[92:95], v19 offset:9216
    ds_read_b128 v[96:99], v19 offset:10240
    v_mfma_f32_16x16x32_bf16 v[172:175], v[40:43], v[28:31], v[172:175]
    ds_read_b128 v[100:103], v19 offset:11264
    ds_read_b128 v[104:107], v19 offset:12288
    v_mfma_f32_16x16x32_bf16 v[176:179], v[44:47], v[28:31], v[176:179]
    ds_read_b128 v[108:111], v20 offset:9216
    v_mfma_f32_16x16x32_bf16 v[140:143], v[44:47], v[24:27], v[140:143]
    v_mfma_f32_16x16x32_bf16 v[144:147], v[48:51], v[24:27], v[144:147]
    v_mfma_f32_16x16x32_bf16 v[180:183], v[48:51], v[28:31], v[180:183]
    v_mfma_f32_16x16x32_bf16 v[184:187], v[52:55], v[28:31], v[184:187]
    v_mfma_f32_16x16x32_bf16 v[148:151], v[52:55], v[24:27], v[148:151]
    v_mfma_f32_16x16x32_bf16 v[152:155], v[56:59], v[24:27], v[152:155]
    v_mfma_f32_16x16x32_bf16 v[188:191], v[56:59], v[28:31], v[188:191]
    v_mfma_f32_16x16x32_bf16 v[192:195], v[60:63], v[28:31], v[192:195]
    v_mfma_f32_16x16x32_bf16 v[156:159], v[60:63], v[24:27], v[156:159]
    v_mfma_f32_16x16x32_bf16 v[160:163], v[64:67], v[24:27], v[160:163]
    v_mfma_f32_16x16x32_bf16 v[196:199], v[64:67], v[28:31], v[196:199]
    s_waitcnt lgkmcnt(0)
    v_mfma_f32_16x16x32_bf16 v[128:131], v[76:79], v[68:71], v[128:131]
    v_mfma_f32_16x16x32_bf16 v[164:167], v[76:79], v[72:75], v[164:167]
    v_mfma_f32_16x16x32_bf16 v[168:171], v[80:83], v[72:75], v[168:171]
    v_mfma_f32_16x16x32_bf16 v[132:135], v[80:83], v[68:71], v[132:135]
    v_mfma_f32_16x16x32_bf16 v[136:139], v[84:87], v[68:71], v[136:139]
    v_mfma_f32_16x16x32_bf16 v[172:175], v[84:87], v[72:75], v[172:175]
    v_mfma_f32_16x16x32_bf16 v[176:179], v[88:91], v[72:75], v[176:179]
    v_mfma_f32_16x16x32_bf16 v[140:143], v[88:91], v[68:71], v[140:143]
    v_mfma_f32_16x16x32_bf16 v[144:147], v[92:95], v[68:71], v[144:147]
    v_mfma_f32_16x16x32_bf16 v[180:183], v[92:95], v[72:75], v[180:183]
    v_mfma_f32_16x16x32_bf16 v[184:187], v[96:99], v[72:75], v[184:187]
    v_mfma_f32_16x16x32_bf16 v[148:151], v[96:99], v[68:71], v[148:151]
    v_mfma_f32_16x16x32_bf16 v[152:155], v[100:103], v[68:71], v[152:155]
    v_mfma_f32_16x16x32_bf16 v[188:191], v[100:103], v[72:75], v[188:191]
    v_mfma_f32_16x16x32_bf16 v[192:195], v[104:107], v[72:75], v[192:195]
    v_mfma_f32_16x16x32_bf16 v[156:159], v[104:107], v[68:71], v[156:159]
    v_mfma_f32_16x16x32_bf16 v[160:163], v[108:111], v[68:71], v[160:163]
    v_mfma_f32_16x16x32_bf16 v[196:199], v[108:111], v[72:75], v[196:199]
    s_cmp_eq_u32 s48, 1
    s_cbranch_scc0 g2_noswap
    s_nop 4
    v_swap_b32 v160, v162
    v_swap_b32 v161, v163
    v_swap_b32 v196, v198
    v_swap_b32 v197, v199
g2_noswap:
    v_cvt_pk_bf16_f32 v112, v144, v145
    v_cvt_pk_bf16_f32 v113, v146, v147
    v_cvt_pk_bf16_f32 v114, v148, v149
    buffer_store_dwordx4 v[112:115], v14, s[28:31], s61 offen offset:0 sc1
    v_cvt_pk_bf16_f32 v116, v150, v151
    v_cvt_pk_bf16_f32 v117, v152, v153
    v_cvt_pk_bf16_f32 v118, v154, v155
    buffer_store_dwordx4 v[116:119], v14, s[28:31], s61 offen offset:1024 sc1
    v_cvt_pk_bf16_f32 v120, v156, v157
    v_cvt_pk_bf16_f32 v121, v158, v159
    v_cvt_pk_bf16_f32 v122, v162, v163
    buffer_store_dwordx4 v[120:123], v14, s[28:31], s61 offen offset:2048 sc1
    v_cvt_pk_bf16_f32 v232, v164, v165
    v_cvt_pk_bf16_f32 v233, v166, v167
    v_cvt_pk_bf16_f32 v234, v168, v169
    buffer_store_dwordx4 v[232:235], v14, s[28:31], s62 offen offset:0 sc1
    v_cvt_pk_bf16_f32 v236, v170, v171
    v_cvt_pk_bf16_f32 v237, v172, v173
    v_cvt_pk_bf16_f32 v238, v174, v175
    buffer_store_dwordx4 v[236:239], v14, s[28:31], s62 offen offset:1024 sc1
    v_cvt_pk_bf16_f32 v240, v176, v177
    v_cvt_pk_bf16_f32 v241, v178, v179
    v_cvt_pk_bf16_f32 v242, v196, v197
    buffer_store_dwordx4 v[240:243], v14, s[28:31], s62 offen offset:2048 sc1
    v_cvt_pk_bf16_f32 v244, v180, v181
    v_cvt_pk_bf16_f32 v245, v182, v183
    v_cvt_pk_bf16_f32 v246, v184, v185
    buffer_store_dwordx4 v[244:247], v14, s[28:31], s63 offen offset:0 sc1
    v_cvt_pk_bf16_f32 v248, v186, v187
    v_cvt_pk_bf16_f32 v249, v188, v189
    v_cvt_pk_bf16_f32 v250, v190, v191
    buffer_store_dwordx4 v[248:251], v14, s[28:31], s63 offen offset:1024 sc1
    v_cvt_pk_bf16_f32 v252, v192, v193
    v_cvt_pk_bf16_f32 v253, v194, v195
    v_cvt_pk_bf16_f32 v254, v198, v199
    buffer_store_dwordx4 v[252:255], v14, s[28:31], s63 offen offset:2048 sc1
    s_mov_b32 s42, 0xffff0000
    s_waitcnt vmcnt(9)
    v_add_f32 v128, v128, v230
    v_add_f32 v129, v129, v230
    v_add_f32 v130, v130, v230
    v_add_f32 v131, v131, v230
    v_add_f32 v132, v132, v230
    v_add_f32 v133, v133, v230
    v_add_f32 v134, v134, v230
    v_add_f32 v135, v135, v230
    v_add_f32 v136, v136, v230
    v_add_f32 v137, v137, v230
    v_add_f32 v138, v138, v230
    v_add_f32 v139, v139, v230
    v_add_f32 v140, v140, v230
    v_add_f32 v141, v141, v230
    v_add_f32 v142, v142, v230
    v_add_f32 v143, v143, v230
    v_add_f32 v160, v160, v230
    v_add_f32 v161, v161, v230
    v_lshlrev_b32 v32, 16, v200
    v_and_b32 v33, s42, v200
    v_lshlrev_b32 v34, 16, v201
    v_and_b32 v35, s42, v201
    v_lshlrev_b32 v36, 16, v202
    v_and_b32 v37, s42, v202
    v_lshlrev_b32 v38, 16, v203
    v_and_b32 v39, s42, v203
    v_lshlrev_b32 v40, 16, v204
    v_and_b32 v41, s42, v204
    v_lshlrev_b32 v42, 16, v205
    v_and_b32 v43, s42, v205
    v_lshlrev_b32 v44, 16, v206
    v_and_b32 v45, s42, v206
    v_lshlrev_b32 v46, 16, v207
    v_and_b32 v47, s42, v207
    v_lshlrev_b32 v48, 16, v208
    v_and_b32 v49, s42, v208
    s_mov_b32 s49, 0
    s_mov_b64 s[40:41], 7
g2_scout:
    s_mov_b64 exec, s[40:41]
    buffer_load_dword v2, v23, s[28:31], 0 offen offset:3068 sc1
    s_add_u32 s49, s49, 1
    s_waitcnt vmcnt(0)
    v_cmp_eq_u32 vcc, s26, v2
    s_mov_b64 exec, -1
    s_bitcmp1_b32 vcc_lo, 0
    s_cbranch_scc0 g2_sc1
    buffer_load_dwordx4 v[68:71], v14, s[28:31], s5 offen offset:0 sc1
    buffer_load_dwordx4 v[72:75], v14, s[28:31], s5 offen offset:1024 sc1
    buffer_load_dwordx4 v[76:79], v14, s[28:31], s5 offen offset:2048 sc1
g2_sc1:
    s_bitcmp1_b32 vcc_lo, 1
    s_cbranch_scc0 g2_sc2
    buffer_load_dwordx4 v[80:83], v14, s[28:31], s6 offen offset:0 sc1
    buffer_load_dwordx4 v[84:87], v14, s[28:31], s6 offen offset:1024 sc1
    buffer_load_dwordx4 v[88:91], v14, s[28:31], s6 offen offset:2048 sc1
g2_sc2:
    s_bitcmp1_b32 vcc_lo, 2
    s_cbranch_scc0 g2_sc3
    buffer_load_dwordx4 v[92:95], v14, s[28:31], s7 offen offset:0 sc1
    buffer_load_dwordx4 v[96:99], v14, s[28:31], s7 offen offset:1024 sc1
    buffer_load_dwordx4 v[100:103], v14, s[28:31], s7 offen offset:2048 sc1
g2_sc3:
    s_andn2_b32 s40, s40, vcc_lo
    s_cbranch_scc0 g2_check
    s_cmp_lt_u32 s49, 30000
    s_cbranch_scc1 g2_scout
g2_poll:
    buffer_load_dwordx4 v[68:71], v14, s[28:31], s5 offen offset:0 sc1
    buffer_load_dwordx4 v[72:75], v14, s[28:31], s5 offen offset:1024 sc1
    buffer_load_dwordx4 v[76:79], v14, s[28:31], s5 offen offset:2048 sc1
    buffer_load_dwordx4 v[80:83], v14, s[28:31], s6 offen offset:0 sc1
    buffer_load_dwordx4 v[84:87], v14, s[28:31], s6 offen offset:1024 sc1
    buffer_load_dwordx4 v[88:91], v14, s[28:31], s6 offen offset:2048 sc1
    buffer_load_dwordx4 v[92:95], v14, s[28:31], s7 offen offset:0 sc1
    buffer_load_dwordx4 v[96:99], v14, s[28:31], s7 offen offset:1024 sc1
    buffer_load_dwordx4 v[100:103], v14, s[28:31], s7 offen offset:2048 sc1
    s_add_u32 s49, s49, 1
g2_check:
    s_waitcnt vmcnt(0)
    v_xor_b32 v24, s26, v71
    v_xor_b32 v25, s26, v75
    v_xor_b32 v26, s26, v79
    v_xor_b32 v27, s26, v83
    v_xor_b32 v28, s26, v87
    v_xor_b32 v29, s26, v91
    v_xor_b32 v30, s26, v95
    v_xor_b32 v31, s26, v99
    v_xor_b32 v2, s26, v103
    v_or3_b32 v24, v24, v25, v26
    v_or3_b32 v27, v27, v28, v29
    v_or3_b32 v30, v30, v31, v2
    v_or3_b32 v24, v24, v27, v30
    v_cmp_ne_u32 vcc, 0, v24
    s_nop 0
    s_and_b64 exec, vcc, vcc
    s_cbranch_scc0 g2_ready
    s_cmp_lt_u32 s49, 30000
    s_cbranch_scc1 g2_poll
g2_ready:
    s_mov_b64 exec, -1
    v_lshlrev_b32 v24, 16, v68
    v_and_b32 v25, s42, v68
    v_pk_add_f32 v[128:129], v[128:129], v[24:25]
    v_lshlrev_b32 v26, 16, v69
    v_and_b32 v27, s42, v69
    v_pk_add_f32 v[130:131], v[130:131], v[26:27]
    v_lshlrev_b32 v24, 16, v70
    v_and_b32 v25, s42, v70
    v_pk_add_f32 v[132:133], v[132:133], v[24:25]
    v_lshlrev_b32 v26, 16, v72
    v_and_b32 v27, s42, v72
    v_pk_add_f32 v[134:135], v[134:135], v[26:27]
    v_lshlrev_b32 v24, 16, v73
    v_and_b32 v25, s42, v73
    v_pk_add_f32 v[136:137], v[136:137], v[24:25]
    v_lshlrev_b32 v26, 16, v74
    v_and_b32 v27, s42, v74
    v_pk_add_f32 v[138:139], v[138:139], v[26:27]
    v_lshlrev_b32 v24, 16, v76
    v_and_b32 v25, s42, v76
    v_pk_add_f32 v[140:141], v[140:141], v[24:25]
    v_lshlrev_b32 v26, 16, v77
    v_and_b32 v27, s42, v77
    v_pk_add_f32 v[142:143], v[142:143], v[26:27]
    v_lshlrev_b32 v24, 16, v78
    v_and_b32 v25, s42, v78
    v_pk_add_f32 v[160:161], v[160:161], v[24:25]
    v_lshlrev_b32 v24, 16, v80
    v_and_b32 v25, s42, v80
    v_pk_add_f32 v[128:129], v[128:129], v[24:25]
    v_lshlrev_b32 v26, 16, v81
    v_and_b32 v27, s42, v81
    v_pk_add_f32 v[130:131], v[130:131], v[26:27]
    v_lshlrev_b32 v24, 16, v82
    v_and_b32 v25, s42, v82
    v_pk_add_f32 v[132:133], v[132:133], v[24:25]
    v_lshlrev_b32 v26, 16, v84
    v_and_b32 v27, s42, v84
    v_pk_add_f32 v[134:135], v[134:135], v[26:27]
    v_lshlrev_b32 v24, 16, v85
    v_and_b32 v25, s42, v85
    v_pk_add_f32 v[136:137], v[136:137], v[24:25]
    v_lshlrev_b32 v26, 16, v86
    v_and_b32 v27, s42, v86
    v_pk_add_f32 v[138:139], v[138:139], v[26:27]
    v_lshlrev_b32 v24, 16, v88
    v_and_b32 v25, s42, v88
    v_pk_add_f32 v[140:141], v[140:141], v[24:25]
    v_lshlrev_b32 v26, 16, v89
    v_and_b32 v27, s42, v89
    v_pk_add_f32 v[142:143], v[142:143], v[26:27]
    v_lshlrev_b32 v24, 16, v90
    v_and_b32 v25, s42, v90
    v_pk_add_f32 v[160:161], v[160:161], v[24:25]
    v_lshlrev_b32 v24, 16, v92
    v_and_b32 v25, s42, v92
    v_pk_add_f32 v[128:129], v[128:129], v[24:25]
    v_lshlrev_b32 v26, 16, v93
    v_and_b32 v27, s42, v93
    v_pk_add_f32 v[130:131], v[130:131], v[26:27]
    v_lshlrev_b32 v24, 16, v94
    v_and_b32 v25, s42, v94
    v_pk_add_f32 v[132:133], v[132:133], v[24:25]
    v_lshlrev_b32 v26, 16, v96
    v_and_b32 v27, s42, v96
    v_pk_add_f32 v[134:135], v[134:135], v[26:27]
    v_lshlrev_b32 v24, 16, v97
    v_and_b32 v25, s42, v97
    v_pk_add_f32 v[136:137], v[136:137], v[24:25]
    v_lshlrev_b32 v26, 16, v98
    v_and_b32 v27, s42, v98
    v_pk_add_f32 v[138:139], v[138:139], v[26:27]
    v_lshlrev_b32 v24, 16, v100
    v_and_b32 v25, s42, v100
    v_pk_add_f32 v[140:141], v[140:141], v[24:25]
    v_lshlrev_b32 v26, 16, v101
    v_and_b32 v27, s42, v101
    v_pk_add_f32 v[142:143], v[142:143], v[26:27]
    v_lshlrev_b32 v24, 16, v102
    v_and_b32 v25, s42, v102
    v_pk_add_f32 v[160:161], v[160:161], v[24:25]
    v_pk_fma_f32 v[128:129], v[128:129], v[210:211], v[32:33]
    v_cvt_pk_bf16_f32 v68, v128, v129
    v_pk_fma_f32 v[130:131], v[130:131], v[212:213], v[34:35]
    v_cvt_pk_bf16_f32 v69, v130, v131
    buffer_store_dwordx2 v[68:69], v22, s[16:19], s52 offen offset:0
    v_pk_fma_f32 v[132:133], v[132:133], v[214:215], v[36:37]
    v_cvt_pk_bf16_f32 v70, v132, v133
    v_pk_fma_f32 v[134:135], v[134:135], v[216:217], v[38:39]
    v_cvt_pk_bf16_f32 v71, v134, v135
    buffer_store_dwordx2 v[70:71], v22, s[16:19], s52 offen offset:32
    v_pk_fma_f32 v[136:137], v[136:137], v[218:219], v[40:41]
    v_cvt_pk_bf16_f32 v72, v136, v137
    v_pk_fma_f32 v[138:139], v[138:139], v[220:221], v[42:43]
    v_cvt_pk_bf16_f32 v73, v138, v139
    buffer_store_dwordx2 v[72:73], v22, s[16:19], s52 offen offset:64
    v_pk_fma_f32 v[140:141], v[140:141], v[222:223], v[44:45]
    v_cvt_pk_bf16_f32 v74, v140, v141
    v_pk_fma_f32 v[142:143], v[142:143], v[224:225], v[46:47]
    v_cvt_pk_bf16_f32 v75, v142, v143
    buffer_store_dwordx2 v[74:75], v22, s[16:19], s52 offen offset:96
    v_pk_fma_f32 v[160:161], v[160:161], v[226:227], v[48:49]
    v_cvt_pk_bf16_f32 v76, v160, v161
    buffer_store_dword v76, v22, s[16:19], s53 offen
t_end:
f_done:
    s_endpgm
f_end:
.section .rodata,"a"
.p2align 6
.amdhsa_kernel f_kernel
  .amdhsa_next_free_vgpr 256
  .amdhsa_next_free_sgpr 102
  .amdhsa_accum_offset 256
  .amdhsa_group_segment_fixed_size 0
  .amdhsa_kernarg_size 104
  .amdhsa_user_sgpr_count 2
  .amdhsa_user_sgpr_kernarg_segment_ptr 1
  .amdhsa_system_sgpr_workgroup_id_x 1
.end_amdhsa_kernel
```
